```python
import torch

def _softmax(x, axis=-1):
    return torch.softmax(x, dim=axis)
def _gelu(x):
    return torch.nn.functional.gelu(x, approximate="tanh")
def _silu(x):
    return torch.nn.functional.silu(x)
def _sigmoid(x):
    return torch.sigmoid(x)
def _layernorm(x, axis=-1, eps=1e-5):
    m = x.mean(dim=axis, keepdim=True)
    v = x.var(dim=axis, keepdim=True, unbiased=False)
    return (x - m) / torch.sqrt(v + eps)
def _scatter_add(tgt, idx, src, axis=0):
    return tgt.clone().index_add_(axis, idx, src)
def _segment_sum(src, seg, n):
    out = torch.zeros((n,) + src.shape[1:], dtype=src.dtype)
    return out.index_add_(0, seg, src)
def _pad(x, pw):
    flat = tuple(v for pair in reversed(pw) for v in pair)
    return torch.nn.functional.pad(x, flat)

kernel_name = 'concat_heads__spectral_fnet__grouped_kv_mqa__prompt'

def setup_inputs():

    _w = (lambda a: (lambda t: t.to(torch.bfloat16) if t.is_floating_point() else t)(torch.as_tensor(a)))
    def _A_setup():
        B, S, D = 1, 2048, 1024
        ns = torch.arange(S)[:, None] * torch.arange(S)[None, :]
        nd = torch.arange(D)[:, None] * torch.arange(D)[None, :]
        Ws_re = torch.cos(-2.0 * torch.pi * ns / S).to(float)
        Ws_im = torch.sin(-2.0 * torch.pi * ns / S).to(float)
        Wd_re = torch.cos(-2.0 * torch.pi * nd / D).to(float)
        Wd_im = torch.sin(-2.0 * torch.pi * nd / D).to(float)
        return {
            "x": _w((lambda *s: torch.randn(*s, dtype=torch.bfloat16) * 0.05)(B, S, D)),
            "dft_seq_re": _w(Ws_re),
            "dft_seq_im": _w(Ws_im),
            "dft_hid_re": _w(Wd_re),
            "dft_hid_im": _w(Wd_im),
        }
    _A_in = _A_setup()

    def _B_setup():
        B, S, D, H = 1, 2048, 1024, 32
        Dh = D // H
        return {
            "x": _w((lambda *s: torch.randn(*s, dtype=torch.bfloat16) * 0.05)(B, S, D)),
            "wq": _w((lambda *s: torch.randn(*s, dtype=torch.bfloat16) * 3.2)(D, H * Dh)),
            "wk": _w((lambda *s: torch.randn(*s, dtype=torch.bfloat16) * 3.2)(D, Dh)),
            "wv": _w((lambda *s: torch.randn(*s, dtype=torch.bfloat16) * 0.4)(D, Dh)),
            "wo": _w((lambda *s: torch.randn(*s, dtype=torch.bfloat16) * 0.4)(H * Dh, D)),
        }
    _B_in = _B_setup()

    return {
        "A_x": _A_in["x"],
        "A_dft_seq_re": _A_in["dft_seq_re"],
        "A_dft_seq_im": _A_in["dft_seq_im"],
        "A_dft_hid_re": _A_in["dft_hid_re"],
        "A_dft_hid_im": _A_in["dft_hid_im"],
        "B_x": _B_in["x"],
        "B_wq": _B_in["wq"],
        "B_wk": _B_in["wk"],
        "B_wv": _B_in["wv"],
        "B_wo": _B_in["wo"],
    }

def reference(A_x, A_dft_seq_re, A_dft_seq_im, A_dft_hid_re, A_dft_hid_im, B_x, B_wq, B_wk, B_wv, B_wo):
    def _A_ref(x, dft_seq_re, dft_seq_im, dft_hid_re, dft_hid_im):
        a = torch.einsum("bsd,ed->bse", x, dft_hid_re)
        b = torch.einsum("bsd,ed->bse", x, dft_hid_im)
        y = torch.einsum("ts,bse->bte", dft_seq_re, a) - torch.einsum("ts,bse->bte", dft_seq_im, b)
        return y

    def _B_ref(x, wq, wk, wv, wo):
        B, S, D = x.shape
        H = 32
        Dh = D // H
        q = (lambda x, *d: x.permute(*d))((x @ wq).reshape(B, S, H, Dh), 0, 2, 1, 3)
        k = x @ wk
        v = x @ wv
        scores = torch.einsum("bhqd,bkd->bhqk", q, k) * (Dh ** -0.5)
        p = _softmax(scores, axis=-1)
        o = torch.einsum("bhqk,bkd->bhqd", p, v)
        return (lambda x, *d: x.permute(*d))(o, 0, 2, 1, 3).reshape(B, S, H * Dh) @ wo

    a = _A_ref(A_x, A_dft_seq_re, A_dft_seq_im, A_dft_hid_re, A_dft_hid_im)
    b = _B_ref(B_x, B_wq, B_wk, B_wv, B_wo)
    return torch.concatenate([a, b], axis=-1)
```

```asm
; @launch grid=(256,1,1) block=(256,1,1) lds=163840
.amdgcn_target "amdgcn-amd-amdhsa--gfx950"
.text
.globl concat_heads__spectral_fnet__grouped_kv_mqa__prompt_kernel
.p2align 8
.type concat_heads__spectral_fnet__grouped_kv_mqa__prompt_kernel,@function
concat_heads__spectral_fnet__grouped_kv_mqa__prompt_kernel:
 s_cmp_ge_u32 s2, 256
 s_cbranch_scc1 Lend
 s_load_dwordx16 s[4:19], s[0:1], 0
 s_load_dwordx8 s[20:27], s[0:1], 64
 s_load_dwordx2 s[28:29], s[0:1], 96
 v_lshrrev_b32 v1, 6, v0
 v_and_b32 v250, 63, v0
 v_readfirstlane_b32 s30, v1
 v_lshlrev_b32 v230, 4, v250
 s_and_b32 s31, s2, 7
 s_lshr_b32 s32, s2, 3
 s_lshl_b32 s80, s32, 2
 s_add_u32 s80, s80, s30
 s_lshl_b32 s80, s80, 10
 s_cmp_ge_u32 s80, Lcode_end-Lpc1
 s_cbranch_scc1 Lnopf
 s_getpc_b64 s[82:83]
Lpc1:
 v_add_u32 v13, s80, v230
 global_load_dwordx4 v[246:249], v13, s[82:83]
Lnopf:
 s_lshl2_add_u32 s98, s31, s30
 s_and_b32 s80, s32, 7
 s_lshr_b32 s81, s31, 1
 s_lshl3_add_u32 s33, s81, s80
 s_lshr_b32 s81, s32, 3
 s_and_b32 s82, s31, 1
 s_lshl2_add_u32 s34, s82, s81
 s_lshl1_add_u32 s80, s81, s80
 s_lshl_b32 s80, s80, 1
 s_and_b32 s35, s80, 15
 s_lshr_b32 s80, s31, 1
 s_mul_i32 s35, s80, 4
 s_and_b32 s80, s31, 1
 s_mul_i32 s80, s80, 8
 s_add_u32 s35, s35, s80
 s_lshr_b32 s80, s32, 3
 s_mul_i32 s80, s80, 2
 s_add_u32 s35, s35, s80
 s_and_b32 s80, s32, 7
 s_mul_i32 s80, s80, 1
 s_lshr_b32 s80, s80, 1
 s_add_u32 s35, s35, s80
 s_and_b32 s35, s35, 15
 v_lshrrev_b32 v1, 5, v250
 v_lshrrev_b32 v2, 4, v250
 v_and_b32 v7, 31, v250
 v_and_b32 v9, 15, v250
 v_xor_b32 v8, v7, v1
 v_lshlrev_b32 v8, 4, v8
 v_lshl_or_b32 v128, v1, 11, v8
 v_xor_b32 v129, 32, v128
 v_add_u32 v129, 3072, v129
 v_xor_b32 v130, 64, v128
 v_add_u32 v130, 6144, v130
 v_xor_b32 v131, 96, v128
 v_add_u32 v131, 9216, v131
 v_xor_b32 v132, 128, v128
 v_add_u32 v132, 16384, v132
 v_xor_b32 v133, 160, v128
 v_add_u32 v133, 19456, v133
 v_xor_b32 v134, 192, v128
 v_add_u32 v134, 22528, v134
 v_xor_b32 v135, 224, v128
 v_add_u32 v135, 25600, v135
 s_lshl_b32 s82, s30, 13
 s_add_u32 s82, s82, 114688
 s_mov_b32 s83, 49152
 s_cmp_eq_u32 s30, 1
 s_cselect_b32 s83, 147456, s83
 s_cmp_eq_u32 s30, 2
 s_cselect_b32 s83, 81920, s83
 s_cmp_eq_u32 s30, 3
 s_cselect_b32 s83, 65536, s83
 s_lshr_b32 s80, s34, 1
 s_lshl2_add_u32 s80, s33, s80
 s_lshl_b32 s84, s80, 15
 s_lshl_b32 s80, s30, 9
 s_add_u32 s84, s84, s80
 s_lshl_b32 s85, s30, 14
 v_lshlrev_b32 v10, 2, v2
 v_xor_b32 v10, v10, v9
 v_lshlrev_b32 v10, 4, v10
 v_lshl_or_b32 v238, v2, 11, v10
 v_add_u32 v239, 7168, v238
 v_xor_b32 v10, 32, v238
 v_add_u32 v240, 14336, v10
 v_add_u32 v241, 21504, v10
 s_lshl_b32 s67, s30, 12
 s_lshl_b32 s68, s30, 11
 s_add_u32 s68, s68, 98304
 s_lshl2_add_u32 s80, s35, s30
 s_lshl_b32 s80, s80, 7
 s_add_u32 s80, s80, s34
 s_lshl_b32 s65, s80, 8
 s_lshl_b32 s66, s35, 7
 s_and_b32 s101, s32, 7
 s_lshr_b32 s80, s32, 4
 s_lshl3_add_u32 s101, s80, s101
 s_lshl_b32 s101, s101, 10
 s_waitcnt lgkmcnt(0)
 s_bitcmp1_b32 s34, 0
 s_cselect_b32 s60, s20, s18
 s_cselect_b32 s61, s21, s19
 s_and_b32 s61, s61, 0xffff
 s_mov_b32 s62, 65536
 s_mov_b32 s63, 0x20000
 s_add_u32 m0, s83, s101
 s_add_u32 s93, s85, s101
 buffer_load_dwordx4 v230, s[60:63], s93 offen lds
 s_add_u32 s101, s101, 1024
 s_and_b32 s101, s101, 0x3fff
 s_mov_b32 s36, s14
 s_and_b32 s37, s15, 0xffff
 s_mov_b32 s38, 4194304
 s_mov_b32 s39, 0x20000
 s_add_u32 m0, s83, s101
 s_add_u32 s93, s85, s101
 buffer_load_dwordx4 v230, s[60:63], s93 offen lds
 s_add_u32 s101, s101, 1024
 s_and_b32 s101, s101, 0x3fff
 s_add_u32 m0, s83, s101
 s_add_u32 s93, s85, s101
 buffer_load_dwordx4 v230, s[60:63], s93 offen lds
 s_add_u32 s101, s101, 1024
 s_and_b32 s101, s101, 0x3fff
 s_add_u32 m0, s83, s101
 s_add_u32 s93, s85, s101
 buffer_load_dwordx4 v230, s[60:63], s93 offen lds
 s_add_u32 s101, s101, 1024
 s_and_b32 s101, s101, 0x3fff
 s_add_u32 m0, s82, 0
 s_nop 0
 buffer_load_dwordx4 v128, s[36:39], s84 offen offset:0  lds
 s_mov_b32 s40, s16
 s_and_b32 s41, s17, 0xffff
 s_mov_b32 s42, 2097152
 s_mov_b32 s43, 0x20000
 buffer_load_dwordx4 v129, s[36:39], s84 offen offset:1024  lds
 s_mov_b32 s44, s28
 s_and_b32 s45, s29, 0xffff
 s_mov_b32 s46, 268435456
 s_mov_b32 s47, 0x20000
 s_mov_b32 s99, 262144
 buffer_load_dwordx4 v130, s[36:39], s84 offen offset:2048  lds
 v_bfe_u32 v3, v250, 2, 2
 v_and_b32 v4, 1, v250
 v_bfe_u32 v5, v250, 1, 1
 v_and_b32 v6, 1, v2
 v_lshlrev_b32 v245, 2, v7
 v_lshrrev_b32 v11, 3, v250
 buffer_load_dwordx4 v131, s[36:39], s84 offen offset:3072  lds
 s_and_b32 s80, s30, 1
 s_lshl1_add_u32 s80, s33, s80
 s_lshl_b32 s80, s80, 16
 s_lshr_b32 s81, s30, 1
 s_lshl_b32 s81, s81, 6
 s_add_u32 s80, s80, s81
 v_lshrrev_b32 v12, 2, v250
 v_and_b32 v13, 3, v250
 v_sub_u32 v14, 0, v2
 v_xor_b32 v14, v13, v14
 v_and_b32 v14, 3, v14
 v_lshlrev_b32 v14, 4, v14
 v_lshl_or_b32 v14, v12, 11, v14
 v_add_u32 v242, s80, v14
 v_add_u32 v243, 31744, v242
 s_add_u32 m0, s82, 4096
 s_nop 0
 buffer_load_dwordx4 v132, s[36:39], s84 offen offset:0  lds
 v_xor_b32 v13, v2, v9
 v_lshlrev_b32 v13, 4, v13
 v_lshl_or_b32 v13, v9, 9, v13
 v_add_u32 v136, s82, v13
 v_xor_b32 v14, 64, v13
 v_add_u32 v137, s82, v14
 v_xor_b32 v14, 128, v13
 v_add_u32 v138, s82, v14
 v_xor_b32 v14, 192, v13
 v_add_u32 v139, s82, v14
 buffer_load_dwordx4 v133, s[36:39], s84 offen offset:1024  lds
 v_lshl_add_u32 v13, v2, 3, v3
 v_lshlrev_b32 v13, 6, v13
 v_add_u32 v13, s83, v13
 v_and_b32 v14, 3, v250
 v_lshlrev_b32 v14, 4, v14
 v_lshlrev_b32 v15, 5, v4
 v_lshl_or_b32 v15, v5, 3, v15
 s_bitcmp1_b32 s34, 0
 s_cselect_b64 vcc, -1, 0
 s_cselect_b32 s81, 16, 8
 v_cndmask_b32 v14, v14, v15, vcc
 v_add_u32 v140, v13, v14
 v_add_u32 v141, s81, v140
 buffer_load_dwordx4 v134, s[36:39], s84 offen offset:2048  lds
 v_lshl_add_u32 v14, v6, 5, v9
 v_lshlrev_b32 v14, 4, v14
 v_lshl_or_b32 v14, v1, 10, v14
 v_cndmask_b32 v142, v14, v230, vcc
 v_add_u32 v189, 65536, v230
 v_min_u32 v237, 1, v250
 v_lshlrev_b32 v237, 28, v237
 buffer_load_dwordx4 v135, s[36:39], s84 offen offset:3072  lds
 v_lshl_add_u32 v13, v2, 3, v3
 v_xor_b32 v14, s30, v3
 v_lshl_add_u32 v14, v14, 1, v6
 v_lshl_add_u32 v14, v14, 1, v5
 v_lshl_add_u32 v14, v14, 1, v4
 v_lshlrev_b32 v14, 3, v14
 v_lshl_or_b32 v233, v13, 8, v14
 v_add_u32 v234, 49152, v233
 v_xor_b32 v190, 32, v233
 v_xor_b32 v191, 32, v234
 buffer_load_dword v143, off, s[44:47], s99 sc1
 s_add_u32 m0, s83, s101
 s_add_u32 s93, s85, s101
 buffer_load_dwordx4 v230, s[60:63], s93 offen lds
 s_add_u32 s101, s101, 1024
 s_and_b32 s101, s101, 0x3fff
 v_sub_u32 v13, 0, v3
 v_xor_b32 v13, v13, v2
 v_and_b32 v13, 3, v13
 v_lshlrev_b32 v13, 4, v13
 v_lshl_or_b32 v13, v9, 6, v13
 v_add_u32 v235, 98304, v13
 v_lshl_add_u32 v13, v1, 3, v3
 v_lshl_add_u32 v14, v6, 1, v4
 v_lshrrev_b32 v15, 1, v3
 v_lshl_add_u32 v14, v14, 1, v15
 v_lshl_add_u32 v14, v14, 1, v5
 v_lshlrev_b32 v14, 3, v14
 v_lshl_or_b32 v13, v13, 7, v14
 s_add_u32 s74, s67, 147456
 v_add_u32 v228, s74, v13
 v_xor_b32 v229, 16, v228
 s_add_u32 m0, s83, s101
 s_add_u32 s93, s85, s101
 buffer_load_dwordx4 v230, s[60:63], s93 offen lds
 s_add_u32 s101, s101, 1024
 s_and_b32 s101, s101, 0x3fff
 v_xor_b32 v13, v4, v6
 v_bfe_u32 v14, v250, 1, 2
 v_lshlrev_b32 v15, 4, v14
 v_lshl_or_b32 v15, v11, 16, v15
 v_lshl_or_b32 v231, v13, 21, v15
 v_lshlrev_b32 v15, 9, v14
 v_lshl_or_b32 v15, v11, 12, v15
 v_lshl_or_b32 v232, v13, 4, v15
 v_lshrrev_b32 v13, 2, v250
 v_and_b32 v14, 3, v250
 v_lshlrev_b32 v14, 4, v14
 v_lshl_or_b32 v231, v13, 16, v14
 v_lshl_add_u32 v13, v1, 3, v3
 v_lshl_add_u32 v14, v6, 1, v4
 v_lshl_add_u32 v14, v14, 1, v5
 v_lshlrev_b32 v14, 3, v14
 v_lshl_or_b32 v13, v13, 6, v14
 v_add_u32 v192, s74, v13
 s_add_u32 m0, s83, s101
 s_add_u32 s93, s85, s101
 buffer_load_dwordx4 v230, s[60:63], s93 offen lds
 s_add_u32 s101, s101, 1024
 s_and_b32 s101, s101, 0x3fff
 s_mov_b32 s48, s24
 s_and_b32 s49, s25, 0xffff
 s_mov_b32 s50, 8388608
 s_mov_b32 s51, 0x20000
 s_mov_b32 s52, s4
 s_and_b32 s53, s5, 0xffff
 s_mov_b32 s54, 4194304
 s_mov_b32 s55, 0x20000
 s_getpc_b64 s[56:57]
 s_add_u32 s56, s56, fn_tables@rel32@lo+4
 s_addc_u32 s57, s57, fn_tables@rel32@hi+12
 s_and_b32 s57, s57, 0xffff
 s_mov_b32 s58, 287744
 s_mov_b32 s59, 0x20000
 s_add_u32 m0, s83, s101
 s_add_u32 s93, s85, s101
 buffer_load_dwordx4 v230, s[60:63], s93 offen lds
 s_add_u32 s101, s101, 1024
 s_and_b32 s101, s101, 0x3fff
 s_lshl3_add_u32 s97, s33, s34
 s_lshl_b32 s97, s97, 2
 s_add_u32 s97, s97, 266240
 s_lshl_b32 s72, s31, 15
 s_add_u32 s72, s72, s67
 s_add_u32 s73, s72, 16384
 s_lshl_b32 s75, s32, 5
 s_add_u32 s75, s75, s98
 s_lshl_b32 s88, s75, 2
 s_add_u32 s88, s88, 274432
 s_lshl_b32 s87, s75, 12
 s_add_u32 s87, s87, 12582912
 s_lshl_b32 s75, s75, 6
 s_lshl_b32 s76, s98, 5
 s_add_u32 s76, s76, s32
 s_lshl_b32 s77, s76, 2
 s_add_u32 s77, s77, 270336
 s_lshl_b32 s76, s76, 12
 s_add_u32 s76, s76, 8388608
 s_lshl_b32 s78, s98, 7
 s_add_u32 s78, s78, 270336
 s_lshl_b32 s89, s32, 7
 s_add_u32 s89, s89, 274432
 s_lshl_b32 s79, s32, 13
 s_add_u32 s79, s79, 25600
 s_add_u32 m0, s83, s101
 s_add_u32 s93, s85, s101
 buffer_load_dwordx4 v230, s[60:63], s93 offen lds
 s_add_u32 s101, s101, 1024
 s_and_b32 s101, s101, 0x3fff
 s_lshl_b32 s86, s98, 17
 s_lshr_b32 s81, s32, 4
 s_lshl_b32 s81, s81, 11
 s_add_u32 s86, s86, s81
 s_and_b32 s81, s32, 15
 s_lshl_b32 s81, s81, 5
 s_add_u32 s86, s86, s81
 s_add_u32 s86, s86, 8388608
 s_add_u32 m0, s83, s101
 s_add_u32 s93, s85, s101
 buffer_load_dwordx4 v230, s[60:63], s93 offen lds
 s_add_u32 s101, s101, 1024
 s_and_b32 s101, s101, 0x3fff
 s_lshl_b32 s90, s32, 17
 s_lshr_b32 s81, s98, 4
 s_lshl_b32 s81, s81, 11
 s_add_u32 s90, s90, s81
 s_and_b32 s81, s98, 15
 s_lshl_b32 s81, s81, 5
 s_add_u32 s90, s90, s81
 s_add_u32 s90, s90, 12582912
 s_add_u32 m0, s83, s101
 s_add_u32 s93, s85, s101
 buffer_load_dwordx4 v230, s[60:63], s93 offen lds
 s_add_u32 s101, s101, 1024
 s_and_b32 s101, s101, 0x3fff
 s_lshl_b32 s81, s98, 6
 s_add_u32 s91, s81, s32
 s_sub_u32 s92, s81, 992
 s_cmp_lt_u32 s98, 16
 s_cselect_b32 s81, s81, s92
 s_cmp_eq_u32 s32, 0
 s_cselect_b32 s91, s81, s91
 s_lshl2_add_u32 s81, s34, s30
 s_lshl_b32 s92, s33, 5
 s_add_u32 s92, s92, s81
 s_lshl_b32 s94, s92, 2
 s_add_u32 s94, s94, 294912
 s_lshl_b32 s92, s92, 12
 s_add_u32 s92, s92, 1048576
 s_add_u32 m0, s83, s101
 s_add_u32 s93, s85, s101
 buffer_load_dwordx4 v230, s[60:63], s93 offen lds
 s_add_u32 s101, s101, 1024
 s_and_b32 s101, s101, 0x3fff
 s_lshl_b32 s95, s33, 7
 s_add_u32 s95, s95, 294912
 s_lshl_b32 s69, s30, 7
 s_add_u32 s69, s69, s34
 s_lshl_b32 s69, s69, 8
 s_lshl_b32 s70, s34, 14
 s_add_u32 s71, s70, 8192
 s_and_b32 s80, s32, 7
 s_lshl_b32 s80, s80, 1
 s_cmp_eq_u32 s80, 14
 s_cselect_b32 s80, 0, s80
 s_lshl1_add_u32 s81, s34, 2
 s_add_u32 m0, s83, s101
 s_add_u32 s93, s85, s101
 buffer_load_dwordx4 v230, s[60:63], s93 offen lds
 s_add_u32 s101, s101, 1024
 s_and_b32 s101, s101, 0x3fff
 s_add_u32 s4, s80, s81
 s_and_b32 s4, s4, 15
 s_lshl_b32 s4, s4, 13
 s_add_u32 s80, s80, 1
 s_cmp_eq_u32 s80, 14
 s_cselect_b32 s80, 0, s80
 s_add_u32 s5, s80, s81
 s_and_b32 s5, s5, 15
 s_lshl_b32 s5, s5, 13
 s_add_u32 s80, s80, 1
 s_cmp_eq_u32 s80, 14
 s_cselect_b32 s80, 0, s80
 s_add_u32 s14, s80, s81
 s_and_b32 s14, s14, 15
 s_lshl_b32 s14, s14, 13
 s_add_u32 s80, s80, 1
 s_cmp_eq_u32 s80, 14
 s_cselect_b32 s80, 0, s80
 s_add_u32 s15, s80, s81
 s_and_b32 s15, s15, 15
 s_lshl_b32 s15, s15, 13
 s_add_u32 s80, s80, 1
 s_cmp_eq_u32 s80, 14
 s_cselect_b32 s80, 0, s80
 s_add_u32 m0, s83, s101
 s_add_u32 s93, s85, s101
 buffer_load_dwordx4 v230, s[60:63], s93 offen lds
 s_add_u32 s101, s101, 1024
 s_and_b32 s101, s101, 0x3fff
 s_add_u32 s18, s80, s81
 s_and_b32 s18, s18, 15
 s_lshl_b32 s18, s18, 13
 s_add_u32 s80, s80, 1
 s_cmp_eq_u32 s80, 14
 s_cselect_b32 s80, 0, s80
 s_add_u32 s19, s80, s81
 s_and_b32 s19, s19, 15
 s_lshl_b32 s19, s19, 13
 s_add_u32 s80, s80, 1
 s_cmp_eq_u32 s80, 14
 s_cselect_b32 s80, 0, s80
 s_add_u32 s20, s80, s81
 s_and_b32 s20, s20, 15
 s_lshl_b32 s20, s20, 13
 s_add_u32 s80, s80, 1
 s_cmp_eq_u32 s80, 14
 s_cselect_b32 s80, 0, s80
 s_add_u32 s21, s80, s81
 s_and_b32 s21, s21, 15
 s_lshl_b32 s21, s21, 13
 s_add_u32 s80, s80, 1
 s_cmp_eq_u32 s80, 14
 s_cselect_b32 s80, 0, s80
 s_add_u32 m0, s83, s101
 s_add_u32 s93, s85, s101
 buffer_load_dwordx4 v230, s[60:63], s93 offen lds
 s_add_u32 s101, s101, 1024
 s_and_b32 s101, s101, 0x3fff
 s_add_u32 s24, s80, s81
 s_and_b32 s24, s24, 15
 s_lshl_b32 s24, s24, 13
 s_add_u32 s80, s80, 1
 s_cmp_eq_u32 s80, 14
 s_cselect_b32 s80, 0, s80
 s_add_u32 s25, s80, s81
 s_and_b32 s25, s25, 15
 s_lshl_b32 s25, s25, 13
 s_add_u32 s80, s80, 1
 s_cmp_eq_u32 s80, 14
 s_cselect_b32 s80, 0, s80
 s_add_u32 s28, s80, s81
 s_and_b32 s28, s28, 15
 s_lshl_b32 s28, s28, 13
 s_add_u32 s80, s80, 1
 s_cmp_eq_u32 s80, 14
 s_cselect_b32 s80, 0, s80
 s_add_u32 s29, s80, s81
 s_and_b32 s29, s29, 15
 s_lshl_b32 s29, s29, 13
 s_add_u32 s80, s80, 1
 s_cmp_eq_u32 s80, 14
 s_cselect_b32 s80, 0, s80
 s_add_u32 m0, s83, s101
 s_add_u32 s93, s85, s101
 buffer_load_dwordx4 v230, s[60:63], s93 offen lds
 s_add_u32 s101, s101, 1024
 s_and_b32 s101, s101, 0x3fff
 s_add_u32 s35, s80, s81
 s_and_b32 s35, s35, 15
 s_lshl_b32 s35, s35, 13
 s_add_u32 s80, s80, 1
 s_cmp_eq_u32 s80, 14
 s_cselect_b32 s80, 0, s80
 s_add_u32 s17, s80, s81
 s_and_b32 s17, s17, 15
 s_lshl_b32 s17, s17, 13
 s_add_u32 s80, s80, 1
 s_cmp_eq_u32 s80, 14
 s_cselect_b32 s80, 0, s80
 s_add_u32 m0, s67, 0
 s_nop 0
 buffer_load_dwordx4 v238, s[40:43], s65 offen offset:0  lds
 buffer_load_dwordx4 v239, s[40:43], s65 offen offset:1024  lds
 s_waitcnt vmcnt(2)
 ds_read_b128 v[0:3], v136 offset:0
 ds_read_b64_tr_b16 v[64:65], v140 offset:0
 ds_read_b64_tr_b16 v[66:67], v140 offset:256
 ds_read_b64_tr_b16 v[68:69], v141 offset:0
 ds_read_b64_tr_b16 v[70:71], v141 offset:256
 v_readfirstlane_b32 s64, v143
 buffer_load_dwordx4 v240, s[40:43], s65 offen offset:2048  lds
 ds_read_b128 v[4:7], v137 offset:0
 ds_read_b64_tr_b16 v[72:73], v140 offset:2048
 ds_read_b64_tr_b16 v[74:75], v140 offset:2304
 ds_read_b64_tr_b16 v[76:77], v141 offset:2048
 ds_read_b64_tr_b16 v[78:79], v141 offset:2304
 s_mul_i32 s64, s64, 0x9e3779b1
 s_add_u32 s64, s64, 0x7f4a7c15
 buffer_load_dwordx4 v241, s[40:43], s65 offen offset:3072  lds
 ds_read_b128 v[8:11], v138 offset:0
 ds_read_b64_tr_b16 v[80:81], v140 offset:4096
 ds_read_b64_tr_b16 v[82:83], v140 offset:4352
 ds_read_b64_tr_b16 v[84:85], v141 offset:4096
 ds_read_b64_tr_b16 v[86:87], v141 offset:4352
 s_add_u32 s65, s65, 0x20000
 s_and_b32 s65, s65, 0x1fffff
 s_add_u32 m0, s68, 0
 s_nop 0
 buffer_load_dwordx4 v242, s[36:39], s66 offen offset:0  lds
 ds_read_b128 v[12:15], v139 offset:0
 ds_read_b64_tr_b16 v[88:89], v140 offset:6144
 ds_read_b64_tr_b16 v[90:91], v140 offset:6400
 ds_read_b64_tr_b16 v[92:93], v141 offset:6144
 ds_read_b64_tr_b16 v[94:95], v141 offset:6400
 buffer_load_dwordx4 v243, s[36:39], s66 offen offset:1024  lds
 ds_read_b128 v[16:19], v136 offset:256
 ds_read_b64_tr_b16 v[96:97], v140 offset:8192
 ds_read_b64_tr_b16 v[98:99], v140 offset:8448
 ds_read_b64_tr_b16 v[100:101], v141 offset:8192
 ds_read_b64_tr_b16 v[102:103], v141 offset:8448
 s_add_u32 s66, s66, 128
 s_and_b32 s66, s66, 2047
 s_add_u32 m0, s67, 16384
 s_nop 0
 buffer_load_dwordx4 v238, s[40:43], s65 offen offset:0  lds
 ds_read_b128 v[20:23], v137 offset:256
 ds_read_b64_tr_b16 v[104:105], v140 offset:10240
 ds_read_b64_tr_b16 v[106:107], v140 offset:10496
 ds_read_b64_tr_b16 v[108:109], v141 offset:10240
 ds_read_b64_tr_b16 v[110:111], v141 offset:10496
 buffer_load_dwordx4 v239, s[40:43], s65 offen offset:1024  lds
 ds_read_b128 v[24:27], v138 offset:256
 ds_read_b64_tr_b16 v[112:113], v140 offset:12288
 ds_read_b64_tr_b16 v[114:115], v140 offset:12544
 ds_read_b64_tr_b16 v[116:117], v141 offset:12288
 ds_read_b64_tr_b16 v[118:119], v141 offset:12544
 buffer_load_dwordx4 v240, s[40:43], s65 offen offset:2048  lds
 ds_read_b128 v[28:31], v139 offset:256
 ds_read_b64_tr_b16 v[120:121], v140 offset:14336
 ds_read_b64_tr_b16 v[122:123], v140 offset:14592
 ds_read_b64_tr_b16 v[124:125], v141 offset:14336
 ds_read_b64_tr_b16 v[126:127], v141 offset:14592
 buffer_load_dwordx4 v241, s[40:43], s65 offen offset:3072  lds
 s_waitcnt lgkmcnt(15)
 s_bitcmp1_b32 s34, 0
 s_cbranch_scc1 Lkv_v
 v_mfma_f32_16x16x32_bf16 v[32:35], v[64:67], v[0:3], 0
 v_mfma_f32_16x16x32_bf16 v[36:39], v[68:71], v[0:3], 0
 s_add_u32 s65, s65, 0x20000
 s_and_b32 s65, s65, 0x1fffff
 s_add_u32 m0, s68, 8192
 s_nop 0
 buffer_load_dwordx4 v242, s[36:39], s66 offen offset:0  lds
 v_mfma_f32_16x16x32_bf16 v[32:35], v[72:75], v[4:7], v[32:35]
 v_mfma_f32_16x16x32_bf16 v[36:39], v[76:79], v[4:7], v[36:39]
 v_mfma_f32_16x16x32_bf16 v[32:35], v[80:83], v[8:11], v[32:35]
 v_mfma_f32_16x16x32_bf16 v[36:39], v[84:87], v[8:11], v[36:39]
 buffer_load_dwordx4 v243, s[36:39], s66 offen offset:1024  lds
 v_mfma_f32_16x16x32_bf16 v[32:35], v[88:91], v[12:15], v[32:35]
 v_mfma_f32_16x16x32_bf16 v[36:39], v[92:95], v[12:15], v[36:39]
 v_mfma_f32_16x16x32_bf16 v[32:35], v[96:99], v[16:19], v[32:35]
 v_mfma_f32_16x16x32_bf16 v[36:39], v[100:103], v[16:19], v[36:39]
 s_add_u32 s66, s66, 128
 s_and_b32 s66, s66, 2047
 s_add_u32 m0, s67, 32768
 s_nop 0
 buffer_load_dwordx4 v238, s[40:43], s65 offen offset:0  lds
 s_waitcnt lgkmcnt(0)
 v_mfma_f32_16x16x32_bf16 v[32:35], v[104:107], v[20:23], v[32:35]
 v_mfma_f32_16x16x32_bf16 v[36:39], v[108:111], v[20:23], v[36:39]
 v_mfma_f32_16x16x32_bf16 v[32:35], v[112:115], v[24:27], v[32:35]
 v_mfma_f32_16x16x32_bf16 v[36:39], v[116:119], v[24:27], v[36:39]
 buffer_load_dwordx4 v239, s[40:43], s65 offen offset:1024  lds
 v_mfma_f32_16x16x32_bf16 v[32:35], v[120:123], v[28:31], v[32:35]
 v_mfma_f32_16x16x32_bf16 v[36:39], v[124:127], v[28:31], v[36:39]
 s_branch Lkv_j
Lkv_v:
 v_mfma_f32_16x16x32_bf16 v[32:35], v[0:3], v[64:67], 0
 v_mfma_f32_16x16x32_bf16 v[36:39], v[0:3], v[68:71], 0
 s_add_u32 s65, s65, 0x20000
 s_and_b32 s65, s65, 0x1fffff
 s_add_u32 m0, s68, 8192
 s_nop 0
 buffer_load_dwordx4 v242, s[36:39], s66 offen offset:0  lds
 v_mfma_f32_16x16x32_bf16 v[32:35], v[4:7], v[72:75], v[32:35]
 v_mfma_f32_16x16x32_bf16 v[36:39], v[4:7], v[76:79], v[36:39]
 v_mfma_f32_16x16x32_bf16 v[32:35], v[8:11], v[80:83], v[32:35]
 v_mfma_f32_16x16x32_bf16 v[36:39], v[8:11], v[84:87], v[36:39]
 buffer_load_dwordx4 v243, s[36:39], s66 offen offset:1024  lds
 v_mfma_f32_16x16x32_bf16 v[32:35], v[12:15], v[88:91], v[32:35]
 v_mfma_f32_16x16x32_bf16 v[36:39], v[12:15], v[92:95], v[36:39]
 v_mfma_f32_16x16x32_bf16 v[32:35], v[16:19], v[96:99], v[32:35]
 v_mfma_f32_16x16x32_bf16 v[36:39], v[16:19], v[100:103], v[36:39]
 s_add_u32 s66, s66, 128
 s_and_b32 s66, s66, 2047
 s_add_u32 m0, s67, 32768
 s_nop 0
 buffer_load_dwordx4 v238, s[40:43], s65 offen offset:0  lds
 s_waitcnt lgkmcnt(0)
 v_mfma_f32_16x16x32_bf16 v[32:35], v[20:23], v[104:107], v[32:35]
 v_mfma_f32_16x16x32_bf16 v[36:39], v[20:23], v[108:111], v[36:39]
 v_mfma_f32_16x16x32_bf16 v[32:35], v[24:27], v[112:115], v[32:35]
 v_mfma_f32_16x16x32_bf16 v[36:39], v[24:27], v[116:119], v[36:39]
 buffer_load_dwordx4 v239, s[40:43], s65 offen offset:1024  lds
 v_mfma_f32_16x16x32_bf16 v[32:35], v[28:31], v[120:123], v[32:35]
 v_mfma_f32_16x16x32_bf16 v[36:39], v[28:31], v[124:127], v[36:39]
Lkv_j:
 s_waitcnt lgkmcnt(0)
 s_cmp_eq_u32 s30, 3
 s_cselect_b32 s81, s82, s83
 v_add_u32 v13, s81, v230
 buffer_load_dwordx4 v240, s[40:43], s65 offen offset:2048  lds
 buffer_load_dwordx4 v241, s[40:43], s65 offen offset:3072  lds
 s_add_u32 s65, s65, 0x20000
 s_and_b32 s65, s65, 0x1fffff
 s_cmp_eq_u32 s30, 0
 s_cbranch_scc1 Lkv_nw
 s_nop 3
 ds_write_b128 v13, v[32:35]
 ds_write_b128 v13, v[36:39] offset:1024
 s_waitcnt lgkmcnt(0)
Lkv_nw:
 s_barrier
 s_cmp_lg_u32 s30, 0
 s_cbranch_scc1 Lkv_done
 v_add_u32 v13, 81920, v230
 v_add_u32 v14, 139264, v230
 ds_read_b128 v[40:43], v13
 ds_read_b128 v[44:47], v13 offset:1024
 ds_read_b128 v[48:51], v14
 ds_read_b128 v[52:55], v14 offset:1024
 ds_read_b128 v[56:59], v14 offset:8192
 ds_read_b128 v[60:63], v14 offset:9216
 s_lshr_b32 s81, s34, 2
 s_lshl1_add_u32 s80, s33, s81
 s_lshl_b32 s80, s80, 12
 s_bfe_u32 s81, s34, 0x10001
 s_lshl_b32 s82, s81, 8
 s_lshl_b32 s81, s81, 10
 s_add_u32 s81, s81, 2048
 s_bitcmp1_b32 s34, 0
 s_cselect_b32 s81, s81, s82
 s_cselect_b32 s82, 1.0, 0x3e8293ee
 s_mov_b32 s83, s82
 s_add_u32 s80, s80, s81
 s_waitcnt lgkmcnt(4)
 v_pk_add_f32 v[32:33], v[32:33], v[40:41]
 v_pk_add_f32 v[34:35], v[34:35], v[42:43]
 v_pk_add_f32 v[36:37], v[36:37], v[44:45]
 v_pk_add_f32 v[38:39], v[38:39], v[46:47]
 s_waitcnt lgkmcnt(2)
 v_pk_add_f32 v[32:33], v[32:33], v[48:49]
 v_pk_add_f32 v[34:35], v[34:35], v[50:51]
 v_pk_add_f32 v[36:37], v[36:37], v[52:53]
 v_pk_add_f32 v[38:39], v[38:39], v[54:55]
 s_waitcnt lgkmcnt(0)
 v_pk_add_f32 v[32:33], v[32:33], v[56:57]
 v_pk_add_f32 v[34:35], v[34:35], v[58:59]
 v_pk_add_f32 v[36:37], v[36:37], v[60:61]
 v_pk_add_f32 v[38:39], v[38:39], v[62:63]
 v_pk_mul_f32 v[32:33], v[32:33], s[82:83]
 v_pk_mul_f32 v[34:35], v[34:35], s[82:83]
 v_pk_mul_f32 v[36:37], v[36:37], s[82:83]
 v_pk_mul_f32 v[38:39], v[38:39], s[82:83]
 v_cvt_pk_bf16_f32 v40, v32, v33
 v_cvt_pk_bf16_f32 v41, v34, v35
 v_cvt_pk_bf16_f32 v42, v36, v37
 v_cvt_pk_bf16_f32 v43, v38, v39
 s_bitcmp1_b32 s34, 0
 s_cbranch_scc0 Lkv_st
 v_permlane16_swap_b32 v40, v42
 v_permlane16_swap_b32 v41, v43
Lkv_st:
 buffer_store_dwordx4 v[40:43], v142, s[44:47], s80 offen sc1
Lkv_done:
 s_add_u32 m0, s68, 16384
 s_nop 0
 buffer_load_dwordx4 v242, s[36:39], s66 offen offset:0  lds
 buffer_load_dwordx4 v243, s[36:39], s66 offen offset:1024  lds
 s_add_u32 s66, s66, 128
 s_and_b32 s66, s66, 2047
 s_add_u32 m0, s67, 49152
 s_nop 0
 buffer_load_dwordx4 v238, s[40:43], s65 offen offset:0  lds
 buffer_load_dwordx4 v239, s[40:43], s65 offen offset:1024  lds
 buffer_load_dwordx4 v240, s[40:43], s65 offen offset:2048  lds
 buffer_load_dwordx4 v241, s[40:43], s65 offen offset:3072  lds
 s_add_u32 s65, s65, 0x20000
 s_and_b32 s65, s65, 0x1fffff
 s_add_u32 m0, s68, 24576
 s_nop 0
 buffer_load_dwordx4 v242, s[36:39], s66 offen offset:0  lds
 buffer_load_dwordx4 v243, s[36:39], s66 offen offset:1024  lds
 s_add_u32 s66, s66, 128
 s_and_b32 s66, s66, 2047
 s_add_u32 m0, s67, 65536
 s_nop 0
 buffer_load_dwordx4 v238, s[40:43], s65 offen offset:0  lds
 buffer_load_dwordx4 v239, s[40:43], s65 offen offset:1024  lds
 buffer_load_dwordx4 v240, s[40:43], s65 offen offset:2048  lds
 s_waitcnt vmcnt(21)
 s_barrier
 ds_read_b128 v[40:43], v235 offset:0
 ds_read_b64_tr_b16 v[32:33], v233 offset:0
 ds_read_b128 v[44:47], v235 offset:1024
 ds_read_b64_tr_b16 v[34:35], v233 offset:1024
 ds_read_b128 v[48:51], v235 offset:2048
 ds_read_b64_tr_b16 v[36:37], v190 offset:0
 ds_read_b128 v[52:55], v235 offset:3072
 ds_read_b64_tr_b16 v[38:39], v190 offset:1024
 ds_read_b128 v[204:207], v235 offset:4096
 ds_read_b64_tr_b16 v[196:197], v233 offset:8192
 ds_read_b128 v[208:211], v235 offset:5120
 ds_read_b64_tr_b16 v[198:199], v233 offset:9216
 ds_read_b128 v[212:215], v235 offset:6144
 ds_read_b64_tr_b16 v[200:201], v190 offset:8192
 ds_read_b128 v[216:219], v235 offset:7168
 ds_read_b64_tr_b16 v[202:203], v190 offset:9216
 buffer_load_dwordx4 v241, s[40:43], s65 offen offset:3072  lds
 s_add_u32 s65, s65, 0x20000
 s_and_b32 s65, s65, 0x1fffff
 s_add_u32 m0, s68, 32768
 s_nop 0
 buffer_load_dwordx4 v242, s[36:39], s66 offen offset:0  lds
 buffer_load_dwordx4 v243, s[36:39], s66 offen offset:1024  lds
 s_add_u32 s66, s66, 128
 s_and_b32 s66, s66, 2047
 s_waitcnt lgkmcnt(8)
 v_mfma_f32_16x16x32_bf16 v[0:3], v[32:35], v[40:43], 0
 s_waitcnt vmcnt(18)
 s_barrier
 ds_read_b128 v[160:163], v235 offset:8192
 v_mfma_f32_16x16x32_bf16 v[4:7], v[36:39], v[40:43], 0
 ds_read_b64_tr_b16 v[152:153], v233 offset:16384
 s_add_u32 m0, s67, 81920
 v_mfma_f32_16x16x32_bf16 v[8:11], v[32:35], v[44:47], 0
 ds_read_b128 v[164:167], v235 offset:9216
 v_mfma_f32_16x16x32_bf16 v[12:15], v[36:39], v[44:47], 0
 ds_read_b64_tr_b16 v[154:155], v233 offset:17408
 buffer_load_dwordx4 v238, s[40:43], s65 offen offset:0  lds
 v_mfma_f32_16x16x32_bf16 v[16:19], v[32:35], v[48:51], 0
 ds_read_b128 v[168:171], v235 offset:10240
 v_mfma_f32_16x16x32_bf16 v[20:23], v[36:39], v[48:51], 0
 ds_read_b64_tr_b16 v[156:157], v190 offset:16384
 buffer_load_dwordx4 v239, s[40:43], s65 offen offset:1024  lds
 v_mfma_f32_16x16x32_bf16 v[24:27], v[32:35], v[52:55], 0
 ds_read_b128 v[172:175], v235 offset:11264
 v_mfma_f32_16x16x32_bf16 v[28:31], v[36:39], v[52:55], 0
 ds_read_b64_tr_b16 v[158:159], v190 offset:17408
 s_cmp_eq_u32 s30, 0
 s_cbranch_scc1 Lkvflag
Lkvflag_b:
 buffer_load_dwordx4 v240, s[40:43], s65 offen offset:2048  lds
 s_waitcnt lgkmcnt(8)
 v_mfma_f32_16x16x32_bf16 v[0:3], v[196:199], v[204:207], v[0:3]
 ds_read_b128 v[40:43], v235 offset:12288
 v_mfma_f32_16x16x32_bf16 v[4:7], v[200:203], v[204:207], v[4:7]
 ds_read_b64_tr_b16 v[32:33], v233 offset:24576
 buffer_load_dwordx4 v241, s[40:43], s65 offen offset:3072  lds
 s_add_u32 s65, s65, 0x20000
 s_and_b32 s65, s65, 0x1fffff
 s_add_u32 m0, s68, 40960
 v_mfma_f32_16x16x32_bf16 v[8:11], v[196:199], v[208:211], v[8:11]
 ds_read_b128 v[44:47], v235 offset:13312
 v_mfma_f32_16x16x32_bf16 v[12:15], v[200:203], v[208:211], v[12:15]
 ds_read_b64_tr_b16 v[34:35], v233 offset:25600
 buffer_load_dwordx4 v242, s[36:39], s66 offen offset:0  lds
 v_mfma_f32_16x16x32_bf16 v[16:19], v[196:199], v[212:215], v[16:19]
 ds_read_b128 v[48:51], v235 offset:14336
 v_mfma_f32_16x16x32_bf16 v[20:23], v[200:203], v[212:215], v[20:23]
 ds_read_b64_tr_b16 v[36:37], v190 offset:24576
 buffer_load_dwordx4 v243, s[36:39], s66 offen offset:1024  lds
 s_add_u32 s66, s66, 128
 s_and_b32 s66, s66, 2047
 v_mfma_f32_16x16x32_bf16 v[24:27], v[196:199], v[216:219], v[24:27]
 ds_read_b128 v[52:55], v235 offset:15360
 v_mfma_f32_16x16x32_bf16 v[28:31], v[200:203], v[216:219], v[28:31]
 ds_read_b64_tr_b16 v[38:39], v190 offset:25600
 s_waitcnt lgkmcnt(8)
 v_mfma_f32_16x16x32_bf16 v[0:3], v[152:155], v[160:163], v[0:3]
 s_waitcnt vmcnt(18)
 s_barrier
 ds_read_b128 v[204:207], v235 offset:16384
 v_mfma_f32_16x16x32_bf16 v[4:7], v[156:159], v[160:163], v[4:7]
 ds_read_b64_tr_b16 v[196:197], v233 offset:32768
 s_add_u32 m0, s67, 0
 v_mfma_f32_16x16x32_bf16 v[8:11], v[152:155], v[164:167], v[8:11]
 ds_read_b128 v[208:211], v235 offset:17408
 v_mfma_f32_16x16x32_bf16 v[12:15], v[156:159], v[164:167], v[12:15]
 ds_read_b64_tr_b16 v[198:199], v233 offset:33792
 buffer_load_dwordx4 v238, s[40:43], s65 offen offset:0  lds
 v_mfma_f32_16x16x32_bf16 v[16:19], v[152:155], v[168:171], v[16:19]
 ds_read_b128 v[212:215], v235 offset:18432
 v_mfma_f32_16x16x32_bf16 v[20:23], v[156:159], v[168:171], v[20:23]
 ds_read_b64_tr_b16 v[200:201], v190 offset:32768
 buffer_load_dwordx4 v239, s[40:43], s65 offen offset:1024  lds
 v_mfma_f32_16x16x32_bf16 v[24:27], v[152:155], v[172:175], v[24:27]
 ds_read_b128 v[216:219], v235 offset:19456
 v_mfma_f32_16x16x32_bf16 v[28:31], v[156:159], v[172:175], v[28:31]
 ds_read_b64_tr_b16 v[202:203], v190 offset:33792
 buffer_load_dwordx4 v240, s[40:43], s65 offen offset:2048  lds
 s_waitcnt lgkmcnt(8)
 v_mfma_f32_16x16x32_bf16 v[0:3], v[32:35], v[40:43], v[0:3]
 ds_read_b128 v[160:163], v235 offset:20480
 v_mfma_f32_16x16x32_bf16 v[4:7], v[36:39], v[40:43], v[4:7]
 ds_read_b64_tr_b16 v[152:153], v233 offset:40960
 buffer_load_dwordx4 v241, s[40:43], s65 offen offset:3072  lds
 s_add_u32 s65, s65, 0x20000
 s_and_b32 s65, s65, 0x1fffff
 s_add_u32 m0, s68, 0
 v_mfma_f32_16x16x32_bf16 v[8:11], v[32:35], v[44:47], v[8:11]
 ds_read_b128 v[164:167], v235 offset:21504
 v_mfma_f32_16x16x32_bf16 v[12:15], v[36:39], v[44:47], v[12:15]
 ds_read_b64_tr_b16 v[154:155], v233 offset:41984
 buffer_load_dwordx4 v242, s[36:39], s66 offen offset:0  lds
 v_mfma_f32_16x16x32_bf16 v[16:19], v[32:35], v[48:51], v[16:19]
 ds_read_b128 v[168:171], v235 offset:22528
 v_mfma_f32_16x16x32_bf16 v[20:23], v[36:39], v[48:51], v[20:23]
 ds_read_b64_tr_b16 v[156:157], v190 offset:40960
 buffer_load_dwordx4 v243, s[36:39], s66 offen offset:1024  lds
 s_add_u32 s66, s66, 128
 s_and_b32 s66, s66, 2047
 v_mfma_f32_16x16x32_bf16 v[24:27], v[32:35], v[52:55], v[24:27]
 ds_read_b128 v[172:175], v235 offset:23552
 v_mfma_f32_16x16x32_bf16 v[28:31], v[36:39], v[52:55], v[28:31]
 ds_read_b64_tr_b16 v[158:159], v190 offset:41984
 s_waitcnt lgkmcnt(8)
 v_mfma_f32_16x16x32_bf16 v[0:3], v[196:199], v[204:207], v[0:3]
 s_waitcnt vmcnt(18)
 s_barrier
 ds_read_b128 v[40:43], v235 offset:24576
 v_mfma_f32_16x16x32_bf16 v[4:7], v[200:203], v[204:207], v[4:7]
 ds_read_b64_tr_b16 v[32:33], v234 offset:0
 s_add_u32 m0, s67, 16384
 v_mfma_f32_16x16x32_bf16 v[8:11], v[196:199], v[208:211], v[8:11]
 ds_read_b128 v[44:47], v235 offset:25600
 v_mfma_f32_16x16x32_bf16 v[12:15], v[200:203], v[208:211], v[12:15]
 ds_read_b64_tr_b16 v[34:35], v234 offset:1024
 buffer_load_dwordx4 v238, s[40:43], s65 offen offset:0  lds
 v_mfma_f32_16x16x32_bf16 v[16:19], v[196:199], v[212:215], v[16:19]
 ds_read_b128 v[48:51], v235 offset:26624
 v_mfma_f32_16x16x32_bf16 v[20:23], v[200:203], v[212:215], v[20:23]
 ds_read_b64_tr_b16 v[36:37], v191 offset:0
 v_mov_b64 v[64:65], 0
 buffer_load_dwordx4 v239, s[40:43], s65 offen offset:1024  lds
 v_mfma_f32_16x16x32_bf16 v[24:27], v[196:199], v[216:219], v[24:27]
 ds_read_b128 v[52:55], v235 offset:27648
 v_mfma_f32_16x16x32_bf16 v[28:31], v[200:203], v[216:219], v[28:31]
 ds_read_b64_tr_b16 v[38:39], v191 offset:1024
 v_mov_b64 v[66:67], 0
 buffer_load_dwordx4 v240, s[40:43], s65 offen offset:2048  lds
 s_waitcnt lgkmcnt(8)
 v_mfma_f32_16x16x32_bf16 v[0:3], v[152:155], v[160:163], v[0:3]
 ds_read_b128 v[204:207], v235 offset:28672
 v_mfma_f32_16x16x32_bf16 v[4:7], v[156:159], v[160:163], v[4:7]
 ds_read_b64_tr_b16 v[196:197], v234 offset:8192
 v_mov_b64 v[68:69], 0
 buffer_load_dwordx4 v241, s[40:43], s65 offen offset:3072  lds
 s_add_u32 s65, s65, 0x20000
 s_and_b32 s65, s65, 0x1fffff
 s_add_u32 m0, s68, 8192
 v_mfma_f32_16x16x32_bf16 v[8:11], v[152:155], v[164:167], v[8:11]
 ds_read_b128 v[208:211], v235 offset:29696
 v_mfma_f32_16x16x32_bf16 v[12:15], v[156:159], v[164:167], v[12:15]
 ds_read_b64_tr_b16 v[198:199], v234 offset:9216
 v_mov_b64 v[70:71], 0
 buffer_load_dwordx4 v242, s[36:39], s66 offen offset:0  lds
 v_mfma_f32_16x16x32_bf16 v[16:19], v[152:155], v[168:171], v[16:19]
 ds_read_b128 v[212:215], v235 offset:30720
 v_mfma_f32_16x16x32_bf16 v[20:23], v[156:159], v[168:171], v[20:23]
 ds_read_b64_tr_b16 v[200:201], v191 offset:8192
 v_mov_b64 v[72:73], 0
 buffer_load_dwordx4 v243, s[36:39], s66 offen offset:1024  lds
 s_add_u32 s66, s66, 128
 s_and_b32 s66, s66, 2047
 v_mfma_f32_16x16x32_bf16 v[24:27], v[152:155], v[172:175], v[24:27]
 ds_read_b128 v[216:219], v235 offset:31744
 v_mfma_f32_16x16x32_bf16 v[28:31], v[156:159], v[172:175], v[28:31]
 ds_read_b64_tr_b16 v[202:203], v191 offset:9216
 v_mov_b64 v[74:75], 0
 s_waitcnt lgkmcnt(8)
 v_mfma_f32_16x16x32_bf16 v[0:3], v[32:35], v[40:43], v[0:3]
 s_waitcnt vmcnt(18)
 s_barrier
 ds_read_b128 v[160:163], v235 offset:32768
 v_mfma_f32_16x16x32_bf16 v[4:7], v[36:39], v[40:43], v[4:7]
 ds_read_b64_tr_b16 v[152:153], v234 offset:16384
 v_mov_b64 v[76:77], 0
 s_add_u32 m0, s67, 32768
 v_mfma_f32_16x16x32_bf16 v[8:11], v[32:35], v[44:47], v[8:11]
 ds_read_b128 v[164:167], v235 offset:33792
 v_mfma_f32_16x16x32_bf16 v[12:15], v[36:39], v[44:47], v[12:15]
 ds_read_b64_tr_b16 v[154:155], v234 offset:17408
 v_mov_b64 v[78:79], 0
 buffer_load_dwordx4 v238, s[40:43], s65 offen offset:0  lds
 v_mfma_f32_16x16x32_bf16 v[16:19], v[32:35], v[48:51], v[16:19]
 ds_read_b128 v[168:171], v235 offset:34816
 v_mfma_f32_16x16x32_bf16 v[20:23], v[36:39], v[48:51], v[20:23]
 ds_read_b64_tr_b16 v[156:157], v191 offset:16384
 v_mov_b64 v[80:81], 0
 buffer_load_dwordx4 v239, s[40:43], s65 offen offset:1024  lds
 v_mfma_f32_16x16x32_bf16 v[24:27], v[32:35], v[52:55], v[24:27]
 ds_read_b128 v[172:175], v235 offset:35840
 v_mfma_f32_16x16x32_bf16 v[28:31], v[36:39], v[52:55], v[28:31]
 ds_read_b64_tr_b16 v[158:159], v191 offset:17408
 v_mov_b64 v[82:83], 0
 buffer_load_dwordx4 v240, s[40:43], s65 offen offset:2048  lds
 s_waitcnt lgkmcnt(8)
 v_mfma_f32_16x16x32_bf16 v[0:3], v[196:199], v[204:207], v[0:3]
 ds_read_b128 v[40:43], v235 offset:36864
 v_mfma_f32_16x16x32_bf16 v[4:7], v[200:203], v[204:207], v[4:7]
 ds_read_b64_tr_b16 v[32:33], v234 offset:24576
 v_mov_b64 v[84:85], 0
 buffer_load_dwordx4 v241, s[40:43], s65 offen offset:3072  lds
 s_add_u32 s65, s65, 0x20000
 s_and_b32 s65, s65, 0x1fffff
 s_add_u32 m0, s68, 16384
 v_mfma_f32_16x16x32_bf16 v[8:11], v[196:199], v[208:211], v[8:11]
 ds_read_b128 v[44:47], v235 offset:37888
 v_mfma_f32_16x16x32_bf16 v[12:15], v[200:203], v[208:211], v[12:15]
 ds_read_b64_tr_b16 v[34:35], v234 offset:25600
 v_mov_b64 v[86:87], 0
 buffer_load_dwordx4 v242, s[36:39], s66 offen offset:0  lds
 v_mfma_f32_16x16x32_bf16 v[16:19], v[196:199], v[212:215], v[16:19]
 ds_read_b128 v[48:51], v235 offset:38912
 v_mfma_f32_16x16x32_bf16 v[20:23], v[200:203], v[212:215], v[20:23]
 ds_read_b64_tr_b16 v[36:37], v191 offset:24576
 v_mov_b64 v[88:89], 0
 buffer_load_dwordx4 v243, s[36:39], s66 offen offset:1024  lds
 s_add_u32 s66, s66, 128
 s_and_b32 s66, s66, 2047
 v_mfma_f32_16x16x32_bf16 v[24:27], v[196:199], v[216:219], v[24:27]
 ds_read_b128 v[52:55], v235 offset:39936
 v_mfma_f32_16x16x32_bf16 v[28:31], v[200:203], v[216:219], v[28:31]
 ds_read_b64_tr_b16 v[38:39], v191 offset:25600
 v_mov_b64 v[90:91], 0
 s_waitcnt lgkmcnt(8)
 v_mfma_f32_16x16x32_bf16 v[0:3], v[152:155], v[160:163], v[0:3]
 s_waitcnt vmcnt(18)
 s_barrier
 ds_read_b128 v[204:207], v235 offset:40960
 v_mfma_f32_16x16x32_bf16 v[4:7], v[156:159], v[160:163], v[4:7]
 ds_read_b64_tr_b16 v[196:197], v234 offset:32768
 v_mov_b64 v[92:93], 0
 s_add_u32 m0, s67, 49152
 v_mfma_f32_16x16x32_bf16 v[8:11], v[152:155], v[164:167], v[8:11]
 ds_read_b128 v[208:211], v235 offset:41984
 v_mfma_f32_16x16x32_bf16 v[12:15], v[156:159], v[164:167], v[12:15]
 ds_read_b64_tr_b16 v[198:199], v234 offset:33792
 v_mov_b64 v[94:95], 0
 buffer_load_dwordx4 v238, s[40:43], s65 offen offset:0  lds
 v_mfma_f32_16x16x32_bf16 v[16:19], v[152:155], v[168:171], v[16:19]
 ds_read_b128 v[212:215], v235 offset:43008
 v_mfma_f32_16x16x32_bf16 v[20:23], v[156:159], v[168:171], v[20:23]
 ds_read_b64_tr_b16 v[200:201], v191 offset:32768
 v_mov_b64 v[96:97], 0
 buffer_load_dwordx4 v239, s[40:43], s65 offen offset:1024  lds
 v_mfma_f32_16x16x32_bf16 v[24:27], v[152:155], v[172:175], v[24:27]
 ds_read_b128 v[216:219], v235 offset:44032
 v_mfma_f32_16x16x32_bf16 v[28:31], v[156:159], v[172:175], v[28:31]
 ds_read_b64_tr_b16 v[202:203], v191 offset:33792
 v_mov_b64 v[98:99], 0
 buffer_load_dwordx4 v240, s[40:43], s65 offen offset:2048  lds
 s_waitcnt lgkmcnt(8)
 v_mfma_f32_16x16x32_bf16 v[0:3], v[32:35], v[40:43], v[0:3]
 ds_read_b128 v[160:163], v235 offset:45056
 v_mfma_f32_16x16x32_bf16 v[4:7], v[36:39], v[40:43], v[4:7]
 ds_read_b64_tr_b16 v[152:153], v234 offset:40960
 v_mov_b64 v[100:101], 0
 buffer_load_dwordx4 v241, s[40:43], s65 offen offset:3072  lds
 s_add_u32 s65, s65, 0x20000
 s_and_b32 s65, s65, 0x1fffff
 s_add_u32 m0, s68, 24576
 v_mfma_f32_16x16x32_bf16 v[8:11], v[32:35], v[44:47], v[8:11]
 ds_read_b128 v[164:167], v235 offset:46080
 v_mfma_f32_16x16x32_bf16 v[12:15], v[36:39], v[44:47], v[12:15]
 ds_read_b64_tr_b16 v[154:155], v234 offset:41984
 v_mov_b64 v[102:103], 0
 buffer_load_dwordx4 v242, s[36:39], s66 offen offset:0  lds
 v_mfma_f32_16x16x32_bf16 v[16:19], v[32:35], v[48:51], v[16:19]
 ds_read_b128 v[168:171], v235 offset:47104
 v_mfma_f32_16x16x32_bf16 v[20:23], v[36:39], v[48:51], v[20:23]
 ds_read_b64_tr_b16 v[156:157], v191 offset:40960
 v_mov_b32 v188, 0xdddddddd
 buffer_load_dwordx4 v243, s[36:39], s66 offen offset:1024  lds
 s_add_u32 s66, s66, 128
 s_and_b32 s66, s66, 2047
 v_mfma_f32_16x16x32_bf16 v[24:27], v[32:35], v[52:55], v[24:27]
 ds_read_b128 v[172:175], v235 offset:48128
 v_mfma_f32_16x16x32_bf16 v[28:31], v[36:39], v[52:55], v[28:31]
 ds_read_b64_tr_b16 v[158:159], v191 offset:41984
 v_mov_b32 v60, 0x3f803f80
 s_waitcnt lgkmcnt(8)
 v_mfma_f32_16x16x32_bf16 v[0:3], v[196:199], v[204:207], v[0:3]
 s_waitcnt vmcnt(18)
 s_barrier
 ds_read_b128 v[40:43], v235 offset:0
 v_mfma_f32_16x16x32_bf16 v[4:7], v[200:203], v[204:207], v[4:7]
 ds_read_b64_tr_b16 v[32:33], v233 offset:0
 v_and_b32 v61, 7, v250
 s_add_u32 m0, s67, 65536
 v_mfma_f32_16x16x32_bf16 v[8:11], v[196:199], v[208:211], v[8:11]
 ds_read_b128 v[44:47], v235 offset:1024
 v_mfma_f32_16x16x32_bf16 v[12:15], v[200:203], v[208:211], v[12:15]
 ds_read_b64_tr_b16 v[34:35], v233 offset:1024
 v_cmp_eq_u32 vcc, 0, v61
 buffer_load_dwordx4 v238, s[40:43], s65 offen offset:0  lds
 v_mfma_f32_16x16x32_bf16 v[16:19], v[196:199], v[212:215], v[16:19]
 ds_read_b128 v[48:51], v235 offset:2048
 v_mfma_f32_16x16x32_bf16 v[20:23], v[200:203], v[212:215], v[20:23]
 ds_read_b64_tr_b16 v[36:37], v190 offset:0
 v_cmp_eq_u32 s[10:11], 4, v61
 buffer_load_dwordx4 v239, s[40:43], s65 offen offset:1024  lds
 v_mfma_f32_16x16x32_bf16 v[24:27], v[196:199], v[216:219], v[24:27]
 ds_read_b128 v[52:55], v235 offset:3072
 v_mfma_f32_16x16x32_bf16 v[28:31], v[200:203], v[216:219], v[28:31]
 ds_read_b64_tr_b16 v[38:39], v190 offset:1024
 s_nop 1
 buffer_load_dwordx4 v240, s[40:43], s65 offen offset:2048  lds
 s_waitcnt lgkmcnt(8)
 v_mfma_f32_16x16x32_bf16 v[0:3], v[152:155], v[160:163], v[0:3]
 ds_read_b128 v[204:207], v235 offset:4096
 v_mfma_f32_16x16x32_bf16 v[4:7], v[156:159], v[160:163], v[4:7]
 ds_read_b64_tr_b16 v[196:197], v233 offset:8192
 v_cndmask_b32 v184, 0, v60, vcc
 buffer_load_dwordx4 v241, s[40:43], s65 offen offset:3072  lds
 s_add_u32 s65, s65, 0x20000
 s_and_b32 s65, s65, 0x1fffff
 s_add_u32 m0, s68, 32768
 v_mfma_f32_16x16x32_bf16 v[8:11], v[152:155], v[164:167], v[8:11]
 ds_read_b128 v[208:211], v235 offset:5120
 v_mfma_f32_16x16x32_bf16 v[12:15], v[156:159], v[164:167], v[12:15]
 ds_read_b64_tr_b16 v[198:199], v233 offset:9216
 v_cndmask_b32 v185, 0, v60, vcc
 buffer_load_dwordx4 v242, s[36:39], s66 offen offset:0  lds
 v_mfma_f32_16x16x32_bf16 v[16:19], v[152:155], v[168:171], v[16:19]
 ds_read_b128 v[212:215], v235 offset:6144
 v_mfma_f32_16x16x32_bf16 v[20:23], v[156:159], v[168:171], v[20:23]
 ds_read_b64_tr_b16 v[200:201], v190 offset:8192
 v_cndmask_b32 v186, 0, v60, s[10:11]
 buffer_load_dwordx4 v243, s[36:39], s66 offen offset:1024  lds
 s_add_u32 s66, s66, 128
 s_and_b32 s66, s66, 2047
 v_mfma_f32_16x16x32_bf16 v[24:27], v[152:155], v[172:175], v[24:27]
 ds_read_b128 v[216:219], v235 offset:7168
 v_mfma_f32_16x16x32_bf16 v[28:31], v[156:159], v[172:175], v[28:31]
 ds_read_b64_tr_b16 v[202:203], v190 offset:9216
 v_cndmask_b32 v187, 0, v60, s[10:11]
 s_waitcnt lgkmcnt(8)
 v_mfma_f32_16x16x32_bf16 v[0:3], v[32:35], v[40:43], v[0:3]
 s_waitcnt vmcnt(18)
 s_barrier
 ds_read_b128 v[160:163], v235 offset:8192
 v_mfma_f32_16x16x32_bf16 v[4:7], v[36:39], v[40:43], v[4:7]
 ds_read_b64_tr_b16 v[152:153], v233 offset:16384
 s_add_u32 m0, s67, 81920
 v_mfma_f32_16x16x32_bf16 v[8:11], v[32:35], v[44:47], v[8:11]
 ds_read_b128 v[164:167], v235 offset:9216
 v_mfma_f32_16x16x32_bf16 v[12:15], v[36:39], v[44:47], v[12:15]
 ds_read_b64_tr_b16 v[154:155], v233 offset:17408
 buffer_load_dwordx4 v238, s[40:43], s65 offen offset:0  lds
 v_mfma_f32_16x16x32_bf16 v[16:19], v[32:35], v[48:51], v[16:19]
 ds_read_b128 v[168:171], v235 offset:10240
 v_mfma_f32_16x16x32_bf16 v[20:23], v[36:39], v[48:51], v[20:23]
 ds_read_b64_tr_b16 v[156:157], v190 offset:16384
 buffer_load_dwordx4 v239, s[40:43], s65 offen offset:1024  lds
 v_mfma_f32_16x16x32_bf16 v[24:27], v[32:35], v[52:55], v[24:27]
 ds_read_b128 v[172:175], v235 offset:11264
 v_mfma_f32_16x16x32_bf16 v[28:31], v[36:39], v[52:55], v[28:31]
 ds_read_b64_tr_b16 v[158:159], v190 offset:17408
 buffer_load_dwordx4 v240, s[40:43], s65 offen offset:2048  lds
 s_waitcnt lgkmcnt(8)
 v_mfma_f32_16x16x32_bf16 v[0:3], v[196:199], v[204:207], v[0:3]
 ds_read_b128 v[40:43], v235 offset:12288
 v_mfma_f32_16x16x32_bf16 v[4:7], v[200:203], v[204:207], v[4:7]
 ds_read_b64_tr_b16 v[32:33], v233 offset:24576
 buffer_load_dwordx4 v241, s[40:43], s65 offen offset:3072  lds
 s_add_u32 s65, s65, 0x20000
 s_and_b32 s65, s65, 0x1fffff
 s_add_u32 m0, s68, 40960
 v_mfma_f32_16x16x32_bf16 v[8:11], v[196:199], v[208:211], v[8:11]
 ds_read_b128 v[44:47], v235 offset:13312
 v_mfma_f32_16x16x32_bf16 v[12:15], v[200:203], v[208:211], v[12:15]
 ds_read_b64_tr_b16 v[34:35], v233 offset:25600
 buffer_load_dwordx4 v242, s[36:39], s66 offen offset:0  lds
 v_mfma_f32_16x16x32_bf16 v[16:19], v[196:199], v[212:215], v[16:19]
 ds_read_b128 v[48:51], v235 offset:14336
 v_mfma_f32_16x16x32_bf16 v[20:23], v[200:203], v[212:215], v[20:23]
 ds_read_b64_tr_b16 v[36:37], v190 offset:24576
 buffer_load_dwordx4 v243, s[36:39], s66 offen offset:1024  lds
 s_add_u32 s66, s66, 128
 s_and_b32 s66, s66, 2047
 v_mfma_f32_16x16x32_bf16 v[24:27], v[196:199], v[216:219], v[24:27]
 ds_read_b128 v[52:55], v235 offset:15360
 v_mfma_f32_16x16x32_bf16 v[28:31], v[200:203], v[216:219], v[28:31]
 ds_read_b64_tr_b16 v[38:39], v190 offset:25600
 s_waitcnt lgkmcnt(8)
 v_mfma_f32_16x16x32_bf16 v[0:3], v[152:155], v[160:163], v[0:3]
 s_waitcnt vmcnt(18)
 s_barrier
 ds_read_b128 v[204:207], v235 offset:16384
 v_mfma_f32_16x16x32_bf16 v[4:7], v[156:159], v[160:163], v[4:7]
 ds_read_b64_tr_b16 v[196:197], v233 offset:32768
 s_add_u32 m0, s67, 0
 v_mfma_f32_16x16x32_bf16 v[8:11], v[152:155], v[164:167], v[8:11]
 ds_read_b128 v[208:211], v235 offset:17408
 v_mfma_f32_16x16x32_bf16 v[12:15], v[156:159], v[164:167], v[12:15]
 ds_read_b64_tr_b16 v[198:199], v233 offset:33792
 buffer_load_dwordx4 v238, s[40:43], s65 offen offset:0  lds
 v_mfma_f32_16x16x32_bf16 v[16:19], v[152:155], v[168:171], v[16:19]
 ds_read_b128 v[212:215], v235 offset:18432
 v_mfma_f32_16x16x32_bf16 v[20:23], v[156:159], v[168:171], v[20:23]
 ds_read_b64_tr_b16 v[200:201], v190 offset:32768
 buffer_load_dwordx4 v239, s[40:43], s65 offen offset:1024  lds
 v_mfma_f32_16x16x32_bf16 v[24:27], v[152:155], v[172:175], v[24:27]
 ds_read_b128 v[216:219], v235 offset:19456
 v_mfma_f32_16x16x32_bf16 v[28:31], v[156:159], v[172:175], v[28:31]
 ds_read_b64_tr_b16 v[202:203], v190 offset:33792
 buffer_load_dwordx4 v240, s[40:43], s65 offen offset:2048  lds
 s_waitcnt lgkmcnt(8)
 v_mfma_f32_16x16x32_bf16 v[0:3], v[32:35], v[40:43], v[0:3]
 ds_read_b128 v[160:163], v235 offset:20480
 v_mfma_f32_16x16x32_bf16 v[4:7], v[36:39], v[40:43], v[4:7]
 ds_read_b64_tr_b16 v[152:153], v233 offset:40960
 buffer_load_dwordx4 v241, s[40:43], s65 offen offset:3072  lds
 s_add_u32 s65, s65, 0x20000
 s_and_b32 s65, s65, 0x1fffff
 s_add_u32 m0, s68, 0
 v_mfma_f32_16x16x32_bf16 v[8:11], v[32:35], v[44:47], v[8:11]
 ds_read_b128 v[164:167], v235 offset:21504
 v_mfma_f32_16x16x32_bf16 v[12:15], v[36:39], v[44:47], v[12:15]
 ds_read_b64_tr_b16 v[154:155], v233 offset:41984
 buffer_load_dwordx4 v242, s[36:39], s66 offen offset:0  lds
 v_mfma_f32_16x16x32_bf16 v[16:19], v[32:35], v[48:51], v[16:19]
 ds_read_b128 v[168:171], v235 offset:22528
 v_mfma_f32_16x16x32_bf16 v[20:23], v[36:39], v[48:51], v[20:23]
 ds_read_b64_tr_b16 v[156:157], v190 offset:40960
 buffer_load_dwordx4 v243, s[36:39], s66 offen offset:1024  lds
 s_add_u32 s66, s66, 128
 s_and_b32 s66, s66, 2047
 v_mfma_f32_16x16x32_bf16 v[24:27], v[32:35], v[52:55], v[24:27]
 ds_read_b128 v[172:175], v235 offset:23552
 v_mfma_f32_16x16x32_bf16 v[28:31], v[36:39], v[52:55], v[28:31]
 ds_read_b64_tr_b16 v[158:159], v190 offset:41984
 s_mov_b32 s85, 266240
 buffer_load_dwordx4 v[56:59], v230, s[44:47], s85 offen sc1
 s_waitcnt lgkmcnt(8)
 v_mfma_f32_16x16x32_bf16 v[0:3], v[196:199], v[204:207], v[0:3]
 s_waitcnt vmcnt(19)
 s_barrier
 ds_read_b128 v[40:43], v235 offset:24576
 v_mfma_f32_16x16x32_bf16 v[4:7], v[200:203], v[204:207], v[4:7]
 ds_read_b64_tr_b16 v[32:33], v234 offset:0
 s_add_u32 m0, s67, 16384
 v_mfma_f32_16x16x32_bf16 v[8:11], v[196:199], v[208:211], v[8:11]
 ds_read_b128 v[44:47], v235 offset:25600
 v_mfma_f32_16x16x32_bf16 v[12:15], v[200:203], v[208:211], v[12:15]
 ds_read_b64_tr_b16 v[34:35], v234 offset:1024
 buffer_load_dwordx4 v238, s[40:43], s65 offen offset:0  lds
 v_mfma_f32_16x16x32_bf16 v[16:19], v[196:199], v[212:215], v[16:19]
 ds_read_b128 v[48:51], v235 offset:26624
 v_mfma_f32_16x16x32_bf16 v[20:23], v[200:203], v[212:215], v[20:23]
 ds_read_b64_tr_b16 v[36:37], v191 offset:0
 buffer_load_dwordx4 v239, s[40:43], s65 offen offset:1024  lds
 v_mfma_f32_16x16x32_bf16 v[24:27], v[196:199], v[216:219], v[24:27]
 ds_read_b128 v[52:55], v235 offset:27648
 v_mfma_f32_16x16x32_bf16 v[28:31], v[200:203], v[216:219], v[28:31]
 ds_read_b64_tr_b16 v[38:39], v191 offset:1024
 buffer_load_dwordx4 v240, s[40:43], s65 offen offset:2048  lds
 s_waitcnt lgkmcnt(8)
 v_mfma_f32_16x16x32_bf16 v[0:3], v[152:155], v[160:163], v[0:3]
 ds_read_b128 v[204:207], v235 offset:28672
 v_mfma_f32_16x16x32_bf16 v[4:7], v[156:159], v[160:163], v[4:7]
 ds_read_b64_tr_b16 v[196:197], v234 offset:8192
 buffer_load_dwordx4 v241, s[40:43], s65 offen offset:3072  lds
 s_add_u32 s65, s65, 0x20000
 s_and_b32 s65, s65, 0x1fffff
 s_add_u32 m0, s68, 8192
 v_mfma_f32_16x16x32_bf16 v[8:11], v[152:155], v[164:167], v[8:11]
 ds_read_b128 v[208:211], v235 offset:29696
 v_mfma_f32_16x16x32_bf16 v[12:15], v[156:159], v[164:167], v[12:15]
 ds_read_b64_tr_b16 v[198:199], v234 offset:9216
 buffer_load_dwordx4 v242, s[36:39], s66 offen offset:0  lds
 v_mfma_f32_16x16x32_bf16 v[16:19], v[152:155], v[168:171], v[16:19]
 ds_read_b128 v[212:215], v235 offset:30720
 v_mfma_f32_16x16x32_bf16 v[20:23], v[156:159], v[168:171], v[20:23]
 ds_read_b64_tr_b16 v[200:201], v191 offset:8192
 buffer_load_dwordx4 v243, s[36:39], s66 offen offset:1024  lds
 s_add_u32 s66, s66, 128
 s_and_b32 s66, s66, 2047
 v_mfma_f32_16x16x32_bf16 v[24:27], v[152:155], v[172:175], v[24:27]
 ds_read_b128 v[216:219], v235 offset:31744
 v_mfma_f32_16x16x32_bf16 v[28:31], v[156:159], v[172:175], v[28:31]
 ds_read_b64_tr_b16 v[202:203], v191 offset:9216
 s_waitcnt lgkmcnt(8)
 v_mfma_f32_16x16x32_bf16 v[0:3], v[32:35], v[40:43], v[0:3]
 s_waitcnt vmcnt(19)
 s_barrier
 ds_read_b128 v[160:163], v235 offset:32768
 v_mfma_f32_16x16x32_bf16 v[4:7], v[36:39], v[40:43], v[4:7]
 ds_read_b64_tr_b16 v[152:153], v234 offset:16384
 s_add_u32 m0, s67, 32768
 v_mfma_f32_16x16x32_bf16 v[8:11], v[32:35], v[44:47], v[8:11]
 ds_read_b128 v[164:167], v235 offset:33792
 v_mfma_f32_16x16x32_bf16 v[12:15], v[36:39], v[44:47], v[12:15]
 ds_read_b64_tr_b16 v[154:155], v234 offset:17408
 buffer_load_dwordx4 v238, s[40:43], s65 offen offset:0  lds
 v_mfma_f32_16x16x32_bf16 v[16:19], v[32:35], v[48:51], v[16:19]
 ds_read_b128 v[168:171], v235 offset:34816
 v_mfma_f32_16x16x32_bf16 v[20:23], v[36:39], v[48:51], v[20:23]
 ds_read_b64_tr_b16 v[156:157], v191 offset:16384
 buffer_load_dwordx4 v239, s[40:43], s65 offen offset:1024  lds
 v_mfma_f32_16x16x32_bf16 v[24:27], v[32:35], v[52:55], v[24:27]
 ds_read_b128 v[172:175], v235 offset:35840
 v_mfma_f32_16x16x32_bf16 v[28:31], v[36:39], v[52:55], v[28:31]
 ds_read_b64_tr_b16 v[158:159], v191 offset:17408
 buffer_load_dwordx4 v240, s[40:43], s65 offen offset:2048  lds
 s_waitcnt lgkmcnt(8)
 v_mfma_f32_16x16x32_bf16 v[0:3], v[196:199], v[204:207], v[0:3]
 ds_read_b128 v[40:43], v235 offset:36864
 v_mfma_f32_16x16x32_bf16 v[4:7], v[200:203], v[204:207], v[4:7]
 ds_read_b64_tr_b16 v[32:33], v234 offset:24576
 buffer_load_dwordx4 v241, s[40:43], s65 offen offset:3072  lds
 s_add_u32 s65, s65, 0x20000
 s_and_b32 s65, s65, 0x1fffff
 s_add_u32 m0, s68, 16384
 v_mfma_f32_16x16x32_bf16 v[8:11], v[196:199], v[208:211], v[8:11]
 ds_read_b128 v[44:47], v235 offset:37888
 v_mfma_f32_16x16x32_bf16 v[12:15], v[200:203], v[208:211], v[12:15]
 ds_read_b64_tr_b16 v[34:35], v234 offset:25600
 buffer_load_dwordx4 v242, s[36:39], s66 offen offset:0  lds
 v_mfma_f32_16x16x32_bf16 v[16:19], v[196:199], v[212:215], v[16:19]
 ds_read_b128 v[48:51], v235 offset:38912
 v_mfma_f32_16x16x32_bf16 v[20:23], v[200:203], v[212:215], v[20:23]
 ds_read_b64_tr_b16 v[36:37], v191 offset:24576
 buffer_load_dwordx4 v243, s[36:39], s66 offen offset:1024  lds
 s_add_u32 s66, s66, 128
 s_and_b32 s66, s66, 2047
 v_mfma_f32_16x16x32_bf16 v[24:27], v[196:199], v[216:219], v[24:27]
 ds_read_b128 v[52:55], v235 offset:39936
 v_mfma_f32_16x16x32_bf16 v[28:31], v[200:203], v[216:219], v[28:31]
 ds_read_b64_tr_b16 v[38:39], v191 offset:25600
 s_waitcnt lgkmcnt(8)
 v_mfma_f32_16x16x32_bf16 v[0:3], v[152:155], v[160:163], v[0:3]
 s_waitcnt vmcnt(19)
 s_barrier
 ds_read_b128 v[204:207], v235 offset:40960
 v_mfma_f32_16x16x32_bf16 v[4:7], v[156:159], v[160:163], v[4:7]
 ds_read_b64_tr_b16 v[196:197], v234 offset:32768
 s_add_u32 m0, s67, 49152
 v_mfma_f32_16x16x32_bf16 v[8:11], v[152:155], v[164:167], v[8:11]
 ds_read_b128 v[208:211], v235 offset:41984
 v_mfma_f32_16x16x32_bf16 v[12:15], v[156:159], v[164:167], v[12:15]
 ds_read_b64_tr_b16 v[198:199], v234 offset:33792
 buffer_load_dwordx4 v238, s[40:43], s65 offen offset:0  lds
 v_mfma_f32_16x16x32_bf16 v[16:19], v[152:155], v[168:171], v[16:19]
 ds_read_b128 v[212:215], v235 offset:43008
 v_mfma_f32_16x16x32_bf16 v[20:23], v[156:159], v[168:171], v[20:23]
 ds_read_b64_tr_b16 v[200:201], v191 offset:32768
 buffer_load_dwordx4 v239, s[40:43], s65 offen offset:1024  lds
 v_mfma_f32_16x16x32_bf16 v[24:27], v[152:155], v[172:175], v[24:27]
 ds_read_b128 v[216:219], v235 offset:44032
 v_mfma_f32_16x16x32_bf16 v[28:31], v[156:159], v[172:175], v[28:31]
 ds_read_b64_tr_b16 v[202:203], v191 offset:33792
 buffer_load_dwordx4 v240, s[40:43], s65 offen offset:2048  lds
 s_waitcnt lgkmcnt(8)
 v_mfma_f32_16x16x32_bf16 v[0:3], v[32:35], v[40:43], v[0:3]
 ds_read_b128 v[160:163], v235 offset:45056
 v_mfma_f32_16x16x32_bf16 v[4:7], v[36:39], v[40:43], v[4:7]
 ds_read_b64_tr_b16 v[152:153], v234 offset:40960
 buffer_load_dwordx4 v241, s[40:43], s65 offen offset:3072  lds
 s_add_u32 s65, s65, 0x20000
 s_and_b32 s65, s65, 0x1fffff
 s_add_u32 m0, s68, 24576
 v_mfma_f32_16x16x32_bf16 v[8:11], v[32:35], v[44:47], v[8:11]
 ds_read_b128 v[164:167], v235 offset:46080
 v_mfma_f32_16x16x32_bf16 v[12:15], v[36:39], v[44:47], v[12:15]
 ds_read_b64_tr_b16 v[154:155], v234 offset:41984
 buffer_load_dwordx4 v242, s[36:39], s66 offen offset:0  lds
 v_mfma_f32_16x16x32_bf16 v[16:19], v[32:35], v[48:51], v[16:19]
 ds_read_b128 v[168:171], v235 offset:47104
 v_mfma_f32_16x16x32_bf16 v[20:23], v[36:39], v[48:51], v[20:23]
 ds_read_b64_tr_b16 v[156:157], v191 offset:40960
 buffer_load_dwordx4 v243, s[36:39], s66 offen offset:1024  lds
 s_add_u32 s66, s66, 128
 s_and_b32 s66, s66, 2047
 v_mfma_f32_16x16x32_bf16 v[24:27], v[32:35], v[52:55], v[24:27]
 ds_read_b128 v[172:175], v235 offset:48128
 v_mfma_f32_16x16x32_bf16 v[28:31], v[36:39], v[52:55], v[28:31]
 ds_read_b64_tr_b16 v[158:159], v191 offset:41984
 s_waitcnt vmcnt(18)
 v_cmp_ne_u32 vcc, s64, v56
 v_cmp_ne_u32 s[10:11], s64, v57
 s_or_b64 vcc, vcc, s[10:11]
 v_cmp_ne_u32 s[10:11], s64, v58
 s_or_b64 vcc, vcc, s[10:11]
 v_cmp_ne_u32 s[10:11], s64, v59
 s_or_b64 vcc, vcc, s[10:11]
 s_cmp_eq_u64 vcc, 0
 s_cbranch_scc0 Lretry_1
Lback_2:
 s_waitcnt lgkmcnt(8)
 v_mfma_f32_16x16x32_bf16 v[0:3], v[196:199], v[204:207], v[0:3]
 s_barrier
 ds_read_b128 v[40:43], v235 offset:0
 v_mfma_f32_16x16x32_bf16 v[4:7], v[200:203], v[204:207], v[4:7]
 ds_read_b64_tr_b16 v[32:33], v233 offset:0
 s_add_u32 m0, s67, 65536
 v_mfma_f32_16x16x32_bf16 v[8:11], v[196:199], v[208:211], v[8:11]
 ds_read_b128 v[44:47], v235 offset:1024
 v_mfma_f32_16x16x32_bf16 v[12:15], v[200:203], v[208:211], v[12:15]
 ds_read_b64_tr_b16 v[34:35], v233 offset:1024
 buffer_load_dwordx4 v230, s[44:47], s72 offen offset:0 sc1 lds
 v_mfma_f32_16x16x32_bf16 v[16:19], v[196:199], v[212:215], v[16:19]
 ds_read_b128 v[48:51], v235 offset:2048
 v_mfma_f32_16x16x32_bf16 v[20:23], v[200:203], v[212:215], v[20:23]
 ds_read_b64_tr_b16 v[36:37], v190 offset:0
 buffer_load_dwordx4 v230, s[44:47], s72 offen offset:1024 sc1 lds
 v_mfma_f32_16x16x32_bf16 v[24:27], v[196:199], v[216:219], v[24:27]
 ds_read_b128 v[52:55], v235 offset:3072
 v_mfma_f32_16x16x32_bf16 v[28:31], v[200:203], v[216:219], v[28:31]
 ds_read_b64_tr_b16 v[38:39], v190 offset:1024
 buffer_load_dwordx4 v230, s[44:47], s72 offen offset:2048 sc1 lds
 s_waitcnt lgkmcnt(8)
 v_mfma_f32_16x16x32_bf16 v[0:3], v[152:155], v[160:163], v[0:3]
 ds_read_b128 v[204:207], v235 offset:4096
 v_mfma_f32_16x16x32_bf16 v[4:7], v[156:159], v[160:163], v[4:7]
 ds_read_b64_tr_b16 v[196:197], v233 offset:8192
 buffer_load_dwordx4 v230, s[44:47], s72 offen offset:3072 sc1 lds
 s_add_u32 s72, s72, 32768
 s_and_b32 s72, s72, 0x3ffff
 v_mfma_f32_16x16x32_bf16 v[8:11], v[152:155], v[164:167], v[8:11]
 ds_read_b128 v[208:211], v235 offset:5120
 v_mfma_f32_16x16x32_bf16 v[12:15], v[156:159], v[164:167], v[12:15]
 ds_read_b64_tr_b16 v[198:199], v233 offset:9216
 v_mfma_f32_16x16x32_bf16 v[16:19], v[152:155], v[168:171], v[16:19]
 ds_read_b128 v[212:215], v235 offset:6144
 v_mfma_f32_16x16x32_bf16 v[20:23], v[156:159], v[168:171], v[20:23]
 ds_read_b64_tr_b16 v[200:201], v190 offset:8192
 v_mfma_f32_16x16x32_bf16 v[24:27], v[152:155], v[172:175], v[24:27]
 ds_read_b128 v[216:219], v235 offset:7168
 v_mfma_f32_16x16x32_bf16 v[28:31], v[156:159], v[172:175], v[28:31]
 ds_read_b64_tr_b16 v[202:203], v190 offset:9216
 s_waitcnt lgkmcnt(8)
 v_mfma_f32_16x16x32_bf16 v[0:3], v[32:35], v[40:43], v[0:3]
 s_waitcnt vmcnt(16)
 s_barrier
 ds_read_b128 v[160:163], v235 offset:8192
 v_mfma_f32_16x16x32_bf16 v[4:7], v[36:39], v[40:43], v[4:7]
 ds_read_b64_tr_b16 v[152:153], v233 offset:16384
 s_add_u32 m0, s67, 81920
 v_mfma_f32_16x16x32_bf16 v[8:11], v[32:35], v[44:47], v[8:11]
 ds_read_b128 v[164:167], v235 offset:9216
 v_mfma_f32_16x16x32_bf16 v[12:15], v[36:39], v[44:47], v[12:15]
 ds_read_b64_tr_b16 v[154:155], v233 offset:17408
 buffer_load_dwordx4 v230, s[44:47], s73 offen offset:0 sc1 lds
 v_mfma_f32_16x16x32_bf16 v[16:19], v[32:35], v[48:51], v[16:19]
 ds_read_b128 v[168:171], v235 offset:10240
 v_mfma_f32_16x16x32_bf16 v[20:23], v[36:39], v[48:51], v[20:23]
 ds_read_b64_tr_b16 v[156:157], v190 offset:16384
 buffer_load_dwordx4 v230, s[44:47], s73 offen offset:1024 sc1 lds
 v_mfma_f32_16x16x32_bf16 v[24:27], v[32:35], v[52:55], v[24:27]
 ds_read_b128 v[172:175], v235 offset:11264
 v_mfma_f32_16x16x32_bf16 v[28:31], v[36:39], v[52:55], v[28:31]
 ds_read_b64_tr_b16 v[158:159], v190 offset:17408
 buffer_load_dwordx4 v230, s[44:47], s73 offen offset:2048 sc1 lds
 s_waitcnt lgkmcnt(8)
 v_mfma_f32_16x16x32_bf16 v[0:3], v[196:199], v[204:207], v[0:3]
 ds_read_b128 v[40:43], v235 offset:12288
 v_mfma_f32_16x16x32_bf16 v[4:7], v[200:203], v[204:207], v[4:7]
 ds_read_b64_tr_b16 v[32:33], v233 offset:24576
 buffer_load_dwordx4 v230, s[44:47], s73 offen offset:3072 sc1 lds
 s_add_u32 s73, s73, 32768
 s_and_b32 s73, s73, 0x3ffff
 v_mfma_f32_16x16x32_bf16 v[8:11], v[196:199], v[208:211], v[8:11]
 ds_read_b128 v[44:47], v235 offset:13312
 v_mfma_f32_16x16x32_bf16 v[12:15], v[200:203], v[208:211], v[12:15]
 ds_read_b64_tr_b16 v[34:35], v233 offset:25600
 v_mfma_f32_16x16x32_bf16 v[16:19], v[196:199], v[212:215], v[16:19]
 ds_read_b128 v[48:51], v235 offset:14336
 v_mfma_f32_16x16x32_bf16 v[20:23], v[200:203], v[212:215], v[20:23]
 ds_read_b64_tr_b16 v[36:37], v190 offset:24576
 v_mfma_f32_16x16x32_bf16 v[24:27], v[196:199], v[216:219], v[24:27]
 ds_read_b128 v[52:55], v235 offset:15360
 v_mfma_f32_16x16x32_bf16 v[28:31], v[200:203], v[216:219], v[28:31]
 ds_read_b64_tr_b16 v[38:39], v190 offset:25600
 s_waitcnt lgkmcnt(8)
 v_mfma_f32_16x16x32_bf16 v[0:3], v[152:155], v[160:163], v[0:3]
 s_waitcnt vmcnt(14)
 s_barrier
 ds_read_b128 v[204:207], v235 offset:16384
 v_mfma_f32_16x16x32_bf16 v[4:7], v[156:159], v[160:163], v[4:7]
 ds_read_b64_tr_b16 v[196:197], v233 offset:32768
 s_add_u32 m0, s67, 0
 v_mfma_f32_16x16x32_bf16 v[8:11], v[152:155], v[164:167], v[8:11]
 ds_read_b128 v[208:211], v235 offset:17408
 v_mfma_f32_16x16x32_bf16 v[12:15], v[156:159], v[164:167], v[12:15]
 ds_read_b64_tr_b16 v[198:199], v233 offset:33792
 buffer_load_dwordx4 v230, s[44:47], s72 offen offset:0 sc1 lds
 v_mfma_f32_16x16x32_bf16 v[16:19], v[152:155], v[168:171], v[16:19]
 ds_read_b128 v[212:215], v235 offset:18432
 v_mfma_f32_16x16x32_bf16 v[20:23], v[156:159], v[168:171], v[20:23]
 ds_read_b64_tr_b16 v[200:201], v190 offset:32768
 buffer_load_dwordx4 v230, s[44:47], s72 offen offset:1024 sc1 lds
 v_mfma_f32_16x16x32_bf16 v[24:27], v[152:155], v[172:175], v[24:27]
 ds_read_b128 v[216:219], v235 offset:19456
 v_mfma_f32_16x16x32_bf16 v[28:31], v[156:159], v[172:175], v[28:31]
 ds_read_b64_tr_b16 v[202:203], v190 offset:33792
 buffer_load_dwordx4 v230, s[44:47], s72 offen offset:2048 sc1 lds
 s_waitcnt lgkmcnt(8)
 v_mfma_f32_16x16x32_bf16 v[0:3], v[32:35], v[40:43], v[0:3]
 ds_read_b128 v[160:163], v235 offset:20480
 v_mfma_f32_16x16x32_bf16 v[4:7], v[36:39], v[40:43], v[4:7]
 ds_read_b64_tr_b16 v[152:153], v233 offset:40960
 buffer_load_dwordx4 v230, s[44:47], s72 offen offset:3072 sc1 lds
 s_add_u32 s72, s72, 32768
 s_and_b32 s72, s72, 0x3ffff
 v_mfma_f32_16x16x32_bf16 v[8:11], v[32:35], v[44:47], v[8:11]
 ds_read_b128 v[164:167], v235 offset:21504
 v_mfma_f32_16x16x32_bf16 v[12:15], v[36:39], v[44:47], v[12:15]
 ds_read_b64_tr_b16 v[154:155], v233 offset:41984
 v_mfma_f32_16x16x32_bf16 v[16:19], v[32:35], v[48:51], v[16:19]
 ds_read_b128 v[168:171], v235 offset:22528
 v_mfma_f32_16x16x32_bf16 v[20:23], v[36:39], v[48:51], v[20:23]
 ds_read_b64_tr_b16 v[156:157], v190 offset:40960
 v_mfma_f32_16x16x32_bf16 v[24:27], v[32:35], v[52:55], v[24:27]
 ds_read_b128 v[172:175], v235 offset:23552
 v_mfma_f32_16x16x32_bf16 v[28:31], v[36:39], v[52:55], v[28:31]
 ds_read_b64_tr_b16 v[158:159], v190 offset:41984
 s_waitcnt lgkmcnt(8)
 v_mfma_f32_16x16x32_bf16 v[0:3], v[196:199], v[204:207], v[0:3]
 s_waitcnt vmcnt(12)
 s_barrier
 ds_read_b128 v[40:43], v235 offset:24576
 v_mfma_f32_16x16x32_bf16 v[4:7], v[200:203], v[204:207], v[4:7]
 ds_read_b64_tr_b16 v[32:33], v234 offset:0
 s_add_u32 m0, s67, 16384
 v_mfma_f32_16x16x32_bf16 v[8:11], v[196:199], v[208:211], v[8:11]
 ds_read_b128 v[44:47], v235 offset:25600
 v_mfma_f32_16x16x32_bf16 v[12:15], v[200:203], v[208:211], v[12:15]
 ds_read_b64_tr_b16 v[34:35], v234 offset:1024
 buffer_load_dwordx4 v230, s[44:47], s73 offen offset:0 sc1 lds
 v_mfma_f32_16x16x32_bf16 v[16:19], v[196:199], v[212:215], v[16:19]
 ds_read_b128 v[48:51], v235 offset:26624
 v_mfma_f32_16x16x32_bf16 v[20:23], v[200:203], v[212:215], v[20:23]
 ds_read_b64_tr_b16 v[36:37], v191 offset:0
 buffer_load_dwordx4 v230, s[44:47], s73 offen offset:1024 sc1 lds
 v_mfma_f32_16x16x32_bf16 v[24:27], v[196:199], v[216:219], v[24:27]
 ds_read_b128 v[52:55], v235 offset:27648
 v_mfma_f32_16x16x32_bf16 v[28:31], v[200:203], v[216:219], v[28:31]
 ds_read_b64_tr_b16 v[38:39], v191 offset:1024
 buffer_load_dwordx4 v230, s[44:47], s73 offen offset:2048 sc1 lds
 s_waitcnt lgkmcnt(8)
 v_mfma_f32_16x16x32_bf16 v[0:3], v[152:155], v[160:163], v[0:3]
 ds_read_b128 v[204:207], v235 offset:28672
 v_mfma_f32_16x16x32_bf16 v[4:7], v[156:159], v[160:163], v[4:7]
 ds_read_b64_tr_b16 v[196:197], v234 offset:8192
 buffer_load_dwordx4 v230, s[44:47], s73 offen offset:3072 sc1 lds
 s_add_u32 s73, s73, 32768
 s_and_b32 s73, s73, 0x3ffff
 v_mfma_f32_16x16x32_bf16 v[8:11], v[152:155], v[164:167], v[8:11]
 ds_read_b128 v[208:211], v235 offset:29696
 v_mfma_f32_16x16x32_bf16 v[12:15], v[156:159], v[164:167], v[12:15]
 ds_read_b64_tr_b16 v[198:199], v234 offset:9216
 v_mfma_f32_16x16x32_bf16 v[16:19], v[152:155], v[168:171], v[16:19]
 ds_read_b128 v[212:215], v235 offset:30720
 v_mfma_f32_16x16x32_bf16 v[20:23], v[156:159], v[168:171], v[20:23]
 ds_read_b64_tr_b16 v[200:201], v191 offset:8192
 v_mfma_f32_16x16x32_bf16 v[24:27], v[152:155], v[172:175], v[24:27]
 ds_read_b128 v[216:219], v235 offset:31744
 v_mfma_f32_16x16x32_bf16 v[28:31], v[156:159], v[172:175], v[28:31]
 ds_read_b64_tr_b16 v[202:203], v191 offset:9216
 s_waitcnt lgkmcnt(8)
 v_mfma_f32_16x16x32_bf16 v[0:3], v[32:35], v[40:43], v[0:3]
 s_waitcnt vmcnt(12)
 s_barrier
 v_mfma_f32_16x16x32_bf16 v[4:7], v[36:39], v[40:43], v[4:7]
 s_add_u32 m0, s67, 32768
 v_mfma_f32_16x16x32_bf16 v[8:11], v[32:35], v[44:47], v[8:11]
 v_mfma_f32_16x16x32_bf16 v[12:15], v[36:39], v[44:47], v[12:15]
 ds_read_b128 v[152:155], v189 offset:0
 ds_read_b128 v[156:159], v189 offset:1024
 buffer_load_dwordx4 v230, s[44:47], s72 offen offset:0 sc1 lds
 v_mfma_f32_16x16x32_bf16 v[16:19], v[32:35], v[48:51], v[16:19]
 v_mfma_f32_16x16x32_bf16 v[20:23], v[36:39], v[48:51], v[20:23]
 ds_read_b128 v[160:163], v189 offset:4096
 ds_read_b128 v[164:167], v189 offset:5120
 buffer_load_dwordx4 v230, s[44:47], s72 offen offset:1024 sc1 lds
 v_mfma_f32_16x16x32_bf16 v[24:27], v[32:35], v[52:55], v[24:27]
 v_mfma_f32_16x16x32_bf16 v[28:31], v[36:39], v[52:55], v[28:31]
 ds_read_b128 v[168:171], v189 offset:2048
 ds_read_b128 v[172:175], v189 offset:3072
 buffer_load_dwordx4 v230, s[44:47], s72 offen offset:2048 sc1 lds
 s_waitcnt lgkmcnt(6)
 v_mfma_f32_16x16x32_bf16 v[0:3], v[196:199], v[204:207], v[0:3]
 v_mfma_f32_16x16x32_bf16 v[4:7], v[200:203], v[204:207], v[4:7]
 buffer_load_dwordx4 v230, s[44:47], s72 offen offset:3072 sc1 lds
 s_add_u32 s72, s72, 32768
 s_and_b32 s72, s72, 0x3ffff
 v_mfma_f32_16x16x32_bf16 v[8:11], v[196:199], v[208:211], v[8:11]
 v_mfma_f32_16x16x32_bf16 v[12:15], v[200:203], v[208:211], v[12:15]
 v_mfma_f32_16x16x32_bf16 v[16:19], v[196:199], v[212:215], v[16:19]
 v_mfma_f32_16x16x32_bf16 v[20:23], v[200:203], v[212:215], v[20:23]
 v_mfma_f32_16x16x32_bf16 v[24:27], v[196:199], v[216:219], v[24:27]
 v_mfma_f32_16x16x32_bf16 v[28:31], v[200:203], v[216:219], v[28:31]
 s_or_b32 s80, s2, s30
 s_cbranch_scc0 Lepoch
Lepoch_b:
 s_mov_b32 m0, s74
 s_nop 0
 v_cvt_pk_bf16_f32 v136, v0, v1
 v_cvt_pk_bf16_f32 v137, v2, v3
 v_cvt_pk_bf16_f32 v138, v8, v9
 v_cvt_pk_bf16_f32 v139, v10, v11
 v_cvt_pk_bf16_f32 v140, v4, v5
 v_cvt_pk_bf16_f32 v141, v6, v7
 v_cvt_pk_bf16_f32 v142, v12, v13
 v_cvt_pk_bf16_f32 v143, v14, v15
 v_permlane16_swap_b32 v136, v138
 v_permlane16_swap_b32 v137, v139
 v_permlane16_swap_b32 v140, v142
 v_permlane16_swap_b32 v141, v143
 buffer_load_dwordx4 v231, s[52:55], s75 offen offset:0  lds
 s_add_u32 s75, s75, 1047552
 s_waitcnt lgkmcnt(4)
 s_nop 0
 v_mfma_f32_32x32x16_bf16 v[32:47], v[152:155], v[136:139], 0
 v_cvt_pk_bf16_f32 v144, v16, v17
 v_cvt_pk_bf16_f32 v145, v18, v19
 v_cvt_pk_bf16_f32 v146, v24, v25
 v_cvt_pk_bf16_f32 v147, v26, v27
 v_cvt_pk_bf16_f32 v148, v20, v21
 v_cvt_pk_bf16_f32 v149, v22, v23
 v_mfma_f32_32x32x16_bf16 v[32:47], v[156:159], v[140:143], v[32:47]
 v_cvt_pk_bf16_f32 v150, v28, v29
 v_cvt_pk_bf16_f32 v151, v30, v31
 v_permlane16_swap_b32 v144, v146
 v_permlane16_swap_b32 v145, v147
 v_permlane16_swap_b32 v148, v150
 v_permlane16_swap_b32 v149, v151
 buffer_load_dwordx4 v231, s[52:55], s75 offen offset:1024  lds
 s_add_u32 s75, s75, 1047552
 s_waitcnt lgkmcnt(2)
 v_mfma_f32_32x32x16_bf16 v[48:63], v[160:163], v[136:139], 0
 v_mfma_f32_32x32x16_bf16 v[48:63], v[164:167], v[140:143], v[48:63]
 buffer_load_dwordx4 v231, s[52:55], s75 offen offset:2048  lds
 s_add_u32 s75, s75, 1047552
 v_mfma_f32_32x32x16_bf16 v[0:15], v[152:155], v[144:147], 0
 s_nop 3
 v_max3_f32 v251, v32, v33, v34
 v_max3_f32 v251, v251, v35, v36
 v_mfma_f32_32x32x16_bf16 v[0:15], v[156:159], v[148:151], v[0:15]
 v_max3_f32 v251, v251, v37, v38
 v_max3_f32 v251, v251, v39, v40
 v_max3_f32 v251, v251, v41, v42
 v_max3_f32 v251, v251, v43, v44
 v_max3_f32 v251, v251, v45, v46
 v_max_f32 v251, v251, v47
 v_mfma_f32_32x32x16_bf16 v[16:31], v[160:163], v[144:147], 0
 s_nop 0
 buffer_load_dwordx4 v231, s[52:55], s75 offen offset:3072  lds
 v_max3_f32 v251, v251, v48, v49
 v_max3_f32 v251, v251, v50, v51
 v_max3_f32 v251, v251, v52, v53
 v_max3_f32 v251, v251, v54, v55
 v_mfma_f32_32x32x16_bf16 v[16:31], v[164:167], v[148:151], v[16:31]
 v_max3_f32 v251, v251, v56, v57
 v_max3_f32 v251, v251, v58, v59
 v_max3_f32 v251, v251, v60, v61
 v_max3_f32 v251, v251, v62, v63
 v_max3_f32 v252, v0, v1, v2
 v_max3_f32 v252, v252, v3, v4
 v_max3_f32 v252, v252, v5, v6
 v_max3_f32 v252, v252, v7, v8
 v_max3_f32 v252, v252, v9, v10
 v_max3_f32 v252, v252, v11, v12
 v_max3_f32 v252, v252, v13, v14
 v_max_f32 v252, v252, v15
 v_max3_f32 v252, v252, v16, v17
 v_max3_f32 v252, v252, v18, v19
 v_max3_f32 v252, v252, v20, v21
 v_max3_f32 v252, v252, v22, v23
 v_max3_f32 v252, v252, v24, v25
 v_max3_f32 v252, v252, v26, v27
 v_max3_f32 v252, v252, v28, v29
 v_max3_f32 v252, v252, v30, v31
 v_mov_b32 v253, v251
 v_mov_b32 v254, v252
 s_nop 0
 v_permlane32_swap_b32 v251, v253
 v_permlane32_swap_b32 v252, v254
 v_max_f32 v251, v251, v253
 v_max_f32 v252, v252, v254
 v_sub_f32 v104, 0xc2c80000, v251
 v_sub_f32 v105, 0xc2c80000, v251
 v_mov_b64 v[106:107], v[104:105]
 v_mov_b64 v[108:109], v[104:105]
 v_mov_b64 v[110:111], v[104:105]
 v_mov_b64 v[112:113], v[104:105]
 v_mov_b64 v[114:115], v[104:105]
 v_mov_b64 v[116:117], v[104:105]
 v_mov_b64 v[118:119], v[104:105]
 v_sub_f32 v120, 0xc2c80000, v252
 v_sub_f32 v121, 0xc2c80000, v252
 v_mfma_f32_32x32x16_bf16 v[0:15], v[152:155], v[136:139], v[104:119]
 v_mfma_f32_32x32x16_bf16 v[0:15], v[156:159], v[140:143], v[0:15]
 v_mov_b64 v[122:123], v[120:121]
 v_mov_b64 v[124:125], v[120:121]
 v_mov_b64 v[126:127], v[120:121]
 v_mov_b64 v[128:129], v[120:121]
 v_mov_b64 v[130:131], v[120:121]
 v_mov_b64 v[132:133], v[120:121]
 v_mov_b64 v[134:135], v[120:121]
 s_add_u32 s60, s44, s72
 s_addc_u32 s61, s45, 0
 s_add_u32 s62, s44, s73
 s_addc_u32 s63, s45, 0
 s_add_u32 s38, s56, 4096
 s_addc_u32 s39, s57, 0
 s_waitcnt vmcnt(12)
 s_barrier
 v_mfma_f32_32x32x16_bf16 v[16:31], v[152:155], v[144:147], v[120:135]
 s_waitcnt lgkmcnt(0)
 v_exp_f32 v0, v0
 v_exp_f32 v1, v1
 v_exp_f32 v2, v2
 v_mfma_f32_32x32x16_bf16 v[16:31], v[156:159], v[148:151], v[16:31]
 v_exp_f32 v3, v3
 v_exp_f32 v4, v4
 v_exp_f32 v5, v5
 global_load_dwordx4 a[16:19], v230, s[38:39] offset:-4096
 v_exp_f32 v6, v6
 v_exp_f32 v7, v7
 v_exp_f32 v8, v8
 ds_read_b128 v[152:155], v189 offset:8192
 v_exp_f32 v9, v9
 v_exp_f32 v10, v10
 v_exp_f32 v11, v11
 v_exp_f32 v12, v12
 v_exp_f32 v13, v13
 ds_read_b128 v[156:159], v189 offset:9216
 v_exp_f32 v14, v14
 v_exp_f32 v15, v15
 v_mfma_f32_32x32x16_bf16 v[32:47], v[160:163], v[136:139], v[104:119]
 v_exp_f32 v16, v16
 v_exp_f32 v17, v17
 v_exp_f32 v18, v18
 v_mfma_f32_32x32x16_bf16 v[32:47], v[164:167], v[140:143], v[32:47]
 v_exp_f32 v19, v19
 v_exp_f32 v20, v20
 v_exp_f32 v21, v21
 v_smfmac_f32_32x32x32_bf16 v[64:79], v[168:171], v[0:7], v188
 global_load_dwordx4 a[20:23], v230, s[38:39] offset:-3072
 v_exp_f32 v22, v22
 v_exp_f32 v23, v23
 v_exp_f32 v24, v24
 v_smfmac_f32_16x16x64_bf16 v[96:99], v[184:187], v[0:7], v188
 ds_read_b128 v[176:179], v189 offset:6144
 v_exp_f32 v25, v25
 v_exp_f32 v26, v26
 v_smfmac_f32_32x32x32_bf16 v[64:79], v[172:175], v[8:15], v188
 v_exp_f32 v27, v27
 v_exp_f32 v28, v28
 v_exp_f32 v29, v29
 v_smfmac_f32_16x16x64_bf16 v[96:99], v[184:187], v[8:15], v188
 ds_read_b128 v[180:183], v189 offset:7168
 v_exp_f32 v30, v30
 v_exp_f32 v31, v31
 v_mfma_f32_32x32x16_bf16 v[48:63], v[160:163], v[144:147], v[120:135]
 s_waitcnt lgkmcnt(2)
 v_exp_f32 v32, v32
 v_exp_f32 v33, v33
 v_exp_f32 v34, v34
 v_mfma_f32_32x32x16_bf16 v[48:63], v[164:167], v[148:151], v[48:63]
 v_exp_f32 v35, v35
 v_exp_f32 v36, v36
 v_exp_f32 v37, v37
 v_smfmac_f32_32x32x32_bf16 v[80:95], v[168:171], v[16:23], v188
 global_load_dwordx4 a[24:27], v230, s[38:39] offset:-2048
 v_exp_f32 v38, v38
 v_exp_f32 v39, v39
 v_exp_f32 v40, v40
 v_smfmac_f32_16x16x64_bf16 v[100:103], v[184:187], v[16:23], v188
 ds_read_b128 v[160:163], v189 offset:12288
 v_exp_f32 v41, v41
 v_exp_f32 v42, v42
 v_smfmac_f32_32x32x32_bf16 v[80:95], v[172:175], v[24:31], v188
 v_exp_f32 v43, v43
 v_exp_f32 v44, v44
 v_exp_f32 v45, v45
 v_smfmac_f32_16x16x64_bf16 v[100:103], v[184:187], v[24:31], v188
 ds_read_b128 v[164:167], v189 offset:13312
 v_exp_f32 v46, v46
 v_exp_f32 v47, v47
 v_mfma_f32_32x32x16_bf16 v[0:15], v[152:155], v[136:139], v[104:119]
 s_waitcnt lgkmcnt(2)
 v_exp_f32 v48, v48
 v_exp_f32 v49, v49
 v_exp_f32 v50, v50
 v_mfma_f32_32x32x16_bf16 v[0:15], v[156:159], v[140:143], v[0:15]
 v_exp_f32 v51, v51
 v_exp_f32 v52, v52
 v_exp_f32 v53, v53
 v_smfmac_f32_32x32x32_bf16 v[64:79], v[176:179], v[32:39], v188
 global_load_dwordx4 a[28:31], v230, s[38:39] offset:-1024
 v_exp_f32 v54, v54
 v_exp_f32 v55, v55
 v_exp_f32 v56, v56
 v_smfmac_f32_16x16x64_bf16 v[96:99], v[184:187], v[32:39], v188
 ds_read_b128 v[168:171], v189 offset:10240
 v_exp_f32 v57, v57
 v_exp_f32 v58, v58
 v_smfmac_f32_32x32x32_bf16 v[64:79], v[180:183], v[40:47], v188
 v_exp_f32 v59, v59
 v_exp_f32 v60, v60
 v_exp_f32 v61, v61
 v_smfmac_f32_16x16x64_bf16 v[96:99], v[184:187], v[40:47], v188
 ds_read_b128 v[172:175], v189 offset:11264
 v_exp_f32 v62, v62
 v_exp_f32 v63, v63
 v_mfma_f32_32x32x16_bf16 v[16:31], v[152:155], v[144:147], v[120:135]
 s_waitcnt lgkmcnt(2)
 v_exp_f32 v0, v0
 v_exp_f32 v1, v1
 v_exp_f32 v2, v2
 v_mfma_f32_32x32x16_bf16 v[16:31], v[156:159], v[148:151], v[16:31]
 v_exp_f32 v3, v3
 v_exp_f32 v4, v4
 v_exp_f32 v5, v5
 v_smfmac_f32_32x32x32_bf16 v[80:95], v[176:179], v[48:55], v188
 global_load_dwordx4 a[32:35], v230, s[38:39] offset:0
 v_exp_f32 v6, v6
 v_exp_f32 v7, v7
 v_exp_f32 v8, v8
 v_smfmac_f32_16x16x64_bf16 v[100:103], v[184:187], v[48:55], v188
 ds_read_b128 v[152:155], v189 offset:16384
 v_exp_f32 v9, v9
 v_exp_f32 v10, v10
 v_smfmac_f32_32x32x32_bf16 v[80:95], v[180:183], v[56:63], v188
 v_exp_f32 v11, v11
 v_exp_f32 v12, v12
 v_exp_f32 v13, v13
 v_smfmac_f32_16x16x64_bf16 v[100:103], v[184:187], v[56:63], v188
 ds_read_b128 v[156:159], v189 offset:17408
 v_exp_f32 v14, v14
 v_exp_f32 v15, v15
 v_mfma_f32_32x32x16_bf16 v[32:47], v[160:163], v[136:139], v[104:119]
 s_waitcnt lgkmcnt(2)
 v_exp_f32 v16, v16
 v_exp_f32 v17, v17
 v_exp_f32 v18, v18
 v_mfma_f32_32x32x16_bf16 v[32:47], v[164:167], v[140:143], v[32:47]
 v_exp_f32 v19, v19
 v_exp_f32 v20, v20
 v_exp_f32 v21, v21
 v_smfmac_f32_32x32x32_bf16 v[64:79], v[168:171], v[0:7], v188
 global_load_dwordx4 a[36:39], v230, s[38:39] offset:1024
 v_exp_f32 v22, v22
 v_exp_f32 v23, v23
 v_exp_f32 v24, v24
 v_smfmac_f32_16x16x64_bf16 v[96:99], v[184:187], v[0:7], v188
 ds_read_b128 v[176:179], v189 offset:14336
 v_exp_f32 v25, v25
 v_exp_f32 v26, v26
 v_smfmac_f32_32x32x32_bf16 v[64:79], v[172:175], v[8:15], v188
 v_exp_f32 v27, v27
 v_exp_f32 v28, v28
 v_exp_f32 v29, v29
 v_smfmac_f32_16x16x64_bf16 v[96:99], v[184:187], v[8:15], v188
 ds_read_b128 v[180:183], v189 offset:15360
 v_exp_f32 v30, v30
 v_exp_f32 v31, v31
 v_mfma_f32_32x32x16_bf16 v[48:63], v[160:163], v[144:147], v[120:135]
 s_waitcnt lgkmcnt(2)
 v_exp_f32 v32, v32
 v_exp_f32 v33, v33
 v_exp_f32 v34, v34
 v_mfma_f32_32x32x16_bf16 v[48:63], v[164:167], v[148:151], v[48:63]
 v_exp_f32 v35, v35
 v_exp_f32 v36, v36
 v_exp_f32 v37, v37
 v_smfmac_f32_32x32x32_bf16 v[80:95], v[168:171], v[16:23], v188
 global_load_dwordx4 a[40:43], v230, s[38:39] offset:2048
 v_exp_f32 v38, v38
 v_exp_f32 v39, v39
 v_exp_f32 v40, v40
 v_smfmac_f32_16x16x64_bf16 v[100:103], v[184:187], v[16:23], v188
 ds_read_b128 v[160:163], v189 offset:20480
 v_exp_f32 v41, v41
 v_exp_f32 v42, v42
 v_smfmac_f32_32x32x32_bf16 v[80:95], v[172:175], v[24:31], v188
 v_exp_f32 v43, v43
 v_exp_f32 v44, v44
 v_exp_f32 v45, v45
 v_smfmac_f32_16x16x64_bf16 v[100:103], v[184:187], v[24:31], v188
 ds_read_b128 v[164:167], v189 offset:21504
 v_exp_f32 v46, v46
 v_exp_f32 v47, v47
 v_mfma_f32_32x32x16_bf16 v[0:15], v[152:155], v[136:139], v[104:119]
 s_waitcnt lgkmcnt(2)
 v_exp_f32 v48, v48
 v_exp_f32 v49, v49
 v_exp_f32 v50, v50
 v_mfma_f32_32x32x16_bf16 v[0:15], v[156:159], v[140:143], v[0:15]
 v_exp_f32 v51, v51
 v_exp_f32 v52, v52
 v_exp_f32 v53, v53
 v_smfmac_f32_32x32x32_bf16 v[64:79], v[176:179], v[32:39], v188
 global_load_dwordx4 a[44:47], v230, s[38:39] offset:3072
 v_exp_f32 v54, v54
 v_exp_f32 v55, v55
 v_exp_f32 v56, v56
 v_smfmac_f32_16x16x64_bf16 v[96:99], v[184:187], v[32:39], v188
 ds_read_b128 v[168:171], v189 offset:18432
 v_exp_f32 v57, v57
 v_exp_f32 v58, v58
 v_smfmac_f32_32x32x32_bf16 v[64:79], v[180:183], v[40:47], v188
 v_exp_f32 v59, v59
 v_exp_f32 v60, v60
 v_exp_f32 v61, v61
 v_smfmac_f32_16x16x64_bf16 v[96:99], v[184:187], v[40:47], v188
 ds_read_b128 v[172:175], v189 offset:19456
 v_exp_f32 v62, v62
 v_exp_f32 v63, v63
 v_mfma_f32_32x32x16_bf16 v[16:31], v[152:155], v[144:147], v[120:135]
 s_waitcnt lgkmcnt(2)
 v_exp_f32 v0, v0
 v_exp_f32 v1, v1
 v_exp_f32 v2, v2
 v_mfma_f32_32x32x16_bf16 v[16:31], v[156:159], v[148:151], v[16:31]
 s_add_u32 m0, s67, 49152
 v_exp_f32 v3, v3
 v_exp_f32 v4, v4
 v_exp_f32 v5, v5
 v_smfmac_f32_32x32x32_bf16 v[80:95], v[176:179], v[48:55], v188
 global_load_lds_dwordx4 v230, s[62:63] offset:0 sc1
 v_exp_f32 v6, v6
 v_exp_f32 v7, v7
 v_exp_f32 v8, v8
 v_smfmac_f32_16x16x64_bf16 v[100:103], v[184:187], v[48:55], v188
 ds_read_b128 v[152:155], v189 offset:24576
 v_exp_f32 v9, v9
 v_exp_f32 v10, v10
 v_smfmac_f32_32x32x32_bf16 v[80:95], v[180:183], v[56:63], v188
 v_exp_f32 v11, v11
 v_exp_f32 v12, v12
 v_exp_f32 v13, v13
 v_smfmac_f32_16x16x64_bf16 v[100:103], v[184:187], v[56:63], v188
 ds_read_b128 v[156:159], v189 offset:25600
 v_exp_f32 v14, v14
 v_exp_f32 v15, v15
 v_mfma_f32_32x32x16_bf16 v[32:47], v[160:163], v[136:139], v[104:119]
 s_waitcnt lgkmcnt(2)
 v_exp_f32 v16, v16
 v_exp_f32 v17, v17
 v_exp_f32 v18, v18
 v_mfma_f32_32x32x16_bf16 v[32:47], v[164:167], v[140:143], v[32:47]
 v_exp_f32 v19, v19
 v_exp_f32 v20, v20
 v_exp_f32 v21, v21
 v_smfmac_f32_32x32x32_bf16 v[64:79], v[168:171], v[0:7], v188
 global_load_lds_dwordx4 v230, s[62:63] offset:1024 sc1
 v_exp_f32 v22, v22
 v_exp_f32 v23, v23
 v_exp_f32 v24, v24
 v_smfmac_f32_16x16x64_bf16 v[96:99], v[184:187], v[0:7], v188
 ds_read_b128 v[176:179], v189 offset:22528
 v_exp_f32 v25, v25
 v_exp_f32 v26, v26
 v_smfmac_f32_32x32x32_bf16 v[64:79], v[172:175], v[8:15], v188
 v_exp_f32 v27, v27
 v_exp_f32 v28, v28
 v_exp_f32 v29, v29
 v_smfmac_f32_16x16x64_bf16 v[96:99], v[184:187], v[8:15], v188
 ds_read_b128 v[180:183], v189 offset:23552
 v_exp_f32 v30, v30
 v_exp_f32 v31, v31
 v_mfma_f32_32x32x16_bf16 v[48:63], v[160:163], v[144:147], v[120:135]
 s_waitcnt lgkmcnt(2)
 v_exp_f32 v32, v32
 v_exp_f32 v33, v33
 v_exp_f32 v34, v34
 v_mfma_f32_32x32x16_bf16 v[48:63], v[164:167], v[148:151], v[48:63]
 v_exp_f32 v35, v35
 v_exp_f32 v36, v36
 v_exp_f32 v37, v37
 v_smfmac_f32_32x32x32_bf16 v[80:95], v[168:171], v[16:23], v188
 global_load_lds_dwordx4 v230, s[62:63] offset:2048 sc1
 v_exp_f32 v38, v38
 v_exp_f32 v39, v39
 v_exp_f32 v40, v40
 v_smfmac_f32_16x16x64_bf16 v[100:103], v[184:187], v[16:23], v188
 ds_read_b128 v[160:163], v189 offset:28672
 v_exp_f32 v41, v41
 v_exp_f32 v42, v42
 v_smfmac_f32_32x32x32_bf16 v[80:95], v[172:175], v[24:31], v188
 v_exp_f32 v43, v43
 v_exp_f32 v44, v44
 v_exp_f32 v45, v45
 v_smfmac_f32_16x16x64_bf16 v[100:103], v[184:187], v[24:31], v188
 ds_read_b128 v[164:167], v189 offset:29696
 v_exp_f32 v46, v46
 v_exp_f32 v47, v47
 v_mfma_f32_32x32x16_bf16 v[0:15], v[152:155], v[136:139], v[104:119]
 s_waitcnt lgkmcnt(2)
 v_exp_f32 v48, v48
 v_exp_f32 v49, v49
 v_exp_f32 v50, v50
 v_mfma_f32_32x32x16_bf16 v[0:15], v[156:159], v[140:143], v[0:15]
 v_exp_f32 v51, v51
 v_exp_f32 v52, v52
 v_exp_f32 v53, v53
 v_smfmac_f32_32x32x32_bf16 v[64:79], v[176:179], v[32:39], v188
 global_load_lds_dwordx4 v230, s[62:63] offset:3072 sc1
 v_exp_f32 v54, v54
 v_exp_f32 v55, v55
 v_exp_f32 v56, v56
 v_smfmac_f32_16x16x64_bf16 v[96:99], v[184:187], v[32:39], v188
 ds_read_b128 v[168:171], v189 offset:26624
 v_exp_f32 v57, v57
 v_exp_f32 v58, v58
 v_smfmac_f32_32x32x32_bf16 v[64:79], v[180:183], v[40:47], v188
 s_add_u32 s73, s73, 32768
 s_and_b32 s73, s73, 0x3ffff
 v_exp_f32 v59, v59
 v_exp_f32 v60, v60
 v_exp_f32 v61, v61
 v_smfmac_f32_16x16x64_bf16 v[96:99], v[184:187], v[40:47], v188
 ds_read_b128 v[172:175], v189 offset:27648
 v_exp_f32 v62, v62
 v_exp_f32 v63, v63
 v_mfma_f32_32x32x16_bf16 v[16:31], v[152:155], v[144:147], v[120:135]
 s_waitcnt lgkmcnt(2)
 v_exp_f32 v0, v0
 v_exp_f32 v1, v1
 v_exp_f32 v2, v2
 v_mfma_f32_32x32x16_bf16 v[16:31], v[156:159], v[148:151], v[16:31]
 s_add_u32 m0, s67, 98304
 s_waitcnt vmcnt(12)
 v_exp_f32 v3, v3
 v_exp_f32 v4, v4
 v_exp_f32 v5, v5
 v_smfmac_f32_32x32x32_bf16 v[80:95], v[176:179], v[48:55], v188
 global_load_lds_dwordx4 v230, s[60:61] offset:0 sc1
 v_exp_f32 v6, v6
 v_exp_f32 v7, v7
 v_exp_f32 v8, v8
 v_smfmac_f32_16x16x64_bf16 v[100:103], v[184:187], v[48:55], v188
 ds_read_b128 v[152:155], v230 offset:0
 v_exp_f32 v9, v9
 v_exp_f32 v10, v10
 v_smfmac_f32_32x32x32_bf16 v[80:95], v[180:183], v[56:63], v188
 ds_read_b64_tr_b16 a[0:1], v192 offset:0
 ds_read_b64_tr_b16 a[2:3], v192 offset:256
 v_exp_f32 v11, v11
 v_exp_f32 v12, v12
 v_exp_f32 v13, v13
 v_smfmac_f32_16x16x64_bf16 v[100:103], v[184:187], v[56:63], v188
 ds_read_b128 v[156:159], v230 offset:1024
 v_exp_f32 v14, v14
 v_exp_f32 v15, v15
 v_mfma_f32_32x32x16_bf16 v[32:47], v[160:163], v[136:139], v[104:119]
 s_waitcnt lgkmcnt(4)
 v_exp_f32 v16, v16
 v_exp_f32 v17, v17
 v_exp_f32 v18, v18
 v_mfma_f32_32x32x16_bf16 v[32:47], v[164:167], v[140:143], v[32:47]
 s_add_u32 s62, s44, s73
 s_addc_u32 s63, s45, 0
 v_exp_f32 v19, v19
 v_exp_f32 v20, v20
 v_exp_f32 v21, v21
 v_smfmac_f32_32x32x32_bf16 v[64:79], v[168:171], v[0:7], v188
 global_load_lds_dwordx4 v230, s[60:61] offset:1024 sc1
 v_exp_f32 v22, v22
 v_exp_f32 v23, v23
 v_exp_f32 v24, v24
 v_smfmac_f32_16x16x64_bf16 v[96:99], v[184:187], v[0:7], v188
 ds_read_b128 v[176:179], v189 offset:30720
 v_exp_f32 v25, v25
 v_exp_f32 v26, v26
 v_smfmac_f32_32x32x32_bf16 v[64:79], v[172:175], v[8:15], v188
 ds_read_b64_tr_b16 a[4:5], v192 offset:1024
 ds_read_b64_tr_b16 a[6:7], v192 offset:1280
 v_exp_f32 v27, v27
 v_exp_f32 v28, v28
 v_exp_f32 v29, v29
 v_smfmac_f32_16x16x64_bf16 v[96:99], v[184:187], v[8:15], v188
 ds_read_b128 v[180:183], v189 offset:31744
 v_exp_f32 v30, v30
 v_exp_f32 v31, v31
 v_mfma_f32_32x32x16_bf16 v[48:63], v[160:163], v[144:147], v[120:135]
 s_waitcnt lgkmcnt(4)
 v_exp_f32 v32, v32
 v_exp_f32 v33, v33
 v_exp_f32 v34, v34
 v_mfma_f32_32x32x16_bf16 v[48:63], v[164:167], v[148:151], v[48:63]
 v_exp_f32 v35, v35
 v_exp_f32 v36, v36
 v_exp_f32 v37, v37
 v_smfmac_f32_32x32x32_bf16 v[80:95], v[168:171], v[16:23], v188
 global_load_lds_dwordx4 v230, s[60:61] offset:2048 sc1
 v_exp_f32 v38, v38
 v_exp_f32 v39, v39
 v_exp_f32 v40, v40
 v_smfmac_f32_16x16x64_bf16 v[100:103], v[184:187], v[16:23], v188
 ds_read_b128 v[160:163], v230 offset:4096
 v_exp_f32 v41, v41
 v_exp_f32 v42, v42
 v_smfmac_f32_32x32x32_bf16 v[80:95], v[172:175], v[24:31], v188
 ds_read_b64_tr_b16 a[8:9], v192 offset:2048
 ds_read_b64_tr_b16 a[10:11], v192 offset:2304
 v_exp_f32 v43, v43
 v_exp_f32 v44, v44
 v_exp_f32 v45, v45
 v_smfmac_f32_16x16x64_bf16 v[100:103], v[184:187], v[24:31], v188
 ds_read_b128 v[164:167], v230 offset:5120
 v_exp_f32 v46, v46
 v_exp_f32 v47, v47
 v_mfma_f32_32x32x16_bf16 v[0:15], v[152:155], v[136:139], v[104:119]
 s_waitcnt lgkmcnt(4)
 v_exp_f32 v48, v48
 v_exp_f32 v49, v49
 v_exp_f32 v50, v50
 v_mfma_f32_32x32x16_bf16 v[0:15], v[156:159], v[140:143], v[0:15]
 v_exp_f32 v51, v51
 v_exp_f32 v52, v52
 v_exp_f32 v53, v53
 v_smfmac_f32_32x32x32_bf16 v[64:79], v[176:179], v[32:39], v188
 global_load_lds_dwordx4 v230, s[60:61] offset:3072 sc1
 v_exp_f32 v54, v54
 v_exp_f32 v55, v55
 v_exp_f32 v56, v56
 v_smfmac_f32_16x16x64_bf16 v[96:99], v[184:187], v[32:39], v188
 ds_read_b128 v[168:171], v230 offset:2048
 v_exp_f32 v57, v57
 v_exp_f32 v58, v58
 v_smfmac_f32_32x32x32_bf16 v[64:79], v[180:183], v[40:47], v188
 s_add_u32 s72, s72, 32768
 s_and_b32 s72, s72, 0x3ffff
 ds_read_b64_tr_b16 a[12:13], v192 offset:3072
 ds_read_b64_tr_b16 a[14:15], v192 offset:3328
 v_exp_f32 v59, v59
 v_exp_f32 v60, v60
 v_exp_f32 v61, v61
 v_smfmac_f32_16x16x64_bf16 v[96:99], v[184:187], v[40:47], v188
 ds_read_b128 v[172:175], v230 offset:3072
 v_exp_f32 v62, v62
 v_exp_f32 v63, v63
 s_barrier
 v_mfma_f32_32x32x16_bf16 v[16:31], v[152:155], v[144:147], v[120:135]
 s_waitcnt lgkmcnt(4)
 s_waitcnt vmcnt(8)
 v_exp_f32 v0, v0
 v_exp_f32 v1, v1
 v_exp_f32 v2, v2
 v_mfma_f32_32x32x16_bf16 v[16:31], v[156:159], v[148:151], v[16:31]
 s_add_u32 m0, s67, 114688
 v_exp_f32 v3, v3
 v_exp_f32 v4, v4
 v_exp_f32 v5, v5
 v_smfmac_f32_32x32x32_bf16 v[80:95], v[176:179], v[48:55], v188
 global_load_lds_dwordx4 v230, s[62:63] offset:0 sc1
 v_exp_f32 v6, v6
 v_exp_f32 v7, v7
 v_smfmac_f32_16x16x64_bf16 v[100:103], v[184:187], v[48:55], v188
 ds_read_b128 v[152:155], v230 offset:8192
 v_exp_f32 v8, v8
 v_smfmac_f32_32x32x32_bf16 v[80:95], v[180:183], v[56:63], v188
 s_add_u32 s60, s44, s72
 s_addc_u32 s61, s45, 0
 v_exp_f32 v9, v9
 v_exp_f32 v10, v10
 v_exp_f32 v11, v11
 v_smfmac_f32_16x16x64_bf16 v[100:103], v[184:187], v[56:63], v188
 ds_read_b128 v[156:159], v230 offset:9216
 v_exp_f32 v12, v12
 v_mfma_f32_32x32x16_bf16 v[196:211], a[0:3], a[16:19], 0
 v_exp_f32 v13, v13
 v_exp_f32 v14, v14
 v_exp_f32 v15, v15
 v_mfma_f32_32x32x16_bf16 v[32:47], v[160:163], v[136:139], v[104:119]
 s_waitcnt lgkmcnt(2)
 v_exp_f32 v16, v16
 v_exp_f32 v17, v17
 v_exp_f32 v18, v18
 v_mfma_f32_32x32x16_bf16 v[32:47], v[164:167], v[140:143], v[32:47]
 v_exp_f32 v19, v19
 v_exp_f32 v20, v20
 v_exp_f32 v21, v21
 v_smfmac_f32_32x32x32_bf16 v[64:79], v[168:171], v[0:7], v188
 global_load_lds_dwordx4 v230, s[62:63] offset:1024 sc1
 v_exp_f32 v22, v22
 v_exp_f32 v23, v23
 v_smfmac_f32_16x16x64_bf16 v[96:99], v[184:187], v[0:7], v188
 ds_read_b128 v[176:179], v230 offset:6144
 v_exp_f32 v24, v24
 v_smfmac_f32_32x32x32_bf16 v[64:79], v[172:175], v[8:15], v188
 v_exp_f32 v25, v25
 v_exp_f32 v26, v26
 v_exp_f32 v27, v27
 v_smfmac_f32_16x16x64_bf16 v[96:99], v[184:187], v[8:15], v188
 ds_read_b128 v[180:183], v230 offset:7168
 v_exp_f32 v28, v28
 v_mfma_f32_32x32x16_bf16 v[212:227], a[0:3], a[32:35], 0
 v_exp_f32 v29, v29
 v_exp_f32 v30, v30
 v_exp_f32 v31, v31
 v_mfma_f32_32x32x16_bf16 v[48:63], v[160:163], v[144:147], v[120:135]
 s_waitcnt lgkmcnt(2)
 v_exp_f32 v32, v32
 v_exp_f32 v33, v33
 v_exp_f32 v34, v34
 v_mfma_f32_32x32x16_bf16 v[48:63], v[164:167], v[148:151], v[48:63]
 v_exp_f32 v35, v35
 v_exp_f32 v36, v36
 v_exp_f32 v37, v37
 v_smfmac_f32_32x32x32_bf16 v[80:95], v[168:171], v[16:23], v188
 global_load_lds_dwordx4 v230, s[62:63] offset:2048 sc1
 v_exp_f32 v38, v38
 v_exp_f32 v39, v39
 v_smfmac_f32_16x16x64_bf16 v[100:103], v[184:187], v[16:23], v188
 ds_read_b128 v[160:163], v230 offset:12288
 v_exp_f32 v40, v40
 v_smfmac_f32_32x32x32_bf16 v[80:95], v[172:175], v[24:31], v188
 v_exp_f32 v41, v41
 v_exp_f32 v42, v42
 v_exp_f32 v43, v43
 v_smfmac_f32_16x16x64_bf16 v[100:103], v[184:187], v[24:31], v188
 ds_read_b128 v[164:167], v230 offset:13312
 v_exp_f32 v44, v44
 v_mfma_f32_32x32x16_bf16 v[196:211], a[4:7], a[20:23], v[196:211]
 v_exp_f32 v45, v45
 v_exp_f32 v46, v46
 v_exp_f32 v47, v47
 v_mfma_f32_32x32x16_bf16 v[0:15], v[152:155], v[136:139], v[104:119]
 s_waitcnt lgkmcnt(2)
 v_exp_f32 v48, v48
 v_exp_f32 v49, v49
 v_exp_f32 v50, v50
 v_mfma_f32_32x32x16_bf16 v[0:15], v[156:159], v[140:143], v[0:15]
 v_exp_f32 v51, v51
 v_exp_f32 v52, v52
 v_exp_f32 v53, v53
 v_smfmac_f32_32x32x32_bf16 v[64:79], v[176:179], v[32:39], v188
 global_load_lds_dwordx4 v230, s[62:63] offset:3072 sc1
 v_exp_f32 v54, v54
 v_exp_f32 v55, v55
 v_smfmac_f32_16x16x64_bf16 v[96:99], v[184:187], v[32:39], v188
 ds_read_b128 v[168:171], v230 offset:10240
 v_exp_f32 v56, v56
 v_smfmac_f32_32x32x32_bf16 v[64:79], v[180:183], v[40:47], v188
 s_add_u32 s73, s73, 32768
 s_and_b32 s73, s73, 0x3ffff
 v_exp_f32 v57, v57
 v_exp_f32 v58, v58
 v_exp_f32 v59, v59
 v_smfmac_f32_16x16x64_bf16 v[96:99], v[184:187], v[40:47], v188
 ds_read_b128 v[172:175], v230 offset:11264
 v_exp_f32 v60, v60
 v_mfma_f32_32x32x16_bf16 v[212:227], a[4:7], a[36:39], v[212:227]
 v_exp_f32 v61, v61
 v_exp_f32 v62, v62
 v_exp_f32 v63, v63
 v_mfma_f32_32x32x16_bf16 v[16:31], v[152:155], v[144:147], v[120:135]
 s_waitcnt lgkmcnt(2)
 v_exp_f32 v0, v0
 v_exp_f32 v1, v1
 v_exp_f32 v2, v2
 v_mfma_f32_32x32x16_bf16 v[16:31], v[156:159], v[148:151], v[16:31]
 s_add_u32 m0, s67, 65536
 v_exp_f32 v3, v3
 v_exp_f32 v4, v4
 v_exp_f32 v5, v5
 v_smfmac_f32_32x32x32_bf16 v[80:95], v[176:179], v[48:55], v188
 global_load_lds_dwordx4 v230, s[60:61] offset:0 sc1
 v_exp_f32 v6, v6
 v_exp_f32 v7, v7
 v_smfmac_f32_16x16x64_bf16 v[100:103], v[184:187], v[48:55], v188
 ds_read_b128 v[152:155], v230 offset:16384
 v_exp_f32 v8, v8
 v_smfmac_f32_32x32x32_bf16 v[80:95], v[180:183], v[56:63], v188
 s_add_u32 s62, s44, s73
 s_addc_u32 s63, s45, 0
 v_exp_f32 v9, v9
 v_exp_f32 v10, v10
 v_exp_f32 v11, v11
 v_smfmac_f32_16x16x64_bf16 v[100:103], v[184:187], v[56:63], v188
 ds_read_b128 v[156:159], v230 offset:17408
 v_exp_f32 v12, v12
 v_mfma_f32_32x32x16_bf16 v[196:211], a[8:11], a[24:27], v[196:211]
 v_exp_f32 v13, v13
 v_exp_f32 v14, v14
 v_exp_f32 v15, v15
 v_mfma_f32_32x32x16_bf16 v[32:47], v[160:163], v[136:139], v[104:119]
 s_waitcnt lgkmcnt(2)
 v_exp_f32 v16, v16
 v_exp_f32 v17, v17
 v_exp_f32 v18, v18
 v_mfma_f32_32x32x16_bf16 v[32:47], v[164:167], v[140:143], v[32:47]
 s_add_u32 s79, s79, 4096
 v_exp_f32 v19, v19
 v_exp_f32 v20, v20
 v_exp_f32 v21, v21
 v_smfmac_f32_32x32x32_bf16 v[64:79], v[168:171], v[0:7], v188
 global_load_lds_dwordx4 v230, s[60:61] offset:1024 sc1
 v_exp_f32 v22, v22
 v_exp_f32 v23, v23
 v_smfmac_f32_16x16x64_bf16 v[96:99], v[184:187], v[0:7], v188
 ds_read_b128 v[176:179], v230 offset:14336
 v_exp_f32 v24, v24
 v_smfmac_f32_32x32x32_bf16 v[64:79], v[172:175], v[8:15], v188
 v_exp_f32 v25, v25
 v_exp_f32 v26, v26
 v_exp_f32 v27, v27
 v_smfmac_f32_16x16x64_bf16 v[96:99], v[184:187], v[8:15], v188
 ds_read_b128 v[180:183], v230 offset:15360
 v_exp_f32 v28, v28
 v_mfma_f32_32x32x16_bf16 v[212:227], a[8:11], a[40:43], v[212:227]
 v_exp_f32 v29, v29
 v_exp_f32 v30, v30
 v_exp_f32 v31, v31
 v_mfma_f32_32x32x16_bf16 v[48:63], v[160:163], v[144:147], v[120:135]
 s_waitcnt lgkmcnt(2)
 v_exp_f32 v32, v32
 v_exp_f32 v33, v33
 v_exp_f32 v34, v34
 v_mfma_f32_32x32x16_bf16 v[48:63], v[164:167], v[148:151], v[48:63]
 s_add_u32 s38, s56, s79
 s_addc_u32 s39, s57, 0
 v_exp_f32 v35, v35
 v_exp_f32 v36, v36
 v_exp_f32 v37, v37
 v_smfmac_f32_32x32x32_bf16 v[80:95], v[168:171], v[16:23], v188
 global_load_lds_dwordx4 v230, s[60:61] offset:2048 sc1
 v_exp_f32 v38, v38
 v_exp_f32 v39, v39
 v_smfmac_f32_16x16x64_bf16 v[100:103], v[184:187], v[16:23], v188
 ds_read_b128 v[160:163], v230 offset:20480
 v_exp_f32 v40, v40
 v_smfmac_f32_32x32x32_bf16 v[80:95], v[172:175], v[24:31], v188
 v_exp_f32 v41, v41
 v_exp_f32 v42, v42
 v_exp_f32 v43, v43
 v_smfmac_f32_16x16x64_bf16 v[100:103], v[184:187], v[24:31], v188
 ds_read_b128 v[164:167], v230 offset:21504
 v_exp_f32 v44, v44
 v_mfma_f32_32x32x16_bf16 v[196:211], a[12:15], a[28:31], v[196:211]
 v_exp_f32 v45, v45
 v_exp_f32 v46, v46
 v_exp_f32 v47, v47
 v_mfma_f32_32x32x16_bf16 v[0:15], v[152:155], v[136:139], v[104:119]
 s_waitcnt lgkmcnt(2)
 v_exp_f32 v48, v48
 v_exp_f32 v49, v49
 v_exp_f32 v50, v50
 v_mfma_f32_32x32x16_bf16 v[0:15], v[156:159], v[140:143], v[0:15]
 v_exp_f32 v51, v51
 v_exp_f32 v52, v52
 v_exp_f32 v53, v53
 v_smfmac_f32_32x32x32_bf16 v[64:79], v[176:179], v[32:39], v188
 global_load_lds_dwordx4 v230, s[60:61] offset:3072 sc1
 v_exp_f32 v54, v54
 v_exp_f32 v55, v55
 v_smfmac_f32_16x16x64_bf16 v[96:99], v[184:187], v[32:39], v188
 ds_read_b128 v[168:171], v230 offset:18432
 v_exp_f32 v56, v56
 v_smfmac_f32_32x32x32_bf16 v[64:79], v[180:183], v[40:47], v188
 s_add_u32 s72, s72, 32768
 s_and_b32 s72, s72, 0x3ffff
 v_exp_f32 v57, v57
 v_exp_f32 v58, v58
 v_exp_f32 v59, v59
 v_smfmac_f32_16x16x64_bf16 v[96:99], v[184:187], v[40:47], v188
 ds_read_b128 v[172:175], v230 offset:19456
 v_exp_f32 v60, v60
 v_mfma_f32_32x32x16_bf16 v[212:227], a[12:15], a[44:47], v[212:227]
 v_exp_f32 v61, v61
 v_exp_f32 v62, v62
 v_exp_f32 v63, v63
 v_mfma_f32_32x32x16_bf16 v[16:31], v[152:155], v[144:147], v[120:135]
 s_waitcnt lgkmcnt(2)
 v_exp_f32 v0, v0
 v_exp_f32 v1, v1
 v_exp_f32 v2, v2
 v_mfma_f32_32x32x16_bf16 v[16:31], v[156:159], v[148:151], v[16:31]
 s_add_u32 s60, s44, s72
 s_addc_u32 s61, s45, 0
 v_exp_f32 v3, v3
 v_exp_f32 v4, v4
 v_exp_f32 v5, v5
 v_smfmac_f32_32x32x32_bf16 v[80:95], v[176:179], v[48:55], v188
 global_load_dwordx4 a[48:51], v230, s[38:39] offset:-4096
 v_exp_f32 v6, v6
 v_exp_f32 v7, v7
 v_exp_f32 v8, v8
 v_smfmac_f32_16x16x64_bf16 v[100:103], v[184:187], v[48:55], v188
 ds_read_b128 v[152:155], v230 offset:24576
 v_exp_f32 v9, v9
 v_exp_f32 v10, v10
 v_smfmac_f32_32x32x32_bf16 v[80:95], v[180:183], v[56:63], v188
 v_exp_f32 v11, v11
 v_exp_f32 v12, v12
 v_exp_f32 v13, v13
 v_smfmac_f32_16x16x64_bf16 v[100:103], v[184:187], v[56:63], v188
 ds_read_b128 v[156:159], v230 offset:25600
 v_exp_f32 v14, v14
 v_exp_f32 v15, v15
 v_mfma_f32_32x32x16_bf16 v[32:47], v[160:163], v[136:139], v[104:119]
 s_waitcnt lgkmcnt(2)
 v_exp_f32 v16, v16
 v_exp_f32 v17, v17
 v_exp_f32 v18, v18
 v_mfma_f32_32x32x16_bf16 v[32:47], v[164:167], v[140:143], v[32:47]
 v_exp_f32 v19, v19
 v_exp_f32 v20, v20
 v_exp_f32 v21, v21
 v_smfmac_f32_32x32x32_bf16 v[64:79], v[168:171], v[0:7], v188
 global_load_dwordx4 a[52:55], v230, s[38:39] offset:-3072
 v_exp_f32 v22, v22
 v_exp_f32 v23, v23
 v_exp_f32 v24, v24
 v_smfmac_f32_16x16x64_bf16 v[96:99], v[184:187], v[0:7], v188
 ds_read_b128 v[176:179], v230 offset:22528
 v_exp_f32 v25, v25
 v_exp_f32 v26, v26
 v_cvt_pk_bf16_f32 v196, v196, v197
 v_cvt_pk_bf16_f32 v197, v198, v199
 v_cvt_pk_bf16_f32 v198, v200, v201
 v_cvt_pk_bf16_f32 v199, v202, v203
 v_smfmac_f32_32x32x32_bf16 v[64:79], v[172:175], v[8:15], v188
 v_exp_f32 v27, v27
 v_exp_f32 v28, v28
 v_exp_f32 v29, v29
 v_smfmac_f32_16x16x64_bf16 v[96:99], v[184:187], v[8:15], v188
 ds_read_b128 v[180:183], v230 offset:23552
 v_exp_f32 v30, v30
 v_exp_f32 v31, v31
 v_mfma_f32_32x32x16_bf16 v[48:63], v[160:163], v[144:147], v[120:135]
 s_waitcnt lgkmcnt(2)
 v_exp_f32 v32, v32
 v_exp_f32 v33, v33
 v_exp_f32 v34, v34
 v_mfma_f32_32x32x16_bf16 v[48:63], v[164:167], v[148:151], v[48:63]
 v_exp_f32 v35, v35
 v_exp_f32 v36, v36
 v_exp_f32 v37, v37
 v_smfmac_f32_32x32x32_bf16 v[80:95], v[168:171], v[16:23], v188
 buffer_store_dwordx4 v[196:199], v230, s[44:47], s76 offen offset:0 sc1
 v_exp_f32 v38, v38
 v_exp_f32 v39, v39
 v_exp_f32 v40, v40
 v_smfmac_f32_16x16x64_bf16 v[100:103], v[184:187], v[16:23], v188
 ds_read_b128 v[160:163], v230 offset:28672
 v_exp_f32 v41, v41
 v_exp_f32 v42, v42
 v_cvt_pk_bf16_f32 v200, v204, v205
 v_cvt_pk_bf16_f32 v201, v206, v207
 v_cvt_pk_bf16_f32 v202, v208, v209
 v_cvt_pk_bf16_f32 v203, v210, v211
 v_smfmac_f32_32x32x32_bf16 v[80:95], v[172:175], v[24:31], v188
 v_exp_f32 v43, v43
 v_exp_f32 v44, v44
 v_exp_f32 v45, v45
 v_smfmac_f32_16x16x64_bf16 v[100:103], v[184:187], v[24:31], v188
 ds_read_b128 v[164:167], v230 offset:29696
 v_exp_f32 v46, v46
 v_exp_f32 v47, v47
 v_mfma_f32_32x32x16_bf16 v[0:15], v[152:155], v[136:139], v[104:119]
 s_waitcnt lgkmcnt(2)
 v_exp_f32 v48, v48
 v_exp_f32 v49, v49
 v_exp_f32 v50, v50
 v_mfma_f32_32x32x16_bf16 v[0:15], v[156:159], v[140:143], v[0:15]
 v_exp_f32 v51, v51
 v_exp_f32 v52, v52
 v_exp_f32 v53, v53
 v_smfmac_f32_32x32x32_bf16 v[64:79], v[176:179], v[32:39], v188
 buffer_store_dwordx4 v[200:203], v230, s[44:47], s76 offen offset:1024 sc1
 v_exp_f32 v54, v54
 v_exp_f32 v55, v55
 v_exp_f32 v56, v56
 v_smfmac_f32_16x16x64_bf16 v[96:99], v[184:187], v[32:39], v188
 ds_read_b128 v[168:171], v230 offset:26624
 v_exp_f32 v57, v57
 v_exp_f32 v58, v58
 v_cvt_pk_bf16_f32 v212, v212, v213
 v_cvt_pk_bf16_f32 v213, v214, v215
 v_cvt_pk_bf16_f32 v214, v216, v217
 v_cvt_pk_bf16_f32 v215, v218, v219
 v_smfmac_f32_32x32x32_bf16 v[64:79], v[180:183], v[40:47], v188
 v_exp_f32 v59, v59
 v_exp_f32 v60, v60
 v_exp_f32 v61, v61
 v_smfmac_f32_16x16x64_bf16 v[96:99], v[184:187], v[40:47], v188
 ds_read_b128 v[172:175], v230 offset:27648
 v_exp_f32 v62, v62
 v_exp_f32 v63, v63
 v_mfma_f32_32x32x16_bf16 v[16:31], v[152:155], v[144:147], v[120:135]
 s_waitcnt lgkmcnt(2)
 v_exp_f32 v0, v0
 v_exp_f32 v1, v1
 v_exp_f32 v2, v2
 v_mfma_f32_32x32x16_bf16 v[16:31], v[156:159], v[148:151], v[16:31]
 v_exp_f32 v3, v3
 v_exp_f32 v4, v4
 v_exp_f32 v5, v5
 v_smfmac_f32_32x32x32_bf16 v[80:95], v[176:179], v[48:55], v188
 buffer_store_dwordx4 v[212:215], v230, s[44:47], s76 offen offset:2048 sc1
 v_exp_f32 v6, v6
 v_exp_f32 v7, v7
 v_exp_f32 v8, v8
 v_smfmac_f32_16x16x64_bf16 v[100:103], v[184:187], v[48:55], v188
 ds_read_b128 v[152:155], v230 offset:32768
 v_exp_f32 v9, v9
 v_exp_f32 v10, v10
 v_cvt_pk_bf16_f32 v216, v220, v221
 v_cvt_pk_bf16_f32 v217, v222, v223
 v_cvt_pk_bf16_f32 v218, v224, v225
 v_cvt_pk_bf16_f32 v219, v226, v227
 v_smfmac_f32_32x32x32_bf16 v[80:95], v[180:183], v[56:63], v188
 v_exp_f32 v11, v11
 v_exp_f32 v12, v12
 v_exp_f32 v13, v13
 v_smfmac_f32_16x16x64_bf16 v[100:103], v[184:187], v[56:63], v188
 ds_read_b128 v[156:159], v230 offset:33792
 v_exp_f32 v14, v14
 v_exp_f32 v15, v15
 v_mfma_f32_32x32x16_bf16 v[32:47], v[160:163], v[136:139], v[104:119]
 s_waitcnt lgkmcnt(2)
 v_exp_f32 v16, v16
 v_exp_f32 v17, v17
 v_exp_f32 v18, v18
 v_mfma_f32_32x32x16_bf16 v[32:47], v[164:167], v[140:143], v[32:47]
 v_exp_f32 v19, v19
 v_exp_f32 v20, v20
 v_exp_f32 v21, v21
 v_smfmac_f32_32x32x32_bf16 v[64:79], v[168:171], v[0:7], v188
 buffer_store_dwordx4 v[216:219], v230, s[44:47], s76 offen offset:3072 sc1
 v_exp_f32 v22, v22
 v_exp_f32 v23, v23
 v_exp_f32 v24, v24
 v_smfmac_f32_16x16x64_bf16 v[96:99], v[184:187], v[0:7], v188
 ds_read_b128 v[176:179], v230 offset:30720
 v_exp_f32 v25, v25
 v_exp_f32 v26, v26
 v_smfmac_f32_32x32x32_bf16 v[64:79], v[172:175], v[8:15], v188
 v_exp_f32 v27, v27
 v_exp_f32 v28, v28
 v_exp_f32 v29, v29
 v_smfmac_f32_16x16x64_bf16 v[96:99], v[184:187], v[8:15], v188
 ds_read_b128 v[180:183], v230 offset:31744
 v_exp_f32 v30, v30
 v_exp_f32 v31, v31
 v_mfma_f32_32x32x16_bf16 v[48:63], v[160:163], v[144:147], v[120:135]
 s_waitcnt lgkmcnt(2)
 v_exp_f32 v32, v32
 v_exp_f32 v33, v33
 v_exp_f32 v34, v34
 v_mfma_f32_32x32x16_bf16 v[48:63], v[164:167], v[148:151], v[48:63]
 s_add_u32 m0, s67, 81920
 v_exp_f32 v35, v35
 v_exp_f32 v36, v36
 v_exp_f32 v37, v37
 v_smfmac_f32_32x32x32_bf16 v[80:95], v[168:171], v[16:23], v188
 global_load_lds_dwordx4 v230, s[62:63] offset:0 sc1
 v_exp_f32 v38, v38
 v_exp_f32 v39, v39
 v_exp_f32 v40, v40
 v_smfmac_f32_16x16x64_bf16 v[100:103], v[184:187], v[16:23], v188
 ds_read_b128 v[160:163], v230 offset:36864
 v_exp_f32 v41, v41
 v_exp_f32 v42, v42
 v_smfmac_f32_32x32x32_bf16 v[80:95], v[172:175], v[24:31], v188
 v_exp_f32 v43, v43
 v_exp_f32 v44, v44
 v_exp_f32 v45, v45
 v_smfmac_f32_16x16x64_bf16 v[100:103], v[184:187], v[24:31], v188
 ds_read_b128 v[164:167], v230 offset:37888
 v_exp_f32 v46, v46
 v_exp_f32 v47, v47
 v_mfma_f32_32x32x16_bf16 v[0:15], v[152:155], v[136:139], v[104:119]
 s_waitcnt lgkmcnt(2)
 v_exp_f32 v48, v48
 v_exp_f32 v49, v49
 v_exp_f32 v50, v50
 v_mfma_f32_32x32x16_bf16 v[0:15], v[156:159], v[140:143], v[0:15]
 v_exp_f32 v51, v51
 v_exp_f32 v52, v52
 v_exp_f32 v53, v53
 v_smfmac_f32_32x32x32_bf16 v[64:79], v[176:179], v[32:39], v188
 global_load_lds_dwordx4 v230, s[62:63] offset:1024 sc1
 v_exp_f32 v54, v54
 v_exp_f32 v55, v55
 v_exp_f32 v56, v56
 v_smfmac_f32_16x16x64_bf16 v[96:99], v[184:187], v[32:39], v188
 ds_read_b128 v[168:171], v230 offset:34816
 v_exp_f32 v57, v57
 v_exp_f32 v58, v58
 v_smfmac_f32_32x32x32_bf16 v[64:79], v[180:183], v[40:47], v188
 v_exp_f32 v59, v59
 v_exp_f32 v60, v60
 v_exp_f32 v61, v61
 v_smfmac_f32_16x16x64_bf16 v[96:99], v[184:187], v[40:47], v188
 ds_read_b128 v[172:175], v230 offset:35840
 v_exp_f32 v62, v62
 v_exp_f32 v63, v63
 s_waitcnt vmcnt(16)
 s_barrier
 v_mfma_f32_32x32x16_bf16 v[16:31], v[152:155], v[144:147], v[120:135]
 s_waitcnt lgkmcnt(2)
 v_exp_f32 v0, v0
 v_exp_f32 v1, v1
 v_exp_f32 v2, v2
 v_mfma_f32_32x32x16_bf16 v[16:31], v[156:159], v[148:151], v[16:31]
 v_exp_f32 v3, v3
 v_exp_f32 v4, v4
 v_exp_f32 v5, v5
 v_smfmac_f32_32x32x32_bf16 v[80:95], v[176:179], v[48:55], v188
 global_load_lds_dwordx4 v230, s[62:63] offset:2048 sc1
 v_exp_f32 v6, v6
 v_exp_f32 v7, v7
 v_exp_f32 v8, v8
 v_smfmac_f32_16x16x64_bf16 v[100:103], v[184:187], v[48:55], v188
 ds_read_b128 v[152:155], v230 offset:40960
 v_exp_f32 v9, v9
 v_exp_f32 v10, v10
 v_smfmac_f32_32x32x32_bf16 v[80:95], v[180:183], v[56:63], v188
 v_exp_f32 v11, v11
 v_exp_f32 v12, v12
 v_exp_f32 v13, v13
 v_smfmac_f32_16x16x64_bf16 v[100:103], v[184:187], v[56:63], v188
 ds_read_b128 v[156:159], v230 offset:41984
 v_exp_f32 v14, v14
 v_exp_f32 v15, v15
 v_mfma_f32_32x32x16_bf16 v[32:47], v[160:163], v[136:139], v[104:119]
 s_waitcnt lgkmcnt(2)
 v_exp_f32 v16, v16
 v_exp_f32 v17, v17
 v_exp_f32 v18, v18
 v_mfma_f32_32x32x16_bf16 v[32:47], v[164:167], v[140:143], v[32:47]
 v_exp_f32 v19, v19
 v_exp_f32 v20, v20
 v_exp_f32 v21, v21
 v_smfmac_f32_32x32x32_bf16 v[64:79], v[168:171], v[0:7], v188
 global_load_lds_dwordx4 v230, s[62:63] offset:3072 sc1
 v_exp_f32 v22, v22
 v_exp_f32 v23, v23
 v_exp_f32 v24, v24
 v_smfmac_f32_16x16x64_bf16 v[96:99], v[184:187], v[0:7], v188
 ds_read_b128 v[176:179], v230 offset:38912
 v_exp_f32 v25, v25
 v_exp_f32 v26, v26
 v_smfmac_f32_32x32x32_bf16 v[64:79], v[172:175], v[8:15], v188
 s_add_u32 s73, s73, 32768
 s_and_b32 s73, s73, 0x3ffff
 v_exp_f32 v27, v27
 v_exp_f32 v28, v28
 v_exp_f32 v29, v29
 v_smfmac_f32_16x16x64_bf16 v[96:99], v[184:187], v[8:15], v188
 ds_read_b128 v[180:183], v230 offset:39936
 v_exp_f32 v30, v30
 v_exp_f32 v31, v31
 v_mfma_f32_32x32x16_bf16 v[48:63], v[160:163], v[144:147], v[120:135]
 s_waitcnt lgkmcnt(2)
 v_exp_f32 v32, v32
 v_exp_f32 v33, v33
 v_exp_f32 v34, v34
 v_mfma_f32_32x32x16_bf16 v[48:63], v[164:167], v[148:151], v[48:63]
 s_add_u32 m0, s67, 0
 v_exp_f32 v35, v35
 v_exp_f32 v36, v36
 v_exp_f32 v37, v37
 v_smfmac_f32_32x32x32_bf16 v[80:95], v[168:171], v[16:23], v188
 global_load_lds_dwordx4 v230, s[60:61] offset:0 sc1
 v_exp_f32 v38, v38
 v_exp_f32 v39, v39
 v_exp_f32 v40, v40
 v_smfmac_f32_16x16x64_bf16 v[100:103], v[184:187], v[16:23], v188
 ds_read_b128 v[160:163], v230 offset:45056
 v_exp_f32 v41, v41
 v_exp_f32 v42, v42
 v_smfmac_f32_32x32x32_bf16 v[80:95], v[172:175], v[24:31], v188
 s_add_u32 s62, s44, s73
 s_addc_u32 s63, s45, 0
 v_exp_f32 v43, v43
 v_exp_f32 v44, v44
 v_exp_f32 v45, v45
 v_smfmac_f32_16x16x64_bf16 v[100:103], v[184:187], v[24:31], v188
 ds_read_b128 v[164:167], v230 offset:46080
 v_exp_f32 v46, v46
 v_exp_f32 v47, v47
 v_mfma_f32_32x32x16_bf16 v[0:15], v[152:155], v[136:139], v[104:119]
 s_waitcnt lgkmcnt(2)
 v_exp_f32 v48, v48
 v_exp_f32 v49, v49
 v_exp_f32 v50, v50
 v_mfma_f32_32x32x16_bf16 v[0:15], v[156:159], v[140:143], v[0:15]
 v_exp_f32 v51, v51
 v_exp_f32 v52, v52
 v_exp_f32 v53, v53
 v_smfmac_f32_32x32x32_bf16 v[64:79], v[176:179], v[32:39], v188
 global_load_lds_dwordx4 v230, s[60:61] offset:1024 sc1
 v_exp_f32 v54, v54
 v_exp_f32 v55, v55
 v_exp_f32 v56, v56
 v_smfmac_f32_16x16x64_bf16 v[96:99], v[184:187], v[32:39], v188
 ds_read_b128 v[168:171], v230 offset:43008
 v_exp_f32 v57, v57
 v_exp_f32 v58, v58
 v_smfmac_f32_32x32x32_bf16 v[64:79], v[180:183], v[40:47], v188
 v_exp_f32 v59, v59
 v_exp_f32 v60, v60
 v_exp_f32 v61, v61
 v_smfmac_f32_16x16x64_bf16 v[96:99], v[184:187], v[40:47], v188
 ds_read_b128 v[172:175], v230 offset:44032
 v_exp_f32 v62, v62
 v_exp_f32 v63, v63
 v_mfma_f32_32x32x16_bf16 v[16:31], v[152:155], v[144:147], v[120:135]
 s_waitcnt lgkmcnt(2)
 v_exp_f32 v0, v0
 v_exp_f32 v1, v1
 v_exp_f32 v2, v2
 v_mfma_f32_32x32x16_bf16 v[16:31], v[156:159], v[148:151], v[16:31]
 v_exp_f32 v3, v3
 v_exp_f32 v4, v4
 v_exp_f32 v5, v5
 v_smfmac_f32_32x32x32_bf16 v[80:95], v[176:179], v[48:55], v188
 global_load_lds_dwordx4 v230, s[60:61] offset:2048 sc1
 v_exp_f32 v6, v6
 v_exp_f32 v7, v7
 v_exp_f32 v8, v8
 v_smfmac_f32_16x16x64_bf16 v[100:103], v[184:187], v[48:55], v188
 ds_read_b128 v[152:155], v230 offset:49152
 v_exp_f32 v9, v9
 v_exp_f32 v10, v10
 v_smfmac_f32_32x32x32_bf16 v[80:95], v[180:183], v[56:63], v188
 v_exp_f32 v11, v11
 v_exp_f32 v12, v12
 v_exp_f32 v13, v13
 v_smfmac_f32_16x16x64_bf16 v[100:103], v[184:187], v[56:63], v188
 ds_read_b128 v[156:159], v230 offset:50176
 v_exp_f32 v14, v14
 v_exp_f32 v15, v15
 v_mfma_f32_32x32x16_bf16 v[32:47], v[160:163], v[136:139], v[104:119]
 s_waitcnt lgkmcnt(2)
 v_exp_f32 v16, v16
 v_exp_f32 v17, v17
 v_exp_f32 v18, v18
 v_mfma_f32_32x32x16_bf16 v[32:47], v[164:167], v[140:143], v[32:47]
 s_waitcnt vmcnt(7)
 v_exp_f32 v19, v19
 v_exp_f32 v20, v20
 v_exp_f32 v21, v21
 v_smfmac_f32_32x32x32_bf16 v[64:79], v[168:171], v[0:7], v188
 global_load_lds_dwordx4 v230, s[60:61] offset:3072 sc1
 v_exp_f32 v22, v22
 v_exp_f32 v23, v23
 v_exp_f32 v24, v24
 v_smfmac_f32_16x16x64_bf16 v[96:99], v[184:187], v[0:7], v188
 ds_read_b128 v[176:179], v230 offset:47104
 v_exp_f32 v25, v25
 v_exp_f32 v26, v26
 v_mov_b32 v251, s64
 v_smfmac_f32_32x32x32_bf16 v[64:79], v[172:175], v[8:15], v188
 s_add_u32 s72, s72, 32768
 s_and_b32 s72, s72, 0x3ffff
 buffer_store_dword v251, v237, s[44:47], s77 offen sc1
 v_exp_f32 v27, v27
 v_exp_f32 v28, v28
 v_exp_f32 v29, v29
 v_smfmac_f32_16x16x64_bf16 v[96:99], v[184:187], v[8:15], v188
 ds_read_b128 v[180:183], v230 offset:48128
 v_exp_f32 v30, v30
 v_exp_f32 v31, v31
 v_mfma_f32_32x32x16_bf16 v[48:63], v[160:163], v[144:147], v[120:135]
 s_waitcnt lgkmcnt(2)
 v_exp_f32 v32, v32
 v_exp_f32 v33, v33
 v_exp_f32 v34, v34
 v_mfma_f32_32x32x16_bf16 v[48:63], v[164:167], v[148:151], v[48:63]
 s_add_u32 m0, s67, 16384
 v_exp_f32 v35, v35
 v_exp_f32 v36, v36
 v_exp_f32 v37, v37
 v_smfmac_f32_32x32x32_bf16 v[80:95], v[168:171], v[16:23], v188
 global_load_lds_dwordx4 v230, s[62:63] offset:0 sc1
 v_exp_f32 v38, v38
 v_exp_f32 v39, v39
 v_exp_f32 v40, v40
 v_smfmac_f32_16x16x64_bf16 v[100:103], v[184:187], v[16:23], v188
 ds_read_b128 v[160:163], v230 offset:53248
 v_exp_f32 v41, v41
 v_exp_f32 v42, v42
 v_smfmac_f32_32x32x32_bf16 v[80:95], v[172:175], v[24:31], v188
 s_add_u32 s60, s44, s72
 s_addc_u32 s61, s45, 0
 v_exp_f32 v43, v43
 v_exp_f32 v44, v44
 v_exp_f32 v45, v45
 v_smfmac_f32_16x16x64_bf16 v[100:103], v[184:187], v[24:31], v188
 ds_read_b128 v[164:167], v230 offset:54272
 v_exp_f32 v46, v46
 v_exp_f32 v47, v47
 v_mfma_f32_32x32x16_bf16 v[0:15], v[152:155], v[136:139], v[104:119]
 s_waitcnt lgkmcnt(2)
 v_exp_f32 v48, v48
 v_exp_f32 v49, v49
 v_exp_f32 v50, v50
 v_mfma_f32_32x32x16_bf16 v[0:15], v[156:159], v[140:143], v[0:15]
 v_exp_f32 v51, v51
 v_exp_f32 v52, v52
 v_exp_f32 v53, v53
 v_smfmac_f32_32x32x32_bf16 v[64:79], v[176:179], v[32:39], v188
 global_load_lds_dwordx4 v230, s[62:63] offset:1024 sc1
 v_exp_f32 v54, v54
 v_exp_f32 v55, v55
 v_exp_f32 v56, v56
 v_smfmac_f32_16x16x64_bf16 v[96:99], v[184:187], v[32:39], v188
 ds_read_b128 v[168:171], v230 offset:51200
 v_exp_f32 v57, v57
 v_exp_f32 v58, v58
 v_smfmac_f32_32x32x32_bf16 v[64:79], v[180:183], v[40:47], v188
 v_exp_f32 v59, v59
 v_exp_f32 v60, v60
 v_exp_f32 v61, v61
 v_smfmac_f32_16x16x64_bf16 v[96:99], v[184:187], v[40:47], v188
 ds_read_b128 v[172:175], v230 offset:52224
 v_exp_f32 v62, v62
 v_exp_f32 v63, v63
 v_mfma_f32_32x32x16_bf16 v[16:31], v[152:155], v[144:147], v[120:135]
 s_waitcnt lgkmcnt(2)
 v_exp_f32 v0, v0
 v_exp_f32 v1, v1
 v_exp_f32 v2, v2
 v_mfma_f32_32x32x16_bf16 v[16:31], v[156:159], v[148:151], v[16:31]
 v_exp_f32 v3, v3
 v_exp_f32 v4, v4
 v_exp_f32 v5, v5
 v_smfmac_f32_32x32x32_bf16 v[80:95], v[176:179], v[48:55], v188
 global_load_lds_dwordx4 v230, s[62:63] offset:2048 sc1
 v_exp_f32 v6, v6
 v_exp_f32 v7, v7
 v_exp_f32 v8, v8
 v_smfmac_f32_16x16x64_bf16 v[100:103], v[184:187], v[48:55], v188
 ds_read_b128 v[152:155], v230 offset:57344
 v_exp_f32 v9, v9
 v_exp_f32 v10, v10
 v_smfmac_f32_32x32x32_bf16 v[80:95], v[180:183], v[56:63], v188
 v_exp_f32 v11, v11
 v_exp_f32 v12, v12
 v_exp_f32 v13, v13
 v_smfmac_f32_16x16x64_bf16 v[100:103], v[184:187], v[56:63], v188
 ds_read_b128 v[156:159], v230 offset:58368
 v_exp_f32 v14, v14
 v_exp_f32 v15, v15
 v_mfma_f32_32x32x16_bf16 v[32:47], v[160:163], v[136:139], v[104:119]
 s_waitcnt lgkmcnt(2)
 v_exp_f32 v16, v16
 v_exp_f32 v17, v17
 v_exp_f32 v18, v18
 v_mfma_f32_32x32x16_bf16 v[32:47], v[164:167], v[140:143], v[32:47]
 v_exp_f32 v19, v19
 v_exp_f32 v20, v20
 v_exp_f32 v21, v21
 v_smfmac_f32_32x32x32_bf16 v[64:79], v[168:171], v[0:7], v188
 global_load_lds_dwordx4 v230, s[62:63] offset:3072 sc1
 v_exp_f32 v22, v22
 v_exp_f32 v23, v23
 v_exp_f32 v24, v24
 v_smfmac_f32_16x16x64_bf16 v[96:99], v[184:187], v[0:7], v188
 ds_read_b128 v[176:179], v230 offset:55296
 v_exp_f32 v25, v25
 v_exp_f32 v26, v26
 v_smfmac_f32_32x32x32_bf16 v[64:79], v[172:175], v[8:15], v188
 s_add_u32 s73, s73, 32768
 s_and_b32 s73, s73, 0x3ffff
 v_exp_f32 v27, v27
 v_exp_f32 v28, v28
 v_exp_f32 v29, v29
 v_smfmac_f32_16x16x64_bf16 v[96:99], v[184:187], v[8:15], v188
 ds_read_b128 v[180:183], v230 offset:56320
 v_exp_f32 v30, v30
 v_exp_f32 v31, v31
 v_mfma_f32_32x32x16_bf16 v[48:63], v[160:163], v[144:147], v[120:135]
 s_waitcnt lgkmcnt(2)
 v_exp_f32 v32, v32
 v_exp_f32 v33, v33
 v_exp_f32 v34, v34
 v_mfma_f32_32x32x16_bf16 v[48:63], v[164:167], v[148:151], v[48:63]
 s_add_u32 s62, s44, s73
 s_addc_u32 s63, s45, 0
 v_exp_f32 v35, v35
 v_exp_f32 v36, v36
 v_exp_f32 v37, v37
 v_smfmac_f32_32x32x32_bf16 v[80:95], v[168:171], v[16:23], v188
 global_load_dwordx4 a[56:59], v230, s[38:39] offset:-2048
 v_exp_f32 v38, v38
 v_exp_f32 v39, v39
 v_exp_f32 v40, v40
 v_smfmac_f32_16x16x64_bf16 v[100:103], v[184:187], v[16:23], v188
 ds_read_b128 v[160:163], v230 offset:61440
 v_exp_f32 v41, v41
 v_exp_f32 v42, v42
 v_smfmac_f32_32x32x32_bf16 v[80:95], v[172:175], v[24:31], v188
 v_exp_f32 v43, v43
 v_exp_f32 v44, v44
 v_exp_f32 v45, v45
 v_smfmac_f32_16x16x64_bf16 v[100:103], v[184:187], v[24:31], v188
 ds_read_b128 v[164:167], v230 offset:62464
 v_exp_f32 v46, v46
 v_exp_f32 v47, v47
 v_mfma_f32_32x32x16_bf16 v[0:15], v[152:155], v[136:139], v[104:119]
 s_waitcnt lgkmcnt(2)
 v_exp_f32 v48, v48
 v_exp_f32 v49, v49
 v_exp_f32 v50, v50
 v_mfma_f32_32x32x16_bf16 v[0:15], v[156:159], v[140:143], v[0:15]
 v_exp_f32 v51, v51
 v_exp_f32 v52, v52
 v_exp_f32 v53, v53
 v_smfmac_f32_32x32x32_bf16 v[64:79], v[176:179], v[32:39], v188
 global_load_dwordx4 a[60:63], v230, s[38:39] offset:-1024
 v_exp_f32 v54, v54
 v_exp_f32 v55, v55
 v_exp_f32 v56, v56
 v_smfmac_f32_16x16x64_bf16 v[96:99], v[184:187], v[32:39], v188
 ds_read_b128 v[168:171], v230 offset:59392
 v_exp_f32 v57, v57
 v_exp_f32 v58, v58
 v_smfmac_f32_32x32x32_bf16 v[64:79], v[180:183], v[40:47], v188
 v_exp_f32 v59, v59
 v_exp_f32 v60, v60
 v_exp_f32 v61, v61
 v_smfmac_f32_16x16x64_bf16 v[96:99], v[184:187], v[40:47], v188
 ds_read_b128 v[172:175], v230 offset:60416
 v_exp_f32 v62, v62
 v_exp_f32 v63, v63
 v_mfma_f32_32x32x16_bf16 v[16:31], v[152:155], v[144:147], v[120:135]
 s_waitcnt lgkmcnt(2)
 v_exp_f32 v0, v0
 v_exp_f32 v1, v1
 v_exp_f32 v2, v2
 v_mfma_f32_32x32x16_bf16 v[16:31], v[156:159], v[148:151], v[16:31]
 v_exp_f32 v3, v3
 v_exp_f32 v4, v4
 v_exp_f32 v5, v5
 v_smfmac_f32_32x32x32_bf16 v[80:95], v[176:179], v[48:55], v188
 global_load_dwordx4 a[64:67], v230, s[38:39] offset:0
 v_exp_f32 v6, v6
 v_exp_f32 v7, v7
 v_exp_f32 v8, v8
 v_smfmac_f32_16x16x64_bf16 v[100:103], v[184:187], v[48:55], v188
 ds_read_b128 v[152:155], v189 offset:32768
 v_exp_f32 v9, v9
 v_exp_f32 v10, v10
 v_smfmac_f32_32x32x32_bf16 v[80:95], v[180:183], v[56:63], v188
 v_exp_f32 v11, v11
 v_exp_f32 v12, v12
 v_exp_f32 v13, v13
 v_smfmac_f32_16x16x64_bf16 v[100:103], v[184:187], v[56:63], v188
 ds_read_b128 v[156:159], v189 offset:33792
 v_exp_f32 v14, v14
 v_exp_f32 v15, v15
 v_mfma_f32_32x32x16_bf16 v[32:47], v[160:163], v[136:139], v[104:119]
 s_waitcnt lgkmcnt(2)
 v_exp_f32 v16, v16
 v_exp_f32 v17, v17
 v_exp_f32 v18, v18
 v_mfma_f32_32x32x16_bf16 v[32:47], v[164:167], v[140:143], v[32:47]
 v_exp_f32 v19, v19
 v_exp_f32 v20, v20
 v_exp_f32 v21, v21
 v_smfmac_f32_32x32x32_bf16 v[64:79], v[168:171], v[0:7], v188
 global_load_dwordx4 a[68:71], v230, s[38:39] offset:1024
 v_exp_f32 v22, v22
 v_exp_f32 v23, v23
 v_exp_f32 v24, v24
 v_smfmac_f32_16x16x64_bf16 v[96:99], v[184:187], v[0:7], v188
 ds_read_b128 v[176:179], v230 offset:63488
 v_exp_f32 v25, v25
 v_exp_f32 v26, v26
 v_smfmac_f32_32x32x32_bf16 v[64:79], v[172:175], v[8:15], v188
 v_exp_f32 v27, v27
 v_exp_f32 v28, v28
 v_exp_f32 v29, v29
 v_smfmac_f32_16x16x64_bf16 v[96:99], v[184:187], v[8:15], v188
 ds_read_b128 v[180:183], v230 offset:64512
 v_exp_f32 v30, v30
 v_exp_f32 v31, v31
 v_mfma_f32_32x32x16_bf16 v[48:63], v[160:163], v[144:147], v[120:135]
 s_waitcnt lgkmcnt(2)
 v_exp_f32 v32, v32
 v_exp_f32 v33, v33
 v_exp_f32 v34, v34
 v_mfma_f32_32x32x16_bf16 v[48:63], v[164:167], v[148:151], v[48:63]
 v_exp_f32 v35, v35
 v_exp_f32 v36, v36
 v_exp_f32 v37, v37
 v_smfmac_f32_32x32x32_bf16 v[80:95], v[168:171], v[16:23], v188
 global_load_dwordx4 a[72:75], v230, s[38:39] offset:2048
 v_exp_f32 v38, v38
 v_exp_f32 v39, v39
 v_exp_f32 v40, v40
 v_smfmac_f32_16x16x64_bf16 v[100:103], v[184:187], v[16:23], v188
 ds_read_b128 v[160:163], v189 offset:36864
 v_exp_f32 v41, v41
 v_exp_f32 v42, v42
 v_smfmac_f32_32x32x32_bf16 v[80:95], v[172:175], v[24:31], v188
 v_exp_f32 v43, v43
 v_exp_f32 v44, v44
 v_exp_f32 v45, v45
 v_smfmac_f32_16x16x64_bf16 v[100:103], v[184:187], v[24:31], v188
 ds_read_b128 v[164:167], v189 offset:37888
 v_exp_f32 v46, v46
 v_exp_f32 v47, v47
 v_mfma_f32_32x32x16_bf16 v[0:15], v[152:155], v[136:139], v[104:119]
 s_waitcnt lgkmcnt(2)
 v_exp_f32 v48, v48
 v_exp_f32 v49, v49
 v_exp_f32 v50, v50
 v_mfma_f32_32x32x16_bf16 v[0:15], v[156:159], v[140:143], v[0:15]
 v_exp_f32 v51, v51
 v_exp_f32 v52, v52
 v_exp_f32 v53, v53
 v_smfmac_f32_32x32x32_bf16 v[64:79], v[176:179], v[32:39], v188
 global_load_dwordx4 a[76:79], v230, s[38:39] offset:3072
 v_exp_f32 v54, v54
 v_exp_f32 v55, v55
 v_exp_f32 v56, v56
 v_smfmac_f32_16x16x64_bf16 v[96:99], v[184:187], v[32:39], v188
 ds_read_b128 v[168:171], v189 offset:34816
 v_exp_f32 v57, v57
 v_exp_f32 v58, v58
 v_smfmac_f32_32x32x32_bf16 v[64:79], v[180:183], v[40:47], v188
 v_exp_f32 v59, v59
 v_exp_f32 v60, v60
 v_exp_f32 v61, v61
 v_smfmac_f32_16x16x64_bf16 v[96:99], v[184:187], v[40:47], v188
 ds_read_b128 v[172:175], v189 offset:35840
 v_exp_f32 v62, v62
 v_exp_f32 v63, v63
 s_barrier
 v_mfma_f32_32x32x16_bf16 v[16:31], v[152:155], v[144:147], v[120:135]
 s_waitcnt lgkmcnt(2)
 v_exp_f32 v0, v0
 v_exp_f32 v1, v1
 v_exp_f32 v2, v2
 v_mfma_f32_32x32x16_bf16 v[16:31], v[156:159], v[148:151], v[16:31]
 s_add_u32 m0, s67, 32768
 v_exp_f32 v3, v3
 v_exp_f32 v4, v4
 v_exp_f32 v5, v5
 v_smfmac_f32_32x32x32_bf16 v[80:95], v[176:179], v[48:55], v188
 global_load_lds_dwordx4 v230, s[60:61] offset:0 sc1
 v_exp_f32 v6, v6
 v_exp_f32 v7, v7
 v_exp_f32 v8, v8
 v_smfmac_f32_16x16x64_bf16 v[100:103], v[184:187], v[48:55], v188
 ds_read_b128 v[152:155], v189 offset:40960
 v_exp_f32 v9, v9
 v_exp_f32 v10, v10
 v_smfmac_f32_32x32x32_bf16 v[80:95], v[180:183], v[56:63], v188
 v_exp_f32 v11, v11
 v_exp_f32 v12, v12
 v_exp_f32 v13, v13
 v_smfmac_f32_16x16x64_bf16 v[100:103], v[184:187], v[56:63], v188
 ds_read_b128 v[156:159], v189 offset:41984
 v_exp_f32 v14, v14
 v_exp_f32 v15, v15
 v_mfma_f32_32x32x16_bf16 v[32:47], v[160:163], v[136:139], v[104:119]
 s_waitcnt lgkmcnt(2)
 v_exp_f32 v16, v16
 v_exp_f32 v17, v17
 v_exp_f32 v18, v18
 v_mfma_f32_32x32x16_bf16 v[32:47], v[164:167], v[140:143], v[32:47]
 v_exp_f32 v19, v19
 v_exp_f32 v20, v20
 v_exp_f32 v21, v21
 v_smfmac_f32_32x32x32_bf16 v[64:79], v[168:171], v[0:7], v188
 global_load_lds_dwordx4 v230, s[60:61] offset:1024 sc1
 v_exp_f32 v22, v22
 v_exp_f32 v23, v23
 v_exp_f32 v24, v24
 v_smfmac_f32_16x16x64_bf16 v[96:99], v[184:187], v[0:7], v188
 ds_read_b128 v[176:179], v189 offset:38912
 v_exp_f32 v25, v25
 v_exp_f32 v26, v26
 v_smfmac_f32_32x32x32_bf16 v[64:79], v[172:175], v[8:15], v188
 v_exp_f32 v27, v27
 v_exp_f32 v28, v28
 v_exp_f32 v29, v29
 v_smfmac_f32_16x16x64_bf16 v[96:99], v[184:187], v[8:15], v188
 ds_read_b128 v[180:183], v189 offset:39936
 v_exp_f32 v30, v30
 v_exp_f32 v31, v31
 v_mfma_f32_32x32x16_bf16 v[48:63], v[160:163], v[144:147], v[120:135]
 s_waitcnt lgkmcnt(2)
 v_exp_f32 v32, v32
 v_exp_f32 v33, v33
 v_exp_f32 v34, v34
 v_mfma_f32_32x32x16_bf16 v[48:63], v[164:167], v[148:151], v[48:63]
 v_exp_f32 v35, v35
 v_exp_f32 v36, v36
 v_exp_f32 v37, v37
 v_smfmac_f32_32x32x32_bf16 v[80:95], v[168:171], v[16:23], v188
 global_load_lds_dwordx4 v230, s[60:61] offset:2048 sc1
 v_exp_f32 v38, v38
 v_exp_f32 v39, v39
 v_exp_f32 v40, v40
 v_smfmac_f32_16x16x64_bf16 v[100:103], v[184:187], v[16:23], v188
 ds_read_b128 v[160:163], v189 offset:45056
 v_exp_f32 v41, v41
 v_exp_f32 v42, v42
 v_smfmac_f32_32x32x32_bf16 v[80:95], v[172:175], v[24:31], v188
 v_exp_f32 v43, v43
 v_exp_f32 v44, v44
 v_exp_f32 v45, v45
 v_smfmac_f32_16x16x64_bf16 v[100:103], v[184:187], v[24:31], v188
 ds_read_b128 v[164:167], v189 offset:46080
 v_exp_f32 v46, v46
 v_exp_f32 v47, v47
 v_mfma_f32_32x32x16_bf16 v[0:15], v[152:155], v[136:139], v[104:119]
 s_waitcnt lgkmcnt(2)
 v_exp_f32 v48, v48
 v_exp_f32 v49, v49
 v_exp_f32 v50, v50
 v_mfma_f32_32x32x16_bf16 v[0:15], v[156:159], v[140:143], v[0:15]
 v_exp_f32 v51, v51
 v_exp_f32 v52, v52
 v_exp_f32 v53, v53
 v_smfmac_f32_32x32x32_bf16 v[64:79], v[176:179], v[32:39], v188
 global_load_lds_dwordx4 v230, s[60:61] offset:3072 sc1
 v_exp_f32 v54, v54
 v_exp_f32 v55, v55
 v_exp_f32 v56, v56
 v_smfmac_f32_16x16x64_bf16 v[96:99], v[184:187], v[32:39], v188
 ds_read_b128 v[168:171], v189 offset:43008
 v_exp_f32 v57, v57
 v_exp_f32 v58, v58
 v_smfmac_f32_32x32x32_bf16 v[64:79], v[180:183], v[40:47], v188
 s_add_u32 s72, s72, 32768
 s_and_b32 s72, s72, 0x3ffff
 buffer_load_dword v244, v245, s[44:47], s78 offen sc1
 v_exp_f32 v59, v59
 v_exp_f32 v60, v60
 v_exp_f32 v61, v61
 v_smfmac_f32_16x16x64_bf16 v[96:99], v[184:187], v[40:47], v188
 ds_read_b128 v[172:175], v189 offset:44032
 v_exp_f32 v62, v62
 v_exp_f32 v63, v63
 v_mfma_f32_32x32x16_bf16 v[16:31], v[152:155], v[144:147], v[120:135]
 s_waitcnt lgkmcnt(2)
 v_exp_f32 v0, v0
 v_exp_f32 v1, v1
 v_exp_f32 v2, v2
 v_mfma_f32_32x32x16_bf16 v[16:31], v[156:159], v[148:151], v[16:31]
 s_add_u32 m0, s67, 49152
 v_exp_f32 v3, v3
 v_exp_f32 v4, v4
 v_exp_f32 v5, v5
 v_smfmac_f32_32x32x32_bf16 v[80:95], v[176:179], v[48:55], v188
 global_load_lds_dwordx4 v230, s[62:63] offset:0 sc1
 v_exp_f32 v6, v6
 v_exp_f32 v7, v7
 v_exp_f32 v8, v8
 v_smfmac_f32_16x16x64_bf16 v[100:103], v[184:187], v[48:55], v188
 ds_read_b128 v[152:155], v189 offset:49152
 v_exp_f32 v9, v9
 v_exp_f32 v10, v10
 v_smfmac_f32_32x32x32_bf16 v[80:95], v[180:183], v[56:63], v188
 s_add_u32 s60, s44, s72
 s_addc_u32 s61, s45, 0
 v_exp_f32 v11, v11
 v_exp_f32 v12, v12
 v_exp_f32 v13, v13
 v_smfmac_f32_16x16x64_bf16 v[100:103], v[184:187], v[56:63], v188
 ds_read_b128 v[156:159], v189 offset:50176
 v_exp_f32 v14, v14
 v_exp_f32 v15, v15
 v_mfma_f32_32x32x16_bf16 v[32:47], v[160:163], v[136:139], v[104:119]
 s_waitcnt lgkmcnt(2)
 v_exp_f32 v16, v16
 v_exp_f32 v17, v17
 v_exp_f32 v18, v18
 v_mfma_f32_32x32x16_bf16 v[32:47], v[164:167], v[140:143], v[32:47]
 s_add_u32 s38, s56, 12288
 s_addc_u32 s39, s57, 0
 v_exp_f32 v19, v19
 v_exp_f32 v20, v20
 v_exp_f32 v21, v21
 v_smfmac_f32_32x32x32_bf16 v[64:79], v[168:171], v[0:7], v188
 global_load_lds_dwordx4 v230, s[62:63] offset:1024 sc1
 v_exp_f32 v22, v22
 v_exp_f32 v23, v23
 v_exp_f32 v24, v24
 v_smfmac_f32_16x16x64_bf16 v[96:99], v[184:187], v[0:7], v188
 ds_read_b128 v[176:179], v189 offset:47104
 v_exp_f32 v25, v25
 v_exp_f32 v26, v26
 v_smfmac_f32_32x32x32_bf16 v[64:79], v[172:175], v[8:15], v188
 v_exp_f32 v27, v27
 v_exp_f32 v28, v28
 v_exp_f32 v29, v29
 v_smfmac_f32_16x16x64_bf16 v[96:99], v[184:187], v[8:15], v188
 ds_read_b128 v[180:183], v189 offset:48128
 v_exp_f32 v30, v30
 v_exp_f32 v31, v31
 v_mfma_f32_32x32x16_bf16 v[48:63], v[160:163], v[144:147], v[120:135]
 s_waitcnt lgkmcnt(2)
 v_exp_f32 v32, v32
 v_exp_f32 v33, v33
 v_exp_f32 v34, v34
 v_mfma_f32_32x32x16_bf16 v[48:63], v[164:167], v[148:151], v[48:63]
 v_exp_f32 v35, v35
 v_exp_f32 v36, v36
 v_exp_f32 v37, v37
 v_smfmac_f32_32x32x32_bf16 v[80:95], v[168:171], v[16:23], v188
 global_load_lds_dwordx4 v230, s[62:63] offset:2048 sc1
 v_exp_f32 v38, v38
 v_exp_f32 v39, v39
 v_exp_f32 v40, v40
 v_smfmac_f32_16x16x64_bf16 v[100:103], v[184:187], v[16:23], v188
 ds_read_b128 v[160:163], v189 offset:53248
 v_exp_f32 v41, v41
 v_exp_f32 v42, v42
 v_smfmac_f32_32x32x32_bf16 v[80:95], v[172:175], v[24:31], v188
 v_exp_f32 v43, v43
 v_exp_f32 v44, v44
 v_exp_f32 v45, v45
 v_smfmac_f32_16x16x64_bf16 v[100:103], v[184:187], v[24:31], v188
 ds_read_b128 v[164:167], v189 offset:54272
 v_exp_f32 v46, v46
 v_exp_f32 v47, v47
 v_mfma_f32_32x32x16_bf16 v[0:15], v[152:155], v[136:139], v[104:119]
 s_waitcnt lgkmcnt(2)
 s_waitcnt vmcnt(3)
 v_exp_f32 v48, v48
 v_exp_f32 v49, v49
 v_exp_f32 v50, v50
 v_mfma_f32_32x32x16_bf16 v[0:15], v[156:159], v[140:143], v[0:15]
 v_cmp_ne_u32 vcc, s64, v244
 s_cmp_eq_u64 vcc, 0
 s_cbranch_scc0 Lretry_3
Lback_4:
 v_exp_f32 v51, v51
 v_exp_f32 v52, v52
 v_exp_f32 v53, v53
 v_smfmac_f32_32x32x32_bf16 v[64:79], v[176:179], v[32:39], v188
 global_load_lds_dwordx4 v230, s[62:63] offset:3072 sc1
 v_exp_f32 v54, v54
 v_exp_f32 v55, v55
 v_exp_f32 v56, v56
 v_smfmac_f32_16x16x64_bf16 v[96:99], v[184:187], v[32:39], v188
 ds_read_b128 v[168:171], v189 offset:51200
 v_exp_f32 v57, v57
 v_exp_f32 v58, v58
 v_smfmac_f32_32x32x32_bf16 v[64:79], v[180:183], v[40:47], v188
 s_add_u32 s73, s73, 32768
 s_and_b32 s73, s73, 0x3ffff
 v_exp_f32 v59, v59
 v_exp_f32 v60, v60
 v_exp_f32 v61, v61
 v_smfmac_f32_16x16x64_bf16 v[96:99], v[184:187], v[40:47], v188
 ds_read_b128 v[172:175], v189 offset:52224
 v_exp_f32 v62, v62
 v_exp_f32 v63, v63
 v_mfma_f32_32x32x16_bf16 v[16:31], v[152:155], v[144:147], v[120:135]
 s_waitcnt lgkmcnt(2)
 v_exp_f32 v0, v0
 v_exp_f32 v1, v1
 v_exp_f32 v2, v2
 v_mfma_f32_32x32x16_bf16 v[16:31], v[156:159], v[148:151], v[16:31]
 s_mov_b32 m0, s74
 v_exp_f32 v3, v3
 v_exp_f32 v4, v4
 v_exp_f32 v5, v5
 v_smfmac_f32_32x32x32_bf16 v[80:95], v[176:179], v[48:55], v188
 buffer_load_dwordx4 v232, s[44:47], s86 offen offset:0 sc1 lds
 v_exp_f32 v6, v6
 v_exp_f32 v7, v7
 v_exp_f32 v8, v8
 v_smfmac_f32_16x16x64_bf16 v[100:103], v[184:187], v[48:55], v188
 ds_read_b128 v[152:155], v189 offset:57344
 v_exp_f32 v9, v9
 v_exp_f32 v10, v10
 v_smfmac_f32_32x32x32_bf16 v[80:95], v[180:183], v[56:63], v188
 s_add_u32 s86, s86, 31744
 v_exp_f32 v11, v11
 v_exp_f32 v12, v12
 v_exp_f32 v13, v13
 v_smfmac_f32_16x16x64_bf16 v[100:103], v[184:187], v[56:63], v188
 ds_read_b128 v[156:159], v189 offset:58368
 v_exp_f32 v14, v14
 v_exp_f32 v15, v15
 v_mfma_f32_32x32x16_bf16 v[32:47], v[160:163], v[136:139], v[104:119]
 s_waitcnt lgkmcnt(2)
 v_exp_f32 v16, v16
 v_exp_f32 v17, v17
 v_exp_f32 v18, v18
 v_mfma_f32_32x32x16_bf16 v[32:47], v[164:167], v[140:143], v[32:47]
 s_add_u32 s62, s44, s73
 s_addc_u32 s63, s45, 0
 v_exp_f32 v19, v19
 v_exp_f32 v20, v20
 v_exp_f32 v21, v21
 v_smfmac_f32_32x32x32_bf16 v[64:79], v[168:171], v[0:7], v188
 buffer_load_dwordx4 v232, s[44:47], s86 offen offset:1024 sc1 lds
 v_exp_f32 v22, v22
 v_exp_f32 v23, v23
 v_exp_f32 v24, v24
 v_smfmac_f32_16x16x64_bf16 v[96:99], v[184:187], v[0:7], v188
 ds_read_b128 v[176:179], v189 offset:55296
 v_exp_f32 v25, v25
 v_exp_f32 v26, v26
 v_smfmac_f32_32x32x32_bf16 v[64:79], v[172:175], v[8:15], v188
 s_add_u32 s86, s86, 31744
 v_exp_f32 v27, v27
 v_exp_f32 v28, v28
 v_exp_f32 v29, v29
 v_smfmac_f32_16x16x64_bf16 v[96:99], v[184:187], v[8:15], v188
 ds_read_b128 v[180:183], v189 offset:56320
 v_exp_f32 v30, v30
 v_exp_f32 v31, v31
 v_mfma_f32_32x32x16_bf16 v[48:63], v[160:163], v[144:147], v[120:135]
 s_waitcnt lgkmcnt(2)
 v_exp_f32 v32, v32
 v_exp_f32 v33, v33
 v_exp_f32 v34, v34
 v_mfma_f32_32x32x16_bf16 v[48:63], v[164:167], v[148:151], v[48:63]
 v_exp_f32 v35, v35
 v_exp_f32 v36, v36
 v_exp_f32 v37, v37
 v_smfmac_f32_32x32x32_bf16 v[80:95], v[168:171], v[16:23], v188
 buffer_load_dwordx4 v232, s[44:47], s86 offen offset:2048 sc1 lds
 v_exp_f32 v38, v38
 v_exp_f32 v39, v39
 v_exp_f32 v40, v40
 v_smfmac_f32_16x16x64_bf16 v[100:103], v[184:187], v[16:23], v188
 ds_read_b128 v[160:163], v189 offset:61440
 v_exp_f32 v41, v41
 v_exp_f32 v42, v42
 v_smfmac_f32_32x32x32_bf16 v[80:95], v[172:175], v[24:31], v188
 s_add_u32 s86, s86, 31744
 v_exp_f32 v43, v43
 v_exp_f32 v44, v44
 v_exp_f32 v45, v45
 v_smfmac_f32_16x16x64_bf16 v[100:103], v[184:187], v[24:31], v188
 ds_read_b128 v[164:167], v189 offset:62464
 v_exp_f32 v46, v46
 v_exp_f32 v47, v47
 v_mfma_f32_32x32x16_bf16 v[0:15], v[152:155], v[136:139], v[104:119]
 s_waitcnt lgkmcnt(2)
 v_exp_f32 v48, v48
 v_exp_f32 v49, v49
 v_exp_f32 v50, v50
 v_mfma_f32_32x32x16_bf16 v[0:15], v[156:159], v[140:143], v[0:15]
 v_exp_f32 v51, v51
 v_exp_f32 v52, v52
 v_exp_f32 v53, v53
 v_smfmac_f32_32x32x32_bf16 v[64:79], v[176:179], v[32:39], v188
 buffer_load_dwordx4 v232, s[44:47], s86 offen offset:3072 sc1 lds
 v_exp_f32 v54, v54
 v_exp_f32 v55, v55
 v_exp_f32 v56, v56
 v_smfmac_f32_16x16x64_bf16 v[96:99], v[184:187], v[32:39], v188
 ds_read_b128 v[168:171], v189 offset:59392
 v_exp_f32 v57, v57
 v_exp_f32 v58, v58
 v_smfmac_f32_32x32x32_bf16 v[64:79], v[180:183], v[40:47], v188
 v_exp_f32 v59, v59
 v_exp_f32 v60, v60
 v_exp_f32 v61, v61
 v_smfmac_f32_16x16x64_bf16 v[96:99], v[184:187], v[40:47], v188
 ds_read_b128 v[172:175], v189 offset:60416
 v_exp_f32 v62, v62
 v_exp_f32 v63, v63
 v_mfma_f32_32x32x16_bf16 v[16:31], v[152:155], v[144:147], v[120:135]
 s_waitcnt lgkmcnt(2)
 v_exp_f32 v0, v0
 v_exp_f32 v1, v1
 v_exp_f32 v2, v2
 v_mfma_f32_32x32x16_bf16 v[16:31], v[156:159], v[148:151], v[16:31]
 v_exp_f32 v3, v3
 v_exp_f32 v4, v4
 v_exp_f32 v5, v5
 v_smfmac_f32_32x32x32_bf16 v[80:95], v[176:179], v[48:55], v188
 global_load_dwordx4 a[80:83], v230, s[38:39] offset:-4096
 v_exp_f32 v6, v6
 v_exp_f32 v7, v7
 v_exp_f32 v8, v8
 v_smfmac_f32_16x16x64_bf16 v[100:103], v[184:187], v[48:55], v188
 ds_read_b128 v[152:155], v189 offset:0
 v_exp_f32 v9, v9
 v_exp_f32 v10, v10
 v_smfmac_f32_32x32x32_bf16 v[80:95], v[180:183], v[56:63], v188
 v_exp_f32 v11, v11
 v_exp_f32 v12, v12
 v_exp_f32 v13, v13
 v_smfmac_f32_16x16x64_bf16 v[100:103], v[184:187], v[56:63], v188
 ds_read_b128 v[156:159], v189 offset:1024
 v_exp_f32 v14, v14
 v_exp_f32 v15, v15
 v_mfma_f32_32x32x16_bf16 v[32:47], v[160:163], v[136:139], v[104:119]
 s_waitcnt lgkmcnt(2)
 v_exp_f32 v16, v16
 v_exp_f32 v17, v17
 v_exp_f32 v18, v18
 v_mfma_f32_32x32x16_bf16 v[32:47], v[164:167], v[140:143], v[32:47]
 v_exp_f32 v19, v19
 v_exp_f32 v20, v20
 v_exp_f32 v21, v21
 v_smfmac_f32_32x32x32_bf16 v[64:79], v[168:171], v[0:7], v188
 global_load_dwordx4 a[84:87], v230, s[38:39] offset:-3072
 v_exp_f32 v22, v22
 v_exp_f32 v23, v23
 v_exp_f32 v24, v24
 v_smfmac_f32_16x16x64_bf16 v[96:99], v[184:187], v[0:7], v188
 ds_read_b128 v[176:179], v189 offset:63488
 v_exp_f32 v25, v25
 v_exp_f32 v26, v26
 v_smfmac_f32_32x32x32_bf16 v[64:79], v[172:175], v[8:15], v188
 v_exp_f32 v27, v27
 v_exp_f32 v28, v28
 v_exp_f32 v29, v29
 v_smfmac_f32_16x16x64_bf16 v[96:99], v[184:187], v[8:15], v188
 ds_read_b128 v[180:183], v189 offset:64512
 v_exp_f32 v30, v30
 v_exp_f32 v31, v31
 v_mfma_f32_32x32x16_bf16 v[48:63], v[160:163], v[144:147], v[120:135]
 s_waitcnt lgkmcnt(2)
 v_exp_f32 v32, v32
 v_exp_f32 v33, v33
 v_exp_f32 v34, v34
 v_mfma_f32_32x32x16_bf16 v[48:63], v[164:167], v[148:151], v[48:63]
 v_exp_f32 v35, v35
 v_exp_f32 v36, v36
 v_exp_f32 v37, v37
 v_smfmac_f32_32x32x32_bf16 v[80:95], v[168:171], v[16:23], v188
 global_load_dwordx4 a[88:91], v230, s[38:39] offset:-2048
 v_exp_f32 v38, v38
 v_exp_f32 v39, v39
 v_exp_f32 v40, v40
 v_smfmac_f32_16x16x64_bf16 v[100:103], v[184:187], v[16:23], v188
 ds_read_b128 v[160:163], v189 offset:4096
 v_exp_f32 v41, v41
 v_exp_f32 v42, v42
 v_smfmac_f32_32x32x32_bf16 v[80:95], v[172:175], v[24:31], v188
 v_exp_f32 v43, v43
 v_exp_f32 v44, v44
 v_exp_f32 v45, v45
 v_smfmac_f32_16x16x64_bf16 v[100:103], v[184:187], v[24:31], v188
 ds_read_b128 v[164:167], v189 offset:5120
 v_exp_f32 v46, v46
 v_exp_f32 v47, v47
 v_mfma_f32_32x32x16_bf16 v[0:15], v[152:155], v[136:139], v[104:119]
 s_waitcnt lgkmcnt(2)
 v_exp_f32 v48, v48
 v_exp_f32 v49, v49
 v_exp_f32 v50, v50
 v_mfma_f32_32x32x16_bf16 v[0:15], v[156:159], v[140:143], v[0:15]
 v_exp_f32 v51, v51
 v_exp_f32 v52, v52
 v_exp_f32 v53, v53
 v_smfmac_f32_32x32x32_bf16 v[64:79], v[176:179], v[32:39], v188
 global_load_dwordx4 a[92:95], v230, s[38:39] offset:-1024
 v_exp_f32 v54, v54
 v_exp_f32 v55, v55
 v_exp_f32 v56, v56
 v_smfmac_f32_16x16x64_bf16 v[96:99], v[184:187], v[32:39], v188
 ds_read_b128 v[168:171], v189 offset:2048
 v_exp_f32 v57, v57
 v_exp_f32 v58, v58
 v_smfmac_f32_32x32x32_bf16 v[64:79], v[180:183], v[40:47], v188
 v_exp_f32 v59, v59
 v_exp_f32 v60, v60
 v_exp_f32 v61, v61
 v_smfmac_f32_16x16x64_bf16 v[96:99], v[184:187], v[40:47], v188
 ds_read_b128 v[172:175], v189 offset:3072
 v_exp_f32 v62, v62
 v_exp_f32 v63, v63
 s_barrier
 v_mfma_f32_32x32x16_bf16 v[16:31], v[152:155], v[144:147], v[120:135]
 s_waitcnt lgkmcnt(2)
 v_exp_f32 v0, v0
 v_exp_f32 v1, v1
 v_exp_f32 v2, v2
 v_mfma_f32_32x32x16_bf16 v[16:31], v[156:159], v[148:151], v[16:31]
 s_add_u32 m0, s67, 98304
 v_exp_f32 v3, v3
 v_exp_f32 v4, v4
 v_exp_f32 v5, v5
 v_smfmac_f32_32x32x32_bf16 v[80:95], v[176:179], v[48:55], v188
 global_load_lds_dwordx4 v230, s[60:61] offset:0 sc1
 v_exp_f32 v6, v6
 v_exp_f32 v7, v7
 v_exp_f32 v8, v8
 v_smfmac_f32_16x16x64_bf16 v[100:103], v[184:187], v[48:55], v188
 ds_read_b128 v[152:155], v189 offset:8192
 v_exp_f32 v9, v9
 v_exp_f32 v10, v10
 v_smfmac_f32_32x32x32_bf16 v[80:95], v[180:183], v[56:63], v188
 v_exp_f32 v11, v11
 v_exp_f32 v12, v12
 v_exp_f32 v13, v13
 v_smfmac_f32_16x16x64_bf16 v[100:103], v[184:187], v[56:63], v188
 ds_read_b128 v[156:159], v189 offset:9216
 v_exp_f32 v14, v14
 v_exp_f32 v15, v15
 v_mfma_f32_32x32x16_bf16 v[32:47], v[160:163], v[136:139], v[104:119]
 s_waitcnt lgkmcnt(2)
 v_exp_f32 v16, v16
 v_exp_f32 v17, v17
 v_exp_f32 v18, v18
 v_mfma_f32_32x32x16_bf16 v[32:47], v[164:167], v[140:143], v[32:47]
 v_exp_f32 v19, v19
 v_exp_f32 v20, v20
 v_exp_f32 v21, v21
 v_smfmac_f32_32x32x32_bf16 v[64:79], v[168:171], v[0:7], v188
 global_load_lds_dwordx4 v230, s[60:61] offset:1024 sc1
 v_exp_f32 v22, v22
 v_exp_f32 v23, v23
 v_exp_f32 v24, v24
 v_smfmac_f32_16x16x64_bf16 v[96:99], v[184:187], v[0:7], v188
 ds_read_b128 v[176:179], v189 offset:6144
 v_exp_f32 v25, v25
 v_exp_f32 v26, v26
 v_smfmac_f32_32x32x32_bf16 v[64:79], v[172:175], v[8:15], v188
 v_exp_f32 v27, v27
 v_exp_f32 v28, v28
 v_exp_f32 v29, v29
 v_smfmac_f32_16x16x64_bf16 v[96:99], v[184:187], v[8:15], v188
 ds_read_b128 v[180:183], v189 offset:7168
 v_exp_f32 v30, v30
 v_exp_f32 v31, v31
 v_mfma_f32_32x32x16_bf16 v[48:63], v[160:163], v[144:147], v[120:135]
 s_waitcnt lgkmcnt(2)
 v_exp_f32 v32, v32
 v_exp_f32 v33, v33
 v_exp_f32 v34, v34
 v_mfma_f32_32x32x16_bf16 v[48:63], v[164:167], v[148:151], v[48:63]
 s_waitcnt vmcnt(6)
 v_exp_f32 v35, v35
 v_exp_f32 v36, v36
 v_exp_f32 v37, v37
 v_smfmac_f32_32x32x32_bf16 v[80:95], v[168:171], v[16:23], v188
 global_load_lds_dwordx4 v230, s[60:61] offset:2048 sc1
 v_exp_f32 v38, v38
 v_exp_f32 v39, v39
 v_exp_f32 v40, v40
 v_smfmac_f32_16x16x64_bf16 v[100:103], v[184:187], v[16:23], v188
 ds_read_b128 v[160:163], v189 offset:12288
 v_exp_f32 v41, v41
 v_exp_f32 v42, v42
 v_smfmac_f32_32x32x32_bf16 v[80:95], v[172:175], v[24:31], v188
 ds_read_b64_tr_b16 a[0:1], v228 offset:0
 ds_read_b64_tr_b16 a[2:3], v228 offset:512
 v_exp_f32 v43, v43
 v_exp_f32 v44, v44
 v_exp_f32 v45, v45
 v_smfmac_f32_16x16x64_bf16 v[100:103], v[184:187], v[24:31], v188
 ds_read_b128 v[164:167], v189 offset:13312
 v_exp_f32 v46, v46
 v_exp_f32 v47, v47
 v_mfma_f32_32x32x16_bf16 v[0:15], v[152:155], v[136:139], v[104:119]
 s_waitcnt lgkmcnt(4)
 v_exp_f32 v48, v48
 v_exp_f32 v49, v49
 v_exp_f32 v50, v50
 v_mfma_f32_32x32x16_bf16 v[0:15], v[156:159], v[140:143], v[0:15]
 v_exp_f32 v51, v51
 v_exp_f32 v52, v52
 v_exp_f32 v53, v53
 v_smfmac_f32_32x32x32_bf16 v[64:79], v[176:179], v[32:39], v188
 global_load_lds_dwordx4 v230, s[60:61] offset:3072 sc1
 v_exp_f32 v54, v54
 v_exp_f32 v55, v55
 v_exp_f32 v56, v56
 v_smfmac_f32_16x16x64_bf16 v[96:99], v[184:187], v[32:39], v188
 ds_read_b128 v[168:171], v189 offset:10240
 v_exp_f32 v57, v57
 v_exp_f32 v58, v58
 v_smfmac_f32_32x32x32_bf16 v[64:79], v[180:183], v[40:47], v188
 s_add_u32 s72, s72, 32768
 s_and_b32 s72, s72, 0x3ffff
 ds_read_b64_tr_b16 a[4:5], v228 offset:2048
 ds_read_b64_tr_b16 a[6:7], v228 offset:2560
 v_exp_f32 v59, v59
 v_exp_f32 v60, v60
 v_exp_f32 v61, v61
 v_smfmac_f32_16x16x64_bf16 v[96:99], v[184:187], v[40:47], v188
 ds_read_b128 v[172:175], v189 offset:11264
 v_exp_f32 v62, v62
 v_exp_f32 v63, v63
 v_mfma_f32_32x32x16_bf16 v[16:31], v[152:155], v[144:147], v[120:135]
 s_waitcnt lgkmcnt(4)
 v_exp_f32 v0, v0
 v_exp_f32 v1, v1
 v_exp_f32 v2, v2
 v_mfma_f32_32x32x16_bf16 v[16:31], v[156:159], v[148:151], v[16:31]
 s_add_u32 m0, s67, 114688
 v_exp_f32 v3, v3
 v_exp_f32 v4, v4
 v_exp_f32 v5, v5
 v_smfmac_f32_32x32x32_bf16 v[80:95], v[176:179], v[48:55], v188
 global_load_lds_dwordx4 v230, s[62:63] offset:0 sc1
 v_exp_f32 v6, v6
 v_exp_f32 v7, v7
 v_exp_f32 v8, v8
 v_smfmac_f32_16x16x64_bf16 v[100:103], v[184:187], v[48:55], v188
 ds_read_b128 v[152:155], v189 offset:16384
 v_exp_f32 v9, v9
 v_exp_f32 v10, v10
 v_smfmac_f32_32x32x32_bf16 v[80:95], v[180:183], v[56:63], v188
 ds_read_b64_tr_b16 a[8:9], v229 offset:0
 ds_read_b64_tr_b16 a[10:11], v229 offset:512
 v_exp_f32 v11, v11
 v_exp_f32 v12, v12
 v_exp_f32 v13, v13
 v_smfmac_f32_16x16x64_bf16 v[100:103], v[184:187], v[56:63], v188
 ds_read_b128 v[156:159], v189 offset:17408
 v_exp_f32 v14, v14
 v_exp_f32 v15, v15
 v_mfma_f32_32x32x16_bf16 v[32:47], v[160:163], v[136:139], v[104:119]
 s_waitcnt lgkmcnt(4)
 v_exp_f32 v16, v16
 v_exp_f32 v17, v17
 v_exp_f32 v18, v18
 v_mfma_f32_32x32x16_bf16 v[32:47], v[164:167], v[140:143], v[32:47]
 s_add_u32 s60, s44, s72
 s_addc_u32 s61, s45, 0
 v_exp_f32 v19, v19
 v_exp_f32 v20, v20
 v_exp_f32 v21, v21
 v_smfmac_f32_32x32x32_bf16 v[64:79], v[168:171], v[0:7], v188
 global_load_lds_dwordx4 v230, s[62:63] offset:1024 sc1
 v_exp_f32 v22, v22
 v_exp_f32 v23, v23
 v_exp_f32 v24, v24
 v_smfmac_f32_16x16x64_bf16 v[96:99], v[184:187], v[0:7], v188
 ds_read_b128 v[176:179], v189 offset:14336
 v_exp_f32 v25, v25
 v_exp_f32 v26, v26
 v_smfmac_f32_32x32x32_bf16 v[64:79], v[172:175], v[8:15], v188
 ds_read_b64_tr_b16 a[12:13], v229 offset:2048
 ds_read_b64_tr_b16 a[14:15], v229 offset:2560
 v_exp_f32 v27, v27
 v_exp_f32 v28, v28
 v_exp_f32 v29, v29
 v_smfmac_f32_16x16x64_bf16 v[96:99], v[184:187], v[8:15], v188
 ds_read_b128 v[180:183], v189 offset:15360
 v_exp_f32 v30, v30
 v_exp_f32 v31, v31
 v_mfma_f32_32x32x16_bf16 v[48:63], v[160:163], v[144:147], v[120:135]
 s_waitcnt lgkmcnt(4)
 s_mov_b32 s40, s22
 v_exp_f32 v32, v32
 v_exp_f32 v33, v33
 v_exp_f32 v34, v34
 v_mfma_f32_32x32x16_bf16 v[48:63], v[164:167], v[148:151], v[48:63]
 v_exp_f32 v35, v35
 v_exp_f32 v36, v36
 v_exp_f32 v37, v37
 v_smfmac_f32_32x32x32_bf16 v[80:95], v[168:171], v[16:23], v188
 global_load_lds_dwordx4 v230, s[62:63] offset:2048 sc1
 v_exp_f32 v38, v38
 v_exp_f32 v39, v39
 v_smfmac_f32_16x16x64_bf16 v[100:103], v[184:187], v[16:23], v188
 ds_read_b128 v[160:163], v189 offset:20480
 v_exp_f32 v40, v40
 v_smfmac_f32_32x32x32_bf16 v[80:95], v[172:175], v[24:31], v188
 s_and_b32 s41, s23, 0xffff
 v_exp_f32 v41, v41
 v_exp_f32 v42, v42
 v_exp_f32 v43, v43
 v_smfmac_f32_16x16x64_bf16 v[100:103], v[184:187], v[24:31], v188
 ds_read_b128 v[164:167], v189 offset:21504
 v_exp_f32 v44, v44
 v_mfma_f32_32x32x16_bf16 v[196:211], a[0:3], a[48:51], 0
 v_exp_f32 v45, v45
 v_exp_f32 v46, v46
 v_exp_f32 v47, v47
 v_mfma_f32_32x32x16_bf16 v[0:15], v[152:155], v[136:139], v[104:119]
 s_waitcnt lgkmcnt(2)
 v_exp_f32 v48, v48
 v_exp_f32 v49, v49
 v_exp_f32 v50, v50
 v_mfma_f32_32x32x16_bf16 v[0:15], v[156:159], v[140:143], v[0:15]
 v_exp_f32 v51, v51
 v_exp_f32 v52, v52
 v_exp_f32 v53, v53
 v_smfmac_f32_32x32x32_bf16 v[64:79], v[176:179], v[32:39], v188
 global_load_lds_dwordx4 v230, s[62:63] offset:3072 sc1
 v_exp_f32 v54, v54
 v_exp_f32 v55, v55
 v_smfmac_f32_16x16x64_bf16 v[96:99], v[184:187], v[32:39], v188
 ds_read_b128 v[168:171], v189 offset:18432
 v_exp_f32 v56, v56
 v_smfmac_f32_32x32x32_bf16 v[64:79], v[180:183], v[40:47], v188
 s_add_u32 s73, s73, 32768
 s_and_b32 s73, s73, 0x3ffff
 v_exp_f32 v57, v57
 v_exp_f32 v58, v58
 v_exp_f32 v59, v59
 v_smfmac_f32_16x16x64_bf16 v[96:99], v[184:187], v[40:47], v188
 ds_read_b128 v[172:175], v189 offset:19456
 v_exp_f32 v60, v60
 v_mfma_f32_32x32x16_bf16 v[212:227], a[0:3], a[64:67], 0
 v_exp_f32 v61, v61
 v_exp_f32 v62, v62
 v_exp_f32 v63, v63
 v_mfma_f32_32x32x16_bf16 v[16:31], v[152:155], v[144:147], v[120:135]
 s_waitcnt lgkmcnt(2)
 v_exp_f32 v0, v0
 v_exp_f32 v1, v1
 v_exp_f32 v2, v2
 v_mfma_f32_32x32x16_bf16 v[16:31], v[156:159], v[148:151], v[16:31]
 v_exp_f32 v3, v3
 v_exp_f32 v4, v4
 v_exp_f32 v5, v5
 v_smfmac_f32_32x32x32_bf16 v[80:95], v[176:179], v[48:55], v188
 global_load_dwordx4 a[96:99], v230, s[38:39] offset:0
 v_exp_f32 v6, v6
 v_exp_f32 v7, v7
 v_smfmac_f32_16x16x64_bf16 v[100:103], v[184:187], v[48:55], v188
 ds_read_b128 v[152:155], v189 offset:24576
 v_exp_f32 v8, v8
 v_smfmac_f32_32x32x32_bf16 v[80:95], v[180:183], v[56:63], v188
 s_add_u32 s62, s44, s73
 s_addc_u32 s63, s45, 0
 v_exp_f32 v9, v9
 v_exp_f32 v10, v10
 v_exp_f32 v11, v11
 v_smfmac_f32_16x16x64_bf16 v[100:103], v[184:187], v[56:63], v188
 ds_read_b128 v[156:159], v189 offset:25600
 v_exp_f32 v12, v12
 v_mfma_f32_32x32x16_bf16 v[196:211], a[4:7], a[52:55], v[196:211]
 v_exp_f32 v13, v13
 v_exp_f32 v14, v14
 v_exp_f32 v15, v15
 v_mfma_f32_32x32x16_bf16 v[32:47], v[160:163], v[136:139], v[104:119]
 s_waitcnt lgkmcnt(2)
 v_exp_f32 v16, v16
 v_exp_f32 v17, v17
 v_exp_f32 v18, v18
 v_mfma_f32_32x32x16_bf16 v[32:47], v[164:167], v[140:143], v[32:47]
 v_exp_f32 v19, v19
 v_exp_f32 v20, v20
 v_exp_f32 v21, v21
 v_smfmac_f32_32x32x32_bf16 v[64:79], v[168:171], v[0:7], v188
 global_load_dwordx4 a[100:103], v230, s[38:39] offset:1024
 v_exp_f32 v22, v22
 v_exp_f32 v23, v23
 v_smfmac_f32_16x16x64_bf16 v[96:99], v[184:187], v[0:7], v188
 ds_read_b128 v[176:179], v189 offset:22528
 v_exp_f32 v24, v24
 v_smfmac_f32_32x32x32_bf16 v[64:79], v[172:175], v[8:15], v188
 s_add_u32 s38, s56, 20480
 s_addc_u32 s39, s57, 0
 v_exp_f32 v25, v25
 v_exp_f32 v26, v26
 v_exp_f32 v27, v27
 v_smfmac_f32_16x16x64_bf16 v[96:99], v[184:187], v[8:15], v188
 ds_read_b128 v[180:183], v189 offset:23552
 v_exp_f32 v28, v28
 v_mfma_f32_32x32x16_bf16 v[212:227], a[4:7], a[68:71], v[212:227]
 v_exp_f32 v29, v29
 v_exp_f32 v30, v30
 v_exp_f32 v31, v31
 v_mfma_f32_32x32x16_bf16 v[48:63], v[160:163], v[144:147], v[120:135]
 s_waitcnt lgkmcnt(2)
 v_exp_f32 v32, v32
 v_exp_f32 v33, v33
 v_exp_f32 v34, v34
 v_mfma_f32_32x32x16_bf16 v[48:63], v[164:167], v[148:151], v[48:63]
 v_exp_f32 v35, v35
 v_exp_f32 v36, v36
 v_exp_f32 v37, v37
 v_smfmac_f32_32x32x32_bf16 v[80:95], v[168:171], v[16:23], v188
 global_load_dwordx4 a[116:119], v230, s[38:39] offset:-4096
 v_exp_f32 v38, v38
 v_exp_f32 v39, v39
 v_smfmac_f32_16x16x64_bf16 v[100:103], v[184:187], v[16:23], v188
 ds_read_b128 v[160:163], v189 offset:28672
 v_exp_f32 v40, v40
 v_smfmac_f32_32x32x32_bf16 v[80:95], v[172:175], v[24:31], v188
 v_exp_f32 v41, v41
 v_exp_f32 v42, v42
 v_exp_f32 v43, v43
 v_smfmac_f32_16x16x64_bf16 v[100:103], v[184:187], v[24:31], v188
 ds_read_b128 v[164:167], v189 offset:29696
 v_exp_f32 v44, v44
 v_mfma_f32_32x32x16_bf16 v[196:211], a[8:11], a[56:59], v[196:211]
 v_exp_f32 v45, v45
 v_exp_f32 v46, v46
 v_exp_f32 v47, v47
 v_mfma_f32_32x32x16_bf16 v[0:15], v[152:155], v[136:139], v[104:119]
 s_waitcnt lgkmcnt(2)
 v_exp_f32 v48, v48
 v_exp_f32 v49, v49
 v_exp_f32 v50, v50
 v_mfma_f32_32x32x16_bf16 v[0:15], v[156:159], v[140:143], v[0:15]
 v_exp_f32 v51, v51
 v_exp_f32 v52, v52
 v_exp_f32 v53, v53
 v_smfmac_f32_32x32x32_bf16 v[64:79], v[176:179], v[32:39], v188
 global_load_dwordx4 a[120:123], v230, s[38:39] offset:-3072
 v_exp_f32 v54, v54
 v_exp_f32 v55, v55
 v_smfmac_f32_16x16x64_bf16 v[96:99], v[184:187], v[32:39], v188
 ds_read_b128 v[168:171], v189 offset:26624
 v_exp_f32 v56, v56
 v_smfmac_f32_32x32x32_bf16 v[64:79], v[180:183], v[40:47], v188
 v_exp_f32 v57, v57
 v_exp_f32 v58, v58
 v_exp_f32 v59, v59
 v_smfmac_f32_16x16x64_bf16 v[96:99], v[184:187], v[40:47], v188
 ds_read_b128 v[172:175], v189 offset:27648
 v_exp_f32 v60, v60
 v_mfma_f32_32x32x16_bf16 v[212:227], a[8:11], a[72:75], v[212:227]
 v_exp_f32 v61, v61
 v_exp_f32 v62, v62
 v_exp_f32 v63, v63
 v_mfma_f32_32x32x16_bf16 v[16:31], v[152:155], v[144:147], v[120:135]
 s_waitcnt lgkmcnt(2)
 v_exp_f32 v0, v0
 v_exp_f32 v1, v1
 v_exp_f32 v2, v2
 v_mfma_f32_32x32x16_bf16 v[16:31], v[156:159], v[148:151], v[16:31]
 v_exp_f32 v3, v3
 v_exp_f32 v4, v4
 v_exp_f32 v5, v5
 v_smfmac_f32_32x32x32_bf16 v[80:95], v[176:179], v[48:55], v188
 global_load_dwordx4 a[124:127], v230, s[38:39] offset:-2048
 v_exp_f32 v6, v6
 v_exp_f32 v7, v7
 v_smfmac_f32_16x16x64_bf16 v[100:103], v[184:187], v[48:55], v188
 ds_read_b128 v[152:155], v230 offset:0
 v_exp_f32 v8, v8
 v_smfmac_f32_32x32x32_bf16 v[80:95], v[180:183], v[56:63], v188
 v_exp_f32 v9, v9
 v_exp_f32 v10, v10
 v_exp_f32 v11, v11
 v_smfmac_f32_16x16x64_bf16 v[100:103], v[184:187], v[56:63], v188
 ds_read_b128 v[156:159], v230 offset:1024
 v_exp_f32 v12, v12
 v_mfma_f32_32x32x16_bf16 v[196:211], a[12:15], a[60:63], v[196:211]
 v_exp_f32 v13, v13
 v_exp_f32 v14, v14
 v_exp_f32 v15, v15
 v_mfma_f32_32x32x16_bf16 v[32:47], v[160:163], v[136:139], v[104:119]
 s_waitcnt lgkmcnt(2)
 v_exp_f32 v16, v16
 v_exp_f32 v17, v17
 v_exp_f32 v18, v18
 v_mfma_f32_32x32x16_bf16 v[32:47], v[164:167], v[140:143], v[32:47]
 v_exp_f32 v19, v19
 v_exp_f32 v20, v20
 v_exp_f32 v21, v21
 v_smfmac_f32_32x32x32_bf16 v[64:79], v[168:171], v[0:7], v188
 global_load_dwordx4 a[128:131], v230, s[38:39] offset:-1024
 v_exp_f32 v22, v22
 v_exp_f32 v23, v23
 v_smfmac_f32_16x16x64_bf16 v[96:99], v[184:187], v[0:7], v188
 ds_read_b128 v[176:179], v189 offset:30720
 v_exp_f32 v24, v24
 v_smfmac_f32_32x32x32_bf16 v[64:79], v[172:175], v[8:15], v188
 v_exp_f32 v25, v25
 v_exp_f32 v26, v26
 v_exp_f32 v27, v27
 v_smfmac_f32_16x16x64_bf16 v[96:99], v[184:187], v[8:15], v188
 ds_read_b128 v[180:183], v189 offset:31744
 v_exp_f32 v28, v28
 v_mfma_f32_32x32x16_bf16 v[212:227], a[12:15], a[76:79], v[212:227]
 v_exp_f32 v29, v29
 v_exp_f32 v30, v30
 v_exp_f32 v31, v31
 v_mfma_f32_32x32x16_bf16 v[48:63], v[160:163], v[144:147], v[120:135]
 s_waitcnt lgkmcnt(2)
 v_exp_f32 v32, v32
 v_exp_f32 v33, v33
 v_exp_f32 v34, v34
 v_mfma_f32_32x32x16_bf16 v[48:63], v[164:167], v[148:151], v[48:63]
 v_exp_f32 v35, v35
 v_exp_f32 v36, v36
 v_exp_f32 v37, v37
 v_smfmac_f32_32x32x32_bf16 v[80:95], v[168:171], v[16:23], v188
 global_load_dwordx4 a[132:135], v230, s[38:39] offset:0
 v_exp_f32 v38, v38
 v_exp_f32 v39, v39
 v_exp_f32 v40, v40
 v_smfmac_f32_16x16x64_bf16 v[100:103], v[184:187], v[16:23], v188
 ds_read_b128 v[160:163], v230 offset:4096
 v_exp_f32 v41, v41
 v_exp_f32 v42, v42
 v_smfmac_f32_32x32x32_bf16 v[80:95], v[172:175], v[24:31], v188
 v_exp_f32 v43, v43
 v_exp_f32 v44, v44
 v_exp_f32 v45, v45
 v_smfmac_f32_16x16x64_bf16 v[100:103], v[184:187], v[24:31], v188
 ds_read_b128 v[164:167], v230 offset:5120
 v_exp_f32 v46, v46
 v_exp_f32 v47, v47
 v_mfma_f32_32x32x16_bf16 v[0:15], v[152:155], v[136:139], v[104:119]
 s_waitcnt lgkmcnt(2)
 v_exp_f32 v48, v48
 v_exp_f32 v49, v49
 v_exp_f32 v50, v50
 v_mfma_f32_32x32x16_bf16 v[0:15], v[156:159], v[140:143], v[0:15]
 v_exp_f32 v51, v51
 v_exp_f32 v52, v52
 v_exp_f32 v53, v53
 v_smfmac_f32_32x32x32_bf16 v[64:79], v[176:179], v[32:39], v188
 global_load_dwordx4 a[136:139], v230, s[38:39] offset:1024
 v_exp_f32 v54, v54
 v_exp_f32 v55, v55
 v_exp_f32 v56, v56
 v_smfmac_f32_16x16x64_bf16 v[96:99], v[184:187], v[32:39], v188
 ds_read_b128 v[168:171], v230 offset:2048
 v_exp_f32 v57, v57
 v_exp_f32 v58, v58
 v_cvt_pk_bf16_f32 v196, v196, v197
 v_cvt_pk_bf16_f32 v197, v198, v199
 v_cvt_pk_bf16_f32 v198, v200, v201
 v_cvt_pk_bf16_f32 v199, v202, v203
 v_smfmac_f32_32x32x32_bf16 v[64:79], v[180:183], v[40:47], v188
 v_exp_f32 v59, v59
 v_exp_f32 v60, v60
 v_exp_f32 v61, v61
 v_smfmac_f32_16x16x64_bf16 v[96:99], v[184:187], v[40:47], v188
 ds_read_b128 v[172:175], v230 offset:3072
 v_exp_f32 v62, v62
 v_exp_f32 v63, v63
 s_barrier
 v_mfma_f32_32x32x16_bf16 v[16:31], v[152:155], v[144:147], v[120:135]
 s_waitcnt lgkmcnt(2)
 v_exp_f32 v0, v0
 v_exp_f32 v1, v1
 v_exp_f32 v2, v2
 v_mfma_f32_32x32x16_bf16 v[16:31], v[156:159], v[148:151], v[16:31]
 v_exp_f32 v3, v3
 v_exp_f32 v4, v4
 v_exp_f32 v5, v5
 v_smfmac_f32_32x32x32_bf16 v[80:95], v[176:179], v[48:55], v188
 buffer_store_dwordx4 v[196:199], v230, s[44:47], s87 offen offset:0 sc1
 v_exp_f32 v6, v6
 v_exp_f32 v7, v7
 v_exp_f32 v8, v8
 v_smfmac_f32_16x16x64_bf16 v[100:103], v[184:187], v[48:55], v188
 ds_read_b128 v[152:155], v230 offset:8192
 v_exp_f32 v9, v9
 v_exp_f32 v10, v10
 v_cvt_pk_bf16_f32 v200, v204, v205
 v_cvt_pk_bf16_f32 v201, v206, v207
 v_cvt_pk_bf16_f32 v202, v208, v209
 v_cvt_pk_bf16_f32 v203, v210, v211
 v_smfmac_f32_32x32x32_bf16 v[80:95], v[180:183], v[56:63], v188
 v_exp_f32 v11, v11
 v_exp_f32 v12, v12
 v_exp_f32 v13, v13
 v_smfmac_f32_16x16x64_bf16 v[100:103], v[184:187], v[56:63], v188
 ds_read_b128 v[156:159], v230 offset:9216
 v_exp_f32 v14, v14
 v_exp_f32 v15, v15
 v_mfma_f32_32x32x16_bf16 v[32:47], v[160:163], v[136:139], v[104:119]
 s_waitcnt lgkmcnt(2)
 v_exp_f32 v16, v16
 v_exp_f32 v17, v17
 v_exp_f32 v18, v18
 v_mfma_f32_32x32x16_bf16 v[32:47], v[164:167], v[140:143], v[32:47]
 v_exp_f32 v19, v19
 v_exp_f32 v20, v20
 v_exp_f32 v21, v21
 v_smfmac_f32_32x32x32_bf16 v[64:79], v[168:171], v[0:7], v188
 buffer_store_dwordx4 v[200:203], v230, s[44:47], s87 offen offset:1024 sc1
 v_exp_f32 v22, v22
 v_exp_f32 v23, v23
 v_exp_f32 v24, v24
 v_smfmac_f32_16x16x64_bf16 v[96:99], v[184:187], v[0:7], v188
 ds_read_b128 v[176:179], v230 offset:6144
 v_exp_f32 v25, v25
 v_exp_f32 v26, v26
 v_cvt_pk_bf16_f32 v212, v212, v213
 v_cvt_pk_bf16_f32 v213, v214, v215
 v_cvt_pk_bf16_f32 v214, v216, v217
 v_cvt_pk_bf16_f32 v215, v218, v219
 v_smfmac_f32_32x32x32_bf16 v[64:79], v[172:175], v[8:15], v188
 v_exp_f32 v27, v27
 v_exp_f32 v28, v28
 v_exp_f32 v29, v29
 v_smfmac_f32_16x16x64_bf16 v[96:99], v[184:187], v[8:15], v188
 ds_read_b128 v[180:183], v230 offset:7168
 v_exp_f32 v30, v30
 v_exp_f32 v31, v31
 v_mfma_f32_32x32x16_bf16 v[48:63], v[160:163], v[144:147], v[120:135]
 s_waitcnt lgkmcnt(2)
 v_exp_f32 v32, v32
 v_exp_f32 v33, v33
 v_exp_f32 v34, v34
 v_mfma_f32_32x32x16_bf16 v[48:63], v[164:167], v[148:151], v[48:63]
 v_exp_f32 v35, v35
 v_exp_f32 v36, v36
 v_exp_f32 v37, v37
 v_smfmac_f32_32x32x32_bf16 v[80:95], v[168:171], v[16:23], v188
 buffer_store_dwordx4 v[212:215], v230, s[44:47], s87 offen offset:2048 sc1
 v_exp_f32 v38, v38
 v_exp_f32 v39, v39
 v_exp_f32 v40, v40
 v_smfmac_f32_16x16x64_bf16 v[100:103], v[184:187], v[16:23], v188
 ds_read_b128 v[160:163], v230 offset:12288
 v_exp_f32 v41, v41
 v_exp_f32 v42, v42
 v_cvt_pk_bf16_f32 v216, v220, v221
 v_cvt_pk_bf16_f32 v217, v222, v223
 v_cvt_pk_bf16_f32 v218, v224, v225
 v_cvt_pk_bf16_f32 v219, v226, v227
 v_smfmac_f32_32x32x32_bf16 v[80:95], v[172:175], v[24:31], v188
 v_exp_f32 v43, v43
 v_exp_f32 v44, v44
 v_exp_f32 v45, v45
 v_smfmac_f32_16x16x64_bf16 v[100:103], v[184:187], v[24:31], v188
 ds_read_b128 v[164:167], v230 offset:13312
 v_exp_f32 v46, v46
 v_exp_f32 v47, v47
 v_mfma_f32_32x32x16_bf16 v[0:15], v[152:155], v[136:139], v[104:119]
 s_waitcnt lgkmcnt(2)
 v_exp_f32 v48, v48
 v_exp_f32 v49, v49
 v_exp_f32 v50, v50
 v_mfma_f32_32x32x16_bf16 v[0:15], v[156:159], v[140:143], v[0:15]
 s_lshl4_add_u32 s65, s4, s69
 v_exp_f32 v51, v51
 v_exp_f32 v52, v52
 v_exp_f32 v53, v53
 v_smfmac_f32_32x32x32_bf16 v[64:79], v[176:179], v[32:39], v188
 buffer_store_dwordx4 v[216:219], v230, s[44:47], s87 offen offset:3072 sc1
 v_exp_f32 v54, v54
 v_exp_f32 v55, v55
 v_exp_f32 v56, v56
 v_smfmac_f32_16x16x64_bf16 v[96:99], v[184:187], v[32:39], v188
 ds_read_b128 v[168:171], v230 offset:10240
 v_exp_f32 v57, v57
 v_exp_f32 v58, v58
 v_smfmac_f32_32x32x32_bf16 v[64:79], v[180:183], v[40:47], v188
 s_add_u32 s36, s40, s65
 s_addc_u32 s37, s41, 0
 v_exp_f32 v59, v59
 v_exp_f32 v60, v60
 v_exp_f32 v61, v61
 v_smfmac_f32_16x16x64_bf16 v[96:99], v[184:187], v[40:47], v188
 ds_read_b128 v[172:175], v230 offset:11264
 v_exp_f32 v62, v62
 v_exp_f32 v63, v63
 v_mfma_f32_32x32x16_bf16 v[16:31], v[152:155], v[144:147], v[120:135]
 s_waitcnt lgkmcnt(2)
 v_exp_f32 v0, v0
 v_exp_f32 v1, v1
 v_exp_f32 v2, v2
 v_mfma_f32_32x32x16_bf16 v[16:31], v[156:159], v[148:151], v[16:31]
 s_add_u32 m0, s67, 65536
 v_exp_f32 v3, v3
 v_exp_f32 v4, v4
 v_exp_f32 v5, v5
 v_smfmac_f32_32x32x32_bf16 v[80:95], v[176:179], v[48:55], v188
 global_load_lds_dwordx4 v238, s[36:37] offset:0
 v_exp_f32 v6, v6
 v_exp_f32 v7, v7
 v_exp_f32 v8, v8
 v_smfmac_f32_16x16x64_bf16 v[100:103], v[184:187], v[48:55], v188
 ds_read_b128 v[152:155], v230 offset:16384
 v_exp_f32 v9, v9
 v_exp_f32 v10, v10
 v_smfmac_f32_32x32x32_bf16 v[80:95], v[180:183], v[56:63], v188
 v_exp_f32 v11, v11
 v_exp_f32 v12, v12
 v_exp_f32 v13, v13
 v_smfmac_f32_16x16x64_bf16 v[100:103], v[184:187], v[56:63], v188
 ds_read_b128 v[156:159], v230 offset:17408
 v_exp_f32 v14, v14
 v_exp_f32 v15, v15
 v_mfma_f32_32x32x16_bf16 v[32:47], v[160:163], v[136:139], v[104:119]
 s_waitcnt lgkmcnt(2)
 v_exp_f32 v16, v16
 v_exp_f32 v17, v17
 v_exp_f32 v18, v18
 v_mfma_f32_32x32x16_bf16 v[32:47], v[164:167], v[140:143], v[32:47]
 v_exp_f32 v19, v19
 v_exp_f32 v20, v20
 v_exp_f32 v21, v21
 v_smfmac_f32_32x32x32_bf16 v[64:79], v[168:171], v[0:7], v188
 global_load_lds_dwordx4 v239, s[36:37] offset:1024
 v_exp_f32 v22, v22
 v_exp_f32 v23, v23
 v_exp_f32 v24, v24
 v_smfmac_f32_16x16x64_bf16 v[96:99], v[184:187], v[0:7], v188
 ds_read_b128 v[176:179], v230 offset:14336
 v_exp_f32 v25, v25
 v_exp_f32 v26, v26
 v_smfmac_f32_32x32x32_bf16 v[64:79], v[172:175], v[8:15], v188
 v_exp_f32 v27, v27
 v_exp_f32 v28, v28
 v_exp_f32 v29, v29
 v_smfmac_f32_16x16x64_bf16 v[96:99], v[184:187], v[8:15], v188
 ds_read_b128 v[180:183], v230 offset:15360
 v_exp_f32 v30, v30
 v_exp_f32 v31, v31
 v_mfma_f32_32x32x16_bf16 v[48:63], v[160:163], v[144:147], v[120:135]
 s_waitcnt lgkmcnt(2)
 v_exp_f32 v32, v32
 v_exp_f32 v33, v33
 v_exp_f32 v34, v34
 v_mfma_f32_32x32x16_bf16 v[48:63], v[164:167], v[148:151], v[48:63]
 v_exp_f32 v35, v35
 v_exp_f32 v36, v36
 v_exp_f32 v37, v37
 v_smfmac_f32_32x32x32_bf16 v[80:95], v[168:171], v[16:23], v188
 global_load_lds_dwordx4 v240, s[36:37] offset:2048
 v_exp_f32 v38, v38
 v_exp_f32 v39, v39
 v_exp_f32 v40, v40
 v_smfmac_f32_16x16x64_bf16 v[100:103], v[184:187], v[16:23], v188
 ds_read_b128 v[160:163], v230 offset:20480
 v_exp_f32 v41, v41
 v_exp_f32 v42, v42
 v_smfmac_f32_32x32x32_bf16 v[80:95], v[172:175], v[24:31], v188
 v_exp_f32 v43, v43
 v_exp_f32 v44, v44
 v_exp_f32 v45, v45
 v_smfmac_f32_16x16x64_bf16 v[100:103], v[184:187], v[24:31], v188
 ds_read_b128 v[164:167], v230 offset:21504
 v_exp_f32 v46, v46
 v_exp_f32 v47, v47
 v_mfma_f32_32x32x16_bf16 v[0:15], v[152:155], v[136:139], v[104:119]
 s_waitcnt lgkmcnt(2)
 v_exp_f32 v48, v48
 v_exp_f32 v49, v49
 v_exp_f32 v50, v50
 v_mfma_f32_32x32x16_bf16 v[0:15], v[156:159], v[140:143], v[0:15]
 s_lshl4_add_u32 s65, s5, s69
 v_exp_f32 v51, v51
 v_exp_f32 v52, v52
 v_exp_f32 v53, v53
 v_smfmac_f32_32x32x32_bf16 v[64:79], v[176:179], v[32:39], v188
 global_load_lds_dwordx4 v241, s[36:37] offset:3072
 v_exp_f32 v54, v54
 v_exp_f32 v55, v55
 v_exp_f32 v56, v56
 v_smfmac_f32_16x16x64_bf16 v[96:99], v[184:187], v[32:39], v188
 ds_read_b128 v[168:171], v230 offset:18432
 v_exp_f32 v57, v57
 v_exp_f32 v58, v58
 v_smfmac_f32_32x32x32_bf16 v[64:79], v[180:183], v[40:47], v188
 s_add_u32 s36, s40, s65
 s_addc_u32 s37, s41, 0
 v_exp_f32 v59, v59
 v_exp_f32 v60, v60
 v_exp_f32 v61, v61
 v_smfmac_f32_16x16x64_bf16 v[96:99], v[184:187], v[40:47], v188
 ds_read_b128 v[172:175], v230 offset:19456
 v_exp_f32 v62, v62
 v_exp_f32 v63, v63
 v_mfma_f32_32x32x16_bf16 v[16:31], v[152:155], v[144:147], v[120:135]
 s_waitcnt lgkmcnt(2)
 v_exp_f32 v0, v0
 v_exp_f32 v1, v1
 v_exp_f32 v2, v2
 v_mfma_f32_32x32x16_bf16 v[16:31], v[156:159], v[148:151], v[16:31]
 s_add_u32 m0, s67, 81920
 v_exp_f32 v3, v3
 v_exp_f32 v4, v4
 v_exp_f32 v5, v5
 v_smfmac_f32_32x32x32_bf16 v[80:95], v[176:179], v[48:55], v188
 global_load_lds_dwordx4 v238, s[36:37] offset:0
 v_exp_f32 v6, v6
 v_exp_f32 v7, v7
 v_exp_f32 v8, v8
 v_smfmac_f32_16x16x64_bf16 v[100:103], v[184:187], v[48:55], v188
 ds_read_b128 v[152:155], v230 offset:24576
 v_exp_f32 v9, v9
 v_exp_f32 v10, v10
 v_smfmac_f32_32x32x32_bf16 v[80:95], v[180:183], v[56:63], v188
 v_exp_f32 v11, v11
 v_exp_f32 v12, v12
 v_exp_f32 v13, v13
 v_smfmac_f32_16x16x64_bf16 v[100:103], v[184:187], v[56:63], v188
 ds_read_b128 v[156:159], v230 offset:25600
 v_exp_f32 v14, v14
 v_exp_f32 v15, v15
 v_mfma_f32_32x32x16_bf16 v[32:47], v[160:163], v[136:139], v[104:119]
 s_waitcnt lgkmcnt(2)
 v_exp_f32 v16, v16
 v_exp_f32 v17, v17
 v_exp_f32 v18, v18
 v_mfma_f32_32x32x16_bf16 v[32:47], v[164:167], v[140:143], v[32:47]
 v_exp_f32 v19, v19
 v_exp_f32 v20, v20
 v_exp_f32 v21, v21
 v_smfmac_f32_32x32x32_bf16 v[64:79], v[168:171], v[0:7], v188
 global_load_lds_dwordx4 v239, s[36:37] offset:1024
 v_exp_f32 v22, v22
 v_exp_f32 v23, v23
 v_exp_f32 v24, v24
 v_smfmac_f32_16x16x64_bf16 v[96:99], v[184:187], v[0:7], v188
 ds_read_b128 v[176:179], v230 offset:22528
 v_exp_f32 v25, v25
 v_exp_f32 v26, v26
 v_smfmac_f32_32x32x32_bf16 v[64:79], v[172:175], v[8:15], v188
 v_exp_f32 v27, v27
 v_exp_f32 v28, v28
 v_exp_f32 v29, v29
 v_smfmac_f32_16x16x64_bf16 v[96:99], v[184:187], v[8:15], v188
 ds_read_b128 v[180:183], v230 offset:23552
 v_exp_f32 v30, v30
 v_exp_f32 v31, v31
 v_mfma_f32_32x32x16_bf16 v[48:63], v[160:163], v[144:147], v[120:135]
 s_waitcnt lgkmcnt(2)
 v_exp_f32 v32, v32
 v_exp_f32 v33, v33
 v_exp_f32 v34, v34
 v_mfma_f32_32x32x16_bf16 v[48:63], v[164:167], v[148:151], v[48:63]
 v_exp_f32 v35, v35
 v_exp_f32 v36, v36
 v_exp_f32 v37, v37
 v_smfmac_f32_32x32x32_bf16 v[80:95], v[168:171], v[16:23], v188
 global_load_lds_dwordx4 v240, s[36:37] offset:2048
 v_exp_f32 v38, v38
 v_exp_f32 v39, v39
 v_exp_f32 v40, v40
 v_smfmac_f32_16x16x64_bf16 v[100:103], v[184:187], v[16:23], v188
 ds_read_b128 v[160:163], v230 offset:28672
 v_exp_f32 v41, v41
 v_exp_f32 v42, v42
 v_smfmac_f32_32x32x32_bf16 v[80:95], v[172:175], v[24:31], v188
 v_exp_f32 v43, v43
 v_exp_f32 v44, v44
 v_exp_f32 v45, v45
 v_smfmac_f32_16x16x64_bf16 v[100:103], v[184:187], v[24:31], v188
 ds_read_b128 v[164:167], v230 offset:29696
 v_exp_f32 v46, v46
 v_exp_f32 v47, v47
 v_mfma_f32_32x32x16_bf16 v[0:15], v[152:155], v[136:139], v[104:119]
 s_waitcnt lgkmcnt(2)
 v_exp_f32 v48, v48
 v_exp_f32 v49, v49
 v_exp_f32 v50, v50
 v_mfma_f32_32x32x16_bf16 v[0:15], v[156:159], v[140:143], v[0:15]
 s_lshl4_add_u32 s65, s70, s69
 s_waitcnt vmcnt(7)
 v_exp_f32 v51, v51
 v_exp_f32 v52, v52
 v_exp_f32 v53, v53
 v_smfmac_f32_32x32x32_bf16 v[64:79], v[176:179], v[32:39], v188
 global_load_lds_dwordx4 v241, s[36:37] offset:3072
 v_exp_f32 v54, v54
 v_exp_f32 v55, v55
 v_exp_f32 v56, v56
 v_smfmac_f32_16x16x64_bf16 v[96:99], v[184:187], v[32:39], v188
 ds_read_b128 v[168:171], v230 offset:26624
 v_exp_f32 v57, v57
 v_exp_f32 v58, v58
 v_mov_b32 v251, s64
 v_smfmac_f32_32x32x32_bf16 v[64:79], v[180:183], v[40:47], v188
 s_add_u32 s36, s40, s65
 s_addc_u32 s37, s41, 0
 buffer_store_dword v251, v237, s[44:47], s88 offen sc1
 v_exp_f32 v59, v59
 v_exp_f32 v60, v60
 v_exp_f32 v61, v61
 v_smfmac_f32_16x16x64_bf16 v[96:99], v[184:187], v[40:47], v188
 ds_read_b128 v[172:175], v230 offset:27648
 v_exp_f32 v62, v62
 v_exp_f32 v63, v63
 v_mfma_f32_32x32x16_bf16 v[16:31], v[152:155], v[144:147], v[120:135]
 s_waitcnt lgkmcnt(2)
 v_exp_f32 v0, v0
 v_exp_f32 v1, v1
 v_exp_f32 v2, v2
 v_mfma_f32_32x32x16_bf16 v[16:31], v[156:159], v[148:151], v[16:31]
 s_add_u32 m0, s67, 131072
 v_exp_f32 v3, v3
 v_exp_f32 v4, v4
 v_exp_f32 v5, v5
 v_smfmac_f32_32x32x32_bf16 v[80:95], v[176:179], v[48:55], v188
 global_load_lds_dwordx4 v238, s[36:37] offset:0
 v_exp_f32 v6, v6
 v_exp_f32 v7, v7
 v_exp_f32 v8, v8
 v_smfmac_f32_16x16x64_bf16 v[100:103], v[184:187], v[48:55], v188
 ds_read_b128 v[152:155], v230 offset:32768
 v_exp_f32 v9, v9
 v_exp_f32 v10, v10
 v_smfmac_f32_32x32x32_bf16 v[80:95], v[180:183], v[56:63], v188
 v_exp_f32 v11, v11
 v_exp_f32 v12, v12
 v_exp_f32 v13, v13
 v_smfmac_f32_16x16x64_bf16 v[100:103], v[184:187], v[56:63], v188
 ds_read_b128 v[156:159], v230 offset:33792
 v_exp_f32 v14, v14
 v_exp_f32 v15, v15
 v_mfma_f32_32x32x16_bf16 v[32:47], v[160:163], v[136:139], v[104:119]
 s_waitcnt lgkmcnt(2)
 v_exp_f32 v16, v16
 v_exp_f32 v17, v17
 v_exp_f32 v18, v18
 v_mfma_f32_32x32x16_bf16 v[32:47], v[164:167], v[140:143], v[32:47]
 v_exp_f32 v19, v19
 v_exp_f32 v20, v20
 v_exp_f32 v21, v21
 v_smfmac_f32_32x32x32_bf16 v[64:79], v[168:171], v[0:7], v188
 global_load_lds_dwordx4 v239, s[36:37] offset:1024
 v_exp_f32 v22, v22
 v_exp_f32 v23, v23
 v_exp_f32 v24, v24
 v_smfmac_f32_16x16x64_bf16 v[96:99], v[184:187], v[0:7], v188
 ds_read_b128 v[176:179], v230 offset:30720
 v_exp_f32 v25, v25
 v_exp_f32 v26, v26
 v_smfmac_f32_32x32x32_bf16 v[64:79], v[172:175], v[8:15], v188
 v_exp_f32 v27, v27
 v_exp_f32 v28, v28
 v_exp_f32 v29, v29
 v_smfmac_f32_16x16x64_bf16 v[96:99], v[184:187], v[8:15], v188
 ds_read_b128 v[180:183], v230 offset:31744
 v_exp_f32 v30, v30
 v_exp_f32 v31, v31
 v_mfma_f32_32x32x16_bf16 v[48:63], v[160:163], v[144:147], v[120:135]
 s_waitcnt lgkmcnt(2)
 v_exp_f32 v32, v32
 v_exp_f32 v33, v33
 v_exp_f32 v34, v34
 v_mfma_f32_32x32x16_bf16 v[48:63], v[164:167], v[148:151], v[48:63]
 v_exp_f32 v35, v35
 v_exp_f32 v36, v36
 v_exp_f32 v37, v37
 v_smfmac_f32_32x32x32_bf16 v[80:95], v[168:171], v[16:23], v188
 global_load_lds_dwordx4 v240, s[36:37] offset:2048
 v_exp_f32 v38, v38
 v_exp_f32 v39, v39
 v_exp_f32 v40, v40
 v_smfmac_f32_16x16x64_bf16 v[100:103], v[184:187], v[16:23], v188
 ds_read_b128 v[160:163], v230 offset:36864
 v_exp_f32 v41, v41
 v_exp_f32 v42, v42
 v_smfmac_f32_32x32x32_bf16 v[80:95], v[172:175], v[24:31], v188
 v_exp_f32 v43, v43
 v_exp_f32 v44, v44
 v_exp_f32 v45, v45
 v_smfmac_f32_16x16x64_bf16 v[100:103], v[184:187], v[24:31], v188
 ds_read_b128 v[164:167], v230 offset:37888
 v_exp_f32 v46, v46
 v_exp_f32 v47, v47
 v_mfma_f32_32x32x16_bf16 v[0:15], v[152:155], v[136:139], v[104:119]
 s_waitcnt lgkmcnt(2)
 v_exp_f32 v48, v48
 v_exp_f32 v49, v49
 v_exp_f32 v50, v50
 v_mfma_f32_32x32x16_bf16 v[0:15], v[156:159], v[140:143], v[0:15]
 s_lshl4_add_u32 s65, s71, s69
 v_exp_f32 v51, v51
 v_exp_f32 v52, v52
 v_exp_f32 v53, v53
 v_smfmac_f32_32x32x32_bf16 v[64:79], v[176:179], v[32:39], v188
 global_load_lds_dwordx4 v241, s[36:37] offset:3072
 v_exp_f32 v54, v54
 v_exp_f32 v55, v55
 v_exp_f32 v56, v56
 v_smfmac_f32_16x16x64_bf16 v[96:99], v[184:187], v[32:39], v188
 ds_read_b128 v[168:171], v230 offset:34816
 v_exp_f32 v57, v57
 v_exp_f32 v58, v58
 v_smfmac_f32_32x32x32_bf16 v[64:79], v[180:183], v[40:47], v188
 s_add_u32 s36, s40, s65
 s_addc_u32 s37, s41, 0
 v_exp_f32 v59, v59
 v_exp_f32 v60, v60
 v_exp_f32 v61, v61
 v_smfmac_f32_16x16x64_bf16 v[96:99], v[184:187], v[40:47], v188
 ds_read_b128 v[172:175], v230 offset:35840
 v_exp_f32 v62, v62
 v_exp_f32 v63, v63
 s_barrier
 v_mfma_f32_32x32x16_bf16 v[16:31], v[152:155], v[144:147], v[120:135]
 s_waitcnt lgkmcnt(2)
 v_exp_f32 v0, v0
 v_exp_f32 v1, v1
 v_exp_f32 v2, v2
 v_mfma_f32_32x32x16_bf16 v[16:31], v[156:159], v[148:151], v[16:31]
 s_add_u32 m0, s67, 0
 v_exp_f32 v3, v3
 v_exp_f32 v4, v4
 v_exp_f32 v5, v5
 v_smfmac_f32_32x32x32_bf16 v[80:95], v[176:179], v[48:55], v188
 global_load_lds_dwordx4 v238, s[36:37] offset:0
 v_exp_f32 v6, v6
 v_exp_f32 v7, v7
 v_exp_f32 v8, v8
 v_smfmac_f32_16x16x64_bf16 v[100:103], v[184:187], v[48:55], v188
 ds_read_b128 v[152:155], v230 offset:40960
 v_exp_f32 v9, v9
 v_exp_f32 v10, v10
 v_smfmac_f32_32x32x32_bf16 v[80:95], v[180:183], v[56:63], v188
 v_exp_f32 v11, v11
 v_exp_f32 v12, v12
 v_exp_f32 v13, v13
 v_smfmac_f32_16x16x64_bf16 v[100:103], v[184:187], v[56:63], v188
 ds_read_b128 v[156:159], v230 offset:41984
 v_exp_f32 v14, v14
 v_exp_f32 v15, v15
 v_mfma_f32_32x32x16_bf16 v[32:47], v[160:163], v[136:139], v[104:119]
 s_waitcnt lgkmcnt(2)
 v_exp_f32 v16, v16
 v_exp_f32 v17, v17
 v_exp_f32 v18, v18
 v_mfma_f32_32x32x16_bf16 v[32:47], v[164:167], v[140:143], v[32:47]
 v_exp_f32 v19, v19
 v_exp_f32 v20, v20
 v_exp_f32 v21, v21
 v_smfmac_f32_32x32x32_bf16 v[64:79], v[168:171], v[0:7], v188
 global_load_lds_dwordx4 v239, s[36:37] offset:1024
 v_exp_f32 v22, v22
 v_exp_f32 v23, v23
 v_exp_f32 v24, v24
 v_smfmac_f32_16x16x64_bf16 v[96:99], v[184:187], v[0:7], v188
 ds_read_b128 v[176:179], v230 offset:38912
 v_exp_f32 v25, v25
 v_exp_f32 v26, v26
 v_smfmac_f32_32x32x32_bf16 v[64:79], v[172:175], v[8:15], v188
 v_exp_f32 v27, v27
 v_exp_f32 v28, v28
 v_exp_f32 v29, v29
 v_smfmac_f32_16x16x64_bf16 v[96:99], v[184:187], v[8:15], v188
 ds_read_b128 v[180:183], v230 offset:39936
 v_exp_f32 v30, v30
 v_exp_f32 v31, v31
 v_mfma_f32_32x32x16_bf16 v[48:63], v[160:163], v[144:147], v[120:135]
 s_waitcnt lgkmcnt(2)
 v_exp_f32 v32, v32
 v_exp_f32 v33, v33
 v_exp_f32 v34, v34
 v_mfma_f32_32x32x16_bf16 v[48:63], v[164:167], v[148:151], v[48:63]
 v_exp_f32 v35, v35
 v_exp_f32 v36, v36
 v_exp_f32 v37, v37
 v_smfmac_f32_32x32x32_bf16 v[80:95], v[168:171], v[16:23], v188
 global_load_lds_dwordx4 v240, s[36:37] offset:2048
 v_exp_f32 v38, v38
 v_exp_f32 v39, v39
 v_exp_f32 v40, v40
 v_smfmac_f32_16x16x64_bf16 v[100:103], v[184:187], v[16:23], v188
 ds_read_b128 v[160:163], v230 offset:45056
 v_exp_f32 v41, v41
 v_exp_f32 v42, v42
 v_smfmac_f32_32x32x32_bf16 v[80:95], v[172:175], v[24:31], v188
 v_exp_f32 v43, v43
 v_exp_f32 v44, v44
 v_exp_f32 v45, v45
 v_smfmac_f32_16x16x64_bf16 v[100:103], v[184:187], v[24:31], v188
 ds_read_b128 v[164:167], v230 offset:46080
 v_exp_f32 v46, v46
 v_exp_f32 v47, v47
 v_mfma_f32_32x32x16_bf16 v[0:15], v[152:155], v[136:139], v[104:119]
 s_waitcnt lgkmcnt(2)
 v_exp_f32 v48, v48
 v_exp_f32 v49, v49
 v_exp_f32 v50, v50
 v_mfma_f32_32x32x16_bf16 v[0:15], v[156:159], v[140:143], v[0:15]
 s_lshl4_add_u32 s65, s14, s69
 v_exp_f32 v51, v51
 v_exp_f32 v52, v52
 v_exp_f32 v53, v53
 v_smfmac_f32_32x32x32_bf16 v[64:79], v[176:179], v[32:39], v188
 global_load_lds_dwordx4 v241, s[36:37] offset:3072
 v_exp_f32 v54, v54
 v_exp_f32 v55, v55
 v_exp_f32 v56, v56
 v_smfmac_f32_16x16x64_bf16 v[96:99], v[184:187], v[32:39], v188
 ds_read_b128 v[168:171], v230 offset:43008
 v_exp_f32 v57, v57
 v_exp_f32 v58, v58
 v_smfmac_f32_32x32x32_bf16 v[64:79], v[180:183], v[40:47], v188
 s_add_u32 s36, s40, s65
 s_addc_u32 s37, s41, 0
 v_exp_f32 v59, v59
 v_exp_f32 v60, v60
 v_exp_f32 v61, v61
 v_smfmac_f32_16x16x64_bf16 v[96:99], v[184:187], v[40:47], v188
 ds_read_b128 v[172:175], v230 offset:44032
 v_exp_f32 v62, v62
 v_exp_f32 v63, v63
 v_mfma_f32_32x32x16_bf16 v[16:31], v[152:155], v[144:147], v[120:135]
 s_waitcnt lgkmcnt(2)
 v_exp_f32 v0, v0
 v_exp_f32 v1, v1
 v_exp_f32 v2, v2
 v_mfma_f32_32x32x16_bf16 v[16:31], v[156:159], v[148:151], v[16:31]
 s_add_u32 m0, s67, 16384
 v_exp_f32 v3, v3
 v_exp_f32 v4, v4
 v_exp_f32 v5, v5
 v_smfmac_f32_32x32x32_bf16 v[80:95], v[176:179], v[48:55], v188
 global_load_lds_dwordx4 v238, s[36:37] offset:0
 v_exp_f32 v6, v6
 v_exp_f32 v7, v7
 v_exp_f32 v8, v8
 v_smfmac_f32_16x16x64_bf16 v[100:103], v[184:187], v[48:55], v188
 ds_read_b128 v[152:155], v230 offset:49152
 v_exp_f32 v9, v9
 v_exp_f32 v10, v10
 v_smfmac_f32_32x32x32_bf16 v[80:95], v[180:183], v[56:63], v188
 v_exp_f32 v11, v11
 v_exp_f32 v12, v12
 v_exp_f32 v13, v13
 v_smfmac_f32_16x16x64_bf16 v[100:103], v[184:187], v[56:63], v188
 ds_read_b128 v[156:159], v230 offset:50176
 v_exp_f32 v14, v14
 v_exp_f32 v15, v15
 v_mfma_f32_32x32x16_bf16 v[32:47], v[160:163], v[136:139], v[104:119]
 s_waitcnt lgkmcnt(2)
 v_exp_f32 v16, v16
 v_exp_f32 v17, v17
 v_exp_f32 v18, v18
 v_mfma_f32_32x32x16_bf16 v[32:47], v[164:167], v[140:143], v[32:47]
 v_exp_f32 v19, v19
 v_exp_f32 v20, v20
 v_exp_f32 v21, v21
 v_smfmac_f32_32x32x32_bf16 v[64:79], v[168:171], v[0:7], v188
 global_load_lds_dwordx4 v239, s[36:37] offset:1024
 v_exp_f32 v22, v22
 v_exp_f32 v23, v23
 v_exp_f32 v24, v24
 v_smfmac_f32_16x16x64_bf16 v[96:99], v[184:187], v[0:7], v188
 ds_read_b128 v[176:179], v230 offset:47104
 v_exp_f32 v25, v25
 v_exp_f32 v26, v26
 v_smfmac_f32_32x32x32_bf16 v[64:79], v[172:175], v[8:15], v188
 v_exp_f32 v27, v27
 v_exp_f32 v28, v28
 v_exp_f32 v29, v29
 v_smfmac_f32_16x16x64_bf16 v[96:99], v[184:187], v[8:15], v188
 ds_read_b128 v[180:183], v230 offset:48128
 v_exp_f32 v30, v30
 v_exp_f32 v31, v31
 v_mfma_f32_32x32x16_bf16 v[48:63], v[160:163], v[144:147], v[120:135]
 s_waitcnt lgkmcnt(2)
 v_exp_f32 v32, v32
 v_exp_f32 v33, v33
 v_exp_f32 v34, v34
 v_mfma_f32_32x32x16_bf16 v[48:63], v[164:167], v[148:151], v[48:63]
 v_exp_f32 v35, v35
 v_exp_f32 v36, v36
 v_exp_f32 v37, v37
 v_smfmac_f32_32x32x32_bf16 v[80:95], v[168:171], v[16:23], v188
 global_load_lds_dwordx4 v240, s[36:37] offset:2048
 v_exp_f32 v38, v38
 v_exp_f32 v39, v39
 v_exp_f32 v40, v40
 v_smfmac_f32_16x16x64_bf16 v[100:103], v[184:187], v[16:23], v188
 ds_read_b128 v[160:163], v230 offset:53248
 v_exp_f32 v41, v41
 v_exp_f32 v42, v42
 v_smfmac_f32_32x32x32_bf16 v[80:95], v[172:175], v[24:31], v188
 v_exp_f32 v43, v43
 v_exp_f32 v44, v44
 v_exp_f32 v45, v45
 v_smfmac_f32_16x16x64_bf16 v[100:103], v[184:187], v[24:31], v188
 ds_read_b128 v[164:167], v230 offset:54272
 v_exp_f32 v46, v46
 v_exp_f32 v47, v47
 v_mfma_f32_32x32x16_bf16 v[0:15], v[152:155], v[136:139], v[104:119]
 s_waitcnt lgkmcnt(2)
 v_exp_f32 v48, v48
 v_exp_f32 v49, v49
 v_exp_f32 v50, v50
 v_mfma_f32_32x32x16_bf16 v[0:15], v[156:159], v[140:143], v[0:15]
 v_exp_f32 v51, v51
 v_exp_f32 v52, v52
 v_exp_f32 v53, v53
 v_smfmac_f32_32x32x32_bf16 v[64:79], v[176:179], v[32:39], v188
 global_load_lds_dwordx4 v241, s[36:37] offset:3072
 v_exp_f32 v54, v54
 v_exp_f32 v55, v55
 v_exp_f32 v56, v56
 v_smfmac_f32_16x16x64_bf16 v[96:99], v[184:187], v[32:39], v188
 ds_read_b128 v[168:171], v230 offset:51200
 v_exp_f32 v57, v57
 v_exp_f32 v58, v58
 v_smfmac_f32_32x32x32_bf16 v[64:79], v[180:183], v[40:47], v188
 v_exp_f32 v59, v59
 v_exp_f32 v60, v60
 v_exp_f32 v61, v61
 v_smfmac_f32_16x16x64_bf16 v[96:99], v[184:187], v[40:47], v188
 ds_read_b128 v[172:175], v230 offset:52224
 v_exp_f32 v62, v62
 v_exp_f32 v63, v63
 v_mfma_f32_32x32x16_bf16 v[16:31], v[152:155], v[144:147], v[120:135]
 s_waitcnt lgkmcnt(2)
 v_exp_f32 v0, v0
 v_exp_f32 v1, v1
 v_exp_f32 v2, v2
 v_mfma_f32_32x32x16_bf16 v[16:31], v[156:159], v[148:151], v[16:31]
 v_exp_f32 v3, v3
 v_exp_f32 v4, v4
 v_exp_f32 v5, v5
 v_smfmac_f32_32x32x32_bf16 v[80:95], v[176:179], v[48:55], v188
 v_exp_f32 v6, v6
 v_exp_f32 v7, v7
 v_exp_f32 v8, v8
 v_smfmac_f32_16x16x64_bf16 v[100:103], v[184:187], v[48:55], v188
 ds_read_b128 v[152:155], v230 offset:57344
 v_exp_f32 v9, v9
 v_exp_f32 v10, v10
 v_smfmac_f32_32x32x32_bf16 v[80:95], v[180:183], v[56:63], v188
 buffer_load_dword v244, v245, s[44:47], s89 offen sc1
 v_exp_f32 v11, v11
 v_exp_f32 v12, v12
 v_exp_f32 v13, v13
 v_smfmac_f32_16x16x64_bf16 v[100:103], v[184:187], v[56:63], v188
 ds_read_b128 v[156:159], v230 offset:58368
 v_exp_f32 v14, v14
 v_exp_f32 v15, v15
 v_mfma_f32_32x32x16_bf16 v[32:47], v[160:163], v[136:139], v[104:119]
 s_waitcnt lgkmcnt(2)
 v_exp_f32 v16, v16
 v_exp_f32 v17, v17
 v_exp_f32 v18, v18
 v_mfma_f32_32x32x16_bf16 v[32:47], v[164:167], v[140:143], v[32:47]
 v_exp_f32 v19, v19
 v_exp_f32 v20, v20
 v_exp_f32 v21, v21
 v_smfmac_f32_32x32x32_bf16 v[64:79], v[168:171], v[0:7], v188
 v_exp_f32 v22, v22
 v_exp_f32 v23, v23
 v_exp_f32 v24, v24
 v_smfmac_f32_16x16x64_bf16 v[96:99], v[184:187], v[0:7], v188
 ds_read_b128 v[176:179], v230 offset:55296
 v_exp_f32 v25, v25
 v_exp_f32 v26, v26
 v_smfmac_f32_32x32x32_bf16 v[64:79], v[172:175], v[8:15], v188
 v_exp_f32 v27, v27
 v_exp_f32 v28, v28
 v_exp_f32 v29, v29
 v_smfmac_f32_16x16x64_bf16 v[96:99], v[184:187], v[8:15], v188
 ds_read_b128 v[180:183], v230 offset:56320
 v_exp_f32 v30, v30
 v_exp_f32 v31, v31
 v_mfma_f32_32x32x16_bf16 v[48:63], v[160:163], v[144:147], v[120:135]
 s_waitcnt lgkmcnt(2)
 v_exp_f32 v32, v32
 v_exp_f32 v33, v33
 v_exp_f32 v34, v34
 v_mfma_f32_32x32x16_bf16 v[48:63], v[164:167], v[148:151], v[48:63]
 v_exp_f32 v35, v35
 v_exp_f32 v36, v36
 v_exp_f32 v37, v37
 v_smfmac_f32_32x32x32_bf16 v[80:95], v[168:171], v[16:23], v188
 v_exp_f32 v38, v38
 v_exp_f32 v39, v39
 v_exp_f32 v40, v40
 v_smfmac_f32_16x16x64_bf16 v[100:103], v[184:187], v[16:23], v188
 ds_read_b128 v[160:163], v230 offset:61440
 v_exp_f32 v41, v41
 v_exp_f32 v42, v42
 v_smfmac_f32_32x32x32_bf16 v[80:95], v[172:175], v[24:31], v188
 v_exp_f32 v43, v43
 v_exp_f32 v44, v44
 v_exp_f32 v45, v45
 v_smfmac_f32_16x16x64_bf16 v[100:103], v[184:187], v[24:31], v188
 ds_read_b128 v[164:167], v230 offset:62464
 v_exp_f32 v46, v46
 v_exp_f32 v47, v47
 v_mfma_f32_32x32x16_bf16 v[0:15], v[152:155], v[136:139], v[104:119]
 s_waitcnt lgkmcnt(2)
 v_exp_f32 v48, v48
 v_exp_f32 v49, v49
 v_exp_f32 v50, v50
 v_mfma_f32_32x32x16_bf16 v[0:15], v[156:159], v[140:143], v[0:15]
 v_exp_f32 v51, v51
 v_exp_f32 v52, v52
 v_exp_f32 v53, v53
 v_smfmac_f32_32x32x32_bf16 v[64:79], v[176:179], v[32:39], v188
 v_exp_f32 v54, v54
 v_exp_f32 v55, v55
 v_exp_f32 v56, v56
 v_smfmac_f32_16x16x64_bf16 v[96:99], v[184:187], v[32:39], v188
 ds_read_b128 v[168:171], v230 offset:59392
 v_exp_f32 v57, v57
 v_exp_f32 v58, v58
 v_smfmac_f32_32x32x32_bf16 v[64:79], v[180:183], v[40:47], v188
 v_exp_f32 v59, v59
 v_exp_f32 v60, v60
 v_exp_f32 v61, v61
 v_smfmac_f32_16x16x64_bf16 v[96:99], v[184:187], v[40:47], v188
 ds_read_b128 v[172:175], v230 offset:60416
 v_exp_f32 v62, v62
 v_exp_f32 v63, v63
 v_mfma_f32_32x32x16_bf16 v[16:31], v[152:155], v[144:147], v[120:135]
 s_waitcnt lgkmcnt(2)
 v_exp_f32 v0, v0
 v_exp_f32 v1, v1
 v_exp_f32 v2, v2
 v_mfma_f32_32x32x16_bf16 v[16:31], v[156:159], v[148:151], v[16:31]
 v_exp_f32 v3, v3
 v_exp_f32 v4, v4
 v_exp_f32 v5, v5
 v_smfmac_f32_32x32x32_bf16 v[80:95], v[176:179], v[48:55], v188
 v_exp_f32 v6, v6
 v_exp_f32 v7, v7
 v_exp_f32 v8, v8
 v_smfmac_f32_16x16x64_bf16 v[100:103], v[184:187], v[48:55], v188
 ds_read_b128 v[152:155], v189 offset:32768
 v_exp_f32 v9, v9
 v_exp_f32 v10, v10
 v_smfmac_f32_32x32x32_bf16 v[80:95], v[180:183], v[56:63], v188
 v_exp_f32 v11, v11
 v_exp_f32 v12, v12
 v_exp_f32 v13, v13
 v_smfmac_f32_16x16x64_bf16 v[100:103], v[184:187], v[56:63], v188
 ds_read_b128 v[156:159], v189 offset:33792
 v_exp_f32 v14, v14
 v_exp_f32 v15, v15
 v_mfma_f32_32x32x16_bf16 v[32:47], v[160:163], v[136:139], v[104:119]
 s_waitcnt lgkmcnt(2)
 v_exp_f32 v16, v16
 v_exp_f32 v17, v17
 v_exp_f32 v18, v18
 v_mfma_f32_32x32x16_bf16 v[32:47], v[164:167], v[140:143], v[32:47]
 v_exp_f32 v19, v19
 v_exp_f32 v20, v20
 v_exp_f32 v21, v21
 v_smfmac_f32_32x32x32_bf16 v[64:79], v[168:171], v[0:7], v188
 v_exp_f32 v22, v22
 v_exp_f32 v23, v23
 v_exp_f32 v24, v24
 v_smfmac_f32_16x16x64_bf16 v[96:99], v[184:187], v[0:7], v188
 ds_read_b128 v[176:179], v230 offset:63488
 v_exp_f32 v25, v25
 v_exp_f32 v26, v26
 v_smfmac_f32_32x32x32_bf16 v[64:79], v[172:175], v[8:15], v188
 v_exp_f32 v27, v27
 v_exp_f32 v28, v28
 v_exp_f32 v29, v29
 v_smfmac_f32_16x16x64_bf16 v[96:99], v[184:187], v[8:15], v188
 ds_read_b128 v[180:183], v230 offset:64512
 v_exp_f32 v30, v30
 v_exp_f32 v31, v31
 v_mfma_f32_32x32x16_bf16 v[48:63], v[160:163], v[144:147], v[120:135]
 s_waitcnt lgkmcnt(2)
 v_exp_f32 v32, v32
 v_exp_f32 v33, v33
 v_exp_f32 v34, v34
 v_mfma_f32_32x32x16_bf16 v[48:63], v[164:167], v[148:151], v[48:63]
 v_exp_f32 v35, v35
 v_exp_f32 v36, v36
 v_exp_f32 v37, v37
 v_smfmac_f32_32x32x32_bf16 v[80:95], v[168:171], v[16:23], v188
 global_load_dwordx4 a[140:143], v230, s[38:39] offset:2048
 v_exp_f32 v38, v38
 v_exp_f32 v39, v39
 v_exp_f32 v40, v40
 v_smfmac_f32_16x16x64_bf16 v[100:103], v[184:187], v[16:23], v188
 ds_read_b128 v[160:163], v189 offset:36864
 v_exp_f32 v41, v41
 v_exp_f32 v42, v42
 v_smfmac_f32_32x32x32_bf16 v[80:95], v[172:175], v[24:31], v188
 v_exp_f32 v43, v43
 v_exp_f32 v44, v44
 v_exp_f32 v45, v45
 v_smfmac_f32_16x16x64_bf16 v[100:103], v[184:187], v[24:31], v188
 ds_read_b128 v[164:167], v189 offset:37888
 v_exp_f32 v46, v46
 v_exp_f32 v47, v47
 v_mfma_f32_32x32x16_bf16 v[0:15], v[152:155], v[136:139], v[104:119]
 s_waitcnt lgkmcnt(2)
 v_exp_f32 v48, v48
 v_exp_f32 v49, v49
 v_exp_f32 v50, v50
 v_mfma_f32_32x32x16_bf16 v[0:15], v[156:159], v[140:143], v[0:15]
 v_exp_f32 v51, v51
 v_exp_f32 v52, v52
 v_exp_f32 v53, v53
 v_smfmac_f32_32x32x32_bf16 v[64:79], v[176:179], v[32:39], v188
 global_load_dwordx4 a[144:147], v230, s[38:39] offset:3072
 v_exp_f32 v54, v54
 v_exp_f32 v55, v55
 v_exp_f32 v56, v56
 v_smfmac_f32_16x16x64_bf16 v[96:99], v[184:187], v[32:39], v188
 ds_read_b128 v[168:171], v189 offset:34816
 v_exp_f32 v57, v57
 v_exp_f32 v58, v58
 v_smfmac_f32_32x32x32_bf16 v[64:79], v[180:183], v[40:47], v188
 s_add_u32 s38, s56, 24576
 s_addc_u32 s39, s57, 0
 v_exp_f32 v59, v59
 v_exp_f32 v60, v60
 v_exp_f32 v61, v61
 v_smfmac_f32_16x16x64_bf16 v[96:99], v[184:187], v[40:47], v188
 ds_read_b128 v[172:175], v189 offset:35840
 v_exp_f32 v62, v62
 v_exp_f32 v63, v63
 s_waitcnt vmcnt(3)
 s_barrier
 v_mfma_f32_32x32x16_bf16 v[16:31], v[152:155], v[144:147], v[120:135]
 s_waitcnt lgkmcnt(2)
 v_exp_f32 v0, v0
 v_exp_f32 v1, v1
 v_exp_f32 v2, v2
 v_mfma_f32_32x32x16_bf16 v[16:31], v[156:159], v[148:151], v[16:31]
 v_exp_f32 v3, v3
 v_exp_f32 v4, v4
 v_exp_f32 v5, v5
 v_smfmac_f32_32x32x32_bf16 v[80:95], v[176:179], v[48:55], v188
 global_load_dwordx4 a[112:115], v230, s[38:39] offset:0
 v_exp_f32 v6, v6
 v_exp_f32 v7, v7
 v_exp_f32 v8, v8
 v_smfmac_f32_16x16x64_bf16 v[100:103], v[184:187], v[48:55], v188
 ds_read_b128 v[152:155], v189 offset:40960
 v_exp_f32 v9, v9
 v_exp_f32 v10, v10
 v_smfmac_f32_32x32x32_bf16 v[80:95], v[180:183], v[56:63], v188
 v_exp_f32 v11, v11
 v_exp_f32 v12, v12
 v_exp_f32 v13, v13
 v_smfmac_f32_16x16x64_bf16 v[100:103], v[184:187], v[56:63], v188
 ds_read_b128 v[156:159], v189 offset:41984
 v_exp_f32 v14, v14
 v_exp_f32 v15, v15
 v_mfma_f32_32x32x16_bf16 v[32:47], v[160:163], v[136:139], v[104:119]
 s_waitcnt lgkmcnt(2)
 v_exp_f32 v16, v16
 v_exp_f32 v17, v17
 v_exp_f32 v18, v18
 v_mfma_f32_32x32x16_bf16 v[32:47], v[164:167], v[140:143], v[32:47]
 v_exp_f32 v19, v19
 v_exp_f32 v20, v20
 v_exp_f32 v21, v21
 v_smfmac_f32_32x32x32_bf16 v[64:79], v[168:171], v[0:7], v188
 v_exp_f32 v22, v22
 v_exp_f32 v23, v23
 v_exp_f32 v24, v24
 v_smfmac_f32_16x16x64_bf16 v[96:99], v[184:187], v[0:7], v188
 ds_read_b128 v[176:179], v189 offset:38912
 v_exp_f32 v25, v25
 v_exp_f32 v26, v26
 v_smfmac_f32_32x32x32_bf16 v[64:79], v[172:175], v[8:15], v188
 v_exp_f32 v27, v27
 v_exp_f32 v28, v28
 v_exp_f32 v29, v29
 v_smfmac_f32_16x16x64_bf16 v[96:99], v[184:187], v[8:15], v188
 ds_read_b128 v[180:183], v189 offset:39936
 v_exp_f32 v30, v30
 v_exp_f32 v31, v31
 v_mfma_f32_32x32x16_bf16 v[48:63], v[160:163], v[144:147], v[120:135]
 s_waitcnt lgkmcnt(2)
 v_exp_f32 v32, v32
 v_exp_f32 v33, v33
 v_exp_f32 v34, v34
 v_mfma_f32_32x32x16_bf16 v[48:63], v[164:167], v[148:151], v[48:63]
 v_exp_f32 v35, v35
 v_exp_f32 v36, v36
 v_exp_f32 v37, v37
 v_smfmac_f32_32x32x32_bf16 v[80:95], v[168:171], v[16:23], v188
 v_exp_f32 v38, v38
 v_exp_f32 v39, v39
 v_exp_f32 v40, v40
 v_smfmac_f32_16x16x64_bf16 v[100:103], v[184:187], v[16:23], v188
 ds_read_b128 v[160:163], v189 offset:45056
 v_exp_f32 v41, v41
 v_exp_f32 v42, v42
 v_smfmac_f32_32x32x32_bf16 v[80:95], v[172:175], v[24:31], v188
 v_exp_f32 v43, v43
 v_exp_f32 v44, v44
 v_exp_f32 v45, v45
 v_smfmac_f32_16x16x64_bf16 v[100:103], v[184:187], v[24:31], v188
 ds_read_b128 v[164:167], v189 offset:46080
 v_exp_f32 v46, v46
 v_exp_f32 v47, v47
 v_mfma_f32_32x32x16_bf16 v[0:15], v[152:155], v[136:139], v[104:119]
 s_waitcnt lgkmcnt(2)
 s_waitcnt vmcnt(3)
 v_exp_f32 v48, v48
 v_exp_f32 v49, v49
 v_exp_f32 v50, v50
 v_mfma_f32_32x32x16_bf16 v[0:15], v[156:159], v[140:143], v[0:15]
 v_cmp_ne_u32 vcc, s64, v244
 s_cmp_eq_u64 vcc, 0
 s_cbranch_scc0 Lretry_5
Lback_6:
 v_exp_f32 v51, v51
 v_exp_f32 v52, v52
 v_exp_f32 v53, v53
 v_smfmac_f32_32x32x32_bf16 v[64:79], v[176:179], v[32:39], v188
 v_exp_f32 v54, v54
 v_exp_f32 v55, v55
 v_exp_f32 v56, v56
 v_smfmac_f32_16x16x64_bf16 v[96:99], v[184:187], v[32:39], v188
 ds_read_b128 v[168:171], v189 offset:43008
 v_exp_f32 v57, v57
 v_exp_f32 v58, v58
 v_smfmac_f32_32x32x32_bf16 v[64:79], v[180:183], v[40:47], v188
 v_exp_f32 v59, v59
 v_exp_f32 v60, v60
 v_exp_f32 v61, v61
 v_smfmac_f32_16x16x64_bf16 v[96:99], v[184:187], v[40:47], v188
 ds_read_b128 v[172:175], v189 offset:44032
 v_exp_f32 v62, v62
 v_exp_f32 v63, v63
 v_mfma_f32_32x32x16_bf16 v[16:31], v[152:155], v[144:147], v[120:135]
 s_waitcnt lgkmcnt(2)
 v_exp_f32 v0, v0
 v_exp_f32 v1, v1
 v_exp_f32 v2, v2
 v_mfma_f32_32x32x16_bf16 v[16:31], v[156:159], v[148:151], v[16:31]
 s_mov_b32 m0, s74
 v_exp_f32 v3, v3
 v_exp_f32 v4, v4
 v_exp_f32 v5, v5
 v_smfmac_f32_32x32x32_bf16 v[80:95], v[176:179], v[48:55], v188
 buffer_load_dwordx4 v232, s[44:47], s90 offen offset:0 sc1 lds
 v_exp_f32 v6, v6
 v_exp_f32 v7, v7
 v_exp_f32 v8, v8
 v_smfmac_f32_16x16x64_bf16 v[100:103], v[184:187], v[48:55], v188
 ds_read_b128 v[152:155], v189 offset:49152
 v_exp_f32 v9, v9
 v_exp_f32 v10, v10
 v_smfmac_f32_32x32x32_bf16 v[80:95], v[180:183], v[56:63], v188
 s_add_u32 s90, s90, 31744
 v_exp_f32 v11, v11
 v_exp_f32 v12, v12
 v_exp_f32 v13, v13
 v_smfmac_f32_16x16x64_bf16 v[100:103], v[184:187], v[56:63], v188
 ds_read_b128 v[156:159], v189 offset:50176
 v_exp_f32 v14, v14
 v_exp_f32 v15, v15
 v_mfma_f32_32x32x16_bf16 v[32:47], v[160:163], v[136:139], v[104:119]
 s_waitcnt lgkmcnt(2)
 v_exp_f32 v16, v16
 v_exp_f32 v17, v17
 v_exp_f32 v18, v18
 v_mfma_f32_32x32x16_bf16 v[32:47], v[164:167], v[140:143], v[32:47]
 v_exp_f32 v19, v19
 v_exp_f32 v20, v20
 v_exp_f32 v21, v21
 v_smfmac_f32_32x32x32_bf16 v[64:79], v[168:171], v[0:7], v188
 buffer_load_dwordx4 v232, s[44:47], s90 offen offset:1024 sc1 lds
 v_exp_f32 v22, v22
 v_exp_f32 v23, v23
 v_exp_f32 v24, v24
 v_smfmac_f32_16x16x64_bf16 v[96:99], v[184:187], v[0:7], v188
 ds_read_b128 v[176:179], v189 offset:47104
 v_exp_f32 v25, v25
 v_exp_f32 v26, v26
 v_smfmac_f32_32x32x32_bf16 v[64:79], v[172:175], v[8:15], v188
 s_add_u32 s90, s90, 31744
 v_exp_f32 v27, v27
 v_exp_f32 v28, v28
 v_exp_f32 v29, v29
 v_smfmac_f32_16x16x64_bf16 v[96:99], v[184:187], v[8:15], v188
 ds_read_b128 v[180:183], v189 offset:48128
 v_exp_f32 v30, v30
 v_exp_f32 v31, v31
 v_mfma_f32_32x32x16_bf16 v[48:63], v[160:163], v[144:147], v[120:135]
 s_waitcnt lgkmcnt(2)
 v_exp_f32 v32, v32
 v_exp_f32 v33, v33
 v_exp_f32 v34, v34
 v_mfma_f32_32x32x16_bf16 v[48:63], v[164:167], v[148:151], v[48:63]
 v_exp_f32 v35, v35
 v_exp_f32 v36, v36
 v_exp_f32 v37, v37
 v_smfmac_f32_32x32x32_bf16 v[80:95], v[168:171], v[16:23], v188
 buffer_load_dwordx4 v232, s[44:47], s90 offen offset:2048 sc1 lds
 v_exp_f32 v38, v38
 v_exp_f32 v39, v39
 v_exp_f32 v40, v40
 v_smfmac_f32_16x16x64_bf16 v[100:103], v[184:187], v[16:23], v188
 ds_read_b128 v[160:163], v189 offset:53248
 v_exp_f32 v41, v41
 v_exp_f32 v42, v42
 v_smfmac_f32_32x32x32_bf16 v[80:95], v[172:175], v[24:31], v188
 s_add_u32 s90, s90, 31744
 v_exp_f32 v43, v43
 v_exp_f32 v44, v44
 v_exp_f32 v45, v45
 v_smfmac_f32_16x16x64_bf16 v[100:103], v[184:187], v[24:31], v188
 ds_read_b128 v[164:167], v189 offset:54272
 v_exp_f32 v46, v46
 v_exp_f32 v47, v47
 v_mfma_f32_32x32x16_bf16 v[0:15], v[152:155], v[136:139], v[104:119]
 s_waitcnt lgkmcnt(2)
 v_exp_f32 v48, v48
 v_exp_f32 v49, v49
 v_exp_f32 v50, v50
 v_mfma_f32_32x32x16_bf16 v[0:15], v[156:159], v[140:143], v[0:15]
 s_lshl4_add_u32 s65, s15, s69
 v_exp_f32 v51, v51
 v_exp_f32 v52, v52
 v_exp_f32 v53, v53
 v_smfmac_f32_32x32x32_bf16 v[64:79], v[176:179], v[32:39], v188
 buffer_load_dwordx4 v232, s[44:47], s90 offen offset:3072 sc1 lds
 v_exp_f32 v54, v54
 v_exp_f32 v55, v55
 v_exp_f32 v56, v56
 v_smfmac_f32_16x16x64_bf16 v[96:99], v[184:187], v[32:39], v188
 ds_read_b128 v[168:171], v189 offset:51200
 v_exp_f32 v57, v57
 v_exp_f32 v58, v58
 v_smfmac_f32_32x32x32_bf16 v[64:79], v[180:183], v[40:47], v188
 s_add_u32 s36, s40, s65
 s_addc_u32 s37, s41, 0
 v_exp_f32 v59, v59
 v_exp_f32 v60, v60
 v_exp_f32 v61, v61
 v_smfmac_f32_16x16x64_bf16 v[96:99], v[184:187], v[40:47], v188
 ds_read_b128 v[172:175], v189 offset:52224
 v_exp_f32 v62, v62
 v_exp_f32 v63, v63
 v_mfma_f32_32x32x16_bf16 v[16:31], v[152:155], v[144:147], v[120:135]
 s_waitcnt lgkmcnt(2)
 v_exp_f32 v0, v0
 v_exp_f32 v1, v1
 v_exp_f32 v2, v2
 v_mfma_f32_32x32x16_bf16 v[16:31], v[156:159], v[148:151], v[16:31]
 s_add_u32 m0, s67, 32768
 v_exp_f32 v3, v3
 v_exp_f32 v4, v4
 v_exp_f32 v5, v5
 v_smfmac_f32_32x32x32_bf16 v[80:95], v[176:179], v[48:55], v188
 global_load_lds_dwordx4 v238, s[36:37] offset:0
 v_exp_f32 v6, v6
 v_exp_f32 v7, v7
 v_exp_f32 v8, v8
 v_smfmac_f32_16x16x64_bf16 v[100:103], v[184:187], v[48:55], v188
 ds_read_b128 v[152:155], v189 offset:57344
 v_exp_f32 v9, v9
 v_exp_f32 v10, v10
 v_smfmac_f32_32x32x32_bf16 v[80:95], v[180:183], v[56:63], v188
 v_exp_f32 v11, v11
 v_exp_f32 v12, v12
 v_exp_f32 v13, v13
 v_smfmac_f32_16x16x64_bf16 v[100:103], v[184:187], v[56:63], v188
 ds_read_b128 v[156:159], v189 offset:58368
 v_exp_f32 v14, v14
 v_exp_f32 v15, v15
 v_mfma_f32_32x32x16_bf16 v[32:47], v[160:163], v[136:139], v[104:119]
 s_waitcnt lgkmcnt(2)
 v_exp_f32 v16, v16
 v_exp_f32 v17, v17
 v_exp_f32 v18, v18
 v_mfma_f32_32x32x16_bf16 v[32:47], v[164:167], v[140:143], v[32:47]
 v_exp_f32 v19, v19
 v_exp_f32 v20, v20
 v_exp_f32 v21, v21
 v_smfmac_f32_32x32x32_bf16 v[64:79], v[168:171], v[0:7], v188
 global_load_lds_dwordx4 v239, s[36:37] offset:1024
 v_exp_f32 v22, v22
 v_exp_f32 v23, v23
 v_exp_f32 v24, v24
 v_smfmac_f32_16x16x64_bf16 v[96:99], v[184:187], v[0:7], v188
 ds_read_b128 v[176:179], v189 offset:55296
 v_exp_f32 v25, v25
 v_exp_f32 v26, v26
 v_smfmac_f32_32x32x32_bf16 v[64:79], v[172:175], v[8:15], v188
 v_exp_f32 v27, v27
 v_exp_f32 v28, v28
 v_exp_f32 v29, v29
 v_smfmac_f32_16x16x64_bf16 v[96:99], v[184:187], v[8:15], v188
 ds_read_b128 v[180:183], v189 offset:56320
 v_exp_f32 v30, v30
 v_exp_f32 v31, v31
 v_mfma_f32_32x32x16_bf16 v[48:63], v[160:163], v[144:147], v[120:135]
 s_waitcnt lgkmcnt(2)
 v_exp_f32 v32, v32
 v_exp_f32 v33, v33
 v_exp_f32 v34, v34
 v_mfma_f32_32x32x16_bf16 v[48:63], v[164:167], v[148:151], v[48:63]
 v_exp_f32 v35, v35
 v_exp_f32 v36, v36
 v_exp_f32 v37, v37
 v_smfmac_f32_32x32x32_bf16 v[80:95], v[168:171], v[16:23], v188
 global_load_lds_dwordx4 v240, s[36:37] offset:2048
 v_exp_f32 v38, v38
 v_exp_f32 v39, v39
 v_exp_f32 v40, v40
 v_smfmac_f32_16x16x64_bf16 v[100:103], v[184:187], v[16:23], v188
 ds_read_b128 v[160:163], v189 offset:61440
 v_exp_f32 v41, v41
 v_exp_f32 v42, v42
 v_smfmac_f32_32x32x32_bf16 v[80:95], v[172:175], v[24:31], v188
 v_exp_f32 v43, v43
 v_exp_f32 v44, v44
 v_exp_f32 v45, v45
 v_smfmac_f32_16x16x64_bf16 v[100:103], v[184:187], v[24:31], v188
 ds_read_b128 v[164:167], v189 offset:62464
 v_exp_f32 v46, v46
 v_exp_f32 v47, v47
 v_mfma_f32_32x32x16_bf16 v[0:15], v[152:155], v[136:139], v[104:119]
 s_waitcnt lgkmcnt(2)
 v_exp_f32 v48, v48
 v_exp_f32 v49, v49
 v_exp_f32 v50, v50
 v_mfma_f32_32x32x16_bf16 v[0:15], v[156:159], v[140:143], v[0:15]
 s_lshl4_add_u32 s65, s18, s69
 v_exp_f32 v51, v51
 v_exp_f32 v52, v52
 v_exp_f32 v53, v53
 v_smfmac_f32_32x32x32_bf16 v[64:79], v[176:179], v[32:39], v188
 global_load_lds_dwordx4 v241, s[36:37] offset:3072
 v_exp_f32 v54, v54
 v_exp_f32 v55, v55
 v_exp_f32 v56, v56
 v_smfmac_f32_16x16x64_bf16 v[96:99], v[184:187], v[32:39], v188
 ds_read_b128 v[168:171], v189 offset:59392
 v_exp_f32 v57, v57
 v_exp_f32 v58, v58
 v_smfmac_f32_32x32x32_bf16 v[64:79], v[180:183], v[40:47], v188
 s_add_u32 s36, s40, s65
 s_addc_u32 s37, s41, 0
 v_exp_f32 v59, v59
 v_exp_f32 v60, v60
 v_exp_f32 v61, v61
 v_smfmac_f32_16x16x64_bf16 v[96:99], v[184:187], v[40:47], v188
 ds_read_b128 v[172:175], v189 offset:60416
 v_exp_f32 v62, v62
 v_exp_f32 v63, v63
 v_mfma_f32_32x32x16_bf16 v[16:31], v[152:155], v[144:147], v[120:135]
 s_waitcnt lgkmcnt(2)
 v_exp_f32 v0, v0
 v_exp_f32 v1, v1
 v_exp_f32 v2, v2
 v_mfma_f32_32x32x16_bf16 v[16:31], v[156:159], v[148:151], v[16:31]
 s_add_u32 m0, s67, 49152
 v_exp_f32 v3, v3
 v_exp_f32 v4, v4
 v_exp_f32 v5, v5
 v_smfmac_f32_32x32x32_bf16 v[80:95], v[176:179], v[48:55], v188
 global_load_lds_dwordx4 v238, s[36:37] offset:0
 v_exp_f32 v6, v6
 v_exp_f32 v7, v7
 v_exp_f32 v8, v8
 v_smfmac_f32_16x16x64_bf16 v[100:103], v[184:187], v[48:55], v188
 v_exp_f32 v9, v9
 v_exp_f32 v10, v10
 v_smfmac_f32_32x32x32_bf16 v[80:95], v[180:183], v[56:63], v188
 v_exp_f32 v11, v11
 v_exp_f32 v12, v12
 v_exp_f32 v13, v13
 v_smfmac_f32_16x16x64_bf16 v[100:103], v[184:187], v[56:63], v188
 v_exp_f32 v14, v14
 v_exp_f32 v15, v15
 v_mfma_f32_32x32x16_bf16 v[32:47], v[160:163], v[136:139], v[104:119]
 s_waitcnt lgkmcnt(0)
 v_exp_f32 v16, v16
 v_exp_f32 v17, v17
 v_exp_f32 v18, v18
 v_mfma_f32_32x32x16_bf16 v[32:47], v[164:167], v[140:143], v[32:47]
 v_exp_f32 v19, v19
 v_exp_f32 v20, v20
 v_exp_f32 v21, v21
 v_smfmac_f32_32x32x32_bf16 v[64:79], v[168:171], v[0:7], v188
 global_load_lds_dwordx4 v239, s[36:37] offset:1024
 v_exp_f32 v22, v22
 v_exp_f32 v23, v23
 v_exp_f32 v24, v24
 v_smfmac_f32_16x16x64_bf16 v[96:99], v[184:187], v[0:7], v188
 ds_read_b128 v[176:179], v189 offset:63488
 v_exp_f32 v25, v25
 v_exp_f32 v26, v26
 v_smfmac_f32_32x32x32_bf16 v[64:79], v[172:175], v[8:15], v188
 v_exp_f32 v27, v27
 v_exp_f32 v28, v28
 v_exp_f32 v29, v29
 v_smfmac_f32_16x16x64_bf16 v[96:99], v[184:187], v[8:15], v188
 ds_read_b128 v[180:183], v189 offset:64512
 v_exp_f32 v30, v30
 v_exp_f32 v31, v31
 v_mfma_f32_32x32x16_bf16 v[48:63], v[160:163], v[144:147], v[120:135]
 v_exp_f32 v32, v32
 v_exp_f32 v33, v33
 v_exp_f32 v34, v34
 v_mfma_f32_32x32x16_bf16 v[48:63], v[164:167], v[148:151], v[48:63]
 v_exp_f32 v35, v35
 v_exp_f32 v36, v36
 v_exp_f32 v37, v37
 v_smfmac_f32_32x32x32_bf16 v[80:95], v[168:171], v[16:23], v188
 global_load_lds_dwordx4 v240, s[36:37] offset:2048
 v_exp_f32 v38, v38
 v_exp_f32 v39, v39
 v_exp_f32 v40, v40
 v_smfmac_f32_16x16x64_bf16 v[100:103], v[184:187], v[16:23], v188
 v_exp_f32 v41, v41
 v_exp_f32 v42, v42
 v_smfmac_f32_32x32x32_bf16 v[80:95], v[172:175], v[24:31], v188
 v_exp_f32 v43, v43
 v_exp_f32 v44, v44
 v_exp_f32 v45, v45
 v_smfmac_f32_16x16x64_bf16 v[100:103], v[184:187], v[24:31], v188
 v_exp_f32 v46, v46
 v_exp_f32 v47, v47
 s_waitcnt lgkmcnt(0)
 v_exp_f32 v48, v48
 v_exp_f32 v49, v49
 v_exp_f32 v50, v50
 v_exp_f32 v51, v51
 v_exp_f32 v52, v52
 v_exp_f32 v53, v53
 v_smfmac_f32_32x32x32_bf16 v[64:79], v[176:179], v[32:39], v188
 global_load_lds_dwordx4 v241, s[36:37] offset:3072
 v_exp_f32 v54, v54
 v_exp_f32 v55, v55
 v_exp_f32 v56, v56
 v_smfmac_f32_16x16x64_bf16 v[96:99], v[184:187], v[32:39], v188
 v_exp_f32 v57, v57
 v_exp_f32 v58, v58
 v_smfmac_f32_32x32x32_bf16 v[64:79], v[180:183], v[40:47], v188
 v_exp_f32 v59, v59
 v_exp_f32 v60, v60
 v_exp_f32 v61, v61
 v_smfmac_f32_16x16x64_bf16 v[96:99], v[184:187], v[40:47], v188
 v_exp_f32 v62, v62
 v_exp_f32 v63, v63
 s_nop 0
 v_smfmac_f32_16x16x64_bf16 v[100:103], v[184:187], v[48:55], v188
 v_smfmac_f32_16x16x64_bf16 v[100:103], v[184:187], v[56:63], v188
 v_smfmac_f32_32x32x32_bf16 v[80:95], v[176:179], v[48:55], v188
 v_smfmac_f32_32x32x32_bf16 v[80:95], v[180:183], v[56:63], v188
 s_mov_b32 s99, 0
 s_nop 2
La_norm:
 v_rcp_f32 v0, v96
 s_nop 0
 v_mov_b32 v1, v0
 v_pk_mul_f32 v[64:65], v[64:65], v[0:1]
 v_pk_mul_f32 v[66:67], v[66:67], v[0:1]
 v_pk_mul_f32 v[68:69], v[68:69], v[0:1]
 v_pk_mul_f32 v[70:71], v[70:71], v[0:1]
 v_pk_mul_f32 v[72:73], v[72:73], v[0:1]
 v_pk_mul_f32 v[74:75], v[74:75], v[0:1]
 v_pk_mul_f32 v[76:77], v[76:77], v[0:1]
 v_pk_mul_f32 v[78:79], v[78:79], v[0:1]
 v_cvt_pk_bf16_f32 v8, v64, v65
 v_cvt_pk_bf16_f32 v9, v66, v67
 v_cvt_pk_bf16_f32 v10, v68, v69
 v_cvt_pk_bf16_f32 v11, v70, v71
 v_cvt_pk_bf16_f32 v12, v72, v73
 v_cvt_pk_bf16_f32 v13, v74, v75
 v_cvt_pk_bf16_f32 v14, v76, v77
 v_cvt_pk_bf16_f32 v15, v78, v79
 buffer_store_dwordx4 v[8:11], v230, s[44:47], s92 offen offset:0 sc1
 buffer_store_dwordx4 v[12:15], v230, s[44:47], s92 offen offset:1024 sc1
 v_rcp_f32 v2, v100
 s_nop 0
 v_mov_b32 v3, v2
 v_pk_mul_f32 v[80:81], v[80:81], v[2:3]
 v_pk_mul_f32 v[82:83], v[82:83], v[2:3]
 v_pk_mul_f32 v[84:85], v[84:85], v[2:3]
 v_pk_mul_f32 v[86:87], v[86:87], v[2:3]
 v_pk_mul_f32 v[88:89], v[88:89], v[2:3]
 v_pk_mul_f32 v[90:91], v[90:91], v[2:3]
 v_pk_mul_f32 v[92:93], v[92:93], v[2:3]
 v_pk_mul_f32 v[94:95], v[94:95], v[2:3]
 v_cvt_pk_bf16_f32 v16, v80, v81
 v_cvt_pk_bf16_f32 v17, v82, v83
 v_cvt_pk_bf16_f32 v18, v84, v85
 v_cvt_pk_bf16_f32 v19, v86, v87
 v_cvt_pk_bf16_f32 v20, v88, v89
 v_cvt_pk_bf16_f32 v21, v90, v91
 v_cvt_pk_bf16_f32 v22, v92, v93
 v_cvt_pk_bf16_f32 v23, v94, v95
 buffer_store_dwordx4 v[16:19], v230, s[44:47], s92 offen offset:2048 sc1
 buffer_store_dwordx4 v[20:23], v230, s[44:47], s92 offen offset:3072 sc1
 v_maximum3_f32 v4, abs(v64), abs(v65), abs(v66)
 v_maximum3_f32 v4, v4, abs(v67), abs(v68)
 v_maximum3_f32 v4, v4, abs(v69), abs(v70)
 v_maximum3_f32 v4, v4, abs(v71), abs(v72)
 v_maximum3_f32 v4, v4, abs(v73), abs(v74)
 v_maximum3_f32 v4, v4, abs(v75), abs(v76)
 v_maximum3_f32 v4, v4, abs(v77), abs(v78)
 v_maximum3_f32 v4, v4, abs(v79), v4
 v_maximum3_f32 v5, abs(v80), abs(v81), abs(v82)
 v_maximum3_f32 v5, v5, abs(v83), abs(v84)
 v_maximum3_f32 v5, v5, abs(v85), abs(v86)
 v_maximum3_f32 v5, v5, abs(v87), abs(v88)
 v_maximum3_f32 v5, v5, abs(v89), abs(v90)
 v_maximum3_f32 v5, v5, abs(v91), abs(v92)
 v_maximum3_f32 v5, v5, abs(v93), abs(v94)
 v_maximum3_f32 v5, v5, abs(v95), v5
 v_mul_f32 v6, v4, v96
 v_mul_f32 v7, v5, v100
 v_maximum3_f32 v4, v4, v5, v96
 v_min_f32 v6, v6, v7
 v_maximum3_f32 v4, v4, v100, v4
 s_mov_b32 s80, 0x9800000
 v_cmp_nge_f32 s[10:11], v6, s80
 s_mov_b32 s80, 0x76800000
 v_cmp_nlt_f32 vcc, v4, s80
 s_or_b64 vcc, vcc, s[10:11]
 s_cmp_eq_u64 vcc, 0
 s_cselect_b32 s80, 1, s99
 s_cmp_eq_u32 s80, 0
 s_cbranch_scc1 Lfb
 s_waitcnt vmcnt(12)
 ds_read_b64_tr_b16 v[32:33], v228 offset:0
 ds_read_b64_tr_b16 v[34:35], v228 offset:512
 ds_read_b64_tr_b16 v[36:37], v228 offset:2048
 ds_read_b64_tr_b16 v[38:39], v228 offset:2560
 ds_read_b64_tr_b16 v[40:41], v229 offset:0
 ds_read_b64_tr_b16 v[42:43], v229 offset:512
 ds_read_b64_tr_b16 v[44:45], v229 offset:2048
 ds_read_b64_tr_b16 v[46:47], v229 offset:2560
 s_sub_u32 s86, 2048, s91
 s_and_b32 s86, s86, 2047
 s_lshl_b32 s86, s86, 12
 s_lshl_b32 s75, s91, 12
 v_add_u32 v5, 131072, v233
 v_add_u32 v6, 131072, v190
 v_and_b32 v7, 7, v250
 v_lshl_or_b32 v7, v7, 2, 1
 v_lshlrev_b32 v7, 2, v7
 s_cmp_eq_u32 s91, 0
 s_cbranch_scc1 Lp3_real
Lp3_mm:
 s_waitcnt lgkmcnt(6)
 v_mfma_f32_32x32x16_bf16 v[48:63], v[32:35], a[80:83], 0
 ds_read_b64_tr_b16 a[0:1], v5 offset:0
 ds_read_b64_tr_b16 a[2:3], v5 offset:1024
 ds_read_b64_tr_b16 a[4:5], v6 offset:0
 ds_read_b64_tr_b16 a[6:7], v6 offset:1024
 ds_read_b64_tr_b16 a[8:9], v5 offset:8192
 v_accvgpr_read_b32 v128, a116
 v_accvgpr_read_b32 v129, a117
 v_accvgpr_read_b32 v130, a118
 v_mfma_f32_32x32x16_bf16 v[64:79], v[32:35], a[96:99], 0
 ds_read_b64_tr_b16 a[10:11], v5 offset:9216
 ds_read_b64_tr_b16 a[12:13], v6 offset:8192
 ds_read_b64_tr_b16 a[14:15], v6 offset:9216
 ds_read_b64_tr_b16 a[16:17], v233 offset:0
 ds_read_b64_tr_b16 a[18:19], v233 offset:1024
 v_accvgpr_read_b32 v131, a119
 v_accvgpr_read_b32 v132, a120
 v_accvgpr_read_b32 v133, a121
 s_waitcnt lgkmcnt(14)
 v_mfma_f32_32x32x16_bf16 v[48:63], v[36:39], a[84:87], v[48:63]
 ds_read_b64_tr_b16 a[20:21], v190 offset:0
 ds_read_b64_tr_b16 a[22:23], v190 offset:1024
 ds_read_b64_tr_b16 a[24:25], v233 offset:8192
 ds_read_b64_tr_b16 a[26:27], v233 offset:9216
 ds_read_b64_tr_b16 a[28:29], v190 offset:8192
 v_accvgpr_read_b32 v134, a122
 v_accvgpr_read_b32 v135, a123
 v_accvgpr_read_b32 v136, a124
 v_mfma_f32_32x32x16_bf16 v[64:79], v[36:39], a[100:103], v[64:79]
 ds_read_b64_tr_b16 a[30:31], v190 offset:9216
 ds_read_b64_tr_b16 a[32:33], v234 offset:16384
 ds_read_b64_tr_b16 a[34:35], v234 offset:17408
 ds_read_b64_tr_b16 a[36:37], v191 offset:16384
 ds_read_b64_tr_b16 a[38:39], v191 offset:17408
 v_accvgpr_read_b32 v137, a125
 v_accvgpr_read_b32 v138, a126
 v_accvgpr_read_b32 v139, a127
 s_waitcnt lgkmcnt(15)
 v_mfma_f32_32x32x16_bf16 v[48:63], v[40:43], a[88:91], v[48:63]
 ds_read_b64_tr_b16 a[40:41], v234 offset:24576
 ds_read_b64_tr_b16 a[42:43], v234 offset:25600
 ds_read_b64_tr_b16 a[44:45], v191 offset:24576
 ds_read_b64_tr_b16 a[46:47], v191 offset:25600
 ds_read_b64_tr_b16 a[48:49], v234 offset:32768
 v_accvgpr_read_b32 v140, a128
 v_accvgpr_read_b32 v141, a129
 v_accvgpr_read_b32 v142, a130
 v_mfma_f32_32x32x16_bf16 v[64:79], v[40:43], a[80:83], v[64:79]
 ds_read_b64_tr_b16 a[50:51], v234 offset:33792
 ds_read_b64_tr_b16 a[52:53], v191 offset:32768
 ds_read_b64_tr_b16 a[54:55], v191 offset:33792
 ds_read_b64_tr_b16 a[56:57], v234 offset:40960
 ds_read_b64_tr_b16 a[58:59], v234 offset:41984
 v_accvgpr_read_b32 v143, a131
 v_accvgpr_read_b32 v144, a132
 v_accvgpr_read_b32 v145, a133
 v_mfma_f32_32x32x16_bf16 v[48:63], v[44:47], a[92:95], v[48:63]
 ds_read_b64_tr_b16 a[60:61], v191 offset:40960
 ds_read_b64_tr_b16 a[62:63], v191 offset:41984
 ds_read_b64_tr_b16 a[64:65], v233 offset:16384
 ds_read_b64_tr_b16 a[66:67], v233 offset:17408
 ds_read_b64_tr_b16 a[68:69], v190 offset:16384
 v_accvgpr_read_b32 v146, a134
 v_accvgpr_read_b32 v147, a135
 v_accvgpr_read_b32 v148, a136
 v_mfma_f32_32x32x16_bf16 v[64:79], v[44:47], a[84:87], v[64:79]
 ds_read_b64_tr_b16 a[70:71], v190 offset:17408
 ds_read_b64_tr_b16 a[72:73], v233 offset:24576
 ds_read_b64_tr_b16 a[74:75], v233 offset:25600
 ds_read_b64_tr_b16 a[76:77], v190 offset:24576
 ds_read_b64_tr_b16 a[78:79], v190 offset:25600
 v_accvgpr_read_b32 v149, a137
 v_accvgpr_read_b32 v150, a138
 v_accvgpr_read_b32 v151, a139
 v_accvgpr_read_b32 v152, a140
 v_accvgpr_read_b32 v153, a141
 v_accvgpr_read_b32 v154, a142
 v_accvgpr_read_b32 v155, a143
 v_accvgpr_read_b32 v156, a144
 v_accvgpr_read_b32 v157, a145
 v_accvgpr_read_b32 v158, a146
 v_accvgpr_read_b32 v159, a147
 v_accvgpr_read_b32 v120, a112
 v_accvgpr_read_b32 v121, a113
 v_accvgpr_read_b32 v122, a114
 s_waitcnt vmcnt(0) lgkmcnt(0)
 s_barrier
 s_cmp_lg_u32 s30, 1
 s_cbranch_scc1 Lnoofl
 v_mov_b32 v0, s64
 buffer_store_dword v0, v237, s[44:47], s94 offen sc1
Lnoofl:
 ds_read_b64_tr_b16 a[148:149], v233 offset:32768
 ds_read_b64_tr_b16 a[150:151], v233 offset:33792
 v_pk_mul_f32 v[96:97], v[48:49], v[128:129]
 v_pk_mul_f32 v[98:99], v[64:65], v[128:129]
 v_pk_fma_f32 v[96:97], v[64:65], v[144:145], v[96:97]
 v_pk_fma_f32 v[98:99], v[48:49], v[144:145], v[98:99] neg_lo:[0,1,0] neg_hi:[0,1,0]
 v_cvt_pk_bf16_f32 v80, v96, v97
 v_cvt_pk_bf16_f32 v88, v98, v99
 ds_read_b64_tr_b16 a[152:153], v190 offset:32768
 ds_read_b64_tr_b16 a[154:155], v190 offset:33792
 s_add_u32 m0, s67, 0
 s_lshl4_add_u32 s65, s19, s69
 s_nop 0
 buffer_load_dwordx4 v238, s[40:43], s65 offen offset:0  lds
 v_pk_mul_f32 v[96:97], v[50:51], v[130:131]
 v_pk_mul_f32 v[98:99], v[66:67], v[130:131]
 v_pk_fma_f32 v[96:97], v[66:67], v[146:147], v[96:97]
 v_pk_fma_f32 v[98:99], v[50:51], v[146:147], v[98:99] neg_lo:[0,1,0] neg_hi:[0,1,0]
 v_cvt_pk_bf16_f32 v81, v96, v97
 v_cvt_pk_bf16_f32 v89, v98, v99
 ds_read_b64_tr_b16 a[156:157], v233 offset:40960
 ds_read_b64_tr_b16 a[158:159], v233 offset:41984
 v_pk_mul_f32 v[96:97], v[52:53], v[132:133]
 v_pk_mul_f32 v[98:99], v[68:69], v[132:133]
 v_pk_fma_f32 v[96:97], v[68:69], v[148:149], v[96:97]
 v_pk_fma_f32 v[98:99], v[52:53], v[148:149], v[98:99] neg_lo:[0,1,0] neg_hi:[0,1,0]
 v_cvt_pk_bf16_f32 v82, v96, v97
 v_cvt_pk_bf16_f32 v90, v98, v99
 ds_read_b64_tr_b16 a[160:161], v190 offset:40960
 ds_read_b64_tr_b16 a[162:163], v190 offset:41984
 buffer_load_dwordx4 v239, s[40:43], s65 offen offset:1024  lds
 v_pk_mul_f32 v[96:97], v[54:55], v[134:135]
 v_pk_mul_f32 v[98:99], v[70:71], v[134:135]
 v_pk_fma_f32 v[96:97], v[70:71], v[150:151], v[96:97]
 v_pk_fma_f32 v[98:99], v[54:55], v[150:151], v[98:99] neg_lo:[0,1,0] neg_hi:[0,1,0]
 v_cvt_pk_bf16_f32 v83, v96, v97
 v_cvt_pk_bf16_f32 v91, v98, v99
 ds_read_b64_tr_b16 a[164:165], v234 offset:0
 ds_read_b64_tr_b16 a[166:167], v234 offset:1024
 v_pk_mul_f32 v[96:97], v[56:57], v[136:137]
 v_pk_mul_f32 v[98:99], v[72:73], v[136:137]
 v_pk_fma_f32 v[96:97], v[72:73], v[152:153], v[96:97]
 v_pk_fma_f32 v[98:99], v[56:57], v[152:153], v[98:99] neg_lo:[0,1,0] neg_hi:[0,1,0]
 v_cvt_pk_bf16_f32 v84, v96, v97
 v_cvt_pk_bf16_f32 v92, v98, v99
 ds_read_b64_tr_b16 a[168:169], v191 offset:0
 ds_read_b64_tr_b16 a[170:171], v191 offset:1024
 buffer_load_dwordx4 v240, s[40:43], s65 offen offset:2048  lds
 v_pk_mul_f32 v[96:97], v[58:59], v[138:139]
 v_pk_mul_f32 v[98:99], v[74:75], v[138:139]
 v_pk_fma_f32 v[96:97], v[74:75], v[154:155], v[96:97]
 v_pk_fma_f32 v[98:99], v[58:59], v[154:155], v[98:99] neg_lo:[0,1,0] neg_hi:[0,1,0]
 v_cvt_pk_bf16_f32 v85, v96, v97
 v_cvt_pk_bf16_f32 v93, v98, v99
 ds_read_b64_tr_b16 a[172:173], v234 offset:8192
 ds_read_b64_tr_b16 a[174:175], v234 offset:9216
 v_pk_mul_f32 v[96:97], v[60:61], v[140:141]
 v_pk_mul_f32 v[98:99], v[76:77], v[140:141]
 v_pk_fma_f32 v[96:97], v[76:77], v[156:157], v[96:97]
 v_pk_fma_f32 v[98:99], v[60:61], v[156:157], v[98:99] neg_lo:[0,1,0] neg_hi:[0,1,0]
 v_cvt_pk_bf16_f32 v86, v96, v97
 v_cvt_pk_bf16_f32 v94, v98, v99
 ds_read_b64_tr_b16 a[176:177], v191 offset:8192
 ds_read_b64_tr_b16 a[178:179], v191 offset:9216
 buffer_load_dwordx4 v241, s[40:43], s65 offen offset:3072  lds
 v_pk_mul_f32 v[96:97], v[62:63], v[142:143]
 v_pk_mul_f32 v[98:99], v[78:79], v[142:143]
 v_pk_fma_f32 v[96:97], v[78:79], v[158:159], v[96:97]
 v_pk_fma_f32 v[98:99], v[62:63], v[158:159], v[98:99] neg_lo:[0,1,0] neg_hi:[0,1,0]
 v_cvt_pk_bf16_f32 v87, v96, v97
 v_cvt_pk_bf16_f32 v95, v98, v99
 s_nop 0
 v_mfma_f32_32x32x16_bf16 v[48:63], v[80:83], a[80:83], 0
 s_add_u32 m0, s67, 16384
 s_lshl4_add_u32 s65, s20, s69
 s_nop 0
 buffer_load_dwordx4 v238, s[40:43], s65 offen offset:0  lds
 v_mfma_f32_32x32x16_bf16 v[48:63], v[84:87], a[84:87], v[48:63]
 buffer_load_dwordx4 v239, s[40:43], s65 offen offset:1024  lds
 v_mfma_f32_32x32x16_bf16 v[48:63], v[88:91], a[88:91], v[48:63]
 buffer_load_dwordx4 v240, s[40:43], s65 offen offset:2048  lds
 v_mfma_f32_32x32x16_bf16 v[48:63], v[92:95], a[92:95], v[48:63]
 buffer_load_dwordx4 v241, s[40:43], s65 offen offset:3072  lds
 s_lshl_b32 s82, s33, 6
 s_add_u32 s82, s82, s30
 s_lshl_b32 s82, s82, 11
 s_add_u32 s82, s82, 1048576
 s_sub_u32 s68, s68, 16384
 v_add_u32 v242, s82, v230
 v_and_b32 v235, 15, v250
 v_bfe_u32 v176, v250, 4, 1
 v_lshlrev_b32 v235, 4, v235
 v_lshl_or_b32 v235, v176, 10, v235
 v_lshrrev_b32 v176, 5, v250
 v_lshl_or_b32 v235, v176, 9, v235
 v_add_u32 v176, 147456, v235
 v_add_u32 v235, 81920, v235
 v_add_u32 v178, s74, v230
 s_nop 0
 ds_bpermute_b32 v64, v120, v48
 v_cvt_pk_bf16_f32 v104, v48, v49
 v_cvt_pk_bf16_f32 v105, v50, v51
 v_cvt_pk_bf16_f32 v106, v52, v53
 v_cvt_pk_bf16_f32 v107, v54, v55
 s_add_u32 m0, s67, 65536
 s_lshl4_add_u32 s65, s21, s69
 s_nop 0
 buffer_load_dwordx4 v238, s[40:43], s65 offen offset:0  lds
 v_cvt_pk_bf16_f32 v108, v56, v57
 v_cvt_pk_bf16_f32 v109, v58, v59
 v_cvt_pk_bf16_f32 v110, v60, v61
 v_cvt_pk_bf16_f32 v111, v62, v63
 buffer_load_dwordx4 v239, s[40:43], s65 offen offset:1024  lds
 v_cvt_pk_bf16_f32 v113, v62, v61
 v_cvt_pk_bf16_f32 v114, v60, v59
 v_cvt_pk_bf16_f32 v115, v58, v57
 v_cvt_pk_bf16_f32 v116, v56, v55
 v_cvt_pk_bf16_f32 v117, v54, v53
 v_cvt_pk_bf16_f32 v118, v52, v51
 v_cvt_pk_bf16_f32 v119, v50, v49
 buffer_load_dwordx4 v240, s[40:43], s65 offen offset:2048  lds
 s_cmp_eq_u32 s30, 3
 s_cbranch_scc1 Lqi
Lqi_b:
 v_permlane16_swap_b32 v104, v108
 v_permlane16_swap_b32 v105, v109
 v_permlane16_swap_b32 v106, v110
 v_permlane16_swap_b32 v107, v111
 s_waitcnt lgkmcnt(0)
 v_cvt_pk_bf16_f32 v112, v64, v63
 s_nop 1
 v_permlane16_swap_b32 v112, v116
 v_permlane16_swap_b32 v113, v117
 v_permlane16_swap_b32 v114, v118
 v_permlane16_swap_b32 v115, v119
 buffer_load_dwordx4 v241, s[40:43], s65 offen offset:3072  lds
 s_cmp_eq_u32 s91, 0
 s_cbranch_scc1 Lp3_again
Lp3_end:
 ds_write_b128 v178, v[8:11] offset:0
 ds_write_b128 v178, v[12:15] offset:1024
 ds_write_b128 v178, v[16:19] offset:2048
 ds_write_b128 v178, v[20:23] offset:3072
Lqc:
 s_cmp_lg_u32 s30, 3
 s_cbranch_scc1 Lnopoll
 s_waitcnt vmcnt(1)
 v_cmp_ne_u32 vcc, s64, v244
 s_cmp_eq_u64 vcc, 0
 s_cbranch_scc0 Lretry_7
Lback_8:
Lnopoll:
 s_waitcnt lgkmcnt(0)
 s_barrier
 s_add_u32 m0, s68, 0
 s_nop 0
 buffer_load_dwordx4 v242, s[44:47], s4 offen offset:0 sc1 lds
 buffer_load_dwordx4 v242, s[44:47], s4 offen offset:1024 sc1 lds
 ds_read_b128 v[40:43], v176 offset:0
 ds_read_b128 v[44:47], v176 offset:256
 ds_read_b128 v[48:51], v176 offset:2048
 ds_read_b128 v[52:55], v176 offset:2304
 ds_read_b128 v[204:207], v176 offset:4096
 ds_read_b128 v[208:211], v176 offset:4352
 ds_read_b128 v[212:215], v176 offset:6144
 ds_read_b128 v[216:219], v176 offset:6400
 s_add_u32 m0, s68, 8192
 s_nop 0
 buffer_load_dwordx4 v242, s[44:47], s5 offen offset:0 sc1 lds
 buffer_load_dwordx4 v242, s[44:47], s5 offen offset:1024 sc1 lds
 s_waitcnt lgkmcnt(4)
 v_mfma_f32_16x16x32_bf16 v[0:3], a[0:3], v[40:43], 0
 ds_read_b128 v[160:163], v176 offset:8192
 v_mfma_f32_16x16x32_bf16 v[4:7], a[4:7], v[40:43], 0
 s_add_u32 m0, s68, 16384
 s_nop 0
 buffer_load_dwordx4 v242, s[44:47], s14 offen offset:0 sc1 lds
 v_and_b32 v56, 15, v250
 v_lshrrev_b32 v57, 5, v250
 v_bfe_u32 v58, v250, 4, 1
 v_lshl_or_b32 v57, v58, 1, v57
 v_mfma_f32_16x16x32_bf16 v[8:11], a[0:3], v[44:47], 0
 ds_read_b128 v[164:167], v176 offset:8448
 v_mfma_f32_16x16x32_bf16 v[12:15], a[4:7], v[44:47], 0
 buffer_load_dwordx4 v242, s[44:47], s14 offen offset:1024 sc1 lds
 v_lshl_or_b32 v57, s30, 2, v57
 v_and_b32 v58, 7, v250
 v_xor_b32 v57, v57, v58
 v_mfma_f32_16x16x32_bf16 v[16:19], a[0:3], v[48:51], 0
 ds_read_b128 v[168:171], v176 offset:10240
 v_mfma_f32_16x16x32_bf16 v[20:23], a[4:7], v[48:51], 0
 s_add_u32 m0, s68, 24576
 s_nop 0
 buffer_load_dwordx4 v242, s[44:47], s15 offen offset:0 sc1 lds
 v_lshlrev_b32 v57, 4, v57
 v_lshl_or_b32 v57, v56, 8, v57
 v_lshrrev_b32 v58, 4, v250
 v_mfma_f32_16x16x32_bf16 v[24:27], a[0:3], v[52:55], 0
 ds_read_b128 v[172:175], v176 offset:10496
 v_mfma_f32_16x16x32_bf16 v[28:31], a[4:7], v[52:55], 0
 buffer_load_dwordx4 v242, s[44:47], s15 offen offset:1024 sc1 lds
 v_xor_b32 v59, v56, v58
 v_lshlrev_b32 v59, 4, v59
 v_lshl_or_b32 v59, v58, 8, v59
 s_waitcnt lgkmcnt(4)
 v_mfma_f32_16x16x32_bf16 v[0:3], a[8:11], v[204:207], v[0:3]
 ds_read_b128 v[40:43], v176 offset:12288
 v_mfma_f32_16x16x32_bf16 v[4:7], a[12:15], v[204:207], v[4:7]
 s_add_u32 m0, s68, 32768
 s_nop 0
 buffer_load_dwordx4 v242, s[44:47], s18 offen offset:0 sc1 lds
 v_add_u32 v59, s67, v59
 v_xor_b32 v60, 64, v59
 v_lshlrev_b32 v56, 4, v56
 v_mfma_f32_16x16x32_bf16 v[8:11], a[8:11], v[208:211], v[8:11]
 ds_read_b128 v[44:47], v176 offset:12544
 v_mfma_f32_16x16x32_bf16 v[12:15], a[12:15], v[208:211], v[12:15]
 v_lshl_or_b32 v58, v58, 12, v56
 s_lshl2_add_u32 s80, s33, s30
 s_lshl_b32 s80, s80, 16
 v_mfma_f32_16x16x32_bf16 v[16:19], a[8:11], v[212:215], v[16:19]
 ds_read_b128 v[48:51], v176 offset:14336
 v_mfma_f32_16x16x32_bf16 v[20:23], a[12:15], v[212:215], v[20:23]
 buffer_load_dwordx4 v242, s[44:47], s18 offen offset:1024 sc1 lds
 s_lshl_b32 s81, s34, 8
 s_add_u32 s80, s80, s81
 s_add_u32 s80, s80, 2048
 v_mfma_f32_16x16x32_bf16 v[24:27], a[8:11], v[216:219], v[24:27]
 ds_read_b128 v[52:55], v176 offset:14592
 v_mfma_f32_16x16x32_bf16 v[28:31], a[12:15], v[216:219], v[28:31]
 s_add_u32 s81, s80, 0x4000
 s_add_u32 s82, s80, 0x8000
 s_add_u32 s83, s80, 0xc000
 s_waitcnt lgkmcnt(4)
 v_mfma_f32_16x16x32_bf16 v[0:3], a[16:19], v[160:163], v[0:3]
 s_waitcnt vmcnt(8)
 s_barrier
 ds_read_b128 v[204:207], v235 offset:0
 v_mfma_f32_16x16x32_bf16 v[4:7], a[20:23], v[160:163], v[4:7]
 s_add_u32 m0, s68, 40960
 s_nop 0
 buffer_load_dwordx4 v242, s[44:47], s19 offen offset:0 sc1 lds
 v_mfma_f32_16x16x32_bf16 v[8:11], a[16:19], v[164:167], v[8:11]
 ds_read_b128 v[208:211], v235 offset:256
 v_mfma_f32_16x16x32_bf16 v[12:15], a[20:23], v[164:167], v[12:15]
 v_mfma_f32_16x16x32_bf16 v[16:19], a[16:19], v[168:171], v[16:19]
 ds_read_b128 v[212:215], v235 offset:2048
 v_mfma_f32_16x16x32_bf16 v[20:23], a[20:23], v[168:171], v[20:23]
 buffer_load_dwordx4 v242, s[44:47], s19 offen offset:1024 sc1 lds
 v_mfma_f32_16x16x32_bf16 v[24:27], a[16:19], v[172:175], v[24:27]
 ds_read_b128 v[216:219], v235 offset:2304
 v_mfma_f32_16x16x32_bf16 v[28:31], a[20:23], v[172:175], v[28:31]
 s_waitcnt lgkmcnt(4)
 v_mfma_f32_16x16x32_bf16 v[0:3], a[24:27], v[40:43], v[0:3]
 ds_read_b128 v[160:163], v235 offset:4096
 v_mfma_f32_16x16x32_bf16 v[4:7], a[28:31], v[40:43], v[4:7]
 s_add_u32 m0, s68, 49152
 s_nop 0
 buffer_load_dwordx4 v242, s[44:47], s20 offen offset:0 sc1 lds
 v_mfma_f32_16x16x32_bf16 v[8:11], a[24:27], v[44:47], v[8:11]
 ds_read_b128 v[164:167], v235 offset:4352
 v_mfma_f32_16x16x32_bf16 v[12:15], a[28:31], v[44:47], v[12:15]
 v_mfma_f32_16x16x32_bf16 v[16:19], a[24:27], v[48:51], v[16:19]
 ds_read_b128 v[168:171], v235 offset:6144
 v_mfma_f32_16x16x32_bf16 v[20:23], a[28:31], v[48:51], v[20:23]
 buffer_load_dwordx4 v242, s[44:47], s20 offen offset:1024 sc1 lds
 v_mfma_f32_16x16x32_bf16 v[24:27], a[24:27], v[52:55], v[24:27]
 ds_read_b128 v[172:175], v235 offset:6400
 v_mfma_f32_16x16x32_bf16 v[28:31], a[28:31], v[52:55], v[28:31]
 s_waitcnt lgkmcnt(4)
 v_mfma_f32_16x16x32_bf16 v[0:3], a[32:35], v[204:207], v[0:3]
 s_waitcnt vmcnt(10)
 s_barrier
 ds_read_b128 v[40:43], v235 offset:8192
 v_mfma_f32_16x16x32_bf16 v[4:7], a[36:39], v[204:207], v[4:7]
 s_add_u32 m0, s68, 57344
 s_nop 0
 buffer_load_dwordx4 v242, s[44:47], s21 offen offset:0 sc1 lds
 v_mfma_f32_16x16x32_bf16 v[8:11], a[32:35], v[208:211], v[8:11]
 ds_read_b128 v[44:47], v235 offset:8448
 v_mfma_f32_16x16x32_bf16 v[12:15], a[36:39], v[208:211], v[12:15]
 v_mfma_f32_16x16x32_bf16 v[16:19], a[32:35], v[212:215], v[16:19]
 ds_read_b128 v[48:51], v235 offset:10240
 v_mfma_f32_16x16x32_bf16 v[20:23], a[36:39], v[212:215], v[20:23]
 buffer_load_dwordx4 v242, s[44:47], s21 offen offset:1024 sc1 lds
 v_mfma_f32_16x16x32_bf16 v[24:27], a[32:35], v[216:219], v[24:27]
 ds_read_b128 v[52:55], v235 offset:10496
 v_mfma_f32_16x16x32_bf16 v[28:31], a[36:39], v[216:219], v[28:31]
 s_waitcnt lgkmcnt(4)
 v_mfma_f32_16x16x32_bf16 v[0:3], a[40:43], v[160:163], v[0:3]
 ds_read_b128 v[204:207], v235 offset:12288
 v_mfma_f32_16x16x32_bf16 v[4:7], a[44:47], v[160:163], v[4:7]
 s_add_u32 m0, s67, 32768
 s_lshl4_add_u32 s65, s24, s69
 buffer_load_dwordx4 v238, s[40:43], s65 offen offset:0  lds
 v_mfma_f32_16x16x32_bf16 v[8:11], a[40:43], v[164:167], v[8:11]
 ds_read_b128 v[208:211], v235 offset:12544
 v_mfma_f32_16x16x32_bf16 v[12:15], a[44:47], v[164:167], v[12:15]
 v_mfma_f32_16x16x32_bf16 v[16:19], a[40:43], v[168:171], v[16:19]
 ds_read_b128 v[212:215], v235 offset:14336
 v_mfma_f32_16x16x32_bf16 v[20:23], a[44:47], v[168:171], v[20:23]
 buffer_load_dwordx4 v239, s[40:43], s65 offen offset:1024  lds
 v_mfma_f32_16x16x32_bf16 v[24:27], a[40:43], v[172:175], v[24:27]
 ds_read_b128 v[216:219], v235 offset:14592
 v_mfma_f32_16x16x32_bf16 v[28:31], a[44:47], v[172:175], v[28:31]
 s_waitcnt lgkmcnt(4)
 v_mfma_f32_16x16x32_bf16 v[0:3], a[48:51], v[40:43], v[0:3]
 s_waitcnt vmcnt(12)
 s_barrier
 ds_read_b128 v[160:163], v235 offset:16384
 v_mfma_f32_16x16x32_bf16 v[4:7], a[52:55], v[40:43], v[4:7]
 buffer_load_dwordx4 v240, s[40:43], s65 offen offset:2048  lds
 v_mfma_f32_16x16x32_bf16 v[8:11], a[48:51], v[44:47], v[8:11]
 ds_read_b128 v[164:167], v235 offset:16640
 v_mfma_f32_16x16x32_bf16 v[12:15], a[52:55], v[44:47], v[12:15]
 v_mfma_f32_16x16x32_bf16 v[16:19], a[48:51], v[48:51], v[16:19]
 ds_read_b128 v[168:171], v235 offset:18432
 v_mfma_f32_16x16x32_bf16 v[20:23], a[52:55], v[48:51], v[20:23]
 buffer_load_dwordx4 v241, s[40:43], s65 offen offset:3072  lds
 v_mfma_f32_16x16x32_bf16 v[24:27], a[48:51], v[52:55], v[24:27]
 ds_read_b128 v[172:175], v235 offset:18688
 v_mfma_f32_16x16x32_bf16 v[28:31], a[52:55], v[52:55], v[28:31]
 s_waitcnt lgkmcnt(4)
 v_mfma_f32_16x16x32_bf16 v[0:3], a[56:59], v[204:207], v[0:3]
 ds_read_b128 v[40:43], v235 offset:20480
 v_mfma_f32_16x16x32_bf16 v[4:7], a[60:63], v[204:207], v[4:7]
 s_add_u32 m0, s68, 0
 s_nop 0
 buffer_load_dwordx4 v242, s[44:47], s24 offen offset:0 sc1 lds
 v_mfma_f32_16x16x32_bf16 v[8:11], a[56:59], v[208:211], v[8:11]
 ds_read_b128 v[44:47], v235 offset:20736
 v_mfma_f32_16x16x32_bf16 v[12:15], a[60:63], v[208:211], v[12:15]
 v_mfma_f32_16x16x32_bf16 v[16:19], a[56:59], v[212:215], v[16:19]
 ds_read_b128 v[48:51], v235 offset:22528
 v_mfma_f32_16x16x32_bf16 v[20:23], a[60:63], v[212:215], v[20:23]
 buffer_load_dwordx4 v242, s[44:47], s24 offen offset:1024 sc1 lds
 v_mfma_f32_16x16x32_bf16 v[24:27], a[56:59], v[216:219], v[24:27]
 ds_read_b128 v[52:55], v235 offset:22784
 v_mfma_f32_16x16x32_bf16 v[28:31], a[60:63], v[216:219], v[28:31]
 s_waitcnt lgkmcnt(4)
 v_mfma_f32_16x16x32_bf16 v[0:3], a[64:67], v[160:163], v[0:3]
 s_waitcnt vmcnt(14)
 s_barrier
 ds_read_b128 v[204:207], v235 offset:24576
 v_mfma_f32_16x16x32_bf16 v[4:7], a[68:71], v[160:163], v[4:7]
 s_add_u32 m0, s68, 8192
 s_nop 0
 buffer_load_dwordx4 v242, s[44:47], s25 offen offset:0 sc1 lds
 v_mfma_f32_16x16x32_bf16 v[8:11], a[64:67], v[164:167], v[8:11]
 ds_read_b128 v[208:211], v235 offset:24832
 v_mfma_f32_16x16x32_bf16 v[12:15], a[68:71], v[164:167], v[12:15]
 v_mfma_f32_16x16x32_bf16 v[16:19], a[64:67], v[168:171], v[16:19]
 ds_read_b128 v[212:215], v235 offset:26624
 v_mfma_f32_16x16x32_bf16 v[20:23], a[68:71], v[168:171], v[20:23]
 buffer_load_dwordx4 v242, s[44:47], s25 offen offset:1024 sc1 lds
 v_mfma_f32_16x16x32_bf16 v[24:27], a[64:67], v[172:175], v[24:27]
 ds_read_b128 v[216:219], v235 offset:26880
 v_mfma_f32_16x16x32_bf16 v[28:31], a[68:71], v[172:175], v[28:31]
 s_waitcnt lgkmcnt(4)
 v_mfma_f32_16x16x32_bf16 v[0:3], a[72:75], v[40:43], v[0:3]
 ds_read_b128 v[160:163], v235 offset:28672
 v_mfma_f32_16x16x32_bf16 v[4:7], a[76:79], v[40:43], v[4:7]
 s_add_u32 m0, s67, 49152
 s_lshl4_add_u32 s65, s25, s69
 buffer_load_dwordx4 v238, s[40:43], s65 offen offset:0  lds
 v_mfma_f32_16x16x32_bf16 v[8:11], a[72:75], v[44:47], v[8:11]
 ds_read_b128 v[164:167], v235 offset:28928
 v_mfma_f32_16x16x32_bf16 v[12:15], a[76:79], v[44:47], v[12:15]
 v_mfma_f32_16x16x32_bf16 v[16:19], a[72:75], v[48:51], v[16:19]
 ds_read_b128 v[168:171], v235 offset:30720
 v_mfma_f32_16x16x32_bf16 v[20:23], a[76:79], v[48:51], v[20:23]
 buffer_load_dwordx4 v239, s[40:43], s65 offen offset:1024  lds
 v_mfma_f32_16x16x32_bf16 v[24:27], a[72:75], v[52:55], v[24:27]
 ds_read_b128 v[172:175], v235 offset:30976
 v_mfma_f32_16x16x32_bf16 v[28:31], a[76:79], v[52:55], v[28:31]
 s_waitcnt lgkmcnt(4)
 v_mfma_f32_16x16x32_bf16 v[0:3], a[148:151], v[204:207], v[0:3]
 s_waitcnt vmcnt(16)
 s_barrier
 ds_read_b128 v[40:43], v235 offset:32768
 v_mfma_f32_16x16x32_bf16 v[4:7], a[152:155], v[204:207], v[4:7]
 buffer_load_dwordx4 v240, s[40:43], s65 offen offset:2048  lds
 v_mfma_f32_16x16x32_bf16 v[8:11], a[148:151], v[208:211], v[8:11]
 ds_read_b128 v[44:47], v235 offset:33024
 v_mfma_f32_16x16x32_bf16 v[12:15], a[152:155], v[208:211], v[12:15]
 v_mfma_f32_16x16x32_bf16 v[16:19], a[148:151], v[212:215], v[16:19]
 ds_read_b128 v[48:51], v235 offset:34816
 v_mfma_f32_16x16x32_bf16 v[20:23], a[152:155], v[212:215], v[20:23]
 buffer_load_dwordx4 v241, s[40:43], s65 offen offset:3072  lds
 v_mfma_f32_16x16x32_bf16 v[24:27], a[148:151], v[216:219], v[24:27]
 ds_read_b128 v[52:55], v235 offset:35072
 v_mfma_f32_16x16x32_bf16 v[28:31], a[152:155], v[216:219], v[28:31]
 s_waitcnt lgkmcnt(4)
 v_mfma_f32_16x16x32_bf16 v[0:3], a[156:159], v[160:163], v[0:3]
 ds_read_b128 v[204:207], v235 offset:36864
 v_mfma_f32_16x16x32_bf16 v[4:7], a[160:163], v[160:163], v[4:7]
 s_add_u32 m0, s68, 16384
 s_nop 0
 buffer_load_dwordx4 v242, s[44:47], s28 offen offset:0 sc1 lds
 v_mfma_f32_16x16x32_bf16 v[8:11], a[156:159], v[164:167], v[8:11]
 ds_read_b128 v[208:211], v235 offset:37120
 v_mfma_f32_16x16x32_bf16 v[12:15], a[160:163], v[164:167], v[12:15]
 v_mfma_f32_16x16x32_bf16 v[16:19], a[156:159], v[168:171], v[16:19]
 ds_read_b128 v[212:215], v235 offset:38912
 v_mfma_f32_16x16x32_bf16 v[20:23], a[160:163], v[168:171], v[20:23]
 buffer_load_dwordx4 v242, s[44:47], s28 offen offset:1024 sc1 lds
 v_mfma_f32_16x16x32_bf16 v[24:27], a[156:159], v[172:175], v[24:27]
 ds_read_b128 v[216:219], v235 offset:39168
 v_mfma_f32_16x16x32_bf16 v[28:31], a[160:163], v[172:175], v[28:31]
 s_waitcnt lgkmcnt(4)
 v_mfma_f32_16x16x32_bf16 v[0:3], a[164:167], v[40:43], v[0:3]
 s_waitcnt vmcnt(18)
 s_barrier
 ds_read_b128 v[160:163], v235 offset:40960
 v_mfma_f32_16x16x32_bf16 v[4:7], a[168:171], v[40:43], v[4:7]
 ds_read_b64_tr_b16 v[152:153], v233 offset:0
 s_add_u32 m0, s68, 24576
 s_nop 0
 buffer_load_dwordx4 v242, s[44:47], s29 offen offset:0 sc1 lds
 v_mfma_f32_16x16x32_bf16 v[8:11], a[164:167], v[44:47], v[8:11]
 ds_read_b128 v[164:167], v235 offset:41216
 v_mfma_f32_16x16x32_bf16 v[12:15], a[168:171], v[44:47], v[12:15]
 ds_read_b64_tr_b16 v[154:155], v233 offset:1024
 v_mfma_f32_16x16x32_bf16 v[16:19], a[164:167], v[48:51], v[16:19]
 ds_read_b128 v[168:171], v235 offset:43008
 v_mfma_f32_16x16x32_bf16 v[20:23], a[168:171], v[48:51], v[20:23]
 ds_read_b64_tr_b16 v[156:157], v190 offset:0
 buffer_load_dwordx4 v242, s[44:47], s29 offen offset:1024 sc1 lds
 v_mfma_f32_16x16x32_bf16 v[24:27], a[164:167], v[52:55], v[24:27]
 ds_read_b128 v[172:175], v235 offset:43264
 v_mfma_f32_16x16x32_bf16 v[28:31], a[168:171], v[52:55], v[28:31]
 ds_read_b64_tr_b16 v[158:159], v190 offset:1024
 s_waitcnt lgkmcnt(8)
 v_mfma_f32_16x16x32_bf16 v[0:3], a[172:175], v[204:207], v[0:3]
 ds_read_b128 v[40:43], v235 offset:45056
 v_mfma_f32_16x16x32_bf16 v[4:7], a[176:179], v[204:207], v[4:7]
 ds_read_b64_tr_b16 v[32:33], v233 offset:8192
 v_mfma_f32_16x16x32_bf16 v[8:11], a[172:175], v[208:211], v[8:11]
 ds_read_b128 v[44:47], v235 offset:45312
 v_mfma_f32_16x16x32_bf16 v[12:15], a[176:179], v[208:211], v[12:15]
 ds_read_b64_tr_b16 v[34:35], v233 offset:9216
 v_mfma_f32_16x16x32_bf16 v[16:19], a[172:175], v[212:215], v[16:19]
 ds_read_b128 v[48:51], v235 offset:47104
 v_mfma_f32_16x16x32_bf16 v[20:23], a[176:179], v[212:215], v[20:23]
 ds_read_b64_tr_b16 v[36:37], v190 offset:8192
 v_mfma_f32_16x16x32_bf16 v[24:27], a[172:175], v[216:219], v[24:27]
 ds_read_b128 v[52:55], v235 offset:47360
 v_mfma_f32_16x16x32_bf16 v[28:31], a[176:179], v[216:219], v[28:31]
 ds_read_b64_tr_b16 v[38:39], v190 offset:9216
 s_waitcnt lgkmcnt(8)
 v_mfma_f32_16x16x32_bf16 v[0:3], v[152:155], v[160:163], v[0:3]
 s_waitcnt vmcnt(18)
 s_barrier
 ds_read_b128 v[204:207], v235 offset:49152
 v_mfma_f32_16x16x32_bf16 v[4:7], v[156:159], v[160:163], v[4:7]
 ds_read_b64_tr_b16 v[196:197], v233 offset:16384
 s_add_u32 m0, s68, 32768
 s_nop 0
 buffer_load_dwordx4 v242, s[44:47], s35 offen offset:0 sc1 lds
 v_mfma_f32_16x16x32_bf16 v[8:11], v[152:155], v[164:167], v[8:11]
 ds_read_b128 v[208:211], v235 offset:49408
 v_mfma_f32_16x16x32_bf16 v[12:15], v[156:159], v[164:167], v[12:15]
 ds_read_b64_tr_b16 v[198:199], v233 offset:17408
 v_mfma_f32_16x16x32_bf16 v[16:19], v[152:155], v[168:171], v[16:19]
 ds_read_b128 v[212:215], v235 offset:51200
 v_mfma_f32_16x16x32_bf16 v[20:23], v[156:159], v[168:171], v[20:23]
 ds_read_b64_tr_b16 v[200:201], v190 offset:16384
 buffer_load_dwordx4 v242, s[44:47], s35 offen offset:1024 sc1 lds
 v_mfma_f32_16x16x32_bf16 v[24:27], v[152:155], v[172:175], v[24:27]
 ds_read_b128 v[216:219], v235 offset:51456
 v_mfma_f32_16x16x32_bf16 v[28:31], v[156:159], v[172:175], v[28:31]
 ds_read_b64_tr_b16 v[202:203], v190 offset:17408
 s_waitcnt lgkmcnt(8)
 v_mfma_f32_16x16x32_bf16 v[0:3], v[32:35], v[40:43], v[0:3]
 ds_read_b128 v[160:163], v235 offset:53248
 v_mfma_f32_16x16x32_bf16 v[4:7], v[36:39], v[40:43], v[4:7]
 ds_read_b64_tr_b16 v[152:153], v233 offset:24576
 v_mfma_f32_16x16x32_bf16 v[8:11], v[32:35], v[44:47], v[8:11]
 ds_read_b128 v[164:167], v235 offset:53504
 v_mfma_f32_16x16x32_bf16 v[12:15], v[36:39], v[44:47], v[12:15]
 ds_read_b64_tr_b16 v[154:155], v233 offset:25600
 v_mfma_f32_16x16x32_bf16 v[16:19], v[32:35], v[48:51], v[16:19]
 ds_read_b128 v[168:171], v235 offset:55296
 v_mfma_f32_16x16x32_bf16 v[20:23], v[36:39], v[48:51], v[20:23]
 ds_read_b64_tr_b16 v[156:157], v190 offset:24576
 v_mfma_f32_16x16x32_bf16 v[24:27], v[32:35], v[52:55], v[24:27]
 ds_read_b128 v[172:175], v235 offset:55552
 v_mfma_f32_16x16x32_bf16 v[28:31], v[36:39], v[52:55], v[28:31]
 ds_read_b64_tr_b16 v[158:159], v190 offset:25600
 s_waitcnt lgkmcnt(8)
 v_mfma_f32_16x16x32_bf16 v[0:3], v[196:199], v[204:207], v[0:3]
 s_waitcnt vmcnt(18)
 s_barrier
 ds_read_b128 v[40:43], v235 offset:57344
 v_mfma_f32_16x16x32_bf16 v[4:7], v[200:203], v[204:207], v[4:7]
 ds_read_b64_tr_b16 v[32:33], v234 offset:16384
 s_add_u32 m0, s67, 0
 s_lshl4_add_u32 s65, s28, s69
 buffer_load_dwordx4 v238, s[40:43], s65 offen offset:0  lds
 v_mfma_f32_16x16x32_bf16 v[8:11], v[196:199], v[208:211], v[8:11]
 ds_read_b128 v[44:47], v235 offset:57600
 v_mfma_f32_16x16x32_bf16 v[12:15], v[200:203], v[208:211], v[12:15]
 ds_read_b64_tr_b16 v[34:35], v234 offset:17408
 buffer_load_dwordx4 v239, s[40:43], s65 offen offset:1024  lds
 v_mfma_f32_16x16x32_bf16 v[16:19], v[196:199], v[212:215], v[16:19]
 ds_read_b128 v[48:51], v235 offset:59392
 v_mfma_f32_16x16x32_bf16 v[20:23], v[200:203], v[212:215], v[20:23]
 ds_read_b64_tr_b16 v[36:37], v191 offset:16384
 buffer_load_dwordx4 v240, s[40:43], s65 offen offset:2048  lds
 v_mfma_f32_16x16x32_bf16 v[24:27], v[196:199], v[216:219], v[24:27]
 ds_read_b128 v[52:55], v235 offset:59648
 v_mfma_f32_16x16x32_bf16 v[28:31], v[200:203], v[216:219], v[28:31]
 ds_read_b64_tr_b16 v[38:39], v191 offset:17408
 buffer_load_dwordx4 v241, s[40:43], s65 offen offset:3072  lds
 s_waitcnt lgkmcnt(8)
 v_mfma_f32_16x16x32_bf16 v[0:3], v[152:155], v[160:163], v[0:3]
 ds_read_b128 v[204:207], v235 offset:61440
 v_mfma_f32_16x16x32_bf16 v[4:7], v[156:159], v[160:163], v[4:7]
 ds_read_b64_tr_b16 v[196:197], v234 offset:24576
 s_add_u32 m0, s68, 40960
 s_nop 0
 buffer_load_dwordx4 v242, s[44:47], s17 offen offset:0 sc1 lds
 v_mfma_f32_16x16x32_bf16 v[8:11], v[152:155], v[164:167], v[8:11]
 ds_read_b128 v[208:211], v235 offset:61696
 v_mfma_f32_16x16x32_bf16 v[12:15], v[156:159], v[164:167], v[12:15]
 ds_read_b64_tr_b16 v[198:199], v234 offset:25600
 v_mfma_f32_16x16x32_bf16 v[16:19], v[152:155], v[168:171], v[16:19]
 ds_read_b128 v[212:215], v235 offset:63488
 v_mfma_f32_16x16x32_bf16 v[20:23], v[156:159], v[168:171], v[20:23]
 ds_read_b64_tr_b16 v[200:201], v191 offset:24576
 buffer_load_dwordx4 v242, s[44:47], s17 offen offset:1024 sc1 lds
 v_mfma_f32_16x16x32_bf16 v[24:27], v[152:155], v[172:175], v[24:27]
 ds_read_b128 v[216:219], v235 offset:63744
 v_mfma_f32_16x16x32_bf16 v[28:31], v[156:159], v[172:175], v[28:31]
 ds_read_b64_tr_b16 v[202:203], v191 offset:25600
 s_waitcnt lgkmcnt(8)
 v_mfma_f32_16x16x32_bf16 v[0:3], v[32:35], v[40:43], v[0:3]
 s_waitcnt vmcnt(18)
 s_barrier
 ds_read_b128 v[160:163], v235 offset:0
 v_mfma_f32_16x16x32_bf16 v[4:7], v[36:39], v[40:43], v[4:7]
 ds_read_b64_tr_b16 v[152:153], v233 offset:32768
 s_add_u32 m0, s67, 16384
 s_lshl4_add_u32 s65, s29, s69
 buffer_load_dwordx4 v238, s[40:43], s65 offen offset:0  lds
 v_mfma_f32_16x16x32_bf16 v[8:11], v[32:35], v[44:47], v[8:11]
 ds_read_b128 v[164:167], v235 offset:256
 v_mfma_f32_16x16x32_bf16 v[12:15], v[36:39], v[44:47], v[12:15]
 ds_read_b64_tr_b16 v[154:155], v233 offset:33792
 buffer_load_dwordx4 v239, s[40:43], s65 offen offset:1024  lds
 v_mfma_f32_16x16x32_bf16 v[16:19], v[32:35], v[48:51], v[16:19]
 ds_read_b128 v[168:171], v235 offset:2048
 v_mfma_f32_16x16x32_bf16 v[20:23], v[36:39], v[48:51], v[20:23]
 ds_read_b64_tr_b16 v[156:157], v190 offset:32768
 buffer_load_dwordx4 v240, s[40:43], s65 offen offset:2048  lds
 v_mfma_f32_16x16x32_bf16 v[24:27], v[32:35], v[52:55], v[24:27]
 ds_read_b128 v[172:175], v235 offset:2304
 v_mfma_f32_16x16x32_bf16 v[28:31], v[36:39], v[52:55], v[28:31]
 ds_read_b64_tr_b16 v[158:159], v190 offset:33792
 buffer_load_dwordx4 v241, s[40:43], s65 offen offset:3072  lds
 s_waitcnt lgkmcnt(8)
 v_mfma_f32_16x16x32_bf16 v[0:3], v[196:199], v[204:207], v[0:3]
 ds_read_b128 v[40:43], v235 offset:4096
 v_mfma_f32_16x16x32_bf16 v[4:7], v[200:203], v[204:207], v[4:7]
 ds_read_b64_tr_b16 v[32:33], v233 offset:40960
 v_mfma_f32_16x16x32_bf16 v[8:11], v[196:199], v[208:211], v[8:11]
 ds_read_b128 v[44:47], v235 offset:4352
 v_mfma_f32_16x16x32_bf16 v[12:15], v[200:203], v[208:211], v[12:15]
 ds_read_b64_tr_b16 v[34:35], v233 offset:41984
 v_mfma_f32_16x16x32_bf16 v[16:19], v[196:199], v[212:215], v[16:19]
 ds_read_b128 v[48:51], v235 offset:6144
 v_mfma_f32_16x16x32_bf16 v[20:23], v[200:203], v[212:215], v[20:23]
 ds_read_b64_tr_b16 v[36:37], v190 offset:40960
 v_mfma_f32_16x16x32_bf16 v[24:27], v[196:199], v[216:219], v[24:27]
 ds_read_b128 v[52:55], v235 offset:6400
 v_mfma_f32_16x16x32_bf16 v[28:31], v[200:203], v[216:219], v[28:31]
 ds_read_b64_tr_b16 v[38:39], v190 offset:41984
 s_waitcnt lgkmcnt(8)
 v_mfma_f32_16x16x32_bf16 v[0:3], v[152:155], v[160:163], v[0:3]
 s_waitcnt vmcnt(16)
 s_barrier
 ds_read_b128 v[204:207], v235 offset:8192
 v_mfma_f32_16x16x32_bf16 v[4:7], v[156:159], v[160:163], v[4:7]
 ds_read_b64_tr_b16 v[196:197], v234 offset:0
 s_add_u32 m0, s67, 65536
 s_lshl4_add_u32 s65, s35, s69
 buffer_load_dwordx4 v238, s[40:43], s65 offen offset:0  lds
 v_mfma_f32_16x16x32_bf16 v[8:11], v[152:155], v[164:167], v[8:11]
 ds_read_b128 v[208:211], v235 offset:8448
 v_mfma_f32_16x16x32_bf16 v[12:15], v[156:159], v[164:167], v[12:15]
 ds_read_b64_tr_b16 v[198:199], v234 offset:1024
 buffer_load_dwordx4 v239, s[40:43], s65 offen offset:1024  lds
 v_mfma_f32_16x16x32_bf16 v[16:19], v[152:155], v[168:171], v[16:19]
 ds_read_b128 v[212:215], v235 offset:10240
 v_mfma_f32_16x16x32_bf16 v[20:23], v[156:159], v[168:171], v[20:23]
 ds_read_b64_tr_b16 v[200:201], v191 offset:0
 buffer_load_dwordx4 v240, s[40:43], s65 offen offset:2048  lds
 v_mfma_f32_16x16x32_bf16 v[24:27], v[152:155], v[172:175], v[24:27]
 ds_read_b128 v[216:219], v235 offset:10496
 v_mfma_f32_16x16x32_bf16 v[28:31], v[156:159], v[172:175], v[28:31]
 ds_read_b64_tr_b16 v[202:203], v191 offset:1024
 buffer_load_dwordx4 v241, s[40:43], s65 offen offset:3072  lds
 s_waitcnt lgkmcnt(8)
 v_mfma_f32_16x16x32_bf16 v[0:3], v[32:35], v[40:43], v[0:3]
 ds_read_b128 v[160:163], v235 offset:12288
 v_mfma_f32_16x16x32_bf16 v[4:7], v[36:39], v[40:43], v[4:7]
 ds_read_b64_tr_b16 v[152:153], v234 offset:8192
 v_mfma_f32_16x16x32_bf16 v[8:11], v[32:35], v[44:47], v[8:11]
 ds_read_b128 v[164:167], v235 offset:12544
 v_mfma_f32_16x16x32_bf16 v[12:15], v[36:39], v[44:47], v[12:15]
 ds_read_b64_tr_b16 v[154:155], v234 offset:9216
 v_mfma_f32_16x16x32_bf16 v[16:19], v[32:35], v[48:51], v[16:19]
 ds_read_b128 v[168:171], v235 offset:14336
 v_mfma_f32_16x16x32_bf16 v[20:23], v[36:39], v[48:51], v[20:23]
 ds_read_b64_tr_b16 v[156:157], v191 offset:8192
 v_mfma_f32_16x16x32_bf16 v[24:27], v[32:35], v[52:55], v[24:27]
 ds_read_b128 v[172:175], v235 offset:14592
 v_mfma_f32_16x16x32_bf16 v[28:31], v[36:39], v[52:55], v[28:31]
 ds_read_b64_tr_b16 v[158:159], v191 offset:9216
 s_waitcnt lgkmcnt(8)
 v_mfma_f32_16x16x32_bf16 v[0:3], v[196:199], v[204:207], v[0:3]
 s_waitcnt vmcnt(10)
 s_barrier
 ds_read_b128 v[40:43], v235 offset:16384
 v_mfma_f32_16x16x32_bf16 v[4:7], v[200:203], v[204:207], v[4:7]
 ds_read_b64_tr_b16 v[32:33], v233 offset:0
 s_add_u32 m0, s67, 32768
 s_lshl4_add_u32 s65, s17, s69
 buffer_load_dwordx4 v238, s[40:43], s65 offen offset:0  lds
 v_mfma_f32_16x16x32_bf16 v[8:11], v[196:199], v[208:211], v[8:11]
 ds_read_b128 v[44:47], v235 offset:16640
 v_mfma_f32_16x16x32_bf16 v[12:15], v[200:203], v[208:211], v[12:15]
 ds_read_b64_tr_b16 v[34:35], v233 offset:1024
 buffer_load_dwordx4 v239, s[40:43], s65 offen offset:1024  lds
 v_mfma_f32_16x16x32_bf16 v[16:19], v[196:199], v[212:215], v[16:19]
 ds_read_b128 v[48:51], v235 offset:18432
 v_mfma_f32_16x16x32_bf16 v[20:23], v[200:203], v[212:215], v[20:23]
 ds_read_b64_tr_b16 v[36:37], v190 offset:0
 buffer_load_dwordx4 v240, s[40:43], s65 offen offset:2048  lds
 v_mfma_f32_16x16x32_bf16 v[24:27], v[196:199], v[216:219], v[24:27]
 ds_read_b128 v[52:55], v235 offset:18688
 v_mfma_f32_16x16x32_bf16 v[28:31], v[200:203], v[216:219], v[28:31]
 ds_read_b64_tr_b16 v[38:39], v190 offset:1024
 buffer_load_dwordx4 v241, s[40:43], s65 offen offset:3072  lds
 s_waitcnt lgkmcnt(8)
 v_mfma_f32_16x16x32_bf16 v[0:3], v[152:155], v[160:163], v[0:3]
 ds_read_b128 v[204:207], v235 offset:20480
 v_mfma_f32_16x16x32_bf16 v[4:7], v[156:159], v[160:163], v[4:7]
 ds_read_b64_tr_b16 v[196:197], v233 offset:8192
 v_mfma_f32_16x16x32_bf16 v[8:11], v[152:155], v[164:167], v[8:11]
 ds_read_b128 v[208:211], v235 offset:20736
 v_mfma_f32_16x16x32_bf16 v[12:15], v[156:159], v[164:167], v[12:15]
 ds_read_b64_tr_b16 v[198:199], v233 offset:9216
 v_mfma_f32_16x16x32_bf16 v[16:19], v[152:155], v[168:171], v[16:19]
 ds_read_b128 v[212:215], v235 offset:22528
 v_mfma_f32_16x16x32_bf16 v[20:23], v[156:159], v[168:171], v[20:23]
 ds_read_b64_tr_b16 v[200:201], v190 offset:8192
 v_mfma_f32_16x16x32_bf16 v[24:27], v[152:155], v[172:175], v[24:27]
 ds_read_b128 v[216:219], v235 offset:22784
 v_mfma_f32_16x16x32_bf16 v[28:31], v[156:159], v[172:175], v[28:31]
 ds_read_b64_tr_b16 v[202:203], v190 offset:9216
 s_waitcnt lgkmcnt(8)
 v_mfma_f32_16x16x32_bf16 v[0:3], v[32:35], v[40:43], v[0:3]
 s_waitcnt vmcnt(8)
 s_barrier
 ds_read_b128 v[160:163], v235 offset:24576
 v_mfma_f32_16x16x32_bf16 v[4:7], v[36:39], v[40:43], v[4:7]
 ds_read_b64_tr_b16 v[152:153], v233 offset:16384
 v_mfma_f32_16x16x32_bf16 v[8:11], v[32:35], v[44:47], v[8:11]
 ds_read_b128 v[164:167], v235 offset:24832
 v_mfma_f32_16x16x32_bf16 v[12:15], v[36:39], v[44:47], v[12:15]
 ds_read_b64_tr_b16 v[154:155], v233 offset:17408
 v_mfma_f32_16x16x32_bf16 v[16:19], v[32:35], v[48:51], v[16:19]
 ds_read_b128 v[168:171], v235 offset:26624
 v_mfma_f32_16x16x32_bf16 v[20:23], v[36:39], v[48:51], v[20:23]
 ds_read_b64_tr_b16 v[156:157], v190 offset:16384
 v_mfma_f32_16x16x32_bf16 v[24:27], v[32:35], v[52:55], v[24:27]
 ds_read_b128 v[172:175], v235 offset:26880
 v_mfma_f32_16x16x32_bf16 v[28:31], v[36:39], v[52:55], v[28:31]
 ds_read_b64_tr_b16 v[158:159], v190 offset:17408
 s_waitcnt lgkmcnt(8)
 v_mfma_f32_16x16x32_bf16 v[0:3], v[196:199], v[204:207], v[0:3]
 ds_read_b128 v[40:43], v235 offset:28672
 v_mfma_f32_16x16x32_bf16 v[4:7], v[200:203], v[204:207], v[4:7]
 ds_read_b64_tr_b16 v[32:33], v233 offset:24576
 v_mfma_f32_16x16x32_bf16 v[8:11], v[196:199], v[208:211], v[8:11]
 ds_read_b128 v[44:47], v235 offset:28928
 v_mfma_f32_16x16x32_bf16 v[12:15], v[200:203], v[208:211], v[12:15]
 ds_read_b64_tr_b16 v[34:35], v233 offset:25600
 v_mfma_f32_16x16x32_bf16 v[16:19], v[196:199], v[212:215], v[16:19]
 ds_read_b128 v[48:51], v235 offset:30720
 v_mfma_f32_16x16x32_bf16 v[20:23], v[200:203], v[212:215], v[20:23]
 ds_read_b64_tr_b16 v[36:37], v190 offset:24576
 v_mfma_f32_16x16x32_bf16 v[24:27], v[196:199], v[216:219], v[24:27]
 ds_read_b128 v[52:55], v235 offset:30976
 v_mfma_f32_16x16x32_bf16 v[28:31], v[200:203], v[216:219], v[28:31]
 ds_read_b64_tr_b16 v[38:39], v190 offset:25600
 s_waitcnt lgkmcnt(8)
 v_mfma_f32_16x16x32_bf16 v[0:3], v[152:155], v[160:163], v[0:3]
 s_waitcnt vmcnt(4)
 s_barrier
 ds_read_b128 v[204:207], v235 offset:32768
 v_mfma_f32_16x16x32_bf16 v[4:7], v[156:159], v[160:163], v[4:7]
 ds_read_b64_tr_b16 v[196:197], v234 offset:16384
 buffer_store_dwordx4 v[104:107], v121, s[48:51], s75 offen nt
 v_mfma_f32_16x16x32_bf16 v[8:11], v[152:155], v[164:167], v[8:11]
 ds_read_b128 v[208:211], v235 offset:33024
 v_mfma_f32_16x16x32_bf16 v[12:15], v[156:159], v[164:167], v[12:15]
 ds_read_b64_tr_b16 v[198:199], v234 offset:17408
 v_mfma_f32_16x16x32_bf16 v[16:19], v[152:155], v[168:171], v[16:19]
 ds_read_b128 v[212:215], v235 offset:34816
 v_mfma_f32_16x16x32_bf16 v[20:23], v[156:159], v[168:171], v[20:23]
 ds_read_b64_tr_b16 v[200:201], v191 offset:16384
 v_mfma_f32_16x16x32_bf16 v[24:27], v[152:155], v[172:175], v[24:27]
 ds_read_b128 v[216:219], v235 offset:35072
 v_mfma_f32_16x16x32_bf16 v[28:31], v[156:159], v[172:175], v[28:31]
 ds_read_b64_tr_b16 v[202:203], v191 offset:17408
 s_waitcnt lgkmcnt(8)
 v_mfma_f32_16x16x32_bf16 v[0:3], v[32:35], v[40:43], v[0:3]
 ds_read_b128 v[160:163], v235 offset:36864
 v_mfma_f32_16x16x32_bf16 v[4:7], v[36:39], v[40:43], v[4:7]
 ds_read_b64_tr_b16 v[152:153], v234 offset:24576
 buffer_store_dwordx4 v[108:111], v121, s[48:51], s75 offen offset:512 nt
 v_mfma_f32_16x16x32_bf16 v[8:11], v[32:35], v[44:47], v[8:11]
 ds_read_b128 v[164:167], v235 offset:37120
 v_mfma_f32_16x16x32_bf16 v[12:15], v[36:39], v[44:47], v[12:15]
 ds_read_b64_tr_b16 v[154:155], v234 offset:25600
 v_mfma_f32_16x16x32_bf16 v[16:19], v[32:35], v[48:51], v[16:19]
 ds_read_b128 v[168:171], v235 offset:38912
 v_mfma_f32_16x16x32_bf16 v[20:23], v[36:39], v[48:51], v[20:23]
 ds_read_b64_tr_b16 v[156:157], v191 offset:24576
 v_mfma_f32_16x16x32_bf16 v[24:27], v[32:35], v[52:55], v[24:27]
 ds_read_b128 v[172:175], v235 offset:39168
 v_mfma_f32_16x16x32_bf16 v[28:31], v[36:39], v[52:55], v[28:31]
 ds_read_b64_tr_b16 v[158:159], v191 offset:25600
 s_waitcnt lgkmcnt(8)
 v_mfma_f32_16x16x32_bf16 v[0:3], v[196:199], v[204:207], v[0:3]
 s_waitcnt vmcnt(2)
 s_barrier
 ds_read_b128 v[40:43], v235 offset:40960
 v_mfma_f32_16x16x32_bf16 v[4:7], v[200:203], v[204:207], v[4:7]
 ds_read_b64_tr_b16 v[32:33], v233 offset:32768
 buffer_store_dwordx4 v[112:115], v122, s[48:51], s86 offen offset:512 nt
 v_mfma_f32_16x16x32_bf16 v[8:11], v[196:199], v[208:211], v[8:11]
 ds_read_b128 v[44:47], v235 offset:41216
 v_mfma_f32_16x16x32_bf16 v[12:15], v[200:203], v[208:211], v[12:15]
 ds_read_b64_tr_b16 v[34:35], v233 offset:33792
 v_mfma_f32_16x16x32_bf16 v[16:19], v[196:199], v[212:215], v[16:19]
 ds_read_b128 v[48:51], v235 offset:43008
 v_mfma_f32_16x16x32_bf16 v[20:23], v[200:203], v[212:215], v[20:23]
 ds_read_b64_tr_b16 v[36:37], v190 offset:32768
 v_mfma_f32_16x16x32_bf16 v[24:27], v[196:199], v[216:219], v[24:27]
 ds_read_b128 v[52:55], v235 offset:43264
 v_mfma_f32_16x16x32_bf16 v[28:31], v[200:203], v[216:219], v[28:31]
 ds_read_b64_tr_b16 v[38:39], v190 offset:33792
 s_waitcnt lgkmcnt(8)
 v_mfma_f32_16x16x32_bf16 v[0:3], v[152:155], v[160:163], v[0:3]
 ds_read_b128 v[204:207], v235 offset:45056
 v_mfma_f32_16x16x32_bf16 v[4:7], v[156:159], v[160:163], v[4:7]
 ds_read_b64_tr_b16 v[196:197], v233 offset:40960
 buffer_store_dwordx4 v[116:119], v122, s[48:51], s86 offen nt
 v_mfma_f32_16x16x32_bf16 v[8:11], v[152:155], v[164:167], v[8:11]
 ds_read_b128 v[208:211], v235 offset:45312
 v_mfma_f32_16x16x32_bf16 v[12:15], v[156:159], v[164:167], v[12:15]
 ds_read_b64_tr_b16 v[198:199], v233 offset:41984
 v_mfma_f32_16x16x32_bf16 v[16:19], v[152:155], v[168:171], v[16:19]
 ds_read_b128 v[212:215], v235 offset:47104
 v_mfma_f32_16x16x32_bf16 v[20:23], v[156:159], v[168:171], v[20:23]
 ds_read_b64_tr_b16 v[200:201], v190 offset:40960
 v_mfma_f32_16x16x32_bf16 v[24:27], v[152:155], v[172:175], v[24:27]
 ds_read_b128 v[216:219], v235 offset:47360
 v_mfma_f32_16x16x32_bf16 v[28:31], v[156:159], v[172:175], v[28:31]
 ds_read_b64_tr_b16 v[202:203], v190 offset:41984
 s_waitcnt lgkmcnt(8)
 v_mfma_f32_16x16x32_bf16 v[0:3], v[32:35], v[40:43], v[0:3]
 v_mfma_f32_16x16x32_bf16 v[4:7], v[36:39], v[40:43], v[4:7]
 v_mfma_f32_16x16x32_bf16 v[8:11], v[32:35], v[44:47], v[8:11]
 v_mfma_f32_16x16x32_bf16 v[12:15], v[36:39], v[44:47], v[12:15]
 v_mfma_f32_16x16x32_bf16 v[16:19], v[32:35], v[48:51], v[16:19]
 v_mfma_f32_16x16x32_bf16 v[20:23], v[36:39], v[48:51], v[20:23]
 v_mfma_f32_16x16x32_bf16 v[24:27], v[32:35], v[52:55], v[24:27]
 v_mfma_f32_16x16x32_bf16 v[28:31], v[36:39], v[52:55], v[28:31]
 s_waitcnt lgkmcnt(0)
 v_mfma_f32_16x16x32_bf16 v[0:3], v[196:199], v[204:207], v[0:3]
 v_mfma_f32_16x16x32_bf16 v[4:7], v[200:203], v[204:207], v[4:7]
 v_mfma_f32_16x16x32_bf16 v[8:11], v[196:199], v[208:211], v[8:11]
 v_mfma_f32_16x16x32_bf16 v[12:15], v[200:203], v[208:211], v[12:15]
 v_mfma_f32_16x16x32_bf16 v[16:19], v[196:199], v[212:215], v[16:19]
 v_mfma_f32_16x16x32_bf16 v[20:23], v[200:203], v[212:215], v[20:23]
 v_mfma_f32_16x16x32_bf16 v[24:27], v[196:199], v[216:219], v[24:27]
 v_mfma_f32_16x16x32_bf16 v[28:31], v[200:203], v[216:219], v[28:31]
 s_nop 1
 v_cvt_pk_bf16_f32 v64, v0, v1
 v_cvt_pk_bf16_f32 v65, v2, v3
 v_cvt_pk_bf16_f32 v66, v4, v5
 v_cvt_pk_bf16_f32 v67, v6, v7
 v_cvt_pk_bf16_f32 v68, v8, v9
 v_cvt_pk_bf16_f32 v69, v10, v11
 v_cvt_pk_bf16_f32 v70, v12, v13
 v_cvt_pk_bf16_f32 v71, v14, v15
 v_permlane16_swap_b32 v64, v66
 v_permlane16_swap_b32 v65, v67
 ds_write_b128 v57, v[64:67] offset:0
 v_cvt_pk_bf16_f32 v72, v16, v17
 v_cvt_pk_bf16_f32 v73, v18, v19
 v_cvt_pk_bf16_f32 v74, v20, v21
 v_cvt_pk_bf16_f32 v75, v22, v23
 v_permlane16_swap_b32 v68, v70
 v_permlane16_swap_b32 v69, v71
 ds_write_b128 v57, v[68:71] offset:4096
 v_cvt_pk_bf16_f32 v76, v24, v25
 v_cvt_pk_bf16_f32 v77, v26, v27
 v_cvt_pk_bf16_f32 v78, v28, v29
 v_cvt_pk_bf16_f32 v79, v30, v31
 v_permlane16_swap_b32 v72, v74
 v_permlane16_swap_b32 v73, v75
 ds_write_b128 v57, v[72:75] offset:8192
 s_nop 0
 v_permlane16_swap_b32 v76, v78
 v_permlane16_swap_b32 v77, v79
 ds_write_b128 v57, v[76:79] offset:12288
 s_waitcnt lgkmcnt(0)
 s_barrier
 ds_read_b128 v[80:83], v59 offset:0
 ds_read_b128 v[84:87], v60 offset:1024
 ds_read_b128 v[88:91], v59 offset:2048
 ds_read_b128 v[92:95], v60 offset:3072
 s_waitcnt lgkmcnt(3)
 buffer_store_dwordx4 v[80:83], v58, s[48:51], s80 offen nt
 s_waitcnt lgkmcnt(2)
 buffer_store_dwordx4 v[84:87], v58, s[48:51], s81 offen nt
 s_waitcnt lgkmcnt(1)
 buffer_store_dwordx4 v[88:91], v58, s[48:51], s82 offen nt
 s_waitcnt lgkmcnt(0)
 buffer_store_dwordx4 v[92:95], v58, s[48:51], s83 offen nt
Lend:
 s_endpgm
Lkvflag:
 s_waitcnt vmcnt(16)
 v_mov_b32 v56, s64
 buffer_store_dword v56, v237, s[44:47], s97 offen sc1
 s_branch Lkvflag_b
Lretry_1:
 s_mov_b32 s100, 1048576
Lretry_1_l:
 buffer_load_dwordx4 v[56:59], v230, s[44:47], s85 offen sc1
 s_waitcnt vmcnt(0)
 v_cmp_ne_u32 vcc, s64, v56
 v_cmp_ne_u32 s[10:11], s64, v57
 s_or_b64 vcc, vcc, s[10:11]
 v_cmp_ne_u32 s[10:11], s64, v58
 s_or_b64 vcc, vcc, s[10:11]
 v_cmp_ne_u32 s[10:11], s64, v59
 s_or_b64 vcc, vcc, s[10:11]
 s_cmp_eq_u64 vcc, 0
 s_cbranch_scc1 Lback_2
 s_sub_u32 s100, s100, 1
 s_cbranch_scc0 Lretry_1_l
 v_mov_b32 v246, 2
 v_mov_b32 v247, 0
 global_store_dword v247, v246, s[26:27] offset:60
 s_branch Lback_2
Lepoch:
 s_mov_b32 s80, 262144
 v_mov_b32 v56, s64
 buffer_store_dword v56, v237, s[44:47], s80 offen sc1
 s_branch Lepoch_b
Lretry_3:
 s_mov_b32 s100, 1048576
Lretry_3_l:
 buffer_load_dword v244, v245, s[44:47], s78 offen sc1
 s_waitcnt vmcnt(0)
 v_cmp_ne_u32 vcc, s64, v244
 s_cmp_eq_u64 vcc, 0
 s_cbranch_scc1 Lback_4
 s_sub_u32 s100, s100, 1
 s_cbranch_scc0 Lretry_3_l
 v_mov_b32 v246, 4
 v_mov_b32 v247, 0
 global_store_dword v247, v246, s[26:27] offset:60
 s_branch Lback_4
Lretry_5:
 s_mov_b32 s100, 1048576
Lretry_5_l:
 buffer_load_dword v244, v245, s[44:47], s89 offen sc1
 s_waitcnt vmcnt(0)
 v_cmp_ne_u32 vcc, s64, v244
 s_cmp_eq_u64 vcc, 0
 s_cbranch_scc1 Lback_6
 s_sub_u32 s100, s100, 1
 s_cbranch_scc0 Lretry_5_l
 v_mov_b32 v246, 6
 v_mov_b32 v247, 0
 global_store_dword v247, v246, s[26:27] offset:60
 s_branch Lback_6
Lqi:
 buffer_load_dword v244, v7, s[44:47], s95 offen sc1
 s_branch Lqi_b
Lp3_real:
 s_waitcnt lgkmcnt(0)
 v_mov_b64 v[40:41], 0
 v_mov_b64 v[42:43], 0
 v_mov_b64 v[44:45], 0
 v_mov_b64 v[46:47], 0
 v_xor_b32 v228, 16, v228
 s_branch Lp3_mm
Lp3_again:
 buffer_store_dwordx4 v[104:107], v121, s[48:51], s75 offen nt
 buffer_store_dwordx4 v[108:111], v121, s[48:51], s75 offen offset:512 nt
 buffer_store_dwordx4 v[112:115], v122, s[48:51], s86 offen offset:512 nt
 buffer_store_dwordx4 v[116:119], v122, s[48:51], s86 offen nt
 s_mov_b32 s75, 4194304
 s_mov_b32 s86, 4194304
 ds_read_b64_tr_b16 v[32:33], v228 offset:0
 ds_read_b64_tr_b16 v[34:35], v228 offset:512
 ds_read_b64_tr_b16 v[36:37], v228 offset:2048
 ds_read_b64_tr_b16 v[38:39], v228 offset:2560
 ds_read_b64_tr_b16 v[40:41], v229 offset:0
 ds_read_b64_tr_b16 v[42:43], v229 offset:512
 ds_read_b64_tr_b16 v[44:45], v229 offset:2048
 ds_read_b64_tr_b16 v[46:47], v229 offset:2560
 s_waitcnt lgkmcnt(0)
 v_mov_b64 v[40:41], 0
 v_mov_b64 v[42:43], 0
 v_mov_b64 v[44:45], 0
 v_mov_b64 v[46:47], 0
 s_nop 1
 v_mfma_f32_32x32x16_bf16 v[48:63], v[32:35], a[80:83], 0
 v_mfma_f32_32x32x16_bf16 v[64:79], v[32:35], a[96:99], 0
 v_mfma_f32_32x32x16_bf16 v[48:63], v[36:39], a[84:87], v[48:63]
 v_mfma_f32_32x32x16_bf16 v[64:79], v[36:39], a[100:103], v[64:79]
 v_mfma_f32_32x32x16_bf16 v[48:63], v[40:43], a[88:91], v[48:63]
 v_mfma_f32_32x32x16_bf16 v[64:79], v[40:43], a[80:83], v[64:79]
 v_mfma_f32_32x32x16_bf16 v[48:63], v[44:47], a[92:95], v[48:63]
 v_mfma_f32_32x32x16_bf16 v[64:79], v[44:47], a[84:87], v[64:79]
 s_nop 11
 v_pk_mul_f32 v[96:97], v[48:49], v[128:129]
 v_pk_mul_f32 v[98:99], v[64:65], v[128:129]
 v_pk_fma_f32 v[96:97], v[64:65], v[144:145], v[96:97]
 v_pk_fma_f32 v[98:99], v[48:49], v[144:145], v[98:99] neg_lo:[0,1,0] neg_hi:[0,1,0]
 v_cvt_pk_bf16_f32 v80, v96, v97
 v_cvt_pk_bf16_f32 v88, v98, v99
 v_pk_mul_f32 v[96:97], v[50:51], v[130:131]
 v_pk_mul_f32 v[98:99], v[66:67], v[130:131]
 v_pk_fma_f32 v[96:97], v[66:67], v[146:147], v[96:97]
 v_pk_fma_f32 v[98:99], v[50:51], v[146:147], v[98:99] neg_lo:[0,1,0] neg_hi:[0,1,0]
 v_cvt_pk_bf16_f32 v81, v96, v97
 v_cvt_pk_bf16_f32 v89, v98, v99
 v_pk_mul_f32 v[96:97], v[52:53], v[132:133]
 v_pk_mul_f32 v[98:99], v[68:69], v[132:133]
 v_pk_fma_f32 v[96:97], v[68:69], v[148:149], v[96:97]
 v_pk_fma_f32 v[98:99], v[52:53], v[148:149], v[98:99] neg_lo:[0,1,0] neg_hi:[0,1,0]
 v_cvt_pk_bf16_f32 v82, v96, v97
 v_cvt_pk_bf16_f32 v90, v98, v99
 v_pk_mul_f32 v[96:97], v[54:55], v[134:135]
 v_pk_mul_f32 v[98:99], v[70:71], v[134:135]
 v_pk_fma_f32 v[96:97], v[70:71], v[150:151], v[96:97]
 v_pk_fma_f32 v[98:99], v[54:55], v[150:151], v[98:99] neg_lo:[0,1,0] neg_hi:[0,1,0]
 v_cvt_pk_bf16_f32 v83, v96, v97
 v_cvt_pk_bf16_f32 v91, v98, v99
 v_pk_mul_f32 v[96:97], v[56:57], v[136:137]
 v_pk_mul_f32 v[98:99], v[72:73], v[136:137]
 v_pk_fma_f32 v[96:97], v[72:73], v[152:153], v[96:97]
 v_pk_fma_f32 v[98:99], v[56:57], v[152:153], v[98:99] neg_lo:[0,1,0] neg_hi:[0,1,0]
 v_cvt_pk_bf16_f32 v84, v96, v97
 v_cvt_pk_bf16_f32 v92, v98, v99
 v_pk_mul_f32 v[96:97], v[58:59], v[138:139]
 v_pk_mul_f32 v[98:99], v[74:75], v[138:139]
 v_pk_fma_f32 v[96:97], v[74:75], v[154:155], v[96:97]
 v_pk_fma_f32 v[98:99], v[58:59], v[154:155], v[98:99] neg_lo:[0,1,0] neg_hi:[0,1,0]
 v_cvt_pk_bf16_f32 v85, v96, v97
 v_cvt_pk_bf16_f32 v93, v98, v99
 v_pk_mul_f32 v[96:97], v[60:61], v[140:141]
 v_pk_mul_f32 v[98:99], v[76:77], v[140:141]
 v_pk_fma_f32 v[96:97], v[76:77], v[156:157], v[96:97]
 v_pk_fma_f32 v[98:99], v[60:61], v[156:157], v[98:99] neg_lo:[0,1,0] neg_hi:[0,1,0]
 v_cvt_pk_bf16_f32 v86, v96, v97
 v_cvt_pk_bf16_f32 v94, v98, v99
 v_pk_mul_f32 v[96:97], v[62:63], v[142:143]
 v_pk_mul_f32 v[98:99], v[78:79], v[142:143]
 v_pk_fma_f32 v[96:97], v[78:79], v[158:159], v[96:97]
 v_pk_fma_f32 v[98:99], v[62:63], v[158:159], v[98:99] neg_lo:[0,1,0] neg_hi:[0,1,0]
 v_cvt_pk_bf16_f32 v87, v96, v97
 v_cvt_pk_bf16_f32 v95, v98, v99
 s_nop 0
 v_mfma_f32_32x32x16_bf16 v[48:63], v[80:83], a[80:83], 0
 v_mfma_f32_32x32x16_bf16 v[48:63], v[84:87], a[84:87], v[48:63]
 v_mfma_f32_32x32x16_bf16 v[48:63], v[88:91], a[88:91], v[48:63]
 v_mfma_f32_32x32x16_bf16 v[48:63], v[92:95], a[92:95], v[48:63]
 s_nop 11
 ds_bpermute_b32 v64, v120, v48
 v_cvt_pk_bf16_f32 v104, v48, v49
 v_cvt_pk_bf16_f32 v105, v50, v51
 v_cvt_pk_bf16_f32 v106, v52, v53
 v_cvt_pk_bf16_f32 v107, v54, v55
 v_cvt_pk_bf16_f32 v108, v56, v57
 v_cvt_pk_bf16_f32 v109, v58, v59
 v_cvt_pk_bf16_f32 v110, v60, v61
 v_cvt_pk_bf16_f32 v111, v62, v63
 v_cvt_pk_bf16_f32 v113, v62, v61
 v_cvt_pk_bf16_f32 v114, v60, v59
 v_cvt_pk_bf16_f32 v115, v58, v57
 v_cvt_pk_bf16_f32 v116, v56, v55
 v_cvt_pk_bf16_f32 v117, v54, v53
 v_cvt_pk_bf16_f32 v118, v52, v51
 v_cvt_pk_bf16_f32 v119, v50, v49
 v_permlane16_swap_b32 v104, v108
 v_permlane16_swap_b32 v105, v109
 v_permlane16_swap_b32 v106, v110
 v_permlane16_swap_b32 v107, v111
 s_waitcnt lgkmcnt(0)
 v_cvt_pk_bf16_f32 v112, v64, v63
 s_nop 1
 v_permlane16_swap_b32 v112, v116
 v_permlane16_swap_b32 v113, v117
 v_permlane16_swap_b32 v114, v118
 v_permlane16_swap_b32 v115, v119
 s_branch Lp3_end
Lretry_7:
 s_mov_b32 s100, 1048576
Lretry_7_l:
 buffer_load_dword v244, v7, s[44:47], s95 offen sc1
 s_waitcnt vmcnt(0)
 v_cmp_ne_u32 vcc, s64, v244
 s_cmp_eq_u64 vcc, 0
 s_cbranch_scc1 Lback_8
 s_sub_u32 s100, s100, 1
 s_cbranch_scc0 Lretry_7_l
 v_mov_b32 v246, 8
 v_mov_b32 v247, 0
 global_store_dword v247, v246, s[26:27] offset:60
 s_branch Lback_8
Lfb:
 s_mov_b32 s99, 1
 v_mov_b32 v251, 0xff800000
 v_mov_b32 v252, 0xff800000
 s_mov_b32 s16, 0
Lfb1:
 buffer_load_dwordx4 v[152:155], v230, s[44:47], s16 offen sc1
 buffer_load_dwordx4 v[156:159], v230, s[44:47], s16 offen offset:1024 sc1
 s_waitcnt vmcnt(0)
 v_mfma_f32_32x32x16_bf16 v[0:15], v[152:155], v[136:139], 0
 v_mfma_f32_32x32x16_bf16 v[0:15], v[156:159], v[140:143], v[0:15]
 v_mfma_f32_32x32x16_bf16 v[16:31], v[152:155], v[144:147], 0
 v_mfma_f32_32x32x16_bf16 v[16:31], v[156:159], v[148:151], v[16:31]
 s_nop 15
 v_max3_f32 v251, v251, v0, v1
 v_max3_f32 v251, v251, v2, v3
 v_max3_f32 v251, v251, v4, v5
 v_max3_f32 v251, v251, v6, v7
 v_max3_f32 v251, v251, v8, v9
 v_max3_f32 v251, v251, v10, v11
 v_max3_f32 v251, v251, v12, v13
 v_max3_f32 v251, v251, v14, v15
 v_max3_f32 v252, v252, v16, v17
 v_max3_f32 v252, v252, v18, v19
 v_max3_f32 v252, v252, v20, v21
 v_max3_f32 v252, v252, v22, v23
 v_max3_f32 v252, v252, v24, v25
 v_max3_f32 v252, v252, v26, v27
 v_max3_f32 v252, v252, v28, v29
 v_max3_f32 v252, v252, v30, v31
 s_add_u32 s16, s16, 4096
 s_cmp_lt_u32 s16, 0x40000
 s_cbranch_scc1 Lfb1
 v_mov_b32 v253, v251
 v_mov_b32 v254, v252
 s_nop 0
 v_permlane32_swap_b32 v251, v253
 v_permlane32_swap_b32 v252, v254
 v_max_f32 v251, v251, v253
 v_max_f32 v252, v252, v254
 v_sub_f32 v104, 0, v251
 v_sub_f32 v105, 0, v251
 v_mov_b64 v[106:107], v[104:105]
 v_mov_b64 v[108:109], v[104:105]
 v_mov_b64 v[110:111], v[104:105]
 v_mov_b64 v[112:113], v[104:105]
 v_mov_b64 v[114:115], v[104:105]
 v_mov_b64 v[116:117], v[104:105]
 v_mov_b64 v[118:119], v[104:105]
 v_sub_f32 v120, 0, v252
 v_sub_f32 v121, 0, v252
 v_mov_b64 v[122:123], v[120:121]
 v_mov_b64 v[124:125], v[120:121]
 v_mov_b64 v[126:127], v[120:121]
 v_mov_b64 v[128:129], v[120:121]
 v_mov_b64 v[130:131], v[120:121]
 v_mov_b64 v[132:133], v[120:121]
 v_mov_b64 v[134:135], v[120:121]
 v_mov_b64 v[64:65], 0
 v_mov_b64 v[66:67], 0
 v_mov_b64 v[68:69], 0
 v_mov_b64 v[70:71], 0
 v_mov_b64 v[72:73], 0
 v_mov_b64 v[74:75], 0
 v_mov_b64 v[76:77], 0
 v_mov_b64 v[78:79], 0
 v_mov_b64 v[80:81], 0
 v_mov_b64 v[82:83], 0
 v_mov_b64 v[84:85], 0
 v_mov_b64 v[86:87], 0
 v_mov_b64 v[88:89], 0
 v_mov_b64 v[90:91], 0
 v_mov_b64 v[92:93], 0
 v_mov_b64 v[94:95], 0
 v_mov_b64 v[96:97], 0
 v_mov_b64 v[98:99], 0
 v_mov_b64 v[100:101], 0
 v_mov_b64 v[102:103], 0
 s_mov_b32 s16, 0
Lfb2:
 buffer_load_dwordx4 v[152:155], v230, s[44:47], s16 offen offset:0 sc1
 buffer_load_dwordx4 v[168:171], v230, s[44:47], s16 offen offset:2048 sc1
 buffer_load_dwordx4 v[156:159], v230, s[44:47], s16 offen offset:1024 sc1
 buffer_load_dwordx4 v[172:175], v230, s[44:47], s16 offen offset:3072 sc1
 s_waitcnt vmcnt(0)
 v_mfma_f32_32x32x16_bf16 v[0:15], v[152:155], v[136:139], v[104:119]
 v_mfma_f32_32x32x16_bf16 v[0:15], v[156:159], v[140:143], v[0:15]
 v_mfma_f32_32x32x16_bf16 v[16:31], v[152:155], v[144:147], v[120:135]
 v_mfma_f32_32x32x16_bf16 v[16:31], v[156:159], v[148:151], v[16:31]
 s_nop 15
 v_exp_f32 v0, v0
 v_exp_f32 v1, v1
 v_exp_f32 v2, v2
 v_exp_f32 v3, v3
 v_exp_f32 v4, v4
 v_exp_f32 v5, v5
 v_exp_f32 v6, v6
 v_exp_f32 v7, v7
 v_exp_f32 v8, v8
 v_exp_f32 v9, v9
 v_exp_f32 v10, v10
 v_exp_f32 v11, v11
 v_exp_f32 v12, v12
 v_exp_f32 v13, v13
 v_exp_f32 v14, v14
 v_exp_f32 v15, v15
 v_exp_f32 v16, v16
 v_exp_f32 v17, v17
 v_exp_f32 v18, v18
 v_exp_f32 v19, v19
 v_exp_f32 v20, v20
 v_exp_f32 v21, v21
 v_exp_f32 v22, v22
 v_exp_f32 v23, v23
 v_exp_f32 v24, v24
 v_exp_f32 v25, v25
 v_exp_f32 v26, v26
 v_exp_f32 v27, v27
 v_exp_f32 v28, v28
 v_exp_f32 v29, v29
 v_exp_f32 v30, v30
 v_exp_f32 v31, v31
 s_nop 1
 v_smfmac_f32_32x32x32_bf16 v[64:79], v[168:171], v[0:7], v188
 v_smfmac_f32_16x16x64_bf16 v[96:99], v[184:187], v[0:7], v188
 v_smfmac_f32_32x32x32_bf16 v[64:79], v[172:175], v[8:15], v188
 v_smfmac_f32_16x16x64_bf16 v[96:99], v[184:187], v[8:15], v188
 v_smfmac_f32_32x32x32_bf16 v[80:95], v[168:171], v[16:23], v188
 v_smfmac_f32_16x16x64_bf16 v[100:103], v[184:187], v[16:23], v188
 v_smfmac_f32_32x32x32_bf16 v[80:95], v[172:175], v[24:31], v188
 v_smfmac_f32_16x16x64_bf16 v[100:103], v[184:187], v[24:31], v188
 s_add_u32 s16, s16, 4096
 s_cmp_lt_u32 s16, 0x40000
 s_cbranch_scc1 Lfb2
 s_nop 15
 s_branch La_norm
Lcode_end:
.fill 256, 4, 0xbf800000
s_endpgm
.section .rodata,"a"
.p2align 6
.amdhsa_kernel concat_heads__spectral_fnet__grouped_kv_mqa__prompt_kernel
  .amdhsa_next_free_vgpr 512
  .amdhsa_next_free_sgpr 102
  .amdhsa_accum_offset 256
  .amdhsa_group_segment_fixed_size 0
  .amdhsa_kernarg_size 104
  .amdhsa_user_sgpr_count 2
  .amdhsa_user_sgpr_kernarg_segment_ptr 1
  .amdhsa_system_sgpr_workgroup_id_x 1
.end_amdhsa_kernel
.p2align 8
fn_tables:
.octa 0x3f803f803f803f803f803f803f803f80,0xbf803f80bf803f80bf803f80bf803f80,0x3f463f553f623f6d3f753f7b3f7f3f80,0xbf22bf0ebef1bec4be95be48bdc98000,0x3e483ec43f0e3f353f553f6d3f7b3f80,0xbf7bbf6dbf55bf35bf0ebec4be488000,0xbef1be483dc93ec43f223f553f753f80,0xbf62bf7bbf7fbf6dbf46bf0ebe958000
.octa 0xbf6dbf35bec400003ec43f353f6d3f80,0xbec4bf35bf6dbf80bf6dbf35bec48000,0xbf75bf7bbf46bec43dc93f0e3f623f80,0x3e95be48bf22bf6dbf7fbf55bef18000,0xbf0ebf6dbf7bbf35be483ec43f553f80,0x3f553ec4be48bf35bf7bbf6dbf0e8000,0x3dc9bf0ebf75bf6dbef13e483f463f80,0x3f7f3f553e95bec4bf62bf7bbf228000
.octa 0x3f350000bf35bf80bf3500003f353f80,0x3f353f803f358000bf35bf80bf358000,0x3f7f3f0ebe95bf6dbf62be483f223f80,0x3dc93f553f753ec4bef1bf7bbf468000,0x3f553f6d3e48bf35bf7bbec43f0e3f80,0xbf0e3ec43f7b3f35be48bf6dbf558000,0x3e953f7b3f22bec4bf7fbf0e3ef13f80,0xbf75be483f463f6d3dc9bf55bf628000
.octa 0xbec43f353f6d0000bf6dbf353ec43f80,0xbf6dbf353ec43f803ec4bf35bf6d8000,0xbf623e483f7f3ec4bf46bf553e953f80,0xbef1bf7bbdc93f6d3f22bf0ebf758000,0xbf7bbec43f553f35bf0ebf6d3e483f80,0x3e48bf6dbf0e3f353f55bec4bf7b8000,0xbf22bf553ef13f6dbe95bf7b3dc93f80,0x3f46bf0ebf623ec43f75be48bf7f8000
.octa 0x3f803f803f803f803f803f803f803f80,0xbf803f80bf803f80bf803f80bf803f80,0x3dc93e483e953ec43ef13f0e3f223f35,0xbf7fbf7bbf75bf6dbf62bf55bf46bf35,0xbf7bbf6dbf55bf35bf0ebec4be480000,0xbe48bec4bf0ebf35bf55bf6dbf7bbf80,0xbe95bf0ebf46bf6dbf7fbf7bbf62bf35,0x3f753f553f223ec43dc9be48bef1bf35
.octa 0x3f6d3f353ec40000bec4bf35bf6dbf80,0x3ec43f353f6d3f803f6d3f353ec48000,0x3ef13f553f7f3f6d3f223e48be95bf35,0xbf62bf0ebdc93ec43f463f7b3f753f35,0xbf55bec43e483f353f7b3f6d3f0e0000,0xbf0ebf6dbf7bbf35be483ec43f553f80,0xbf22bf7bbf62bec43e953f553f7f3f35,0x3f463e48bef1bf6dbf75bf0e3dc93f35
.octa 0x3f350000bf35bf80bf3500003f353f80,0x3f353f803f358000bf35bf80bf358000,0x3f463f7b3ef1bec4bf75bf55bdc93f35,0xbf223e483f623f6d3e95bf0ebf7fbf35,0xbf0e3ec43f7b3f35be48bf6dbf550000,0xbf55bf6dbe483f353f7b3ec4bf0ebf80,0xbf62bf553dc93f6d3f46be48bf75bf35,0x3ef1bf0ebf7fbec43f223f7b3e95bf35
.octa 0x3ec4bf35bf6d00003f6d3f35bec4bf80,0x3f6d3f35bec4bf80bec43f353f6d8000,0x3f753f0ebf22bf6d3dc93f7b3ef1bf35,0xbe953f553f46bec4bf7fbe483f623f35,0xbe483f6d3f0ebf35bf553ec43f7b0000,0xbf7bbec43f553f35bf0ebf6d3e483f80,0xbf7fbe483f753ec4bf62bf0e3f463f35,0x3dc9bf7bbe953f6d3ef1bf55bf223f35
.octa 0x3f803f803f803f803f803f803f803f80,0xbf803f80bf803f80bf803f80bf803f80,0xbf22bf0ebef1bec4be95be48bdc90000,0xbf46bf55bf62bf6dbf75bf7bbf7fbf80,0xbe48bec4bf0ebf35bf55bf6dbf7bbf80,0x3f7b3f6d3f553f353f0e3ec43e488000,0x3f623f7b3f7f3f6d3f463f0e3e950000,0xbef1be483dc93ec43f223f553f753f80
.octa 0xbf6dbf35bec400003ec43f353f6d3f80,0xbec4bf35bf6dbf80bf6dbf35bec48000,0x3e95be48bf22bf6dbf7fbf55bef10000,0x3f753f7b3f463ec4bdc9bf0ebf62bf80,0x3f0e3f6d3f7b3f353e48bec4bf55bf80,0xbf55bec43e483f353f7b3f6d3f0e8000,0xbf7fbf55be953ec43f623f7b3f220000,0x3dc9bf0ebf75bf6dbef13e483f463f80
.octa 0x3f350000bf35bf80bf3500003f353f80,0x3f353f803f358000bf35bf80bf358000,0x3dc93f553f753ec4bef1bf7bbf460000,0xbf7fbf0e3e953f6d3f623e48bf22bf80,0xbf55bf6dbe483f353f7b3ec4bf0ebf80,0x3f0ebec4bf7bbf353e483f6d3f558000,0x3f753e48bf46bf6dbdc93f553f620000,0x3e953f7b3f22bec4bf7fbf0e3ef13f80
.octa 0xbec43f353f6d0000bf6dbf353ec43f80,0xbf6dbf353ec43f803ec4bf35bf6d8000,0xbef1bf7bbdc93f6d3f22bf0ebf750000,0x3f62be48bf7fbec43f463f55be95bf80,0x3f7b3ec4bf55bf353f0e3f6dbe48bf80,0xbe483f6d3f0ebf35bf553ec43f7b8000,0xbf463f0e3f62bec4bf753e483f7f0000,0xbf22bf553ef13f6dbe95bf7b3dc93f80
.octa 0x3f803f803f803f803f803f803f803f80,0xbf803f80bf803f80bf803f80bf803f80,0xbf7fbf7bbf75bf6dbf62bf55bf46bf35,0xbdc9be48be95bec4bef1bf0ebf22bf35,0x3f7b3f6d3f553f353f0e3ec43e480000,0x3e483ec43f0e3f353f553f6d3f7b3f80,0xbf75bf55bf22bec4bdc93e483ef13f35,0xbe95bf0ebf46bf6dbf7fbf7bbf62bf35
.octa 0x3f6d3f353ec40000bec4bf35bf6dbf80,0x3ec43f353f6d3f803f6d3f353ec48000,0xbf62bf0ebdc93ec43f463f7b3f753f35,0xbef1bf55bf7fbf6dbf22be483e953f35,0x3f553ec4be48bf35bf7bbf6dbf0e0000,0x3f0e3f6d3f7b3f353e48bec4bf55bf80,0xbf46be483ef13f6d3f753f0ebdc9bf35,0xbf22bf7bbf62bec43e953f553f7f3f35
.octa 0x3f350000bf35bf80bf3500003f353f80,0x3f353f803f358000bf35bf80bf358000,0xbf223e483f623f6d3e95bf0ebf7fbf35,0xbf46bf7bbef13ec43f753f553dc9bf35,0x3f0ebec4bf7bbf353e483f6d3f550000,0x3f553f6d3e48bf35bf7bbec43f0e3f80,0xbef13f0e3f7f3ec4bf22bf7bbe953f35,0xbf62bf553dc93f6d3f46be48bf75bf35
.octa 0x3ec4bf35bf6d00003f6d3f35bec4bf80,0x3f6d3f35bec4bf80bec43f353f6d8000,0xbe953f553f46bec4bf7fbe483f623f35,0xbf75bf0e3f223f6dbdc9bf7bbef13f35,0x3e48bf6dbf0e3f353f55bec4bf7b0000,0x3f7b3ec4bf55bf353f0e3f6dbe48bf80,0xbdc93f7b3e95bf6dbef13f553f22bf35,0xbf7fbe483f753ec4bf62bf0e3f463f35
.octa 0x3f803f803f803f803f803f803f803f80,0xbf803f80bf803f80bf803f80bf803f80,0xbf46bf55bf62bf6dbf75bf7bbf7fbf80,0x3f223f0e3ef13ec43e953e483dc98000,0x3e483ec43f0e3f353f553f6d3f7b3f80,0xbf7bbf6dbf55bf35bf0ebec4be488000,0x3ef13e48bdc9bec4bf22bf55bf75bf80,0x3f623f7b3f7f3f6d3f463f0e3e958000
.octa 0xbf6dbf35bec400003ec43f353f6d3f80,0xbec4bf35bf6dbf80bf6dbf35bec48000,0x3f753f7b3f463ec4bdc9bf0ebf62bf80,0xbe953e483f223f6d3f7f3f553ef18000,0xbf0ebf6dbf7bbf35be483ec43f553f80,0x3f553ec4be48bf35bf7bbf6dbf0e8000,0xbdc93f0e3f753f6d3ef1be48bf46bf80,0xbf7fbf55be953ec43f623f7b3f228000
.octa 0x3f350000bf35bf80bf3500003f353f80,0x3f353f803f358000bf35bf80bf358000,0xbf7fbf0e3e953f6d3f623e48bf22bf80,0xbdc9bf55bf75bec43ef13f7b3f468000,0x3f553f6d3e48bf35bf7bbec43f0e3f80,0xbf0e3ec43f7b3f35be48bf6dbf558000,0xbe95bf7bbf223ec43f7f3f0ebef1bf80,0x3f753e48bf46bf6dbdc93f553f628000
.octa 0xbec43f353f6d0000bf6dbf353ec43f80,0xbf6dbf353ec43f803ec4bf35bf6d8000,0x3f62be48bf7fbec43f463f55be95bf80,0x3ef13f7b3dc9bf6dbf223f0e3f758000,0xbf7bbec43f553f35bf0ebf6d3e483f80,0x3e48bf6dbf0e3f353f55bec4bf7b8000,0x3f223f55bef1bf6d3e953f7bbdc9bf80,0xbf463f0e3f62bec4bf753e483f7f8000
.octa 0x3f803f803f803f803f803f803f803f80,0xbf803f80bf803f80bf803f80bf803f80,0xbdc9be48be95bec4bef1bf0ebf22bf35,0x3f7f3f7b3f753f6d3f623f553f463f35,0xbf7bbf6dbf55bf35bf0ebec4be480000,0xbe48bec4bf0ebf35bf55bf6dbf7bbf80,0x3e953f0e3f463f6d3f7f3f7b3f623f35,0xbf75bf55bf22bec4bdc93e483ef13f35
.octa 0x3f6d3f353ec40000bec4bf35bf6dbf80,0x3ec43f353f6d3f803f6d3f353ec48000,0xbef1bf55bf7fbf6dbf22be483e953f35,0x3f623f0e3dc9bec4bf46bf7bbf75bf35,0xbf55bec43e483f353f7b3f6d3f0e0000,0xbf0ebf6dbf7bbf35be483ec43f553f80,0x3f223f7b3f623ec4be95bf55bf7fbf35,0xbf46be483ef13f6d3f753f0ebdc9bf35
.octa 0x3f350000bf35bf80bf3500003f353f80,0x3f353f803f358000bf35bf80bf358000,0xbf46bf7bbef13ec43f753f553dc9bf35,0x3f22be48bf62bf6dbe953f0e3f7f3f35,0xbf0e3ec43f7b3f35be48bf6dbf550000,0xbf55bf6dbe483f353f7b3ec4bf0ebf80,0x3f623f55bdc9bf6dbf463e483f753f35,0xbef13f0e3f7f3ec4bf22bf7bbe953f35
.octa 0x3ec4bf35bf6d00003f6d3f35bec4bf80,0x3f6d3f35bec4bf80bec43f353f6d8000,0xbf75bf0e3f223f6dbdc9bf7bbef13f35,0x3e95bf55bf463ec43f7f3e48bf62bf35,0xbe483f6d3f0ebf35bf553ec43f7b0000,0xbf7bbec43f553f35bf0ebf6d3e483f80,0x3f7f3e48bf75bec43f623f0ebf46bf35,0xbdc93f7b3e95bf6dbef13f553f22bf35
.octa 0x3f803f803f803f803f803f803f803f80,0xbf803f80bf803f80bf803f80bf803f80,0x3f223f0e3ef13ec43e953e483dc90000,0x3f463f553f623f6d3f753f7b3f7f3f80,0xbe48bec4bf0ebf35bf55bf6dbf7bbf80,0x3f7b3f6d3f553f353f0e3ec43e488000,0xbf62bf7bbf7fbf6dbf46bf0ebe950000,0x3ef13e48bdc9bec4bf22bf55bf75bf80
.octa 0xbf6dbf35bec400003ec43f353f6d3f80,0xbec4bf35bf6dbf80bf6dbf35bec48000,0xbe953e483f223f6d3f7f3f553ef10000,0xbf75bf7bbf46bec43dc93f0e3f623f80,0x3f0e3f6d3f7b3f353e48bec4bf55bf80,0xbf55bec43e483f353f7b3f6d3f0e8000,0x3f7f3f553e95bec4bf62bf7bbf220000,0xbdc93f0e3f753f6d3ef1be48bf46bf80
.octa 0x3f350000bf35bf80bf3500003f353f80,0x3f353f803f358000bf35bf80bf358000,0xbdc9bf55bf75bec43ef13f7b3f460000,0x3f7f3f0ebe95bf6dbf62be483f223f80,0xbf55bf6dbe483f353f7b3ec4bf0ebf80,0x3f0ebec4bf7bbf353e483f6d3f558000,0xbf75be483f463f6d3dc9bf55bf620000,0xbe95bf7bbf223ec43f7f3f0ebef1bf80
.octa 0xbec43f353f6d0000bf6dbf353ec43f80,0xbf6dbf353ec43f803ec4bf35bf6d8000,0x3ef13f7b3dc9bf6dbf223f0e3f750000,0xbf623e483f7f3ec4bf46bf553e953f80,0x3f7b3ec4bf55bf353f0e3f6dbe48bf80,0xbe483f6d3f0ebf35bf553ec43f7b8000,0x3f46bf0ebf623ec43f75be48bf7f0000,0x3f223f55bef1bf6d3e953f7bbdc9bf80
.octa 0x3f803f803f803f803f803f803f803f80,0xbf803f80bf803f80bf803f80bf803f80,0x3f7f3f7b3f753f6d3f623f553f463f35,0x3dc93e483e953ec43ef13f0e3f223f35,0x3f7b3f6d3f553f353f0e3ec43e480000,0x3e483ec43f0e3f353f553f6d3f7b3f80,0x3f753f553f223ec43dc9be48bef1bf35,0x3e953f0e3f463f6d3f7f3f7b3f623f35
.octa 0x3f6d3f353ec40000bec4bf35bf6dbf80,0x3ec43f353f6d3f803f6d3f353ec48000,0x3f623f0e3dc9bec4bf46bf7bbf75bf35,0x3ef13f553f7f3f6d3f223e48be95bf35,0x3f553ec4be48bf35bf7bbf6dbf0e0000,0x3f0e3f6d3f7b3f353e48bec4bf55bf80,0x3f463e48bef1bf6dbf75bf0e3dc93f35,0x3f223f7b3f623ec4be95bf55bf7fbf35
.octa 0x3f350000bf35bf80bf3500003f353f80,0x3f353f803f358000bf35bf80bf358000,0x3f22be48bf62bf6dbe953f0e3f7f3f35,0x3f463f7b3ef1bec4bf75bf55bdc93f35,0x3f0ebec4bf7bbf353e483f6d3f550000,0x3f553f6d3e48bf35bf7bbec43f0e3f80,0x3ef1bf0ebf7fbec43f223f7b3e95bf35,0x3f623f55bdc9bf6dbf463e483f753f35
.octa 0x3ec4bf35bf6d00003f6d3f35bec4bf80,0x3f6d3f35bec4bf80bec43f353f6d8000,0x3e95bf55bf463ec43f7f3e48bf62bf35,0x3f753f0ebf22bf6d3dc93f7b3ef1bf35,0x3e48bf6dbf0e3f353f55bec4bf7b0000,0x3f7b3ec4bf55bf353f0e3f6dbe48bf80,0x3dc9bf7bbe953f6d3ef1bf55bf223f35,0x3f7f3e48bf75bec43f623f0ebf46bf35
.octa 0xbf8000003f800000bf8000003f80,0x3f808000bf8080003f808000bf808000,0x3f22bf55bef13f6d3e95bf7bbdc93f80,0x3f463f0ebf62bec43f753e48bf7f8000,0x3f7bbec4bf553f353f0ebf6dbe483f80,0x3e483f6dbf0ebf353f553ec4bf7b8000,0x3f623e48bf7f3ec43f46bf55be953f80,0xbef13f7bbdc9bf6d3f223f0ebf758000
.octa 0x3ec43f35bf6d00003f6dbf35bec43f80,0xbf6d3f353ec4bf803ec43f35bf6d8000,0xbe953f7bbf22bec43f7fbf0ebef13f80,0xbf753e483f46bf6d3dc93f55bf628000,0xbf553f6dbe48bf353f7bbec4bf0e3f80,0xbf0ebec43f7bbf35be483f6dbf558000,0xbf7f3f0e3e95bf6d3f62be48bf223f80,0x3dc9bf553f75bec4bef13f7bbf468000
.octa 0xbf3500003f35bf803f350000bf353f80,0x3f35bf803f358000bf353f80bf358000,0xbdc9bf0e3f75bf6d3ef13e48bf463f80,0x3f7fbf553e953ec4bf623f7bbf228000,0x3f0ebf6d3f7bbf353e483ec4bf553f80,0x3f55bec4be483f35bf7b3f6dbf0e8000,0x3f75bf7b3f46bec4bdc93f0ebf623f80,0x3e953e48bf223f6dbf7f3f55bef18000
.octa 0x3f6dbf353ec40000bec43f35bf6d3f80,0xbec43f35bf6d3f80bf6d3f35bec48000,0x3ef1be48bdc93ec4bf223f55bf753f80,0xbf623f7bbf7f3f6dbf463f0ebe958000,0xbe483ec4bf0e3f35bf553f6dbf7b3f80,0xbf7b3f6dbf553f35bf0e3ec4be488000,0xbf463f55bf623f6dbf753f7bbf7f3f80,0xbf223f0ebef13ec4be953e48bdc98000
.octa 0xbf8000003f800000bf8000003f80,0x3f808000bf8080003f808000bf808000,0x3f7fbe48bf753ec43f62bf0ebf463f35,0x3dc93f7bbe95bf6d3ef13f55bf22bf35,0x3e483f6dbf0ebf353f553ec4bf7b0000,0xbf7b3ec43f55bf35bf0e3f6d3e48bf80,0xbf753f0e3f22bf6dbdc93f7bbef1bf35,0xbe95bf553f463ec4bf7f3e483f62bf35
.octa 0xbec4bf353f6d0000bf6d3f353ec4bf80,0x3f6dbf35bec43f80bec4bf353f6d8000,0x3f62bf55bdc93f6dbf46be483f75bf35,0x3ef13f0ebf7f3ec43f22bf7b3e953f35,0x3f0e3ec4bf7b3f353e48bf6d3f550000,0xbf553f6dbe48bf353f7bbec4bf0e3f80,0xbf463f7bbef1bec43f75bf553dc93f35,0xbf22be483f62bf6d3e953f0ebf7f3f35
.octa 0xbf3500003f35bf803f350000bf353f80,0x3f35bf803f358000bf353f80bf358000,0x3f22bf7b3f62bec4be953f55bf7f3f35,0x3f46be48bef13f6dbf753f0e3dc9bf35,0x3f55bec4be483f35bf7b3f6dbf0e0000,0xbf0e3f6dbf7b3f35be48bec43f55bf80,0xbef13f55bf7f3f6dbf223e483e95bf35,0xbf623f0ebdc9bec43f46bf7b3f75bf35
.octa 0xbf6d3f35bec400003ec4bf353f6dbf80,0x3ec4bf353f6dbf803f6dbf353ec48000,0x3e95bf0e3f46bf6d3f7fbf7b3f62bf35,0x3f75bf553f22bec43dc93e48bef13f35,0x3f7bbf6d3f55bf353f0ebec43e480000,0xbe483ec4bf0e3f35bf553f6dbf7b3f80,0xbdc93e48be953ec4bef13f0ebf223f35,0xbf7f3f7bbf753f6dbf623f55bf463f35
.octa 0xbf8000003f800000bf8000003f80,0x3f808000bf8080003f808000bf808000,0x3f463f0ebf62bec43f753e48bf7f0000,0xbf223f553ef1bf6dbe953f7b3dc9bf80,0xbf7b3ec43f55bf35bf0e3f6d3e48bf80,0xbe48bf6d3f0e3f35bf55bec43f7b8000,0x3ef1bf7b3dc93f6dbf22bf0e3f750000,0x3f623e48bf7f3ec43f46bf55be953f80
.octa 0x3ec43f35bf6d00003f6dbf35bec43f80,0xbf6d3f353ec4bf803ec43f35bf6d8000,0xbf753e483f46bf6d3dc93f55bf620000,0x3e95bf7b3f223ec4bf7f3f0e3ef1bf80,0x3f55bf6d3e483f35bf7b3ec43f0ebf80,0x3f0e3ec4bf7b3f353e48bf6d3f558000,0xbdc93f55bf753ec43ef1bf7b3f460000,0xbf7f3f0e3e95bf6d3f62be48bf223f80
.octa 0xbf3500003f35bf803f350000bf353f80,0x3f35bf803f358000bf353f80bf358000,0x3f7fbf553e953ec4bf623f7bbf220000,0x3dc93f0ebf753f6dbef1be483f46bf80,0xbf0e3f6dbf7b3f35be48bec43f55bf80,0xbf553ec43e48bf353f7bbf6d3f0e8000,0xbe95be483f22bf6d3f7fbf553ef10000,0x3f75bf7b3f46bec4bdc93f0ebf623f80
.octa 0x3f6dbf353ec40000bec43f35bf6d3f80,0xbec43f35bf6d3f80bf6d3f35bec48000,0xbf623f7bbf7f3f6dbf463f0ebe950000,0xbef13e483dc9bec43f22bf553f75bf80,0x3e48bec43f0ebf353f55bf6d3f7bbf80,0x3f7bbf6d3f55bf353f0ebec43e488000,0x3f22bf0e3ef1bec43e95be483dc90000,0xbf463f55bf623f6dbf753f7bbf7f3f80
.octa 0xbf8000003f800000bf8000003f80,0x3f808000bf8080003f808000bf808000,0x3dc93f7bbe95bf6d3ef13f55bf22bf35,0xbf7f3e483f75bec4bf623f0e3f46bf35,0xbe48bf6d3f0e3f35bf55bec43f7b0000,0x3f7bbec4bf553f353f0ebf6dbe483f80,0x3e953f55bf46bec43f7fbe48bf623f35,0xbf753f0e3f22bf6dbdc93f7bbef1bf35
.octa 0xbec4bf353f6d0000bf6d3f353ec4bf80,0x3f6dbf35bec43f80bec4bf353f6d8000,0x3ef13f0ebf7f3ec43f22bf7b3e953f35,0xbf623f553dc9bf6d3f463e48bf753f35,0xbf0ebec43f7bbf35be483f6dbf550000,0x3f55bf6d3e483f35bf7b3ec43f0ebf80,0x3f223e48bf623f6dbe95bf0e3f7fbf35,0xbf463f7bbef1bec43f75bf553dc93f35
.octa 0xbf3500003f35bf803f350000bf353f80,0x3f35bf803f358000bf353f80bf358000,0x3f46be48bef13f6dbf753f0e3dc9bf35,0xbf223f7bbf623ec43e95bf553f7fbf35,0xbf553ec43e48bf353f7bbf6d3f0e0000,0x3f0ebf6d3f7bbf353e483ec4bf553f80,0x3f62bf0e3dc93ec4bf463f7bbf753f35,0xbef13f55bf7f3f6dbf223e483e95bf35
.octa 0xbf6d3f35bec400003ec4bf353f6dbf80,0x3ec4bf353f6dbf803f6dbf353ec48000,0x3f75bf553f22bec43dc93e48bef13f35,0xbe953f0ebf463f6dbf7f3f7bbf623f35,0xbf7b3f6dbf553f35bf0e3ec4be480000,0x3e48bec43f0ebf353f55bf6d3f7bbf80,0x3f7fbf7b3f75bf6d3f62bf553f46bf35,0xbdc93e48be953ec4bef13f0ebf223f35
.octa 0xbf8000003f800000bf8000003f80,0x3f808000bf8080003f808000bf808000,0xbf223f553ef1bf6dbe953f7b3dc9bf80,0xbf46bf0e3f623ec4bf75be483f7f8000,0x3f7bbec4bf553f353f0ebf6dbe483f80,0x3e483f6dbf0ebf353f553ec4bf7b8000,0xbf62be483f7fbec4bf463f553e95bf80,0x3ef1bf7b3dc93f6dbf22bf0e3f758000
.octa 0x3ec43f35bf6d00003f6dbf35bec43f80,0xbf6d3f353ec4bf803ec43f35bf6d8000,0x3e95bf7b3f223ec4bf7f3f0e3ef1bf80,0x3f75be48bf463f6dbdc9bf553f628000,0xbf553f6dbe48bf353f7bbec4bf0e3f80,0xbf0ebec43f7bbf35be483f6dbf558000,0x3f7fbf0ebe953f6dbf623e483f22bf80,0xbdc93f55bf753ec43ef1bf7b3f468000
.octa 0xbf3500003f35bf803f350000bf353f80,0x3f35bf803f358000bf353f80bf358000,0x3dc93f0ebf753f6dbef1be483f46bf80,0xbf7f3f55be95bec43f62bf7b3f228000,0x3f0ebf6d3f7bbf353e483ec4bf553f80,0x3f55bec4be483f35bf7b3f6dbf0e8000,0xbf753f7bbf463ec43dc9bf0e3f62bf80,0xbe95be483f22bf6d3f7fbf553ef18000
.octa 0x3f6dbf353ec40000bec43f35bf6d3f80,0xbec43f35bf6d3f80bf6d3f35bec48000,0xbef13e483dc9bec43f22bf553f75bf80,0x3f62bf7b3f7fbf6d3f46bf0e3e958000,0xbe483ec4bf0e3f35bf553f6dbf7b3f80,0xbf7b3f6dbf553f35bf0e3ec4be488000,0x3f46bf553f62bf6d3f75bf7b3f7fbf80,0x3f22bf0e3ef1bec43e95be483dc98000
.octa 0xbf8000003f800000bf8000003f80,0x3f808000bf8080003f808000bf808000,0xbf7f3e483f75bec4bf623f0e3f46bf35,0xbdc9bf7b3e953f6dbef1bf553f223f35,0x3e483f6dbf0ebf353f553ec4bf7b0000,0xbf7b3ec43f55bf35bf0e3f6d3e48bf80,0x3f75bf0ebf223f6d3dc9bf7b3ef13f35,0x3e953f55bf46bec43f7fbe48bf623f35
.octa 0xbec4bf353f6d0000bf6d3f353ec4bf80,0x3f6dbf35bec43f80bec4bf353f6d8000,0xbf623f553dc9bf6d3f463e48bf753f35,0xbef1bf0e3f7fbec4bf223f7bbe95bf35,0x3f0e3ec4bf7b3f353e48bf6d3f550000,0xbf553f6dbe48bf353f7bbec4bf0e3f80,0x3f46bf7b3ef13ec4bf753f55bdc9bf35,0x3f223e48bf623f6dbe95bf0e3f7fbf35
.octa 0xbf3500003f35bf803f350000bf353f80,0x3f35bf803f358000bf353f80bf358000,0xbf223f7bbf623ec43e95bf553f7fbf35,0xbf463e483ef1bf6d3f75bf0ebdc93f35,0x3f55bec4be483f35bf7b3f6dbf0e0000,0xbf0e3f6dbf7b3f35be48bec43f55bf80,0x3ef1bf553f7fbf6d3f22be48be953f35,0x3f62bf0e3dc93ec4bf463f7bbf753f35
.octa 0xbf6d3f35bec400003ec4bf353f6dbf80,0x3ec4bf353f6dbf803f6dbf353ec48000,0xbe953f0ebf463f6dbf7f3f7bbf623f35,0xbf753f55bf223ec4bdc9be483ef1bf35,0x3f7bbf6d3f55bf353f0ebec43e480000,0xbe483ec4bf0e3f35bf553f6dbf7b3f80,0x3dc9be483e95bec43ef1bf0e3f22bf35,0x3f7fbf7b3f75bf6d3f62bf553f46bf35
.octa 0xbf8000003f800000bf8000003f80,0x3f808000bf8080003f808000bf808000,0xbf46bf0e3f623ec4bf75be483f7f0000,0x3f22bf55bef13f6d3e95bf7bbdc93f80,0xbf7b3ec43f55bf35bf0e3f6d3e48bf80,0xbe48bf6d3f0e3f35bf55bec43f7b8000,0xbef13f7bbdc9bf6d3f223f0ebf750000,0xbf62be483f7fbec4bf463f553e95bf80
.octa 0x3ec43f35bf6d00003f6dbf35bec43f80,0xbf6d3f353ec4bf803ec43f35bf6d8000,0x3f75be48bf463f6dbdc9bf553f620000,0xbe953f7bbf22bec43f7fbf0ebef13f80,0x3f55bf6d3e483f35bf7b3ec43f0ebf80,0x3f0e3ec4bf7b3f353e48bf6d3f558000,0x3dc9bf553f75bec4bef13f7bbf460000,0x3f7fbf0ebe953f6dbf623e483f22bf80
.octa 0xbf3500003f35bf803f350000bf353f80,0x3f35bf803f358000bf353f80bf358000,0xbf7f3f55be95bec43f62bf7b3f220000,0xbdc9bf0e3f75bf6d3ef13e48bf463f80,0xbf0e3f6dbf7b3f35be48bec43f55bf80,0xbf553ec43e48bf353f7bbf6d3f0e8000,0x3e953e48bf223f6dbf7f3f55bef10000,0xbf753f7bbf463ec43dc9bf0e3f62bf80
.octa 0x3f6dbf353ec40000bec43f35bf6d3f80,0xbec43f35bf6d3f80bf6d3f35bec48000,0x3f62bf7b3f7fbf6d3f46bf0e3e950000,0x3ef1be48bdc93ec4bf223f55bf753f80,0x3e48bec43f0ebf353f55bf6d3f7bbf80,0x3f7bbf6d3f55bf353f0ebec43e488000,0xbf223f0ebef13ec4be953e48bdc90000,0x3f46bf553f62bf6d3f75bf7b3f7fbf80
.octa 0xbf8000003f800000bf8000003f80,0x3f808000bf8080003f808000bf808000,0xbdc9bf7b3e953f6dbef1bf553f223f35,0x3f7fbe48bf753ec43f62bf0ebf463f35,0xbe48bf6d3f0e3f35bf55bec43f7b0000,0x3f7bbec4bf553f353f0ebf6dbe483f80,0xbe95bf553f463ec4bf7f3e483f62bf35,0x3f75bf0ebf223f6d3dc9bf7b3ef13f35
.octa 0xbec4bf353f6d0000bf6d3f353ec4bf80,0x3f6dbf35bec43f80bec4bf353f6d8000,0xbef1bf0e3f7fbec4bf223f7bbe95bf35,0x3f62bf55bdc93f6dbf46be483f75bf35,0xbf0ebec43f7bbf35be483f6dbf550000,0x3f55bf6d3e483f35bf7b3ec43f0ebf80,0xbf22be483f62bf6d3e953f0ebf7f3f35,0x3f46bf7b3ef13ec4bf753f55bdc9bf35
.octa 0xbf3500003f35bf803f350000bf353f80,0x3f35bf803f358000bf353f80bf358000,0xbf463e483ef1bf6d3f75bf0ebdc93f35,0x3f22bf7b3f62bec4be953f55bf7f3f35,0xbf553ec43e48bf353f7bbf6d3f0e0000,0x3f0ebf6d3f7bbf353e483ec4bf553f80,0xbf623f0ebdc9bec43f46bf7b3f75bf35,0x3ef1bf553f7fbf6d3f22be48be953f35
.octa 0xbf6d3f35bec400003ec4bf353f6dbf80,0x3ec4bf353f6dbf803f6dbf353ec48000,0xbf753f55bf223ec4bdc9be483ef1bf35,0x3e95bf0e3f46bf6d3f7fbf7b3f62bf35,0xbf7b3f6dbf553f35bf0e3ec4be480000,0x3e48bec43f0ebf353f55bf6d3f7bbf80,0xbf7f3f7bbf753f6dbf623f55bf463f35,0x3dc9be483e95bec43ef1bf0e3f22bf35
.octa 0x3f803f803f803f803f803f803f803f80,0x3e483ec43f0e3f353f553f6d3f7b3f80,0xbf6dbf35bec400003ec43f353f6d3f80,0xbf0ebf6dbf7bbf35be483ec43f553f80,0xbf803f80bf803f80bf803f80bf803f80,0xbe483ec4bf0e3f35bf553f6dbf7b3f80,0x3f6dbf353ec40000bec43f35bf6d3f80,0x3f0ebf6d3f7bbf353e483ec4bf553f80
.octa 0x3f350000bf35bf80bf3500003f353f80,0x3f553f6d3e48bf35bf7bbec43f0e3f80,0xbec43f353f6d0000bf6dbf353ec43f80,0xbf7bbec43f553f35bf0ebf6d3e483f80,0xbf3500003f35bf803f350000bf353f80,0xbf553f6dbe48bf353f7bbec4bf0e3f80,0x3ec43f35bf6d00003f6dbf35bec43f80,0x3f7bbec4bf553f353f0ebf6dbe483f80
.octa 0xbf8000003f800000bf8000003f80,0x3f7bbec4bf553f353f0ebf6dbe483f80,0x3ec43f35bf6d00003f6dbf35bec43f80,0xbf553f6dbe48bf353f7bbec4bf0e3f80,0xbf8000003f800000bf8000003f80,0xbf7bbec43f553f35bf0ebf6d3e483f80,0xbec43f353f6d0000bf6dbf353ec43f80,0x3f553f6d3e48bf35bf7bbec43f0e3f80
.octa 0xbf3500003f35bf803f350000bf353f80,0x3f0ebf6d3f7bbf353e483ec4bf553f80,0x3f6dbf353ec40000bec43f35bf6d3f80,0xbe483ec4bf0e3f35bf553f6dbf7b3f80,0x3f350000bf35bf80bf3500003f353f80,0xbf0ebf6dbf7bbf35be483ec43f553f80,0xbf6dbf35bec400003ec43f353f6d3f80,0x3e483ec43f0e3f353f553f6d3f7b3f80
.octa 0x3f803f803f803f803f803f803f803f80,0xbf7bbf6dbf55bf35bf0ebec4be480000,0x3f6d3f353ec40000bec4bf35bf6dbf80,0xbf55bec43e483f353f7b3f6d3f0e0000,0xbf803f80bf803f80bf803f80bf803f80,0x3f7bbf6d3f55bf353f0ebec43e480000,0xbf6d3f35bec400003ec4bf353f6dbf80,0x3f55bec4be483f35bf7b3f6dbf0e0000
.octa 0x3f350000bf35bf80bf3500003f353f80,0xbf0e3ec43f7b3f35be48bf6dbf550000,0x3ec4bf35bf6d00003f6d3f35bec4bf80,0xbe483f6d3f0ebf35bf553ec43f7b0000,0xbf3500003f35bf803f350000bf353f80,0x3f0e3ec4bf7b3f353e48bf6d3f550000,0xbec4bf353f6d0000bf6d3f353ec4bf80,0x3e483f6dbf0ebf353f553ec4bf7b0000
.octa 0xbf8000003f800000bf8000003f80,0x3e483f6dbf0ebf353f553ec4bf7b0000,0xbec4bf353f6d0000bf6d3f353ec4bf80,0x3f0e3ec4bf7b3f353e48bf6d3f550000,0xbf8000003f800000bf8000003f80,0xbe483f6d3f0ebf35bf553ec43f7b0000,0x3ec4bf35bf6d00003f6d3f35bec4bf80,0xbf0e3ec43f7b3f35be48bf6dbf550000
.octa 0xbf3500003f35bf803f350000bf353f80,0x3f55bec4be483f35bf7b3f6dbf0e0000,0xbf6d3f35bec400003ec4bf353f6dbf80,0x3f7bbf6d3f55bf353f0ebec43e480000,0x3f350000bf35bf80bf3500003f353f80,0xbf55bec43e483f353f7b3f6d3f0e0000,0x3f6d3f353ec40000bec4bf35bf6dbf80,0xbf7bbf6dbf55bf35bf0ebec4be480000
.octa 0x3f803f803f803f803f803f803f803f80,0xbe48bec4bf0ebf35bf55bf6dbf7bbf80,0xbf6dbf35bec400003ec43f353f6d3f80,0x3f0e3f6d3f7b3f353e48bec4bf55bf80,0xbf803f80bf803f80bf803f80bf803f80,0x3e48bec43f0ebf353f55bf6d3f7bbf80,0x3f6dbf353ec40000bec43f35bf6d3f80,0xbf0e3f6dbf7b3f35be48bec43f55bf80
.octa 0x3f350000bf35bf80bf3500003f353f80,0xbf55bf6dbe483f353f7b3ec4bf0ebf80,0xbec43f353f6d0000bf6dbf353ec43f80,0x3f7b3ec4bf55bf353f0e3f6dbe48bf80,0xbf3500003f35bf803f350000bf353f80,0x3f55bf6d3e483f35bf7b3ec43f0ebf80,0x3ec43f35bf6d00003f6dbf35bec43f80,0xbf7b3ec43f55bf35bf0e3f6d3e48bf80
.octa 0xbf8000003f800000bf8000003f80,0xbf7b3ec43f55bf35bf0e3f6d3e48bf80,0x3ec43f35bf6d00003f6dbf35bec43f80,0x3f55bf6d3e483f35bf7b3ec43f0ebf80,0xbf8000003f800000bf8000003f80,0x3f7b3ec4bf55bf353f0e3f6dbe48bf80,0xbec43f353f6d0000bf6dbf353ec43f80,0xbf55bf6dbe483f353f7b3ec4bf0ebf80
.octa 0xbf3500003f35bf803f350000bf353f80,0xbf0e3f6dbf7b3f35be48bec43f55bf80,0x3f6dbf353ec40000bec43f35bf6d3f80,0x3e48bec43f0ebf353f55bf6d3f7bbf80,0x3f350000bf35bf80bf3500003f353f80,0x3f0e3f6d3f7b3f353e48bec4bf55bf80,0xbf6dbf35bec400003ec43f353f6d3f80,0xbe48bec4bf0ebf35bf55bf6dbf7bbf80
.octa 0x3f803f803f803f803f803f803f803f80,0x3f7b3f6d3f553f353f0e3ec43e480000,0x3f6d3f353ec40000bec4bf35bf6dbf80,0x3f553ec4be48bf35bf7bbf6dbf0e0000,0xbf803f80bf803f80bf803f80bf803f80,0xbf7b3f6dbf553f35bf0e3ec4be480000,0xbf6d3f35bec400003ec4bf353f6dbf80,0xbf553ec43e48bf353f7bbf6d3f0e0000
.octa 0x3f350000bf35bf80bf3500003f353f80,0x3f0ebec4bf7bbf353e483f6d3f550000,0x3ec4bf35bf6d00003f6d3f35bec4bf80,0x3e48bf6dbf0e3f353f55bec4bf7b0000,0xbf3500003f35bf803f350000bf353f80,0xbf0ebec43f7bbf35be483f6dbf550000,0xbec4bf353f6d0000bf6d3f353ec4bf80,0xbe48bf6d3f0e3f35bf55bec43f7b0000
.octa 0xbf8000003f800000bf8000003f80,0xbe48bf6d3f0e3f35bf55bec43f7b0000,0xbec4bf353f6d0000bf6d3f353ec4bf80,0xbf0ebec43f7bbf35be483f6dbf550000,0xbf8000003f800000bf8000003f80,0x3e48bf6dbf0e3f353f55bec4bf7b0000,0x3ec4bf35bf6d00003f6d3f35bec4bf80,0x3f0ebec4bf7bbf353e483f6d3f550000
.octa 0xbf3500003f35bf803f350000bf353f80,0xbf553ec43e48bf353f7bbf6d3f0e0000,0xbf6d3f35bec400003ec4bf353f6dbf80,0xbf7b3f6dbf553f35bf0e3ec4be480000,0x3f350000bf35bf80bf3500003f353f80,0x3f553ec4be48bf35bf7bbf6dbf0e0000,0x3f6d3f353ec40000bec4bf35bf6dbf80,0x3f7b3f6d3f553f353f0e3ec43e480000
.octa 0x0,0x3f7b3f6d3f553f353f0e3ec43e480000,0x3ec43f353f6d3f803f6d3f353ec40000,0xbf55bec43e483f353f7b3f6d3f0e0000,0x0,0xbf7b3f6dbf553f35bf0e3ec4be480000,0xbec43f35bf6d3f80bf6d3f35bec40000,0x3f55bec4be483f35bf7b3f6dbf0e0000
.octa 0xbf35bf80bf3500003f353f803f350000,0x3f0ebec4bf7bbf353e483f6d3f550000,0x3f6d3f35bec4bf80bec43f353f6d0000,0xbe483f6d3f0ebf35bf553ec43f7b0000,0x3f35bf803f350000bf353f80bf350000,0xbf0ebec43f7bbf35be483f6dbf550000,0xbf6d3f353ec4bf803ec43f35bf6d0000,0x3e483f6dbf0ebf353f553ec4bf7b0000
.octa 0xbf8000003f800000bf8000003f800000,0xbe48bf6d3f0e3f35bf55bec43f7b0000,0x3f6dbf35bec43f80bec4bf353f6d0000,0x3f0e3ec4bf7b3f353e48bf6d3f550000,0x3f800000bf8000003f800000bf800000,0x3e48bf6dbf0e3f353f55bec4bf7b0000,0xbf6dbf353ec43f803ec4bf35bf6d0000,0xbf0e3ec43f7b3f35be48bf6dbf550000
.octa 0xbf353f80bf3500003f35bf803f350000,0xbf553ec43e48bf353f7bbf6d3f0e0000,0x3ec4bf353f6dbf803f6dbf353ec40000,0x3f7bbf6d3f55bf353f0ebec43e480000,0x3f353f803f350000bf35bf80bf350000,0x3f553ec4be48bf35bf7bbf6dbf0e0000,0xbec4bf35bf6dbf80bf6dbf35bec40000,0xbf7bbf6dbf55bf35bf0ebec4be480000
.octa 0x0,0x3e483ec43f0e3f353f553f6d3f7b3f80,0xbec4bf35bf6dbf80bf6dbf35bec40000,0x3f0e3f6d3f7b3f353e48bec4bf55bf80,0x0,0xbe483ec4bf0e3f35bf553f6dbf7b3f80,0x3ec4bf353f6dbf803f6dbf353ec40000,0xbf0e3f6dbf7b3f35be48bec43f55bf80
.octa 0xbf35bf80bf3500003f353f803f350000,0x3f553f6d3e48bf35bf7bbec43f0e3f80,0xbf6dbf353ec43f803ec4bf35bf6d0000,0x3f7b3ec4bf55bf353f0e3f6dbe48bf80,0x3f35bf803f350000bf353f80bf350000,0xbf553f6dbe48bf353f7bbec4bf0e3f80,0x3f6dbf35bec43f80bec4bf353f6d0000,0xbf7b3ec43f55bf35bf0e3f6d3e48bf80
.octa 0xbf8000003f800000bf8000003f800000,0x3f7bbec4bf553f353f0ebf6dbe483f80,0xbf6d3f353ec4bf803ec43f35bf6d0000,0x3f55bf6d3e483f35bf7b3ec43f0ebf80,0x3f800000bf8000003f800000bf800000,0xbf7bbec43f553f35bf0ebf6d3e483f80,0x3f6d3f35bec4bf80bec43f353f6d0000,0xbf55bf6dbe483f353f7b3ec4bf0ebf80
.octa 0xbf353f80bf3500003f35bf803f350000,0x3f0ebf6d3f7bbf353e483ec4bf553f80,0xbec43f35bf6d3f80bf6d3f35bec40000,0x3e48bec43f0ebf353f55bf6d3f7bbf80,0x3f353f803f350000bf35bf80bf350000,0xbf0ebf6dbf7bbf35be483ec43f553f80,0x3ec43f353f6d3f803f6d3f353ec40000,0xbe48bec4bf0ebf35bf55bf6dbf7bbf80
.octa 0x0,0xbf7bbf6dbf55bf35bf0ebec4be480000,0x3ec43f353f6d3f803f6d3f353ec40000,0x3f553ec4be48bf35bf7bbf6dbf0e0000,0x0,0x3f7bbf6d3f55bf353f0ebec43e480000,0xbec43f35bf6d3f80bf6d3f35bec40000,0xbf553ec43e48bf353f7bbf6d3f0e0000
.octa 0xbf35bf80bf3500003f353f803f350000,0xbf0e3ec43f7b3f35be48bf6dbf550000,0x3f6d3f35bec4bf80bec43f353f6d0000,0x3e48bf6dbf0e3f353f55bec4bf7b0000,0x3f35bf803f350000bf353f80bf350000,0x3f0e3ec4bf7b3f353e48bf6d3f550000,0xbf6d3f353ec4bf803ec43f35bf6d0000,0xbe48bf6d3f0e3f35bf55bec43f7b0000
.octa 0xbf8000003f800000bf8000003f800000,0x3e483f6dbf0ebf353f553ec4bf7b0000,0x3f6dbf35bec43f80bec4bf353f6d0000,0xbf0ebec43f7bbf35be483f6dbf550000,0x3f800000bf8000003f800000bf800000,0xbe483f6d3f0ebf35bf553ec43f7b0000,0xbf6dbf353ec43f803ec4bf35bf6d0000,0x3f0ebec4bf7bbf353e483f6d3f550000
.octa 0xbf353f80bf3500003f35bf803f350000,0x3f55bec4be483f35bf7b3f6dbf0e0000,0x3ec4bf353f6dbf803f6dbf353ec40000,0xbf7b3f6dbf553f35bf0e3ec4be480000,0x3f353f803f350000bf35bf80bf350000,0xbf55bec43e483f353f7b3f6d3f0e0000,0xbec4bf35bf6dbf80bf6dbf35bec40000,0x3f7b3f6d3f553f353f0e3ec43e480000
.octa 0x0,0xbe48bec4bf0ebf35bf55bf6dbf7bbf80,0xbec4bf35bf6dbf80bf6dbf35bec40000,0xbf0ebf6dbf7bbf35be483ec43f553f80,0x0,0x3e48bec43f0ebf353f55bf6d3f7bbf80,0x3ec4bf353f6dbf803f6dbf353ec40000,0x3f0ebf6d3f7bbf353e483ec4bf553f80
.octa 0xbf35bf80bf3500003f353f803f350000,0xbf55bf6dbe483f353f7b3ec4bf0ebf80,0xbf6dbf353ec43f803ec4bf35bf6d0000,0xbf7bbec43f553f35bf0ebf6d3e483f80,0x3f35bf803f350000bf353f80bf350000,0x3f55bf6d3e483f35bf7b3ec43f0ebf80,0x3f6dbf35bec43f80bec4bf353f6d0000,0x3f7bbec4bf553f353f0ebf6dbe483f80
.octa 0xbf8000003f800000bf8000003f800000,0xbf7b3ec43f55bf35bf0e3f6d3e48bf80,0xbf6d3f353ec4bf803ec43f35bf6d0000,0xbf553f6dbe48bf353f7bbec4bf0e3f80,0x3f800000bf8000003f800000bf800000,0x3f7b3ec4bf55bf353f0e3f6dbe48bf80,0x3f6d3f35bec4bf80bec43f353f6d0000,0x3f553f6d3e48bf35bf7bbec43f0e3f80
.octa 0xbf353f80bf3500003f35bf803f350000,0xbf0e3f6dbf7b3f35be48bec43f55bf80,0xbec43f35bf6d3f80bf6d3f35bec40000,0xbe483ec4bf0e3f35bf553f6dbf7b3f80,0x3f353f803f350000bf35bf80bf350000,0x3f0e3f6d3f7b3f353e48bec4bf55bf80,0x3ec43f353f6d3f803f6d3f353ec40000,0x3e483ec43f0e3f353f553f6d3f7b3f80
.octa 0x80008000800080008000800080008000,0xbf7bbf6dbf55bf35bf0ebec4be488000,0xbec4bf35bf6dbf80bf6dbf35bec48000,0x3f553ec4be48bf35bf7bbf6dbf0e8000,0x80008000800080008000800080008000,0x3f7bbf6d3f55bf353f0ebec43e488000,0x3ec4bf353f6dbf803f6dbf353ec48000,0xbf553ec43e48bf353f7bbf6d3f0e8000
.octa 0x3f353f803f358000bf35bf80bf358000,0xbf0e3ec43f7b3f35be48bf6dbf558000,0xbf6dbf353ec43f803ec4bf35bf6d8000,0x3e48bf6dbf0e3f353f55bec4bf7b8000,0xbf353f80bf3580003f35bf803f358000,0x3f0e3ec4bf7b3f353e48bf6d3f558000,0x3f6dbf35bec43f80bec4bf353f6d8000,0xbe48bf6d3f0e3f35bf55bec43f7b8000
.octa 0x3f808000bf8080003f808000bf808000,0x3e483f6dbf0ebf353f553ec4bf7b8000,0xbf6d3f353ec4bf803ec43f35bf6d8000,0xbf0ebec43f7bbf35be483f6dbf558000,0xbf8080003f808000bf8080003f808000,0xbe483f6d3f0ebf35bf553ec43f7b8000,0x3f6d3f35bec4bf80bec43f353f6d8000,0x3f0ebec4bf7bbf353e483f6d3f558000
.octa 0x3f35bf803f358000bf353f80bf358000,0x3f55bec4be483f35bf7b3f6dbf0e8000,0xbec43f35bf6d3f80bf6d3f35bec48000,0xbf7b3f6dbf553f35bf0e3ec4be488000,0xbf35bf80bf3580003f353f803f358000,0xbf55bec43e483f353f7b3f6d3f0e8000,0x3ec43f353f6d3f803f6d3f353ec48000,0x3f7b3f6d3f553f353f0e3ec43e488000
.octa 0x80008000800080008000800080008000,0xbe48bec4bf0ebf35bf55bf6dbf7bbf80,0x3ec43f353f6d3f803f6d3f353ec48000,0xbf0ebf6dbf7bbf35be483ec43f553f80,0x80008000800080008000800080008000,0x3e48bec43f0ebf353f55bf6d3f7bbf80,0xbec43f35bf6d3f80bf6d3f35bec48000,0x3f0ebf6d3f7bbf353e483ec4bf553f80
.octa 0x3f353f803f358000bf35bf80bf358000,0xbf55bf6dbe483f353f7b3ec4bf0ebf80,0x3f6d3f35bec4bf80bec43f353f6d8000,0xbf7bbec43f553f35bf0ebf6d3e483f80,0xbf353f80bf3580003f35bf803f358000,0x3f55bf6d3e483f35bf7b3ec43f0ebf80,0xbf6d3f353ec4bf803ec43f35bf6d8000,0x3f7bbec4bf553f353f0ebf6dbe483f80
.octa 0x3f808000bf8080003f808000bf808000,0xbf7b3ec43f55bf35bf0e3f6d3e48bf80,0x3f6dbf35bec43f80bec4bf353f6d8000,0xbf553f6dbe48bf353f7bbec4bf0e3f80,0xbf8080003f808000bf8080003f808000,0x3f7b3ec4bf55bf353f0e3f6dbe48bf80,0xbf6dbf353ec43f803ec4bf35bf6d8000,0x3f553f6d3e48bf35bf7bbec43f0e3f80
.octa 0x3f35bf803f358000bf353f80bf358000,0xbf0e3f6dbf7b3f35be48bec43f55bf80,0x3ec4bf353f6dbf803f6dbf353ec48000,0xbe483ec4bf0e3f35bf553f6dbf7b3f80,0xbf35bf80bf3580003f353f803f358000,0x3f0e3f6d3f7b3f353e48bec4bf55bf80,0xbec4bf35bf6dbf80bf6dbf35bec48000,0x3e483ec43f0e3f353f553f6d3f7b3f80
.octa 0x80008000800080008000800080008000,0x3f7b3f6d3f553f353f0e3ec43e488000,0xbec4bf35bf6dbf80bf6dbf35bec48000,0xbf55bec43e483f353f7b3f6d3f0e8000,0x80008000800080008000800080008000,0xbf7b3f6dbf553f35bf0e3ec4be488000,0x3ec4bf353f6dbf803f6dbf353ec48000,0x3f55bec4be483f35bf7b3f6dbf0e8000
.octa 0x3f353f803f358000bf35bf80bf358000,0x3f0ebec4bf7bbf353e483f6d3f558000,0xbf6dbf353ec43f803ec4bf35bf6d8000,0xbe483f6d3f0ebf35bf553ec43f7b8000,0xbf353f80bf3580003f35bf803f358000,0xbf0ebec43f7bbf35be483f6dbf558000,0x3f6dbf35bec43f80bec4bf353f6d8000,0x3e483f6dbf0ebf353f553ec4bf7b8000
.octa 0x3f808000bf8080003f808000bf808000,0xbe48bf6d3f0e3f35bf55bec43f7b8000,0xbf6d3f353ec4bf803ec43f35bf6d8000,0x3f0e3ec4bf7b3f353e48bf6d3f558000,0xbf8080003f808000bf8080003f808000,0x3e48bf6dbf0e3f353f55bec4bf7b8000,0x3f6d3f35bec4bf80bec43f353f6d8000,0xbf0e3ec43f7b3f35be48bf6dbf558000
.octa 0x3f35bf803f358000bf353f80bf358000,0xbf553ec43e48bf353f7bbf6d3f0e8000,0xbec43f35bf6d3f80bf6d3f35bec48000,0x3f7bbf6d3f55bf353f0ebec43e488000,0xbf35bf80bf3580003f353f803f358000,0x3f553ec4be48bf35bf7bbf6dbf0e8000,0x3ec43f353f6d3f803f6d3f353ec48000,0xbf7bbf6dbf55bf35bf0ebec4be488000
.octa 0x80008000800080008000800080008000,0x3e483ec43f0e3f353f553f6d3f7b3f80,0x3ec43f353f6d3f803f6d3f353ec48000,0x3f0e3f6d3f7b3f353e48bec4bf55bf80,0x80008000800080008000800080008000,0xbe483ec4bf0e3f35bf553f6dbf7b3f80,0xbec43f35bf6d3f80bf6d3f35bec48000,0xbf0e3f6dbf7b3f35be48bec43f55bf80
.octa 0x3f353f803f358000bf35bf80bf358000,0x3f553f6d3e48bf35bf7bbec43f0e3f80,0x3f6d3f35bec4bf80bec43f353f6d8000,0x3f7b3ec4bf55bf353f0e3f6dbe48bf80,0xbf353f80bf3580003f35bf803f358000,0xbf553f6dbe48bf353f7bbec4bf0e3f80,0xbf6d3f353ec4bf803ec43f35bf6d8000,0xbf7b3ec43f55bf35bf0e3f6d3e48bf80
.octa 0x3f808000bf8080003f808000bf808000,0x3f7bbec4bf553f353f0ebf6dbe483f80,0x3f6dbf35bec43f80bec4bf353f6d8000,0x3f55bf6d3e483f35bf7b3ec43f0ebf80,0xbf8080003f808000bf8080003f808000,0xbf7bbec43f553f35bf0ebf6d3e483f80,0xbf6dbf353ec43f803ec4bf35bf6d8000,0xbf55bf6dbe483f353f7b3ec4bf0ebf80
.octa 0x3f35bf803f358000bf353f80bf358000,0x3f0ebf6d3f7bbf353e483ec4bf553f80,0x3ec4bf353f6dbf803f6dbf353ec48000,0x3e48bec43f0ebf353f55bf6d3f7bbf80,0xbf35bf80bf3580003f353f803f358000,0xbf0ebf6dbf7bbf35be483ec43f553f80,0xbec4bf35bf6dbf80bf6dbf35bec48000,0xbe48bec4bf0ebf35bf55bf6dbf7bbf80
.octa 0x3f803f803f803f803f803f803f803f80,0x3e483ec43f0e3f353f553f6d3f7b3f80,0xbf6dbf35bec400003ec43f353f6d3f80,0xbf0ebf6dbf7bbf35be483ec43f553f80,0xbf803f80bf803f80bf803f80bf803f80,0xbe483ec4bf0e3f35bf553f6dbf7b3f80,0x3f6dbf353ec40000bec43f35bf6d3f80,0x3f0ebf6d3f7bbf353e483ec4bf553f80
.octa 0x3f350000bf35bf80bf3500003f353f80,0x3f553f6d3e48bf35bf7bbec43f0e3f80,0xbec43f353f6d0000bf6dbf353ec43f80,0xbf7bbec43f553f35bf0ebf6d3e483f80,0xbf3500003f35bf803f350000bf353f80,0xbf553f6dbe48bf353f7bbec4bf0e3f80,0x3ec43f35bf6d00003f6dbf35bec43f80,0x3f7bbec4bf553f353f0ebf6dbe483f80
.octa 0xbf8000003f800000bf8000003f80,0x3f7bbec4bf553f353f0ebf6dbe483f80,0x3ec43f35bf6d00003f6dbf35bec43f80,0xbf553f6dbe48bf353f7bbec4bf0e3f80,0xbf8000003f800000bf8000003f80,0xbf7bbec43f553f35bf0ebf6d3e483f80,0xbec43f353f6d0000bf6dbf353ec43f80,0x3f553f6d3e48bf35bf7bbec43f0e3f80
.octa 0xbf3500003f35bf803f350000bf353f80,0x3f0ebf6d3f7bbf353e483ec4bf553f80,0x3f6dbf353ec40000bec43f35bf6d3f80,0xbe483ec4bf0e3f35bf553f6dbf7b3f80,0x3f350000bf35bf80bf3500003f353f80,0xbf0ebf6dbf7bbf35be483ec43f553f80,0xbf6dbf35bec400003ec43f353f6d3f80,0x3e483ec43f0e3f353f553f6d3f7b3f80
.octa 0x3f803f803f803f803f803f803f803f80,0xbf7bbf6dbf55bf35bf0ebec4be480000,0x3f6d3f353ec40000bec4bf35bf6dbf80,0xbf55bec43e483f353f7b3f6d3f0e0000,0xbf803f80bf803f80bf803f80bf803f80,0x3f7bbf6d3f55bf353f0ebec43e480000,0xbf6d3f35bec400003ec4bf353f6dbf80,0x3f55bec4be483f35bf7b3f6dbf0e0000
.octa 0x3f350000bf35bf80bf3500003f353f80,0xbf0e3ec43f7b3f35be48bf6dbf550000,0x3ec4bf35bf6d00003f6d3f35bec4bf80,0xbe483f6d3f0ebf35bf553ec43f7b0000,0xbf3500003f35bf803f350000bf353f80,0x3f0e3ec4bf7b3f353e48bf6d3f550000,0xbec4bf353f6d0000bf6d3f353ec4bf80,0x3e483f6dbf0ebf353f553ec4bf7b0000
.octa 0xbf8000003f800000bf8000003f80,0x3e483f6dbf0ebf353f553ec4bf7b0000,0xbec4bf353f6d0000bf6d3f353ec4bf80,0x3f0e3ec4bf7b3f353e48bf6d3f550000,0xbf8000003f800000bf8000003f80,0xbe483f6d3f0ebf35bf553ec43f7b0000,0x3ec4bf35bf6d00003f6d3f35bec4bf80,0xbf0e3ec43f7b3f35be48bf6dbf550000
.octa 0xbf3500003f35bf803f350000bf353f80,0x3f55bec4be483f35bf7b3f6dbf0e0000,0xbf6d3f35bec400003ec4bf353f6dbf80,0x3f7bbf6d3f55bf353f0ebec43e480000,0x3f350000bf35bf80bf3500003f353f80,0xbf55bec43e483f353f7b3f6d3f0e0000,0x3f6d3f353ec40000bec4bf35bf6dbf80,0xbf7bbf6dbf55bf35bf0ebec4be480000
.octa 0x3f803f803f803f803f803f803f803f80,0xbe48bec4bf0ebf35bf55bf6dbf7bbf80,0xbf6dbf35bec400003ec43f353f6d3f80,0x3f0e3f6d3f7b3f353e48bec4bf55bf80,0xbf803f80bf803f80bf803f80bf803f80,0x3e48bec43f0ebf353f55bf6d3f7bbf80,0x3f6dbf353ec40000bec43f35bf6d3f80,0xbf0e3f6dbf7b3f35be48bec43f55bf80
.octa 0x3f350000bf35bf80bf3500003f353f80,0xbf55bf6dbe483f353f7b3ec4bf0ebf80,0xbec43f353f6d0000bf6dbf353ec43f80,0x3f7b3ec4bf55bf353f0e3f6dbe48bf80,0xbf3500003f35bf803f350000bf353f80,0x3f55bf6d3e483f35bf7b3ec43f0ebf80,0x3ec43f35bf6d00003f6dbf35bec43f80,0xbf7b3ec43f55bf35bf0e3f6d3e48bf80
.octa 0xbf8000003f800000bf8000003f80,0xbf7b3ec43f55bf35bf0e3f6d3e48bf80,0x3ec43f35bf6d00003f6dbf35bec43f80,0x3f55bf6d3e483f35bf7b3ec43f0ebf80,0xbf8000003f800000bf8000003f80,0x3f7b3ec4bf55bf353f0e3f6dbe48bf80,0xbec43f353f6d0000bf6dbf353ec43f80,0xbf55bf6dbe483f353f7b3ec4bf0ebf80
.octa 0xbf3500003f35bf803f350000bf353f80,0xbf0e3f6dbf7b3f35be48bec43f55bf80,0x3f6dbf353ec40000bec43f35bf6d3f80,0x3e48bec43f0ebf353f55bf6d3f7bbf80,0x3f350000bf35bf80bf3500003f353f80,0x3f0e3f6d3f7b3f353e48bec4bf55bf80,0xbf6dbf35bec400003ec43f353f6d3f80,0xbe48bec4bf0ebf35bf55bf6dbf7bbf80
.octa 0x3f803f803f803f803f803f803f803f80,0x3f7b3f6d3f553f353f0e3ec43e480000,0x3f6d3f353ec40000bec4bf35bf6dbf80,0x3f553ec4be48bf35bf7bbf6dbf0e0000,0xbf803f80bf803f80bf803f80bf803f80,0xbf7b3f6dbf553f35bf0e3ec4be480000,0xbf6d3f35bec400003ec4bf353f6dbf80,0xbf553ec43e48bf353f7bbf6d3f0e0000
.octa 0x3f350000bf35bf80bf3500003f353f80,0x3f0ebec4bf7bbf353e483f6d3f550000,0x3ec4bf35bf6d00003f6d3f35bec4bf80,0x3e48bf6dbf0e3f353f55bec4bf7b0000,0xbf3500003f35bf803f350000bf353f80,0xbf0ebec43f7bbf35be483f6dbf550000,0xbec4bf353f6d0000bf6d3f353ec4bf80,0xbe48bf6d3f0e3f35bf55bec43f7b0000
.octa 0xbf8000003f800000bf8000003f80,0xbe48bf6d3f0e3f35bf55bec43f7b0000,0xbec4bf353f6d0000bf6d3f353ec4bf80,0xbf0ebec43f7bbf35be483f6dbf550000,0xbf8000003f800000bf8000003f80,0x3e48bf6dbf0e3f353f55bec4bf7b0000,0x3ec4bf35bf6d00003f6d3f35bec4bf80,0x3f0ebec4bf7bbf353e483f6d3f550000
.octa 0xbf3500003f35bf803f350000bf353f80,0xbf553ec43e48bf353f7bbf6d3f0e0000,0xbf6d3f35bec400003ec4bf353f6dbf80,0xbf7b3f6dbf553f35bf0e3ec4be480000,0x3f350000bf35bf80bf3500003f353f80,0x3f553ec4be48bf35bf7bbf6dbf0e0000,0x3f6d3f353ec40000bec4bf35bf6dbf80,0x3f7b3f6d3f553f353f0e3ec43e480000
.octa 0x3f8000003f8000003f8000003f800000,0x3f7ff4e63f7ffb113f7ffec43f800000,0x3f7fd3973f7fec433f7ffb113f800000,0x3f7f9c183f7fd3973f7ff4e63f800000,0x3f74fa0b3f7b14be3f7ec46d3f800000,0x3f73913f3f7a73023f7e9bc93f800000,0x3f7213523f79c79d3f7e70b03f800000,0x3f7080663f7912983f7e43233f800000
.octa 0x3f7f4e6d3f7fb10f3f7fec433f800000,0x3f7eea9d3f7f84ab3f7fe1293f800000,0x3f7e70b03f7f4e6d3f7fd3973f800000,0x3f7de0b13f7f0e583f7fc38f3f800000,0x3f6ed89e3f7853f83f7e13243f800000,0x3f6d1c1d3f778bc53f7de0b13f800000,0x3f6b4b0c3f76ba073f7dabcc3f800000,0x3f6965913f75dec63f7d74743f800000
.octa 0x3f7d3aac3f7ec46d3f7fb10f3f800000,0x3f7c7eb03f7e70b03f7f9c183f800000,0x3f7baccd3f7e13243f7f84ab3f800000,0x3f7ac5163f7dabcc3f7f6ac73f800000,0x3f676bd83f74fa0b3f7d3aac3f800000,0x3f655e0b3f740bdd3f7cfe733f800000,0x3f633c5a3f7314473f7cbfc93f800000,0x3f6106f23f7213523f7c7eb03f800000
.octa 0x3f79c79d3f7d3aac3f7f4e6d3f800000,0x3f78b47b3f7cbfc93f7f2f9d3f800000,0x3f778bc53f7c3b283f7f0e583f800000,0x3f764d973f7baccd3f7eea9d3f800000,0x3f5ebe053f7109083f7c3b283f800000,0x3f5c61c73f6ff5733f7bf5313f800000,0x3f59f26a3f6ed89e3f7baccd3f800000,0x3f5770263f6db2933f7b61fc3f800000
.octa 0x3f8000003f8000003f8000003f800000,0x3f7f6ac73f7f84ab3f7f9c183f7fb10f,0x3f7dabcc3f7e13243f7e70b03f7ec46d,0x3f7ac5163f7baccd3f7c7eb03f7d3aac,0x3ef15aea3f0e39da3f2267993f3504f3,0x3ed25a093f00e7e43f173c073f2beb4a,0x3eb263ef3ee633753f0b9a6b3f226799,0x3e919ddd3ec9b9533eff17b23f187fc0
.octa 0x3f76ba073f7853f83f79c79d3f7b14be,0x3f718f573f740bdd3f764d973f7853f8,0x3f6b4b0c3f6ed89e3f7213523f74fa0b,0x3f63f4733f68bf3c3f6d1c1d3f710908,0x3e605c133eac7cd43ee633753f0e39da,0x3e1c76de3e8e9a223ecc9b8b3f039c3d,0x3dafb6803e605c133eb263ef3ef15aea,0x3c96c9b63e22abb63e97a1173edae880
.octa 0x3f5b941a3f61c5983f676bd83f6c835e,0x3f5233c63f59f26a3f6106f23f676bd8,0x3f47de653f514d3d3f59f26a3f61c598,0x3f3ca0033f47de653f5233c63f5b941a,0xbd48fb303dc8bd363e78cfcc3ec3ef15,0xbdee38763d16c32c3e419b373eac7cd4,0xbe3b6ecfbcc90ab03e09cf863e94a031,0xbe7ee6e1bdafb6803da3308c3e78cfcc
.octa 0x3f3085bb3f3daef93f49d1123f54db31,0x3f239da93f32c8c93f40d0da3f4d9f02,0x3f15f6d93f2736563f373a233f45e403,0x3f07a1363f1b02c63f2d14693f3daef9,0xbea09ae5be1640833cc90ab03e47c5c2,0xbec1071ebe541501bcfb49ba3e164083,0xbee0924fbe888e93bdafb6803dc8bd36,0xbeff17b2bea68f12be1008b73d48fb30
.octa 0x3f8000003f8000003f8000003f800000,0x3f7fc38f3f7fd3973f7fe1293f7fec43,0x3f7f0e583f7f4e6d3f7f84ab3f7fb10f,0x3f7de0b13f7e70b03f7eea9d3f7f4e6d,0x3f45e4033f54db313f61c5983f6c835e,0x3f3ebc1b3f4f7a1f3f5df6be3f6a09a7,0x3f373a233f49d1123f59f26a3f676bd8,0x3f2f61a53f43e2003f55b9933f64aa59
.octa 0x3f7c3b283f7d3aac3f7e13243f7ec46d,0x3f7a1e843f7baccd3f7cfe733f7e1324,0x3f778bc53f79c79d3f7baccd3f7d3aac,0x3f7484223f778bc53f7a1e843f7c3b28,0x3f2736563f3daef93f514d3d3f61c598,0x3f1ebc123f373a233f4cae793f5ebe05,0x3f15f6d93f3085bb3f47de653f5b941a,0x3f0cead03f2994153f42de293f584853
.octa 0x3f7109083f74fa0b3f7853f83f7b14be,0x3f6d1c1d3f7213523f764d973f79c79d,0x3f68bf3c3f6ed89e3f740bdd3f7853f8,0x3f63f4733f6b4b0c3f718f573f76ba07,0x3f039c3d3f2267993f3daef93f54db31,0x3ef41f073f1b02c63f3852163f514d3d,0x3ee0924f3f13682a3f32c8c93f4d9f02,0x3ecc9b8b3f0b9a6b3f2d14693f49d112
.octa 0x3f5ebe053f676bd83f6ed89e3f74fa0b,0x3f591e6a3f633c5a3f6be8583f731447,0x3f5318493f5ebe053f68bf3c3f710908,0x3f4cae793f59f26a3f655e0b3f6ed89e,0x3eb8442a3f039c3d3f2736563f45e403,0x3ea395c53ef6e0cb3f212ff93f41d870,0x3e8e9a223ee633753f1b02c63f3daef9,0x3e72b6513ed536413f14b0393f396842
.octa 0x3f8000003f8000003f8000003f800000,0x3f7eea9d3f7f0e583f7f2f9d3f7f4e6d,0x3f7baccd3f7c3b283f7cbfc93f7d3aac,0x3f764d973f778bc53f78b47b3f79c79d,0x3dc8bd363e47c5c23e94a0313ec3ef15,0x3bc90f883de1bc2e3e5a39973ea09ae5,0xbdafb6803cc90ab03e09cf863e78cfcc,0xbe354098bd7b2b743d6214693e2f10a2
.octa 0x3f6ed89e3f7109083f7314473f74fa0b,0x3f655e0b3f68bf3c3f6be8583f6ed89e,0x3f59f26a3f5ebe053f633c5a3f676bd8,0x3f4cae793f5318493f591e6a3f5ebe05,0xbe888e93be164083bcc90ab03dc8bd36,0xbeb554ecbe6c9a7fbdd53db93cc90ab0,0xbee0924fbea09ae5be3b6ecfbd48fb30,0xbf04f484bec9b953be8586cebdfab273
.octa 0x3f3daef93f45e4033f4d9f023f54db31,0x3f2d14693f373a233f40d0da3f49d112,0x3f1b02c63f2736563f32c8c93f3daef9,0x3f07a1363f15f6d93f239da93f3085bb,0xbf187fc0bef15aeabeac7cd4be47c5c2,0xbf2ac082bf0b9a6bbed25a09be888e93,0xbf3b8f3bbf1d7fd1bef6e0cbbeac7cd4,0xbf4ac77fbf2e3bdebf0cead0becf7bca
.octa 0x3ee633753f039c3d3f13682a3f226799,0x3ebb31a03ee0924f3f0242b13f13682a,0x3e8e9a223eb8442a3ee0924f3f039c3d,0x3e419b373e8e9a223ebb31a03ee63375,0xbf584853bf3daef9bf1d7fd1bef15aea,0xbf63f473bf4bbbf8bf2d1469bf08f59b,0xbf6db293bf584853bf3b8f3bbf187fc0,0xbf756d97bf633c5abf48d8b3bf273656
.octa 0x3f8000003f8000003f8000003f800000,0x3f7e43233f7e70b03f7e9bc93f7ec46d,0x3f7912983f79c79d3f7a73023f7b14be,0x3f7080663f7213523f73913f3f74fa0b,0xbe94a031be47c5c2bdc8bd3600000000,0xbecc9b8bbe9aa086be4dee60bdc8bd36,0xbf00e7e4becf7bcabe9aa086be47c5c2,0xbf19c200bf00e7e4becc9b8bbe94a031
.octa 0x3f64aa593f676bd83f6a09a73f6c835e,0x3f55b9933f59f26a3f5df6be3f61c598,0x3f43e2003f49d1123f4f7a1f3f54db31,0x3f2f61a53f373a233f3ebc1b3f45e403,0xbf3085bbbf187fc0befc5d27bec3ef15,0xbf44e3f5bf2e3bdebf14b039bef15aea,0xbf5695e5bf41d870bf299415bf0e39da,0xbf655e0bbf531849bf3ca003bf226799
.octa 0x3f187fc03f2267993f2beb4a3f3504f3,0x3eff17b23f0b9a6b3f173c073f226799,0x3ec9b9533ee633753f00e7e43f0e39da,0x3e919ddd3eb263ef3ed25a093ef15aea,0xbf710908bf61c598bf4d9f02bf3504f3,0xbf796e4ebf6db293bf5c61c7bf45e403,0xbf7e70b0bf76ba07bf68bf3cbf54db31,0xbf7ffec4bf7cbfc9bf7294f8bf61c598
.octa 0x3e2f10a23e78cfcc3ea09ae53ec3ef15,0x3d6214693e09cf863e5a39973e94a031,0xbd7b2b743cc90ab03de1bc2e3e47c5c2,0xbe354098bdafb6803bc90f883dc8bd36,0xbf7e1324bf7fb10fbf79c79dbf6c835e,0xbf78b47bbf7f84abbf7e4323bf74fa0b,0xbf6ff573bf7c3b28bf7ffb11bf7b14be,0xbf63f473bf75dec6bf7eea9dbf7ec46d
.octa 0x3f8000003f8000003f8000003f800000,0x3f7c7eb03f7cbfc93f7cfe733f7d3aac,0x3f7213523f7314473f740bdd3f74fa0b,0x3f6106f23f633c5a3f655e0b3f676bd8,0xbf61c598bf54db31bf45e403bf3504f3,0xbf7294f8bf68bf3cbf5c61c7bf4d9f02,0xbf7cbfc9bf76ba07bf6db293bf61c598,0xbf7ffec4bf7e70b0bf796e4ebf710908
.octa 0x3f49d1123f4d9f023f514d3d3f54db31,0x3f2d14693f32c8c93f3852163f3daef9,0x3f0b9a6b3f13682a3f1b02c63f226799,0x3ecc9b8b3ee0924f3ef41f073f039c3d,0xbf7c3b28bf7fb10fbf7f4e6dbf7b14be,0xbf718f57bf7a7302bf7f2f9dbf7fb10f,0xbf604621bf6ed89ebf791298bf7ec46d,0xbf48d8b3bf5d2d53bf6d1c1dbf7853f8
.octa 0x3e78cfcc3e94a0313eac7cd43ec3ef15,0x3da3308c3e09cf863e419b373e78cfcc,0xbdafb680bcc90ab03d16c32c3dc8bd36,0xbe7ee6e1be3b6ecfbdee3876bd48fb30,0xbf2beb4abf45e403bf5b941abf6c835e,0xbf0a48adbf299415bf44e3f5bf5b941a,0xbec9b953bf08f59bbf299415bf45e403,0xbe72b651bec9b953bf0a48adbf2beb4a
.octa 0xbecf7bcabeac7cd4be888e93be47c5c2,0xbf0cead0bef6e0cbbed25a09beac7cd4,0xbf2e3bdebf1d7fd1bf0b9a6bbef15aea,0xbf4ac77fbf3b8f3bbf2ac082bf187fc0,0xbd96a905be78cfccbecf7bcabf0e39da,0x3dbc3ac3bdafb680be8586cebedae880,0x3e827dc03d96a905bde1bc2ebe94a031,0x3ed25a093e6c9a7f3d2fe007be164083
.octa 0x3f8000003f8000003f8000003f800000,0x3f7d74743f7dabcc3f7de0b13f7e1324,0x3f75dec63f76ba073f778bc53f7853f8,0x3f6965913f6b4b0c3f6d1c1d3f6ed89e,0xbf226799bf0e39dabef15aeabec3ef15,0xbf3ca003bf299415bf14b039befc5d27,0xbf531849bf41d870bf2e3bdebf187fc0,0xbf655e0bbf5695e5bf44e3f5bf3085bb
.octa 0x3f5848533f5b941a3f5ebe053f61c598,0x3f42de293f47de653f4cae793f514d3d,0x3f2994153f3085bb3f373a233f3daef9,0x3f0cead03f15f6d93f1ebc123f273656,0xbf731447bf676bd8bf584853bf45e403,0xbf7bf531bf740bddbf6816a8bf584853,0xbf7fd397bf7c3b28bf740bddbf676bd8,0xbf7e9bc9bf7fd397bf7bf531bf731447
.octa 0x3edae8803ef15aea3f039c3d3f0e39da,0x3e97a1173eb263ef3ecc9b8b3ee63375,0x3e22abb63e605c133e8e9a223eac7cd4,0x3c96c9b63dafb6803e1c76de3e605c13,0xbf7853f8bf7ec46dbf7fb10fbf7b14be,0xbf6d1c1dbf791298bf7f2f9dbf7f4e6d,0xbf5d2d53bf6ed89ebf7a7302bf7fb10f,0xbf48d8b3bf604621bf718f57bf7c3b28
.octa 0xbdfab273bd48fb303cc90ab03dc8bd36,0xbe8586cebe3b6ecfbdd53db9bcc90ab0,0xbec9b953bea09ae5be6c9a7fbe164083,0xbf04f484bee0924fbeb554ecbe888e93,0xbf3085bbbf4d9f02bf64aa59bf74fa0b,0xbf14b039bf373a23bf53fac3bf6a09a7,0xbeebcbbbbf1d7fd1bf3fc767bf5b941a,0xbea986c4bf00e7e4bf286605bf49d112
.octa 0x3f8000003f8000003f8000003f800000,0x3f7b61fc3f7baccd3f7bf5313f7c3b28,0x3f6db2933f6ed89e3f6ff5733f710908,0x3f5770263f59f26a3f5c61c73f5ebe05,0xbf7ec46dbf7b14bebf74fa0bbf6c835e,0xbf7eea9dbf7ffb11bf7e4323bf79c79d,0xbf75dec6bf7c3b28bf7f84abbf7fb10f,0xbf63f473bf6ff573bf78b47bbf7e1324
.octa 0x3f3968423f3daef93f41d8703f45e403,0x3f14b0393f1b02c63f212ff93f273656,0x3ed536413ee633753ef6e0cb3f039c3d,0x3e72b6513e8e9a223ea395c53eb8442a,0xbf49d112bf5b941abf6a09a7bf74fa0b,0xbf286605bf3fc767bf53fac3bf64aa59,0xbf00e7e4bf1d7fd1bf373a23bf4d9f02,0xbea986c4beebcbbbbf14b039bf3085bb
.octa 0x3d48fb303dc8bd363e1640833e47c5c2,0xbe1008b7bdafb680bcfb49ba3cc90ab0,0xbea68f12be888e93be541501be164083,0xbeff17b2bee0924fbec1071ebea09ae5,0xbe164083be94a031bedae880bf0e39da,0x3d2fe007bde1bc2ebe8586cebecf7bca,0x3e6c9a7f3d96a905bdafb680be78cfcc,0x3ed25a093e827dc03dbc3ac3bd96a905
.octa 0xbf273656bf187fc0bf08f59bbef15aea,0xbf48d8b3bf3b8f3bbf2d1469bf1d7fd1,0xbf633c5abf584853bf4bbbf8bf3daef9,0xbf756d97bf6db293bf63f473bf584853,0x3f13682a3edae8803e888e933dc8bd36,0x3f3852163f15f6d93eddbe793e888e93,0x3f5695e53f3968423f15f6d93edae880,0x3f6d1c1d3f5695e53f3852163f13682a
.octa 0x0,0x3c96c9b63c490e903bc90f8800000000,0x3d16c32c3cc90ab03c490e9000000000,0x3d6214693d16c32c3c96c9b600000000,0x3e94a0313e47c5c23dc8bd3600000000,0x3e9d9e783e5415013dd53db900000000,0x3ea68f123e605c133de1bc2e00000000,0x3eaf713a3e6c9a7f3dee387600000000
.octa 0x3d96a9053d48fb303cc90ab000000000,0x3dbc3ac33d7b2b743cfb49ba00000000,0x3de1bc2e3d96a9053d16c32c00000000,0x3e0395023dafb6803d2fe00700000000,0x3eb8442a3e78cfcc3dfab27300000000,0x3ec1071e3e827dc03e03950200000000,0x3ec9b9533e888e933e09cf8600000000,0x3ed25a093e8e9a223e1008b700000000
.octa 0x3e1640833dc8bd363d48fb3000000000,0x3e28defc3de1bc2e3d62146900000000,0x3e3b6ecf3dfab2733d7b2b7400000000,0x3e4dee603e09cf863d8a200a00000000,0x3edae8803e94a0313e16408300000000,0x3ee363fa3e9aa0863e1c76de00000000,0x3eebcbbb3ea09ae53e22abb600000000,0x3ef41f073ea68f123e28defc00000000
.octa 0x3e605c133e1640833d96a90500000000,0x3e72b6513e22abb63da3308c00000000,0x3e827dc03e2f10a23dafb68000000000,0x3e8b95073e3b6ecf3dbc3ac300000000,0x3efc5d273eac7cd43e2f10a200000000,0x3f0242b13eb263ef3e35409800000000,0x3f064b823eb8442a3e3b6ecf00000000,0x3f0a48ad3ebe1d4a3e419b3700000000
.octa 0x0,0x3d8a200a3d7b2b743d6214693d48fb30,0x3e09cf863dfab2733de1bc2e3dc8bd36,0x3e4dee603e3b6ecf3e28defc3e164083,0x3f61c5983f54db313f45e4033f3504f3,0x3f6965913f5d2d533f4e8d903f3daef9,0x3f6ff5733f64aa593f5695e53f45e403,0x3f756d973f6b4b0c3f5df6be3f4d9f02
.octa 0x3e888e933e78cfcc3e605c133e47c5c2,0x3ea986c43e9aa0863e8b95073e78cfcc,0x3ec9b9533eb8442a3ea68f123e94a031,0x3ee900b73ed536413ec1071e3eac7cd4,0x3f79c79d3f7109083f64aa593f54db31,0x3f7cfe733f75dec63f6aab7b3f5b941a,0x3f7f0e583f79c79d3f6ff5733f61c598,0x3f7ff4e63f7cbfc93f7484223f676bd8
.octa 0x3f039c3d3ef15aea3edae8803ec3ef15,0x3f121eb03f064b823ef41f073edae880,0x3f1ff6cb3f13682a3f064b823ef15aea,0x3f2d14693f1ff6cb3f121eb03f039c3d,0x3f7fb10f3f7ec46d3f7853f83f6c835e,0x3f7e43233f7fd3973f7b61fc3f710908,0x3f7baccd3f7fec433f7dabcc3f74fa0b,0x3f77f1103f7f0e583f7f2f9d3f7853f8
.octa 0x3f3968423f2beb4a3f1d7fd13f0e39da,0x3f44e3f53f373a233f2866053f187fc0,0x3f4f7a1f3f41d8703f32c8c93f226799,0x3f591e6a3f4bbbf83f3ca0033f2beb4a,0x3f7314473f7d3aac3f7fec433f7b14be,0x3f6d1c1d3f7a73023f7fe1293f7d3aac,0x3f660f883f76ba073f7f0e583f7ec46d,0x3f5df6be3f7213523f7d74743f7fb10f
.octa 0x0,0x3d2fe0073d16c32c3cfb49ba3cc90ab0,0x3dafb6803d96a9053d7b2b743d48fb30,0x3e0395023de1bc2e3dbc3ac33d96a905,0x3f2267993f0e39da3ef15aea3ec3ef15,0x3f2ac0823f15f6d93eff17b23ecf7bca,0x3f32c8c93f1d7fd13f064b823edae880,0x3f3a7ca43f24d2253f0cead03ee63375
.octa 0x3e2f10a23e1640833dfab2733dc8bd36,0x3e5a39973e3b6ecf3e1c76de3dfab273,0x3e827dc03e605c133e3b6ecf3e164083,0x3e97a1173e827dc03e5a39973e2f10a2,0x3f41d8703f2beb4a3f13682a3ef15aea,0x3f48d8b33f32c8c93f19c2003efc5d27,0x3f4f7a1f3f3968423f1ff6cb3f039c3d,0x3f55b9933f3fc7673f26050a3f08f59b
.octa 0x3eac7cd43e94a0313e78cfcc3e47c5c2,0x3ec1071e3ea68f123e8b95073e605c13,0x3ed536413eb8442a3e9aa0863e78cfcc,0x3ee900b73ec9b9533ea986c43e888e93,0x3f5b941a3f45e4033f2beb4a3f0e39da,0x3f6106f23f4bbbf83f31a81d3f13682a,0x3f660f883f514d3d3f373a233f187fc0,0x3f6aab7b3f5695e53f3ca0033f1d7fd1
.octa 0x3efc5d273edae8803eb8442a3e94a031,0x3f07a1363eebcbbb3ec6d5293ea09ae5,0x3f10d3cd3efc5d273ed536413eac7cd4,0x3f19c2003f064b823ee363fa3eb8442a,0x3f6ed89e3f5b941a3f41d8703f226799,0x3f7294f83f6046213f46e22a3f273656,0x3f75dec63f64aa593f4bbbf83f2beb4a,0x3f78b47b3f68bf3c3f5064af3f3085bb
.octa 0x0,0x3dbc3ac33dafb6803da3308c3d96a905,0x3e3b6ecf3e2f10a23e22abb63e164083,0x3e8b95073e827dc03e72b6513e605c13,0x3f7ec46d3f7b14be3f74fa0b3f6c835e,0x3f7ffec43f7e70b03f7a1e843f731447,0x3f7f0e583f7fec433f7dabcc3f7853f8,0x3f7bf5313f7f84ab3f7f9c183f7c3b28
.octa 0x3eb8442a3eac7cd43ea09ae53e94a031,0x3ee363fa3ed536413ec6d5293eb8442a,0x3f064b823efc5d273eebcbbb3edae880,0x3f19c2003f10d3cd3f07a1363efc5d27,0x3f76ba073f7d3aac3f7fec433f7ec46d,0x3f6f68303f7912983f7e9bc93f7fec43,0x3f660f883f7314473f7baccd3f7fb10f,0x3f5ac4503f6b4b0c3f7724173f7e1324
.octa 0x3f2beb4a3f2267993f187fc03f0e39da,0x3f3ca0033f32c8c93f2866053f1d7fd1,0x3f4bbbf83f41d8703f373a233f2beb4a,0x3f591e6a3f4f7a1f3f44e3f53f396842,0x3f4d9f023f61c5983f7109083f7b14be,0x3f3ebc1b3f5695e53f6965913f76ba07,0x3f2e3bde3f49d1123f6046213f710908,0x3f1c420c3f3b8f3b3f55b9933f6a09a7
.octa 0x3f64aa593f5b941a3f514d3d3f45e403,0x3f6e46be3f660f883f5c61c73f514d3d,0x3f75dec63f6ed89e3f660f883f5b941a,0x3f7b61fc3f75dec63f6e46be3f64aa59,0x3f08f59b3f2beb4a3f49d1123f61c598,0x3ee900b73f1b02c63f3ca0033f584853,0x3ebe1d4a3f08f59b3f2e3bde3f4d9f02,0x3e919ddd3eebcbbb3f1ebc123f41d870
.octa 0x0,0x3dee38763de1bc2e3dd53db93dc8bd36,0x3e6c9a7f3e605c133e5415013e47c5c2,0x3eaf713a3ea68f123e9d9e783e94a031,0x3f74fa0b3f7b14be3f7ec46d3f800000,0x3f6aab7b3f740bdd3f7ac5163f7ec46d,0x3f5d2d533f6a09a73f740bdd3f7b14be,0x3f4cae793f5d2d533f6aab7b3f74fa0b
.octa 0x3ee633753edae8803ecf7bca3ec3ef15,0x3f0cead03f064b823eff17b23ef15aea,0x3f24d2253f1d7fd13f15f6d93f0e39da,0x3f3a7ca43f32c8c93f2ac0823f226799,0x3f3968423f4d9f023f5ebe053f6c835e,0x3f239da93f3b8f3b3f5064af3f61c598,0x3f0b9a6b3f2736563f3fc7673f54db31,0x3ee363fa3f10d3cd3f2d14693f45e403
.octa 0x3f4d9f023f45e4033f3daef93f3504f3,0x3f5df6be3f5695e53f4e8d903f45e403,0x3f6b4b0c3f64aa593f5d2d533f54db31,0x3f756d973f6ff5733f6965913f61c598,0x3eac7cd43ef15aea3f187fc03f3504f3,0x3e667c663ebe1d4a3f0242b13f226799,0x3de1bc2e3e888e933ed536413f0e39da,0xbbc90f883e22abb63ea395c53ef15aea
.octa 0x3f7c3b283f7853f83f7314473f6c835e,0x3f7f9c183f7dabcc3f7a1e843f74fa0b,0x3f7f84ab3f7fec433f7e70b03f7b14be,0x3f7bf5313f7f0e583f7ffec43f7ec46d,0xbdfab2733d48fb303e605c133ec3ef15,0xbe72b651bd7b2b743dee38763e94a031,0xbeb263efbe2f10a23c490e903e47c5c2,0xbee900b7be8e9a22bdbc3ac33dc8bd36
.octa 0x0,0x3e28defc3e22abb63e1c76de3e164083,0x3ea68f123ea09ae53e9aa0863e94a031,0x3ef41f073eebcbbb3ee363fa3edae880,0x3ef15aea3f0e39da3f2267993f3504f3,0x3ea395c53ed536413f0242b13f187fc0,0x3e22abb63e888e933ebe1d4a3ef15aea,0xbbc90f883de1bc2e3e667c663eac7cd4
.octa 0x3f1d7fd13f187fc03f13682a3f0e39da,0x3f3ca0033f373a233f31a81d3f2beb4a,0x3f5695e53f514d3d3f4bbbf83f45e403,0x3f6aab7b3f660f883f6106f23f5b941a,0xbe2f10a2bd48fb303d96a9053e47c5c2,0xbea986c4be541501bda3308c3d48fb30,0xbef6e0cbbeb8442abe6c9a7fbdc8bd36,0xbf1ebc12bf00e7e4bec1071ebe78cfcc
.octa 0x3f7853f83f74fa0b3f7109083f6c835e,0x3f7f2f9d3f7dabcc3f7b61fc3f7853f8,0x3f7f0e583f7fec433f7fd3973f7ec46d,0x3f77f1103f7baccd3f7e43233f7fb10f,0xbf3daef9bf226799bf039c3dbec3ef15,0xbf577026bf3fc767bf239da9bf039c3d,0xbf6b4b0cbf584853bf3fc767bf226799,0xbf78b47bbf6b4b0cbf577026bf3daef9
.octa 0x3f6a09a73f7109083f76ba073f7b14be,0x3f55b9933f6046213f6965913f710908,0x3f3b8f3b3f49d1123f5695e53f61c598,0x3f1c420c3f2e3bde3f3ebc1b3f4d9f02,0xbf7f4e6dbf7853f8bf6a09a7bf54db31,0xbf7eea9dbf7f0e58bf772417bf676bd8,0xbf778bc5bf7f4e6dbf7e70b0bf74fa0b,0xbf696591bf791298bf7fc38fbf7d3aac
.octa 0x0,0x3e1008b73e09cf863e0395023dfab273,0x3e8e9a223e888e933e827dc03e78cfcc,0x3ed25a093ec9b9533ec1071e3eb8442a,0x3f45e4033f54db313f61c5983f6c835e,0x3f2d14693f3fc7673f5064af3f5ebe05,0x3f10d3cd3f2736563f3b8f3b3f4d9f02,0x3ee363fa3f0b9a6b3f239da93f396842
.octa 0x3f08f59b3f039c3d3efc5d273ef15aea,0x3f26050a3f1ff6cb3f19c2003f13682a,0x3f3fc7673f3968423f32c8c93f2beb4a,0x3f55b9933f4f7a1f3f48d8b33f41d870,0x3ea09ae53edae8803f08f59b3f226799,0x3e3540983e9aa0863ed8106b3f08f59b,0x3d16c32c3e2f10a23e9aa0863edae880,0xbdd53db93d16c32c3e3540983ea09ae5
.octa 0x3f676bd83f61c5983f5b941a3f54db31,0x3f7484223f6ff5733f6aab7b3f64aa59,0x3f7cbfc93f79c79d3f75dec63f710908,0x3f7ff4e63f7f0e583f7cfe733f79c79d,0xbe78cfccbdc8bd363d48fb303e47c5c2,0xbec1071ebe6c9a7fbda3308c3d96a905,0xbf00e7e4beb8442abe541501bd48fb30,0xbf1ebc12bef6e0cbbea986c4be2f10a2
.octa 0x3f7e13243f7fb10f3f7fec433f7ec46d,0x3f7724173f7baccd3f7e9bc93f7fec43,0x3f6b4b0c3f7314473f7912983f7d3aac,0x3f5ac4503f660f883f6f68303f76ba07,0xbf396842bf187fc0bee63375be94a031,0xbf5064afbf32c8c9bf0f8784becf7bca,0xbf633c5abf49d112bf299415bf039c3d,0xbf718f57bf5d2d53bf40d0dabf1d7fd1
.octa 0x0,0x3e419b373e3b6ecf3e3540983e2f10a2,0x3ebe1d4a3eb8442a3eb263ef3eac7cd4,0x3f0a48ad3f064b823f0242b13efc5d27,0x3dc8bd363e47c5c23e94a0313ec3ef15,0xbdbc3ac33c490e903dee38763e605c13,0xbe8e9a22be2f10a2bd7b2b743d48fb30,0xbee900b7beb263efbe72b651bdfab273
.octa 0x3f3085bb3f2beb4a3f2736563f226799,0x3f5064af3f4bbbf83f46e22a3f41d870,0x3f68bf3c3f64aa593f6046213f5b941a,0x3f78b47b3f75dec63f7294f83f6ed89e,0xbf1d7fd1bf039c3dbecf7bcabe94a031,0xbf40d0dabf299415bf0f8784bee63375,0xbf5d2d53bf49d112bf32c8c9bf187fc0,0xbf718f57bf633c5abf5064afbf396842
.octa 0x3f7fb10f3f7ec46d3f7d3aac3f7b14be,0x3f7d74743f7f0e583f7fe1293f7fec43,0x3f7213523f76ba073f7a73023f7d3aac,0x3f5df6be3f660f883f6d1c1d3f731447,0xbf7d3aacbf74fa0bbf676bd8bf54db31,0xbf7fc38fbf7e70b0bf772417bf6a09a7,0xbf791298bf7f4e6dbf7f0e58bf7853f8,0xbf696591bf778bc5bf7eea9dbf7f4e6d
.octa 0x3f41d8703f4d9f023f5848533f61c598,0x3f1ebc123f2e3bde3f3ca0033f49d112,0x3eebcbbb3f08f59b3f1b02c63f2beb4a,0x3e919ddd3ebe1d4a3ee900b73f08f59b,0xbf514d3dbf676bd8bf76ba07bf7ec46d,0xbf31a81dbf4f7a1fbf66beccbf76ba07,0xbf0b9a6bbf3085bbbf4f7a1fbf676bd8,0xbec1071ebf0b9a6bbf31a81dbf514d3d
.octa 0x5e00000000000000080,0x5a00000004000000084,0x5600000008000000088,0x520000000c00000008c,0x1e00000040000000090,0x1a00000044000000094,0x1600000048000000098,0x120000004c00000009c
.octa 0x4e000000100000000a0,0x4a000000140000000a4,0x46000000180000000a8,0x420000001c0000000ac,0xe000000500000000b0,0xa000000540000000b4,0x6000000580000000b8,0x20000005c0000000bc
.octa 0x5f000000010000000c0,0x5b000000050000000c4,0x57000000090000000c8,0x530000000d0000000cc,0x1f000000410000000d0,0x1b000000450000000d4,0x17000000490000000d8,0x130000004d0000000dc
.octa 0x4f000000110000000e0,0x4b000000150000000e4,0x47000000190000000e8,0x430000001d0000000ec,0xf000000510000000f0,0xb000000550000000f4,0x7000000590000000f8,0x30000005d0000000fc
.octa 0x5c00000002000000004,0x5800000006000000008,0x540000000a00000000c,0x500000000e000000020,0x1c00000042000000014,0x1800000046000000018,0x140000004a00000001c,0x100000004e000000030
.octa 0x4c00000012000000024,0x4800000016000000028,0x440000001a00000002c,0x400000001e000000040,0xc00000052000000034,0x800000056000000038,0x40000005a00000003c,0x5e000000050
.octa 0x5d00000003000000044,0x5900000007000000048,0x550000000b00000004c,0x510000000f000000060,0x1d00000043000000054,0x1900000047000000058,0x150000004b00000005c,0x110000004f000000070
.octa 0x4d00000013000000064,0x4900000017000000068,0x450000001b00000006c,0x410000001f000000010,0xd00000053000000074,0x900000057000000078,0x50000005b00000007c,0x10000005f000000000
.octa 0x3f803f803f803f803f803f803f803f80,0xbf803f80bf803f80bf803f80bf803f80,0x3e483ec43f0e3f353f553f6d3f7b3f80,0xbf7bbf6dbf55bf35bf0ebec4be488000,0xbf6dbf35bec400003ec43f353f6d3f80,0xbec4bf35bf6dbf80bf6dbf35bec48000,0xbf0ebf6dbf7bbf35be483ec43f553f80,0x3f553ec4be48bf35bf7bbf6dbf0e8000
.octa 0x3f350000bf35bf80bf3500003f353f80,0x3f353f803f358000bf35bf80bf358000,0x3f553f6d3e48bf35bf7bbec43f0e3f80,0xbf0e3ec43f7b3f35be48bf6dbf558000,0xbec43f353f6d0000bf6dbf353ec43f80,0xbf6dbf353ec43f803ec4bf35bf6d8000,0xbf7bbec43f553f35bf0ebf6d3e483f80,0x3e48bf6dbf0e3f353f55bec4bf7b8000
.octa 0xbf8000003f800000bf8000003f80,0x3f808000bf8080003f808000bf808000,0x3f7bbec4bf553f353f0ebf6dbe483f80,0x3e483f6dbf0ebf353f553ec4bf7b8000,0x3ec43f35bf6d00003f6dbf35bec43f80,0xbf6d3f353ec4bf803ec43f35bf6d8000,0xbf553f6dbe48bf353f7bbec4bf0e3f80,0xbf0ebec43f7bbf35be483f6dbf558000
.octa 0xbf3500003f35bf803f350000bf353f80,0x3f35bf803f358000bf353f80bf358000,0x3f0ebf6d3f7bbf353e483ec4bf553f80,0x3f55bec4be483f35bf7b3f6dbf0e8000,0x3f6dbf353ec40000bec43f35bf6d3f80,0xbec43f35bf6d3f80bf6d3f35bec48000,0xbe483ec4bf0e3f35bf553f6dbf7b3f80,0xbf7b3f6dbf553f35bf0e3ec4be488000
.octa 0x3f803f803f803f803f803f803f803f80,0xbf803f80bf803f80bf803f80bf803f80,0xbf7bbf6dbf55bf35bf0ebec4be480000,0xbe48bec4bf0ebf35bf55bf6dbf7bbf80,0x3f6d3f353ec40000bec4bf35bf6dbf80,0x3ec43f353f6d3f803f6d3f353ec48000,0xbf55bec43e483f353f7b3f6d3f0e0000,0xbf0ebf6dbf7bbf35be483ec43f553f80
.octa 0x3f350000bf35bf80bf3500003f353f80,0x3f353f803f358000bf35bf80bf358000,0xbf0e3ec43f7b3f35be48bf6dbf550000,0xbf55bf6dbe483f353f7b3ec4bf0ebf80,0x3ec4bf35bf6d00003f6d3f35bec4bf80,0x3f6d3f35bec4bf80bec43f353f6d8000,0xbe483f6d3f0ebf35bf553ec43f7b0000,0xbf7bbec43f553f35bf0ebf6d3e483f80
.octa 0xbf8000003f800000bf8000003f80,0x3f808000bf8080003f808000bf808000,0x3e483f6dbf0ebf353f553ec4bf7b0000,0xbf7b3ec43f55bf35bf0e3f6d3e48bf80,0xbec4bf353f6d0000bf6d3f353ec4bf80,0x3f6dbf35bec43f80bec4bf353f6d8000,0x3f0e3ec4bf7b3f353e48bf6d3f550000,0xbf553f6dbe48bf353f7bbec4bf0e3f80
.octa 0xbf3500003f35bf803f350000bf353f80,0x3f35bf803f358000bf353f80bf358000,0x3f55bec4be483f35bf7b3f6dbf0e0000,0xbf0e3f6dbf7b3f35be48bec43f55bf80,0xbf6d3f35bec400003ec4bf353f6dbf80,0x3ec4bf353f6dbf803f6dbf353ec48000,0x3f7bbf6d3f55bf353f0ebec43e480000,0xbe483ec4bf0e3f35bf553f6dbf7b3f80
.octa 0x3f803f803f803f803f803f803f803f80,0xbf803f80bf803f80bf803f80bf803f80,0xbe48bec4bf0ebf35bf55bf6dbf7bbf80,0x3f7b3f6d3f553f353f0e3ec43e488000,0xbf6dbf35bec400003ec43f353f6d3f80,0xbec4bf35bf6dbf80bf6dbf35bec48000,0x3f0e3f6d3f7b3f353e48bec4bf55bf80,0xbf55bec43e483f353f7b3f6d3f0e8000
.octa 0x3f350000bf35bf80bf3500003f353f80,0x3f353f803f358000bf35bf80bf358000,0xbf55bf6dbe483f353f7b3ec4bf0ebf80,0x3f0ebec4bf7bbf353e483f6d3f558000,0xbec43f353f6d0000bf6dbf353ec43f80,0xbf6dbf353ec43f803ec4bf35bf6d8000,0x3f7b3ec4bf55bf353f0e3f6dbe48bf80,0xbe483f6d3f0ebf35bf553ec43f7b8000
.octa 0xbf8000003f800000bf8000003f80,0x3f808000bf8080003f808000bf808000,0xbf7b3ec43f55bf35bf0e3f6d3e48bf80,0xbe48bf6d3f0e3f35bf55bec43f7b8000,0x3ec43f35bf6d00003f6dbf35bec43f80,0xbf6d3f353ec4bf803ec43f35bf6d8000,0x3f55bf6d3e483f35bf7b3ec43f0ebf80,0x3f0e3ec4bf7b3f353e48bf6d3f558000
.octa 0xbf3500003f35bf803f350000bf353f80,0x3f35bf803f358000bf353f80bf358000,0xbf0e3f6dbf7b3f35be48bec43f55bf80,0xbf553ec43e48bf353f7bbf6d3f0e8000,0x3f6dbf353ec40000bec43f35bf6d3f80,0xbec43f35bf6d3f80bf6d3f35bec48000,0x3e48bec43f0ebf353f55bf6d3f7bbf80,0x3f7bbf6d3f55bf353f0ebec43e488000
.octa 0x3f803f803f803f803f803f803f803f80,0xbf803f80bf803f80bf803f80bf803f80,0x3f7b3f6d3f553f353f0e3ec43e480000,0x3e483ec43f0e3f353f553f6d3f7b3f80,0x3f6d3f353ec40000bec4bf35bf6dbf80,0x3ec43f353f6d3f803f6d3f353ec48000,0x3f553ec4be48bf35bf7bbf6dbf0e0000,0x3f0e3f6d3f7b3f353e48bec4bf55bf80
.octa 0x3f350000bf35bf80bf3500003f353f80,0x3f353f803f358000bf35bf80bf358000,0x3f0ebec4bf7bbf353e483f6d3f550000,0x3f553f6d3e48bf35bf7bbec43f0e3f80,0x3ec4bf35bf6d00003f6d3f35bec4bf80,0x3f6d3f35bec4bf80bec43f353f6d8000,0x3e48bf6dbf0e3f353f55bec4bf7b0000,0x3f7b3ec4bf55bf353f0e3f6dbe48bf80
.octa 0xbf8000003f800000bf8000003f80,0x3f808000bf8080003f808000bf808000,0xbe48bf6d3f0e3f35bf55bec43f7b0000,0x3f7bbec4bf553f353f0ebf6dbe483f80,0xbec4bf353f6d0000bf6d3f353ec4bf80,0x3f6dbf35bec43f80bec4bf353f6d8000,0xbf0ebec43f7bbf35be483f6dbf550000,0x3f55bf6d3e483f35bf7b3ec43f0ebf80
.octa 0xbf3500003f35bf803f350000bf353f80,0x3f35bf803f358000bf353f80bf358000,0xbf553ec43e48bf353f7bbf6d3f0e0000,0x3f0ebf6d3f7bbf353e483ec4bf553f80,0xbf6d3f35bec400003ec4bf353f6dbf80,0x3ec4bf353f6dbf803f6dbf353ec48000,0xbf7b3f6dbf553f35bf0e3ec4be480000,0x3e48bec43f0ebf353f55bf6d3f7bbf80
.octa 0x0,0x0,0x0,0x0,0x0,0x0,0x0,0x0
.octa 0x0,0x0,0x0,0x0,0x0,0x0,0x0,0x0
.octa 0x0,0x0,0x0,0x0,0x0,0x0,0x0,0x0
.octa 0x0,0x0,0x0,0x0,0x0,0x0,0x0,0x0
.octa 0x0,0x0,0x0,0x0,0x0,0x0,0x0,0x0
.octa 0x0,0x0,0x0,0x0,0x0,0x0,0x0,0x0
.octa 0x0,0x0,0x0,0x0,0x0,0x0,0x0,0x0
.octa 0x0,0x0,0x0,0x0,0x0,0x0,0x0,0x0
.octa 0x0,0x0,0x0,0x0,0x0,0x0,0x0,0x0
.octa 0x0,0x0,0x0,0x0,0x0,0x0,0x0,0x0
.octa 0x0,0x0,0x0,0x0,0x0,0x0,0x0,0x0
.octa 0x0,0x0,0x0,0x0,0x0,0x0,0x0,0x0
.octa 0x0,0x0,0x0,0x0,0x0,0x0,0x0,0x0
.octa 0x0,0x0,0x0,0x0,0x0,0x0,0x0,0x0
.octa 0x0,0x0,0x0,0x0,0x0,0x0,0x0,0x0
.octa 0x0,0x0,0x0,0x0,0x0,0x0,0x0,0x0
.octa 0x0,0x0,0x0,0x0,0x0,0x0,0x0,0x0
.octa 0x0,0x0,0x0,0x0,0x0,0x0,0x0,0x0
.octa 0x0,0x0,0x0,0x0,0x0,0x0,0x0,0x0
.octa 0x0,0x0,0x0,0x0,0x0,0x0,0x0,0x0
.octa 0x0,0x0,0x0,0x0,0x0,0x0,0x0,0x0
.octa 0x0,0x0,0x0,0x0,0x0,0x0,0x0,0x0
.octa 0x0,0x0,0x0,0x0,0x0,0x0,0x0,0x0
.octa 0x0,0x0,0x0,0x0,0x0,0x0,0x0,0x0
.octa 0x0,0x0,0x0,0x0,0x0,0x0,0x0,0x0
.octa 0x0,0x0,0x0,0x0,0x0,0x0,0x0,0x0
.octa 0x0,0x0,0x0,0x0,0x0,0x0,0x0,0x0
.octa 0x0,0x0,0x0,0x0,0x0,0x0,0x0,0x0
.octa 0x0,0x0,0x0,0x0,0x0,0x0,0x0,0x0
.octa 0x0,0x0,0x0,0x0,0x0,0x0,0x0,0x0
.octa 0x0,0x0,0x0,0x0,0x0,0x0,0x0,0x0
.octa 0x0,0x0,0x0,0x0,0x0,0x0,0x0,0x0
.octa 0x3f463f553f623f6d3f753f7b3f7f3f80,0xbf22bf0ebef1bec4be95be48bdc98000,0xbef1be483dc93ec43f223f553f753f80,0xbf62bf7bbf7fbf6dbf46bf0ebe958000,0xbf75bf7bbf46bec43dc93f0e3f623f80,0x3e95be48bf22bf6dbf7fbf55bef18000,0x3dc9bf0ebf75bf6dbef13e483f463f80,0x3f7f3f553e95bec4bf62bf7bbf228000
.octa 0x3f7f3f0ebe95bf6dbf62be483f223f80,0x3dc93f553f753ec4bef1bf7bbf468000,0x3e953f7b3f22bec4bf7fbf0e3ef13f80,0xbf75be483f463f6d3dc9bf55bf628000,0xbf623e483f7f3ec4bf46bf553e953f80,0xbef1bf7bbdc93f6d3f22bf0ebf758000,0xbf22bf553ef13f6dbe95bf7b3dc93f80,0x3f46bf0ebf623ec43f75be48bf7f8000
.octa 0x3f22bf55bef13f6d3e95bf7bbdc93f80,0x3f463f0ebf62bec43f753e48bf7f8000,0x3f623e48bf7f3ec43f46bf55be953f80,0xbef13f7bbdc9bf6d3f223f0ebf758000,0xbe953f7bbf22bec43f7fbf0ebef13f80,0xbf753e483f46bf6d3dc93f55bf628000,0xbf7f3f0e3e95bf6d3f62be48bf223f80,0x3dc9bf553f75bec4bef13f7bbf468000
.octa 0xbdc9bf0e3f75bf6d3ef13e48bf463f80,0x3f7fbf553e953ec4bf623f7bbf228000,0x3f75bf7b3f46bec4bdc93f0ebf623f80,0x3e953e48bf223f6dbf7f3f55bef18000,0x3ef1be48bdc93ec4bf223f55bf753f80,0xbf623f7bbf7f3f6dbf463f0ebe958000,0xbf463f55bf623f6dbf753f7bbf7f3f80,0xbf223f0ebef13ec4be953e48bdc98000
.octa 0x3dc93e483e953ec43ef13f0e3f223f35,0xbf7fbf7bbf75bf6dbf62bf55bf46bf35,0xbe95bf0ebf46bf6dbf7fbf7bbf62bf35,0x3f753f553f223ec43dc9be48bef1bf35,0x3ef13f553f7f3f6d3f223e48be95bf35,0xbf62bf0ebdc93ec43f463f7b3f753f35,0xbf22bf7bbf62bec43e953f553f7f3f35,0x3f463e48bef1bf6dbf75bf0e3dc93f35
.octa 0x3f463f7b3ef1bec4bf75bf55bdc93f35,0xbf223e483f623f6d3e95bf0ebf7fbf35,0xbf62bf553dc93f6d3f46be48bf75bf35,0x3ef1bf0ebf7fbec43f223f7b3e95bf35,0x3f753f0ebf22bf6d3dc93f7b3ef1bf35,0xbe953f553f46bec4bf7fbe483f623f35,0xbf7fbe483f753ec4bf62bf0e3f463f35,0x3dc9bf7bbe953f6d3ef1bf55bf223f35
.octa 0x3f7fbe48bf753ec43f62bf0ebf463f35,0x3dc93f7bbe95bf6d3ef13f55bf22bf35,0xbf753f0e3f22bf6dbdc93f7bbef1bf35,0xbe95bf553f463ec4bf7f3e483f62bf35,0x3f62bf55bdc93f6dbf46be483f75bf35,0x3ef13f0ebf7f3ec43f22bf7b3e953f35,0xbf463f7bbef1bec43f75bf553dc93f35,0xbf22be483f62bf6d3e953f0ebf7f3f35
.octa 0x3f22bf7b3f62bec4be953f55bf7f3f35,0x3f46be48bef13f6dbf753f0e3dc9bf35,0xbef13f55bf7f3f6dbf223e483e95bf35,0xbf623f0ebdc9bec43f46bf7b3f75bf35,0x3e95bf0e3f46bf6d3f7fbf7b3f62bf35,0x3f75bf553f22bec43dc93e48bef13f35,0xbdc93e48be953ec4bef13f0ebf223f35,0xbf7f3f7bbf753f6dbf623f55bf463f35
.octa 0xbf22bf0ebef1bec4be95be48bdc90000,0xbf46bf55bf62bf6dbf75bf7bbf7fbf80,0x3f623f7b3f7f3f6d3f463f0e3e950000,0xbef1be483dc93ec43f223f553f753f80,0x3e95be48bf22bf6dbf7fbf55bef10000,0x3f753f7b3f463ec4bdc9bf0ebf62bf80,0xbf7fbf55be953ec43f623f7b3f220000,0x3dc9bf0ebf75bf6dbef13e483f463f80
.octa 0x3dc93f553f753ec4bef1bf7bbf460000,0xbf7fbf0e3e953f6d3f623e48bf22bf80,0x3f753e48bf46bf6dbdc93f553f620000,0x3e953f7b3f22bec4bf7fbf0e3ef13f80,0xbef1bf7bbdc93f6d3f22bf0ebf750000,0x3f62be48bf7fbec43f463f55be95bf80,0xbf463f0e3f62bec4bf753e483f7f0000,0xbf22bf553ef13f6dbe95bf7b3dc93f80
.octa 0x3f463f0ebf62bec43f753e48bf7f0000,0xbf223f553ef1bf6dbe953f7b3dc9bf80,0x3ef1bf7b3dc93f6dbf22bf0e3f750000,0x3f623e48bf7f3ec43f46bf55be953f80,0xbf753e483f46bf6d3dc93f55bf620000,0x3e95bf7b3f223ec4bf7f3f0e3ef1bf80,0xbdc93f55bf753ec43ef1bf7b3f460000,0xbf7f3f0e3e95bf6d3f62be48bf223f80
.octa 0x3f7fbf553e953ec4bf623f7bbf220000,0x3dc93f0ebf753f6dbef1be483f46bf80,0xbe95be483f22bf6d3f7fbf553ef10000,0x3f75bf7b3f46bec4bdc93f0ebf623f80,0xbf623f7bbf7f3f6dbf463f0ebe950000,0xbef13e483dc9bec43f22bf553f75bf80,0x3f22bf0e3ef1bec43e95be483dc90000,0xbf463f55bf623f6dbf753f7bbf7f3f80
.octa 0xbf7fbf7bbf75bf6dbf62bf55bf46bf35,0xbdc9be48be95bec4bef1bf0ebf22bf35,0xbf75bf55bf22bec4bdc93e483ef13f35,0xbe95bf0ebf46bf6dbf7fbf7bbf62bf35,0xbf62bf0ebdc93ec43f463f7b3f753f35,0xbef1bf55bf7fbf6dbf22be483e953f35,0xbf46be483ef13f6d3f753f0ebdc9bf35,0xbf22bf7bbf62bec43e953f553f7f3f35
.octa 0xbf223e483f623f6d3e95bf0ebf7fbf35,0xbf46bf7bbef13ec43f753f553dc9bf35,0xbef13f0e3f7f3ec4bf22bf7bbe953f35,0xbf62bf553dc93f6d3f46be48bf75bf35,0xbe953f553f46bec4bf7fbe483f623f35,0xbf75bf0e3f223f6dbdc9bf7bbef13f35,0xbdc93f7b3e95bf6dbef13f553f22bf35,0xbf7fbe483f753ec4bf62bf0e3f463f35
.octa 0x3dc93f7bbe95bf6d3ef13f55bf22bf35,0xbf7f3e483f75bec4bf623f0e3f46bf35,0x3e953f55bf46bec43f7fbe48bf623f35,0xbf753f0e3f22bf6dbdc93f7bbef1bf35,0x3ef13f0ebf7f3ec43f22bf7b3e953f35,0xbf623f553dc9bf6d3f463e48bf753f35,0x3f223e48bf623f6dbe95bf0e3f7fbf35,0xbf463f7bbef1bec43f75bf553dc93f35
.octa 0x3f46be48bef13f6dbf753f0e3dc9bf35,0xbf223f7bbf623ec43e95bf553f7fbf35,0x3f62bf0e3dc93ec4bf463f7bbf753f35,0xbef13f55bf7f3f6dbf223e483e95bf35,0x3f75bf553f22bec43dc93e48bef13f35,0xbe953f0ebf463f6dbf7f3f7bbf623f35,0x3f7fbf7b3f75bf6d3f62bf553f46bf35,0xbdc93e48be953ec4bef13f0ebf223f35
.octa 0x3f803f803f803f803f803f803f803f80,0xbcb0bc97bc7bbc49bc17bbc9bb498000,0x3e323ebb3f0b3f333f543f6c3f7b3f80,0xbf7cbf6ebf57bf37bf10bec7be4b8000,0xbf6fbf38becbbc493ec03f343f6c3f80,0xbebabf32bf6bbf80bf6dbf36bec58000,0xbf0abf6bbf7cbf37be513ec13f543f80,0x3f583ecdbe38bf33bf7bbf6dbf0f8000
.octa 0x3f393c97bf32bf80bf37bbc93f343f80,0x3f313f803f383c49bf33bf80bf368000,0x3f523f6e3e57bf33bf7cbec73f0e3f80,0xbf133ebb3f7a3f37be3fbf6cbf558000,0xbece3f323f6e3c49bf6cbf363ec23f80,0xbf6abf383ebd3f803ec8bf34bf6d8000,0xbf7abecd3f533f37bf0cbf6d3e453f80,0x3e5dbf6bbf113f333f56bec1bf7b8000
.octa 0x3cb0bf80bc7b3f803c17bf80bb493f80,0x3f803c97bf80bc493f803bc9bf808000,0x3f7cbebbbf573f333f10bf6cbe4b3f80,0x3e323f6ebf0bbf373f543ec7bf7b8000,0x3eba3f38bf6bbc493f6dbf34bec53f80,0xbf6f3f323ecbbf803ec03f36bf6c8000,0xbf583f6bbe38bf373f7bbec1bf0f3f80,0xbf0abecd3f7cbf33be513f6dbf548000
.octa 0xbf31bc973f38bf803f333bc9bf363f80,0x3f39bf803f323c49bf373f80bf348000,0x3f13bf6e3f7abf333e3f3ec7bf553f80,0x3f52bebbbe573f37bf7c3f6cbf0e8000,0x3f6abf323ebd3c49bec83f36bf6d3f80,0xbece3f38bf6e3f80bf6c3f34bec28000,0xbe5d3ecdbf113f37bf563f6dbf7b3f80,0xbf7a3f6bbf533f33bf0c3ec1be458000
.octa 0x3f803f803f803f803f803f803f803f80,0xbd3cbd30bd23bd17bd0abcfbbce2bcc9,0xbf7dbf71bf5abf3cbf15bed2be63bcc9,0xbe19beafbf06bf2ebf50bf69bf7abf80,0x3f713f3d3ed73d17beb4bf2fbf6abf80,0x3eae3f2d3f683f803f703f3a3ed13cc9,0xbf5bbed83e203f2e3f793f6f3f143cc9,0xbf04bf68bf7dbf3cbe6a3eb53f513f80
.octa 0x3f3d3d30bf2ebf80bf3bbcfb3f303f80,0x3f2d3f803f3c3d17bf2fbf80bf3abcc9,0xbf183eaf3f793f3cbe26bf69bf59bcc9,0xbf4ebf71be703f2e3f7d3ed2bf08bf80,0x3ed9bf2dbf70bd173f693f3abeb7bf80,0x3f683f3dbeb1bf80bed43f2f3f6f3cc9,0xbe763f683f17bf2ebf5a3eb53f7c3cc9,0xbf79bed83f4f3f3cbf07bf6f3e2c3f80
.octa 0x3d3cbf80bd233f803d0abf80bce23f80,0x3f803d30bf80bd173f803cfbbf80bcc9,0x3e193f71bf06bf3c3f503ed2bf7abcc9,0xbf7d3eaf3f5abf2ebf153f693e63bf80,0xbeaebf3d3f683d17bf703f2f3ed1bf80,0x3f71bf2dbed73f80beb4bf3a3f6a3cc9,0x3f043ed8bf7d3f2e3e6abf6f3f513cc9,0xbf5b3f68be20bf3c3f79beb5bf143f80
.octa 0xbf2dbd303f3cbf803f2f3cfbbf3a3f80,0x3f3dbf803f2e3d17bf3b3f80bf30bcc9,0x3f4ebeafbe703f3cbf7d3f69bf08bcc9,0xbf183f71bf793f2ebe26bed23f59bf80,0xbf683f2dbeb1bd173ed4bf3a3f6fbf80,0x3ed9bf3d3f70bf803f69bf2f3eb73cc9,0x3f79bf683f4fbf2e3f07beb53e2c3cc9,0xbe763ed8bf173f3cbf5a3f6fbf7c3f80
.octa 0x3f7f3f7f3f7f3f803f803f803f803f80,0xbd90bd8abd84bd7bbd6fbd62bd56bd49,0xbe00bea4bf00bf2abf4cbf67bf78bf80,0x3f7e3f733f5e3f403f1a3ede3e7c3d49,0xbf73bf41bee2bd7b3ea83f2b3f673f80,0xbea2bf28bf66bf80bf72bf3fbedcbd49,0x3efe3f653f7e3f403e81beaabf4dbf80,0xbf5ebee33e073f2a3f783f723f193d49
.octa 0x3f413d8abf29bf80bf3fbd623f2b3f80,0x3f283f7f3f403d7bbf2abf80bf3ebd49,0xbf4abf73be843f2a3f7e3edebf03bf80,0x3f1dbea4bf77bf403e0d3f673f5c3d49,0xbee53f283f723d7bbf66bf3f3eab3f80,0xbf65bf413ea53f803edfbf2bbf71bd49,0x3f773ee3bf4bbf403f023f72be13bf80,0xbe873f653f1cbf2abf5d3eaa3f7d3d49
.octa 0x3d90bf7fbd843f803d6fbf80bd563f80,0x3f7f3d8abf7fbd7b3f803d62bf80bd49,0xbf7e3ea43f5ebf2abf1a3f673e7cbf80,0xbe00bf733f003f40bf4cbede3f783d49,0x3ea23f41bf66bd7b3f72bf2bbedc3f80,0xbf733f283ee2bf803ea83f3fbf67bd49,0x3f5ebf653e073f40bf783eaa3f19bf80,0x3efe3ee3bf7e3f2a3e81bf723f4d3d49
.octa 0xbf28bd8a3f40bf803f2a3d62bf3e3f80,0x3f41bf7f3f293d7bbf3f3f80bf2bbd49,0xbf1d3f73bf773f2abe0dbede3f5cbf80,0xbf4a3ea43e84bf403f7ebf673f033d49,0x3f65bf283ea53d7bbedf3f3fbf713f80,0xbee53f41bf723f80bf663f2bbeabbd49,0x3e87bee33f1cbf403f5dbf723f7dbf80,0x3f77bf653f4bbf2a3f02beaa3e133d49
.octa 0x3f7f3f7f3f7f3f7f3f7f3f7f3f7f3f7f,0xbdc2bdbcbdb6bdb0bda9bda3bd9dbd97,0x3f7f3f753f613f443f1f3ee93e8a3d97,0x3dcf3e983ef63f253f483f643f773f7f,0x3f753f453eed3db0be9cbf26bf64bf7f,0x3e963f243f633f7f3f743f433ee83d97,0x3f613eefbddbbf25bf76bf74bf1ebd97,0x3ef33f633f7f3f443e8dbe9ebf49bf7f
.octa 0x3f453dbcbf24bf7fbf43bda33f273f7f,0x3f233f7f3f443db0bf25bf7fbf42bd97,0x3f22be98bf76bf443de83f643f5f3d97,0x3f463f753e90bf25bf7ebee93efb3f7f,0x3ef0bf24bf74bdb03f643f43be9fbf7f,0x3f623f45be99bf7fbeea3f263f733d97,0x3e93bf63bf213f253f60be9ebf7ebd97,0x3f753eefbf47bf443ef83f74bdf4bf7f
.octa 0x3dc2bf7fbdb63f7f3da9bf7fbd9d3f7f,0x3f7f3dbcbf7fbdb03f7f3da3bf7fbd97,0xbdcfbf753ef63f44bf48bee93f773d97,0x3f7fbe98bf613f253f1fbf64be8a3f7f,0xbe96bf453f633db0bf743f263ee8bf7f,0x3f75bf24beed3f7fbe9cbf433f643d97,0xbef3beef3f7fbf25be8d3f74bf49bd97,0x3f61bf633ddb3f44bf763e9e3f1ebf7f
.octa 0xbf23bdbc3f44bf7f3f253da3bf423f7f,0x3f45bf7f3f243db0bf433f7fbf27bd97,0xbf463e983e90bf443f7ebf643efb3d97,0x3f22bf753f76bf253de83ee9bf5f3f7f,0xbf623f24be99bdb03eeabf433f73bf7f,0x3ef0bf453f74bf7f3f64bf263e9f3d97,0xbf753f63bf473f25bef83e9ebdf4bd97,0x3e93beef3f21bf443f60bf743f7ebf7f
.octa 0x3cb03c973c7b3c493c173bc93b490000,0x3f803f803f803f803f803f803f803f80,0x3f7c3f6e3f573f373f103ec73e4b0000,0x3e323ebb3f0b3f333f543f6c3f7b3f80,0x3eba3f323f6b3f803f6d3f363ec50000,0xbf6fbf38becbbc493ec03f343f6c3f80,0xbf58becd3e383f333f7b3f6d3f0f0000,0xbf0abf6bbf7cbf37be513ec13f543f80
.octa 0xbf31bf80bf38bc493f333f803f360000,0x3f393c97bf32bf80bf37bbc93f343f80,0x3f13bebbbf7abf373e3f3f6c3f550000,0x3f523f6e3e57bf33bf7cbec73f0e3f80,0x3f6a3f38bebdbf80bec83f343f6d0000,0xbece3f323f6e3c49bf6cbf363ec23f80,0xbe5d3f6b3f11bf33bf563ec13f7b0000,0xbf7abecd3f533f37bf0cbf6d3e453f80
.octa 0xbf80bc973f803c49bf80bbc93f800000,0x3cb0bf80bc7b3f803c17bf80bb493f80,0xbe32bf6e3f0b3f37bf54bec73f7b0000,0x3f7cbebbbf573f333f10bf6cbe4b3f80,0x3f6fbf32becb3f80bec0bf363f6c0000,0x3eba3f38bf6bbc493f6dbf34bec53f80,0x3f0a3ecdbf7c3f333e51bf6d3f540000,0xbf583f6bbe38bf373f7bbec1bf0f3f80
.octa 0xbf393f80bf32bc493f37bf803f340000,0xbf31bc973f38bf803f333bc9bf363f80,0xbf523ebb3e57bf373f7cbf6c3f0e0000,0x3f13bf6e3f7abf333e3f3ec7bf553f80,0x3ecebf383f6ebf803f6cbf343ec20000,0x3f6abf323ebd3c49bec83f36bf6d3f80,0x3f7abf6b3f53bf333f0cbec13e450000,0xbe5d3ecdbf113f37bf563f6dbf7b3f80
.octa 0x3d3c3d303d233d173d0a3cfb3ce23cc9,0x3f803f803f803f803f803f803f803f80,0x3e193eaf3f063f2e3f503f693f7a3f80,0xbf7dbf71bf5abf3cbf15bed2be63bcc9,0xbeaebf2dbf68bf80bf70bf3abed1bcc9,0x3f713f3d3ed73d17beb4bf2fbf6abf80,0x3f043f683f7d3f3c3e6abeb5bf51bf80,0xbf5bbed83e203f2e3f793f6f3f143cc9
.octa 0xbf2dbf80bf3cbd173f2f3f803f3a3cc9,0x3f3d3d30bf2ebf80bf3bbcfb3f303f80,0x3f4e3f713e70bf2ebf7dbed23f083f80,0xbf183eaf3f793f3cbe26bf69bf59bcc9,0xbf68bf3d3eb13f803ed4bf2fbf6fbcc9,0x3ed9bf2dbf70bd173f693f3abeb7bf80,0x3f793ed8bf4fbf3c3f073f6fbe2cbf80,0xbe763f683f17bf2ebf5a3eb53f7c3cc9
.octa 0xbf80bd303f803d17bf80bcfb3f803cc9,0x3d3cbf80bd233f803d0abf80bce23f80,0x3f7dbeafbf5a3f2e3f15bf69be633f80,0x3e193f71bf06bf3c3f503ed2bf7abcc9,0xbf713f2d3ed7bf803eb43f3abf6abcc9,0xbeaebf3d3f683d17bf703f2f3ed1bf80,0x3f5bbf683e203f3cbf793eb53f14bf80,0x3f043ed8bf7d3f2e3e6abf6f3f513cc9
.octa 0xbf3d3f80bf2ebd173f3bbf803f303cc9,0xbf2dbd303f3cbf803f2f3cfbbf3a3f80,0x3f18bf713f79bf2e3e263ed2bf593f80,0x3f4ebeafbe703f3cbf7d3f69bf08bcc9,0xbed93f3dbf703f80bf693f2fbeb7bcc9,0xbf683f2dbeb1bd173ed4bf3a3f6fbf80,0x3e76bed83f17bf3c3f5abf6f3f7cbf80,0x3f79bf683f4fbf2e3f07beb53e2c3cc9
.octa 0x3d903d8a3d843d7b3d6f3d623d563d49,0x3f7f3f7f3f7f3f803f803f803f803f80,0xbf7ebf73bf5ebf40bf1abedebe7cbd49,0xbe00bea4bf00bf2abf4cbf67bf78bf80,0x3ea23f283f663f803f723f3f3edc3d49,0xbf73bf41bee2bd7b3ea83f2b3f673f80,0x3f5e3ee3be07bf2abf78bf72bf19bd49,0x3efe3f653f7e3f403e81beaabf4dbf80
.octa 0xbf28bf7fbf40bd7b3f2a3f803f3e3d49,0x3f413d8abf29bf80bf3fbd623f2b3f80,0xbf1d3ea43f773f40be0dbf67bf5cbd49,0xbf4abf73be843f2a3f7e3edebf03bf80,0x3f653f41bea5bf80bedf3f2b3f713d49,0xbee53f283f723d7bbf66bf3f3eab3f80,0x3e87bf65bf1c3f2a3f5dbeaabf7dbd49,0x3f773ee3bf4bbf403f023f72be13bf80
.octa 0xbf7fbd8a3f7f3d7bbf80bd623f803d49,0x3d90bf7fbd843f803d6fbf80bd563f80,0x3e003f73bf00bf403f4c3edebf78bd49,0xbf7e3ea43f5ebf2abf1a3f673e7cbf80,0x3f73bf28bee23f80bea8bf3f3f673d49,0x3ea23f41bf66bd7b3f72bf2bbedc3f80,0xbefebee33f7ebf2abe813f72bf4dbd49,0x3f5ebf653e073f40bf783eaa3f19bf80
.octa 0xbf413f7fbf29bd7b3f3fbf803f2b3d49,0xbf28bd8a3f40bf803f2a3d62bf3e3f80,0x3f4abea4be843f40bf7e3f67bf03bd49,0xbf1d3f73bf773f2abe0dbede3f5cbf80,0x3ee5bf413f72bf803f66bf2b3eab3d49,0x3f65bf283ea53d7bbedf3f3fbf713f80,0xbf773f65bf4b3f2abf023eaabe13bd49,0x3e87bee33f1cbf403f5dbf723f7dbf80
.octa 0x3dc23dbc3db63db03da93da33d9d3d97,0x3f7f3f7f3f7f3f7f3f7f3f7f3f7f3f7f,0xbdcfbe98bef6bf25bf48bf64bf77bf7f,0x3f7f3f753f613f443f1f3ee93e8a3d97,0xbe96bf24bf63bf7fbf74bf43bee8bd97,0x3f753f453eed3db0be9cbf26bf64bf7f,0xbef3bf63bf7fbf44be8d3e9e3f493f7f,0x3f613eefbddbbf25bf76bf74bf1ebd97
.octa 0xbf23bf7fbf44bdb03f253f7f3f423d97,0x3f453dbcbf24bf7fbf43bda33f273f7f,0xbf46bf75be903f253f7e3ee9befbbf7f,0x3f22be98bf76bf443de83f643f5f3d97,0xbf62bf453e993f7f3eeabf26bf73bd97,0x3ef0bf24bf74bdb03f643f43be9fbf7f,0xbf75beef3f473f44bef8bf743df43f7f,0x3e93bf63bf213f253f60be9ebf7ebd97
.octa 0xbf7fbdbc3f7f3db0bf7fbda33f7f3d97,0x3dc2bf7fbdb63f7f3da9bf7fbd9d3f7f,0xbf7f3e983f61bf25bf1f3f643e8abf7f,0xbdcfbf753ef63f44bf48bee93f773d97,0xbf753f243eedbf7f3e9c3f43bf64bd97,0xbe96bf453f633db0bf743f263ee8bf7f,0xbf613f63bddbbf443f76be9ebf1e3f7f,0xbef3beef3f7fbf25be8d3f74bf49bd97
.octa 0xbf453f7fbf24bdb03f43bf7f3f273d97,0xbf23bdbc3f44bf7f3f253da3bf423f7f,0xbf223f75bf763f25bde8bee93f5fbf7f,0xbf463e983e90bf443f7ebf643efb3d97,0xbef03f45bf743f7fbf643f26be9fbd97,0xbf623f24be99bdb03eeabf433f73bf7f,0xbe933eefbf213f44bf603f74bf7e3f7f,0xbf753f63bf473f25bef83e9ebdf4bd97
.octa 0xbf803f80bf803f80bf803f80bf803f80,0x3cb0bc973c7bbc493c17bbc93b498000,0xbe323ebbbf0b3f33bf543f6cbf7b3f80,0x3f7cbf6e3f57bf373f10bec73e4b8000,0x3f6fbf383ecbbc49bec03f34bf6c3f80,0x3ebabf323f6bbf803f6dbf363ec58000,0x3f0abf6b3f7cbf373e513ec1bf543f80,0xbf583ecd3e38bf333f7bbf6d3f0f8000
.octa 0xbf393c973f32bf803f37bbc9bf343f80,0xbf313f80bf383c493f33bf803f368000,0xbf523f6ebe57bf333f7cbec7bf0e3f80,0x3f133ebbbf7a3f373e3fbf6c3f558000,0x3ece3f32bf6e3c493f6cbf36bec23f80,0x3f6abf38bebd3f80bec8bf343f6d8000,0x3f7abecdbf533f373f0cbf6dbe453f80,0xbe5dbf6b3f113f33bf56bec13f7b8000
.octa 0xbcb0bf803c7b3f80bc17bf803b493f80,0xbf803c973f80bc49bf803bc93f808000,0xbf7cbebb3f573f33bf10bf6c3e4b3f80,0xbe323f6e3f0bbf37bf543ec73f7b8000,0xbeba3f383f6bbc49bf6dbf343ec53f80,0x3f6f3f32becbbf80bec03f363f6c8000,0x3f583f6b3e38bf37bf7bbec13f0f3f80,0x3f0abecdbf7cbf333e513f6d3f548000
.octa 0x3f31bc97bf38bf80bf333bc93f363f80,0xbf39bf80bf323c493f373f803f348000,0xbf13bf6ebf7abf33be3f3ec73f553f80,0xbf52bebb3e573f373f7c3f6c3f0e8000,0xbf6abf32bebd3c493ec83f363f6d3f80,0x3ece3f383f6e3f803f6c3f343ec28000,0x3e5d3ecd3f113f373f563f6d3f7b3f80,0x3f7a3f6b3f533f333f0c3ec13e458000
.octa 0xbf803f80bf803f80bf803f80bf803f80,0x3d3cbd303d23bd173d0abcfb3ce2bcc9,0x3f7dbf713f5abf3c3f15bed23e63bcc9,0x3e19beaf3f06bf2e3f50bf693f7abf80,0xbf713f3dbed73d173eb4bf2f3f6abf80,0xbeae3f2dbf683f80bf703f3abed13cc9,0x3f5bbed8be203f2ebf793f6fbf143cc9,0x3f04bf683f7dbf3c3e6a3eb5bf513f80
.octa 0xbf3d3d303f2ebf803f3bbcfbbf303f80,0xbf2d3f80bf3c3d173f2fbf803f3abcc9,0x3f183eafbf793f3c3e26bf693f59bcc9,0x3f4ebf713e703f2ebf7d3ed23f08bf80,0xbed9bf2d3f70bd17bf693f3a3eb7bf80,0xbf683f3d3eb1bf803ed43f2fbf6f3cc9,0x3e763f68bf17bf2e3f5a3eb5bf7c3cc9,0x3f79bed8bf4f3f3c3f07bf6fbe2c3f80
.octa 0xbd3cbf803d233f80bd0abf803ce23f80,0xbf803d303f80bd17bf803cfb3f80bcc9,0xbe193f713f06bf3cbf503ed23f7abcc9,0x3f7d3eafbf5abf2e3f153f69be63bf80,0x3eaebf3dbf683d173f703f2fbed1bf80,0xbf71bf2d3ed73f803eb4bf3abf6a3cc9,0xbf043ed83f7d3f2ebe6abf6fbf513cc9,0x3f5b3f683e20bf3cbf79beb53f143f80
.octa 0x3f2dbd30bf3cbf80bf2f3cfb3f3a3f80,0xbf3dbf80bf2e3d173f3b3f803f30bcc9,0xbf4ebeaf3e703f3c3f7d3f693f08bcc9,0x3f183f713f793f2e3e26bed2bf59bf80,0x3f683f2d3eb1bd17bed4bf3abf6fbf80,0xbed9bf3dbf70bf80bf69bf2fbeb73cc9,0xbf79bf68bf4fbf2ebf07beb5be2c3cc9,0x3e763ed83f173f3c3f5a3f6f3f7c3f80
.octa 0xbf7f3f7fbf7f3f80bf803f80bf803f80,0x3d90bd8a3d84bd7b3d6fbd623d56bd49,0x3e00bea43f00bf2a3f4cbf673f78bf80,0xbf7e3f73bf5e3f40bf1a3edebe7c3d49,0x3f73bf413ee2bd7bbea83f2bbf673f80,0x3ea2bf283f66bf803f72bf3f3edcbd49,0xbefe3f65bf7e3f40be81beaa3f4dbf80,0x3f5ebee3be073f2abf783f72bf193d49
.octa 0xbf413d8a3f29bf803f3fbd62bf2b3f80,0xbf283f7fbf403d7b3f2abf803f3ebd49,0x3f4abf733e843f2abf7e3ede3f03bf80,0xbf1dbea43f77bf40be0d3f67bf5c3d49,0x3ee53f28bf723d7b3f66bf3fbeab3f80,0x3f65bf41bea53f80bedfbf2b3f71bd49,0xbf773ee33f4bbf40bf023f723e13bf80,0x3e873f65bf1cbf2a3f5d3eaabf7d3d49
.octa 0xbd90bf7f3d843f80bd6fbf803d563f80,0xbf7f3d8a3f7fbd7bbf803d623f80bd49,0x3f7e3ea4bf5ebf2a3f1a3f67be7cbf80,0x3e00bf73bf003f403f4cbedebf783d49,0xbea23f413f66bd7bbf72bf2b3edc3f80,0x3f733f28bee2bf80bea83f3f3f67bd49,0xbf5ebf65be073f403f783eaabf19bf80,0xbefe3ee33f7e3f2abe81bf72bf4d3d49
.octa 0x3f28bd8abf40bf80bf2a3d623f3e3f80,0xbf41bf7fbf293d7b3f3f3f803f2bbd49,0x3f1d3f733f773f2a3e0dbedebf5cbf80,0x3f4a3ea4be84bf40bf7ebf67bf033d49,0xbf65bf28bea53d7b3edf3f3f3f713f80,0x3ee53f413f723f803f663f2b3eabbd49,0xbe87bee3bf1cbf40bf5dbf72bf7dbf80,0xbf77bf65bf4bbf2abf02beaabe133d49
.octa 0xbf7f3f7fbf7f3f7fbf7f3f7fbf7f3f7f,0x3dc2bdbc3db6bdb03da9bda33d9dbd97,0xbf7f3f75bf613f44bf1f3ee9be8a3d97,0xbdcf3e98bef63f25bf483f64bf773f7f,0xbf753f45beed3db03e9cbf263f64bf7f,0xbe963f24bf633f7fbf743f43bee83d97,0xbf613eef3ddbbf253f76bf743f1ebd97,0xbef33f63bf7f3f44be8dbe9e3f49bf7f
.octa 0xbf453dbc3f24bf7f3f43bda3bf273f7f,0xbf233f7fbf443db03f25bf7f3f42bd97,0xbf22be983f76bf44bde83f64bf5f3d97,0xbf463f75be90bf253f7ebee9befb3f7f,0xbef0bf243f74bdb0bf643f433e9fbf7f,0xbf623f453e99bf7f3eea3f26bf733d97,0xbe93bf633f213f25bf60be9e3f7ebd97,0xbf753eef3f47bf44bef83f743df4bf7f
.octa 0xbdc2bf7f3db63f7fbda9bf7f3d9d3f7f,0xbf7f3dbc3f7fbdb0bf7f3da33f7fbd97,0x3dcfbf75bef63f443f48bee9bf773d97,0xbf7fbe983f613f25bf1fbf643e8a3f7f,0x3e96bf45bf633db03f743f26bee8bf7f,0xbf75bf243eed3f7f3e9cbf43bf643d97,0x3ef3beefbf7fbf253e8d3f743f49bd97,0xbf61bf63bddb3f443f763e9ebf1ebf7f
.octa 0x3f23bdbcbf44bf7fbf253da33f423f7f,0xbf45bf7fbf243db03f433f7f3f27bd97,0x3f463e98be90bf44bf7ebf64befb3d97,0xbf22bf75bf76bf25bde83ee93f5f3f7f,0x3f623f243e99bdb0beeabf43bf73bf7f,0xbef0bf45bf74bf7fbf64bf26be9f3d97,0x3f753f633f473f253ef83e9e3df4bd97,0xbe93beefbf21bf44bf60bf74bf7ebf7f
.octa 0xbcb03c97bc7b3c49bc173bc9bb490000,0xbf803f80bf803f80bf803f80bf803f80,0xbf7c3f6ebf573f37bf103ec7be4b0000,0xbe323ebbbf0b3f33bf543f6cbf7b3f80,0xbeba3f32bf6b3f80bf6d3f36bec50000,0x3f6fbf383ecbbc49bec03f34bf6c3f80,0x3f58becdbe383f33bf7b3f6dbf0f0000,0x3f0abf6b3f7cbf373e513ec1bf543f80
.octa 0x3f31bf803f38bc49bf333f80bf360000,0xbf393c973f32bf803f37bbc9bf343f80,0xbf13bebb3f7abf37be3f3f6cbf550000,0xbf523f6ebe57bf333f7cbec7bf0e3f80,0xbf6a3f383ebdbf803ec83f34bf6d0000,0x3ece3f32bf6e3c493f6cbf36bec23f80,0x3e5d3f6bbf11bf333f563ec1bf7b0000,0x3f7abecdbf533f373f0cbf6dbe453f80
.octa 0x3f80bc97bf803c493f80bbc9bf800000,0xbcb0bf803c7b3f80bc17bf803b493f80,0x3e32bf6ebf0b3f373f54bec7bf7b0000,0xbf7cbebb3f573f33bf10bf6c3e4b3f80,0xbf6fbf323ecb3f803ec0bf36bf6c0000,0xbeba3f383f6bbc49bf6dbf343ec53f80,0xbf0a3ecd3f7c3f33be51bf6dbf540000,0x3f583f6b3e38bf37bf7bbec13f0f3f80
.octa 0x3f393f803f32bc49bf37bf80bf340000,0x3f31bc97bf38bf80bf333bc93f363f80,0x3f523ebbbe57bf37bf7cbf6cbf0e0000,0xbf13bf6ebf7abf33be3f3ec73f553f80,0xbecebf38bf6ebf80bf6cbf34bec20000,0xbf6abf32bebd3c493ec83f363f6d3f80,0xbf7abf6bbf53bf33bf0cbec1be450000,0x3e5d3ecd3f113f373f563f6d3f7b3f80
.octa 0xbd3c3d30bd233d17bd0a3cfbbce23cc9,0xbf803f80bf803f80bf803f80bf803f80,0xbe193eafbf063f2ebf503f69bf7a3f80,0x3f7dbf713f5abf3c3f15bed23e63bcc9,0x3eaebf2d3f68bf803f70bf3a3ed1bcc9,0xbf713f3dbed73d173eb4bf2f3f6abf80,0xbf043f68bf7d3f3cbe6abeb53f51bf80,0x3f5bbed8be203f2ebf793f6fbf143cc9
.octa 0x3f2dbf803f3cbd17bf2f3f80bf3a3cc9,0xbf3d3d303f2ebf803f3bbcfbbf303f80,0xbf4e3f71be70bf2e3f7dbed2bf083f80,0x3f183eafbf793f3c3e26bf693f59bcc9,0x3f68bf3dbeb13f80bed4bf2f3f6fbcc9,0xbed9bf2d3f70bd17bf693f3a3eb7bf80,0xbf793ed83f4fbf3cbf073f6f3e2cbf80,0x3e763f68bf17bf2e3f5a3eb5bf7c3cc9
.octa 0x3f80bd30bf803d173f80bcfbbf803cc9,0xbd3cbf803d233f80bd0abf803ce23f80,0xbf7dbeaf3f5a3f2ebf15bf693e633f80,0xbe193f713f06bf3cbf503ed23f7abcc9,0x3f713f2dbed7bf80beb43f3a3f6abcc9,0x3eaebf3dbf683d173f703f2fbed1bf80,0xbf5bbf68be203f3c3f793eb5bf14bf80,0xbf043ed83f7d3f2ebe6abf6fbf513cc9
.octa 0x3f3d3f803f2ebd17bf3bbf80bf303cc9,0x3f2dbd30bf3cbf80bf2f3cfb3f3a3f80,0xbf18bf71bf79bf2ebe263ed23f593f80,0xbf4ebeaf3e703f3c3f7d3f693f08bcc9,0x3ed93f3d3f703f803f693f2f3eb7bcc9,0x3f683f2d3eb1bd17bed4bf3abf6fbf80,0xbe76bed8bf17bf3cbf5abf6fbf7cbf80,0xbf79bf68bf4fbf2ebf07beb5be2c3cc9
.octa 0xbd903d8abd843d7bbd6f3d62bd563d49,0xbf7f3f7fbf7f3f80bf803f80bf803f80,0x3f7ebf733f5ebf403f1abede3e7cbd49,0x3e00bea43f00bf2a3f4cbf673f78bf80,0xbea23f28bf663f80bf723f3fbedc3d49,0x3f73bf413ee2bd7bbea83f2bbf673f80,0xbf5e3ee33e07bf2a3f78bf723f19bd49,0xbefe3f65bf7e3f40be81beaa3f4dbf80
.octa 0x3f28bf7f3f40bd7bbf2a3f80bf3e3d49,0xbf413d8a3f29bf803f3fbd62bf2b3f80,0x3f1d3ea4bf773f403e0dbf673f5cbd49,0x3f4abf733e843f2abf7e3ede3f03bf80,0xbf653f413ea5bf803edf3f2bbf713d49,0x3ee53f28bf723d7b3f66bf3fbeab3f80,0xbe87bf653f1c3f2abf5dbeaa3f7dbd49,0xbf773ee33f4bbf40bf023f723e13bf80
.octa 0x3f7fbd8abf7f3d7b3f80bd62bf803d49,0xbd90bf7f3d843f80bd6fbf803d563f80,0xbe003f733f00bf40bf4c3ede3f78bd49,0x3f7e3ea4bf5ebf2a3f1a3f67be7cbf80,0xbf73bf283ee23f803ea8bf3fbf673d49,0xbea23f413f66bd7bbf72bf2b3edc3f80,0x3efebee3bf7ebf2a3e813f723f4dbd49,0xbf5ebf65be073f403f783eaabf19bf80
.octa 0x3f413f7f3f29bd7bbf3fbf80bf2b3d49,0x3f28bd8abf40bf80bf2a3d623f3e3f80,0xbf4abea43e843f403f7e3f673f03bd49,0x3f1d3f733f773f2a3e0dbedebf5cbf80,0xbee5bf41bf72bf80bf66bf2bbeab3d49,0xbf65bf28bea53d7b3edf3f3f3f713f80,0x3f773f653f4b3f2a3f023eaa3e13bd49,0xbe87bee3bf1cbf40bf5dbf72bf7dbf80
.octa 0xbdc23dbcbdb63db0bda93da3bd9d3d97,0xbf7f3f7fbf7f3f7fbf7f3f7fbf7f3f7f,0x3dcfbe983ef6bf253f48bf643f77bf7f,0xbf7f3f75bf613f44bf1f3ee9be8a3d97,0x3e96bf243f63bf7f3f74bf433ee8bd97,0xbf753f45beed3db03e9cbf263f64bf7f,0x3ef3bf633f7fbf443e8d3e9ebf493f7f,0xbf613eef3ddbbf253f76bf743f1ebd97
.octa 0x3f23bf7f3f44bdb0bf253f7fbf423d97,0xbf453dbc3f24bf7f3f43bda3bf273f7f,0x3f46bf753e903f25bf7e3ee93efbbf7f,0xbf22be983f76bf44bde83f64bf5f3d97,0x3f62bf45be993f7fbeeabf263f73bd97,0xbef0bf243f74bdb0bf643f433e9fbf7f,0x3f75beefbf473f443ef8bf74bdf43f7f,0xbe93bf633f213f25bf60be9e3f7ebd97
.octa 0x3f7fbdbcbf7f3db03f7fbda3bf7f3d97,0xbdc2bf7f3db63f7fbda9bf7f3d9d3f7f,0x3f7f3e98bf61bf253f1f3f64be8abf7f,0x3dcfbf75bef63f443f48bee9bf773d97,0x3f753f24beedbf7fbe9c3f433f64bd97,0x3e96bf45bf633db03f743f26bee8bf7f,0x3f613f633ddbbf44bf76be9e3f1e3f7f,0x3ef3beefbf7fbf253e8d3f743f49bd97
.octa 0x3f453f7f3f24bdb0bf43bf7fbf273d97,0x3f23bdbcbf44bf7fbf253da33f423f7f,0x3f223f753f763f253de8bee9bf5fbf7f,0x3f463e98be90bf44bf7ebf64befb3d97,0x3ef03f453f743f7f3f643f263e9fbd97,0x3f623f243e99bdb0beeabf43bf73bf7f,0x3e933eef3f213f443f603f743f7e3f7f,0x3f753f633f473f253ef83e9e3df4bd97
.octa 0x3f803f803f803f803f803f803f803f80,0xbd30bd17bcfbbcc9bc97bc49bbc98000,0x3e1c3eb23f083f313f523f6b3f7b3f80,0xbf7dbf70bf59bf39bf12becabe4e8000,0xbf71bf3cbed2bcc93ebb3f333f6c3f80,0xbeafbf2ebf69bf80bf6ebf37bec78000,0xbf05bf69bf7cbf39be5a3ebe3f543f80,0x3f5b3ed5be29bf31bf7abf6ebf108000
.octa 0x3f3d3d17bf2fbf80bf38bc493f343f80,0x3f2d3f803f3a3cc9bf32bf80bf368000,0x3f4f3f703e66bf31bf7cbeca3f0d3f80,0xbf173eb23f793f39be35bf6bbf568000,0xbed83f2e3f6f3cc9bf6bbf373ec13f80,0xbf68bf3c3eb53f803ecdbf33bf6d8000,0xbf79bed53f503f39bf0abf6e3e423f80,0x3e73bf69bf153f313f57bebebf7b8000
.octa 0x3d30bf80bcfb3f803c97bf80bbc93f80,0x3f803d17bf80bcc93f803c49bf808000,0x3f7dbeb2bf593f313f12bf6bbe4e3f80,0x3e1c3f70bf08bf393f523ecabf7b8000,0x3eaf3f3cbf69bcc93f6ebf33bec73f80,0xbf713f2e3ed2bf803ebb3f37bf6c8000,0xbf5b3f69be29bf393f7abebebf103f80,0xbf05bed53f7cbf31be5a3f6ebf548000
.octa 0xbf2dbd173f3abf803f323c49bf363f80,0x3f3dbf803f2f3cc9bf383f80bf348000,0x3f17bf703f79bf313e353ecabf563f80,0x3f4fbeb2be663f39bf7c3f6bbf0d8000,0x3f68bf2e3eb53cc9becd3f37bf6d3f80,0xbed83f3cbf6f3f80bf6b3f33bec18000,0xbe733ed5bf153f39bf573f6ebf7b3f80,0xbf793f69bf503f31bf0a3ebebe428000
.octa 0x3f7f3f7f3f7f3f7f3f7f3f803f803f80,0xbdbcbdb0bda3bd97bd8abd7bbd62bd49,0xbf7fbf74bf60bf42bf1cbee1be7fbd49,0xbdd5be9bbefabf27bf4bbf66bf78bf80,0x3f753f443ee93d97bea4bf2abf67bf80,0x3e983f253f643f7f3f733f403ede3d49,0xbf61beec3dee3f273f773f723f1a3d49,0xbef4bf63bf7ebf42be863ea73f4d3f80
.octa 0x3f453db0bf26bf7fbf41bd7b3f2b3f80,0x3f243f7f3f433d97bf28bf80bf3fbd49,0xbf213e9b3f763f42be04bf66bf5cbd49,0xbf47bf74be8c3f273f7e3ee1bf02bf80,0x3eefbf25bf74bd973f653f40beaabf80,0x3f633f44be9ebf7fbee33f2a3f723d49,0xbe923f633f1fbf27bf5e3ea73f7d3d49,0xbf75beec3f493f42beffbf723e103f80
.octa 0x3dbcbf7fbda33f7f3d8abf80bd623f80,0x3f7f3db0bf7fbd973f7f3d7bbf80bd49,0x3dd53f74befabf423f4b3ee1bf78bd49,0xbf7f3e9b3f60bf27bf1c3f663e7fbf80,0xbe98bf443f643d97bf733f2a3edebf80,0x3f75bf25bee93f7fbea4bf403f673d49,0x3ef43eecbf7e3f273e86bf723f4d3d49,0xbf613f63bdeebf423f77bea7bf1a3f80
.octa 0xbf24bdb03f43bf7f3f283d7bbf3f3f80,0x3f45bf7f3f263d97bf413f80bf2bbd49,0x3f47be9bbe8c3f42bf7e3f66bf02bd49,0xbf213f74bf763f27be04bee13f5cbf80,0xbf633f25be9ebd973ee3bf403f72bf80,0x3eefbf443f74bf7f3f65bf2a3eaa3d49,0x3f75bf633f49bf273effbea73e103d49,0xbe923eecbf1f3f42bf5e3f72bf7d3f80
.octa 0x3f7d3f7e3f7e3f7e3f7e3f7e3f7f3f7f,0xbe10be0abe04bdfbbdeebde2bdd5bdc9,0xbd62be82bee3bf1dbf43bf60bf75bf7f,0x3f803f783f653f4a3f263ef73e983dc9,0xbf78bf4cbeffbdfb3e8c3f203f613f7f,0xbe7fbf1bbf5ebf7ebf76bf48bef4bdc9,0x3ede3f5d3f7f3f4a3e9ebe8fbf45bf7f,0xbf67bf013d8a3f1d3f743f763f243dc9
.octa 0x3f4d3e0abf1cbf7ebf49bde23f213f7f,0x3f1a3f7e3f4b3dfbbf1fbf7ebf47bdc9,0xbf3fbf78bea43f1d3f7f3ef7beefbf7f,0x3f2bbe82bf73bf4a3da33f603f633dc9,0xbf023f1b3f773dfbbf60bf483e923f7f,0xbf5cbf4c3e863f7e3efabf20bf75bdc9,0x3f723f01bf41bf4a3ee93f76bdbcbf7f,0xbeaa3f5d3f28bf1dbf643e8f3f7f3dc9
.octa 0x3e10bf7ebe043f7e3deebf7ebdd53f7f,0x3f7d3e0abf7ebdfb3f7e3de2bf7fbdc9,0xbf803e823f65bf1dbf263f603e98bf7f,0xbd62bf783ee33f4abf43bef73f753dc9,0x3e7f3f4cbf5ebdfb3f76bf20bef43f7f,0xbf783f1b3effbf7e3e8c3f48bf61bdc9,0x3f67bf5d3d8a3f4abf743e8f3f24bf7f,0x3ede3f01bf7f3f1d3e9ebf763f453dc9
.octa 0xbf1abe0a3f4bbf7e3f1f3de2bf473f7f,0x3f4dbf7e3f1c3dfbbf493f7ebf21bdc9,0xbf2b3f78bf733f1dbda3bef73f63bf7f,0xbf3f3e823ea4bf4a3f7fbf603eef3dc9,0x3f5cbf1b3e863dfbbefa3f48bf753f7f,0xbf023f4cbf773f7ebf603f20be92bdc9,0x3eaabf013f28bf4a3f64bf763f7fbf7f,0x3f72bf5d3f41bf1d3ee9be8f3dbc3dc9
.octa 0x3f7b3f7c3f7c3f7c3f7c3f7d3f7d3f7d,0xbe42be3bbe35be2fbe29be23be1cbe16,0x3f803f7a3f6b3f513f2f3f063eaf3e16,0x3bc93e543ecd3f133f3a3f5a3f713f7d,0x3f7b3f533f0a3e2fbe66bf16bf5bbf7d,0x3e4e3f113f573f7c3f793f4f3f053e16,0x3f6c3f0cbc97bf13bf6fbf79bf2dbe16,0x3ec73f573f803f513eb5be6dbf3dbf7d
.octa 0x3f543e3bbf12bf7cbf50be233f173f7d,0x3f103f7c3f523e2fbf15bf7dbf4fbe16,0x3f34be54bf6ebf513cfb3f5a3f683e16,0x3f363f7a3ebbbf13bf80bf063ed83f7d,0x3f0dbf11bf7abe2f3f593f4fbe73bf7d,0x3f563f53be5abf7cbf083f163f793e16,0x3ec1bf57bf323f133f69be6dbf80be16,0x3f6d3f0cbf38bf513ed23f79bd30bf7d
.octa 0x3e42bf7cbe353f7c3e29bf7dbe1c3f7d,0x3f7b3e3bbf7cbe2f3f7c3e23bf7dbe16,0xbbc9bf7a3ecd3f51bf3abf063f713e16,0x3f80be54bf6b3f133f2fbf5abeaf3f7d,0xbe4ebf533f573e2fbf793f163f05bf7d,0x3f7bbf11bf0a3f7cbe66bf4f3f5b3e16,0xbec7bf0c3f80bf13beb53f79bf3dbe16,0x3f6cbf573c973f51bf6f3e6d3f2dbf7d
.octa 0xbf10be3b3f52bf7c3f153e23bf4f3f7d,0x3f54bf7c3f123e2fbf503f7dbf17be16,0xbf363e543ebbbf513f80bf5a3ed83e16,0x3f34bf7a3f6ebf133cfb3f06bf683f7d,0xbf563f11be5abe2f3f08bf4f3f79bf7d,0x3f0dbf533f7abf7c3f59bf163e733e16,0xbf6d3f57bf383f13bed23e6dbd30be16,0x3ec1bf0c3f32bf513f69bf793f80bf7d
.octa 0x3d303d173cfb3cc93c973c493bc90000,0x3f803f803f803f803f803f803f803f80,0x3f7d3f703f593f393f123eca3e4e0000,0x3e1c3eb23f083f313f523f6b3f7b3f80,0x3eaf3f2e3f693f803f6e3f373ec70000,0xbf71bf3cbed2bcc93ebb3f333f6c3f80,0xbf5bbed53e293f313f7a3f6e3f100000,0xbf05bf69bf7cbf39be5a3ebe3f543f80
.octa 0xbf2dbf80bf3abcc93f323f803f360000,0x3f3d3d17bf2fbf80bf38bc493f343f80,0x3f17beb2bf79bf393e353f6b3f560000,0x3f4f3f703e66bf31bf7cbeca3f0d3f80,0x3f683f3cbeb5bf80becd3f333f6d0000,0xbed83f2e3f6f3cc9bf6bbf373ec13f80,0xbe733f693f15bf31bf573ebe3f7b0000,0xbf79bed53f503f39bf0abf6e3e423f80
.octa 0xbf80bd173f803cc9bf80bc493f800000,0x3d30bf80bcfb3f803c97bf80bbc93f80,0xbe1cbf703f083f39bf52beca3f7b0000,0x3f7dbeb2bf593f313f12bf6bbe4e3f80,0x3f71bf2ebed23f80bebbbf373f6c0000,0x3eaf3f3cbf69bcc93f6ebf33bec73f80,0x3f053ed5bf7c3f313e5abf6e3f540000,0xbf5b3f69be29bf393f7abebebf103f80
.octa 0xbf3d3f80bf2fbcc93f38bf803f340000,0xbf2dbd173f3abf803f323c49bf363f80,0xbf4f3eb23e66bf393f7cbf6b3f0d0000,0x3f17bf703f79bf313e353ecabf563f80,0x3ed8bf3c3f6fbf803f6bbf333ec10000,0x3f68bf2e3eb53cc9becd3f37bf6d3f80,0x3f79bf693f50bf313f0abebe3e420000,0xbe733ed5bf153f39bf573f6ebf7b3f80
.octa 0x3dbc3db03da33d973d8a3d7b3d623d49,0x3f7f3f7f3f7f3f7f3f7f3f803f803f80,0x3dd53e9b3efa3f273f4b3f663f783f80,0xbf7fbf74bf60bf42bf1cbee1be7fbd49,0xbe98bf25bf64bf7fbf73bf40bedebd49,0x3f753f443ee93d97bea4bf2abf67bf80,0x3ef43f633f7e3f423e86bea7bf4dbf80,0xbf61beec3dee3f273f773f723f1a3d49
.octa 0xbf24bf7fbf43bd973f283f803f3f3d49,0x3f453db0bf26bf7fbf41bd7b3f2b3f80,0x3f473f743e8cbf27bf7ebee13f023f80,0xbf213e9b3f763f42be04bf66bf5cbd49,0xbf63bf443e9e3f7f3ee3bf2abf72bd49,0x3eefbf25bf74bd973f653f40beaabf80,0x3f753eecbf49bf423eff3f72be10bf80,0xbe923f633f1fbf27bf5e3ea73f7d3d49
.octa 0xbf7fbdb03f7f3d97bf7fbd7b3f803d49,0x3dbcbf7fbda33f7f3d8abf80bd623f80,0x3f7fbe9bbf603f273f1cbf66be7f3f80,0x3dd53f74befabf423f4b3ee1bf78bd49,0xbf753f253ee9bf7f3ea43f40bf67bd49,0xbe98bf443f643d97bf733f2a3edebf80,0x3f61bf633dee3f42bf773ea73f1abf80,0x3ef43eecbf7e3f273e86bf723f4d3d49
.octa 0xbf453f7fbf26bd973f41bf803f2b3d49,0xbf24bdb03f43bf7f3f283d7bbf3f3f80,0x3f21bf743f76bf273e043ee1bf5c3f80,0x3f47be9bbe8c3f42bf7e3f66bf02bd49,0xbeef3f44bf743f7fbf653f2abeaabd49,0xbf633f25be9ebd973ee3bf403f72bf80,0x3e92beec3f1fbf423f5ebf723f7dbf80,0x3f75bf633f49bf273effbea73e103d49
.octa 0x3e103e0a3e043dfb3dee3de23dd53dc9,0x3f7d3f7e3f7e3f7e3f7e3f7e3f7f3f7f,0xbf80bf78bf65bf4abf26bef7be98bdc9,0xbd62be82bee3bf1dbf43bf60bf75bf7f,0x3e7f3f1b3f5e3f7e3f763f483ef43dc9,0xbf78bf4cbeffbdfb3e8c3f203f613f7f,0x3f673f01bd8abf1dbf74bf76bf24bdc9,0x3ede3f5d3f7f3f4a3e9ebe8fbf45bf7f
.octa 0xbf1abf7ebf4bbdfb3f1f3f7e3f473dc9,0x3f4d3e0abf1cbf7ebf49bde23f213f7f,0xbf2b3e823f733f4abda3bf60bf63bdc9,0xbf3fbf78bea43f1d3f7f3ef7beefbf7f,0x3f5c3f4cbe86bf7ebefa3f203f753dc9,0xbf023f1b3f773dfbbf60bf483e923f7f,0x3eaabf5dbf283f1d3f64be8fbf7fbdc9,0x3f723f01bf41bf4a3ee93f76bdbcbf7f
.octa 0xbf7dbe0a3f7e3dfbbf7ebde23f7f3dc9,0x3e10bf7ebe043f7e3deebf7ebdd53f7f,0x3d623f78bee3bf4a3f433ef7bf75bdc9,0xbf803e823f65bf1dbf263f603e98bf7f,0x3f78bf1bbeff3f7ebe8cbf483f613dc9,0x3e7f3f4cbf5ebdfb3f76bf20bef43f7f,0xbedebf013f7fbf1dbe9e3f76bf45bdc9,0x3f67bf5d3d8a3f4abf743e8f3f24bf7f
.octa 0xbf4d3f7ebf1cbdfb3f49bf7e3f213dc9,0xbf1abe0a3f4bbf7e3f1f3de2bf473f7f,0x3f3fbe82bea43f4abf7f3f60beefbdc9,0xbf2b3f78bf733f1dbda3bef73f63bf7f,0x3f02bf4c3f77bf7e3f60bf203e923dc9,0x3f5cbf1b3e863dfbbefa3f48bf753f7f,0xbf723f5dbf413f1dbee93e8fbdbcbdc9,0x3eaabf013f28bf4a3f64bf763f7fbf7f
.octa 0x3e423e3b3e353e2f3e293e233e1c3e16,0x3f7b3f7c3f7c3f7c3f7c3f7d3f7d3f7d,0xbbc9be54becdbf13bf3abf5abf71bf7d,0x3f803f7a3f6b3f513f2f3f063eaf3e16,0xbe4ebf11bf57bf7cbf79bf4fbf05be16,0x3f7b3f533f0a3e2fbe66bf16bf5bbf7d,0xbec7bf57bf80bf51beb53e6d3f3d3f7d,0x3f6c3f0cbc97bf13bf6fbf79bf2dbe16
.octa 0xbf10bf7cbf52be2f3f153f7d3f4f3e16,0x3f543e3bbf12bf7cbf50be233f173f7d,0xbf36bf7abebb3f133f803f06bed8bf7d,0x3f34be54bf6ebf513cfb3f5a3f683e16,0xbf56bf533e5a3f7c3f08bf16bf79be16,0x3f0dbf11bf7abe2f3f593f4fbe73bf7d,0xbf6dbf0c3f383f51bed2bf793d303f7d,0x3ec1bf57bf323f133f69be6dbf80be16
.octa 0xbf7bbe3b3f7c3e2fbf7cbe233f7d3e16,0x3e42bf7cbe353f7c3e29bf7dbe1c3f7d,0xbf803e543f6bbf13bf2f3f5a3eafbf7d,0xbbc9bf7a3ecd3f51bf3abf063f713e16,0xbf7b3f113f0abf7c3e663f4fbf5bbe16,0xbe4ebf533f573e2fbf793f163f05bf7d,0xbf6c3f57bc97bf513f6fbe6dbf2d3f7d,0xbec7bf0c3f80bf13beb53f79bf3dbe16
.octa 0xbf543f7cbf12be2f3f50bf7d3f173e16,0xbf10be3b3f52bf7c3f153e23bf4f3f7d,0xbf343f7abf6e3f13bcfbbf063f68bf7d,0xbf363e543ebbbf513f80bf5a3ed83e16,0xbf0d3f53bf7a3f7cbf593f16be73be16,0xbf563f11be5abe2f3f08bf4f3f79bf7d,0xbec13f0cbf323f51bf693f79bf803f7d,0xbf6d3f57bf383f13bed23e6dbd30be16
.octa 0xbf803f80bf803f80bf803f80bf803f80,0x3d30bd173cfbbcc93c97bc493bc98000,0xbe1c3eb2bf083f31bf523f6bbf7b3f80,0x3f7dbf703f59bf393f12beca3e4e8000,0x3f71bf3c3ed2bcc9bebb3f33bf6c3f80,0x3eafbf2e3f69bf803f6ebf373ec78000,0x3f05bf693f7cbf393e5a3ebebf543f80,0xbf5b3ed53e29bf313f7abf6e3f108000
.octa 0xbf3d3d173f2fbf803f38bc49bf343f80,0xbf2d3f80bf3a3cc93f32bf803f368000,0xbf4f3f70be66bf313f7cbecabf0d3f80,0x3f173eb2bf793f393e35bf6b3f568000,0x3ed83f2ebf6f3cc93f6bbf37bec13f80,0x3f68bf3cbeb53f80becdbf333f6d8000,0x3f79bed5bf503f393f0abf6ebe423f80,0xbe73bf693f153f31bf57bebe3f7b8000
.octa 0xbd30bf803cfb3f80bc97bf803bc93f80,0xbf803d173f80bcc9bf803c493f808000,0xbf7dbeb23f593f31bf12bf6b3e4e3f80,0xbe1c3f703f08bf39bf523eca3f7b8000,0xbeaf3f3c3f69bcc9bf6ebf333ec73f80,0x3f713f2ebed2bf80bebb3f373f6c8000,0x3f5b3f693e29bf39bf7abebe3f103f80,0x3f05bed5bf7cbf313e5a3f6e3f548000
.octa 0x3f2dbd17bf3abf80bf323c493f363f80,0xbf3dbf80bf2f3cc93f383f803f348000,0xbf17bf70bf79bf31be353eca3f563f80,0xbf4fbeb23e663f393f7c3f6b3f0d8000,0xbf68bf2ebeb53cc93ecd3f373f6d3f80,0x3ed83f3c3f6f3f803f6b3f333ec18000,0x3e733ed53f153f393f573f6e3f7b3f80,0x3f793f693f503f313f0a3ebe3e428000
.octa 0xbf7f3f7fbf7f3f7fbf7f3f80bf803f80,0x3dbcbdb03da3bd973d8abd7b3d62bd49,0x3f7fbf743f60bf423f1cbee13e7fbd49,0x3dd5be9b3efabf273f4bbf663f78bf80,0xbf753f44bee93d973ea4bf2a3f67bf80,0xbe983f25bf643f7fbf733f40bede3d49,0x3f61beecbdee3f27bf773f72bf1a3d49,0x3ef4bf633f7ebf423e863ea7bf4d3f80
.octa 0xbf453db03f26bf7f3f41bd7bbf2b3f80,0xbf243f7fbf433d973f28bf803f3fbd49,0x3f213e9bbf763f423e04bf663f5cbd49,0x3f47bf743e8c3f27bf7e3ee13f02bf80,0xbeefbf253f74bd97bf653f403eaabf80,0xbf633f443e9ebf7f3ee33f2abf723d49,0x3e923f63bf1fbf273f5e3ea7bf7d3d49,0x3f75beecbf493f423effbf72be103f80
.octa 0xbdbcbf7f3da33f7fbd8abf803d623f80,0xbf7f3db03f7fbd97bf7f3d7b3f80bd49,0xbdd53f743efabf42bf4b3ee13f78bd49,0x3f7f3e9bbf60bf273f1c3f66be7fbf80,0x3e98bf44bf643d973f733f2abedebf80,0xbf75bf253ee93f7f3ea4bf40bf673d49,0xbef43eec3f7e3f27be86bf72bf4d3d49,0x3f613f633deebf42bf77bea73f1a3f80
.octa 0x3f24bdb0bf43bf7fbf283d7b3f3f3f80,0xbf45bf7fbf263d973f413f803f2bbd49,0xbf47be9b3e8c3f423f7e3f663f02bd49,0x3f213f743f763f273e04bee1bf5cbf80,0x3f633f253e9ebd97bee3bf40bf72bf80,0xbeefbf44bf74bf7fbf65bf2abeaa3d49,0xbf75bf63bf49bf27beffbea7be103d49,0x3e923eec3f1f3f423f5e3f723f7d3f80
.octa 0xbf7d3f7ebf7e3f7ebf7e3f7ebf7f3f7f,0x3e10be0a3e04bdfb3deebde23dd5bdc9,0x3d62be823ee3bf1d3f43bf603f75bf7f,0xbf803f78bf653f4abf263ef7be983dc9,0x3f78bf4c3effbdfbbe8c3f20bf613f7f,0x3e7fbf1b3f5ebf7e3f76bf483ef4bdc9,0xbede3f5dbf7f3f4abe9ebe8f3f45bf7f,0x3f67bf01bd8a3f1dbf743f76bf243dc9
.octa 0xbf4d3e0a3f1cbf7e3f49bde2bf213f7f,0xbf1a3f7ebf4b3dfb3f1fbf7e3f47bdc9,0x3f3fbf783ea43f1dbf7f3ef73eefbf7f,0xbf2bbe823f73bf4abda33f60bf633dc9,0x3f023f1bbf773dfb3f60bf48be923f7f,0x3f5cbf4cbe863f7ebefabf203f75bdc9,0xbf723f013f41bf4abee93f763dbcbf7f,0x3eaa3f5dbf28bf1d3f643e8fbf7f3dc9
.octa 0xbe10bf7e3e043f7ebdeebf7e3dd53f7f,0xbf7d3e0a3f7ebdfbbf7e3de23f7fbdc9,0x3f803e82bf65bf1d3f263f60be98bf7f,0x3d62bf78bee33f4a3f43bef7bf753dc9,0xbe7f3f4c3f5ebdfbbf76bf203ef43f7f,0x3f783f1bbeffbf7ebe8c3f483f61bdc9,0xbf67bf5dbd8a3f4a3f743e8fbf24bf7f,0xbede3f013f7f3f1dbe9ebf76bf453dc9
.octa 0x3f1abe0abf4bbf7ebf1f3de23f473f7f,0xbf4dbf7ebf1c3dfb3f493f7e3f21bdc9,0x3f2b3f783f733f1d3da3bef7bf63bf7f,0x3f3f3e82bea4bf4abf7fbf60beef3dc9,0xbf5cbf1bbe863dfb3efa3f483f753f7f,0x3f023f4c3f773f7e3f603f203e92bdc9,0xbeaabf01bf28bf4abf64bf76bf7fbf7f,0xbf72bf5dbf41bf1dbee9be8fbdbc3dc9
.octa 0xbf7b3f7cbf7c3f7cbf7c3f7dbf7d3f7d,0x3e42be3b3e35be2f3e29be233e1cbe16,0xbf803f7abf6b3f51bf2f3f06beaf3e16,0xbbc93e54becd3f13bf3a3f5abf713f7d,0xbf7b3f53bf0a3e2f3e66bf163f5bbf7d,0xbe4e3f11bf573f7cbf793f4fbf053e16,0xbf6c3f0c3c97bf133f6fbf793f2dbe16,0xbec73f57bf803f51beb5be6d3f3dbf7d
.octa 0xbf543e3b3f12bf7c3f50be23bf173f7d,0xbf103f7cbf523e2f3f15bf7d3f4fbe16,0xbf34be543f6ebf51bcfb3f5abf683e16,0xbf363f7abebbbf133f80bf06bed83f7d,0xbf0dbf113f7abe2fbf593f4f3e73bf7d,0xbf563f533e5abf7c3f083f16bf793e16,0xbec1bf573f323f13bf69be6d3f80be16,0xbf6d3f0c3f38bf51bed23f793d30bf7d
.octa 0xbe42bf7c3e353f7cbe29bf7d3e1c3f7d,0xbf7b3e3b3f7cbe2fbf7c3e233f7dbe16,0x3bc9bf7abecd3f513f3abf06bf713e16,0xbf80be543f6b3f13bf2fbf5a3eaf3f7d,0x3e4ebf53bf573e2f3f793f16bf05bf7d,0xbf7bbf113f0a3f7c3e66bf4fbf5b3e16,0x3ec7bf0cbf80bf133eb53f793f3dbe16,0xbf6cbf57bc973f513f6f3e6dbf2dbf7d
.octa 0x3f10be3bbf52bf7cbf153e233f4f3f7d,0xbf54bf7cbf123e2f3f503f7d3f17be16,0x3f363e54bebbbf51bf80bf5abed83e16,0xbf34bf7abf6ebf13bcfb3f063f683f7d,0x3f563f113e5abe2fbf08bf4fbf79bf7d,0xbf0dbf53bf7abf7cbf59bf16be733e16,0x3f6d3f573f383f133ed23e6d3d30be16,0xbec1bf0cbf32bf51bf69bf79bf80bf7d
.octa 0xbd303d17bcfb3cc9bc973c49bbc90000,0xbf803f80bf803f80bf803f80bf803f80,0xbf7d3f70bf593f39bf123ecabe4e0000,0xbe1c3eb2bf083f31bf523f6bbf7b3f80,0xbeaf3f2ebf693f80bf6e3f37bec70000,0x3f71bf3c3ed2bcc9bebb3f33bf6c3f80,0x3f5bbed5be293f31bf7a3f6ebf100000,0x3f05bf693f7cbf393e5a3ebebf543f80
.octa 0x3f2dbf803f3abcc9bf323f80bf360000,0xbf3d3d173f2fbf803f38bc49bf343f80,0xbf17beb23f79bf39be353f6bbf560000,0xbf4f3f70be66bf313f7cbecabf0d3f80,0xbf683f3c3eb5bf803ecd3f33bf6d0000,0x3ed83f2ebf6f3cc93f6bbf37bec13f80,0x3e733f69bf15bf313f573ebebf7b0000,0x3f79bed5bf503f393f0abf6ebe423f80
.octa 0x3f80bd17bf803cc93f80bc49bf800000,0xbd30bf803cfb3f80bc97bf803bc93f80,0x3e1cbf70bf083f393f52becabf7b0000,0xbf7dbeb23f593f31bf12bf6b3e4e3f80,0xbf71bf2e3ed23f803ebbbf37bf6c0000,0xbeaf3f3c3f69bcc9bf6ebf333ec73f80,0xbf053ed53f7c3f31be5abf6ebf540000,0x3f5b3f693e29bf39bf7abebe3f103f80
.octa 0x3f3d3f803f2fbcc9bf38bf80bf340000,0x3f2dbd17bf3abf80bf323c493f363f80,0x3f4f3eb2be66bf39bf7cbf6bbf0d0000,0xbf17bf70bf79bf31be353eca3f563f80,0xbed8bf3cbf6fbf80bf6bbf33bec10000,0xbf68bf2ebeb53cc93ecd3f373f6d3f80,0xbf79bf69bf50bf31bf0abebebe420000,0x3e733ed53f153f393f573f6e3f7b3f80
.octa 0xbdbc3db0bda33d97bd8a3d7bbd623d49,0xbf7f3f7fbf7f3f7fbf7f3f80bf803f80,0xbdd53e9bbefa3f27bf4b3f66bf783f80,0x3f7fbf743f60bf423f1cbee13e7fbd49,0x3e98bf253f64bf7f3f73bf403edebd49,0xbf753f44bee93d973ea4bf2a3f67bf80,0xbef43f63bf7e3f42be86bea73f4dbf80,0x3f61beecbdee3f27bf773f72bf1a3d49
.octa 0x3f24bf7f3f43bd97bf283f80bf3f3d49,0xbf453db03f26bf7f3f41bd7bbf2b3f80,0xbf473f74be8cbf273f7ebee1bf023f80,0x3f213e9bbf763f423e04bf663f5cbd49,0x3f63bf44be9e3f7fbee3bf2a3f72bd49,0xbeefbf253f74bd97bf653f403eaabf80,0xbf753eec3f49bf42beff3f723e10bf80,0x3e923f63bf1fbf273f5e3ea7bf7d3d49
.octa 0x3f7fbdb0bf7f3d973f7fbd7bbf803d49,0xbdbcbf7f3da33f7fbd8abf803d623f80,0xbf7fbe9b3f603f27bf1cbf663e7f3f80,0xbdd53f743efabf42bf4b3ee13f78bd49,0x3f753f25bee9bf7fbea43f403f67bd49,0x3e98bf44bf643d973f733f2abedebf80,0xbf61bf63bdee3f423f773ea7bf1abf80,0xbef43eec3f7e3f27be86bf72bf4d3d49
.octa 0x3f453f7f3f26bd97bf41bf80bf2b3d49,0x3f24bdb0bf43bf7fbf283d7b3f3f3f80,0xbf21bf74bf76bf27be043ee13f5c3f80,0xbf47be9b3e8c3f423f7e3f663f02bd49,0x3eef3f443f743f7f3f653f2a3eaabd49,0x3f633f253e9ebd97bee3bf40bf72bf80,0xbe92beecbf1fbf42bf5ebf72bf7dbf80,0xbf75bf63bf49bf27beffbea7be103d49
.octa 0xbe103e0abe043dfbbdee3de2bdd53dc9,0xbf7d3f7ebf7e3f7ebf7e3f7ebf7f3f7f,0x3f80bf783f65bf4a3f26bef73e98bdc9,0x3d62be823ee3bf1d3f43bf603f75bf7f,0xbe7f3f1bbf5e3f7ebf763f48bef43dc9,0x3f78bf4c3effbdfbbe8c3f20bf613f7f,0xbf673f013d8abf1d3f74bf763f24bdc9,0xbede3f5dbf7f3f4abe9ebe8f3f45bf7f
.octa 0x3f1abf7e3f4bbdfbbf1f3f7ebf473dc9,0xbf4d3e0a3f1cbf7e3f49bde2bf213f7f,0x3f2b3e82bf733f4a3da3bf603f63bdc9,0x3f3fbf783ea43f1dbf7f3ef73eefbf7f,0xbf5c3f4c3e86bf7e3efa3f20bf753dc9,0x3f023f1bbf773dfb3f60bf48be923f7f,0xbeaabf5d3f283f1dbf64be8f3f7fbdc9,0xbf723f013f41bf4abee93f763dbcbf7f
.octa 0x3f7dbe0abf7e3dfb3f7ebde2bf7f3dc9,0xbe10bf7e3e043f7ebdeebf7e3dd53f7f,0xbd623f783ee3bf4abf433ef73f75bdc9,0x3f803e82bf65bf1d3f263f60be98bf7f,0xbf78bf1b3eff3f7e3e8cbf48bf613dc9,0xbe7f3f4c3f5ebdfbbf76bf203ef43f7f,0x3edebf01bf7fbf1d3e9e3f763f45bdc9,0xbf67bf5dbd8a3f4a3f743e8fbf24bf7f
.octa 0x3f4d3f7e3f1cbdfbbf49bf7ebf213dc9,0x3f1abe0abf4bbf7ebf1f3de23f473f7f,0xbf3fbe823ea43f4a3f7f3f603eefbdc9,0x3f2b3f783f733f1d3da3bef7bf63bf7f,0xbf02bf4cbf77bf7ebf60bf20be923dc9,0xbf5cbf1bbe863dfb3efa3f483f753f7f,0x3f723f5d3f413f1d3ee93e8f3dbcbdc9,0xbeaabf01bf28bf4abf64bf76bf7fbf7f
.octa 0xbe423e3bbe353e2fbe293e23be1c3e16,0xbf7b3f7cbf7c3f7cbf7c3f7dbf7d3f7d,0x3bc9be543ecdbf133f3abf5a3f71bf7d,0xbf803f7abf6b3f51bf2f3f06beaf3e16,0x3e4ebf113f57bf7c3f79bf4f3f05be16,0xbf7b3f53bf0a3e2f3e66bf163f5bbf7d,0x3ec7bf573f80bf513eb53e6dbf3d3f7d,0xbf6c3f0c3c97bf133f6fbf793f2dbe16
.octa 0x3f10bf7c3f52be2fbf153f7dbf4f3e16,0xbf543e3b3f12bf7c3f50be23bf173f7d,0x3f36bf7a3ebb3f13bf803f063ed8bf7d,0xbf34be543f6ebf51bcfb3f5abf683e16,0x3f56bf53be5a3f7cbf08bf163f79be16,0xbf0dbf113f7abe2fbf593f4f3e73bf7d,0x3f6dbf0cbf383f513ed2bf79bd303f7d,0xbec1bf573f323f13bf69be6d3f80be16
.octa 0x3f7bbe3bbf7c3e2f3f7cbe23bf7d3e16,0xbe42bf7c3e353f7cbe29bf7d3e1c3f7d,0x3f803e54bf6bbf133f2f3f5abeafbf7d,0x3bc9bf7abecd3f513f3abf06bf713e16,0x3f7b3f11bf0abf7cbe663f4f3f5bbe16,0x3e4ebf53bf573e2f3f793f16bf05bf7d,0x3f6c3f573c97bf51bf6fbe6d3f2d3f7d,0x3ec7bf0cbf80bf133eb53f793f3dbe16
.octa 0x3f543f7c3f12be2fbf50bf7dbf173e16,0x3f10be3bbf52bf7cbf153e233f4f3f7d,0x3f343f7a3f6e3f133cfbbf06bf68bf7d,0x3f363e54bebbbf51bf80bf5abed83e16,0x3f0d3f533f7a3f7c3f593f163e73be16,0x3f563f113e5abe2fbf08bf4fbf79bf7d,0x3ec13f0c3f323f513f693f793f803f7d,0x3f6d3f573f383f133ed23e6d3d30be16
.octa 0x3f7f3f803f803f803f803f803f803f80,0xbd84bd62bd3cbd17bce2bc97bc178000,0x3e073eaa3f043f2e3f513f6b3f7b3f80,0xbf7ebf72bf5bbf3cbf14becdbe518000,0xbf72bf3fbed9bd173eb73f323f6c3f80,0xbea5bf2bbf68bf80bf6fbf38bec88000,0xbf00bf67bf7dbf3cbe633ebb3f543f80,0x3f5e3edebe19bf2ebf7abf6ebf108000
.octa 0x3f403d62bf2dbf80bf3abc973f333f80,0x3f293f803f3d3d17bf30bf80bf378000,0x3f4b3f723e76bf2ebf7cbecd3f0c3f80,0xbf1c3eaa3f793f3cbe2cbf6bbf568000,0xbee23f2b3f713d17bf6abf383ec03f80,0xbf66bf3f3eae3f803ed1bf32bf6d8000,0xbf77bede3f4e3f3cbf08bf6e3e3f3f80,0x3e84bf67bf183f2e3f59bebbbf7c8000
.octa 0x3d84bf80bd3c3f803ce2bf80bc173f80,0x3f7f3d62bf80bd173f803c97bf808000,0x3f7ebeaabf5b3f2e3f14bf6bbe513f80,0x3e073f72bf04bf3c3f513ecdbf7b8000,0x3ea53f3fbf68bd173f6fbf32bec83f80,0xbf723f2b3ed9bf803eb73f38bf6c8000,0xbf5e3f67be19bf3c3f7abebbbf103f80,0xbf00bede3f7dbf2ebe633f6ebf548000
.octa 0xbf29bd623f3dbf803f303c97bf373f80,0x3f40bf803f2d3d17bf3a3f80bf338000,0x3f1cbf723f79bf2e3e2c3ecdbf563f80,0x3f4bbeaabe763f3cbf7c3f6bbf0c8000,0x3f66bf2b3eae3d17bed13f38bf6d3f80,0xbee23f3fbf713f80bf6a3f32bec08000,0xbe843edebf183f3cbf593f6ebf7c3f80,0xbf773f67bf4e3f2ebf083ebbbe3f8000
.octa 0x3f7e3f7e3f7e3f7e3f7f3f7f3f7f3f7f,0xbe0dbe04bdf4bde2bdcfbdbcbda9bd97,0xbf80bf77bf64bf48bf23beefbe8dbd97,0xbd6fbe86bee8bf20bf45bf63bf76bf7f,0x3f783f4b3efb3de2be93bf24bf64bf7f,0x3e813f1c3f5f3f7e3f753f453eea3d97,0xbf66beff3d9d3f203f753f753f1f3d97,0xbedfbf5ebf7fbf48be963e983f483f7f
.octa 0x3f4c3e04bf1ebf7ebf46bdbc3f253f7f,0x3f1a3f7e3f493de2bf22bf7fbf43bd97,0xbf2a3e863f733f48bdc2bf63bf60bd97,0xbf3fbf77be9f3f203f7f3eefbef8bf7f,0x3f02bf1cbf77bde23f613f45be9cbf7f,0x3f5d3f4bbe8abf7ebef33f243f743d97,0xbea83f5e3f27bf20bf623e983f7e3d97,0xbf72beff3f423f48bef0bf753de83f7f
.octa 0x3e0dbf7ebdf43f7e3dcfbf7fbda93f7f,0x3f7e3e04bf7ebde23f7f3dbcbf7fbd97,0x3d6f3f77bee8bf483f453eefbf76bd97,0xbf803e863f64bf20bf233f633e8dbf7f,0xbe81bf4b3f5f3de2bf753f243eeabf7f,0x3f78bf1cbefb3f7ebe93bf453f643d97,0x3edf3effbf7f3f203e96bf753f483d97,0xbf663f5ebd9dbf483f75be98bf1f3f7f
.octa 0xbf1abe043f49bf7e3f223dbcbf433f7f,0x3f4cbf7e3f1e3de2bf463f7fbf25bd97,0x3f3fbe86be9f3f48bf7f3f63bef8bd97,0xbf2a3f77bf733f20bdc2beef3f60bf7f,0xbf5d3f1cbe8abde23ef3bf453f74bf7f,0x3f02bf4b3f77bf7e3f61bf243e9c3d97,0x3f72bf5e3f42bf203ef0be983de83d97,0xbea83effbf273f48bf623f75bf7e3f7f
.octa 0x3f7a3f7b3f7b3f7c3f7c3f7c3f7d3f7d,0xbe57be4ebe45be3bbe32be29be20be16,0x3c7bbe42bec5bf11bf39bf59bf70bf7d,0x3f803f7b3f6c3f533f313f083eb13e16,0xbf7cbf56bf0ebe3b3e5d3f153f5a3f7d,0xbe38bf0dbf55bf7cbf7abf50bf06be16,0x3ebd3f543f803f533ebabe66bf3cbf7d,0xbf6ebf103b493f113f6f3f793f2e3e16
.octa 0x3f573e4ebf0fbf7cbf52be293f173f7d,0x3f0b3f7b3f543e3bbf13bf7cbf4fbe16,0xbf32bf7bbec23f113f803f08bed7bf7d,0x3f38be42bf6dbf533cb03f593f683e16,0xbf113f0d3f7b3e3bbf58bf503e703f7d,0xbf53bf563e4b3f7c3f0abf15bf79be16,0x3f6b3f10bf36bf533ece3f79bd23bf7d,0xbecb3f543f34bf11bf6a3e663f803e16
.octa 0x3e57bf7bbe453f7c3e32bf7cbe203f7d,0x3f7a3e4ebf7bbe3b3f7c3e29bf7dbe16,0xbf803e423f6cbf11bf313f593eb1bf7d,0x3c7bbf7b3ec53f53bf39bf083f703e16,0x3e383f56bf55be3b3f7abf15bf063f7d,0xbf7c3f0d3f0ebf7c3e5d3f50bf5abe16,0x3f6ebf543b493f53bf6f3e663f2ebf7d,0x3ebd3f10bf803f113ebabf793f3c3e16
.octa 0xbf0bbe4e3f54bf7c3f133e29bf4f3f7d,0x3f57bf7b3f0f3e3bbf523f7cbf17be16,0xbf383f7bbf6d3f11bcb0bf083f68bf7d,0xbf323e423ec2bf533f80bf593ed73e16,0x3f53bf0d3e4b3e3bbf0a3f50bf793f7d,0xbf113f56bf7b3f7cbf583f15be70be16,0x3ecbbf103f34bf533f6abf793f80bf7d,0x3f6bbf543f36bf113ecebe663d233e16
.octa 0x3f763f763f773f783f783f793f793f7a,0xbe90be8cbe87be82be7cbe73be6abe60,0x3f7f3f7e3f733f5d3f3e3f173ed43e60,0xbdb63dee3ea23f013f2b3f4f3f693f7a,0x3f7f3f603f1d3e82be13bf05bf50bf7a,0x3ddb3efa3f4a3f783f7d3f5b3f153e60,0x3f743f1f3d90bf01bf67bf7dbf3bbe60,0x3e993f493f7f3f5d3edcbe1cbf2fbf7a
.octa 0x3f613e8cbefebf78bf5cbe733f073f7a,0x3ef63f763f5e3e82bf03bf79bf5abe60,0x3f44bdeebf65bf5dbd563f4f3f703e60,0x3f243f7e3ee5bf01bf80bf173eb43f7a,0x3f21befabf7ebe823f4d3f5bbe26bf7a,0x3f473f60be00bf78bf193f053f7d3e60,0x3eedbf49bf413f013f71be1cbf80be60,0x3f633f1fbf28bf5d3eab3f7d3d0abf7a
.octa 0x3e90bf76be873f783e7cbf79be6a3f7a,0x3f763e8cbf77be823f783e73bf79be60,0x3db6bf7e3ea23f5dbf2bbf173f693e60,0x3f7fbdeebf733f013f3ebf4fbed43f7a,0xbddbbf603f4a3e82bf7d3f053f15bf7a,0x3f7fbefabf1d3f78be13bf5b3f503e60,0xbe99bf1f3f7fbf01bedc3f7dbf2fbe60,0x3f74bf49bd903f5dbf673e1c3f3bbf7a
.octa 0xbef6be8c3f5ebf783f033e73bf5a3f7a,0x3f61bf763efe3e82bf5c3f79bf07be60,0xbf243dee3ee5bf5d3f80bf4f3eb43e60,0x3f44bf7e3f65bf01bd563f17bf703f7a,0xbf473efabe00be823f19bf5b3f7dbf7a,0x3f21bf603f7ebf783f4dbf053e263e60,0xbf633f49bf283f01beab3e1c3d0abe60,0x3eedbf1f3f41bf5d3f71bf7d3f80bf7a
.octa 0x3d843d623d3c3d173ce23c973c170000,0x3f7f3f803f803f803f803f803f803f80,0x3f7e3f723f5b3f3c3f143ecd3e510000,0x3e073eaa3f043f2e3f513f6b3f7b3f80,0x3ea53f2b3f683f803f6f3f383ec80000,0xbf72bf3fbed9bd173eb73f323f6c3f80,0xbf5ebede3e193f2e3f7a3f6e3f100000,0xbf00bf67bf7dbf3cbe633ebb3f543f80
.octa 0xbf29bf80bf3dbd173f303f803f370000,0x3f403d62bf2dbf80bf3abc973f333f80,0x3f1cbeaabf79bf3c3e2c3f6b3f560000,0x3f4b3f723e76bf2ebf7cbecd3f0c3f80,0x3f663f3fbeaebf80bed13f323f6d0000,0xbee23f2b3f713d17bf6abf383ec03f80,0xbe843f673f18bf2ebf593ebb3f7c0000,0xbf77bede3f4e3f3cbf08bf6e3e3f3f80
.octa 0xbf7fbd623f803d17bf80bc973f800000,0x3d84bf80bd3c3f803ce2bf80bc173f80,0xbe07bf723f043f3cbf51becd3f7b0000,0x3f7ebeaabf5b3f2e3f14bf6bbe513f80,0x3f72bf2bbed93f80beb7bf383f6c0000,0x3ea53f3fbf68bd173f6fbf32bec83f80,0x3f003edebf7d3f2e3e63bf6e3f540000,0xbf5e3f67be19bf3c3f7abebbbf103f80
.octa 0xbf403f80bf2dbd173f3abf803f330000,0xbf29bd623f3dbf803f303c97bf373f80,0xbf4b3eaa3e76bf3c3f7cbf6b3f0c0000,0x3f1cbf723f79bf2e3e2c3ecdbf563f80,0x3ee2bf3f3f71bf803f6abf323ec00000,0x3f66bf2b3eae3d17bed13f38bf6d3f80,0x3f77bf673f4ebf2e3f08bebb3e3f0000,0xbe843edebf183f3cbf593f6ebf7c3f80
.octa 0x3e0d3e043df43de23dcf3dbc3da93d97,0x3f7e3f7e3f7e3f7e3f7f3f7f3f7f3f7f,0x3d6f3e863ee83f203f453f633f763f7f,0xbf80bf77bf64bf48bf23beefbe8dbd97,0xbe81bf1cbf5fbf7ebf75bf45beeabd97,0x3f783f4b3efb3de2be93bf24bf64bf7f,0x3edf3f5e3f7f3f483e96be98bf48bf7f,0xbf66beff3d9d3f203f753f753f1f3d97
.octa 0xbf1abf7ebf49bde23f223f7f3f433d97,0x3f4c3e04bf1ebf7ebf46bdbc3f253f7f,0x3f3f3f773e9fbf20bf7fbeef3ef83f7f,0xbf2a3e863f733f48bdc2bf63bf60bd97,0xbf5dbf4b3e8a3f7e3ef3bf24bf74bd97,0x3f02bf1cbf77bde23f613f45be9cbf7f,0x3f723effbf42bf483ef03f75bde8bf7f,0xbea83f5e3f27bf20bf623e983f7e3d97
.octa 0xbf7ebe043f7e3de2bf7fbdbc3f7f3d97,0x3e0dbf7ebdf43f7e3dcfbf7fbda93f7f,0x3f80be86bf643f203f23bf63be8d3f7f,0x3d6f3f77bee8bf483f453eefbf76bd97,0xbf783f1c3efbbf7e3e933f45bf64bd97,0xbe81bf4b3f5f3de2bf753f243eeabf7f,0x3f66bf5e3d9d3f48bf753e983f1fbf7f,0x3edf3effbf7f3f203e96bf753f483d97
.octa 0xbf4c3f7ebf1ebde23f46bf7f3f253d97,0xbf1abe043f49bf7e3f223dbcbf433f7f,0x3f2abf773f73bf203dc23eefbf603f7f,0x3f3fbe86be9f3f48bf7f3f63bef8bd97,0xbf023f4bbf773f7ebf613f24be9cbd97,0xbf5d3f1cbe8abde23ef3bf453f74bf7f,0x3ea8beff3f27bf483f62bf753f7ebf7f,0x3f72bf5e3f42bf203ef0be983de83d97
.octa 0x3e573e4e3e453e3b3e323e293e203e16,0x3f7a3f7b3f7b3f7c3f7c3f7c3f7d3f7d,0xbf80bf7bbf6cbf53bf31bf08beb1be16,0x3c7bbe42bec5bf11bf39bf59bf70bf7d,0x3e383f0d3f553f7c3f7a3f503f063e16,0xbf7cbf56bf0ebe3b3e5d3f153f5a3f7d,0x3f6e3f10bb49bf11bf6fbf79bf2ebe16,0x3ebd3f543f803f533ebabe66bf3cbf7d
.octa 0xbf0bbf7bbf54be3b3f133f7c3f4f3e16,0x3f573e4ebf0fbf7cbf52be293f173f7d,0xbf383e423f6d3f53bcb0bf59bf68be16,0xbf32bf7bbec23f113f803f08bed7bf7d,0x3f533f56be4bbf7cbf0a3f153f793e16,0xbf113f0d3f7b3e3bbf58bf503e703f7d,0x3ecbbf54bf343f113f6abe66bf80be16,0x3f6b3f10bf36bf533ece3f79bd23bf7d
.octa 0xbf7abe4e3f7b3e3bbf7cbe293f7d3e16,0x3e57bf7bbe453f7c3e32bf7cbe203f7d,0xbc7b3f7bbec5bf533f393f08bf70be16,0xbf803e423f6cbf11bf313f593eb1bf7d,0x3f7cbf0dbf0e3f7cbe5dbf503f5a3e16,0x3e383f56bf55be3b3f7abf15bf063f7d,0xbebdbf103f80bf11beba3f79bf3cbe16,0x3f6ebf543b493f53bf6f3e663f2ebf7d
.octa 0xbf573f7bbf0fbe3b3f52bf7c3f173e16,0xbf0bbe4e3f54bf7c3f133e29bf4f3f7d,0x3f32be42bec23f53bf803f59bed7be16,0xbf383f7bbf6d3f11bcb0bf083f68bf7d,0x3f11bf563f7bbf7c3f58bf153e703e16,0x3f53bf0d3e4b3e3bbf0a3f50bf793f7d,0xbf6b3f54bf363f11bece3e66bd23be16,0x3ecbbf103f34bf533f6abf793f80bf7d
.octa 0x3e903e8c3e873e823e7c3e733e6a3e60,0x3f763f763f773f783f783f793f793f7a,0x3db6bdeebea2bf01bf2bbf4fbf69bf7a,0x3f7f3f7e3f733f5d3f3e3f173ed43e60,0xbddbbefabf4abf78bf7dbf5bbf15be60,0x3f7f3f603f1d3e82be13bf05bf50bf7a,0xbe99bf49bf7fbf5dbedc3e1c3f2f3f7a,0x3f743f1f3d90bf01bf67bf7dbf3bbe60
.octa 0xbef6bf76bf5ebe823f033f793f5a3e60,0x3f613e8cbefebf78bf5cbe733f073f7a,0xbf24bf7ebee53f013f803f17beb4bf7a,0x3f44bdeebf65bf5dbd563f4f3f703e60,0xbf47bf603e003f783f19bf05bf7dbe60,0x3f21befabf7ebe823f4d3f5bbe26bf7a,0xbf63bf1f3f283f5dbeabbf7dbd0a3f7a,0x3eedbf49bf413f013f71be1cbf80be60
.octa 0xbf76be8c3f773e82bf78be733f793e60,0x3e90bf76be873f783e7cbf79be6a3f7a,0xbf7f3dee3f73bf01bf3e3f4f3ed4bf7a,0x3db6bf7e3ea23f5dbf2bbf173f693e60,0xbf7f3efa3f1dbf783e133f5bbf50be60,0xbddbbf603f4a3e82bf7d3f053f15bf7a,0xbf743f493d90bf5d3f67be1cbf3b3f7a,0xbe99bf1f3f7fbf01bedc3f7dbf2fbe60
.octa 0xbf613f76befebe823f5cbf793f073e60,0xbef6be8c3f5ebf783f033e73bf5a3f7a,0xbf443f7ebf653f013d56bf173f70bf7a,0xbf243dee3ee5bf5d3f80bf4f3eb43e60,0xbf213f60bf7e3f78bf4d3f05be26be60,0xbf473efabe00be823f19bf5b3f7dbf7a,0xbeed3f1fbf413f5dbf713f7dbf803f7a,0xbf633f49bf283f01beab3e1c3d0abe60
.octa 0xbf7f3f80bf803f80bf803f80bf803f80,0x3d84bd623d3cbd173ce2bc973c178000,0xbe073eaabf043f2ebf513f6bbf7b3f80,0x3f7ebf723f5bbf3c3f14becd3e518000,0x3f72bf3f3ed9bd17beb73f32bf6c3f80,0x3ea5bf2b3f68bf803f6fbf383ec88000,0x3f00bf673f7dbf3c3e633ebbbf543f80,0xbf5e3ede3e19bf2e3f7abf6e3f108000
.octa 0xbf403d623f2dbf803f3abc97bf333f80,0xbf293f80bf3d3d173f30bf803f378000,0xbf4b3f72be76bf2e3f7cbecdbf0c3f80,0x3f1c3eaabf793f3c3e2cbf6b3f568000,0x3ee23f2bbf713d173f6abf38bec03f80,0x3f66bf3fbeae3f80bed1bf323f6d8000,0x3f77bedebf4e3f3c3f08bf6ebe3f3f80,0xbe84bf673f183f2ebf59bebb3f7c8000
.octa 0xbd84bf803d3c3f80bce2bf803c173f80,0xbf7f3d623f80bd17bf803c973f808000,0xbf7ebeaa3f5b3f2ebf14bf6b3e513f80,0xbe073f723f04bf3cbf513ecd3f7b8000,0xbea53f3f3f68bd17bf6fbf323ec83f80,0x3f723f2bbed9bf80beb73f383f6c8000,0x3f5e3f673e19bf3cbf7abebb3f103f80,0x3f00bedebf7dbf2e3e633f6e3f548000
.octa 0x3f29bd62bf3dbf80bf303c973f373f80,0xbf40bf80bf2d3d173f3a3f803f338000,0xbf1cbf72bf79bf2ebe2c3ecd3f563f80,0xbf4bbeaa3e763f3c3f7c3f6b3f0c8000,0xbf66bf2bbeae3d173ed13f383f6d3f80,0x3ee23f3f3f713f803f6a3f323ec08000,0x3e843ede3f183f3c3f593f6e3f7c3f80,0x3f773f673f4e3f2e3f083ebb3e3f8000
.octa 0xbf7e3f7ebf7e3f7ebf7f3f7fbf7f3f7f,0x3e0dbe043df4bde23dcfbdbc3da9bd97,0x3f80bf773f64bf483f23beef3e8dbd97,0x3d6fbe863ee8bf203f45bf633f76bf7f,0xbf783f4bbefb3de23e93bf243f64bf7f,0xbe813f1cbf5f3f7ebf753f45beea3d97,0x3f66beffbd9d3f20bf753f75bf1f3d97,0x3edfbf5e3f7fbf483e963e98bf483f7f
.octa 0xbf4c3e043f1ebf7e3f46bdbcbf253f7f,0xbf1a3f7ebf493de23f22bf7f3f43bd97,0x3f2a3e86bf733f483dc2bf633f60bd97,0x3f3fbf773e9f3f20bf7f3eef3ef8bf7f,0xbf02bf1c3f77bde2bf613f453e9cbf7f,0xbf5d3f4b3e8abf7e3ef33f24bf743d97,0x3ea83f5ebf27bf203f623e98bf7e3d97,0x3f72beffbf423f483ef0bf75bde83f7f
.octa 0xbe0dbf7e3df43f7ebdcfbf7f3da93f7f,0xbf7e3e043f7ebde2bf7f3dbc3f7fbd97,0xbd6f3f773ee8bf48bf453eef3f76bd97,0x3f803e86bf64bf203f233f63be8dbf7f,0x3e81bf4bbf5f3de23f753f24beeabf7f,0xbf78bf1c3efb3f7e3e93bf45bf643d97,0xbedf3eff3f7f3f20be96bf75bf483d97,0x3f663f5e3d9dbf48bf75be983f1f3f7f
.octa 0x3f1abe04bf49bf7ebf223dbc3f433f7f,0xbf4cbf7ebf1e3de23f463f7f3f25bd97,0xbf3fbe863e9f3f483f7f3f633ef8bd97,0x3f2a3f773f733f203dc2beefbf60bf7f,0x3f5d3f1c3e8abde2bef3bf45bf74bf7f,0xbf02bf4bbf77bf7ebf61bf24be9c3d97,0xbf72bf5ebf42bf20bef0be98bde83d97,0x3ea83eff3f273f483f623f753f7e3f7f
.octa 0xbf7a3f7bbf7b3f7cbf7c3f7cbf7d3f7d,0x3e57be4e3e45be3b3e32be293e20be16,0xbc7bbe423ec5bf113f39bf593f70bf7d,0xbf803f7bbf6c3f53bf313f08beb13e16,0x3f7cbf563f0ebe3bbe5d3f15bf5a3f7d,0x3e38bf0d3f55bf7c3f7abf503f06be16,0xbebd3f54bf803f53bebabe663f3cbf7d,0x3f6ebf10bb493f11bf6f3f79bf2e3e16
.octa 0xbf573e4e3f0fbf7c3f52be29bf173f7d,0xbf0b3f7bbf543e3b3f13bf7c3f4fbe16,0x3f32bf7b3ec23f11bf803f083ed7bf7d,0xbf38be423f6dbf53bcb03f59bf683e16,0x3f113f0dbf7b3e3b3f58bf50be703f7d,0x3f53bf56be4b3f7cbf0abf153f79be16,0xbf6b3f103f36bf53bece3f793d23bf7d,0x3ecb3f54bf34bf113f6a3e66bf803e16
.octa 0xbe57bf7b3e453f7cbe32bf7c3e203f7d,0xbf7a3e4e3f7bbe3bbf7c3e293f7dbe16,0x3f803e42bf6cbf113f313f59beb1bf7d,0xbc7bbf7bbec53f533f39bf08bf703e16,0xbe383f563f55be3bbf7abf153f063f7d,0x3f7c3f0dbf0ebf7cbe5d3f503f5abe16,0xbf6ebf54bb493f533f6f3e66bf2ebf7d,0xbebd3f103f803f11bebabf79bf3c3e16
.octa 0x3f0bbe4ebf54bf7cbf133e293f4f3f7d,0xbf57bf7bbf0f3e3b3f523f7c3f17be16,0x3f383f7b3f6d3f113cb0bf08bf68bf7d,0x3f323e42bec2bf53bf80bf59bed73e16,0xbf53bf0dbe4b3e3b3f0a3f503f793f7d,0x3f113f563f7b3f7c3f583f153e70be16,0xbecbbf10bf34bf53bf6abf79bf80bf7d,0xbf6bbf54bf36bf11becebe66bd233e16
.octa 0xbf763f76bf773f78bf783f79bf793f7a,0x3e90be8c3e87be823e7cbe733e6abe60,0xbf7f3f7ebf733f5dbf3e3f17bed43e60,0x3db63deebea23f01bf2b3f4fbf693f7a,0xbf7f3f60bf1d3e823e13bf053f50bf7a,0xbddb3efabf4a3f78bf7d3f5bbf153e60,0xbf743f1fbd90bf013f67bf7d3f3bbe60,0xbe993f49bf7f3f5dbedcbe1c3f2fbf7a
.octa 0xbf613e8c3efebf783f5cbe73bf073f7a,0xbef63f76bf5e3e823f03bf793f5abe60,0xbf44bdee3f65bf5d3d563f4fbf703e60,0xbf243f7ebee5bf013f80bf17beb43f7a,0xbf21befa3f7ebe82bf4d3f5b3e26bf7a,0xbf473f603e00bf783f193f05bf7d3e60,0xbeedbf493f413f01bf71be1c3f80be60,0xbf633f1f3f28bf5dbeab3f7dbd0abf7a
.octa 0xbe90bf763e873f78be7cbf793e6a3f7a,0xbf763e8c3f77be82bf783e733f79be60,0xbdb6bf7ebea23f5d3f2bbf17bf693e60,0xbf7fbdee3f733f01bf3ebf4f3ed43f7a,0x3ddbbf60bf4a3e823f7d3f05bf15bf7a,0xbf7fbefa3f1d3f783e13bf5bbf503e60,0x3e99bf1fbf7fbf013edc3f7d3f2fbe60,0xbf74bf493d903f5d3f673e1cbf3bbf7a
.octa 0x3ef6be8cbf5ebf78bf033e733f5a3f7a,0xbf61bf76befe3e823f5c3f793f07be60,0x3f243deebee5bf5dbf80bf4fbeb43e60,0xbf44bf7ebf65bf013d563f173f703f7a,0x3f473efa3e00be82bf19bf5bbf7dbf7a,0xbf21bf60bf7ebf78bf4dbf05be263e60,0x3f633f493f283f013eab3e1cbd0abe60,0xbeedbf1fbf41bf5dbf71bf7dbf80bf7a
.octa 0xbd843d62bd3c3d17bce23c97bc170000,0xbf7f3f80bf803f80bf803f80bf803f80,0xbf7e3f72bf5b3f3cbf143ecdbe510000,0xbe073eaabf043f2ebf513f6bbf7b3f80,0xbea53f2bbf683f80bf6f3f38bec80000,0x3f72bf3f3ed9bd17beb73f32bf6c3f80,0x3f5ebedebe193f2ebf7a3f6ebf100000,0x3f00bf673f7dbf3c3e633ebbbf543f80
.octa 0x3f29bf803f3dbd17bf303f80bf370000,0xbf403d623f2dbf803f3abc97bf333f80,0xbf1cbeaa3f79bf3cbe2c3f6bbf560000,0xbf4b3f72be76bf2e3f7cbecdbf0c3f80,0xbf663f3f3eaebf803ed13f32bf6d0000,0x3ee23f2bbf713d173f6abf38bec03f80,0x3e843f67bf18bf2e3f593ebbbf7c0000,0x3f77bedebf4e3f3c3f08bf6ebe3f3f80
.octa 0x3f7fbd62bf803d173f80bc97bf800000,0xbd84bf803d3c3f80bce2bf803c173f80,0x3e07bf72bf043f3c3f51becdbf7b0000,0xbf7ebeaa3f5b3f2ebf14bf6b3e513f80,0xbf72bf2b3ed93f803eb7bf38bf6c0000,0xbea53f3f3f68bd17bf6fbf323ec83f80,0xbf003ede3f7d3f2ebe63bf6ebf540000,0x3f5e3f673e19bf3cbf7abebb3f103f80
.octa 0x3f403f803f2dbd17bf3abf80bf330000,0x3f29bd62bf3dbf80bf303c973f373f80,0x3f4b3eaabe76bf3cbf7cbf6bbf0c0000,0xbf1cbf72bf79bf2ebe2c3ecd3f563f80,0xbee2bf3fbf71bf80bf6abf32bec00000,0xbf66bf2bbeae3d173ed13f383f6d3f80,0xbf77bf67bf4ebf2ebf08bebbbe3f0000,0x3e843ede3f183f3c3f593f6e3f7c3f80
.octa 0xbe0d3e04bdf43de2bdcf3dbcbda93d97,0xbf7e3f7ebf7e3f7ebf7f3f7fbf7f3f7f,0xbd6f3e86bee83f20bf453f63bf763f7f,0x3f80bf773f64bf483f23beef3e8dbd97,0x3e81bf1c3f5fbf7e3f75bf453eeabd97,0xbf783f4bbefb3de23e93bf243f64bf7f,0xbedf3f5ebf7f3f48be96be983f48bf7f,0x3f66beffbd9d3f20bf753f75bf1f3d97
.octa 0x3f1abf7e3f49bde2bf223f7fbf433d97,0xbf4c3e043f1ebf7e3f46bdbcbf253f7f,0xbf3f3f77be9fbf203f7fbeefbef83f7f,0x3f2a3e86bf733f483dc2bf633f60bd97,0x3f5dbf4bbe8a3f7ebef3bf243f74bd97,0xbf02bf1c3f77bde2bf613f453e9cbf7f,0xbf723eff3f42bf48bef03f753de8bf7f,0x3ea83f5ebf27bf203f623e98bf7e3d97
.octa 0x3f7ebe04bf7e3de23f7fbdbcbf7f3d97,0xbe0dbf7e3df43f7ebdcfbf7f3da93f7f,0xbf80be863f643f20bf23bf633e8d3f7f,0xbd6f3f773ee8bf48bf453eef3f76bd97,0x3f783f1cbefbbf7ebe933f453f64bd97,0x3e81bf4bbf5f3de23f753f24beeabf7f,0xbf66bf5ebd9d3f483f753e98bf1fbf7f,0xbedf3eff3f7f3f20be96bf75bf483d97
.octa 0x3f4c3f7e3f1ebde2bf46bf7fbf253d97,0x3f1abe04bf49bf7ebf223dbc3f433f7f,0xbf2abf77bf73bf20bdc23eef3f603f7f,0xbf3fbe863e9f3f483f7f3f633ef8bd97,0x3f023f4b3f773f7e3f613f243e9cbd97,0x3f5d3f1c3e8abde2bef3bf45bf74bf7f,0xbea8beffbf27bf48bf62bf75bf7ebf7f,0xbf72bf5ebf42bf20bef0be98bde83d97
.octa 0xbe573e4ebe453e3bbe323e29be203e16,0xbf7a3f7bbf7b3f7cbf7c3f7cbf7d3f7d,0x3f80bf7b3f6cbf533f31bf083eb1be16,0xbc7bbe423ec5bf113f39bf593f70bf7d,0xbe383f0dbf553f7cbf7a3f50bf063e16,0x3f7cbf563f0ebe3bbe5d3f15bf5a3f7d,0xbf6e3f103b49bf113f6fbf793f2ebe16,0xbebd3f54bf803f53bebabe663f3cbf7d
.octa 0x3f0bbf7b3f54be3bbf133f7cbf4f3e16,0xbf573e4e3f0fbf7c3f52be29bf173f7d,0x3f383e42bf6d3f533cb0bf593f68be16,0x3f32bf7b3ec23f11bf803f083ed7bf7d,0xbf533f563e4bbf7c3f0a3f15bf793e16,0x3f113f0dbf7b3e3b3f58bf50be703f7d,0xbecbbf543f343f11bf6abe663f80be16,0xbf6b3f103f36bf53bece3f793d23bf7d
.octa 0x3f7abe4ebf7b3e3b3f7cbe29bf7d3e16,0xbe57bf7b3e453f7cbe32bf7c3e203f7d,0x3c7b3f7b3ec5bf53bf393f083f70be16,0x3f803e42bf6cbf113f313f59beb1bf7d,0xbf7cbf0d3f0e3f7c3e5dbf50bf5a3e16,0xbe383f563f55be3bbf7abf153f063f7d,0x3ebdbf10bf80bf113eba3f793f3cbe16,0xbf6ebf54bb493f533f6f3e66bf2ebf7d
.octa 0x3f573f7b3f0fbe3bbf52bf7cbf173e16,0x3f0bbe4ebf54bf7cbf133e293f4f3f7d,0xbf32be423ec23f533f803f593ed7be16,0x3f383f7b3f6d3f113cb0bf08bf68bf7d,0xbf11bf56bf7bbf7cbf58bf15be703e16,0xbf53bf0dbe4b3e3b3f0a3f503f793f7d,0x3f6b3f543f363f113ece3e663d23be16,0xbecbbf10bf34bf53bf6abf79bf80bf7d
.octa 0xbe903e8cbe873e82be7c3e73be6a3e60,0xbf763f76bf773f78bf783f79bf793f7a,0xbdb6bdee3ea2bf013f2bbf4f3f69bf7a,0xbf7f3f7ebf733f5dbf3e3f17bed43e60,0x3ddbbefa3f4abf783f7dbf5b3f15be60,0xbf7f3f60bf1d3e823e13bf053f50bf7a,0x3e99bf493f7fbf5d3edc3e1cbf2f3f7a,0xbf743f1fbd90bf013f67bf7d3f3bbe60
.octa 0x3ef6bf763f5ebe82bf033f79bf5a3e60,0xbf613e8c3efebf783f5cbe73bf073f7a,0x3f24bf7e3ee53f01bf803f173eb4bf7a,0xbf44bdee3f65bf5d3d563f4fbf703e60,0x3f47bf60be003f78bf19bf053f7dbe60,0xbf21befa3f7ebe82bf4d3f5b3e26bf7a,0x3f63bf1fbf283f5d3eabbf7d3d0a3f7a,0xbeedbf493f413f01bf71be1c3f80be60
.octa 0x3f76be8cbf773e823f78be73bf793e60,0xbe90bf763e873f78be7cbf793e6a3f7a,0x3f7f3deebf73bf013f3e3f4fbed4bf7a,0xbdb6bf7ebea23f5d3f2bbf17bf693e60,0x3f7f3efabf1dbf78be133f5b3f50be60,0x3ddbbf60bf4a3e823f7d3f05bf15bf7a,0x3f743f49bd90bf5dbf67be1c3f3b3f7a,0x3e99bf1fbf7fbf013edc3f7d3f2fbe60
.octa 0x3f613f763efebe82bf5cbf79bf073e60,0x3ef6be8cbf5ebf78bf033e733f5a3f7a,0x3f443f7e3f653f01bd56bf17bf70bf7a,0x3f243deebee5bf5dbf80bf4fbeb43e60,0x3f213f603f7e3f783f4d3f053e26be60,0x3f473efa3e00be82bf19bf5bbf7dbf7a,0x3eed3f1f3f413f5d3f713f7d3f803f7a,0x3f633f493f283f013eab3e1cbd0abe60
.octa 0x3f7f3f7f3f803f803f803f803f803f80,0xbdb0bd97bd7bbd49bd17bcc9bc498000,0x3de23ea13f013f2c3f4f3f6a3f7a3f80,0xbf7ebf73bf5dbf3ebf16becfbe548000,0xbf74bf42bee1bd493eb23f313f6b3f80,0xbe9bbf27bf66bf80bf70bf39beca8000,0xbef7bf65bf7ebf3ebe6d3eb83f533f80,0x3f603ee6be0abf2cbf79bf6fbf118000
.octa 0x3f443d97bf2abf80bf3cbcc93f333f80,0x3f253f7f3f403d49bf2ebf80bf378000,0x3f483f733e82bf2cbf7dbecf3f0c3f80,0xbf203ea13f783f3ebe23bf6abf578000,0xbeec3f273f723d49bf69bf393ebe3f80,0xbf63bf423ea73f803ed5bf31bf6e8000,0xbf76bee63f4c3f3ebf06bf6f3e3b3f80,0x3e8fbf65bf1b3f2c3f5abeb8bf7c8000
.octa 0x3db0bf7fbd7b3f803d17bf80bc493f80,0x3f7f3d97bf80bd493f803cc9bf808000,0x3f7ebea1bf5d3f2c3f16bf6abe543f80,0x3de23f73bf01bf3e3f4f3ecfbf7a8000,0x3e9b3f42bf66bd493f70bf31beca3f80,0xbf743f273ee1bf803eb23f39bf6b8000,0xbf603f65be0abf3e3f79beb8bf113f80,0xbef7bee63f7ebf2cbe6d3f6fbf538000
.octa 0xbf25bd973f40bf803f2e3cc9bf373f80,0x3f44bf7f3f2a3d49bf3c3f80bf338000,0x3f20bf733f78bf2c3e233ecfbf573f80,0x3f48bea1be823f3ebf7d3f6abf0c8000,0x3f63bf273ea73d49bed53f39bf6e3f80,0xbeec3f42bf723f80bf693f31bebe8000,0xbe8f3ee6bf1b3f3ebf5a3f6fbf7c3f80,0xbf763f65bf4c3f2cbf063eb8be3b8000
.octa 0x3f7c3f7c3f7d3f7d3f7e3f7e3f7e3f7f,0xbe3bbe2fbe23be16be0abdfbbde2bdc9,0xbf80bf7abf69bf4ebf2abefcbe9bbdc9,0xbc49be60bed5bf18bf40bf5fbf74bf7f,0x3f7a3f513f063e16be82bf1dbf60bf7f,0x3e543f133f5a3f7d3f783f4a3ef73dc9,0xbf6bbf093d173f183f723f773f253dc9,0xbecabf58bf80bf4ebea73e893f443f7f
.octa 0x3f533e2fbf16bf7dbf4cbdfb3f203f7f,0x3f113f7c3f4f3e16bf1bbf7ebf48bdc9,0xbf333e603f703f4ebd7bbf5fbf63bdc9,0xbf37bf7abeb23f183f803efcbeecbf7f,0x3f0cbf13bf79be163f5d3f4abe8fbf7f,0x3f573f51be6dbf7dbf013f1d3f763dc9,0xbebe3f583f2ebf18bf663e893f7f3dc9,0xbf6ebf093f3c3f4ebee1bf773db03f7f
.octa 0x3e3bbf7cbe233f7d3e0abf7ebde23f7f,0x3f7c3e2fbf7dbe163f7e3dfbbf7ebdc9,0x3c493f7abed5bf4e3f403efcbf74bdc9,0xbf803e603f69bf18bf2a3f5f3e9bbf7f,0xbe54bf513f5a3e16bf783f1d3ef7bf7f,0x3f7abf13bf063f7dbe82bf4a3f603dc9,0x3eca3f09bf803f183ea7bf773f443dc9,0xbf6b3f58bd17bf4e3f72be89bf253f7f
.octa 0xbf11be2f3f4fbf7d3f1b3dfbbf483f7f,0x3f53bf7c3f163e16bf4c3f7ebf20bdc9,0x3f37be60beb23f4ebf803f5fbeecbdc9,0xbf333f7abf703f18bd7bbefc3f63bf7f,0xbf573f13be6dbe163f01bf4a3f76bf7f,0x3f0cbf513f79bf7d3f5dbf1d3e8f3dc9,0x3f6ebf583f3cbf183ee1be893db03dc9,0xbebe3f09bf2e3f4ebf663f77bf7f3f7f
.octa 0x3f763f773f783f783f793f7a3f7a3f7b,0xbe8fbe89be82be79be6dbe60be54be48,0x3db0bdfbbea7bf04bf2ebf51bf6bbf7b,0x3f7f3f7e3f723f5c3f3c3f133eca3e48,0xbf7ebf5fbf1bbe793e233f093f533f7b,0xbde2befcbf4cbf78bf7dbf58bf11be48,0x3e9b3f4a3f803f5c3ed5be2fbf33bf7b,0xbf74bf1dbd7b3f043f693f7c3f373e48
.octa 0x3f603e89bf01bf78bf5abe603f0c3f7b,0x3ef73f773f5d3e79bf06bf7abf57be48,0xbf25bf7ebee13f043f803f13bebebf7b,0x3f44bdfbbf66bf5cbd173f513f6e3e48,0xbf203efc3f7e3e79bf4fbf583e3b3f7b,0xbf48bf5f3e0a3f783f16bf09bf7cbe48,0x3f633f1dbf2abf5c3eb23f7c3c49bf7b,0xbeec3f4a3f40bf04bf703e2f3f803e48
.octa 0x3e8fbf77be823f783e6dbf7abe543f7b,0x3f763e89bf78be793f793e60bf7abe48,0xbf7f3dfb3f72bf04bf3c3f513ecabf7b,0x3db0bf7e3ea73f5cbf2ebf133f6b3e48,0x3de23f5fbf4cbe793f7dbf09bf113f7b,0xbf7e3efc3f1bbf783e233f58bf53be48,0x3f74bf4abd7b3f5cbf693e2f3f37bf7b,0x3e9b3f1dbf803f043ed5bf7c3f333e48
.octa 0xbef7be893f5dbf783f063e60bf573f7b,0x3f60bf773f013e79bf5a3f7abf0cbe48,0xbf443f7ebf663f043d17bf133f6ebf7b,0xbf253dfb3ee1bf5c3f80bf513ebe3e48,0x3f48befc3e0a3e79bf163f58bf7c3f7b,0xbf203f5fbf7e3f78bf4f3f09be3bbe48,0x3eecbf1d3f40bf5c3f70bf7c3f80bf7b,0x3f63bf4a3f2abf043eb2be2fbc493e48
.octa 0x3f6e3f6f3f703f713f723f733f743f75,0xbebebeb8beb2beacbea7bea1be9bbe95,0x3f7c3f803f793f673f4c3f273ef73e95,0xbe3b3cc93e6d3edb3f1b3f423f603f75,0x3f803f6a3f2e3eacbd7bbee6bf44bf75,0x3c493ecf3f3c3f713f803f653f253e95,0x3f7a3f313e23bedbbf5dbf7fbf48be95,0x3e543f393f7d3f673f01bd97bf20bf75
.octa 0x3f6b3eb8bed5bf71bf66bea13eec3f75,0x3eca3f6f3f693eacbee1bf73bf63be95,0x3f53bcc9bf5abf67be0a3f423f763e95,0x3f113f803f06bedbbf7ebf273e8f3f75,0x3f33becfbf80beac3f403f65bdb0bf75,0x3f373f6abd17bf71bf2a3ee63f7f3e95,0x3f0cbf39bf4f3edb3f78bd97bf7ebe95,0x3f573f31bf16bf673e823f7f3de2bf75
.octa 0x3ebebf6fbeb23f713ea7bf73be9b3f75,0x3f6e3eb8bf70beac3f723ea1bf74be95,0x3e3bbf803e6d3f67bf1bbf273f603e95,0x3f7cbcc9bf793edb3f4cbf42bef73f75,0xbc49bf6a3f3c3eacbf803ee63f25bf75,0x3f80becfbf2e3f71bd7bbf653f443e95,0xbe54bf313f7dbedbbf013f7fbf20be95,0x3f7abf39be233f67bf5d3d973f48bf75
.octa 0xbecabeb83f69bf713ee13ea1bf633f75,0x3f6bbf6f3ed53eacbf663f73beecbe95,0xbf113cc93f06bf673f7ebf423e8f3e95,0x3f53bf803f5abedbbe0a3f27bf763f75,0xbf373ecfbd17beac3f2abf653f7fbf75,0x3f33bf6a3f80bf713f40bee63db03e95,0xbf573f39bf163edbbe823d973de2be95,0x3f0cbf313f4fbf673f78bf7f3f7ebf75
.octa 0x3db03d973d7b3d493d173cc93c490000,0x3f7f3f7f3f803f803f803f803f803f80,0x3f7e3f733f5d3f3e3f163ecf3e540000,0x3de23ea13f013f2c3f4f3f6a3f7a3f80,0x3e9b3f273f663f803f703f393eca0000,0xbf74bf42bee1bd493eb23f313f6b3f80,0xbf60bee63e0a3f2c3f793f6f3f110000,0xbef7bf65bf7ebf3ebe6d3eb83f533f80
.octa 0xbf25bf7fbf40bd493f2e3f803f370000,0x3f443d97bf2abf80bf3cbcc93f333f80,0x3f20bea1bf78bf3e3e233f6a3f570000,0x3f483f733e82bf2cbf7dbecf3f0c3f80,0x3f633f42bea7bf80bed53f313f6e0000,0xbeec3f273f723d49bf69bf393ebe3f80,0xbe8f3f653f1bbf2cbf5a3eb83f7c0000,0xbf76bee63f4c3f3ebf06bf6f3e3b3f80
.octa 0xbf7fbd973f803d49bf80bcc93f800000,0x3db0bf7fbd7b3f803d17bf80bc493f80,0xbde2bf733f013f3ebf4fbecf3f7a0000,0x3f7ebea1bf5d3f2c3f16bf6abe543f80,0x3f74bf27bee13f80beb2bf393f6b0000,0x3e9b3f42bf66bd493f70bf31beca3f80,0x3ef73ee6bf7e3f2c3e6dbf6f3f530000,0xbf603f65be0abf3e3f79beb8bf113f80
.octa 0xbf443f7fbf2abd493f3cbf803f330000,0xbf25bd973f40bf803f2e3cc9bf373f80,0xbf483ea13e82bf3e3f7dbf6a3f0c0000,0x3f20bf733f78bf2c3e233ecfbf573f80,0x3eecbf423f72bf803f69bf313ebe0000,0x3f63bf273ea73d49bed53f39bf6e3f80,0x3f76bf653f4cbf2c3f06beb83e3b0000,0xbe8f3ee6bf1b3f3ebf5a3f6fbf7c3f80
.octa 0x3e3b3e2f3e233e163e0a3dfb3de23dc9,0x3f7c3f7c3f7d3f7d3f7e3f7e3f7e3f7f,0x3c493e603ed53f183f403f5f3f743f7f,0xbf80bf7abf69bf4ebf2abefcbe9bbdc9,0xbe54bf13bf5abf7dbf78bf4abef7bdc9,0x3f7a3f513f063e16be82bf1dbf60bf7f,0x3eca3f583f803f4e3ea7be89bf44bf7f,0xbf6bbf093d173f183f723f773f253dc9
.octa 0xbf11bf7cbf4fbe163f1b3f7e3f483dc9,0x3f533e2fbf16bf7dbf4cbdfb3f203f7f,0x3f373f7a3eb2bf18bf80befc3eec3f7f,0xbf333e603f703f4ebd7bbf5fbf63bdc9,0xbf57bf513e6d3f7d3f01bf1dbf76bdc9,0x3f0cbf13bf79be163f5d3f4abe8fbf7f,0x3f6e3f09bf3cbf4e3ee13f77bdb0bf7f,0xbebe3f583f2ebf18bf663e893f7f3dc9
.octa 0xbf7cbe2f3f7d3e16bf7ebdfb3f7e3dc9,0x3e3bbf7cbe233f7d3e0abf7ebde23f7f,0x3f80be60bf693f183f2abf5fbe9b3f7f,0x3c493f7abed5bf4e3f403efcbf74bdc9,0xbf7a3f133f06bf7d3e823f4abf60bdc9,0xbe54bf513f5a3e16bf783f1d3ef7bf7f,0x3f6bbf583d173f4ebf723e893f25bf7f,0x3eca3f09bf803f183ea7bf773f443dc9
.octa 0xbf533f7cbf16be163f4cbf7e3f203dc9,0xbf11be2f3f4fbf7d3f1b3dfbbf483f7f,0x3f33bf7a3f70bf183d7b3efcbf633f7f,0x3f37be60beb23f4ebf803f5fbeecbdc9,0xbf0c3f51bf793f7dbf5d3f1dbe8fbdc9,0xbf573f13be6dbe163f01bf4a3f76bf7f,0x3ebebf093f2ebf4e3f66bf773f7fbf7f,0x3f6ebf583f3cbf183ee1be893db03dc9
.octa 0x3e8f3e893e823e793e6d3e603e543e48,0x3f763f773f783f783f793f7a3f7a3f7b,0xbf7fbf7ebf72bf5cbf3cbf13becabe48,0x3db0bdfbbea7bf04bf2ebf51bf6bbf7b,0x3de23efc3f4c3f783f7d3f583f113e48,0xbf7ebf5fbf1bbe793e233f093f533f7b,0x3f743f1d3d7bbf04bf69bf7cbf37be48,0x3e9b3f4a3f803f5c3ed5be2fbf33bf7b
.octa 0xbef7bf77bf5dbe793f063f7a3f573e48,0x3f603e89bf01bf78bf5abe603f0c3f7b,0xbf443dfb3f663f5c3d17bf51bf6ebe48,0xbf25bf7ebee13f043f803f13bebebf7b,0x3f483f5fbe0abf78bf163f093f7c3e48,0xbf203efc3f7e3e79bf4fbf583e3b3f7b,0x3eecbf4abf403f043f70be2fbf80be48,0x3f633f1dbf2abf5c3eb23f7c3c49bf7b
.octa 0xbf76be893f783e79bf79be603f7a3e48,0x3e8fbf77be823f783e6dbf7abe543f7b,0xbdb03f7ebea7bf5c3f2e3f13bf6bbe48,0xbf7f3dfb3f72bf04bf3c3f513ecabf7b,0x3f7ebefcbf1b3f78be23bf583f533e48,0x3de23f5fbf4cbe793f7dbf09bf113f7b,0xbe9bbf1d3f80bf04bed53f7cbf33be48,0x3f74bf4abd7b3f5cbf693e2f3f37bf7b
.octa 0xbf603f77bf01be793f5abf7a3f0c3e48,0xbef7be893f5dbf783f063e60bf573f7b,0x3f25bdfbbee13f5cbf803f51bebebe48,0xbf443f7ebf663f043d17bf133f6ebf7b,0x3f20bf5f3f7ebf783f4fbf093e3b3e48,0x3f48befc3e0a3e79bf163f58bf7c3f7b,0xbf633f4abf2a3f04beb23e2f3c49be48,0x3eecbf1d3f40bf5c3f70bf7c3f80bf7b
.octa 0x3ebe3eb83eb23eac3ea73ea13e9b3e95,0x3f6e3f6f3f703f713f723f733f743f75,0x3e3bbcc9be6dbedbbf1bbf42bf60bf75,0x3f7c3f803f793f673f4c3f273ef73e95,0xbc49becfbf3cbf71bf80bf65bf25be95,0x3f803f6a3f2e3eacbd7bbee6bf44bf75,0xbe54bf39bf7dbf67bf013d973f203f75,0x3f7a3f313e23bedbbf5dbf7fbf48be95
.octa 0xbecabf6fbf69beac3ee13f733f633e95,0x3f6b3eb8bed5bf71bf66bea13eec3f75,0xbf11bf80bf063edb3f7e3f27be8fbf75,0x3f53bcc9bf5abf67be0a3f423f763e95,0xbf37bf6a3d173f713f2abee6bf7fbe95,0x3f33becfbf80beac3f403f65bdb0bf75,0xbf57bf313f163f67be82bf7fbde23f75,0x3f0cbf39bf4f3edb3f78bd97bf7ebe95
.octa 0xbf6ebeb83f703eacbf72bea13f743e95,0x3ebebf6fbeb23f713ea7bf73be9b3f75,0xbf7c3cc93f79bedbbf4c3f423ef7bf75,0x3e3bbf803e6d3f67bf1bbf273f603e95,0xbf803ecf3f2ebf713d7b3f65bf44be95,0xbc49bf6a3f3c3eacbf803ee63f25bf75,0xbf7a3f393e23bf673f5dbd97bf483f75,0xbe54bf313f7dbedbbf013f7fbf20be95
.octa 0xbf6b3f6fbed5beac3f66bf733eec3e95,0xbecabeb83f69bf713ee13ea1bf633f75,0xbf533f80bf5a3edb3e0abf273f76bf75,0xbf113cc93f06bf673f7ebf423e8f3e95,0xbf333f6abf803f71bf403ee6bdb0be95,0xbf373ecfbd17beac3f2abf653f7fbf75,0xbf0c3f31bf4f3f67bf783f7fbf7e3f75,0xbf573f39bf163edbbe823d973de2be95
.octa 0xbf7f3f7fbf803f80bf803f80bf803f80,0x3db0bd973d7bbd493d17bcc93c498000,0xbde23ea1bf013f2cbf4f3f6abf7a3f80,0x3f7ebf733f5dbf3e3f16becf3e548000,0x3f74bf423ee1bd49beb23f31bf6b3f80,0x3e9bbf273f66bf803f70bf393eca8000,0x3ef7bf653f7ebf3e3e6d3eb8bf533f80,0xbf603ee63e0abf2c3f79bf6f3f118000
.octa 0xbf443d973f2abf803f3cbcc9bf333f80,0xbf253f7fbf403d493f2ebf803f378000,0xbf483f73be82bf2c3f7dbecfbf0c3f80,0x3f203ea1bf783f3e3e23bf6a3f578000,0x3eec3f27bf723d493f69bf39bebe3f80,0x3f63bf42bea73f80bed5bf313f6e8000,0x3f76bee6bf4c3f3e3f06bf6fbe3b3f80,0xbe8fbf653f1b3f2cbf5abeb83f7c8000
.octa 0xbdb0bf7f3d7b3f80bd17bf803c493f80,0xbf7f3d973f80bd49bf803cc93f808000,0xbf7ebea13f5d3f2cbf16bf6a3e543f80,0xbde23f733f01bf3ebf4f3ecf3f7a8000,0xbe9b3f423f66bd49bf70bf313eca3f80,0x3f743f27bee1bf80beb23f393f6b8000,0x3f603f653e0abf3ebf79beb83f113f80,0x3ef7bee6bf7ebf2c3e6d3f6f3f538000
.octa 0x3f25bd97bf40bf80bf2e3cc93f373f80,0xbf44bf7fbf2a3d493f3c3f803f338000,0xbf20bf73bf78bf2cbe233ecf3f573f80,0xbf48bea13e823f3e3f7d3f6a3f0c8000,0xbf63bf27bea73d493ed53f393f6e3f80,0x3eec3f423f723f803f693f313ebe8000,0x3e8f3ee63f1b3f3e3f5a3f6f3f7c3f80,0x3f763f653f4c3f2c3f063eb83e3b8000
.octa 0xbf7c3f7cbf7d3f7dbf7e3f7ebf7e3f7f,0x3e3bbe2f3e23be163e0abdfb3de2bdc9,0x3f80bf7a3f69bf4e3f2abefc3e9bbdc9,0x3c49be603ed5bf183f40bf5f3f74bf7f,0xbf7a3f51bf063e163e82bf1d3f60bf7f,0xbe543f13bf5a3f7dbf783f4abef73dc9,0x3f6bbf09bd173f18bf723f77bf253dc9,0x3ecabf583f80bf4e3ea73e89bf443f7f
.octa 0xbf533e2f3f16bf7d3f4cbdfbbf203f7f,0xbf113f7cbf4f3e163f1bbf7e3f48bdc9,0x3f333e60bf703f4e3d7bbf5f3f63bdc9,0x3f37bf7a3eb23f18bf803efc3eecbf7f,0xbf0cbf133f79be16bf5d3f4a3e8fbf7f,0xbf573f513e6dbf7d3f013f1dbf763dc9,0x3ebe3f58bf2ebf183f663e89bf7f3dc9,0x3f6ebf09bf3c3f4e3ee1bf77bdb03f7f
.octa 0xbe3bbf7c3e233f7dbe0abf7e3de23f7f,0xbf7c3e2f3f7dbe16bf7e3dfb3f7ebdc9,0xbc493f7a3ed5bf4ebf403efc3f74bdc9,0x3f803e60bf69bf183f2a3f5fbe9bbf7f,0x3e54bf51bf5a3e163f783f1dbef7bf7f,0xbf7abf133f063f7d3e82bf4abf603dc9,0xbeca3f093f803f18bea7bf77bf443dc9,0x3f6b3f583d17bf4ebf72be893f253f7f
.octa 0x3f11be2fbf4fbf7dbf1b3dfb3f483f7f,0xbf53bf7cbf163e163f4c3f7e3f20bdc9,0xbf37be603eb23f4e3f803f5f3eecbdc9,0x3f333f7a3f703f183d7bbefcbf63bf7f,0x3f573f133e6dbe16bf01bf4abf76bf7f,0xbf0cbf51bf79bf7dbf5dbf1dbe8f3dc9,0xbf6ebf58bf3cbf18bee1be89bdb03dc9,0x3ebe3f093f2e3f4e3f663f773f7f3f7f
.octa 0xbf763f77bf783f78bf793f7abf7a3f7b,0x3e8fbe893e82be793e6dbe603e54be48,0xbdb0bdfb3ea7bf043f2ebf513f6bbf7b,0xbf7f3f7ebf723f5cbf3c3f13beca3e48,0x3f7ebf5f3f1bbe79be233f09bf533f7b,0x3de2befc3f4cbf783f7dbf583f11be48,0xbe9b3f4abf803f5cbed5be2f3f33bf7b,0x3f74bf1d3d7b3f04bf693f7cbf373e48
.octa 0xbf603e893f01bf783f5abe60bf0c3f7b,0xbef73f77bf5d3e793f06bf7a3f57be48,0x3f25bf7e3ee13f04bf803f133ebebf7b,0xbf44bdfb3f66bf5c3d173f51bf6e3e48,0x3f203efcbf7e3e793f4fbf58be3b3f7b,0x3f48bf5fbe0a3f78bf16bf093f7cbe48,0xbf633f1d3f2abf5cbeb23f7cbc49bf7b,0x3eec3f4abf40bf043f703e2fbf803e48
.octa 0xbe8fbf773e823f78be6dbf7a3e543f7b,0xbf763e893f78be79bf793e603f7abe48,0x3f7f3dfbbf72bf043f3c3f51becabf7b,0xbdb0bf7ebea73f5c3f2ebf13bf6b3e48,0xbde23f5f3f4cbe79bf7dbf093f113f7b,0x3f7e3efcbf1bbf78be233f583f53be48,0xbf74bf4a3d7b3f5c3f693e2fbf37bf7b,0xbe9b3f1d3f803f04bed5bf7cbf333e48
.octa 0x3ef7be89bf5dbf78bf063e603f573f7b,0xbf60bf77bf013e793f5a3f7a3f0cbe48,0x3f443f7e3f663f04bd17bf13bf6ebf7b,0x3f253dfbbee1bf5cbf80bf51bebe3e48,0xbf48befcbe0a3e793f163f583f7c3f7b,0x3f203f5f3f7e3f783f4f3f093e3bbe48,0xbeecbf1dbf40bf5cbf70bf7cbf80bf7b,0xbf63bf4abf2abf04beb2be2f3c493e48
.octa 0xbf6e3f6fbf703f71bf723f73bf743f75,0x3ebebeb83eb2beac3ea7bea13e9bbe95,0xbf7c3f80bf793f67bf4c3f27bef73e95,0x3e3b3cc9be6d3edbbf1b3f42bf603f75,0xbf803f6abf2e3eac3d7bbee63f44bf75,0xbc493ecfbf3c3f71bf803f65bf253e95,0xbf7a3f31be23bedb3f5dbf7f3f48be95,0xbe543f39bf7d3f67bf01bd973f20bf75
.octa 0xbf6b3eb83ed5bf713f66bea1beec3f75,0xbeca3f6fbf693eac3ee1bf733f63be95,0xbf53bcc93f5abf673e0a3f42bf763e95,0xbf113f80bf06bedb3f7ebf27be8f3f75,0xbf33becf3f80beacbf403f653db0bf75,0xbf373f6a3d17bf713f2a3ee6bf7f3e95,0xbf0cbf393f4f3edbbf78bd973f7ebe95,0xbf573f313f16bf67be823f7fbde2bf75
.octa 0xbebebf6f3eb23f71bea7bf733e9b3f75,0xbf6e3eb83f70beacbf723ea13f74be95,0xbe3bbf80be6d3f673f1bbf27bf603e95,0xbf7cbcc93f793edbbf4cbf423ef73f75,0x3c49bf6abf3c3eac3f803ee6bf25bf75,0xbf80becf3f2e3f713d7bbf65bf443e95,0x3e54bf31bf7dbedb3f013f7f3f20be95,0xbf7abf393e233f673f5d3d97bf48bf75
.octa 0x3ecabeb8bf69bf71bee13ea13f633f75,0xbf6bbf6fbed53eac3f663f733eecbe95,0x3f113cc9bf06bf67bf7ebf42be8f3e95,0xbf53bf80bf5abedb3e0a3f273f763f75,0x3f373ecf3d17beacbf2abf65bf7fbf75,0xbf33bf6abf80bf71bf40bee6bdb03e95,0x3f573f393f163edb3e823d97bde2be95,0xbf0cbf31bf4fbf67bf78bf7fbf7ebf75
.octa 0xbdb03d97bd7b3d49bd173cc9bc490000,0xbf7f3f7fbf803f80bf803f80bf803f80,0xbf7e3f73bf5d3f3ebf163ecfbe540000,0xbde23ea1bf013f2cbf4f3f6abf7a3f80,0xbe9b3f27bf663f80bf703f39beca0000,0x3f74bf423ee1bd49beb23f31bf6b3f80,0x3f60bee6be0a3f2cbf793f6fbf110000,0x3ef7bf653f7ebf3e3e6d3eb8bf533f80
.octa 0x3f25bf7f3f40bd49bf2e3f80bf370000,0xbf443d973f2abf803f3cbcc9bf333f80,0xbf20bea13f78bf3ebe233f6abf570000,0xbf483f73be82bf2c3f7dbecfbf0c3f80,0xbf633f423ea7bf803ed53f31bf6e0000,0x3eec3f27bf723d493f69bf39bebe3f80,0x3e8f3f65bf1bbf2c3f5a3eb8bf7c0000,0x3f76bee6bf4c3f3e3f06bf6fbe3b3f80
.octa 0x3f7fbd97bf803d493f80bcc9bf800000,0xbdb0bf7f3d7b3f80bd17bf803c493f80,0x3de2bf73bf013f3e3f4fbecfbf7a0000,0xbf7ebea13f5d3f2cbf16bf6a3e543f80,0xbf74bf273ee13f803eb2bf39bf6b0000,0xbe9b3f423f66bd49bf70bf313eca3f80,0xbef73ee63f7e3f2cbe6dbf6fbf530000,0x3f603f653e0abf3ebf79beb83f113f80
.octa 0x3f443f7f3f2abd49bf3cbf80bf330000,0x3f25bd97bf40bf80bf2e3cc93f373f80,0x3f483ea1be82bf3ebf7dbf6abf0c0000,0xbf20bf73bf78bf2cbe233ecf3f573f80,0xbeecbf42bf72bf80bf69bf31bebe0000,0xbf63bf27bea73d493ed53f393f6e3f80,0xbf76bf65bf4cbf2cbf06beb8be3b0000,0x3e8f3ee63f1b3f3e3f5a3f6f3f7c3f80
.octa 0xbe3b3e2fbe233e16be0a3dfbbde23dc9,0xbf7c3f7cbf7d3f7dbf7e3f7ebf7e3f7f,0xbc493e60bed53f18bf403f5fbf743f7f,0x3f80bf7a3f69bf4e3f2abefc3e9bbdc9,0x3e54bf133f5abf7d3f78bf4a3ef7bdc9,0xbf7a3f51bf063e163e82bf1d3f60bf7f,0xbeca3f58bf803f4ebea7be893f44bf7f,0x3f6bbf09bd173f18bf723f77bf253dc9
.octa 0x3f11bf7c3f4fbe16bf1b3f7ebf483dc9,0xbf533e2f3f16bf7d3f4cbdfbbf203f7f,0xbf373f7abeb2bf183f80befcbeec3f7f,0x3f333e60bf703f4e3d7bbf5f3f63bdc9,0x3f57bf51be6d3f7dbf01bf1d3f76bdc9,0xbf0cbf133f79be16bf5d3f4a3e8fbf7f,0xbf6e3f093f3cbf4ebee13f773db0bf7f,0x3ebe3f58bf2ebf183f663e89bf7f3dc9
.octa 0x3f7cbe2fbf7d3e163f7ebdfbbf7e3dc9,0xbe3bbf7c3e233f7dbe0abf7e3de23f7f,0xbf80be603f693f18bf2abf5f3e9b3f7f,0xbc493f7a3ed5bf4ebf403efc3f74bdc9,0x3f7a3f13bf06bf7dbe823f4a3f60bdc9,0x3e54bf51bf5a3e163f783f1dbef7bf7f,0xbf6bbf58bd173f4e3f723e89bf25bf7f,0xbeca3f093f803f18bea7bf77bf443dc9
.octa 0x3f533f7c3f16be16bf4cbf7ebf203dc9,0x3f11be2fbf4fbf7dbf1b3dfb3f483f7f,0xbf33bf7abf70bf18bd7b3efc3f633f7f,0xbf37be603eb23f4e3f803f5f3eecbdc9,0x3f0c3f513f793f7d3f5d3f1d3e8fbdc9,0x3f573f133e6dbe16bf01bf4abf76bf7f,0xbebebf09bf2ebf4ebf66bf77bf7fbf7f,0xbf6ebf58bf3cbf18bee1be89bdb03dc9
.octa 0xbe8f3e89be823e79be6d3e60be543e48,0xbf763f77bf783f78bf793f7abf7a3f7b,0x3f7fbf7e3f72bf5c3f3cbf133ecabe48,0xbdb0bdfb3ea7bf043f2ebf513f6bbf7b,0xbde23efcbf4c3f78bf7d3f58bf113e48,0x3f7ebf5f3f1bbe79be233f09bf533f7b,0xbf743f1dbd7bbf043f69bf7c3f37be48,0xbe9b3f4abf803f5cbed5be2f3f33bf7b
.octa 0x3ef7bf773f5dbe79bf063f7abf573e48,0xbf603e893f01bf783f5abe60bf0c3f7b,0x3f443dfbbf663f5cbd17bf513f6ebe48,0x3f25bf7e3ee13f04bf803f133ebebf7b,0xbf483f5f3e0abf783f163f09bf7c3e48,0x3f203efcbf7e3e793f4fbf58be3b3f7b,0xbeecbf4a3f403f04bf70be2f3f80be48,0xbf633f1d3f2abf5cbeb23f7cbc49bf7b
.octa 0x3f76be89bf783e793f79be60bf7a3e48,0xbe8fbf773e823f78be6dbf7a3e543f7b,0x3db03f7e3ea7bf5cbf2e3f133f6bbe48,0x3f7f3dfbbf72bf043f3c3f51becabf7b,0xbf7ebefc3f1b3f783e23bf58bf533e48,0xbde23f5f3f4cbe79bf7dbf093f113f7b,0x3e9bbf1dbf80bf043ed53f7c3f33be48,0xbf74bf4a3d7b3f5c3f693e2fbf37bf7b
.octa 0x3f603f773f01be79bf5abf7abf0c3e48,0x3ef7be89bf5dbf78bf063e603f573f7b,0xbf25bdfb3ee13f5c3f803f513ebebe48,0x3f443f7e3f663f04bd17bf13bf6ebf7b,0xbf20bf5fbf7ebf78bf4fbf09be3b3e48,0xbf48befcbe0a3e793f163f583f7c3f7b,0x3f633f4a3f2a3f043eb23e2fbc49be48,0xbeecbf1dbf40bf5cbf70bf7cbf80bf7b
.octa 0xbebe3eb8beb23eacbea73ea1be9b3e95,0xbf6e3f6fbf703f71bf723f73bf743f75,0xbe3bbcc93e6dbedb3f1bbf423f60bf75,0xbf7c3f80bf793f67bf4c3f27bef73e95,0x3c49becf3f3cbf713f80bf653f25be95,0xbf803f6abf2e3eac3d7bbee63f44bf75,0x3e54bf393f7dbf673f013d97bf203f75,0xbf7a3f31be23bedb3f5dbf7f3f48be95
.octa 0x3ecabf6f3f69beacbee13f73bf633e95,0xbf6b3eb83ed5bf713f66bea1beec3f75,0x3f11bf803f063edbbf7e3f273e8fbf75,0xbf53bcc93f5abf673e0a3f42bf763e95,0x3f37bf6abd173f71bf2abee63f7fbe95,0xbf33becf3f80beacbf403f653db0bf75,0x3f57bf31bf163f673e82bf7f3de23f75,0xbf0cbf393f4f3edbbf78bd973f7ebe95
.octa 0x3f6ebeb8bf703eac3f72bea1bf743e95,0xbebebf6f3eb23f71bea7bf733e9b3f75,0x3f7c3cc9bf79bedb3f4c3f42bef7bf75,0xbe3bbf80be6d3f673f1bbf27bf603e95,0x3f803ecfbf2ebf71bd7b3f653f44be95,0x3c49bf6abf3c3eac3f803ee6bf25bf75,0x3f7a3f39be23bf67bf5dbd973f483f75,0x3e54bf31bf7dbedb3f013f7f3f20be95
.octa 0x3f6b3f6f3ed5beacbf66bf73beec3e95,0x3ecabeb8bf69bf71bee13ea13f633f75,0x3f533f803f5a3edbbe0abf27bf76bf75,0x3f113cc9bf06bf67bf7ebf42be8f3e95,0x3f333f6a3f803f713f403ee63db0be95,0x3f373ecf3d17beacbf2abf65bf7fbf75,0x3f0c3f313f4f3f673f783f7f3f7e3f75,0x3f573f393f163edb3e823d97bde2be95
.octa 0x3f7f3f7f3f7f3f803f803f803f803f80,0xbddbbdbcbd9dbd7bbd3cbcfbbc7b8000,0x3db63e983efb3f2a3f4e3f693f7a3f80,0xbf7fbf75bf5fbf40bf18bed2be578000,0xbf76bf45bee8bd7b3eae3f2f3f6b3f80,0xbe90bf24bf64bf80bf71bf3abecb8000,0xbeedbf63bf7ebf40be763eb53f533f80,0x3f633eefbdf4bf2abf79bf6fbf118000
.octa 0x3f473dbcbf27bf80bf3dbcfb3f323f80,0x3f213f7f3f423d7bbf2dbf80bf388000,0x3f443f753e8abf2abf7dbed23f0b3f80,0xbf243e983f773f40be19bf69bf578000,0xbef63f243f733d7bbf68bf3a3ebd3f80,0xbf61bf453e9f3f803ed9bf2fbf6e8000,0xbf74beef3f493f40bf04bf6f3e383f80,0x3e99bf63bf1e3f2a3f5bbeb5bf7c8000
.octa 0x3ddbbf7fbd9d3f803d3cbf80bc7b3f80,0x3f7f3dbcbf7fbd7b3f803cfbbf808000,0x3f7fbe98bf5f3f2a3f18bf69be573f80,0x3db63f75befbbf403f4e3ed2bf7a8000,0x3e903f45bf64bd7b3f71bf2fbecb3f80,0xbf763f243ee8bf803eae3f3abf6b8000,0xbf633f63bdf4bf403f79beb5bf113f80,0xbeedbeef3f7ebf2abe763f6fbf538000
.octa 0xbf21bdbc3f42bf803f2d3cfbbf383f80,0x3f47bf7f3f273d7bbf3d3f80bf328000,0x3f24bf753f77bf2a3e193ed2bf573f80,0x3f44be98be8a3f40bf7d3f69bf0b8000,0x3f61bf243e9f3d7bbed93f3abf6e3f80,0xbef63f45bf733f80bf683f2fbebd8000,0xbe993eefbf1e3f40bf5b3f6fbf7c3f80,0xbf743f63bf493f2abf043eb5be388000
.octa 0x3f793f7a3f7b3f7c3f7c3f7d3f7e3f7e,0xbe6abe5abe4bbe3bbe2cbe1cbe0dbdfb,0xbf80bf7cbf6dbf53bf30bf05bea8bdfb,0x3d0abe35bec2bf11bf3abf5bbf72bf7e,0x3f7d3f573f0f3e3bbe63bf17bf5dbf7e,0x3e263f0a3f543f7c3f7a3f4f3f023dfb,0xbf70bf12bb493f113f6f3f793f2a3dfb,0xbeb4bf52bf80bf53beb73e733f3f3f7e
.octa 0x3f5a3e5abf0ebf7cbf51be1c3f1a3f7e,0x3f073f7a3f553e3bbf14bf7dbf4cbdfb,0xbf3b3e353f6c3f53bce2bf5bbf66bdfb,0xbf2fbf7cbec53f113f803f05bedfbf7e,0x3f15bf0abf7bbe3b3f593f4fbe81bf7e,0x3f503f57be45bf7cbf083f173f783dfb,0xbed43f523f36bf11bf6a3e733f803dfb,0xbf69bf123f343f53bed1bf793d6f3f7e
.octa 0x3e6abf7abe4b3f7c3e2cbf7dbe0d3f7e,0x3f793e5abf7bbe3b3f7c3e1cbf7ebdfb,0xbd0a3f7cbec2bf533f3a3f05bf72bdfb,0xbf803e353f6dbf11bf303f5b3ea8bf7e,0xbe26bf573f543e3bbf7a3f173f02bf7e,0x3f7dbf0abf0f3f7cbe63bf4f3f5d3dfb,0x3eb43f12bf803f113eb7bf793f3f3dfb,0xbf703f523b49bf533f6fbe73bf2a3f7e
.octa 0xbf07be5a3f55bf7c3f143e1cbf4c3f7e,0x3f5abf7a3f0e3e3bbf513f7dbf1abdfb,0x3f2fbe35bec53f53bf803f5bbedfbdfb,0xbf3b3f7cbf6c3f11bce2bf053f66bf7e,0xbf503f0abe45be3b3f08bf4f3f78bf7e,0x3f15bf573f7bbf7c3f59bf173e813dfb,0x3f69bf523f34bf113ed1be733d6f3dfb,0xbed43f12bf363f53bf6a3f79bf803f7e
.octa 0x3f703f723f733f743f753f763f773f78,0xbeb1beaabea2be9bbe93be8cbe84be79,0x3e20bd62be87beecbf23bf49bf66bf78,0x3f7d3f803f773f633f453f1f3ee23e79,0xbf80bf67bf28be9b3dcf3efa3f4b3f78,0xbd23bedebf41bf74bf7fbf60bf1cbe79,0x3e703f3f3f7e3f633ef0bdeebf29bf78,0xbf79bf2bbe003eec3f623f7e3f403e79
.octa 0x3f683eaabee5bf74bf61be8c3f003f78,0x3ed73f723f653e9bbef3bf76bf5ebe79,0xbf17bf80befe3eec3f7f3f1fbea5bf78,0x3f4fbd62bf5ebf63bdc23f493f723e79,0xbf2e3ede3f7f3e9bbf46bf603e073f78,0xbf3cbf673d903f743f22befabf7ebe79,0x3f5a3f2bbf1dbf633e963f7e3d84bf78,0xbf063f3f3f4abeecbf753dee3f7f3e79
.octa 0x3eb1bf72bea23f743e93bf76be843f78,0x3f703eaabf73be9b3f753e8cbf77be79,0xbf7d3d623f77beecbf453f493ee2bf78,0x3e20bf803e873f63bf23bf1f3f663e79,0x3d233f67bf41be9b3f7fbefabf1c3f78,0xbf803ede3f28bf743dcf3f60bf4bbe79,0x3f79bf3fbe003f63bf623dee3f40bf78,0x3e703f2bbf7e3eec3ef0bf7e3f293e79
.octa 0xbed7beaa3f65bf743ef33e8cbf5e3f78,0x3f68bf723ee53e9bbf613f76bf00be79,0xbf4f3f80bf5e3eec3dc2bf1f3f72bf78,0xbf173d623efebf633f7fbf493ea53e79,0x3f3cbede3d903e9bbf223f60bf7e3f78,0xbf2e3f67bf7f3f74bf463efabe07be79,0x3f06bf2b3f4abf633f75bf7e3f7fbf78,0x3f5abf3f3f1dbeec3e96bdeebd843e79
.octa 0x3f643f653f673f693f6a3f6c3f6d3f6f,0xbeeabee3bedcbed5becebec7bec0beb8,0x3f763f7f3f7d3f703f583f363f0c3eb8,0xbe8dbd8a3e133eb23f0a3f343f563f6f,0x3f7f3f733f3e3ed53cb0bec1bf37bf6f,0xbda93ea43f2b3f693f803f6d3f333eb8,0x3f7e3f413e7cbeb2bf52bf80bf54beb8,0x3de83f283f783f703f133bc9bf10bf6f
.octa 0x3f743ee3beabbf69bf6fbec73ec83f6f,0x3e9c3f653f713ed5bebabf6cbf6cbeb8,0x3f603d8abf4dbf70be5d3f343f7b3eb8,0x3ef83f7f3f19beb2bf7abf363e513f6f,0x3f43bea4bf80bed53f313f6dbc17bf6f,0x3f253f733d56bf69bf393ec13f803eb8,0x3f1fbf28bf5c3eb23f7c3bc9bf7cbeb8,0x3f483f41bf03bf703e323f803e3fbf6f
.octa 0x3eeabf65bedc3f693ecebf6cbec03f6f,0x3f643ee3bf67bed53f6a3ec7bf6dbeb8,0x3e8dbf7f3e133f70bf0abf363f563eb8,0x3f763d8abf7d3eb23f58bf34bf0c3f6f,0x3da9bf733f2b3ed5bf803ec13f33bf6f,0x3f7fbea4bf3e3f693cb0bf6d3f373eb8,0xbde8bf413f78beb2bf133f80bf10beb8,0x3f7ebf28be7c3f70bf52bbc93f54bf6f
.octa 0xbe9cbee33f71bf693eba3ec7bf6c3f6f,0x3f74bf653eab3ed5bf6f3f6cbec8beb8,0xbef8bd8a3f19bf703f7abf343e513eb8,0x3f60bf7f3f4dbeb2be5d3f36bf7b3f6f,0xbf253ea43d56bed53f39bf6d3f80bf6f,0x3f43bf733f80bf693f31bec13c173eb8,0xbf483f28bf033eb2be32bbc93e3fbeb8,0x3f1fbf413f5cbf703f7cbf803f7cbf6f
.octa 0x3ddb3dbc3d9d3d7b3d3c3cfb3c7b0000,0x3f7f3f7f3f7f3f803f803f803f803f80,0x3f7f3f753f5f3f403f183ed23e570000,0x3db63e983efb3f2a3f4e3f693f7a3f80,0x3e903f243f643f803f713f3a3ecb0000,0xbf76bf45bee8bd7b3eae3f2f3f6b3f80,0xbf63beef3df43f2a3f793f6f3f110000,0xbeedbf63bf7ebf40be763eb53f533f80
.octa 0xbf21bf7fbf42bd7b3f2d3f803f380000,0x3f473dbcbf27bf80bf3dbcfb3f323f80,0x3f24be98bf77bf403e193f693f570000,0x3f443f753e8abf2abf7dbed23f0b3f80,0x3f613f45be9fbf80bed93f2f3f6e0000,0xbef63f243f733d7bbf68bf3a3ebd3f80,0xbe993f633f1ebf2abf5b3eb53f7c0000,0xbf74beef3f493f40bf04bf6f3e383f80
.octa 0xbf7fbdbc3f7f3d7bbf80bcfb3f800000,0x3ddbbf7fbd9d3f803d3cbf80bc7b3f80,0xbdb6bf753efb3f40bf4ebed23f7a0000,0x3f7fbe98bf5f3f2a3f18bf69be573f80,0x3f76bf24bee83f80beaebf3a3f6b0000,0x3e903f45bf64bd7b3f71bf2fbecb3f80,0x3eed3eefbf7e3f2a3e76bf6f3f530000,0xbf633f63bdf4bf403f79beb5bf113f80
.octa 0xbf473f7fbf27bd7b3f3dbf803f320000,0xbf21bdbc3f42bf803f2d3cfbbf383f80,0xbf443e983e8abf403f7dbf693f0b0000,0x3f24bf753f77bf2a3e193ed2bf573f80,0x3ef6bf453f73bf803f68bf2f3ebd0000,0x3f61bf243e9f3d7bbed93f3abf6e3f80,0x3f74bf633f49bf2a3f04beb53e380000,0xbe993eefbf1e3f40bf5b3f6fbf7c3f80
.octa 0x3e6a3e5a3e4b3e3b3e2c3e1c3e0d3dfb,0x3f793f7a3f7b3f7c3f7c3f7d3f7e3f7e,0xbd0a3e353ec23f113f3a3f5b3f723f7e,0xbf80bf7cbf6dbf53bf30bf05bea8bdfb,0xbe26bf0abf54bf7cbf7abf4fbf02bdfb,0x3f7d3f573f0f3e3bbe63bf17bf5dbf7e,0x3eb43f523f803f533eb7be73bf3fbf7e,0xbf70bf12bb493f113f6f3f793f2a3dfb
.octa 0xbf07bf7abf55be3b3f143f7d3f4c3dfb,0x3f5a3e5abf0ebf7cbf51be1c3f1a3f7e,0x3f2f3f7c3ec5bf11bf80bf053edf3f7e,0xbf3b3e353f6c3f53bce2bf5bbf66bdfb,0xbf50bf573e453f7c3f08bf17bf78bdfb,0x3f15bf0abf7bbe3b3f593f4fbe81bf7e,0x3f693f12bf34bf533ed13f79bd6fbf7e,0xbed43f523f36bf11bf6a3e733f803dfb
.octa 0xbf79be5a3f7b3e3bbf7cbe1c3f7e3dfb,0x3e6abf7abe4b3f7c3e2cbf7dbe0d3f7e,0x3f80be35bf6d3f113f30bf5bbea83f7e,0xbd0a3f7cbec2bf533f3a3f05bf72bdfb,0xbf7d3f0a3f0fbf7c3e633f4fbf5dbdfb,0xbe26bf573f543e3bbf7a3f173f02bf7e,0x3f70bf52bb493f53bf6f3e733f2abf7e,0x3eb43f12bf803f113eb7bf793f3f3dfb
.octa 0xbf5a3f7abf0ebe3b3f51bf7d3f1a3dfb,0xbf07be5a3f55bf7c3f143e1cbf4c3f7e,0x3f3bbf7c3f6cbf113ce23f05bf663f7e,0x3f2fbe35bec53f53bf803f5bbedfbdfb,0xbf153f57bf7b3f7cbf593f17be81bdfb,0xbf503f0abe45be3b3f08bf4f3f78bf7e,0x3ed4bf123f36bf533f6abf793f80bf7e,0x3f69bf523f34bf113ed1be733d6f3dfb
.octa 0x3eb13eaa3ea23e9b3e933e8c3e843e79,0x3f703f723f733f743f753f763f773f78,0xbf7dbf80bf77bf63bf45bf1fbee2be79,0x3e20bd62be87beecbf23bf49bf66bf78,0x3d233ede3f413f743f7f3f603f1c3e79,0xbf80bf67bf28be9b3dcf3efa3f4b3f78,0x3f793f2b3e00beecbf62bf7ebf40be79,0x3e703f3f3f7e3f633ef0bdeebf29bf78
.octa 0xbed7bf72bf65be9b3ef33f763f5e3e79,0x3f683eaabee5bf74bf61be8c3f003f78,0xbf4f3d623f5e3f633dc2bf49bf72be79,0xbf17bf80befe3eec3f7f3f1fbea5bf78,0x3f3c3f67bd90bf74bf223efa3f7e3e79,0xbf2e3ede3f7f3e9bbf46bf603e073f78,0x3f06bf3fbf4a3eec3f75bdeebf7fbe79,0x3f5a3f2bbf1dbf633e963f7e3d84bf78
.octa 0xbf70beaa3f733e9bbf75be8c3f773e79,0x3eb1bf72bea23f743e93bf76be843f78,0xbe203f80be87bf633f233f1fbf66be79,0xbf7d3d623f77beecbf453f493ee2bf78,0x3f80bedebf283f74bdcfbf603f4b3e79,0x3d233f67bf41be9b3f7fbefabf1c3f78,0xbe70bf2b3f7ebeecbef03f7ebf29be79,0x3f79bf3fbe003f63bf623dee3f40bf78
.octa 0xbf683f72bee5be9b3f61bf763f003e79,0xbed7beaa3f65bf743ef33e8cbf5e3f78,0x3f17bd62befe3f63bf7f3f49bea5be79,0xbf4f3f80bf5e3eec3dc2bf1f3f72bf78,0x3f2ebf673f7fbf743f46befa3e073e79,0x3f3cbede3d903e9bbf223f60bf7e3f78,0xbf5a3f3fbf1d3eecbe963dee3d84be79,0x3f06bf2b3f4abf633f75bf7e3f7fbf78
.octa 0x3eea3ee33edc3ed53ece3ec73ec03eb8,0x3f643f653f673f693f6a3f6c3f6d3f6f,0x3e8d3d8abe13beb2bf0abf34bf56bf6f,0x3f763f7f3f7d3f703f583f363f0c3eb8,0x3da9bea4bf2bbf69bf80bf6dbf33beb8,0x3f7f3f733f3e3ed53cb0bec1bf37bf6f,0xbde8bf28bf78bf70bf13bbc93f103f6f,0x3f7e3f413e7cbeb2bf52bf80bf54beb8
.octa 0xbe9cbf65bf71bed53eba3f6c3f6c3eb8,0x3f743ee3beabbf69bf6fbec73ec83f6f,0xbef8bf7fbf193eb23f7a3f36be51bf6f,0x3f603d8abf4dbf70be5d3f343f7b3eb8,0xbf25bf73bd563f693f39bec1bf80beb8,0x3f43bea4bf80bed53f313f6dbc17bf6f,0xbf48bf413f033f70be32bf80be3f3f6f,0x3f1fbf28bf5c3eb23f7c3bc9bf7cbeb8
.octa 0xbf64bee33f673ed5bf6abec73f6d3eb8,0x3eeabf65bedc3f693ecebf6cbec03f6f,0xbf76bd8a3f7dbeb2bf583f343f0cbf6f,0x3e8dbf7f3e133f70bf0abf363f563eb8,0xbf7f3ea43f3ebf69bcb03f6dbf37beb8,0x3da9bf733f2b3ed5bf803ec13f33bf6f,0xbf7e3f283e7cbf703f523bc9bf543f6f,0xbde8bf413f78beb2bf133f80bf10beb8
.octa 0xbf743f65beabbed53f6fbf6c3ec83eb8,0xbe9cbee33f71bf693eba3ec7bf6c3f6f,0xbf603f7fbf4d3eb23e5dbf363f7bbf6f,0xbef8bd8a3f19bf703f7abf343e513eb8,0xbf433f73bf803f69bf313ec1bc17beb8,0xbf253ea43d56bed53f39bf6d3f80bf6f,0xbf1f3f41bf5c3f70bf7c3f80bf7c3f6f,0xbf483f28bf033eb2be32bbc93e3fbeb8
.octa 0xbf7f3f7fbf7f3f80bf803f80bf803f80,0x3ddbbdbc3d9dbd7b3d3cbcfb3c7b8000,0xbdb63e98befb3f2abf4e3f69bf7a3f80,0x3f7fbf753f5fbf403f18bed23e578000,0x3f76bf453ee8bd7bbeae3f2fbf6b3f80,0x3e90bf243f64bf803f71bf3a3ecb8000,0x3eedbf633f7ebf403e763eb5bf533f80,0xbf633eef3df4bf2a3f79bf6f3f118000
.octa 0xbf473dbc3f27bf803f3dbcfbbf323f80,0xbf213f7fbf423d7b3f2dbf803f388000,0xbf443f75be8abf2a3f7dbed2bf0b3f80,0x3f243e98bf773f403e19bf693f578000,0x3ef63f24bf733d7b3f68bf3abebd3f80,0x3f61bf45be9f3f80bed9bf2f3f6e8000,0x3f74beefbf493f403f04bf6fbe383f80,0xbe99bf633f1e3f2abf5bbeb53f7c8000
.octa 0xbddbbf7f3d9d3f80bd3cbf803c7b3f80,0xbf7f3dbc3f7fbd7bbf803cfb3f808000,0xbf7fbe983f5f3f2abf18bf693e573f80,0xbdb63f753efbbf40bf4e3ed23f7a8000,0xbe903f453f64bd7bbf71bf2f3ecb3f80,0x3f763f24bee8bf80beae3f3a3f6b8000,0x3f633f633df4bf40bf79beb53f113f80,0x3eedbeefbf7ebf2a3e763f6f3f538000
.octa 0x3f21bdbcbf42bf80bf2d3cfb3f383f80,0xbf47bf7fbf273d7b3f3d3f803f328000,0xbf24bf75bf77bf2abe193ed23f573f80,0xbf44be983e8a3f403f7d3f693f0b8000,0xbf61bf24be9f3d7b3ed93f3a3f6e3f80,0x3ef63f453f733f803f683f2f3ebd8000,0x3e993eef3f1e3f403f5b3f6f3f7c3f80,0x3f743f633f493f2a3f043eb53e388000
.octa 0xbf793f7abf7b3f7cbf7c3f7dbf7e3f7e,0x3e6abe5a3e4bbe3b3e2cbe1c3e0dbdfb,0x3f80bf7c3f6dbf533f30bf053ea8bdfb,0xbd0abe353ec2bf113f3abf5b3f72bf7e,0xbf7d3f57bf0f3e3b3e63bf173f5dbf7e,0xbe263f0abf543f7cbf7a3f4fbf023dfb,0x3f70bf123b493f11bf6f3f79bf2a3dfb,0x3eb4bf523f80bf533eb73e73bf3f3f7e
.octa 0xbf5a3e5a3f0ebf7c3f51be1cbf1a3f7e,0xbf073f7abf553e3b3f14bf7d3f4cbdfb,0x3f3b3e35bf6c3f533ce2bf5b3f66bdfb,0x3f2fbf7c3ec53f11bf803f053edfbf7e,0xbf15bf0a3f7bbe3bbf593f4f3e81bf7e,0xbf503f573e45bf7c3f083f17bf783dfb,0x3ed43f52bf36bf113f6a3e73bf803dfb,0x3f69bf12bf343f533ed1bf79bd6f3f7e
.octa 0xbe6abf7a3e4b3f7cbe2cbf7d3e0d3f7e,0xbf793e5a3f7bbe3bbf7c3e1c3f7ebdfb,0x3d0a3f7c3ec2bf53bf3a3f053f72bdfb,0x3f803e35bf6dbf113f303f5bbea8bf7e,0x3e26bf57bf543e3b3f7a3f17bf02bf7e,0xbf7dbf0a3f0f3f7c3e63bf4fbf5d3dfb,0xbeb43f123f803f11beb7bf79bf3f3dfb,0x3f703f52bb49bf53bf6fbe733f2a3f7e
.octa 0x3f07be5abf55bf7cbf143e1c3f4c3f7e,0xbf5abf7abf0e3e3b3f513f7d3f1abdfb,0xbf2fbe353ec53f533f803f5b3edfbdfb,0x3f3b3f7c3f6c3f113ce2bf05bf66bf7e,0x3f503f0a3e45be3bbf08bf4fbf78bf7e,0xbf15bf57bf7bbf7cbf59bf17be813dfb,0xbf69bf52bf34bf11bed1be73bd6f3dfb,0x3ed43f123f363f533f6a3f793f803f7e
.octa 0xbf703f72bf733f74bf753f76bf773f78,0x3eb1beaa3ea2be9b3e93be8c3e84be79,0xbe20bd623e87beec3f23bf493f66bf78,0xbf7d3f80bf773f63bf453f1fbee23e79,0x3f80bf673f28be9bbdcf3efabf4b3f78,0x3d23bede3f41bf743f7fbf603f1cbe79,0xbe703f3fbf7e3f63bef0bdee3f29bf78,0x3f79bf2b3e003eecbf623f7ebf403e79
.octa 0xbf683eaa3ee5bf743f61be8cbf003f78,0xbed73f72bf653e9b3ef3bf763f5ebe79,0x3f17bf803efe3eecbf7f3f1f3ea5bf78,0xbf4fbd623f5ebf633dc23f49bf723e79,0x3f2e3edebf7f3e9b3f46bf60be073f78,0x3f3cbf67bd903f74bf22befa3f7ebe79,0xbf5a3f2b3f1dbf63be963f7ebd84bf78,0x3f063f3fbf4abeec3f753deebf7f3e79
.octa 0xbeb1bf723ea23f74be93bf763e843f78,0xbf703eaa3f73be9bbf753e8c3f77be79,0x3f7d3d62bf77beec3f453f49bee2bf78,0xbe20bf80be873f633f23bf1fbf663e79,0xbd233f673f41be9bbf7fbefa3f1c3f78,0x3f803edebf28bf74bdcf3f603f4bbe79,0xbf79bf3f3e003f633f623deebf40bf78,0xbe703f2b3f7e3eecbef0bf7ebf293e79
.octa 0x3ed7beaabf65bf74bef33e8c3f5e3f78,0xbf68bf72bee53e9b3f613f763f00be79,0x3f4f3f803f5e3eecbdc2bf1fbf72bf78,0x3f173d62befebf63bf7fbf49bea53e79,0xbf3cbedebd903e9b3f223f603f7e3f78,0x3f2e3f673f7f3f743f463efa3e07be79,0xbf06bf2bbf4abf63bf75bf7ebf7fbf78,0xbf5abf3fbf1dbeecbe96bdee3d843e79
.octa 0xbf643f65bf673f69bf6a3f6cbf6d3f6f,0x3eeabee33edcbed53ecebec73ec0beb8,0xbf763f7fbf7d3f70bf583f36bf0c3eb8,0x3e8dbd8abe133eb2bf0a3f34bf563f6f,0xbf7f3f73bf3e3ed5bcb0bec13f37bf6f,0x3da93ea4bf2b3f69bf803f6dbf333eb8,0xbf7e3f41be7cbeb23f52bf803f54beb8,0xbde83f28bf783f70bf133bc93f10bf6f
.octa 0xbf743ee33eabbf693f6fbec7bec83f6f,0xbe9c3f65bf713ed53ebabf6c3f6cbeb8,0xbf603d8a3f4dbf703e5d3f34bf7b3eb8,0xbef83f7fbf19beb23f7abf36be513f6f,0xbf43bea43f80bed5bf313f6d3c17bf6f,0xbf253f73bd56bf693f393ec1bf803eb8,0xbf1fbf283f5c3eb2bf7c3bc93f7cbeb8,0xbf483f413f03bf70be323f80be3fbf6f
.octa 0xbeeabf653edc3f69becebf6c3ec03f6f,0xbf643ee33f67bed5bf6a3ec73f6dbeb8,0xbe8dbf7fbe133f703f0abf36bf563eb8,0xbf763d8a3f7d3eb2bf58bf343f0c3f6f,0xbda9bf73bf2b3ed53f803ec1bf33bf6f,0xbf7fbea43f3e3f69bcb0bf6dbf373eb8,0x3de8bf41bf78beb23f133f803f10beb8,0xbf7ebf283e7c3f703f52bbc9bf54bf6f
.octa 0x3e9cbee3bf71bf69beba3ec73f6c3f6f,0xbf74bf65beab3ed53f6f3f6c3ec8beb8,0x3ef8bd8abf19bf70bf7abf34be513eb8,0xbf60bf7fbf4dbeb23e5d3f363f7b3f6f,0x3f253ea4bd56bed5bf39bf6dbf80bf6f,0xbf43bf73bf80bf69bf31bec1bc173eb8,0x3f483f283f033eb23e32bbc9be3fbeb8,0xbf1fbf41bf5cbf70bf7cbf80bf7cbf6f
.octa 0xbddb3dbcbd9d3d7bbd3c3cfbbc7b0000,0xbf7f3f7fbf7f3f80bf803f80bf803f80,0xbf7f3f75bf5f3f40bf183ed2be570000,0xbdb63e98befb3f2abf4e3f69bf7a3f80,0xbe903f24bf643f80bf713f3abecb0000,0x3f76bf453ee8bd7bbeae3f2fbf6b3f80,0x3f63beefbdf43f2abf793f6fbf110000,0x3eedbf633f7ebf403e763eb5bf533f80
.octa 0x3f21bf7f3f42bd7bbf2d3f80bf380000,0xbf473dbc3f27bf803f3dbcfbbf323f80,0xbf24be983f77bf40be193f69bf570000,0xbf443f75be8abf2a3f7dbed2bf0b3f80,0xbf613f453e9fbf803ed93f2fbf6e0000,0x3ef63f24bf733d7b3f68bf3abebd3f80,0x3e993f63bf1ebf2a3f5b3eb5bf7c0000,0x3f74beefbf493f403f04bf6fbe383f80
.octa 0x3f7fbdbcbf7f3d7b3f80bcfbbf800000,0xbddbbf7f3d9d3f80bd3cbf803c7b3f80,0x3db6bf75befb3f403f4ebed2bf7a0000,0xbf7fbe983f5f3f2abf18bf693e573f80,0xbf76bf243ee83f803eaebf3abf6b0000,0xbe903f453f64bd7bbf71bf2f3ecb3f80,0xbeed3eef3f7e3f2abe76bf6fbf530000,0x3f633f633df4bf40bf79beb53f113f80
.octa 0x3f473f7f3f27bd7bbf3dbf80bf320000,0x3f21bdbcbf42bf80bf2d3cfb3f383f80,0x3f443e98be8abf40bf7dbf69bf0b0000,0xbf24bf75bf77bf2abe193ed23f573f80,0xbef6bf45bf73bf80bf68bf2fbebd0000,0xbf61bf24be9f3d7b3ed93f3a3f6e3f80,0xbf74bf63bf49bf2abf04beb5be380000,0x3e993eef3f1e3f403f5b3f6f3f7c3f80
.octa 0xbe6a3e5abe4b3e3bbe2c3e1cbe0d3dfb,0xbf793f7abf7b3f7cbf7c3f7dbf7e3f7e,0x3d0a3e35bec23f11bf3a3f5bbf723f7e,0x3f80bf7c3f6dbf533f30bf053ea8bdfb,0x3e26bf0a3f54bf7c3f7abf4f3f02bdfb,0xbf7d3f57bf0f3e3b3e63bf173f5dbf7e,0xbeb43f52bf803f53beb7be733f3fbf7e,0x3f70bf123b493f11bf6f3f79bf2a3dfb
.octa 0x3f07bf7a3f55be3bbf143f7dbf4c3dfb,0xbf5a3e5a3f0ebf7c3f51be1cbf1a3f7e,0xbf2f3f7cbec5bf113f80bf05bedf3f7e,0x3f3b3e35bf6c3f533ce2bf5b3f66bdfb,0x3f50bf57be453f7cbf08bf173f78bdfb,0xbf15bf0a3f7bbe3bbf593f4f3e81bf7e,0xbf693f123f34bf53bed13f793d6fbf7e,0x3ed43f52bf36bf113f6a3e73bf803dfb
.octa 0x3f79be5abf7b3e3b3f7cbe1cbf7e3dfb,0xbe6abf7a3e4b3f7cbe2cbf7d3e0d3f7e,0xbf80be353f6d3f11bf30bf5b3ea83f7e,0x3d0a3f7c3ec2bf53bf3a3f053f72bdfb,0x3f7d3f0abf0fbf7cbe633f4f3f5dbdfb,0x3e26bf57bf543e3b3f7a3f17bf02bf7e,0xbf70bf523b493f533f6f3e73bf2abf7e,0xbeb43f123f803f11beb7bf79bf3f3dfb
.octa 0x3f5a3f7a3f0ebe3bbf51bf7dbf1a3dfb,0x3f07be5abf55bf7cbf143e1c3f4c3f7e,0xbf3bbf7cbf6cbf11bce23f053f663f7e,0xbf2fbe353ec53f533f803f5b3edfbdfb,0x3f153f573f7b3f7c3f593f173e81bdfb,0x3f503f0a3e45be3bbf08bf4fbf78bf7e,0xbed4bf12bf36bf53bf6abf79bf80bf7e,0xbf69bf52bf34bf11bed1be73bd6f3dfb
.octa 0xbeb13eaabea23e9bbe933e8cbe843e79,0xbf703f72bf733f74bf753f76bf773f78,0x3f7dbf803f77bf633f45bf1f3ee2be79,0xbe20bd623e87beec3f23bf493f66bf78,0xbd233edebf413f74bf7f3f60bf1c3e79,0x3f80bf673f28be9bbdcf3efabf4b3f78,0xbf793f2bbe00beec3f62bf7e3f40be79,0xbe703f3fbf7e3f63bef0bdee3f29bf78
.octa 0x3ed7bf723f65be9bbef33f76bf5e3e79,0xbf683eaa3ee5bf743f61be8cbf003f78,0x3f4f3d62bf5e3f63bdc2bf493f72be79,0x3f17bf803efe3eecbf7f3f1f3ea5bf78,0xbf3c3f673d90bf743f223efabf7e3e79,0x3f2e3edebf7f3e9b3f46bf60be073f78,0xbf06bf3f3f4a3eecbf75bdee3f7fbe79,0xbf5a3f2b3f1dbf63be963f7ebd84bf78
.octa 0x3f70beaabf733e9b3f75be8cbf773e79,0xbeb1bf723ea23f74be93bf763e843f78,0x3e203f803e87bf63bf233f1f3f66be79,0x3f7d3d62bf77beec3f453f49bee2bf78,0xbf80bede3f283f743dcfbf60bf4b3e79,0xbd233f673f41be9bbf7fbefa3f1c3f78,0x3e70bf2bbf7ebeec3ef03f7e3f29be79,0xbf79bf3f3e003f633f623deebf40bf78
.octa 0x3f683f723ee5be9bbf61bf76bf003e79,0x3ed7beaabf65bf74bef33e8c3f5e3f78,0xbf17bd623efe3f633f7f3f493ea5be79,0x3f4f3f803f5e3eecbdc2bf1fbf72bf78,0xbf2ebf67bf7fbf74bf46befabe073e79,0xbf3cbedebd903e9b3f223f603f7e3f78,0x3f5a3f3f3f1d3eec3e963deebd84be79,0xbf06bf2bbf4abf63bf75bf7ebf7fbf78
.octa 0xbeea3ee3bedc3ed5bece3ec7bec03eb8,0xbf643f65bf673f69bf6a3f6cbf6d3f6f,0xbe8d3d8a3e13beb23f0abf343f56bf6f,0xbf763f7fbf7d3f70bf583f36bf0c3eb8,0xbda9bea43f2bbf693f80bf6d3f33beb8,0xbf7f3f73bf3e3ed5bcb0bec13f37bf6f,0x3de8bf283f78bf703f13bbc9bf103f6f,0xbf7e3f41be7cbeb23f52bf803f54beb8
.octa 0x3e9cbf653f71bed5beba3f6cbf6c3eb8,0xbf743ee33eabbf693f6fbec7bec83f6f,0x3ef8bf7f3f193eb2bf7a3f363e51bf6f,0xbf603d8a3f4dbf703e5d3f34bf7b3eb8,0x3f25bf733d563f69bf39bec13f80beb8,0xbf43bea43f80bed5bf313f6d3c17bf6f,0x3f48bf41bf033f703e32bf803e3f3f6f,0xbf1fbf283f5c3eb2bf7c3bc93f7cbeb8
.octa 0x3f64bee3bf673ed53f6abec7bf6d3eb8,0xbeeabf653edc3f69becebf6c3ec03f6f,0x3f76bd8abf7dbeb23f583f34bf0cbf6f,0xbe8dbf7fbe133f703f0abf36bf563eb8,0x3f7f3ea4bf3ebf693cb03f6d3f37beb8,0xbda9bf73bf2b3ed53f803ec1bf33bf6f,0x3f7e3f28be7cbf70bf523bc93f543f6f,0x3de8bf41bf78beb23f133f803f10beb8
.octa 0x3f743f653eabbed5bf6fbf6cbec83eb8,0x3e9cbee3bf71bf69beba3ec73f6c3f6f,0x3f603f7f3f4d3eb2be5dbf36bf7bbf6f,0x3ef8bd8abf19bf70bf7abf34be513eb8,0x3f433f733f803f693f313ec13c17beb8,0x3f253ea4bd56bed5bf39bf6dbf80bf6f,0x3f1f3f413f5c3f703f7c3f803f7c3f6f,0x3f483f283f033eb23e32bbc9be3fbeb8
.octa 0x3f7e3f7e3f7f3f7f3f803f803f803f80,0xbe04bde2bdbcbd97bd62bd17bc978000,0x3d8a3e8f3ef43f273f4d3f693f7a3f80,0xbf7fbf76bf61bf42bf1abed5be5a8000,0xbf77bf48beefbd973eaa3f2e3f6b3f80,0xbe86bf20bf63bf7fbf72bf3cbecd8000,0xbee3bf60bf7fbf42be7f3eb23f523f80,0x3f653ef7bdd5bf27bf78bf70bf128000
.octa 0x3f4b3de2bf24bf7fbf3fbd173f323f80,0x3f1c3f7e3f453d97bf2bbf80bf388000,0x3f413f763e92bf27bf7dbed53f0a3f80,0xbf283e8f3f753f42be10bf69bf578000,0xbeff3f203f753d97bf67bf3c3ebb3f80,0xbf5ebf483e983f7f3edebf2ebf6e8000,0xbf73bef73f473f42bf02bf703e353f80,0x3ea4bf60bf213f273f5cbeb2bf7c8000
.octa 0x3e04bf7ebdbc3f7f3d62bf80bc973f80,0x3f7e3de2bf7fbd973f803d17bf808000,0x3f7fbe8fbf613f273f1abf69be5a3f80,0x3d8a3f76bef4bf423f4d3ed5bf7a8000,0x3e863f48bf63bd973f72bf2ebecd3f80,0xbf773f203eefbf7f3eaa3f3cbf6b8000,0xbf653f60bdd5bf423f78beb2bf123f80,0xbee3bef73f7fbf27be7f3f70bf528000
.octa 0xbf1cbde23f45bf7f3f2b3d17bf383f80,0x3f4bbf7e3f243d97bf3f3f80bf328000,0x3f28bf763f75bf273e103ed5bf573f80,0x3f41be8fbe923f42bf7d3f69bf0a8000,0x3f5ebf203e983d97bede3f3cbf6e3f80,0xbeff3f48bf753f7fbf673f2ebebb8000,0xbea43ef7bf213f42bf5c3f70bf7c3f80,0xbf733f60bf473f27bf023eb2be358000
.octa 0x3f763f783f793f7a3f7b3f7c3f7c3f7d,0xbe8cbe82be73be60be4ebe3bbe29be16,0xbf7fbf7ebf71bf58bf36bf0cbeb5be16,0x3da3be0abeafbf09bf34bf57bf6fbf7d,0x3f7e3f5d3f173e60be42bf11bf59bf7d,0x3dee3f013f4f3f7a3f7b3f533f083e16,0xbf74bf1bbd303f093f6c3f7a3f2f3e16,0xbe9ebf4cbf80bf58bec73e543f3a3f7d
.octa 0x3f603e82bf05bf7abf56be3b3f153f7d,0x3efa3f783f5b3e60bf0dbf7cbf50be16,0xbf433e0a3f683f583bc9bf57bf69be16,0xbf26bf7ebed83f093f803f0cbed2bf7d,0x3f1fbf01bf7dbe603f543f53be66bf7d,0x3f493f5dbe1cbf7abf103f113f793e16,0xbee93f4c3f3dbf09bf6d3e543f803e16,0xbf64bf1b3f2d3f58bec1bf7a3cfb3f7d
.octa 0x3e8cbf78be733f7a3e4ebf7cbe293f7d,0x3f763e82bf79be603f7b3e3bbf7cbe16,0xbda33f7ebeafbf583f343f0cbf6fbe16,0xbf7f3e0a3f71bf09bf363f573eb5bf7d,0xbdeebf5d3f4f3e60bf7b3f113f08bf7d,0x3f7ebf01bf173f7abe42bf533f593e16,0x3e9e3f1bbf803f093ec7bf7a3f3a3e16,0xbf743f4c3d30bf583f6cbe54bf2f3f7d
.octa 0xbefabe823f5bbf7a3f0d3e3bbf503f7d,0x3f60bf783f053e60bf563f7cbf15be16,0x3f26be0abed83f58bf803f57bed2be16,0xbf433f7ebf683f093bc9bf0c3f69bf7d,0xbf493f01be1cbe603f10bf533f79bf7d,0x3f1fbf5d3f7dbf7a3f54bf113e663e16,0x3f64bf4c3f2dbf093ec1be543cfb3e16,0xbee93f1bbf3d3f58bf6d3f7abf803f7d
.octa 0x3f693f6b3f6d3f6f3f713f723f743f75,0xbed2becabec1beb8beafbea7be9ebe95,0x3e663c49be4ebecfbf17bf40bf60bf75,0x3f793f803f7b3f6a3f4f3f2a3efa3e95,0xbf80bf6ebf34beb83d303ee13f433f75,0x3cfbbebebf36bf6fbf80bf66bf26be95,0x3e293f333f7b3f6a3f05bd7bbf1fbf75,0xbf7cbf37be423ecf3f5b3f803f493e95
.octa 0x3f6f3ecabec7bf6fbf68bea73ee93f75,0x3eb53f6b3f6c3eb8bed8bf72bf64be95,0xbf08bf80bf0d3ecf3f7d3f2abe8cbf75,0x3f593c49bf56bf6abe1c3f403f763e95,0xbf3a3ebe3f803eb8bf3dbf663da33f75,0xbf2fbf6e3bc93f6f3f2dbee1bf7fbe95,0x3f503f37bf10bf6a3e733f803deebf75,0xbf153f333f54becfbf793d7b3f7e3e95
.octa 0x3ed2bf6bbec13f6f3eafbf72be9e3f75,0x3f693ecabf6dbeb83f713ea7bf74be95,0xbf79bc493f7bbecfbf4f3f403efabf75,0x3e66bf803e4e3f6abf17bf2a3f603e95,0xbcfb3f6ebf36beb83f80bee1bf263f75,0xbf803ebe3f34bf6f3d303f66bf43be95,0x3f7cbf33be423f6abf5b3d7b3f49bf75,0x3e293f37bf7b3ecf3f05bf803f1f3e95
.octa 0xbeb5beca3f6cbf6f3ed83ea7bf643f75,0x3f6fbf6b3ec73eb8bf683f72bee9be95,0xbf593f80bf563ecf3e1cbf2a3f76bf75,0xbf08bc493f0dbf6a3f7dbf403e8c3e95,0x3f2fbebe3bc93eb8bf2d3f66bf7f3f75,0xbf3a3f6ebf803f6fbf3d3ee1bda3be95,0x3f15bf373f54bf6a3f79bf803f7ebf75,0x3f50bf333f10becf3e73bd7bbdee3e95
.octa 0x3f573f5a3f5c3f5f3f613f633f653f67,0xbf0abf06bf02befcbef4beecbee3bedb,0x3f6e3f7d3f803f773f633f443f1c3edb,0xbebbbe233d623e893eef3f253f4b3f67,0x3f7c3f793f4d3efc3dd5be9bbf28bf67,0xbe353e6d3f1a3f5f3f7f3f743f413edb,0x3f803f4f3eaabe89bf45bf7fbf5ebedb,0x3c973f163f723f773f243db0beffbf67
.octa 0x3f7a3f06be7fbf5fbf75beec3ea43f67,0x3e5a3f5a3f783efcbe92bf63bf73bedb,0x3f6b3e23bf3fbf77be983f253f7e3edb,0x3ecd3f7d3f2bbe89bf75bf443e043f67,0x3f52be6dbf7dbefc3f213f743d8abf67,0x3f123f793e10bf5fbf473e9b3f7f3edb,0x3f32bf16bf673e893f7f3db0bf77bedb,0x3f383f4fbedebf773dbc3f7f3e86bf67
.octa 0x3f0abf5abf023f5f3ef4bf63bee33f67,0x3f573f06bf5cbefc3f613eecbf65bedb,0x3ebbbf7d3d623f77beefbf443f4b3edb,0x3f6e3e23bf803e893f63bf25bf1c3f67,0x3e35bf793f1a3efcbf7f3e9b3f41bf67,0x3f7cbe6dbf4d3f5f3dd5bf743f283edb,0xbc97bf4f3f72be89bf243f7fbeffbedb,0x3f80bf16beaa3f77bf45bdb03f5ebf67
.octa 0xbe5abf063f78bf5f3e923eecbf733f67,0x3f7abf5a3e7f3efcbf753f63bea4bedb,0xbecdbe233f2bbf773f75bf253e043edb,0x3f6bbf7d3f3fbe89be983f44bf7e3f67,0xbf123e6d3e10befc3f47bf743f7fbf67,0x3f52bf793f7dbf5f3f21be9bbd8a3edb,0xbf383f16bede3e89bdbcbdb03e86bedb,0x3f32bf4f3f67bf773f7fbf7f3f77bf67
.octa 0x3e043de23dbc3d973d623d173c970000,0x3f7e3f7e3f7f3f7f3f803f803f803f80,0x3f7f3f763f613f423f1a3ed53e5a0000,0x3d8a3e8f3ef43f273f4d3f693f7a3f80,0x3e863f203f633f7f3f723f3c3ecd0000,0xbf77bf48beefbd973eaa3f2e3f6b3f80,0xbf65bef73dd53f273f783f703f120000,0xbee3bf60bf7fbf42be7f3eb23f523f80
.octa 0xbf1cbf7ebf45bd973f2b3f803f380000,0x3f4b3de2bf24bf7fbf3fbd173f323f80,0x3f28be8fbf75bf423e103f693f570000,0x3f413f763e92bf27bf7dbed53f0a3f80,0x3f5e3f48be98bf7fbede3f2e3f6e0000,0xbeff3f203f753d97bf67bf3c3ebb3f80,0xbea43f603f21bf27bf5c3eb23f7c0000,0xbf73bef73f473f42bf02bf703e353f80
.octa 0xbf7ebde23f7f3d97bf80bd173f800000,0x3e04bf7ebdbc3f7f3d62bf80bc973f80,0xbd8abf763ef43f42bf4dbed53f7a0000,0x3f7fbe8fbf613f273f1abf69be5a3f80,0x3f77bf20beef3f7fbeaabf3c3f6b0000,0x3e863f48bf63bd973f72bf2ebecd3f80,0x3ee33ef7bf7f3f273e7fbf703f520000,0xbf653f60bdd5bf423f78beb2bf123f80
.octa 0xbf4b3f7ebf24bd973f3fbf803f320000,0xbf1cbde23f45bf7f3f2b3d17bf383f80,0xbf413e8f3e92bf423f7dbf693f0a0000,0x3f28bf763f75bf273e103ed5bf573f80,0x3effbf483f75bf7f3f67bf2e3ebb0000,0x3f5ebf203e983d97bede3f3cbf6e3f80,0x3f73bf603f47bf273f02beb23e350000,0xbea43ef7bf213f42bf5c3f70bf7c3f80
.octa 0x3e8c3e823e733e603e4e3e3b3e293e16,0x3f763f783f793f7a3f7b3f7c3f7c3f7d,0xbda33e0a3eaf3f093f343f573f6f3f7d,0xbf7fbf7ebf71bf58bf36bf0cbeb5be16,0xbdeebf01bf4fbf7abf7bbf53bf08be16,0x3f7e3f5d3f173e60be42bf11bf59bf7d,0x3e9e3f4c3f803f583ec7be54bf3abf7d,0xbf74bf1bbd303f093f6c3f7a3f2f3e16
.octa 0xbefabf78bf5bbe603f0d3f7c3f503e16,0x3f603e82bf05bf7abf56be3b3f153f7d,0x3f263f7e3ed8bf09bf80bf0c3ed23f7d,0xbf433e0a3f683f583bc9bf57bf69be16,0xbf49bf5d3e1c3f7a3f10bf11bf79be16,0x3f1fbf01bf7dbe603f543f53be66bf7d,0x3f643f1bbf2dbf583ec13f7abcfbbf7d,0xbee93f4c3f3dbf09bf6d3e543f803e16
.octa 0xbf76be823f793e60bf7bbe3b3f7c3e16,0x3e8cbf78be733f7a3e4ebf7cbe293f7d,0x3f7fbe0abf713f093f36bf57beb53f7d,0xbda33f7ebeafbf583f343f0cbf6fbe16,0xbf7e3f013f17bf7a3e423f53bf59be16,0xbdeebf5d3f4f3e60bf7b3f113f08bf7d,0x3f74bf4cbd303f58bf6c3e543f2fbf7d,0x3e9e3f1bbf803f093ec7bf7a3f3a3e16
.octa 0xbf603f78bf05be603f56bf7c3f153e16,0xbefabe823f5bbf7a3f0d3e3bbf503f7d,0x3f43bf7e3f68bf09bbc93f0cbf693f7d,0x3f26be0abed83f58bf803f57bed2be16,0xbf1f3f5dbf7d3f7abf543f11be66be16,0xbf493f01be1cbe603f10bf533f79bf7d,0x3ee9bf1b3f3dbf583f6dbf7a3f80bf7d,0x3f64bf4c3f2dbf093ec1be543cfb3e16
.octa 0x3ed23eca3ec13eb83eaf3ea73e9e3e95,0x3f693f6b3f6d3f6f3f713f723f743f75,0xbf79bf80bf7bbf6abf4fbf2abefabe95,0x3e663c49be4ebecfbf17bf40bf60bf75,0xbcfb3ebe3f363f6f3f803f663f263e95,0xbf80bf6ebf34beb83d303ee13f433f75,0x3f7c3f373e42becfbf5bbf80bf49be95,0x3e293f333f7b3f6a3f05bd7bbf1fbf75
.octa 0xbeb5bf6bbf6cbeb83ed83f723f643e95,0x3f6f3ecabec7bf6fbf68bea73ee93f75,0xbf59bc493f563f6a3e1cbf40bf76be95,0xbf08bf80bf0d3ecf3f7d3f2abe8cbf75,0x3f2f3f6ebbc9bf6fbf2d3ee13f7f3e95,0xbf3a3ebe3f803eb8bf3dbf663da33f75,0x3f15bf33bf543ecf3f79bd7bbf7ebe95,0x3f503f37bf10bf6a3e733f803deebf75
.octa 0xbf69beca3f6d3eb8bf71bea73f743e95,0x3ed2bf6bbec13f6f3eafbf72be9e3f75,0xbe663f80be4ebf6a3f173f2abf60be95,0xbf79bc493f7bbecfbf4f3f403efabf75,0x3f80bebebf343f6fbd30bf663f433e95,0xbcfb3f6ebf36beb83f80bee1bf263f75,0xbe29bf373f7bbecfbf053f80bf1fbe95,0x3f7cbf33be423f6abf5b3d7b3f49bf75
.octa 0xbf6f3f6bbec7beb83f68bf723ee93e95,0xbeb5beca3f6cbf6f3ed83ea7bf643f75,0x3f083c49bf0d3f6abf7d3f40be8cbe95,0xbf593f80bf563ecf3e1cbf2a3f76bf75,0x3f3abf6e3f80bf6f3f3dbee13da33e95,0x3f2fbebe3bc93eb8bf2d3f66bf7f3f75,0xbf503f33bf103ecfbe733d7b3deebe95,0x3f15bf373f54bf6a3f79bf803f7ebf75
.octa 0x3f0a3f063f023efc3ef43eec3ee33edb,0x3f573f5a3f5c3f5f3f613f633f653f67,0x3ebb3e23bd62be89beefbf25bf4bbf67,0x3f6e3f7d3f803f773f633f443f1c3edb,0x3e35be6dbf1abf5fbf7fbf74bf41bedb,0x3f7c3f793f4d3efc3dd5be9bbf28bf67,0xbc97bf16bf72bf77bf24bdb03eff3f67,0x3f803f4f3eaabe89bf45bf7fbf5ebedb
.octa 0xbe5abf5abf78befc3e923f633f733edb,0x3f7a3f06be7fbf5fbf75beec3ea43f67,0xbecdbf7dbf2b3e893f753f44be04bf67,0x3f6b3e23bf3fbf77be983f253f7e3edb,0xbf12bf79be103f5f3f47be9bbf7fbedb,0x3f52be6dbf7dbefc3f213f743d8abf67,0xbf38bf4f3ede3f77bdbcbf7fbe863f67,0x3f32bf16bf673e893f7f3db0bf77bedb
.octa 0xbf57bf063f5c3efcbf61beec3f653edb,0x3f0abf5abf023f5f3ef4bf63bee33f67,0xbf6ebe233f80be89bf633f253f1cbf67,0x3ebbbf7d3d623f77beefbf443f4b3edb,0xbf7c3e6d3f4dbf5fbdd53f74bf28bedb,0x3e35bf793f1a3efcbf7f3e9b3f41bf67,0xbf803f163eaabf773f453db0bf5e3f67,0xbc97bf4f3f72be89bf243f7fbeffbedb
.octa 0xbf7a3f5abe7fbefc3f75bf633ea43edb,0xbe5abf063f78bf5f3e923eecbf733f67,0xbf6b3f7dbf3f3e893e98bf443f7ebf67,0xbecdbe233f2bbf773f75bf253e043edb,0xbf523f79bf7d3f5fbf213e9b3d8abedb,0xbf123e6d3e10befc3f47bf743f7fbf67,0xbf323f4fbf673f77bf7f3f7fbf773f67,0xbf383f16bede3e89bdbcbdb03e86bedb
.octa 0xbf7e3f7ebf7f3f7fbf803f80bf803f80,0x3e04bde23dbcbd973d62bd173c978000,0xbd8a3e8fbef43f27bf4d3f69bf7a3f80,0x3f7fbf763f61bf423f1abed53e5a8000,0x3f77bf483eefbd97beaa3f2ebf6b3f80,0x3e86bf203f63bf7f3f72bf3c3ecd8000,0x3ee3bf603f7fbf423e7f3eb2bf523f80,0xbf653ef73dd5bf273f78bf703f128000
.octa 0xbf4b3de23f24bf7f3f3fbd17bf323f80,0xbf1c3f7ebf453d973f2bbf803f388000,0xbf413f76be92bf273f7dbed5bf0a3f80,0x3f283e8fbf753f423e10bf693f578000,0x3eff3f20bf753d973f67bf3cbebb3f80,0x3f5ebf48be983f7fbedebf2e3f6e8000,0x3f73bef7bf473f423f02bf70be353f80,0xbea4bf603f213f27bf5cbeb23f7c8000
.octa 0xbe04bf7e3dbc3f7fbd62bf803c973f80,0xbf7e3de23f7fbd97bf803d173f808000,0xbf7fbe8f3f613f27bf1abf693e5a3f80,0xbd8a3f763ef4bf42bf4d3ed53f7a8000,0xbe863f483f63bd97bf72bf2e3ecd3f80,0x3f773f20beefbf7fbeaa3f3c3f6b8000,0x3f653f603dd5bf42bf78beb23f123f80,0x3ee3bef7bf7fbf273e7f3f703f528000
.octa 0x3f1cbde2bf45bf7fbf2b3d173f383f80,0xbf4bbf7ebf243d973f3f3f803f328000,0xbf28bf76bf75bf27be103ed53f573f80,0xbf41be8f3e923f423f7d3f693f0a8000,0xbf5ebf20be983d973ede3f3c3f6e3f80,0x3eff3f483f753f7f3f673f2e3ebb8000,0x3ea43ef73f213f423f5c3f703f7c3f80,0x3f733f603f473f273f023eb23e358000
.octa 0xbf763f78bf793f7abf7b3f7cbf7c3f7d,0x3e8cbe823e73be603e4ebe3b3e29be16,0x3f7fbf7e3f71bf583f36bf0c3eb5be16,0xbda3be0a3eafbf093f34bf573f6fbf7d,0xbf7e3f5dbf173e603e42bf113f59bf7d,0xbdee3f01bf4f3f7abf7b3f53bf083e16,0x3f74bf1b3d303f09bf6c3f7abf2f3e16,0x3e9ebf4c3f80bf583ec73e54bf3a3f7d
.octa 0xbf603e823f05bf7a3f56be3bbf153f7d,0xbefa3f78bf5b3e603f0dbf7c3f50be16,0x3f433e0abf683f58bbc9bf573f69be16,0x3f26bf7e3ed83f09bf803f0c3ed2bf7d,0xbf1fbf013f7dbe60bf543f533e66bf7d,0xbf493f5d3e1cbf7a3f103f11bf793e16,0x3ee93f4cbf3dbf093f6d3e54bf803e16,0x3f64bf1bbf2d3f583ec1bf7abcfb3f7d
.octa 0xbe8cbf783e733f7abe4ebf7c3e293f7d,0xbf763e823f79be60bf7b3e3b3f7cbe16,0x3da33f7e3eafbf58bf343f0c3f6fbe16,0x3f7f3e0abf71bf093f363f57beb5bf7d,0x3deebf5dbf4f3e603f7b3f11bf08bf7d,0xbf7ebf013f173f7a3e42bf53bf593e16,0xbe9e3f1b3f803f09bec7bf7abf3a3e16,0x3f743f4cbd30bf58bf6cbe543f2f3f7d
.octa 0x3efabe82bf5bbf7abf0d3e3b3f503f7d,0xbf60bf78bf053e603f563f7c3f15be16,0xbf26be0a3ed83f583f803f573ed2be16,0x3f433f7e3f683f09bbc9bf0cbf69bf7d,0x3f493f013e1cbe60bf10bf53bf79bf7d,0xbf1fbf5dbf7dbf7abf54bf11be663e16,0xbf64bf4cbf2dbf09bec1be54bcfb3e16,0x3ee93f1b3f3d3f583f6d3f7a3f803f7d
.octa 0xbf693f6bbf6d3f6fbf713f72bf743f75,0x3ed2beca3ec1beb83eafbea73e9ebe95,0xbe663c493e4ebecf3f17bf403f60bf75,0xbf793f80bf7b3f6abf4f3f2abefa3e95,0x3f80bf6e3f34beb8bd303ee1bf433f75,0xbcfbbebe3f36bf6f3f80bf663f26be95,0xbe293f33bf7b3f6abf05bd7b3f1fbf75,0x3f7cbf373e423ecfbf5b3f80bf493e95
.octa 0xbf6f3eca3ec7bf6f3f68bea7bee93f75,0xbeb53f6bbf6c3eb83ed8bf723f64be95,0x3f08bf803f0d3ecfbf7d3f2a3e8cbf75,0xbf593c493f56bf6a3e1c3f40bf763e95,0x3f3a3ebebf803eb83f3dbf66bda33f75,0x3f2fbf6ebbc93f6fbf2dbee13f7fbe95,0xbf503f373f10bf6abe733f80bdeebf75,0x3f153f33bf54becf3f793d7bbf7e3e95
.octa 0xbed2bf6b3ec13f6fbeafbf723e9e3f75,0xbf693eca3f6dbeb8bf713ea73f74be95,0x3f79bc49bf7bbecf3f4f3f40befabf75,0xbe66bf80be4e3f6a3f17bf2abf603e95,0x3cfb3f6e3f36beb8bf80bee13f263f75,0x3f803ebebf34bf6fbd303f663f43be95,0xbf7cbf333e423f6a3f5b3d7bbf49bf75,0xbe293f373f7b3ecfbf05bf80bf1f3e95
.octa 0x3eb5becabf6cbf6fbed83ea73f643f75,0xbf6fbf6bbec73eb83f683f723ee9be95,0x3f593f803f563ecfbe1cbf2abf76bf75,0x3f08bc49bf0dbf6abf7dbf40be8c3e95,0xbf2fbebebbc93eb83f2d3f663f7f3f75,0x3f3a3f6e3f803f6f3f3d3ee13da3be95,0xbf15bf37bf54bf6abf79bf80bf7ebf75,0xbf50bf33bf10becfbe73bd7b3dee3e95
.octa 0xbf573f5abf5c3f5fbf613f63bf653f67,0x3f0abf063f02befc3ef4beec3ee3bedb,0xbf6e3f7dbf803f77bf633f44bf1c3edb,0x3ebbbe23bd623e89beef3f25bf4b3f67,0xbf7c3f79bf4d3efcbdd5be9b3f28bf67,0x3e353e6dbf1a3f5fbf7f3f74bf413edb,0xbf803f4fbeaabe893f45bf7f3f5ebedb,0xbc973f16bf723f77bf243db03effbf67
.octa 0xbf7a3f063e7fbf5f3f75beecbea43f67,0xbe5a3f5abf783efc3e92bf633f73bedb,0xbf6b3e233f3fbf773e983f25bf7e3edb,0xbecd3f7dbf2bbe893f75bf44be043f67,0xbf52be6d3f7dbefcbf213f74bd8abf67,0xbf123f79be10bf5f3f473e9bbf7f3edb,0xbf32bf163f673e89bf7f3db03f77bedb,0xbf383f4f3edebf77bdbc3f7fbe86bf67
.octa 0xbf0abf5a3f023f5fbef4bf633ee33f67,0xbf573f063f5cbefcbf613eec3f65bedb,0xbebbbf7dbd623f773eefbf44bf4b3edb,0xbf6e3e233f803e89bf63bf253f1c3f67,0xbe35bf79bf1a3efc3f7f3e9bbf41bf67,0xbf7cbe6d3f4d3f5fbdd5bf74bf283edb,0x3c97bf4fbf72be893f243f7f3effbedb,0xbf80bf163eaa3f773f45bdb0bf5ebf67
.octa 0x3e5abf06bf78bf5fbe923eec3f733f67,0xbf7abf5abe7f3efc3f753f633ea4bedb,0x3ecdbe23bf2bbf77bf75bf25be043edb,0xbf6bbf7dbf3fbe893e983f443f7e3f67,0x3f123e6dbe10befcbf47bf74bf7fbf67,0xbf52bf79bf7dbf5fbf21be9b3d8a3edb,0x3f383f163ede3e893dbcbdb0be86bedb,0xbf32bf4fbf67bf77bf7fbf7fbf77bf67
.octa 0xbe043de2bdbc3d97bd623d17bc970000,0xbf7e3f7ebf7f3f7fbf803f80bf803f80,0xbf7f3f76bf613f42bf1a3ed5be5a0000,0xbd8a3e8fbef43f27bf4d3f69bf7a3f80,0xbe863f20bf633f7fbf723f3cbecd0000,0x3f77bf483eefbd97beaa3f2ebf6b3f80,0x3f65bef7bdd53f27bf783f70bf120000,0x3ee3bf603f7fbf423e7f3eb2bf523f80
.octa 0x3f1cbf7e3f45bd97bf2b3f80bf380000,0xbf4b3de23f24bf7f3f3fbd17bf323f80,0xbf28be8f3f75bf42be103f69bf570000,0xbf413f76be92bf273f7dbed5bf0a3f80,0xbf5e3f483e98bf7f3ede3f2ebf6e0000,0x3eff3f20bf753d973f67bf3cbebb3f80,0x3ea43f60bf21bf273f5c3eb2bf7c0000,0x3f73bef7bf473f423f02bf70be353f80
.octa 0x3f7ebde2bf7f3d973f80bd17bf800000,0xbe04bf7e3dbc3f7fbd62bf803c973f80,0x3d8abf76bef43f423f4dbed5bf7a0000,0xbf7fbe8f3f613f27bf1abf693e5a3f80,0xbf77bf203eef3f7f3eaabf3cbf6b0000,0xbe863f483f63bd97bf72bf2e3ecd3f80,0xbee33ef73f7f3f27be7fbf70bf520000,0x3f653f603dd5bf42bf78beb23f123f80
.octa 0x3f4b3f7e3f24bd97bf3fbf80bf320000,0x3f1cbde2bf45bf7fbf2b3d173f383f80,0x3f413e8fbe92bf42bf7dbf69bf0a0000,0xbf28bf76bf75bf27be103ed53f573f80,0xbeffbf48bf75bf7fbf67bf2ebebb0000,0xbf5ebf20be983d973ede3f3c3f6e3f80,0xbf73bf60bf47bf27bf02beb2be350000,0x3ea43ef73f213f423f5c3f703f7c3f80
.octa 0xbe8c3e82be733e60be4e3e3bbe293e16,0xbf763f78bf793f7abf7b3f7cbf7c3f7d,0x3da33e0abeaf3f09bf343f57bf6f3f7d,0x3f7fbf7e3f71bf583f36bf0c3eb5be16,0x3deebf013f4fbf7a3f7bbf533f08be16,0xbf7e3f5dbf173e603e42bf113f59bf7d,0xbe9e3f4cbf803f58bec7be543f3abf7d,0x3f74bf1b3d303f09bf6c3f7abf2f3e16
.octa 0x3efabf783f5bbe60bf0d3f7cbf503e16,0xbf603e823f05bf7a3f56be3bbf153f7d,0xbf263f7ebed8bf093f80bf0cbed23f7d,0x3f433e0abf683f58bbc9bf573f69be16,0x3f49bf5dbe1c3f7abf10bf113f79be16,0xbf1fbf013f7dbe60bf543f533e66bf7d,0xbf643f1b3f2dbf58bec13f7a3cfbbf7d,0x3ee93f4cbf3dbf093f6d3e54bf803e16
.octa 0x3f76be82bf793e603f7bbe3bbf7c3e16,0xbe8cbf783e733f7abe4ebf7c3e293f7d,0xbf7fbe0a3f713f09bf36bf573eb53f7d,0x3da33f7e3eafbf58bf343f0c3f6fbe16,0x3f7e3f01bf17bf7abe423f533f59be16,0x3deebf5dbf4f3e603f7b3f11bf08bf7d,0xbf74bf4c3d303f583f6c3e54bf2fbf7d,0xbe9e3f1b3f803f09bec7bf7abf3a3e16
.octa 0x3f603f783f05be60bf56bf7cbf153e16,0x3efabe82bf5bbf7abf0d3e3b3f503f7d,0xbf43bf7ebf68bf093bc93f0c3f693f7d,0xbf26be0a3ed83f583f803f573ed2be16,0x3f1f3f5d3f7d3f7a3f543f113e66be16,0x3f493f013e1cbe60bf10bf53bf79bf7d,0xbee9bf1bbf3dbf58bf6dbf7abf80bf7d,0xbf64bf4cbf2dbf09bec1be54bcfb3e16
.octa 0xbed23ecabec13eb8beaf3ea7be9e3e95,0xbf693f6bbf6d3f6fbf713f72bf743f75,0x3f79bf803f7bbf6a3f4fbf2a3efabe95,0xbe663c493e4ebecf3f17bf403f60bf75,0x3cfb3ebebf363f6fbf803f66bf263e95,0x3f80bf6e3f34beb8bd303ee1bf433f75,0xbf7c3f37be42becf3f5bbf803f49be95,0xbe293f33bf7b3f6abf05bd7b3f1fbf75
.octa 0x3eb5bf6b3f6cbeb8bed83f72bf643e95,0xbf6f3eca3ec7bf6f3f68bea7bee93f75,0x3f59bc49bf563f6abe1cbf403f76be95,0x3f08bf803f0d3ecfbf7d3f2a3e8cbf75,0xbf2f3f6e3bc9bf6f3f2d3ee1bf7f3e95,0x3f3a3ebebf803eb83f3dbf66bda33f75,0xbf15bf333f543ecfbf79bd7b3f7ebe95,0xbf503f373f10bf6abe733f80bdeebf75
.octa 0x3f69becabf6d3eb83f71bea7bf743e95,0xbed2bf6b3ec13f6fbeafbf723e9e3f75,0x3e663f803e4ebf6abf173f2a3f60be95,0x3f79bc49bf7bbecf3f4f3f40befabf75,0xbf80bebe3f343f6f3d30bf66bf433e95,0x3cfb3f6e3f36beb8bf80bee13f263f75,0x3e29bf37bf7bbecf3f053f803f1fbe95,0xbf7cbf333e423f6a3f5b3d7bbf49bf75
.octa 0x3f6f3f6b3ec7beb8bf68bf72bee93e95,0x3eb5becabf6cbf6fbed83ea73f643f75,0xbf083c493f0d3f6a3f7d3f403e8cbe95,0x3f593f803f563ecfbe1cbf2abf76bf75,0xbf3abf6ebf80bf6fbf3dbee1bda33e95,0xbf2fbebebbc93eb83f2d3f663f7f3f75,0x3f503f333f103ecf3e733d7bbdeebe95,0xbf15bf37bf54bf6abf79bf80bf7ebf75
.octa 0xbf0a3f06bf023efcbef43eecbee33edb,0xbf573f5abf5c3f5fbf613f63bf653f67,0xbebb3e233d62be893eefbf253f4bbf67,0xbf6e3f7dbf803f77bf633f44bf1c3edb,0xbe35be6d3f1abf5f3f7fbf743f41bedb,0xbf7c3f79bf4d3efcbdd5be9b3f28bf67,0x3c97bf163f72bf773f24bdb0beff3f67,0xbf803f4fbeaabe893f45bf7f3f5ebedb
.octa 0x3e5abf5a3f78befcbe923f63bf733edb,0xbf7a3f063e7fbf5f3f75beecbea43f67,0x3ecdbf7d3f2b3e89bf753f443e04bf67,0xbf6b3e233f3fbf773e983f25bf7e3edb,0x3f12bf793e103f5fbf47be9b3f7fbedb,0xbf52be6d3f7dbefcbf213f74bd8abf67,0x3f38bf4fbede3f773dbcbf7f3e863f67,0xbf32bf163f673e89bf7f3db03f77bedb
.octa 0x3f57bf06bf5c3efc3f61beecbf653edb,0xbf0abf5a3f023f5fbef4bf633ee33f67,0x3f6ebe23bf80be893f633f25bf1cbf67,0xbebbbf7dbd623f773eefbf44bf4b3edb,0x3f7c3e6dbf4dbf5f3dd53f743f28bedb,0xbe35bf79bf1a3efc3f7f3e9bbf41bf67,0x3f803f16beaabf77bf453db03f5e3f67,0x3c97bf4fbf72be893f243f7f3effbedb
.octa 0x3f7a3f5a3e7fbefcbf75bf63bea43edb,0x3e5abf06bf78bf5fbe923eec3f733f67,0x3f6b3f7d3f3f3e89be98bf44bf7ebf67,0x3ecdbe23bf2bbf77bf75bf25be043edb,0x3f523f793f7d3f5f3f213e9bbd8abedb,0x3f123e6dbe10befcbf47bf74bf7fbf67,0x3f323f4f3f673f773f7f3f7f3f773f67,0x3f383f163ede3e893dbcbdb0be86bedb
.octa 0x3f7d3f7e3f7f3f7f3f7f3f803f803f80,0xbe19be04bddbbdb0bd84bd30bcb08000,0x3d3c3e863eed3f253f4b3f683f7a3f80,0xbf80bf77bf63bf44bf1cbed8be5d8000,0xbf79bf4bbef6bdb03ea53f2d3f6a3f80,0xbe76bf1cbf61bf7fbf72bf3dbece8000,0xbed9bf5ebf7fbf44be843eaf3f523f80,0x3f683effbdb6bf25bf77bf71bf138000
.octa 0x3f4e3e04bf21bf7fbf40bd303f313f80,0x3f183f7e3f473db0bf29bf80bf398000,0x3f3d3f773e99bf25bf7ebed83f0a3f80,0xbf2d3e863f743f44be07bf68bf588000,0xbf043f1c3f763db0bf66bf3d3eba3f80,0xbf5bbf4b3e903f7f3ee2bf2dbf6f8000,0xbf71beff3f443f44bf00bf713e323f80,0x3eaebf5ebf243f253f5ebeafbf7c8000
.octa 0x3e19bf7ebddb3f7f3d84bf80bcb03f80,0x3f7d3e04bf7fbdb03f7f3d30bf808000,0x3f80be86bf633f253f1cbf68be5d3f80,0x3d3c3f77beedbf443f4b3ed8bf7a8000,0x3e763f4bbf61bdb03f72bf2dbece3f80,0xbf793f1c3ef6bf7f3ea53f3dbf6a8000,0xbf683f5ebdb6bf443f77beafbf133f80,0xbed9beff3f7fbf25be843f71bf528000
.octa 0xbf18be043f47bf7f3f293d30bf393f80,0x3f4ebf7e3f213db0bf403f80bf318000,0x3f2dbf773f74bf253e073ed8bf583f80,0x3f3dbe86be993f44bf7e3f68bf0a8000,0x3f5bbf1c3e903db0bee23f3dbf6f3f80,0xbf043f4bbf763f7fbf663f2dbeba8000,0xbeae3effbf243f44bf5e3f71bf7c3f80,0xbf713f5ebf443f25bf003eafbe328000
.octa 0x3f733f753f763f783f793f7a3f7b3f7c,0xbea2be98be8dbe82be70be5abe45be2f,0xbf7ebf7fbf74bf5dbf3cbf12bec2be2f,0x3e00bdbcbe9cbf01bf2ebf52bf6dbf7c,0x3f7f3f633f1f3e82be20bf0abf55bf7c,0x3d903eef3f483f783f7d3f573f0e3e2f,0xbf77bf24bda93f013f683f7c3f343e2f,0xbe87bf45bf7fbf5dbed73e353f363f7c
.octa 0x3f653e98bef8bf78bf5abe5a3f0f3f7c,0x3ee53f753f603e82bf06bf7abf54be2f,0xbf4a3dbc3f643f5d3d23bf52bf6cbe2f,0xbf1dbf7fbeea3f013f803f12bec5bf7c,0x3f28beefbf7ebe823f4f3f57be4bbf7c,0x3f413f63bde8bf78bf173f0a3f7b3e2f,0xbefe3f453f43bf01bf703e353f803e2f,0xbf5ebf243f253f5dbeb1bf7c3b493f7c
.octa 0x3ea2bf75be8d3f783e70bf7abe453f7c,0x3f733e98bf76be823f793e5abf7bbe2f,0xbe003f7fbe9cbf5d3f2e3f12bf6dbe2f,0xbf7e3dbc3f74bf01bf3c3f523ec2bf7c,0xbd90bf633f483e82bf7d3f0a3f0ebf7c,0x3f7fbeefbf1f3f78be20bf573f553e2f,0x3e873f24bf7f3f013ed7bf7c3f363e2f,0xbf773f453da9bf5d3f68be35bf343f7c
.octa 0xbee5be983f60bf783f063e5abf543f7c,0x3f65bf753ef83e82bf5a3f7abf0fbe2f,0x3f1dbdbcbeea3f5dbf803f52bec5be2f,0xbf4a3f7fbf643f013d23bf123f6cbf7c,0xbf413eefbde8be823f17bf573f7bbf7c,0x3f28bf633f7ebf783f4fbf0a3e4b3e2f,0x3f5ebf453f25bf013eb1be353b493e2f,0xbefe3f24bf433f5dbf703f7cbf803f7c
.octa 0x3f613f643f663f693f6b3f6d3f6f3f71,0xbef3bee9bedfbed5becbbec1beb7beac,0x3e963da3be0dbeb2bf0bbf36bf59bf71,0x3f753f7f3f7e3f703f573f343f083eac,0xbf7fbf74bf3fbed5bc7b3ec73f3a3f71,0x3dcfbe9ebf2abf69bf80bf6cbf30beac,0x3dc23f263f783f703f11bbc9bf14bf71,0xbf7fbf43be813eb23f533f803f513eac
.octa 0x3f753ee9bea8bf69bf6ebec13ed13f71,0x3e933f643f723ed5bebdbf6dbf6abeac,0xbef0bf7fbf1a3eb23f7a3f34be63bf71,0x3f623da3bf4cbf70be573f363f7a3eac,0xbf463e9e3f803ed5bf32bf6c3ce23f71,0xbf22bf74bd6f3f693f38bec7bf80beac,0x3f453f43bf02bf703e383f803e2cbf71,0xbf233f263f5dbeb2bf7c3bc93f7c3eac
.octa 0x3ef3bf64bedf3f693ecbbf6dbeb73f71,0x3f613ee9bf66bed53f6b3ec1bf6fbeac,0xbf75bda33f7ebeb2bf573f363f08bf71,0x3e96bf7f3e0d3f70bf0bbf343f593eac,0xbdcf3f74bf2abed53f80bec7bf303f71,0xbf7f3e9e3f3fbf69bc7b3f6cbf3abeac,0x3f7fbf26be813f70bf533bc93f51bf71,0x3dc23f43bf783eb23f11bf803f143eac
.octa 0xbe93bee93f72bf693ebd3ec1bf6a3f71,0x3f75bf643ea83ed5bf6e3f6dbed1beac,0xbf623f7fbf4c3eb23e57bf343f7abf71,0xbef0bda33f1abf703f7abf363e633eac,0x3f22be9ebd6f3ed5bf383f6cbf803f71,0xbf463f74bf803f69bf323ec7bce2beac,0x3f23bf433f5dbf703f7cbf803f7cbf71,0x3f45bf263f02beb23e38bbc9be2c3eac
.octa 0x3f493f4d3f503f533f563f593f5c3f5f,0xbf1ebf1abf15bf11bf0cbf08bf03befc,0x3f643f783f803f7c3f6c3f503f2b3efc,0xbee8be7fbd0a3e3b3ec83f153f3e3f5f,0x3f773f7d3f5a3f113e3fbe66bf19bf5f,0xbe8a3e103f073f533f7c3f793f4d3efc,0x3f7f3f5c3ed4be3bbf37bf7cbf67befc,0xbd9d3f023f693f7c3f333e29bedcbf5f
.octa 0x3f7e3f1abe26bf53bf7bbf083e7c3f5f,0x3df43f4d3f7d3f11be51bf59bf78befc,0x3f733e7fbf2fbf7cbec03f153f803efc,0x3e9f3f783f3bbe3bbf6dbf503d563f5f,0x3f5fbe10bf79bf113f103f793e13bf5f,0x3efb3f7d3e6abf53bf543e663f7d3efc,0x3f42bf02bf703e3b3f803e29bf71befc,0x3f273f5cbeb4bf7c3c173f7c3eabbf5f
.octa 0x3f1ebf4dbf153f533f0cbf59bf033f5f,0x3f493f1abf50bf113f563f08bf5cbefc,0x3ee8bf78bd0a3f7cbec8bf503f3e3efc,0x3f643e7fbf803e3b3f6cbf15bf2b3f5f,0x3e8abf7d3f073f11bf7c3e663f4dbf5f,0x3f77be10bf5a3f533e3fbf793f193efc,0x3d9dbf5c3f69be3bbf333f7cbedcbefc,0x3f7fbf02bed43f7cbf37be293f67bf5f
.octa 0xbdf4bf1a3f7dbf533e513f08bf783f5f,0x3f7ebf4d3e263f11bf7b3f59be7cbefc,0xbe9fbe7f3f3bbf7c3f6dbf153d563efc,0x3f73bf783f2fbe3bbec03f50bf803f5f,0xbefb3e103e6abf113f54bf793f7dbf5f,0x3f5fbf7d3f79bf533f10be66be133efc,0xbf273f02beb43e3bbc17be293eabbefc,0x3f42bf5c3f70bf7c3f80bf7c3f71bf5f
.octa 0x3e193e043ddb3db03d843d303cb00000,0x3f7d3f7e3f7f3f7f3f7f3f803f803f80,0x3f803f773f633f443f1c3ed83e5d0000,0x3d3c3e863eed3f253f4b3f683f7a3f80,0x3e763f1c3f613f7f3f723f3d3ece0000,0xbf79bf4bbef6bdb03ea53f2d3f6a3f80,0xbf68beff3db63f253f773f713f130000,0xbed9bf5ebf7fbf44be843eaf3f523f80
.octa 0xbf18bf7ebf47bdb03f293f803f390000,0x3f4e3e04bf21bf7fbf40bd303f313f80,0x3f2dbe86bf74bf443e073f683f580000,0x3f3d3f773e99bf25bf7ebed83f0a3f80,0x3f5b3f4bbe90bf7fbee23f2d3f6f0000,0xbf043f1c3f763db0bf66bf3d3eba3f80,0xbeae3f5e3f24bf25bf5e3eaf3f7c0000,0xbf71beff3f443f44bf00bf713e323f80
.octa 0xbf7dbe043f7f3db0bf7fbd303f800000,0x3e19bf7ebddb3f7f3d84bf80bcb03f80,0xbd3cbf773eed3f44bf4bbed83f7a0000,0x3f80be86bf633f253f1cbf68be5d3f80,0x3f79bf1cbef63f7fbea5bf3d3f6a0000,0x3e763f4bbf61bdb03f72bf2dbece3f80,0x3ed93effbf7f3f253e84bf713f520000,0xbf683f5ebdb6bf443f77beafbf133f80
.octa 0xbf4e3f7ebf21bdb03f40bf803f310000,0xbf18be043f47bf7f3f293d30bf393f80,0xbf3d3e863e99bf443f7ebf683f0a0000,0x3f2dbf773f74bf253e073ed8bf583f80,0x3f04bf4b3f76bf7f3f66bf2d3eba0000,0x3f5bbf1c3e903db0bee23f3dbf6f3f80,0x3f71bf5e3f44bf253f00beaf3e320000,0xbeae3effbf243f44bf5e3f71bf7c3f80
.octa 0x3ea23e983e8d3e823e703e5a3e453e2f,0x3f733f753f763f783f793f7a3f7b3f7c,0xbe003dbc3e9c3f013f2e3f523f6d3f7c,0xbf7ebf7fbf74bf5dbf3cbf12bec2be2f,0xbd90beefbf48bf78bf7dbf57bf0ebe2f,0x3f7f3f633f1f3e82be20bf0abf55bf7c,0x3e873f453f7f3f5d3ed7be35bf36bf7c,0xbf77bf24bda93f013f683f7c3f343e2f
.octa 0xbee5bf75bf60be823f063f7a3f543e2f,0x3f653e98bef8bf78bf5abe5a3f0f3f7c,0x3f1d3f7f3eeabf01bf80bf123ec53f7c,0xbf4a3dbc3f643f5d3d23bf52bf6cbe2f,0xbf41bf633de83f783f17bf0abf7bbe2f,0x3f28beefbf7ebe823f4f3f57be4bbf7c,0x3f5e3f24bf25bf5d3eb13f7cbb49bf7c,0xbefe3f453f43bf01bf703e353f803e2f
.octa 0xbf73be983f763e82bf79be5a3f7b3e2f,0x3ea2bf75be8d3f783e70bf7abe453f7c,0x3f7ebdbcbf743f013f3cbf52bec23f7c,0xbe003f7fbe9cbf5d3f2e3f12bf6dbe2f,0xbf7f3eef3f1fbf783e203f57bf55be2f,0xbd90bf633f483e82bf7d3f0a3f0ebf7c,0x3f77bf45bda93f5dbf683e353f34bf7c,0x3e873f24bf7f3f013ed7bf7c3f363e2f
.octa 0xbf653f75bef8be823f5abf7a3f0f3e2f,0xbee5be983f60bf783f063e5abf543f7c,0x3f4abf7f3f64bf01bd233f12bf6c3f7c,0x3f1dbdbcbeea3f5dbf803f52bec5be2f,0xbf283f63bf7e3f78bf4f3f0abe4bbe2f,0xbf413eefbde8be823f17bf573f7bbf7c,0x3efebf243f43bf5d3f70bf7c3f80bf7c,0x3f5ebf453f25bf013eb1be353b493e2f
.octa 0x3ef33ee93edf3ed53ecb3ec13eb73eac,0x3f613f643f663f693f6b3f6d3f6f3f71,0xbf75bf7fbf7ebf70bf57bf34bf08beac,0x3e963da3be0dbeb2bf0bbf36bf59bf71,0xbdcf3e9e3f2a3f693f803f6c3f303eac,0xbf7fbf74bf3fbed5bc7b3ec73f3a3f71,0x3f7f3f433e81beb2bf53bf80bf51beac,0x3dc23f263f783f703f11bbc9bf14bf71
.octa 0xbe93bf64bf72bed53ebd3f6d3f6a3eac,0x3f753ee9bea8bf69bf6ebec13ed13f71,0xbf62bda33f4c3f703e57bf36bf7abeac,0xbef0bf7fbf1a3eb23f7a3f34be63bf71,0x3f223f743d6fbf69bf383ec73f803eac,0xbf463e9e3f803ed5bf32bf6c3ce23f71,0x3f23bf26bf5d3eb23f7cbbc9bf7cbeac,0x3f453f43bf02bf703e383f803e2cbf71
.octa 0xbf61bee93f663ed5bf6bbec13f6f3eac,0x3ef3bf64bedf3f693ecbbf6dbeb73f71,0xbe963f7fbe0dbf703f0b3f34bf59beac,0xbf75bda33f7ebeb2bf573f363f08bf71,0x3f7fbe9ebf3f3f693c7bbf6c3f3a3eac,0xbdcf3f74bf2abed53f80bec7bf303f71,0xbdc2bf433f78beb2bf113f80bf14beac,0x3f7fbf26be813f70bf533bc93f51bf71
.octa 0xbf753f64bea8bed53f6ebf6d3ed13eac,0xbe93bee93f72bf693ebd3ec1bf6a3f71,0x3ef03da3bf1a3f70bf7a3f36be63beac,0xbf623f7fbf4c3eb23e57bf343f7abf71,0x3f46bf743f80bf693f32bec73ce23eac,0x3f22be9ebd6f3ed5bf383f6cbf803f71,0xbf453f26bf023eb2be383bc93e2cbeac,0x3f23bf433f5dbf703f7cbf803f7cbf71
.octa 0x3f1e3f1a3f153f113f0c3f083f033efc,0x3f493f4d3f503f533f563f593f5c3f5f,0x3ee83e7f3d0abe3bbec8bf15bf3ebf5f,0x3f643f783f803f7c3f6c3f503f2b3efc,0x3e8abe10bf07bf53bf7cbf79bf4dbefc,0x3f773f7d3f5a3f113e3fbe66bf19bf5f,0x3d9dbf02bf69bf7cbf33be293edc3f5f,0x3f7f3f5c3ed4be3bbf37bf7cbf67befc
.octa 0xbdf4bf4dbf7dbf113e513f593f783efc,0x3f7e3f1abe26bf53bf7bbf083e7c3f5f,0xbe9fbf78bf3b3e3b3f6d3f50bd56bf5f,0x3f733e7fbf2fbf7cbec03f153f803efc,0xbefbbf7dbe6a3f533f54be66bf7dbefc,0x3f5fbe10bf79bf113f103f793e13bf5f,0xbf27bf5c3eb43f7cbc17bf7cbeab3f5f,0x3f42bf02bf703e3b3f803e29bf71befc
.octa 0xbf49bf1a3f503f11bf56bf083f5c3efc,0x3f1ebf4dbf153f533f0cbf59bf033f5f,0xbf64be7f3f80be3bbf6c3f153f2bbf5f,0x3ee8bf78bd0a3f7cbec8bf503f3e3efc,0xbf773e103f5abf53be3f3f79bf19befc,0x3e8abf7d3f073f11bf7c3e663f4dbf5f,0xbf7f3f023ed4bf7c3f373e29bf673f5f,0x3d9dbf5c3f69be3bbf333f7cbedcbefc
.octa 0xbf7e3f4dbe26bf113f7bbf593e7c3efc,0xbdf4bf1a3f7dbf533e513f08bf783f5f,0xbf733f78bf2f3e3b3ec0bf503f80bf5f,0xbe9fbe7f3f3bbf7c3f6dbf153d563efc,0xbf5f3f7dbf793f53bf103e663e13befc,0xbefb3e103e6abf113f54bf793f7dbf5f,0xbf423f5cbf703f7cbf803f7cbf713f5f,0xbf273f02beb43e3bbc17be293eabbefc
.octa 0xbf7d3f7ebf7f3f7fbf7f3f80bf803f80,0x3e19be043ddbbdb03d84bd303cb08000,0xbd3c3e86beed3f25bf4b3f68bf7a3f80,0x3f80bf773f63bf443f1cbed83e5d8000,0x3f79bf4b3ef6bdb0bea53f2dbf6a3f80,0x3e76bf1c3f61bf7f3f72bf3d3ece8000,0x3ed9bf5e3f7fbf443e843eafbf523f80,0xbf683eff3db6bf253f77bf713f138000
.octa 0xbf4e3e043f21bf7f3f40bd30bf313f80,0xbf183f7ebf473db03f29bf803f398000,0xbf3d3f77be99bf253f7ebed8bf0a3f80,0x3f2d3e86bf743f443e07bf683f588000,0x3f043f1cbf763db03f66bf3dbeba3f80,0x3f5bbf4bbe903f7fbee2bf2d3f6f8000,0x3f71beffbf443f443f00bf71be323f80,0xbeaebf5e3f243f25bf5ebeaf3f7c8000
.octa 0xbe19bf7e3ddb3f7fbd84bf803cb03f80,0xbf7d3e043f7fbdb0bf7f3d303f808000,0xbf80be863f633f25bf1cbf683e5d3f80,0xbd3c3f773eedbf44bf4b3ed83f7a8000,0xbe763f4b3f61bdb0bf72bf2d3ece3f80,0x3f793f1cbef6bf7fbea53f3d3f6a8000,0x3f683f5e3db6bf44bf77beaf3f133f80,0x3ed9beffbf7fbf253e843f713f528000
.octa 0x3f18be04bf47bf7fbf293d303f393f80,0xbf4ebf7ebf213db03f403f803f318000,0xbf2dbf77bf74bf25be073ed83f583f80,0xbf3dbe863e993f443f7e3f683f0a8000,0xbf5bbf1cbe903db03ee23f3d3f6f3f80,0x3f043f4b3f763f7f3f663f2d3eba8000,0x3eae3eff3f243f443f5e3f713f7c3f80,0x3f713f5e3f443f253f003eaf3e328000
.octa 0xbf733f75bf763f78bf793f7abf7b3f7c,0x3ea2be983e8dbe823e70be5a3e45be2f,0x3f7ebf7f3f74bf5d3f3cbf123ec2be2f,0xbe00bdbc3e9cbf013f2ebf523f6dbf7c,0xbf7f3f63bf1f3e823e20bf0a3f55bf7c,0xbd903eefbf483f78bf7d3f57bf0e3e2f,0x3f77bf243da93f01bf683f7cbf343e2f,0x3e87bf453f7fbf5d3ed73e35bf363f7c
.octa 0xbf653e983ef8bf783f5abe5abf0f3f7c,0xbee53f75bf603e823f06bf7a3f54be2f,0x3f4a3dbcbf643f5dbd23bf523f6cbe2f,0x3f1dbf7f3eea3f01bf803f123ec5bf7c,0xbf28beef3f7ebe82bf4f3f573e4bbf7c,0xbf413f633de8bf783f173f0abf7b3e2f,0x3efe3f45bf43bf013f703e35bf803e2f,0x3f5ebf24bf253f5d3eb1bf7cbb493f7c
.octa 0xbea2bf753e8d3f78be70bf7a3e453f7c,0xbf733e983f76be82bf793e5a3f7bbe2f,0x3e003f7f3e9cbf5dbf2e3f123f6dbe2f,0x3f7e3dbcbf74bf013f3c3f52bec2bf7c,0x3d90bf63bf483e823f7d3f0abf0ebf7c,0xbf7fbeef3f1f3f783e20bf57bf553e2f,0xbe873f243f7f3f01bed7bf7cbf363e2f,0x3f773f45bda9bf5dbf68be353f343f7c
.octa 0x3ee5be98bf60bf78bf063e5a3f543f7c,0xbf65bf75bef83e823f5a3f7a3f0fbe2f,0xbf1dbdbc3eea3f5d3f803f523ec5be2f,0x3f4a3f7f3f643f01bd23bf12bf6cbf7c,0x3f413eef3de8be82bf17bf57bf7bbf7c,0xbf28bf63bf7ebf78bf4fbf0abe4b3e2f,0xbf5ebf45bf25bf01beb1be35bb493e2f,0x3efe3f243f433f5d3f703f7c3f803f7c
.octa 0xbf613f64bf663f69bf6b3f6dbf6f3f71,0x3ef3bee93edfbed53ecbbec13eb7beac,0xbe963da33e0dbeb23f0bbf363f59bf71,0xbf753f7fbf7e3f70bf573f34bf083eac,0x3f7fbf743f3fbed53c7b3ec7bf3a3f71,0xbdcfbe9e3f2abf693f80bf6c3f30beac,0xbdc23f26bf783f70bf11bbc93f14bf71,0x3f7fbf433e813eb2bf533f80bf513eac
.octa 0xbf753ee93ea8bf693f6ebec1bed13f71,0xbe933f64bf723ed53ebdbf6d3f6abeac,0x3ef0bf7f3f1a3eb2bf7a3f343e63bf71,0xbf623da33f4cbf703e573f36bf7a3eac,0x3f463e9ebf803ed53f32bf6cbce23f71,0x3f22bf743d6f3f69bf38bec73f80beac,0xbf453f433f02bf70be383f80be2cbf71,0x3f233f26bf5dbeb23f7c3bc9bf7c3eac
.octa 0xbef3bf643edf3f69becbbf6d3eb73f71,0xbf613ee93f66bed5bf6b3ec13f6fbeac,0x3f75bda3bf7ebeb23f573f36bf08bf71,0xbe96bf7fbe0d3f703f0bbf34bf593eac,0x3dcf3f743f2abed5bf80bec73f303f71,0x3f7f3e9ebf3fbf693c7b3f6c3f3abeac,0xbf7fbf263e813f703f533bc9bf51bf71,0xbdc23f433f783eb2bf11bf80bf143eac
.octa 0x3e93bee9bf72bf69bebd3ec13f6a3f71,0xbf75bf64bea83ed53f6e3f6d3ed1beac,0x3f623f7f3f4c3eb2be57bf34bf7abf71,0x3ef0bda3bf1abf70bf7abf36be633eac,0xbf22be9e3d6f3ed53f383f6c3f803f71,0x3f463f743f803f693f323ec73ce2beac,0xbf23bf43bf5dbf70bf7cbf80bf7cbf71,0xbf45bf26bf02beb2be38bbc93e2c3eac
.octa 0xbf493f4dbf503f53bf563f59bf5c3f5f,0x3f1ebf1a3f15bf113f0cbf083f03befc,0xbf643f78bf803f7cbf6c3f50bf2b3efc,0x3ee8be7f3d0a3e3bbec83f15bf3e3f5f,0xbf773f7dbf5a3f11be3fbe663f19bf5f,0x3e8a3e10bf073f53bf7c3f79bf4d3efc,0xbf7f3f5cbed4be3b3f37bf7c3f67befc,0x3d9d3f02bf693f7cbf333e293edcbf5f
.octa 0xbf7e3f1a3e26bf533f7bbf08be7c3f5f,0xbdf43f4dbf7d3f113e51bf593f78befc,0xbf733e7f3f2fbf7c3ec03f15bf803efc,0xbe9f3f78bf3bbe3b3f6dbf50bd563f5f,0xbf5fbe103f79bf11bf103f79be13bf5f,0xbefb3f7dbe6abf533f543e66bf7d3efc,0xbf42bf023f703e3bbf803e293f71befc,0xbf273f5c3eb4bf7cbc173f7cbeabbf5f
.octa 0xbf1ebf4d3f153f53bf0cbf593f033f5f,0xbf493f1a3f50bf11bf563f083f5cbefc,0xbee8bf783d0a3f7c3ec8bf50bf3e3efc,0xbf643e7f3f803e3bbf6cbf153f2b3f5f,0xbe8abf7dbf073f113f7c3e66bf4dbf5f,0xbf77be103f5a3f53be3fbf79bf193efc,0xbd9dbf5cbf69be3b3f333f7c3edcbefc,0xbf7fbf023ed43f7c3f37be29bf67bf5f
.octa 0x3df4bf1abf7dbf53be513f083f783f5f,0xbf7ebf4dbe263f113f7b3f593e7cbefc,0x3e9fbe7fbf3bbf7cbf6dbf15bd563efc,0xbf73bf78bf2fbe3b3ec03f503f803f5f,0x3efb3e10be6abf11bf54bf79bf7dbf5f,0xbf5fbf7dbf79bf53bf10be663e133efc,0x3f273f023eb43e3b3c17be29beabbefc,0xbf42bf5cbf70bf7cbf80bf7cbf71bf5f
.octa 0xbe193e04bddb3db0bd843d30bcb00000,0xbf7d3f7ebf7f3f7fbf7f3f80bf803f80,0xbf803f77bf633f44bf1c3ed8be5d0000,0xbd3c3e86beed3f25bf4b3f68bf7a3f80,0xbe763f1cbf613f7fbf723f3dbece0000,0x3f79bf4b3ef6bdb0bea53f2dbf6a3f80,0x3f68beffbdb63f25bf773f71bf130000,0x3ed9bf5e3f7fbf443e843eafbf523f80
.octa 0x3f18bf7e3f47bdb0bf293f80bf390000,0xbf4e3e043f21bf7f3f40bd30bf313f80,0xbf2dbe863f74bf44be073f68bf580000,0xbf3d3f77be99bf253f7ebed8bf0a3f80,0xbf5b3f4b3e90bf7f3ee23f2dbf6f0000,0x3f043f1cbf763db03f66bf3dbeba3f80,0x3eae3f5ebf24bf253f5e3eafbf7c0000,0x3f71beffbf443f443f00bf71be323f80
.octa 0x3f7dbe04bf7f3db03f7fbd30bf800000,0xbe19bf7e3ddb3f7fbd84bf803cb03f80,0x3d3cbf77beed3f443f4bbed8bf7a0000,0xbf80be863f633f25bf1cbf683e5d3f80,0xbf79bf1c3ef63f7f3ea5bf3dbf6a0000,0xbe763f4b3f61bdb0bf72bf2d3ece3f80,0xbed93eff3f7f3f25be84bf71bf520000,0x3f683f5e3db6bf44bf77beaf3f133f80
.octa 0x3f4e3f7e3f21bdb0bf40bf80bf310000,0x3f18be04bf47bf7fbf293d303f393f80,0x3f3d3e86be99bf44bf7ebf68bf0a0000,0xbf2dbf77bf74bf25be073ed83f583f80,0xbf04bf4bbf76bf7fbf66bf2dbeba0000,0xbf5bbf1cbe903db03ee23f3d3f6f3f80,0xbf71bf5ebf44bf25bf00beafbe320000,0x3eae3eff3f243f443f5e3f713f7c3f80
.octa 0xbea23e98be8d3e82be703e5abe453e2f,0xbf733f75bf763f78bf793f7abf7b3f7c,0x3e003dbcbe9c3f01bf2e3f52bf6d3f7c,0x3f7ebf7f3f74bf5d3f3cbf123ec2be2f,0x3d90beef3f48bf783f7dbf573f0ebe2f,0xbf7f3f63bf1f3e823e20bf0a3f55bf7c,0xbe873f45bf7f3f5dbed7be353f36bf7c,0x3f77bf243da93f01bf683f7cbf343e2f
.octa 0x3ee5bf753f60be82bf063f7abf543e2f,0xbf653e983ef8bf783f5abe5abf0f3f7c,0xbf1d3f7fbeeabf013f80bf12bec53f7c,0x3f4a3dbcbf643f5dbd23bf523f6cbe2f,0x3f41bf63bde83f78bf17bf0a3f7bbe2f,0xbf28beef3f7ebe82bf4f3f573e4bbf7c,0xbf5e3f243f25bf5dbeb13f7c3b49bf7c,0x3efe3f45bf43bf013f703e35bf803e2f
.octa 0x3f73be98bf763e823f79be5abf7b3e2f,0xbea2bf753e8d3f78be70bf7a3e453f7c,0xbf7ebdbc3f743f01bf3cbf523ec23f7c,0x3e003f7f3e9cbf5dbf2e3f123f6dbe2f,0x3f7f3eefbf1fbf78be203f573f55be2f,0x3d90bf63bf483e823f7d3f0abf0ebf7c,0xbf77bf453da93f5d3f683e35bf34bf7c,0xbe873f243f7f3f01bed7bf7cbf363e2f
.octa 0x3f653f753ef8be82bf5abf7abf0f3e2f,0x3ee5be98bf60bf78bf063e5a3f543f7c,0xbf4abf7fbf64bf013d233f123f6c3f7c,0xbf1dbdbc3eea3f5d3f803f523ec5be2f,0x3f283f633f7e3f783f4f3f0a3e4bbe2f,0x3f413eef3de8be82bf17bf57bf7bbf7c,0xbefebf24bf43bf5dbf70bf7cbf80bf7c,0xbf5ebf45bf25bf01beb1be35bb493e2f
.octa 0xbef33ee9bedf3ed5becb3ec1beb73eac,0xbf613f64bf663f69bf6b3f6dbf6f3f71,0x3f75bf7f3f7ebf703f57bf343f08beac,0xbe963da33e0dbeb23f0bbf363f59bf71,0x3dcf3e9ebf2a3f69bf803f6cbf303eac,0x3f7fbf743f3fbed53c7b3ec7bf3a3f71,0xbf7f3f43be81beb23f53bf803f51beac,0xbdc23f26bf783f70bf11bbc93f14bf71
.octa 0x3e93bf643f72bed5bebd3f6dbf6a3eac,0xbf753ee93ea8bf693f6ebec1bed13f71,0x3f62bda3bf4c3f70be57bf363f7abeac,0x3ef0bf7f3f1a3eb2bf7a3f343e63bf71,0xbf223f74bd6fbf693f383ec7bf803eac,0x3f463e9ebf803ed53f32bf6cbce23f71,0xbf23bf263f5d3eb2bf7cbbc93f7cbeac,0xbf453f433f02bf70be383f80be2cbf71
.octa 0x3f61bee9bf663ed53f6bbec1bf6f3eac,0xbef3bf643edf3f69becbbf6d3eb73f71,0x3e963f7f3e0dbf70bf0b3f343f59beac,0x3f75bda3bf7ebeb23f573f36bf08bf71,0xbf7fbe9e3f3f3f69bc7bbf6cbf3a3eac,0x3dcf3f743f2abed5bf80bec73f303f71,0x3dc2bf43bf78beb23f113f803f14beac,0xbf7fbf263e813f703f533bc9bf51bf71
.octa 0x3f753f643ea8bed5bf6ebf6dbed13eac,0x3e93bee9bf72bf69bebd3ec13f6a3f71,0xbef03da33f1a3f703f7a3f363e63beac,0x3f623f7f3f4c3eb2be57bf34bf7abf71,0xbf46bf74bf80bf69bf32bec7bce23eac,0xbf22be9e3d6f3ed53f383f6c3f803f71,0x3f453f263f023eb23e383bc9be2cbeac,0xbf23bf43bf5dbf70bf7cbf80bf7cbf71
.octa 0xbf1e3f1abf153f11bf0c3f08bf033efc,0xbf493f4dbf503f53bf563f59bf5c3f5f,0xbee83e7fbd0abe3b3ec8bf153f3ebf5f,0xbf643f78bf803f7cbf6c3f50bf2b3efc,0xbe8abe103f07bf533f7cbf793f4dbefc,0xbf773f7dbf5a3f11be3fbe663f19bf5f,0xbd9dbf023f69bf7c3f33be29bedc3f5f,0xbf7f3f5cbed4be3b3f37bf7c3f67befc
.octa 0x3df4bf4d3f7dbf11be513f59bf783efc,0xbf7e3f1a3e26bf533f7bbf08be7c3f5f,0x3e9fbf783f3b3e3bbf6d3f503d56bf5f,0xbf733e7f3f2fbf7c3ec03f15bf803efc,0x3efbbf7d3e6a3f53bf54be663f7dbefc,0xbf5fbe103f79bf11bf103f79be13bf5f,0x3f27bf5cbeb43f7c3c17bf7c3eab3f5f,0xbf42bf023f703e3bbf803e293f71befc
.octa 0x3f49bf1abf503f113f56bf08bf5c3efc,0xbf1ebf4d3f153f53bf0cbf593f033f5f,0x3f64be7fbf80be3b3f6c3f15bf2bbf5f,0xbee8bf783d0a3f7c3ec8bf50bf3e3efc,0x3f773e10bf5abf533e3f3f793f19befc,0xbe8abf7dbf073f113f7c3e66bf4dbf5f,0x3f7f3f02bed4bf7cbf373e293f673f5f,0xbd9dbf5cbf69be3b3f333f7c3edcbefc
.octa 0x3f7e3f4d3e26bf11bf7bbf59be7c3efc,0x3df4bf1abf7dbf53be513f083f783f5f,0x3f733f783f2f3e3bbec0bf50bf80bf5f,0x3e9fbe7fbf3bbf7cbf6dbf15bd563efc,0x3f5f3f7d3f793f533f103e66be13befc,0x3efb3e10be6abf11bf54bf79bf7dbf5f,0x3f423f5c3f703f7c3f803f7c3f713f5f,0x3f273f023eb43e3b3c17be29beabbefc
.octa 0x3f7c3f7d3f7e3f7f3f7f3f803f803f80,0xbe2fbe16bdfbbdc9bd97bd49bcc98000,0x3cc93e793ee63f223f4a3f673f7a3f80,0xbf80bf78bf65bf46bf1dbedbbe608000,0xbf7abf4ebefcbdc93ea13f2c3f6a3f80,0xbe60bf18bf5fbf7fbf73bf3ebecf8000,0xbecfbf5cbf7fbf46be893eac3f513f80,0x3f6a3f04bd97bf22bf77bf71bf138000
.octa 0x3f513e16bf1dbf7fbf42bd493f313f80,0x3f133f7d3f4a3dc9bf27bf80bf398000,0x3f393f783ea1bf22bf7ebedb3f093f80,0xbf313e793f733f46bdfbbf67bf588000,0xbf093f183f773dc9bf65bf3e3eb83f80,0xbf58bf4e3e893f7f3ee6bf2cbf6f8000,0xbf6fbf043f423f46befcbf713e2f3f80,0x3eb8bf5cbf273f223f5fbeacbf7c8000
.octa 0x3e2fbf7dbdfb3f7f3d97bf80bcc93f80,0x3f7c3e16bf7ebdc93f7f3d49bf808000,0x3f80be79bf653f223f1dbf67be603f80,0x3cc93f78bee6bf463f4a3edbbf7a8000,0x3e603f4ebf5fbdc93f73bf2cbecf3f80,0xbf7a3f183efcbf7f3ea13f3ebf6a8000,0xbf6a3f5cbd97bf463f77beacbf133f80,0xbecfbf043f7fbf22be893f71bf518000
.octa 0xbf13be163f4abf7f3f273d49bf393f80,0x3f51bf7d3f1d3dc9bf423f80bf318000,0x3f31bf783f73bf223dfb3edbbf583f80,0x3f39be79bea13f46bf7e3f67bf098000,0x3f58bf183e893dc9bee63f3ebf6f3f80,0xbf093f4ebf773f7fbf653f2cbeb88000,0xbeb83f04bf273f46bf5f3f71bf7c3f80,0xbf6f3f5cbf423f22befc3eacbe2f8000
.octa 0x3f6f3f713f733f753f773f783f7a3f7b,0xbeb8beacbea1be95be89be79be60be48,0xbf7cbf80bf77bf62bf42bf18becfbe48,0x3e2fbd49be89bef1bf27bf4ebf6abf7b,0x3f803f673f273e95bdfbbf04bf51bf7b,0x3cc93edb3f423f753f7e3f5c3f133e48,0xbf7abf2cbdfb3ef13f653f7d3f393e48,0xbe60bf3ebf7ebf62bee63e163f313f7b
.octa 0x3f6a3eacbee6bf75bf5fbe793f093f7b,0x3ecf3f713f653e95befcbf78bf58be48,0xbf513d493f5f3f623d97bf4ebf6fbe48,0xbf13bf80befc3ef13f7f3f18beb8bf7b,0x3f31bedbbf7fbe953f4a3f5cbe2fbf7b,0x3f393f67bd97bf75bf1d3f043f7c3e48,0xbf093f3e3f4abef1bf733e163f803e48,0xbf58bf2c3f1d3f62bea1bf7dbcc93f7b
.octa 0x3eb8bf71bea13f753e89bf78be603f7b,0x3f6f3eacbf73be953f773e79bf7abe48,0xbe2f3f80be89bf623f273f18bf6abe48,0xbf7c3d493f77bef1bf423f4e3ecfbf7b,0xbcc9bf673f423e95bf7e3f043f13bf7b,0x3f80bedbbf273f75bdfbbf5c3f513e48,0x3e603f2cbf7e3ef13ee6bf7d3f313e48,0xbf7a3f3e3dfbbf623f65be16bf393f7b
.octa 0xbecfbeac3f65bf753efc3e79bf583f7b,0x3f6abf713ee63e95bf5f3f78bf09be48,0x3f13bd49befc3f62bf7f3f4ebeb8be48,0xbf513f80bf5f3ef13d97bf183f6fbf7b,0xbf393edbbd97be953f1dbf5c3f7cbf7b,0x3f31bf673f7fbf753f4abf043e2f3e48,0x3f58bf3e3f1dbef13ea1be16bcc93e48,0xbf093f2cbf4a3f62bf733f7dbf803f7b
.octa 0x3f583f5c3f5f3f623f653f673f6a3f6d,0xbf09bf04befcbef1bee6bedbbecfbec4,0x3eb83e16bd97be95befcbf2cbf51bf6d,0x3f6f3f7d3f7f3f753f5f3f3e3f133ec4,0xbf7cbf78bf4abef1bd973eac3f313f6d,0x3e2fbe79bf1dbf62bf7fbf71bf39bec4,0x3cc93f183f733f753f1d3d49bf09bf6d,0xbf80bf4ebea13e953f4a3f803f583ec4
.octa 0x3f7a3f04be89bf62bf73bedb3eb83f6d,0x3e603f5c3f773ef1bea1bf67bf6fbec4,0xbecfbf7dbf273e953f773f3ebe2fbf6d,0x3f6a3e16bf42bf75be893f2c3f7c3ec4,0xbf513e793f7e3ef1bf27bf71bcc93f6d,0xbf13bf78bdfb3f623f42beacbf80bec4,0x3f393f4ebee6bf753dfb3f803e60bf6d,0xbf313f183f65be95bf7ebd493f7a3ec4
.octa 0x3f09bf5cbefc3f623ee6bf67becf3f6d,0x3f583f04bf5fbef13f653edbbf6abec4,0xbf6fbe163f7fbe95bf5f3f2c3f13bf6d,0x3eb8bf7d3d973f75befcbf3e3f513ec4,0xbe2f3f78bf1dbef13f7fbeacbf393f6d,0xbf7c3e793f4abf62bd973f71bf31bec4,0x3f80bf18bea13f75bf4abd493f58bf6d,0x3cc93f4ebf733e953f1dbf803f093ec4
.octa 0xbe60bf043f77bf623ea13edbbf6f3f6d,0x3f7abf5c3e893ef1bf733f67beb8bec4,0xbf6a3f7dbf423e953e89bf3e3f7cbf6d,0xbecfbe163f27bf753f77bf2c3e2f3ec4,0x3f13be79bdfb3ef1bf423f71bf803f6d,0xbf513f78bf7e3f62bf273eac3cc9bec4,0x3f31bf4e3f65bf753f7ebf803f7abf6d,0x3f39bf183ee6be953dfb3d49be603ec4
.octa 0x3f393f3e3f423f463f4a3f4e3f513f55,0xbf31bf2cbf27bf22bf1dbf18bf13bf0e,0x3f583f713f7e3f7f3f733f5c3f393f0e,0xbf09beacbdfb3dc93ea13f043f313f55,0x3f6f3f803f653f223e89be16bf09bf55,0xbeb83d493ee63f463f773f7d3f583f0e,0x3f7c3f673efcbdc9bf27bf78bf6fbf0e,0xbe2f3edb3f5f3f7f3f423e79beb8bf55
.octa 0x3f803f2cbd97bf46bf7ebf183e2f3f55,0x3cc93f3e3f7f3f22bdfbbf4ebf7cbf0e,0x3f7a3eacbf1dbf7fbee63f043f803f0e,0x3e603f713f4abdc9bf65bf5cbcc93f55,0x3f6abd49bf73bf223efc3f7d3e60bf55,0x3ecf3f803ea1bf46bf5f3e163f7a3f0e,0x3f51bedbbf773dc93f7f3e79bf6abf0e,0x3f133f67be89bf7fbd973f783ecfbf55
.octa 0x3f31bf3ebf273f463f1dbf4ebf133f55,0x3f393f2cbf42bf223f4a3f18bf51bf0e,0x3f09bf71bdfb3f7fbea1bf5c3f313f0e,0x3f583eacbf7e3dc93f73bf04bf393f55,0x3eb8bf803ee63f22bf773e163f58bf55,0x3f6fbd49bf653f463e89bf7d3f093f0e,0x3e2fbf673f5fbdc9bf423f78beb8bf0e,0x3f7cbedbbefc3f7fbf27be793f6fbf55
.octa 0xbcc9bf2c3f7fbf463dfb3f18bf7c3f55,0x3f80bf3e3d973f22bf7e3f4ebe2fbf0e,0xbe60beac3f4abf7f3f65bf04bcc93f0e,0x3f7abf713f1dbdc9bee63f5cbf803f55,0xbecf3d493ea1bf223f5fbf7d3f7abf55,0x3f6abf803f73bf463efcbe16be603f0e,0xbf133edbbe893dc93d97be793ecfbf0e,0x3f51bf673f77bf7f3f7fbf783f6abf55
.octa 0x3e2f3e163dfb3dc93d973d493cc90000,0x3f7c3f7d3f7e3f7f3f7f3f803f803f80,0x3f803f783f653f463f1d3edb3e600000,0x3cc93e793ee63f223f4a3f673f7a3f80,0x3e603f183f5f3f7f3f733f3e3ecf0000,0xbf7abf4ebefcbdc93ea13f2c3f6a3f80,0xbf6abf043d973f223f773f713f130000,0xbecfbf5cbf7fbf46be893eac3f513f80
.octa 0xbf13bf7dbf4abdc93f273f803f390000,0x3f513e16bf1dbf7fbf42bd493f313f80,0x3f31be79bf73bf463dfb3f673f580000,0x3f393f783ea1bf22bf7ebedb3f093f80,0x3f583f4ebe89bf7fbee63f2c3f6f0000,0xbf093f183f773dc9bf65bf3e3eb83f80,0xbeb83f5c3f27bf22bf5f3eac3f7c0000,0xbf6fbf043f423f46befcbf713e2f3f80
.octa 0xbf7cbe163f7e3dc9bf7fbd493f800000,0x3e2fbf7dbdfb3f7f3d97bf80bcc93f80,0xbcc9bf783ee63f46bf4abedb3f7a0000,0x3f80be79bf653f223f1dbf67be603f80,0x3f7abf18befc3f7fbea1bf3e3f6a0000,0x3e603f4ebf5fbdc93f73bf2cbecf3f80,0x3ecf3f04bf7f3f223e89bf713f510000,0xbf6a3f5cbd97bf463f77beacbf133f80
.octa 0xbf513f7dbf1dbdc93f42bf803f310000,0xbf13be163f4abf7f3f273d49bf393f80,0xbf393e793ea1bf463f7ebf673f090000,0x3f31bf783f73bf223dfb3edbbf583f80,0x3f09bf4e3f77bf7f3f65bf2c3eb80000,0x3f58bf183e893dc9bee63f3ebf6f3f80,0x3f6fbf5c3f42bf223efcbeac3e2f0000,0xbeb83f04bf273f46bf5f3f71bf7c3f80
.octa 0x3eb83eac3ea13e953e893e793e603e48,0x3f6f3f713f733f753f773f783f7a3f7b,0xbe2f3d493e893ef13f273f4e3f6a3f7b,0xbf7cbf80bf77bf62bf42bf18becfbe48,0xbcc9bedbbf42bf75bf7ebf5cbf13be48,0x3f803f673f273e95bdfbbf04bf51bf7b,0x3e603f3e3f7e3f623ee6be16bf31bf7b,0xbf7abf2cbdfb3ef13f653f7d3f393e48
.octa 0xbecfbf71bf65be953efc3f783f583e48,0x3f6a3eacbee6bf75bf5fbe793f093f7b,0x3f133f803efcbef1bf7fbf183eb83f7b,0xbf513d493f5f3f623d97bf4ebf6fbe48,0xbf39bf673d973f753f1dbf04bf7cbe48,0x3f31bedbbf7fbe953f4a3f5cbe2fbf7b,0x3f583f2cbf1dbf623ea13f7d3cc9bf7b,0xbf093f3e3f4abef1bf733e163f803e48
.octa 0xbf6fbeac3f733e95bf77be793f7a3e48,0x3eb8bf71bea13f753e89bf78be603f7b,0x3f7cbd49bf773ef13f42bf4ebecf3f7b,0xbe2f3f80be89bf623f273f18bf6abe48,0xbf803edb3f27bf753dfb3f5cbf51be48,0xbcc9bf673f423e95bf7e3f043f13bf7b,0x3f7abf3ebdfb3f62bf653e163f39bf7b,0x3e603f2cbf7e3ef13ee6bf7d3f313e48
.octa 0xbf6a3f71bee6be953f5fbf783f093e48,0xbecfbeac3f65bf753efc3e79bf583f7b,0x3f51bf803f5fbef1bd973f18bf6f3f7b,0x3f13bd49befc3f62bf7f3f4ebeb8be48,0xbf313f67bf7f3f75bf4a3f04be2fbe48,0xbf393edbbd97be953f1dbf5c3f7cbf7b,0x3f09bf2c3f4abf623f73bf7d3f80bf7b,0x3f58bf3e3f1dbef13ea1be16bcc93e48
.octa 0x3f093f043efc3ef13ee63edb3ecf3ec4,0x3f583f5c3f5f3f623f653f673f6a3f6d,0xbf6fbf7dbf7fbf75bf5fbf3ebf13bec4,0x3eb83e16bd97be95befcbf2cbf51bf6d,0xbe2f3e793f1d3f623f7f3f713f393ec4,0xbf7cbf78bf4abef1bd973eac3f313f6d,0x3f803f4e3ea1be95bf4abf80bf58bec4,0x3cc93f183f733f753f1d3d49bf09bf6d
.octa 0xbe60bf5cbf77bef13ea13f673f6f3ec4,0x3f7a3f04be89bf62bf73bedb3eb83f6d,0xbf6abe163f423f753e89bf2cbf7cbec4,0xbecfbf7dbf273e953f773f3ebe2fbf6d,0x3f133f783dfbbf62bf423eac3f803ec4,0xbf513e793f7e3ef1bf27bf71bcc93f6d,0x3f31bf18bf653e953f7e3d49bf7abec4,0x3f393f4ebee6bf753dfb3f803e60bf6d
.octa 0xbf58bf043f5f3ef1bf65bedb3f6a3ec4,0x3f09bf5cbefc3f623ee6bf67becf3f6d,0xbeb83f7dbd97bf753efc3f3ebf51bec4,0xbf6fbe163f7fbe95bf5f3f2c3f13bf6d,0x3f7cbe79bf4a3f623d97bf713f313ec4,0xbe2f3f78bf1dbef13f7fbeacbf393f6d,0xbcc9bf4e3f73be95bf1d3f80bf09bec4,0x3f80bf18bea13f75bf4abd493f58bf6d
.octa 0xbf7a3f5cbe89bef13f73bf673eb83ec4,0xbe60bf043f77bf623ea13edbbf6f3f6d,0x3ecf3e16bf273f75bf773f2cbe2fbec4,0xbf6a3f7dbf423e953e89bf3e3f7cbf6d,0x3f51bf783f7ebf623f27beacbcc93ec4,0x3f13be79bdfb3ef1bf423f71bf803f6d,0xbf393f18bee63e95bdfbbd493e60bec4,0x3f31bf4e3f65bf753f7ebf803f7abf6d
.octa 0x3f313f2c3f273f223f1d3f183f133f0e,0x3f393f3e3f423f463f4a3f4e3f513f55,0x3f093eac3dfbbdc9bea1bf04bf31bf55,0x3f583f713f7e3f7f3f733f5c3f393f0e,0x3eb8bd49bee6bf46bf77bf7dbf58bf0e,0x3f6f3f803f653f223e89be16bf09bf55,0x3e2fbedbbf5fbf7fbf42be793eb83f55,0x3f7c3f673efcbdc9bf27bf78bf6fbf0e
.octa 0xbcc9bf3ebf7fbf223dfb3f4e3f7c3f0e,0x3f803f2cbd97bf46bf7ebf183e2f3f55,0xbe60bf71bf4a3dc93f653f5c3cc9bf55,0x3f7a3eacbf1dbf7fbee63f043f803f0e,0xbecfbf80bea13f463f5fbe16bf7abf0e,0x3f6abd49bf73bf223efc3f7d3e60bf55,0xbf13bf673e893f7f3d97bf78becf3f55,0x3f51bedbbf773dc93f7f3e79bf6abf0e
.octa 0xbf39bf2c3f423f22bf4abf183f513f0e,0x3f31bf3ebf273f463f1dbf4ebf133f55,0xbf58beac3f7ebdc9bf733f043f39bf55,0x3f09bf71bdfb3f7fbea1bf5c3f313f0e,0xbf6f3d493f65bf46be893f7dbf09bf0e,0x3eb8bf803ee63f22bf773e163f58bf55,0xbf7c3edb3efcbf7f3f273e79bf6f3f55,0x3e2fbf673f5fbdc9bf423f78beb8bf0e
.octa 0xbf803f3ebd97bf223f7ebf4e3e2f3f0e,0xbcc9bf2c3f7fbf463dfb3f18bf7c3f55,0xbf7a3f71bf1d3dc93ee6bf5c3f80bf55,0xbe60beac3f4abf7f3f65bf04bcc93f0e,0xbf6a3f80bf733f46befc3e163e60bf0e,0xbecf3d493ea1bf223f5fbf7d3f7abf55,0xbf513f67bf773f7fbf7f3f78bf6a3f55,0xbf133edbbe893dc93d97be793ecfbf0e
.octa 0xbf7c3f7dbf7e3f7fbf7f3f80bf803f80,0x3e2fbe163dfbbdc93d97bd493cc98000,0xbcc93e79bee63f22bf4a3f67bf7a3f80,0x3f80bf783f65bf463f1dbedb3e608000,0x3f7abf4e3efcbdc9bea13f2cbf6a3f80,0x3e60bf183f5fbf7f3f73bf3e3ecf8000,0x3ecfbf5c3f7fbf463e893eacbf513f80,0xbf6a3f043d97bf223f77bf713f138000
.octa 0xbf513e163f1dbf7f3f42bd49bf313f80,0xbf133f7dbf4a3dc93f27bf803f398000,0xbf393f78bea1bf223f7ebedbbf093f80,0x3f313e79bf733f463dfbbf673f588000,0x3f093f18bf773dc93f65bf3ebeb83f80,0x3f58bf4ebe893f7fbee6bf2c3f6f8000,0x3f6fbf04bf423f463efcbf71be2f3f80,0xbeb8bf5c3f273f22bf5fbeac3f7c8000
.octa 0xbe2fbf7d3dfb3f7fbd97bf803cc93f80,0xbf7c3e163f7ebdc9bf7f3d493f808000,0xbf80be793f653f22bf1dbf673e603f80,0xbcc93f783ee6bf46bf4a3edb3f7a8000,0xbe603f4e3f5fbdc9bf73bf2c3ecf3f80,0x3f7a3f18befcbf7fbea13f3e3f6a8000,0x3f6a3f5c3d97bf46bf77beac3f133f80,0x3ecfbf04bf7fbf223e893f713f518000
.octa 0x3f13be16bf4abf7fbf273d493f393f80,0xbf51bf7dbf1d3dc93f423f803f318000,0xbf31bf78bf73bf22bdfb3edb3f583f80,0xbf39be793ea13f463f7e3f673f098000,0xbf58bf18be893dc93ee63f3e3f6f3f80,0x3f093f4e3f773f7f3f653f2c3eb88000,0x3eb83f043f273f463f5f3f713f7c3f80,0x3f6f3f5c3f423f223efc3eac3e2f8000
.octa 0xbf6f3f71bf733f75bf773f78bf7a3f7b,0x3eb8beac3ea1be953e89be793e60be48,0x3f7cbf803f77bf623f42bf183ecfbe48,0xbe2fbd493e89bef13f27bf4e3f6abf7b,0xbf803f67bf273e953dfbbf043f51bf7b,0xbcc93edbbf423f75bf7e3f5cbf133e48,0x3f7abf2c3dfb3ef1bf653f7dbf393e48,0x3e60bf3e3f7ebf623ee63e16bf313f7b
.octa 0xbf6a3eac3ee6bf753f5fbe79bf093f7b,0xbecf3f71bf653e953efcbf783f58be48,0x3f513d49bf5f3f62bd97bf4e3f6fbe48,0x3f13bf803efc3ef1bf7f3f183eb8bf7b,0xbf31bedb3f7fbe95bf4a3f5c3e2fbf7b,0xbf393f673d97bf753f1d3f04bf7c3e48,0x3f093f3ebf4abef13f733e16bf803e48,0x3f58bf2cbf1d3f623ea1bf7d3cc93f7b
.octa 0xbeb8bf713ea13f75be89bf783e603f7b,0xbf6f3eac3f73be95bf773e793f7abe48,0x3e2f3f803e89bf62bf273f183f6abe48,0x3f7c3d49bf77bef13f423f4ebecfbf7b,0x3cc9bf67bf423e953f7e3f04bf13bf7b,0xbf80bedb3f273f753dfbbf5cbf513e48,0xbe603f2c3f7e3ef1bee6bf7dbf313e48,0x3f7a3f3ebdfbbf62bf65be163f393f7b
.octa 0x3ecfbeacbf65bf75befc3e793f583f7b,0xbf6abf71bee63e953f5f3f783f09be48,0xbf13bd493efc3f623f7f3f4e3eb8be48,0x3f513f803f5f3ef1bd97bf18bf6fbf7b,0x3f393edb3d97be95bf1dbf5cbf7cbf7b,0xbf31bf67bf7fbf75bf4abf04be2f3e48,0xbf58bf3ebf1dbef1bea1be163cc93e48,0x3f093f2c3f4a3f623f733f7d3f803f7b
.octa 0xbf583f5cbf5f3f62bf653f67bf6a3f6d,0x3f09bf043efcbef13ee6bedb3ecfbec4,0xbeb83e163d97be953efcbf2c3f51bf6d,0xbf6f3f7dbf7f3f75bf5f3f3ebf133ec4,0x3f7cbf783f4abef13d973eacbf313f6d,0xbe2fbe793f1dbf623f7fbf713f39bec4,0xbcc93f18bf733f75bf1d3d493f09bf6d,0x3f80bf4e3ea13e95bf4a3f80bf583ec4
.octa 0xbf7a3f043e89bf623f73bedbbeb83f6d,0xbe603f5cbf773ef13ea1bf673f6fbec4,0x3ecfbf7d3f273e95bf773f3e3e2fbf6d,0xbf6a3e163f42bf753e893f2cbf7c3ec4,0x3f513e79bf7e3ef13f27bf713cc93f6d,0x3f13bf783dfb3f62bf42beac3f80bec4,0xbf393f4e3ee6bf75bdfb3f80be60bf6d,0x3f313f18bf65be953f7ebd49bf7a3ec4
.octa 0xbf09bf5c3efc3f62bee6bf673ecf3f6d,0xbf583f043f5fbef1bf653edb3f6abec4,0x3f6fbe16bf7fbe953f5f3f2cbf13bf6d,0xbeb8bf7dbd973f753efcbf3ebf513ec4,0x3e2f3f783f1dbef1bf7fbeac3f393f6d,0x3f7c3e79bf4abf623d973f713f31bec4,0xbf80bf183ea13f753f4abd49bf58bf6d,0xbcc93f4e3f733e95bf1dbf80bf093ec4
.octa 0x3e60bf04bf77bf62bea13edb3f6f3f6d,0xbf7abf5cbe893ef13f733f673eb8bec4,0x3f6a3f7d3f423e95be89bf3ebf7cbf6d,0x3ecfbe16bf27bf75bf77bf2cbe2f3ec4,0xbf13be793dfb3ef13f423f713f803f6d,0x3f513f783f7e3f623f273eacbcc9bec4,0xbf31bf4ebf65bf75bf7ebf80bf7abf6d,0xbf39bf18bee6be95bdfb3d493e603ec4
.octa 0xbf393f3ebf423f46bf4a3f4ebf513f55,0x3f31bf2c3f27bf223f1dbf183f13bf0e,0xbf583f71bf7e3f7fbf733f5cbf393f0e,0x3f09beac3dfb3dc9bea13f04bf313f55,0xbf6f3f80bf653f22be89be163f09bf55,0x3eb83d49bee63f46bf773f7dbf583f0e,0xbf7c3f67befcbdc93f27bf783f6fbf0e,0x3e2f3edbbf5f3f7fbf423e793eb8bf55
.octa 0xbf803f2c3d97bf463f7ebf18be2f3f55,0xbcc93f3ebf7f3f223dfbbf4e3f7cbf0e,0xbf7a3eac3f1dbf7f3ee63f04bf803f0e,0xbe603f71bf4abdc93f65bf5c3cc93f55,0xbf6abd493f73bf22befc3f7dbe60bf55,0xbecf3f80bea1bf463f5f3e16bf7a3f0e,0xbf51bedb3f773dc9bf7f3e793f6abf0e,0xbf133f673e89bf7f3d973f78becfbf55
.octa 0xbf31bf3e3f273f46bf1dbf4e3f133f55,0xbf393f2c3f42bf22bf4a3f183f51bf0e,0xbf09bf713dfb3f7f3ea1bf5cbf313f0e,0xbf583eac3f7e3dc9bf73bf043f393f55,0xbeb8bf80bee63f223f773e16bf58bf55,0xbf6fbd493f653f46be89bf7dbf093f0e,0xbe2fbf67bf5fbdc93f423f783eb8bf0e,0xbf7cbedb3efc3f7f3f27be79bf6fbf55
.octa 0x3cc9bf2cbf7fbf46bdfb3f183f7c3f55,0xbf80bf3ebd973f223f7e3f4e3e2fbf0e,0x3e60beacbf4abf7fbf65bf043cc93f0e,0xbf7abf71bf1dbdc93ee63f5c3f803f55,0x3ecf3d49bea1bf22bf5fbf7dbf7abf55,0xbf6abf80bf73bf46befcbe163e603f0e,0x3f133edb3e893dc9bd97be79becfbf0e,0xbf51bf67bf77bf7fbf7fbf78bf6abf55
.octa 0xbe2f3e16bdfb3dc9bd973d49bcc90000,0xbf7c3f7dbf7e3f7fbf7f3f80bf803f80,0xbf803f78bf653f46bf1d3edbbe600000,0xbcc93e79bee63f22bf4a3f67bf7a3f80,0xbe603f18bf5f3f7fbf733f3ebecf0000,0x3f7abf4e3efcbdc9bea13f2cbf6a3f80,0x3f6abf04bd973f22bf773f71bf130000,0x3ecfbf5c3f7fbf463e893eacbf513f80
.octa 0x3f13bf7d3f4abdc9bf273f80bf390000,0xbf513e163f1dbf7f3f42bd49bf313f80,0xbf31be793f73bf46bdfb3f67bf580000,0xbf393f78bea1bf223f7ebedbbf093f80,0xbf583f4e3e89bf7f3ee63f2cbf6f0000,0x3f093f18bf773dc93f65bf3ebeb83f80,0x3eb83f5cbf27bf223f5f3eacbf7c0000,0x3f6fbf04bf423f463efcbf71be2f3f80
.octa 0x3f7cbe16bf7e3dc93f7fbd49bf800000,0xbe2fbf7d3dfb3f7fbd97bf803cc93f80,0x3cc9bf78bee63f463f4abedbbf7a0000,0xbf80be793f653f22bf1dbf673e603f80,0xbf7abf183efc3f7f3ea1bf3ebf6a0000,0xbe603f4e3f5fbdc9bf73bf2c3ecf3f80,0xbecf3f043f7f3f22be89bf71bf510000,0x3f6a3f5c3d97bf46bf77beac3f133f80
.octa 0x3f513f7d3f1dbdc9bf42bf80bf310000,0x3f13be16bf4abf7fbf273d493f393f80,0x3f393e79bea1bf46bf7ebf67bf090000,0xbf31bf78bf73bf22bdfb3edb3f583f80,0xbf09bf4ebf77bf7fbf65bf2cbeb80000,0xbf58bf18be893dc93ee63f3e3f6f3f80,0xbf6fbf5cbf42bf22befcbeacbe2f0000,0x3eb83f043f273f463f5f3f713f7c3f80
.octa 0xbeb83eacbea13e95be893e79be603e48,0xbf6f3f71bf733f75bf773f78bf7a3f7b,0x3e2f3d49be893ef1bf273f4ebf6a3f7b,0x3f7cbf803f77bf623f42bf183ecfbe48,0x3cc9bedb3f42bf753f7ebf5c3f13be48,0xbf803f67bf273e953dfbbf043f51bf7b,0xbe603f3ebf7e3f62bee6be163f31bf7b,0x3f7abf2c3dfb3ef1bf653f7dbf393e48
.octa 0x3ecfbf713f65be95befc3f78bf583e48,0xbf6a3eac3ee6bf753f5fbe79bf093f7b,0xbf133f80befcbef13f7fbf18beb83f7b,0x3f513d49bf5f3f62bd97bf4e3f6fbe48,0x3f39bf67bd973f75bf1dbf043f7cbe48,0xbf31bedb3f7fbe95bf4a3f5c3e2fbf7b,0xbf583f2c3f1dbf62bea13f7dbcc9bf7b,0x3f093f3ebf4abef13f733e16bf803e48
.octa 0x3f6fbeacbf733e953f77be79bf7a3e48,0xbeb8bf713ea13f75be89bf783e603f7b,0xbf7cbd493f773ef1bf42bf4e3ecf3f7b,0x3e2f3f803e89bf62bf273f183f6abe48,0x3f803edbbf27bf75bdfb3f5c3f51be48,0x3cc9bf67bf423e953f7e3f04bf13bf7b,0xbf7abf3e3dfb3f623f653e16bf39bf7b,0xbe603f2c3f7e3ef1bee6bf7dbf313e48
.octa 0x3f6a3f713ee6be95bf5fbf78bf093e48,0x3ecfbeacbf65bf75befc3e793f583f7b,0xbf51bf80bf5fbef13d973f183f6f3f7b,0xbf13bd493efc3f623f7f3f4e3eb8be48,0x3f313f673f7f3f753f4a3f043e2fbe48,0x3f393edb3d97be95bf1dbf5cbf7cbf7b,0xbf09bf2cbf4abf62bf73bf7dbf80bf7b,0xbf58bf3ebf1dbef1bea1be163cc93e48
.octa 0xbf093f04befc3ef1bee63edbbecf3ec4,0xbf583f5cbf5f3f62bf653f67bf6a3f6d,0x3f6fbf7d3f7fbf753f5fbf3e3f13bec4,0xbeb83e163d97be953efcbf2c3f51bf6d,0x3e2f3e79bf1d3f62bf7f3f71bf393ec4,0x3f7cbf783f4abef13d973eacbf313f6d,0xbf803f4ebea1be953f4abf803f58bec4,0xbcc93f18bf733f75bf1d3d493f09bf6d
.octa 0x3e60bf5c3f77bef1bea13f67bf6f3ec4,0xbf7a3f043e89bf623f73bedbbeb83f6d,0x3f6abe16bf423f75be89bf2c3f7cbec4,0x3ecfbf7d3f273e95bf773f3e3e2fbf6d,0xbf133f78bdfbbf623f423eacbf803ec4,0x3f513e79bf7e3ef13f27bf713cc93f6d,0xbf31bf183f653e95bf7e3d493f7abec4,0xbf393f4e3ee6bf75bdfb3f80be60bf6d
.octa 0x3f58bf04bf5f3ef13f65bedbbf6a3ec4,0xbf09bf5c3efc3f62bee6bf673ecf3f6d,0x3eb83f7d3d97bf75befc3f3e3f51bec4,0x3f6fbe16bf7fbe953f5f3f2cbf13bf6d,0xbf7cbe793f4a3f62bd97bf71bf313ec4,0x3e2f3f783f1dbef1bf7fbeac3f393f6d,0x3cc9bf4ebf73be953f1d3f803f09bec4,0xbf80bf183ea13f753f4abd49bf58bf6d
.octa 0x3f7a3f5c3e89bef1bf73bf67beb83ec4,0x3e60bf04bf77bf62bea13edb3f6f3f6d,0xbecf3e163f273f753f773f2c3e2fbec4,0x3f6a3f7d3f423e95be89bf3ebf7cbf6d,0xbf51bf78bf7ebf62bf27beac3cc93ec4,0xbf13be793dfb3ef13f423f713f803f6d,0x3f393f183ee63e953dfbbd49be60bec4,0xbf31bf4ebf65bf75bf7ebf80bf7abf6d
.octa 0xbf313f2cbf273f22bf1d3f18bf133f0e,0xbf393f3ebf423f46bf4a3f4ebf513f55,0xbf093eacbdfbbdc93ea1bf043f31bf55,0xbf583f71bf7e3f7fbf733f5cbf393f0e,0xbeb8bd493ee6bf463f77bf7d3f58bf0e,0xbf6f3f80bf653f22be89be163f09bf55,0xbe2fbedb3f5fbf7f3f42be79beb83f55,0xbf7c3f67befcbdc93f27bf783f6fbf0e
.octa 0x3cc9bf3e3f7fbf22bdfb3f4ebf7c3f0e,0xbf803f2c3d97bf463f7ebf18be2f3f55,0x3e60bf713f4a3dc9bf653f5cbcc9bf55,0xbf7a3eac3f1dbf7f3ee63f04bf803f0e,0x3ecfbf803ea13f46bf5fbe163f7abf0e,0xbf6abd493f73bf22befc3f7dbe60bf55,0x3f13bf67be893f7fbd97bf783ecf3f55,0xbf51bedb3f773dc9bf7f3e793f6abf0e
.octa 0x3f39bf2cbf423f223f4abf18bf513f0e,0xbf31bf3e3f273f46bf1dbf4e3f133f55,0x3f58beacbf7ebdc93f733f04bf39bf55,0xbf09bf713dfb3f7f3ea1bf5cbf313f0e,0x3f6f3d49bf65bf463e893f7d3f09bf0e,0xbeb8bf80bee63f223f773e16bf58bf55,0x3f7c3edbbefcbf7fbf273e793f6f3f55,0xbe2fbf67bf5fbdc93f423f783eb8bf0e
.octa 0x3f803f3e3d97bf22bf7ebf4ebe2f3f0e,0x3cc9bf2cbf7fbf46bdfb3f183f7c3f55,0x3f7a3f713f1d3dc9bee6bf5cbf80bf55,0x3e60beacbf4abf7fbf65bf043cc93f0e,0x3f6a3f803f733f463efc3e16be60bf0e,0x3ecf3d49bea1bf22bf5fbf7dbf7abf55,0x3f513f673f773f7f3f7f3f783f6a3f55,0x3f133edb3e893dc9bd97be79becfbf0e
.octa 0x3f7b3f7c3f7e3f7e3f7f3f803f803f80,0xbe45be29be0dbde2bda9bd62bce28000,0x3b493e663edf3f203f483f673f7a3f80,0xbf80bf79bf66bf48bf1fbedebe638000,0xbf7bbf50bf02bde23e9c3f2b3f6a3f80,0xbe4bbf15bf5dbf7ebf74bf3fbed18000,0xbec5bf59bf80bf48be8d3eaa3f513f80,0x3f6c3f08bd6fbf20bf76bf72bf148000
.octa 0x3f543e29bf1abf7ebf43bd623f303f80,0x3f0f3f7c3f4c3de2bf25bf80bf3a8000,0x3f363f793ea8bf20bf7ebede3f083f80,0xbf343e663f723f48bde8bf67bf598000,0xbf0e3f153f783de2bf64bf3f3eb73f80,0xbf55bf503e813f7e3eeabf2bbf6f8000,0xbf6dbf083f3f3f48bef8bf723e2c3f80,0x3ec2bf59bf2a3f203f60beaabf7c8000
.octa 0x3e45bf7cbe0d3f7e3da9bf80bce23f80,0x3f7b3e29bf7ebde23f7f3d62bf808000,0x3f80be66bf663f203f1fbf67be633f80,0x3b493f79bedfbf483f483edebf7a8000,0x3e4b3f50bf5dbde23f74bf2bbed13f80,0xbf7b3f153f02bf7e3e9c3f3fbf6a8000,0xbf6c3f59bd6fbf483f76beaabf143f80,0xbec5bf083f80bf20be8d3f72bf518000
.octa 0xbf0fbe293f4cbf7e3f253d62bf3a3f80,0x3f54bf7c3f1a3de2bf433f80bf308000,0x3f34bf793f72bf203de83edebf593f80,0x3f36be66bea83f48bf7e3f67bf088000,0x3f55bf153e813de2beea3f3fbf6f3f80,0xbf0e3f50bf783f7ebf643f2bbeb78000,0xbec23f08bf2a3f48bf603f72bf7c3f80,0xbf6d3f59bf3f3f20bef83eaabe2c8000
.octa 0x3f6a3f6d3f703f723f743f763f783f7a,0xbecebec1beb4bea7be99be8cbe7cbe60,0xbf7abf80bf79bf66bf47bf1fbedcbe60,0x3e5dbbc9be6abee1bf21bf49bf67bf7a,0x3f803f6c3f2f3ea7bdb6befabf4dbf7a,0xbcb03ec73f3b3f723f7f3f603f193e60,0xbf7cbf34be263ee13f613f7e3f3e3e60,0xbe32bf36bf7dbf66bef63dee3f2b3f7a
.octa 0x3f6f3ec1bed4bf72bf63be8c3f033f7a,0x3eba3f6d3f693ea7beedbf76bf5cbe60,0xbf583bc93f5a3f663ddbbf49bf71be60,0xbf0abf80bf073ee13f7f3f1fbeabbf7a,0x3f39bec7bf80bea73f443f60be13bf7a,0x3f313f6cbd0abf72bf243efa3f7d3e60,0xbf133f363f50bee1bf763dee3f803e60,0xbf52bf343f153f66be90bf7ebd563f7a
.octa 0x3ecebf6dbeb43f723e99bf76be7c3f7a,0x3f6a3ec1bf70bea73f743e8cbf78be60,0xbe5d3f80be6abf663f213f1fbf67be60,0xbf7a3bc93f79bee1bf473f493edcbf7a,0x3cb0bf6c3f3b3ea7bf7f3efa3f19bf7a,0x3f80bec7bf2f3f72bdb6bf603f4d3e60,0x3e323f34bf7d3ee13ef6bf7e3f2b3e60,0xbf7c3f363e26bf663f61bdeebf3e3f7a
.octa 0xbebabec13f69bf723eed3e8cbf5c3f7a,0x3f6fbf6d3ed43ea7bf633f76bf03be60,0x3f0abbc9bf073f66bf7f3f49beabbe60,0xbf583f80bf5a3ee13ddbbf1f3f71bf7a,0xbf313ec7bd0abea73f24bf603f7dbf7a,0x3f39bf6c3f80bf723f44befa3e133e60,0x3f52bf363f15bee13e90bdeebd563e60,0xbf133f34bf503f66bf763f7ebf803f7a
.octa 0x3f4e3f523f563f5a3f5e3f613f643f67,0xbf18bf12bf0cbf06bf00bef4bee8bedb,0x3ed93e5abc17be6dbee2bf21bf49bf67,0x3f683f7a3f803f793f663f473f1e3edb,0xbf79bf7cbf54bf06be073e923f273f67,0x3e76be35bf10bf5abf7ebf75bf42bedb,0xbd3c3f0a3f6d3f793f293dd5befbbf67,0xbf80bf57bec03e6d3f403f7f3f5f3edb
.octa 0x3f7d3f12be51bf5abf77bef43e9f3f67,0x3e193f523f7b3f06be84bf61bf73bedb,0xbeaebf7abf333e6d3f723f47bdf4bf67,0x3f713e5abf37bf79bea53f213f7e3edb,0xbf5b3e353f7c3f06bf1cbf75bd9d3f67,0xbf04bf7cbe3f3f5a3f4bbe92bf7fbedb,0x3f2d3f57bec8bf793d843f7f3e8abf67,0xbf3d3f0a3f6cbe6dbf7fbdd53f773edb
.octa 0x3f18bf52bf0c3f5a3f00bf61bee83f67,0x3f4e3f12bf56bf063f5e3ef4bf64bedb,0xbf68be5a3f80be6dbf663f213f1ebf67,0x3ed9bf7a3c173f79bee2bf473f493edb,0xbe763f7cbf10bf063f7ebe92bf423f67,0xbf793e353f54bf5abe073f75bf27bedb,0x3f80bf0abec03f79bf40bdd53f5fbf67,0xbd3c3f57bf6d3e6d3f29bf7f3efb3edb
.octa 0xbe19bf123f7bbf5a3e843ef4bf733f67,0x3f7dbf523e513f06bf773f61be9fbedb,0xbf713f7abf373e6d3ea5bf473f7ebf67,0xbeaebe5a3f33bf793f72bf213df43edb,0x3f04be35be3f3f06bf4b3f75bf7f3f67,0xbf5b3f7cbf7c3f5abf1c3e923d9dbedb,0x3f3dbf573f6cbf793f7fbf7f3f77bf67,0x3f2dbf0a3ec8be6d3d843dd5be8a3edb
.octa 0x3f283f2d3f323f373f3c3f413f453f4a,0xbf41bf3dbf38bf33bf2ebf28bf23bf1d,0x3f4a3f683f7a3f803f793f653f463f1d,0xbf1dbed8be573c493e703ee33f223f4a,0x3f653f803f6e3f333eb1bd8abef0bf4a,0xbee5bd303ebd3f373f703f7f3f623f1d,0x3f773f713f11bc49bf17bf73bf75bf1d,0xbe873eaf3f533f803f4f3ea4be93bf4a
.octa 0x3f7f3f3d3c7bbf37bf80bf283dc23f4a,0xbd903f2d3f803f33bd23bf41bf7fbf1d,0x3f7e3ed8bf0bbf80bf063ee33f7f3f1d,0x3e003f683f57bc49bf5abf65bdcf3f4a,0x3f733d30bf6bbf333ed73f7f3e96bf4a,0x3ea23f803ecbbf37bf683d8a3f753f1d,0x3f5ebeafbf7c3c493f7d3ea4bf61bf1d,0x3efe3f71be38bf80be203f733ef3bf4a
.octa 0x3f41bf2dbf383f373f2ebf41bf233f4a,0x3f283f3dbf32bf333f3c3f28bf45bf1d,0x3f1dbf68be573f80be70bf653f223f1d,0x3f4a3ed8bf7a3c493f79bee3bf463f4a,0x3ee5bf803ebd3f33bf703d8a3f62bf4a,0x3f653d30bf6e3f373eb1bf7f3ef03f1d,0x3e87bf713f53bc49bf4f3f73be93bf1d,0x3f77beafbf113f80bf17bea43f75bf4a
.octa 0x3d90bf3d3f80bf373d233f28bf7f3f4a,0x3f7fbf2dbc7b3f33bf803f41bdc2bf1d,0xbe00bed83f57bf803f5abee3bdcf3f1d,0x3f7ebf683f0bbc49bf063f65bf7f3f4a,0xbea2bd303ecbbf333f68bf7f3f75bf4a,0x3f73bf803f6bbf373ed7bd8abe963f1d,0xbefe3eafbe383c493e20bea43ef3bf1d,0x3f5ebf713f7cbf803f7dbf733f61bf4a
.octa 0x3e453e293e0d3de23da93d623ce20000,0x3f7b3f7c3f7e3f7e3f7f3f803f803f80,0x3f803f793f663f483f1f3ede3e630000,0x3b493e663edf3f203f483f673f7a3f80,0x3e4b3f153f5d3f7e3f743f3f3ed10000,0xbf7bbf50bf02bde23e9c3f2b3f6a3f80,0xbf6cbf083d6f3f203f763f723f140000,0xbec5bf59bf80bf48be8d3eaa3f513f80
.octa 0xbf0fbf7cbf4cbde23f253f803f3a0000,0x3f543e29bf1abf7ebf43bd623f303f80,0x3f34be66bf72bf483de83f673f590000,0x3f363f793ea8bf20bf7ebede3f083f80,0x3f553f50be81bf7ebeea3f2b3f6f0000,0xbf0e3f153f783de2bf64bf3f3eb73f80,0xbec23f593f2abf20bf603eaa3f7c0000,0xbf6dbf083f3f3f48bef8bf723e2c3f80
.octa 0xbf7bbe293f7e3de2bf7fbd623f800000,0x3e45bf7cbe0d3f7e3da9bf80bce23f80,0xbb49bf793edf3f48bf48bede3f7a0000,0x3f80be66bf663f203f1fbf67be633f80,0x3f7bbf15bf023f7ebe9cbf3f3f6a0000,0x3e4b3f50bf5dbde23f74bf2bbed13f80,0x3ec53f08bf803f203e8dbf723f510000,0xbf6c3f59bd6fbf483f76beaabf143f80
.octa 0xbf543f7cbf1abde23f43bf803f300000,0xbf0fbe293f4cbf7e3f253d62bf3a3f80,0xbf363e663ea8bf483f7ebf673f080000,0x3f34bf793f72bf203de83edebf593f80,0x3f0ebf503f78bf7e3f64bf2b3eb70000,0x3f55bf153e813de2beea3f3fbf6f3f80,0x3f6dbf593f3fbf203ef8beaa3e2c0000,0xbec23f08bf2a3f48bf603f72bf7c3f80
.octa 0x3ece3ec13eb43ea73e993e8c3e7c3e60,0x3f6a3f6d3f703f723f743f763f783f7a,0xbe5d3bc93e6a3ee13f213f493f673f7a,0xbf7abf80bf79bf66bf47bf1fbedcbe60,0x3cb0bec7bf3bbf72bf7fbf60bf19be60,0x3f803f6c3f2f3ea7bdb6befabf4dbf7a,0x3e323f363f7d3f663ef6bdeebf2bbf7a,0xbf7cbf34be263ee13f613f7e3f3e3e60
.octa 0xbebabf6dbf69bea73eed3f763f5c3e60,0x3f6f3ec1bed4bf72bf63be8c3f033f7a,0x3f0a3f803f07bee1bf7fbf1f3eab3f7a,0xbf583bc93f5a3f663ddbbf49bf71be60,0xbf31bf6c3d0a3f723f24befabf7dbe60,0x3f39bec7bf80bea73f443f60be13bf7a,0x3f523f34bf15bf663e903f7e3d56bf7a,0xbf133f363f50bee1bf763dee3f803e60
.octa 0xbf6abec13f703ea7bf74be8c3f783e60,0x3ecebf6dbeb43f723e99bf76be7c3f7a,0x3f7abbc9bf793ee13f47bf49bedc3f7a,0xbe5d3f80be6abf663f213f1fbf67be60,0xbf803ec73f2fbf723db63f60bf4dbe60,0x3cb0bf6c3f3b3ea7bf7f3efa3f19bf7a,0x3f7cbf36be263f66bf613dee3f3ebf7a,0x3e323f34bf7d3ee13ef6bf7e3f2b3e60
.octa 0xbf6f3f6dbed4bea73f63bf763f033e60,0xbebabec13f69bf723eed3e8cbf5c3f7a,0x3f58bf803f5abee1bddb3f1fbf713f7a,0x3f0abbc9bf073f66bf7f3f49beabbe60,0xbf393f6cbf803f72bf443efabe13be60,0xbf313ec7bd0abea73f24bf603f7dbf7a,0x3f13bf343f50bf663f76bf7e3f80bf7a,0x3f52bf363f15bee13e90bdeebd563e60
.octa 0x3f183f123f0c3f063f003ef43ee83edb,0x3f4e3f523f563f5a3f5e3f613f643f67,0xbf68bf7abf80bf79bf66bf47bf1ebedb,0x3ed93e5abc17be6dbee2bf21bf49bf67,0xbe763e353f103f5a3f7e3f753f423edb,0xbf79bf7cbf54bf06be073e923f273f67,0x3f803f573ec0be6dbf40bf7fbf5fbedb,0xbd3c3f0a3f6d3f793f293dd5befbbf67
.octa 0xbe19bf52bf7bbf063e843f613f733edb,0x3f7d3f12be51bf5abf77bef43e9f3f67,0xbf71be5a3f373f793ea5bf21bf7ebedb,0xbeaebf7abf333e6d3f723f47bdf4bf67,0x3f043f7c3e3fbf5abf4b3e923f7f3edb,0xbf5b3e353f7c3f06bf1cbf75bd9d3f67,0x3f3dbf0abf6c3e6d3f7f3dd5bf77bedb,0x3f2d3f57bec8bf793d843f7f3e8abf67
.octa 0xbf4ebf123f563f06bf5ebef43f643edb,0x3f18bf52bf0c3f5a3f00bf61bee83f67,0xbed93f7abc17bf793ee23f47bf49bedb,0xbf68be5a3f80be6dbf663f213f1ebf67,0x3f79be35bf543f5a3e07bf753f273edb,0xbe763f7cbf10bf063f7ebe92bf423f67,0x3d3cbf573f6dbe6dbf293f7fbefbbedb,0x3f80bf0abec03f79bf40bdd53f5fbf67
.octa 0xbf7d3f52be51bf063f77bf613e9f3edb,0xbe19bf123f7bbf5a3e843ef4bf733f67,0x3eae3e5abf333f79bf723f21bdf4bedb,0xbf713f7abf373e6d3ea5bf473f7ebf67,0x3f5bbf7c3f7cbf5a3f1cbe92bd9d3edb,0x3f04be35be3f3f06bf4b3f75bf7f3f67,0xbf2d3f0abec83e6dbd84bdd53e8abedb,0x3f3dbf573f6cbf793f7fbf7f3f77bf67
.octa 0x3f413f3d3f383f333f2e3f283f233f1d,0x3f283f2d3f323f373f3c3f413f453f4a,0x3f1d3ed83e57bc49be70bee3bf22bf4a,0x3f4a3f683f7a3f803f793f653f463f1d,0x3ee53d30bebdbf37bf70bf7fbf62bf1d,0x3f653f803f6e3f333eb1bd8abef0bf4a,0x3e87beafbf53bf80bf4fbea43e933f4a,0x3f773f713f11bc49bf17bf73bf75bf1d
.octa 0x3d90bf2dbf80bf333d233f413f7f3f1d,0x3f7f3f3d3c7bbf37bf80bf283dc23f4a,0xbe00bf68bf573c493f5a3f653dcfbf4a,0x3f7e3ed8bf0bbf80bf063ee33f7f3f1d,0xbea2bf80becb3f373f68bd8abf75bf1d,0x3f733d30bf6bbf333ed73f7f3e96bf4a,0xbefebf713e383f803e20bf73bef33f4a,0x3f5ebeafbf7c3c493f7d3ea4bf61bf1d
.octa 0xbf28bf3d3f323f33bf3cbf283f453f1d,0x3f41bf2dbf383f373f2ebf41bf233f4a,0xbf4abed83f7abc49bf793ee33f46bf4a,0x3f1dbf68be573f80be70bf653f223f1d,0xbf65bd303f6ebf37beb13f7fbef0bf1d,0x3ee5bf803ebd3f33bf703d8a3f62bf4a,0xbf773eaf3f11bf803f173ea4bf753f4a,0x3e87bf713f53bc49bf4f3f73be93bf1d
.octa 0xbf7f3f2d3c7bbf333f80bf413dc23f1d,0x3d90bf3d3f80bf373d233f28bf7f3f4a,0xbf7e3f68bf0b3c493f06bf653f7fbf4a,0xbe00bed83f57bf803f5abee3bdcf3f1d,0xbf733f80bf6b3f37bed73d8a3e96bf1d,0xbea2bd303ecbbf333f68bf7f3f75bf4a,0xbf5e3f71bf7c3f80bf7d3f73bf613f4a,0xbefe3eafbe383c493e20bea43ef3bf1d
.octa 0xbf7b3f7cbf7e3f7ebf7f3f80bf803f80,0x3e45be293e0dbde23da9bd623ce28000,0xbb493e66bedf3f20bf483f67bf7a3f80,0x3f80bf793f66bf483f1fbede3e638000,0x3f7bbf503f02bde2be9c3f2bbf6a3f80,0x3e4bbf153f5dbf7e3f74bf3f3ed18000,0x3ec5bf593f80bf483e8d3eaabf513f80,0xbf6c3f083d6fbf203f76bf723f148000
.octa 0xbf543e293f1abf7e3f43bd62bf303f80,0xbf0f3f7cbf4c3de23f25bf803f3a8000,0xbf363f79bea8bf203f7ebedebf083f80,0x3f343e66bf723f483de8bf673f598000,0x3f0e3f15bf783de23f64bf3fbeb73f80,0x3f55bf50be813f7ebeeabf2b3f6f8000,0x3f6dbf08bf3f3f483ef8bf72be2c3f80,0xbec2bf593f2a3f20bf60beaa3f7c8000
.octa 0xbe45bf7c3e0d3f7ebda9bf803ce23f80,0xbf7b3e293f7ebde2bf7f3d623f808000,0xbf80be663f663f20bf1fbf673e633f80,0xbb493f793edfbf48bf483ede3f7a8000,0xbe4b3f503f5dbde2bf74bf2b3ed13f80,0x3f7b3f15bf02bf7ebe9c3f3f3f6a8000,0x3f6c3f593d6fbf48bf76beaa3f143f80,0x3ec5bf08bf80bf203e8d3f723f518000
.octa 0x3f0fbe29bf4cbf7ebf253d623f3a3f80,0xbf54bf7cbf1a3de23f433f803f308000,0xbf34bf79bf72bf20bde83ede3f593f80,0xbf36be663ea83f483f7e3f673f088000,0xbf55bf15be813de23eea3f3f3f6f3f80,0x3f0e3f503f783f7e3f643f2b3eb78000,0x3ec23f083f2a3f483f603f723f7c3f80,0x3f6d3f593f3f3f203ef83eaa3e2c8000
.octa 0xbf6a3f6dbf703f72bf743f76bf783f7a,0x3ecebec13eb4bea73e99be8c3e7cbe60,0x3f7abf803f79bf663f47bf1f3edcbe60,0xbe5dbbc93e6abee13f21bf493f67bf7a,0xbf803f6cbf2f3ea73db6befa3f4dbf7a,0x3cb03ec7bf3b3f72bf7f3f60bf193e60,0x3f7cbf343e263ee1bf613f7ebf3e3e60,0x3e32bf363f7dbf663ef63deebf2b3f7a
.octa 0xbf6f3ec13ed4bf723f63be8cbf033f7a,0xbeba3f6dbf693ea73eedbf763f5cbe60,0x3f583bc9bf5a3f66bddbbf493f71be60,0x3f0abf803f073ee1bf7f3f1f3eabbf7a,0xbf39bec73f80bea7bf443f603e13bf7a,0xbf313f6c3d0abf723f243efabf7d3e60,0x3f133f36bf50bee13f763deebf803e60,0x3f52bf34bf153f663e90bf7e3d563f7a
.octa 0xbecebf6d3eb43f72be99bf763e7c3f7a,0xbf6a3ec13f70bea7bf743e8c3f78be60,0x3e5d3f803e6abf66bf213f1f3f67be60,0x3f7a3bc9bf79bee13f473f49bedcbf7a,0xbcb0bf6cbf3b3ea73f7f3efabf19bf7a,0xbf80bec73f2f3f723db6bf60bf4d3e60,0xbe323f343f7d3ee1bef6bf7ebf2b3e60,0x3f7c3f36be26bf66bf61bdee3f3e3f7a
.octa 0x3ebabec1bf69bf72beed3e8c3f5c3f7a,0xbf6fbf6dbed43ea73f633f763f03be60,0xbf0abbc93f073f663f7f3f493eabbe60,0x3f583f803f5a3ee1bddbbf1fbf71bf7a,0x3f313ec73d0abea7bf24bf60bf7dbf7a,0xbf39bf6cbf80bf72bf44befabe133e60,0xbf52bf36bf15bee1be90bdee3d563e60,0x3f133f343f503f663f763f7e3f803f7a
.octa 0xbf4e3f52bf563f5abf5e3f61bf643f67,0x3f18bf123f0cbf063f00bef43ee8bedb,0xbed93e5a3c17be6d3ee2bf213f49bf67,0xbf683f7abf803f79bf663f47bf1e3edb,0x3f79bf7c3f54bf063e073e92bf273f67,0xbe76be353f10bf5a3f7ebf753f42bedb,0x3d3c3f0abf6d3f79bf293dd53efbbf67,0x3f80bf573ec03e6dbf403f7fbf5f3edb
.octa 0xbf7d3f123e51bf5a3f77bef4be9f3f67,0xbe193f52bf7b3f063e84bf613f73bedb,0x3eaebf7a3f333e6dbf723f473df4bf67,0xbf713e5a3f37bf793ea53f21bf7e3edb,0x3f5b3e35bf7c3f063f1cbf753d9d3f67,0x3f04bf7c3e3f3f5abf4bbe923f7fbedb,0xbf2d3f573ec8bf79bd843f7fbe8abf67,0x3f3d3f0abf6cbe6d3f7fbdd5bf773edb
.octa 0xbf18bf523f0c3f5abf00bf613ee83f67,0xbf4e3f123f56bf06bf5e3ef43f64bedb,0x3f68be5abf80be6d3f663f21bf1ebf67,0xbed9bf7abc173f793ee2bf47bf493edb,0x3e763f7c3f10bf06bf7ebe923f423f67,0x3f793e35bf54bf5a3e073f753f27bedb,0xbf80bf0a3ec03f793f40bdd5bf5fbf67,0x3d3c3f573f6d3e6dbf29bf7fbefb3edb
.octa 0x3e19bf12bf7bbf5abe843ef43f733f67,0xbf7dbf52be513f063f773f613e9fbedb,0x3f713f7a3f373e6dbea5bf47bf7ebf67,0x3eaebe5abf33bf79bf72bf21bdf43edb,0xbf04be353e3f3f063f4b3f753f7f3f67,0x3f5b3f7c3f7c3f5a3f1c3e92bd9dbedb,0xbf3dbf57bf6cbf79bf7fbf7fbf77bf67,0xbf2dbf0abec8be6dbd843dd53e8a3edb
.octa 0xbf283f2dbf323f37bf3c3f41bf453f4a,0x3f41bf3d3f38bf333f2ebf283f23bf1d,0xbf4a3f68bf7a3f80bf793f65bf463f1d,0x3f1dbed83e573c49be703ee3bf223f4a,0xbf653f80bf6e3f33beb1bd8a3ef0bf4a,0x3ee5bd30bebd3f37bf703f7fbf623f1d,0xbf773f71bf11bc493f17bf733f75bf1d,0x3e873eafbf533f80bf4f3ea43e93bf4a
.octa 0xbf7f3f3dbc7bbf373f80bf28bdc23f4a,0x3d903f2dbf803f333d23bf413f7fbf1d,0xbf7e3ed83f0bbf803f063ee3bf7f3f1d,0xbe003f68bf57bc493f5abf653dcf3f4a,0xbf733d303f6bbf33bed73f7fbe96bf4a,0xbea23f80becbbf373f683d8abf753f1d,0xbf5ebeaf3f7c3c49bf7d3ea43f61bf1d,0xbefe3f713e38bf803e203f73bef3bf4a
.octa 0xbf41bf2d3f383f37bf2ebf413f233f4a,0xbf283f3d3f32bf33bf3c3f283f45bf1d,0xbf1dbf683e573f803e70bf65bf223f1d,0xbf4a3ed83f7a3c49bf79bee33f463f4a,0xbee5bf80bebd3f333f703d8abf62bf4a,0xbf653d303f6e3f37beb1bf7fbef03f1d,0xbe87bf71bf53bc493f4f3f733e93bf1d,0xbf77beaf3f113f803f17bea4bf75bf4a
.octa 0xbd90bf3dbf80bf37bd233f283f7f3f4a,0xbf7fbf2d3c7b3f333f803f413dc2bf1d,0x3e00bed8bf57bf80bf5abee33dcf3f1d,0xbf7ebf68bf0bbc493f063f653f7f3f4a,0x3ea2bd30becbbf33bf68bf7fbf75bf4a,0xbf73bf80bf6bbf37bed7bd8a3e963f1d,0x3efe3eaf3e383c49be20bea4bef3bf1d,0xbf5ebf71bf7cbf80bf7dbf73bf61bf4a
.octa 0xbe453e29be0d3de2bda93d62bce20000,0xbf7b3f7cbf7e3f7ebf7f3f80bf803f80,0xbf803f79bf663f48bf1f3edebe630000,0xbb493e66bedf3f20bf483f67bf7a3f80,0xbe4b3f15bf5d3f7ebf743f3fbed10000,0x3f7bbf503f02bde2be9c3f2bbf6a3f80,0x3f6cbf08bd6f3f20bf763f72bf140000,0x3ec5bf593f80bf483e8d3eaabf513f80
.octa 0x3f0fbf7c3f4cbde2bf253f80bf3a0000,0xbf543e293f1abf7e3f43bd62bf303f80,0xbf34be663f72bf48bde83f67bf590000,0xbf363f79bea8bf203f7ebedebf083f80,0xbf553f503e81bf7e3eea3f2bbf6f0000,0x3f0e3f15bf783de23f64bf3fbeb73f80,0x3ec23f59bf2abf203f603eaabf7c0000,0x3f6dbf08bf3f3f483ef8bf72be2c3f80
.octa 0x3f7bbe29bf7e3de23f7fbd62bf800000,0xbe45bf7c3e0d3f7ebda9bf803ce23f80,0x3b49bf79bedf3f483f48bedebf7a0000,0xbf80be663f663f20bf1fbf673e633f80,0xbf7bbf153f023f7e3e9cbf3fbf6a0000,0xbe4b3f503f5dbde2bf74bf2b3ed13f80,0xbec53f083f803f20be8dbf72bf510000,0x3f6c3f593d6fbf48bf76beaa3f143f80
.octa 0x3f543f7c3f1abde2bf43bf80bf300000,0x3f0fbe29bf4cbf7ebf253d623f3a3f80,0x3f363e66bea8bf48bf7ebf67bf080000,0xbf34bf79bf72bf20bde83ede3f593f80,0xbf0ebf50bf78bf7ebf64bf2bbeb70000,0xbf55bf15be813de23eea3f3f3f6f3f80,0xbf6dbf59bf3fbf20bef8beaabe2c0000,0x3ec23f083f2a3f483f603f723f7c3f80
.octa 0xbece3ec1beb43ea7be993e8cbe7c3e60,0xbf6a3f6dbf703f72bf743f76bf783f7a,0x3e5d3bc9be6a3ee1bf213f49bf673f7a,0x3f7abf803f79bf663f47bf1f3edcbe60,0xbcb0bec73f3bbf723f7fbf603f19be60,0xbf803f6cbf2f3ea73db6befa3f4dbf7a,0xbe323f36bf7d3f66bef6bdee3f2bbf7a,0x3f7cbf343e263ee1bf613f7ebf3e3e60
.octa 0x3ebabf6d3f69bea7beed3f76bf5c3e60,0xbf6f3ec13ed4bf723f63be8cbf033f7a,0xbf0a3f80bf07bee13f7fbf1fbeab3f7a,0x3f583bc9bf5a3f66bddbbf493f71be60,0x3f31bf6cbd0a3f72bf24befa3f7dbe60,0xbf39bec73f80bea7bf443f603e13bf7a,0xbf523f343f15bf66be903f7ebd56bf7a,0x3f133f36bf50bee13f763deebf803e60
.octa 0x3f6abec1bf703ea73f74be8cbf783e60,0xbecebf6d3eb43f72be99bf763e7c3f7a,0xbf7abbc93f793ee1bf47bf493edc3f7a,0x3e5d3f803e6abf66bf213f1f3f67be60,0x3f803ec7bf2fbf72bdb63f603f4dbe60,0xbcb0bf6cbf3b3ea73f7f3efabf19bf7a,0xbf7cbf363e263f663f613deebf3ebf7a,0xbe323f343f7d3ee1bef6bf7ebf2b3e60
.octa 0x3f6f3f6d3ed4bea7bf63bf76bf033e60,0x3ebabec1bf69bf72beed3e8c3f5c3f7a,0xbf58bf80bf5abee13ddb3f1f3f713f7a,0xbf0abbc93f073f663f7f3f493eabbe60,0x3f393f6c3f803f723f443efa3e13be60,0x3f313ec73d0abea7bf24bf60bf7dbf7a,0xbf13bf34bf50bf66bf76bf7ebf80bf7a,0xbf52bf36bf15bee1be90bdee3d563e60
.octa 0xbf183f12bf0c3f06bf003ef4bee83edb,0xbf4e3f52bf563f5abf5e3f61bf643f67,0x3f68bf7a3f80bf793f66bf473f1ebedb,0xbed93e5a3c17be6d3ee2bf213f49bf67,0x3e763e35bf103f5abf7e3f75bf423edb,0x3f79bf7c3f54bf063e073e92bf273f67,0xbf803f57bec0be6d3f40bf7f3f5fbedb,0x3d3c3f0abf6d3f79bf293dd53efbbf67
.octa 0x3e19bf523f7bbf06be843f61bf733edb,0xbf7d3f123e51bf5a3f77bef4be9f3f67,0x3f71be5abf373f79bea5bf213f7ebedb,0x3eaebf7a3f333e6dbf723f473df4bf67,0xbf043f7cbe3fbf5a3f4b3e92bf7f3edb,0x3f5b3e35bf7c3f063f1cbf753d9d3f67,0xbf3dbf0a3f6c3e6dbf7f3dd53f77bedb,0xbf2d3f573ec8bf79bd843f7fbe8abf67
.octa 0x3f4ebf12bf563f063f5ebef4bf643edb,0xbf18bf523f0c3f5abf00bf613ee83f67,0x3ed93f7a3c17bf79bee23f473f49bedb,0x3f68be5abf80be6d3f663f21bf1ebf67,0xbf79be353f543f5abe07bf75bf273edb,0x3e763f7c3f10bf06bf7ebe923f423f67,0xbd3cbf57bf6dbe6d3f293f7f3efbbedb,0xbf80bf0a3ec03f793f40bdd5bf5fbf67
.octa 0x3f7d3f523e51bf06bf77bf61be9f3edb,0x3e19bf12bf7bbf5abe843ef43f733f67,0xbeae3e5a3f333f793f723f213df4bedb,0x3f713f7a3f373e6dbea5bf47bf7ebf67,0xbf5bbf7cbf7cbf5abf1cbe923d9d3edb,0xbf04be353e3f3f063f4b3f753f7f3f67,0x3f2d3f0a3ec83e6d3d84bdd5be8abedb,0xbf3dbf57bf6cbf79bf7fbf7fbf77bf67
.octa 0xbf413f3dbf383f33bf2e3f28bf233f1d,0xbf283f2dbf323f37bf3c3f41bf453f4a,0xbf1d3ed8be57bc493e70bee33f22bf4a,0xbf4a3f68bf7a3f80bf793f65bf463f1d,0xbee53d303ebdbf373f70bf7f3f62bf1d,0xbf653f80bf6e3f33beb1bd8a3ef0bf4a,0xbe87beaf3f53bf803f4fbea4be933f4a,0xbf773f71bf11bc493f17bf733f75bf1d
.octa 0xbd90bf2d3f80bf33bd233f41bf7f3f1d,0xbf7f3f3dbc7bbf373f80bf28bdc23f4a,0x3e00bf683f573c49bf5a3f65bdcfbf4a,0xbf7e3ed83f0bbf803f063ee3bf7f3f1d,0x3ea2bf803ecb3f37bf68bd8a3f75bf1d,0xbf733d303f6bbf33bed73f7fbe96bf4a,0x3efebf71be383f80be20bf733ef33f4a,0xbf5ebeaf3f7c3c49bf7d3ea43f61bf1d
.octa 0x3f28bf3dbf323f333f3cbf28bf453f1d,0xbf41bf2d3f383f37bf2ebf413f233f4a,0x3f4abed8bf7abc493f793ee3bf46bf4a,0xbf1dbf683e573f803e70bf65bf223f1d,0x3f65bd30bf6ebf373eb13f7f3ef0bf1d,0xbee5bf80bebd3f333f703d8abf62bf4a,0x3f773eafbf11bf80bf173ea43f753f4a,0xbe87bf71bf53bc493f4f3f733e93bf1d
.octa 0x3f7f3f2dbc7bbf33bf80bf41bdc23f1d,0xbd90bf3dbf80bf37bd233f283f7f3f4a,0x3f7e3f683f0b3c49bf06bf65bf7fbf4a,0x3e00bed8bf57bf80bf5abee33dcf3f1d,0x3f733f803f6b3f373ed73d8abe96bf1d,0x3ea2bd30becbbf33bf68bf7fbf75bf4a,0x3f5e3f713f7c3f803f7d3f733f613f4a,0x3efe3eaf3e383c49be20bea4bef3bf1d
.octa 0x3f7a3f7c3f7d3f7e3f7f3f803f803f80,0xbe5abe3bbe1cbdfbbdbcbd7bbcfb8000,0xbc973e543ed83f1d3f473f663f793f80,0xbf80bf7abf68bf4abf21bee1be668000,0xbf7cbf53bf05bdfb3e983f2a3f693f80,0xbe35bf11bf5bbf7ebf75bf40bed28000,0xbebbbf57bf80bf4abe923ea73f503f80,0x3f6e3f0cbd30bf1dbf75bf72bf158000
.octa 0x3f573e3bbf17bf7ebf45bd7b3f2f3f80,0x3f0a3f7c3f4f3dfbbf24bf80bf3a8000,0x3f323f7a3eafbf1dbf7fbee13f083f80,0xbf383e543f713f4abdd5bf66bf598000,0xbf123f113f793dfbbf63bf403eb53f80,0xbf52bf533e733f7e3eefbf2abf6f8000,0xbf6bbf0c3f3d3f4abef4bf723e293f80,0x3ecdbf57bf2d3f1d3f61bea7bf7c8000
.octa 0x3e5abf7cbe1c3f7e3dbcbf80bcfb3f80,0x3f7a3e3bbf7dbdfb3f7f3d7bbf808000,0x3f80be54bf683f1d3f21bf66be663f80,0xbc973f7abed8bf4a3f473ee1bf798000,0x3e353f53bf5bbdfb3f75bf2abed23f80,0xbf7c3f113f05bf7e3e983f40bf698000,0xbf6e3f57bd30bf4a3f75bea7bf153f80,0xbebbbf0c3f80bf1dbe923f72bf508000
.octa 0xbf0abe3b3f4fbf7e3f243d7bbf3a3f80,0x3f57bf7c3f173dfbbf453f80bf2f8000,0x3f38bf7a3f71bf1d3dd53ee1bf593f80,0x3f32be54beaf3f4abf7f3f66bf088000,0x3f52bf113e733dfbbeef3f40bf6f3f80,0xbf123f53bf793f7ebf633f2abeb58000,0xbecd3f0cbf2d3f4abf613f72bf7c3f80,0xbf6b3f57bf3d3f1dbef43ea7be298000
.octa 0x3f653f693f6c3f6f3f723f743f763f78,0xbee3bed5bec7beb8beaabe9bbe8cbe79,0xbf77bf80bf7bbf6abf4dbf25bee9be79,0x3e863d17be42becfbf1abf44bf64bf78,0x3f7f3f703f363eb8bd62beecbf49bf78,0xbd8a3eb23f343f6f3f803f633f1f3e79,0xbf7ebf3cbe4e3ecf3f5c3f7f3f433e79,0xbe04bf2ebf7bbf6abf023db03f263f78
.octa 0x3f733ed5bec1bf6fbf67be9b3efa3f78,0x3ea43f693f6d3eb8bedebf74bf60be79,0xbf5ebd173f543f6a3e10bf44bf74be79,0xbeffbf80bf103ecf3f7d3f25be9ebf78,0x3f41beb2bf80beb83f3f3f63bdeebf78,0x3f283f703bc9bf6fbf2b3eec3f7e3e79,0xbf1c3f2e3f56becfbf783db03f7f3e79,0xbf4bbf3c3f0d3f6abe7fbf7fbda33f78
.octa 0x3ee3bf69bec73f6f3eaabf74be8c3f78,0x3f653ed5bf6cbeb83f723e9bbf76be79,0xbe863f80be42bf6a3f1a3f25bf64be79,0xbf77bd173f7bbecfbf4d3f443ee9bf78,0x3d8abf703f343eb8bf803eec3f1fbf78,0x3f7fbeb2bf363f6fbd62bf633f493e79,0x3e043f3cbf7b3ecf3f02bf7f3f263e79,0xbf7e3f2e3e4ebf6a3f5cbdb0bf433f78
.octa 0xbea4bed53f6dbf6f3ede3e9bbf603f78,0x3f73bf693ec13eb8bf673f74befabe79,0x3eff3d17bf103f6abf7d3f44be9ebe79,0xbf5e3f80bf543ecf3e10bf253f74bf78,0xbf283eb23bc9beb83f2bbf633f7ebf78,0x3f41bf703f80bf6f3f3fbeec3dee3e79,0x3f4bbf2e3f0dbecf3e7fbdb0bda33e79,0xbf1c3f3cbf563f6abf783f7fbf7f3f78
.octa 0x3f433f483f4d3f513f563f5a3f5e3f62,0xbf26bf20bf1abf13bf0dbf06beffbef1,0x3efa3e8f3d62be2fbec7bf16bf41bf62,0x3f603f763f803f7c3f6c3f4f3f283ef1,0xbf74bf7ebf5cbf13be423e6d3f1c3f62,0x3e9ebde2bf02bf51bf7bbf79bf4bbef1,0xbdee3ef73f673f7c3f343e23bee3bf62,0xbf7ebf60bede3e2f3f363f7d3f653ef1
.octa 0x3f7f3f20be10bf51bf7bbf063e863f62,0x3da33f483f7d3f13be4ebf5abf77bef1,0xbe8cbf76bf3f3e2f3f6d3f4fbd8abf62,0x3f763e8fbf2bbf7cbec13f163f7f3ef1,0xbf643de23f783f13bf10bf79be043f62,0xbee9bf7ebe7f3f513f54be6dbf7ebef1,0x3f1f3f60beaabf7c3bc93f7d3ea4bf62,0xbf493ef73f72be2fbf80be233f733ef1
.octa 0x3f26bf48bf1a3f513f0dbf5abeff3f62,0x3f433f20bf4dbf133f563f06bf5ebef1,0xbf60be8f3f80be2fbf6c3f163f28bf62,0x3efabf76bd623f7cbec7bf4f3f413ef1,0xbe9e3f7ebf02bf133f7bbe6dbf4b3f62,0xbf743de23f5cbf51be423f79bf1cbef1,0x3f7ebef7bede3f7cbf36be233f65bf62,0xbdee3f60bf673e2f3f34bf7d3ee33ef1
.octa 0xbda3bf203f7dbf513e4e3f06bf773f62,0x3f7fbf483e103f13bf7b3f5abe86bef1,0xbf763f76bf2b3e2f3ec1bf4f3f7fbf62,0xbe8cbe8f3f3fbf7c3f6dbf163d8a3ef1,0x3ee9bde2be7f3f13bf543f79bf7e3f62,0xbf643f7ebf783f51bf103e6d3e04bef1,0x3f49bf603f72bf7c3f80bf7d3f73bf62,0x3f1fbef73eaabe2f3bc93e23bea43ef1
.octa 0x3f153f1b3f213f273f2d3f333f383f3e,0xbf50bf4cbf47bf42bf3dbf37bf32bf2c,0x3f3a3f5d3f753f7f3f7d3f6e3f523f2c,0xbf2fbf01be98bd973e1c3ebe3f123f3e,0x3f593f7e3f753f423ed83c49becdbf3e,0xbf08be0a3e923f273f683f803f6b3f2c,0x3f6f3f783f243d97bf05bf6bbf7abf2c,0xbeb53e823f453f7f3f5b3ecabe5abf3e
.octa 0x3f7c3f4c3dd5bf27bf80bf373c973f3e,0xbe293f1b3f7f3f423d30bf33bf80bf2c,0x3f803f01beefbf7fbf173ebe3f7c3f2c,0x3cfb3f5d3f633d97bf4fbf6ebe353f3e,0x3f793e0abf61bf423eaf3f803ebbbf3e,0x3e663f7e3ef4bf27bf71bc493f6e3f2c,0x3f69be82bf7fbd973f793ecabf57bf2c,0x3ed23f78bdbcbf7fbe733f6b3f0abf3e
.octa 0x3f50bf1bbf473f273f3dbf33bf323f3e,0x3f153f4cbf21bf423f2d3f37bf38bf2c,0x3f2fbf5dbe983f7fbe1cbf6e3f123f2c,0x3f3a3f01bf75bd973f7dbebebf523f3e,0x3f08bf7e3e923f42bf68bc493f6bbf3e,0x3f593e0abf753f273ed8bf803ecd3f2c,0x3eb5bf783f453d97bf5b3f6bbe5abf2c,0x3f6fbe82bf243f7fbf05beca3f7abf3e
.octa 0x3e29bf4c3f7fbf27bd303f37bf803f3e,0x3f7cbf1bbdd53f42bf803f33bc97bf2c,0xbcfbbf013f63bf7f3f4fbebebe353f2c,0x3f80bf5d3eef3d97bf173f6ebf7c3f3e,0xbe66be0a3ef4bf423f71bf803f6ebf3e,0x3f79bf7e3f61bf273eaf3c49bebb3f2c,0xbed23e82bdbcbd973e73beca3f0abf2c,0x3f69bf783f7fbf7f3f79bf6b3f57bf3e
.octa 0x3e5a3e3b3e1c3dfb3dbc3d7b3cfb0000,0x3f7a3f7c3f7d3f7e3f7f3f803f803f80,0x3f803f7a3f683f4a3f213ee13e660000,0xbc973e543ed83f1d3f473f663f793f80,0x3e353f113f5b3f7e3f753f403ed20000,0xbf7cbf53bf05bdfb3e983f2a3f693f80,0xbf6ebf0c3d303f1d3f753f723f150000,0xbebbbf57bf80bf4abe923ea73f503f80
.octa 0xbf0abf7cbf4fbdfb3f243f803f3a0000,0x3f573e3bbf17bf7ebf45bd7b3f2f3f80,0x3f38be54bf71bf4a3dd53f663f590000,0x3f323f7a3eafbf1dbf7fbee13f083f80,0x3f523f53be73bf7ebeef3f2a3f6f0000,0xbf123f113f793dfbbf63bf403eb53f80,0xbecd3f573f2dbf1dbf613ea73f7c0000,0xbf6bbf0c3f3d3f4abef4bf723e293f80
.octa 0xbf7abe3b3f7d3dfbbf7fbd7b3f800000,0x3e5abf7cbe1c3f7e3dbcbf80bcfb3f80,0x3c97bf7a3ed83f4abf47bee13f790000,0x3f80be54bf683f1d3f21bf66be663f80,0x3f7cbf11bf053f7ebe98bf403f690000,0x3e353f53bf5bbdfb3f75bf2abed23f80,0x3ebb3f0cbf803f1d3e92bf723f500000,0xbf6e3f57bd30bf4a3f75bea7bf153f80
.octa 0xbf573f7cbf17bdfb3f45bf803f2f0000,0xbf0abe3b3f4fbf7e3f243d7bbf3a3f80,0xbf323e543eafbf4a3f7fbf663f080000,0x3f38bf7a3f71bf1d3dd53ee1bf593f80,0x3f12bf533f79bf7e3f63bf2a3eb50000,0x3f52bf113e733dfbbeef3f40bf6f3f80,0x3f6bbf573f3dbf1d3ef4bea73e290000,0xbecd3f0cbf2d3f4abf613f72bf7c3f80
.octa 0x3ee33ed53ec73eb83eaa3e9b3e8c3e79,0x3f653f693f6c3f6f3f723f743f763f78,0xbe86bd173e423ecf3f1a3f443f643f78,0xbf77bf80bf7bbf6abf4dbf25bee9be79,0x3d8abeb2bf34bf6fbf80bf63bf1fbe79,0x3f7f3f703f363eb8bd62beecbf49bf78,0x3e043f2e3f7b3f6a3f02bdb0bf26bf78,0xbf7ebf3cbe4e3ecf3f5c3f7f3f433e79
.octa 0xbea4bf69bf6dbeb83ede3f743f603e79,0x3f733ed5bec1bf6fbf67be9b3efa3f78,0x3eff3f803f10becfbf7dbf253e9e3f78,0xbf5ebd173f543f6a3e10bf44bf74be79,0xbf28bf70bbc93f6f3f2bbeecbf7ebe79,0x3f41beb2bf80beb83f3f3f63bdeebf78,0x3f4b3f3cbf0dbf6a3e7f3f7f3da3bf78,0xbf1c3f2e3f56becfbf783db03f7f3e79
.octa 0xbf65bed53f6c3eb8bf72be9b3f763e79,0x3ee3bf69bec73f6f3eaabf74be8c3f78,0x3f773d17bf7b3ecf3f4dbf44bee93f78,0xbe863f80be42bf6a3f1a3f25bf64be79,0xbf7f3eb23f36bf6f3d623f63bf49be79,0x3d8abf703f343eb8bf803eec3f1fbf78,0x3f7ebf2ebe4e3f6abf5c3db03f43bf78,0x3e043f3cbf7b3ecf3f02bf7f3f263e79
.octa 0xbf733f69bec1beb83f67bf743efa3e79,0xbea4bed53f6dbf6f3ede3e9bbf603f78,0x3f5ebf803f54becfbe103f25bf743f78,0x3eff3d17bf103f6abf7d3f44be9ebe79,0xbf413f70bf803f6fbf3f3eecbdeebe79,0xbf283eb23bc9beb83f2bbf633f7ebf78,0x3f1cbf3c3f56bf6a3f78bf7f3f7fbf78,0x3f4bbf2e3f0dbecf3e7fbdb0bda33e79
.octa 0x3f263f203f1a3f133f0d3f063eff3ef1,0x3f433f483f4d3f513f563f5a3f5e3f62,0xbf60bf76bf80bf7cbf6cbf4fbf28bef1,0x3efa3e8f3d62be2fbec7bf16bf41bf62,0xbe9e3de23f023f513f7b3f793f4b3ef1,0xbf74bf7ebf5cbf13be423e6d3f1c3f62,0x3f7e3f603edebe2fbf36bf7dbf65bef1,0xbdee3ef73f673f7c3f343e23bee3bf62
.octa 0xbda3bf48bf7dbf133e4e3f5a3f773ef1,0x3f7f3f20be10bf51bf7bbf063e863f62,0xbf76be8f3f2b3f7c3ec1bf16bf7fbef1,0xbe8cbf76bf3f3e2f3f6d3f4fbd8abf62,0x3ee93f7e3e7fbf51bf543e6d3f7e3ef1,0xbf643de23f783f13bf10bf79be043f62,0x3f49bef7bf723e2f3f803e23bf73bef1,0x3f1f3f60beaabf7c3bc93f7d3ea4bf62
.octa 0xbf43bf203f4d3f13bf56bf063f5e3ef1,0x3f26bf48bf1a3f513f0dbf5abeff3f62,0xbefa3f763d62bf7c3ec73f4fbf41bef1,0xbf60be8f3f80be2fbf6c3f163f28bf62,0x3f74bde2bf5c3f513e42bf793f1c3ef1,0xbe9e3f7ebf02bf133f7bbe6dbf4b3f62,0x3deebf603f67be2fbf343f7dbee3bef1,0x3f7ebef7bede3f7cbf36be233f65bf62
.octa 0xbf7f3f48be10bf133f7bbf5a3e863ef1,0xbda3bf203f7dbf513e4e3f06bf773f62,0x3e8c3e8fbf3f3f7cbf6d3f16bd8abef1,0xbf763f76bf2b3e2f3ec1bf4f3f7fbf62,0x3f64bf7e3f78bf513f10be6dbe043ef1,0x3ee9bde2be7f3f13bf543f79bf7e3f62,0xbf1f3ef7beaa3e2fbbc9be233ea4bef1,0x3f49bf603f72bf7c3f80bf7d3f73bf62
.octa 0x3f503f4c3f473f423f3d3f373f323f2c,0x3f153f1b3f213f273f2d3f333f383f3e,0x3f2f3f013e983d97be1cbebebf12bf3e,0x3f3a3f5d3f753f7f3f7d3f6e3f523f2c,0x3f083e0abe92bf27bf68bf80bf6bbf2c,0x3f593f7e3f753f423ed83c49becdbf3e,0x3eb5be82bf45bf7fbf5bbeca3e5a3f3e,0x3f6f3f783f243d97bf05bf6bbf7abf2c
.octa 0x3e29bf1bbf7fbf42bd303f333f803f2c,0x3f7c3f4c3dd5bf27bf80bf373c973f3e,0xbcfbbf5dbf63bd973f4f3f6e3e35bf3e,0x3f803f01beefbf7fbf173ebe3f7c3f2c,0xbe66bf7ebef43f273f713c49bf6ebf2c,0x3f793e0abf61bf423eaf3f803ebbbf3e,0xbed2bf783dbc3f7f3e73bf6bbf0a3f3e,0x3f69be82bf7fbd973f793ecabf57bf2c
.octa 0xbf15bf4c3f213f42bf2dbf373f383f2c,0x3f50bf1bbf473f273f3dbf33bf323f3e,0xbf3abf013f753d97bf7d3ebe3f52bf3e,0x3f2fbf5dbe983f7fbe1cbf6e3f123f2c,0xbf59be0a3f75bf27bed83f80becdbf2c,0x3f08bf7e3e923f42bf68bc493f6bbf3e,0xbf6f3e823f24bf7f3f053ecabf7a3f3e,0x3eb5bf783f453d97bf5b3f6bbe5abf2c
.octa 0xbf7c3f1b3dd5bf423f80bf333c973f2c,0x3e29bf4c3f7fbf27bd303f37bf803f3e,0xbf803f5dbeefbd973f17bf6e3f7cbf3e,0xbcfbbf013f63bf7f3f4fbebebe353f2c,0xbf793f7ebf613f27beafbc493ebbbf2c,0xbe66be0a3ef4bf423f71bf803f6ebf3e,0xbf693f78bf7f3f7fbf793f6bbf573f3e,0xbed23e82bdbcbd973e73beca3f0abf2c
.octa 0xbf7a3f7cbf7d3f7ebf7f3f80bf803f80,0x3e5abe3b3e1cbdfb3dbcbd7b3cfb8000,0x3c973e54bed83f1dbf473f66bf793f80,0x3f80bf7a3f68bf4a3f21bee13e668000,0x3f7cbf533f05bdfbbe983f2abf693f80,0x3e35bf113f5bbf7e3f75bf403ed28000,0x3ebbbf573f80bf4a3e923ea7bf503f80,0xbf6e3f0c3d30bf1d3f75bf723f158000
.octa 0xbf573e3b3f17bf7e3f45bd7bbf2f3f80,0xbf0a3f7cbf4f3dfb3f24bf803f3a8000,0xbf323f7abeafbf1d3f7fbee1bf083f80,0x3f383e54bf713f4a3dd5bf663f598000,0x3f123f11bf793dfb3f63bf40beb53f80,0x3f52bf53be733f7ebeefbf2a3f6f8000,0x3f6bbf0cbf3d3f4a3ef4bf72be293f80,0xbecdbf573f2d3f1dbf61bea73f7c8000
.octa 0xbe5abf7c3e1c3f7ebdbcbf803cfb3f80,0xbf7a3e3b3f7dbdfbbf7f3d7b3f808000,0xbf80be543f683f1dbf21bf663e663f80,0x3c973f7a3ed8bf4abf473ee13f798000,0xbe353f533f5bbdfbbf75bf2a3ed23f80,0x3f7c3f11bf05bf7ebe983f403f698000,0x3f6e3f573d30bf4abf75bea73f153f80,0x3ebbbf0cbf80bf1d3e923f723f508000
.octa 0x3f0abe3bbf4fbf7ebf243d7b3f3a3f80,0xbf57bf7cbf173dfb3f453f803f2f8000,0xbf38bf7abf71bf1dbdd53ee13f593f80,0xbf32be543eaf3f4a3f7f3f663f088000,0xbf52bf11be733dfb3eef3f403f6f3f80,0x3f123f533f793f7e3f633f2a3eb58000,0x3ecd3f0c3f2d3f4a3f613f723f7c3f80,0x3f6b3f573f3d3f1d3ef43ea73e298000
.octa 0xbf653f69bf6c3f6fbf723f74bf763f78,0x3ee3bed53ec7beb83eaabe9b3e8cbe79,0x3f77bf803f7bbf6a3f4dbf253ee9be79,0xbe863d173e42becf3f1abf443f64bf78,0xbf7f3f70bf363eb83d62beec3f49bf78,0x3d8a3eb2bf343f6fbf803f63bf1f3e79,0x3f7ebf3c3e4e3ecfbf5c3f7fbf433e79,0x3e04bf2e3f7bbf6a3f023db0bf263f78
.octa 0xbf733ed53ec1bf6f3f67be9bbefa3f78,0xbea43f69bf6d3eb83edebf743f60be79,0x3f5ebd17bf543f6abe10bf443f74be79,0x3effbf803f103ecfbf7d3f253e9ebf78,0xbf41beb23f80beb8bf3f3f633deebf78,0xbf283f70bbc9bf6f3f2b3eecbf7e3e79,0x3f1c3f2ebf56becf3f783db0bf7f3e79,0x3f4bbf3cbf0d3f6a3e7fbf7f3da33f78
.octa 0xbee3bf693ec73f6fbeaabf743e8c3f78,0xbf653ed53f6cbeb8bf723e9b3f76be79,0x3e863f803e42bf6abf1a3f253f64be79,0x3f77bd17bf7bbecf3f4d3f44bee9bf78,0xbd8abf70bf343eb83f803eecbf1fbf78,0xbf7fbeb23f363f6f3d62bf63bf493e79,0xbe043f3c3f7b3ecfbf02bf7fbf263e79,0x3f7e3f2ebe4ebf6abf5cbdb03f433f78
.octa 0x3ea4bed5bf6dbf6fbede3e9b3f603f78,0xbf73bf69bec13eb83f673f743efabe79,0xbeff3d173f103f6a3f7d3f443e9ebe79,0x3f5e3f803f543ecfbe10bf25bf74bf78,0x3f283eb2bbc9beb8bf2bbf63bf7ebf78,0xbf41bf70bf80bf6fbf3fbeecbdee3e79,0xbf4bbf2ebf0dbecfbe7fbdb03da33e79,0x3f1c3f3c3f563f6a3f783f7f3f7f3f78
.octa 0xbf433f48bf4d3f51bf563f5abf5e3f62,0x3f26bf203f1abf133f0dbf063effbef1,0xbefa3e8fbd62be2f3ec7bf163f41bf62,0xbf603f76bf803f7cbf6c3f4fbf283ef1,0x3f74bf7e3f5cbf133e423e6dbf1c3f62,0xbe9ebde23f02bf513f7bbf793f4bbef1,0x3dee3ef7bf673f7cbf343e233ee3bf62,0x3f7ebf603ede3e2fbf363f7dbf653ef1
.octa 0xbf7f3f203e10bf513f7bbf06be863f62,0xbda33f48bf7d3f133e4ebf5a3f77bef1,0x3e8cbf763f3f3e2fbf6d3f4f3d8abf62,0xbf763e8f3f2bbf7c3ec13f16bf7f3ef1,0x3f643de2bf783f133f10bf793e043f62,0x3ee9bf7e3e7f3f51bf54be6d3f7ebef1,0xbf1f3f603eaabf7cbbc93f7dbea4bf62,0x3f493ef7bf72be2f3f80be23bf733ef1
.octa 0xbf26bf483f1a3f51bf0dbf5a3eff3f62,0xbf433f203f4dbf13bf563f063f5ebef1,0x3f60be8fbf80be2f3f6c3f16bf28bf62,0xbefabf763d623f7c3ec7bf4fbf413ef1,0x3e9e3f7e3f02bf13bf7bbe6d3f4b3f62,0x3f743de2bf5cbf513e423f793f1cbef1,0xbf7ebef73ede3f7c3f36be23bf65bf62,0x3dee3f603f673e2fbf34bf7dbee33ef1
.octa 0x3da3bf20bf7dbf51be4e3f063f773f62,0xbf7fbf48be103f133f7b3f5a3e86bef1,0x3f763f763f2b3e2fbec1bf4fbf7fbf62,0x3e8cbe8fbf3fbf7cbf6dbf16bd8a3ef1,0xbee9bde23e7f3f133f543f793f7e3f62,0x3f643f7e3f783f513f103e6dbe04bef1,0xbf49bf60bf72bf7cbf80bf7dbf73bf62,0xbf1fbef7beaabe2fbbc93e233ea43ef1
.octa 0xbf153f1bbf213f27bf2d3f33bf383f3e,0x3f50bf4c3f47bf423f3dbf373f32bf2c,0xbf3a3f5dbf753f7fbf7d3f6ebf523f2c,0x3f2fbf013e98bd97be1c3ebebf123f3e,0xbf593f7ebf753f42bed83c493ecdbf3e,0x3f08be0abe923f27bf683f80bf6b3f2c,0xbf6f3f78bf243d973f05bf6b3f7abf2c,0x3eb53e82bf453f7fbf5b3eca3e5abf3e
.octa 0xbf7c3f4cbdd5bf273f80bf37bc973f3e,0x3e293f1bbf7f3f42bd30bf333f80bf2c,0xbf803f013eefbf7f3f173ebebf7c3f2c,0xbcfb3f5dbf633d973f4fbf6e3e353f3e,0xbf793e0a3f61bf42beaf3f80bebbbf3e,0xbe663f7ebef4bf273f71bc49bf6e3f2c,0xbf69be823f7fbd97bf793eca3f57bf2c,0xbed23f783dbcbf7f3e733f6bbf0abf3e
.octa 0xbf50bf1b3f473f27bf3dbf333f323f3e,0xbf153f4c3f21bf42bf2d3f373f38bf2c,0xbf2fbf5d3e983f7f3e1cbf6ebf123f2c,0xbf3a3f013f75bd97bf7dbebe3f523f3e,0xbf08bf7ebe923f423f68bc49bf6bbf3e,0xbf593e0a3f753f27bed8bf80becd3f2c,0xbeb5bf78bf453d973f5b3f6b3e5abf2c,0xbf6fbe823f243f7f3f05becabf7abf3e
.octa 0xbe29bf4cbf7fbf273d303f373f803f3e,0xbf7cbf1b3dd53f423f803f333c97bf2c,0x3cfbbf01bf63bf7fbf4fbebe3e353f2c,0xbf80bf5dbeef3d973f173f6e3f7c3f3e,0x3e66be0abef4bf42bf71bf80bf6ebf3e,0xbf79bf7ebf61bf27beaf3c493ebb3f2c,0x3ed23e823dbcbd97be73becabf0abf2c,0xbf69bf78bf7fbf7fbf79bf6bbf57bf3e
.octa 0xbe5a3e3bbe1c3dfbbdbc3d7bbcfb0000,0xbf7a3f7cbf7d3f7ebf7f3f80bf803f80,0xbf803f7abf683f4abf213ee1be660000,0x3c973e54bed83f1dbf473f66bf793f80,0xbe353f11bf5b3f7ebf753f40bed20000,0x3f7cbf533f05bdfbbe983f2abf693f80,0x3f6ebf0cbd303f1dbf753f72bf150000,0x3ebbbf573f80bf4a3e923ea7bf503f80
.octa 0x3f0abf7c3f4fbdfbbf243f80bf3a0000,0xbf573e3b3f17bf7e3f45bd7bbf2f3f80,0xbf38be543f71bf4abdd53f66bf590000,0xbf323f7abeafbf1d3f7fbee1bf083f80,0xbf523f533e73bf7e3eef3f2abf6f0000,0x3f123f11bf793dfb3f63bf40beb53f80,0x3ecd3f57bf2dbf1d3f613ea7bf7c0000,0x3f6bbf0cbf3d3f4a3ef4bf72be293f80
.octa 0x3f7abe3bbf7d3dfb3f7fbd7bbf800000,0xbe5abf7c3e1c3f7ebdbcbf803cfb3f80,0xbc97bf7abed83f4a3f47bee1bf790000,0xbf80be543f683f1dbf21bf663e663f80,0xbf7cbf113f053f7e3e98bf40bf690000,0xbe353f533f5bbdfbbf75bf2a3ed23f80,0xbebb3f0c3f803f1dbe92bf72bf500000,0x3f6e3f573d30bf4abf75bea73f153f80
.octa 0x3f573f7c3f17bdfbbf45bf80bf2f0000,0x3f0abe3bbf4fbf7ebf243d7b3f3a3f80,0x3f323e54beafbf4abf7fbf66bf080000,0xbf38bf7abf71bf1dbdd53ee13f593f80,0xbf12bf53bf79bf7ebf63bf2abeb50000,0xbf52bf11be733dfb3eef3f403f6f3f80,0xbf6bbf57bf3dbf1dbef4bea7be290000,0x3ecd3f0c3f2d3f4a3f613f723f7c3f80
.octa 0xbee33ed5bec73eb8beaa3e9bbe8c3e79,0xbf653f69bf6c3f6fbf723f74bf763f78,0x3e86bd17be423ecfbf1a3f44bf643f78,0x3f77bf803f7bbf6a3f4dbf253ee9be79,0xbd8abeb23f34bf6f3f80bf633f1fbe79,0xbf7f3f70bf363eb83d62beec3f49bf78,0xbe043f2ebf7b3f6abf02bdb03f26bf78,0x3f7ebf3c3e4e3ecfbf5c3f7fbf433e79
.octa 0x3ea4bf693f6dbeb8bede3f74bf603e79,0xbf733ed53ec1bf6f3f67be9bbefa3f78,0xbeff3f80bf10becf3f7dbf25be9e3f78,0x3f5ebd17bf543f6abe10bf443f74be79,0x3f28bf703bc93f6fbf2bbeec3f7ebe79,0xbf41beb23f80beb8bf3f3f633deebf78,0xbf4b3f3c3f0dbf6abe7f3f7fbda3bf78,0x3f1c3f2ebf56becf3f783db0bf7f3e79
.octa 0x3f65bed5bf6c3eb83f72be9bbf763e79,0xbee3bf693ec73f6fbeaabf743e8c3f78,0xbf773d173f7b3ecfbf4dbf443ee93f78,0x3e863f803e42bf6abf1a3f253f64be79,0x3f7f3eb2bf36bf6fbd623f633f49be79,0xbd8abf70bf343eb83f803eecbf1fbf78,0xbf7ebf2e3e4e3f6a3f5c3db0bf43bf78,0xbe043f3c3f7b3ecfbf02bf7fbf263e79
.octa 0x3f733f693ec1beb8bf67bf74befa3e79,0x3ea4bed5bf6dbf6fbede3e9b3f603f78,0xbf5ebf80bf54becf3e103f253f743f78,0xbeff3d173f103f6a3f7d3f443e9ebe79,0x3f413f703f803f6f3f3f3eec3deebe79,0x3f283eb2bbc9beb8bf2bbf63bf7ebf78,0xbf1cbf3cbf56bf6abf78bf7fbf7fbf78,0xbf4bbf2ebf0dbecfbe7fbdb03da33e79
.octa 0xbf263f20bf1a3f13bf0d3f06beff3ef1,0xbf433f48bf4d3f51bf563f5abf5e3f62,0x3f60bf763f80bf7c3f6cbf4f3f28bef1,0xbefa3e8fbd62be2f3ec7bf163f41bf62,0x3e9e3de2bf023f51bf7b3f79bf4b3ef1,0x3f74bf7e3f5cbf133e423e6dbf1c3f62,0xbf7e3f60bedebe2f3f36bf7d3f65bef1,0x3dee3ef7bf673f7cbf343e233ee3bf62
.octa 0x3da3bf483f7dbf13be4e3f5abf773ef1,0xbf7f3f203e10bf513f7bbf06be863f62,0x3f76be8fbf2b3f7cbec1bf163f7fbef1,0x3e8cbf763f3f3e2fbf6d3f4f3d8abf62,0xbee93f7ebe7fbf513f543e6dbf7e3ef1,0x3f643de2bf783f133f10bf793e043f62,0xbf49bef73f723e2fbf803e233f73bef1,0xbf1f3f603eaabf7cbbc93f7dbea4bf62
.octa 0x3f43bf20bf4d3f133f56bf06bf5e3ef1,0xbf26bf483f1a3f51bf0dbf5a3eff3f62,0x3efa3f76bd62bf7cbec73f4f3f41bef1,0x3f60be8fbf80be2f3f6c3f16bf28bf62,0xbf74bde23f5c3f51be42bf79bf1c3ef1,0x3e9e3f7e3f02bf13bf7bbe6d3f4b3f62,0xbdeebf60bf67be2f3f343f7d3ee3bef1,0xbf7ebef73ede3f7c3f36be23bf65bf62
.octa 0x3f7f3f483e10bf13bf7bbf5abe863ef1,0x3da3bf20bf7dbf51be4e3f063f773f62,0xbe8c3e8f3f3f3f7c3f6d3f163d8abef1,0x3f763f763f2b3e2fbec1bf4fbf7fbf62,0xbf64bf7ebf78bf51bf10be6d3e043ef1,0xbee9bde23e7f3f133f543f793f7e3f62,0x3f1f3ef73eaa3e2f3bc9be23bea4bef1,0xbf49bf60bf72bf7cbf80bf7dbf73bf62
.octa 0xbf503f4cbf473f42bf3d3f37bf323f2c,0xbf153f1bbf213f27bf2d3f33bf383f3e,0xbf2f3f01be983d973e1cbebe3f12bf3e,0xbf3a3f5dbf753f7fbf7d3f6ebf523f2c,0xbf083e0a3e92bf273f68bf803f6bbf2c,0xbf593f7ebf753f42bed83c493ecdbf3e,0xbeb5be823f45bf7f3f5bbecabe5a3f3e,0xbf6f3f78bf243d973f05bf6b3f7abf2c
.octa 0xbe29bf1b3f7fbf423d303f33bf803f2c,0xbf7c3f4cbdd5bf273f80bf37bc973f3e,0x3cfbbf5d3f63bd97bf4f3f6ebe35bf3e,0xbf803f013eefbf7f3f173ebebf7c3f2c,0x3e66bf7e3ef43f27bf713c493f6ebf2c,0xbf793e0a3f61bf42beaf3f80bebbbf3e,0x3ed2bf78bdbc3f7fbe73bf6b3f0a3f3e,0xbf69be823f7fbd97bf793eca3f57bf2c
.octa 0x3f15bf4cbf213f423f2dbf37bf383f2c,0xbf50bf1b3f473f27bf3dbf333f323f3e,0x3f3abf01bf753d973f7d3ebebf52bf3e,0xbf2fbf5d3e983f7f3e1cbf6ebf123f2c,0x3f59be0abf75bf273ed83f803ecdbf2c,0xbf08bf7ebe923f423f68bc49bf6bbf3e,0x3f6f3e82bf24bf7fbf053eca3f7a3f3e,0xbeb5bf78bf453d973f5b3f6b3e5abf2c
.octa 0x3f7c3f1bbdd5bf42bf80bf33bc973f2c,0xbe29bf4cbf7fbf273d303f373f803f3e,0x3f803f5d3eefbd97bf17bf6ebf7cbf3e,0x3cfbbf01bf63bf7fbf4fbebe3e353f2c,0x3f793f7e3f613f273eafbc49bebbbf2c,0x3e66be0abef4bf42bf71bf80bf6ebf3e,0x3f693f783f7f3f7f3f793f6b3f573f3e,0x3ed23e823dbcbd97be73becabf0abf2c
.octa 0x3f793f7b3f7c3f7e3f7f3f7f3f803f80,0xbe70be4ebe2cbe0abdcfbd8abd0a8000,0xbd233e423ed13f1b3f453f653f793f80,0xbf80bf7bbf6abf4cbf23bee3be6a8000,0xbf7dbf56bf08be0a3e933f283f693f80,0xbe20bf0dbf59bf7ebf75bf41bed48000,0xbeb1bf54bf80bf4cbe963ea43f503f80,0x3f703f10bce2bf1bbf75bf73bf158000
.octa 0x3f5a3e4ebf14bf7ebf46bd8a3f2f3f80,0x3f063f7b3f513e0abf22bf7fbf3b8000,0x3f2e3f7b3eb7bf1bbf7fbee33f073f80,0xbf3c3e423f6f3f4cbdc2bf65bf5a8000,0xbf173f0d3f7a3e0abf61bf413eb43f80,0xbf4fbf563e633f7e3ef3bf28bf708000,0xbf68bf103f3a3f4cbef0bf733e263f80,0x3ed7bf54bf303f1b3f62bea4bf7d8000
.octa 0x3e70bf7bbe2c3f7e3dcfbf7fbd0a3f80,0x3f793e4ebf7cbe0a3f7f3d8abf808000,0x3f80be42bf6a3f1b3f23bf65be6a3f80,0xbd233f7bbed1bf4c3f453ee3bf798000,0x3e203f56bf59be0a3f75bf28bed43f80,0xbf7d3f0d3f08bf7e3e933f41bf698000,0xbf703f54bce2bf4c3f75bea4bf153f80,0xbeb1bf103f80bf1bbe963f73bf508000
.octa 0xbf06be4e3f51bf7e3f223d8abf3b3f80,0x3f5abf7b3f143e0abf463f7fbf2f8000,0x3f3cbf7b3f6fbf1b3dc23ee3bf5a3f80,0x3f2ebe42beb73f4cbf7f3f65bf078000,0x3f4fbf0d3e633e0abef33f41bf703f80,0xbf173f56bf7a3f7ebf613f28beb48000,0xbed73f10bf303f4cbf623f73bf7d3f80,0xbf683f54bf3a3f1bbef03ea4be268000
.octa 0x3f603f643f683f6b3f6f3f723f743f77,0xbef8bee9bed9becabebabeaabe99be89,0xbf74bf7fbf7dbf6ebf52bf2bbef6be89,0x3e9c3da3be19bebebf13bf3fbf61bf77,0x3f7e3f743f3d3ecabcb0bedebf44bf77,0xbde83e9e3f2d3f6b3f803f673f243e89,0xbf7fbf43be763ebe3f583f803f473e89,0xbda9bf26bf79bf6ebf0a3d623f213f77
.octa 0x3f763ee9beaebf6bbf6abeaa3eed3f77,0x3e8d3f643f713ecabecebf72bf63be89,0xbf64bda33f4e3f6e3e32bf3fbf76be89,0xbeeabf7fbf183ebe3f7c3f2bbe90bf77,0x3f48be9ebf80beca3f393f67bdb6bf77,0x3f1f3f743d3cbf6bbf313ede3f7f3e89,0xbf253f263f5bbebebf7a3d623f7f3e89,0xbf43bf433f043f6ebe5dbf80bddb3f77
.octa 0x3ef8bf64bed93f6b3ebabf72be993f77,0x3f603ee9bf68beca3f6f3eaabf74be89,0xbe9c3f7fbe19bf6e3f133f2bbf61be89,0xbf74bda33f7dbebebf523f3f3ef6bf77,0x3de8bf743f2d3ecabf803ede3f24bf77,0x3f7ebe9ebf3d3f6bbcb0bf673f443e89,0x3da93f43bf793ebe3f0abf803f213e89,0xbf7f3f263e76bf6e3f58bd62bf473f77
.octa 0xbe8dbee93f71bf6b3ece3eaabf633f77,0x3f76bf643eae3ecabf6a3f72beedbe89,0x3eea3da3bf183f6ebf7c3f3fbe90be89,0xbf643f7fbf4e3ebe3e32bf2b3f76bf77,0xbf1f3e9e3d3cbeca3f31bf673f7fbf77,0x3f48bf743f80bf6b3f39bede3db63e89,0x3f43bf263f04bebe3e5dbd62bddb3e89,0xbf253f43bf5b3f6ebf7a3f80bf7f3f77
.octa 0x3f373f3d3f423f483f4d3f523f573f5c,0xbf33bf2dbf27bf20bf19bf12bf0bbf04,0x3f0c3eaf3df4bde2beabbf0abf38bf5c,0x3f563f713f7e3f7e3f713f573f323f04,0xbf6dbf80bf64bf20be7c3e353f113f5c,0x3ec0bd30bee8bf48bf78bf7cbf53bf04,0xbe3f3ed83f5f3f7e3f3e3e5abecbbf5c,0xbf7cbf68befb3de23f2b3f7a3f6b3f04
.octa 0x3f803f2dbd9dbf48bf7dbf123e573f5c,0x3c173f3d3f7f3f20be13bf52bf7abf04,0xbe51bf71bf493de23f673f57bc7bbf5c,0x3f7b3eafbf1ebf7ebedc3f0a3f803f04,0xbf6c3d303f733f20bf03bf7cbe383f5c,0xbec8bf80be9f3f483f5cbe35bf7cbf04,0x3f103f68be8abf7ebd563f7a3ebdbf5c,0xbf543ed83f77bde2bf80be5a3f6e3f04
.octa 0x3f33bf3dbf273f483f19bf52bf0b3f5c,0x3f373f2dbf42bf203f4d3f12bf57bf04,0xbf56beaf3f7ebde2bf713f0a3f32bf5c,0x3f0cbf71bdf43f7ebeabbf573f383f04,0xbec03f80bee8bf203f78be35bf533f5c,0xbf6d3d303f64bf48be7c3f7cbf11bf04,0x3f7cbed8befb3f7ebf2bbe5a3f6bbf5c,0xbe3f3f68bf5f3de23f3ebf7a3ecb3f04
.octa 0xbc17bf2d3f7fbf483e133f12bf7a3f5c,0x3f80bf3d3d9d3f20bf7d3f52be57bf04,0xbf7b3f71bf1e3de23edcbf573f80bf5c,0xbe51beaf3f49bf7e3f67bf0a3c7b3f04,0x3ec8bd30be9f3f20bf5c3f7cbf7c3f5c,0xbf6c3f80bf733f48bf033e353e38bf04,0x3f54bf683f77bf7e3f80bf7a3f6ebf5c,0x3f10bed83e8abde2bd563e5abebd3f04
.octa 0x3f003f083f0f3f163f1d3f243f2a3f31,0xbf5ebf59bf54bf4fbf4abf45bf3fbf39,0x3f293f503f6d3f7d3f7f3f753f5d3f39,0xbf40bf15bec2be233d903e983f023f31,0x3f4b3f793f7b3f4f3efe3dbcbea8bf31,0xbf1cbe663e4b3f163f5e3f7f3f723f39,0x3f663f7c3f343e23bee5bf63bf7ebf39,0xbee23e293f363f7d3f653eefbe0dbf31
.octa 0x3f773f593e45bf16bf7ebf45bd6f3f31,0xbe843f083f7b3f4f3e00bf24bf80bf39,0x3f7f3f15bec5bf7dbf283e983f783f39,0xbd843f503f6c3e23bf41bf75be813f31,0x3f7e3e66bf55bf4f3e873f7f3edfbf31,0x3e073f793f0ebf16bf77bdbc3f663f39,0x3f72be29bf80be233f733eefbf4cbf39,0x3ea53f7cbb49bf7dbea23f633f1abf31
.octa 0x3f5ebf08bf543f163f4abf24bf3f3f31,0x3f003f59bf0fbf4f3f1d3f45bf2abf39,0x3f40bf50bec23f7dbd90bf753f023f39,0x3f293f15bf6dbe233f7fbe98bf5d3f31,0x3f1cbf793e4b3f4fbf5ebdbc3f72bf31,0x3f4b3e66bf7b3f163efebf7f3ea83f39,0x3ee2bf7c3f363e23bf653f63be0dbf39,0x3f66be29bf343f7dbee5beef3f7ebf31
.octa 0x3e84bf593f7bbf16be003f45bf803f31,0x3f77bf08be453f4fbf7e3f243d6fbf39,0x3d84bf153f6cbf7d3f41be98be813f39,0x3f7fbf503ec53e23bf283f75bf783f31,0xbe07be663f0ebf4f3f77bf7f3f66bf31,0x3f7ebf793f55bf163e873dbcbedf3f39,0xbea53e29bb49be233ea2beef3f1abf39,0x3f72bf7c3f80bf7d3f73bf633f4cbf31
.octa 0x3e703e4e3e2c3e0a3dcf3d8a3d0a0000,0x3f793f7b3f7c3f7e3f7f3f7f3f803f80,0x3f803f7b3f6a3f4c3f233ee33e6a0000,0xbd233e423ed13f1b3f453f653f793f80,0x3e203f0d3f593f7e3f753f413ed40000,0xbf7dbf56bf08be0a3e933f283f693f80,0xbf70bf103ce23f1b3f753f733f150000,0xbeb1bf54bf80bf4cbe963ea43f503f80
.octa 0xbf06bf7bbf51be0a3f223f7f3f3b0000,0x3f5a3e4ebf14bf7ebf46bd8a3f2f3f80,0x3f3cbe42bf6fbf4c3dc23f653f5a0000,0x3f2e3f7b3eb7bf1bbf7fbee33f073f80,0x3f4f3f56be63bf7ebef33f283f700000,0xbf173f0d3f7a3e0abf61bf413eb43f80,0xbed73f543f30bf1bbf623ea43f7d0000,0xbf68bf103f3a3f4cbef0bf733e263f80
.octa 0xbf79be4e3f7c3e0abf7fbd8a3f800000,0x3e70bf7bbe2c3f7e3dcfbf7fbd0a3f80,0x3d23bf7b3ed13f4cbf45bee33f790000,0x3f80be42bf6a3f1b3f23bf65be6a3f80,0x3f7dbf0dbf083f7ebe93bf413f690000,0x3e203f56bf59be0a3f75bf28bed43f80,0x3eb13f10bf803f1b3e96bf733f500000,0xbf703f54bce2bf4c3f75bea4bf153f80
.octa 0xbf5a3f7bbf14be0a3f46bf7f3f2f0000,0xbf06be4e3f51bf7e3f223d8abf3b3f80,0xbf2e3e423eb7bf4c3f7fbf653f070000,0x3f3cbf7b3f6fbf1b3dc23ee3bf5a3f80,0x3f17bf563f7abf7e3f61bf283eb40000,0x3f4fbf0d3e633e0abef33f41bf703f80,0x3f68bf543f3abf1b3ef0bea43e260000,0xbed73f10bf303f4cbf623f73bf7d3f80
.octa 0x3ef83ee93ed93eca3eba3eaa3e993e89,0x3f603f643f683f6b3f6f3f723f743f77,0xbe9cbda33e193ebe3f133f3f3f613f77,0xbf74bf7fbf7dbf6ebf52bf2bbef6be89,0x3de8be9ebf2dbf6bbf80bf67bf24be89,0x3f7e3f743f3d3ecabcb0bedebf44bf77,0x3da93f263f793f6e3f0abd62bf21bf77,0xbf7fbf43be763ebe3f583f803f473e89
.octa 0xbe8dbf64bf71beca3ece3f723f633e89,0x3f763ee9beaebf6bbf6abeaa3eed3f77,0x3eea3f7f3f18bebebf7cbf2b3e903f77,0xbf64bda33f4e3f6e3e32bf3fbf76be89,0xbf1fbf74bd3c3f6b3f31bedebf7fbe89,0x3f48be9ebf80beca3f393f67bdb6bf77,0x3f433f43bf04bf6e3e5d3f803ddbbf77,0xbf253f263f5bbebebf7a3d623f7f3e89
.octa 0xbf60bee93f683ecabf6fbeaa3f743e89,0x3ef8bf64bed93f6b3ebabf72be993f77,0x3f743da3bf7d3ebe3f52bf3fbef63f77,0xbe9c3f7fbe19bf6e3f133f2bbf61be89,0xbf7e3e9e3f3dbf6b3cb03f67bf44be89,0x3de8bf743f2d3ecabf803ede3f24bf77,0x3f7fbf26be763f6ebf583d623f47bf77,0x3da93f43bf793ebe3f0abf803f213e89
.octa 0xbf763f64beaebeca3f6abf723eed3e89,0xbe8dbee93f71bf6b3ece3eaabf633f77,0x3f64bf7f3f4ebebebe323f2bbf763f77,0x3eea3da3bf183f6ebf7c3f3fbe90be89,0xbf483f74bf803f6bbf393edebdb6be89,0xbf1f3e9e3d3cbeca3f31bf673f7fbf77,0x3f25bf433f5bbf6e3f7abf803f7fbf77,0x3f43bf263f04bebe3e5dbd62bddb3e89
.octa 0x3f333f2d3f273f203f193f123f0b3f04,0x3f373f3d3f423f483f4d3f523f573f5c,0xbf56bf71bf7ebf7ebf71bf57bf32bf04,0x3f0c3eaf3df4bde2beabbf0abf38bf5c,0xbec03d303ee83f483f783f7c3f533f04,0xbf6dbf80bf64bf20be7c3e353f113f5c,0x3f7c3f683efbbde2bf2bbf7abf6bbf04,0xbe3f3ed83f5f3f7e3f3e3e5abecbbf5c
.octa 0xbc17bf3dbf7fbf203e133f523f7a3f04,0x3f803f2dbd9dbf48bf7dbf123e573f5c,0xbf7bbeaf3f1e3f7e3edcbf0abf80bf04,0xbe51bf71bf493de23f673f57bc7bbf5c,0x3ec83f803e9fbf48bf5c3e353f7c3f04,0xbf6c3d303f733f20bf03bf7cbe383f5c,0x3f54bed8bf773de23f803e5abf6ebf04,0x3f103f68be8abf7ebd563f7a3ebdbf5c
.octa 0xbf37bf2d3f423f20bf4dbf123f573f04,0x3f33bf3dbf273f483f19bf52bf0b3f5c,0xbf0c3f713df4bf7e3eab3f57bf38bf04,0xbf56beaf3f7ebde2bf713f0a3f32bf5c,0x3f6dbd30bf643f483e7cbf7c3f113f04,0xbec03f80bee8bf203f78be35bf533f5c,0x3e3fbf683f5fbde2bf3e3f7abecbbf04,0x3f7cbed8befb3f7ebf2bbe5a3f6bbf5c
.octa 0xbf803f3dbd9dbf203f7dbf523e573f04,0xbc17bf2d3f7fbf483e133f12bf7a3f5c,0x3e513eafbf493f7ebf673f0abc7bbf04,0xbf7b3f71bf1e3de23edcbf573f80bf5c,0x3f6cbf803f73bf483f03be35be383f04,0x3ec8bd30be9f3f20bf5c3f7cbf7c3f5c,0xbf103ed8be8a3de23d56be5a3ebdbf04,0x3f54bf683f77bf7e3f80bf7a3f6ebf5c
.octa 0x3f5e3f593f543f4f3f4a3f453f3f3f39,0x3f003f083f0f3f163f1d3f243f2a3f31,0x3f403f153ec23e23bd90be98bf02bf31,0x3f293f503f6d3f7d3f7f3f753f5d3f39,0x3f1c3e66be4bbf16bf5ebf7fbf72bf39,0x3f4b3f793f7b3f4f3efe3dbcbea8bf31,0x3ee2be29bf36bf7dbf65beef3e0d3f31,0x3f663f7c3f343e23bee5bf63bf7ebf39
.octa 0x3e84bf08bf7bbf4fbe003f243f803f39,0x3f773f593e45bf16bf7ebf45bd6f3f31,0x3d84bf50bf6cbe233f413f753e81bf31,0x3f7f3f15bec5bf7dbf283e983f783f39,0xbe07bf79bf0e3f163f773dbcbf66bf39,0x3f7e3e66bf55bf4f3e873f7f3edfbf31,0xbea5bf7c3b493f7d3ea2bf63bf1a3f31,0x3f72be29bf80be233f733eefbf4cbf39
.octa 0xbf00bf593f0f3f4fbf1dbf453f2a3f39,0x3f5ebf08bf543f163f4abf24bf3f3f31,0xbf29bf153f6d3e23bf7f3e983f5dbf31,0x3f40bf50bec23f7dbd90bf753f023f39,0xbf4bbe663f7bbf16befe3f7fbea8bf39,0x3f1cbf793e4b3f4fbf5ebdbc3f72bf31,0xbf663e293f34bf7d3ee53eefbf7e3f31,0x3ee2bf7c3f363e23bf653f63be0dbf39
.octa 0xbf773f083e45bf4f3f7ebf24bd6f3f39,0x3e84bf593f7bbf16be003f45bf803f31,0xbf7f3f50bec5be233f28bf753f78bf31,0x3d84bf153f6cbf7d3f41be98be813f39,0xbf7e3f79bf553f16be87bdbc3edfbf39,0xbe07be663f0ebf4f3f77bf7f3f66bf31,0xbf723f7cbf803f7dbf733f63bf4c3f31,0xbea53e29bb49be233ea2beef3f1abf39
.octa 0xbf793f7bbf7c3f7ebf7f3f7fbf803f80,0x3e70be4e3e2cbe0a3dcfbd8a3d0a8000,0x3d233e42bed13f1bbf453f65bf793f80,0x3f80bf7b3f6abf4c3f23bee33e6a8000,0x3f7dbf563f08be0abe933f28bf693f80,0x3e20bf0d3f59bf7e3f75bf413ed48000,0x3eb1bf543f80bf4c3e963ea4bf503f80,0xbf703f103ce2bf1b3f75bf733f158000
.octa 0xbf5a3e4e3f14bf7e3f46bd8abf2f3f80,0xbf063f7bbf513e0a3f22bf7f3f3b8000,0xbf2e3f7bbeb7bf1b3f7fbee3bf073f80,0x3f3c3e42bf6f3f4c3dc2bf653f5a8000,0x3f173f0dbf7a3e0a3f61bf41beb43f80,0x3f4fbf56be633f7ebef3bf283f708000,0x3f68bf10bf3a3f4c3ef0bf73be263f80,0xbed7bf543f303f1bbf62bea43f7d8000
.octa 0xbe70bf7b3e2c3f7ebdcfbf7f3d0a3f80,0xbf793e4e3f7cbe0abf7f3d8a3f808000,0xbf80be423f6a3f1bbf23bf653e6a3f80,0x3d233f7b3ed1bf4cbf453ee33f798000,0xbe203f563f59be0abf75bf283ed43f80,0x3f7d3f0dbf08bf7ebe933f413f698000,0x3f703f543ce2bf4cbf75bea43f153f80,0x3eb1bf10bf80bf1b3e963f733f508000
.octa 0x3f06be4ebf51bf7ebf223d8a3f3b3f80,0xbf5abf7bbf143e0a3f463f7f3f2f8000,0xbf3cbf7bbf6fbf1bbdc23ee33f5a3f80,0xbf2ebe423eb73f4c3f7f3f653f078000,0xbf4fbf0dbe633e0a3ef33f413f703f80,0x3f173f563f7a3f7e3f613f283eb48000,0x3ed73f103f303f4c3f623f733f7d3f80,0x3f683f543f3a3f1b3ef03ea43e268000
.octa 0xbf603f64bf683f6bbf6f3f72bf743f77,0x3ef8bee93ed9beca3ebabeaa3e99be89,0x3f74bf7f3f7dbf6e3f52bf2b3ef6be89,0xbe9c3da33e19bebe3f13bf3f3f61bf77,0xbf7e3f74bf3d3eca3cb0bede3f44bf77,0x3de83e9ebf2d3f6bbf803f67bf243e89,0x3f7fbf433e763ebebf583f80bf473e89,0x3da9bf263f79bf6e3f0a3d62bf213f77
.octa 0xbf763ee93eaebf6b3f6abeaabeed3f77,0xbe8d3f64bf713eca3ecebf723f63be89,0x3f64bda3bf4e3f6ebe32bf3f3f76be89,0x3eeabf7f3f183ebebf7c3f2b3e90bf77,0xbf48be9e3f80becabf393f673db6bf77,0xbf1f3f74bd3cbf6b3f313edebf7f3e89,0x3f253f26bf5bbebe3f7a3d62bf7f3e89,0x3f43bf43bf043f6e3e5dbf803ddb3f77
.octa 0xbef8bf643ed93f6bbebabf723e993f77,0xbf603ee93f68becabf6f3eaa3f74be89,0x3e9c3f7f3e19bf6ebf133f2b3f61be89,0x3f74bda3bf7dbebe3f523f3fbef6bf77,0xbde8bf74bf2d3eca3f803edebf24bf77,0xbf7ebe9e3f3d3f6b3cb0bf67bf443e89,0xbda93f433f793ebebf0abf80bf213e89,0x3f7f3f26be76bf6ebf58bd623f473f77
.octa 0x3e8dbee9bf71bf6bbece3eaa3f633f77,0xbf76bf64beae3eca3f6a3f723eedbe89,0xbeea3da33f183f6e3f7c3f3f3e90be89,0x3f643f7f3f4e3ebebe32bf2bbf76bf77,0x3f1f3e9ebd3cbecabf31bf67bf7fbf77,0xbf48bf74bf80bf6bbf39bedebdb63e89,0xbf43bf26bf04bebebe5dbd623ddb3e89,0x3f253f433f5b3f6e3f7a3f803f7f3f77
.octa 0xbf373f3dbf423f48bf4d3f52bf573f5c,0x3f33bf2d3f27bf203f19bf123f0bbf04,0xbf0c3eafbdf4bde23eabbf0a3f38bf5c,0xbf563f71bf7e3f7ebf713f57bf323f04,0x3f6dbf803f64bf203e7c3e35bf113f5c,0xbec0bd303ee8bf483f78bf7c3f53bf04,0x3e3f3ed8bf5f3f7ebf3e3e5a3ecbbf5c,0x3f7cbf683efb3de2bf2b3f7abf6b3f04
.octa 0xbf803f2d3d9dbf483f7dbf12be573f5c,0xbc173f3dbf7f3f203e13bf523f7abf04,0x3e51bf713f493de2bf673f573c7bbf5c,0xbf7b3eaf3f1ebf7e3edc3f0abf803f04,0x3f6c3d30bf733f203f03bf7c3e383f5c,0x3ec8bf803e9f3f48bf5cbe353f7cbf04,0xbf103f683e8abf7e3d563f7abebdbf5c,0x3f543ed8bf77bde23f80be5abf6e3f04
.octa 0xbf33bf3d3f273f48bf19bf523f0b3f5c,0xbf373f2d3f42bf20bf4d3f123f57bf04,0x3f56beafbf7ebde23f713f0abf32bf5c,0xbf0cbf713df43f7e3eabbf57bf383f04,0x3ec03f803ee8bf20bf78be353f533f5c,0x3f6d3d30bf64bf483e7c3f7c3f11bf04,0xbf7cbed83efb3f7e3f2bbe5abf6bbf5c,0x3e3f3f683f5f3de2bf3ebf7abecb3f04
.octa 0x3c17bf2dbf7fbf48be133f123f7a3f5c,0xbf80bf3dbd9d3f203f7d3f523e57bf04,0x3f7b3f713f1e3de2bedcbf57bf80bf5c,0x3e51beafbf49bf7ebf67bf0abc7b3f04,0xbec8bd303e9f3f203f5c3f7c3f7c3f5c,0x3f6c3f803f733f483f033e35be38bf04,0xbf54bf68bf77bf7ebf80bf7abf6ebf5c,0xbf10bed8be8abde23d563e5a3ebd3f04
.octa 0xbf003f08bf0f3f16bf1d3f24bf2a3f31,0x3f5ebf593f54bf4f3f4abf453f3fbf39,0xbf293f50bf6d3f7dbf7f3f75bf5d3f39,0x3f40bf153ec2be23bd903e98bf023f31,0xbf4b3f79bf7b3f4fbefe3dbc3ea8bf31,0x3f1cbe66be4b3f16bf5e3f7fbf723f39,0xbf663f7cbf343e233ee5bf633f7ebf39,0x3ee23e29bf363f7dbf653eef3e0dbf31
.octa 0xbf773f59be45bf163f7ebf453d6f3f31,0x3e843f08bf7b3f4fbe00bf243f80bf39,0xbf7f3f153ec5bf7d3f283e98bf783f39,0x3d843f50bf6c3e233f41bf753e813f31,0xbf7e3e663f55bf4fbe873f7fbedfbf31,0xbe073f79bf0ebf163f77bdbcbf663f39,0xbf72be293f80be23bf733eef3f4cbf39,0xbea53f7c3b49bf7d3ea23f63bf1abf31
.octa 0xbf5ebf083f543f16bf4abf243f3f3f31,0xbf003f593f0fbf4fbf1d3f453f2abf39,0xbf40bf503ec23f7d3d90bf75bf023f39,0xbf293f153f6dbe23bf7fbe983f5d3f31,0xbf1cbf79be4b3f4f3f5ebdbcbf72bf31,0xbf4b3e663f7b3f16befebf7fbea83f39,0xbee2bf7cbf363e233f653f633e0dbf39,0xbf66be293f343f7d3ee5beefbf7ebf31
.octa 0xbe84bf59bf7bbf163e003f453f803f31,0xbf77bf083e453f4f3f7e3f24bd6fbf39,0xbd84bf15bf6cbf7dbf41be983e813f39,0xbf7fbf50bec53e233f283f753f783f31,0x3e07be66bf0ebf4fbf77bf7fbf66bf31,0xbf7ebf79bf55bf16be873dbc3edf3f39,0x3ea53e293b49be23bea2beefbf1abf39,0xbf72bf7cbf80bf7dbf73bf63bf4cbf31
.octa 0xbe703e4ebe2c3e0abdcf3d8abd0a0000,0xbf793f7bbf7c3f7ebf7f3f7fbf803f80,0xbf803f7bbf6a3f4cbf233ee3be6a0000,0x3d233e42bed13f1bbf453f65bf793f80,0xbe203f0dbf593f7ebf753f41bed40000,0x3f7dbf563f08be0abe933f28bf693f80,0x3f70bf10bce23f1bbf753f73bf150000,0x3eb1bf543f80bf4c3e963ea4bf503f80
.octa 0x3f06bf7b3f51be0abf223f7fbf3b0000,0xbf5a3e4e3f14bf7e3f46bd8abf2f3f80,0xbf3cbe423f6fbf4cbdc23f65bf5a0000,0xbf2e3f7bbeb7bf1b3f7fbee3bf073f80,0xbf4f3f563e63bf7e3ef33f28bf700000,0x3f173f0dbf7a3e0a3f61bf41beb43f80,0x3ed73f54bf30bf1b3f623ea4bf7d0000,0x3f68bf10bf3a3f4c3ef0bf73be263f80
.octa 0x3f79be4ebf7c3e0a3f7fbd8abf800000,0xbe70bf7b3e2c3f7ebdcfbf7f3d0a3f80,0xbd23bf7bbed13f4c3f45bee3bf790000,0xbf80be423f6a3f1bbf23bf653e6a3f80,0xbf7dbf0d3f083f7e3e93bf41bf690000,0xbe203f563f59be0abf75bf283ed43f80,0xbeb13f103f803f1bbe96bf73bf500000,0x3f703f543ce2bf4cbf75bea43f153f80
.octa 0x3f5a3f7b3f14be0abf46bf7fbf2f0000,0x3f06be4ebf51bf7ebf223d8a3f3b3f80,0x3f2e3e42beb7bf4cbf7fbf65bf070000,0xbf3cbf7bbf6fbf1bbdc23ee33f5a3f80,0xbf17bf56bf7abf7ebf61bf28beb40000,0xbf4fbf0dbe633e0a3ef33f413f703f80,0xbf68bf54bf3abf1bbef0bea4be260000,0x3ed73f103f303f4c3f623f733f7d3f80
.octa 0xbef83ee9bed93ecabeba3eaabe993e89,0xbf603f64bf683f6bbf6f3f72bf743f77,0x3e9cbda3be193ebebf133f3fbf613f77,0x3f74bf7f3f7dbf6e3f52bf2b3ef6be89,0xbde8be9e3f2dbf6b3f80bf673f24be89,0xbf7e3f74bf3d3eca3cb0bede3f44bf77,0xbda93f26bf793f6ebf0abd623f21bf77,0x3f7fbf433e763ebebf583f80bf473e89
.octa 0x3e8dbf643f71becabece3f72bf633e89,0xbf763ee93eaebf6b3f6abeaabeed3f77,0xbeea3f7fbf18bebe3f7cbf2bbe903f77,0x3f64bda3bf4e3f6ebe32bf3f3f76be89,0x3f1fbf743d3c3f6bbf31bede3f7fbe89,0xbf48be9e3f80becabf393f673db6bf77,0xbf433f433f04bf6ebe5d3f80bddbbf77,0x3f253f26bf5bbebe3f7a3d62bf7f3e89
.octa 0x3f60bee9bf683eca3f6fbeaabf743e89,0xbef8bf643ed93f6bbebabf723e993f77,0xbf743da33f7d3ebebf52bf3f3ef63f77,0x3e9c3f7f3e19bf6ebf133f2b3f61be89,0x3f7e3e9ebf3dbf6bbcb03f673f44be89,0xbde8bf74bf2d3eca3f803edebf24bf77,0xbf7fbf263e763f6e3f583d62bf47bf77,0xbda93f433f793ebebf0abf80bf213e89
.octa 0x3f763f643eaebecabf6abf72beed3e89,0x3e8dbee9bf71bf6bbece3eaa3f633f77,0xbf64bf7fbf4ebebe3e323f2b3f763f77,0xbeea3da33f183f6e3f7c3f3f3e90be89,0x3f483f743f803f6b3f393ede3db6be89,0x3f1f3e9ebd3cbecabf31bf67bf7fbf77,0xbf25bf43bf5bbf6ebf7abf80bf7fbf77,0xbf43bf26bf04bebebe5dbd623ddb3e89
.octa 0xbf333f2dbf273f20bf193f12bf0b3f04,0xbf373f3dbf423f48bf4d3f52bf573f5c,0x3f56bf713f7ebf7e3f71bf573f32bf04,0xbf0c3eafbdf4bde23eabbf0a3f38bf5c,0x3ec03d30bee83f48bf783f7cbf533f04,0x3f6dbf803f64bf203e7c3e35bf113f5c,0xbf7c3f68befbbde23f2bbf7a3f6bbf04,0x3e3f3ed8bf5f3f7ebf3e3e5a3ecbbf5c
.octa 0x3c17bf3d3f7fbf20be133f52bf7a3f04,0xbf803f2d3d9dbf483f7dbf12be573f5c,0x3f7bbeafbf1e3f7ebedcbf0a3f80bf04,0x3e51bf713f493de2bf673f573c7bbf5c,0xbec83f80be9fbf483f5c3e35bf7c3f04,0x3f6c3d30bf733f203f03bf7c3e383f5c,0xbf54bed83f773de2bf803e5a3f6ebf04,0xbf103f683e8abf7e3d563f7abebdbf5c
.octa 0x3f37bf2dbf423f203f4dbf12bf573f04,0xbf33bf3d3f273f48bf19bf523f0b3f5c,0x3f0c3f71bdf4bf7ebeab3f573f38bf04,0x3f56beafbf7ebde23f713f0abf32bf5c,0xbf6dbd303f643f48be7cbf7cbf113f04,0x3ec03f803ee8bf20bf78be353f533f5c,0xbe3fbf68bf5fbde23f3e3f7a3ecbbf04,0xbf7cbed83efb3f7e3f2bbe5abf6bbf5c
.octa 0x3f803f3d3d9dbf20bf7dbf52be573f04,0x3c17bf2dbf7fbf48be133f123f7a3f5c,0xbe513eaf3f493f7e3f673f0a3c7bbf04,0x3f7b3f713f1e3de2bedcbf57bf80bf5c,0xbf6cbf80bf73bf48bf03be353e383f04,0xbec8bd303e9f3f203f5c3f7c3f7c3f5c,0x3f103ed83e8a3de2bd56be5abebdbf04,0xbf54bf68bf77bf7ebf80bf7abf6ebf5c
.octa 0xbf5e3f59bf543f4fbf4a3f45bf3f3f39,0xbf003f08bf0f3f16bf1d3f24bf2a3f31,0xbf403f15bec23e233d90be983f02bf31,0xbf293f50bf6d3f7dbf7f3f75bf5d3f39,0xbf1c3e663e4bbf163f5ebf7f3f72bf39,0xbf4b3f79bf7b3f4fbefe3dbc3ea8bf31,0xbee2be293f36bf7d3f65beefbe0d3f31,0xbf663f7cbf343e233ee5bf633f7ebf39
.octa 0xbe84bf083f7bbf4f3e003f24bf803f39,0xbf773f59be45bf163f7ebf453d6f3f31,0xbd84bf503f6cbe23bf413f75be81bf31,0xbf7f3f153ec5bf7d3f283e98bf783f39,0x3e07bf793f0e3f16bf773dbc3f66bf39,0xbf7e3e663f55bf4fbe873f7fbedfbf31,0x3ea5bf7cbb493f7dbea2bf633f1a3f31,0xbf72be293f80be23bf733eef3f4cbf39
.octa 0x3f00bf59bf0f3f4f3f1dbf45bf2a3f39,0xbf5ebf083f543f16bf4abf243f3f3f31,0x3f29bf15bf6d3e233f7f3e98bf5dbf31,0xbf40bf503ec23f7d3d90bf75bf023f39,0x3f4bbe66bf7bbf163efe3f7f3ea8bf39,0xbf1cbf79be4b3f4f3f5ebdbcbf72bf31,0x3f663e29bf34bf7dbee53eef3f7e3f31,0xbee2bf7cbf363e233f653f633e0dbf39
.octa 0x3f773f08be45bf4fbf7ebf243d6f3f39,0xbe84bf59bf7bbf163e003f453f803f31,0x3f7f3f503ec5be23bf28bf75bf78bf31,0xbd84bf15bf6cbf7dbf41be983e813f39,0x3f7e3f793f553f163e87bdbcbedfbf39,0x3e07be66bf0ebf4fbf77bf7fbf66bf31,0x3f723f7c3f803f7d3f733f633f4c3f31,0x3ea53e293b49be23bea2beefbf1abf39
.octa 0x3f783f7a3f7c3f7d3f7e3f7f3f803f80,0xbe82be60be3bbe16bde2bd97bd178000,0xbd7b3e2f3eca3f183f443f653f793f80,0xbf80bf7cbf6bbf4ebf25bee6be6d8000,0xbf7ebf58bf0cbe163e8f3f273f693f80,0xbe0abf09bf57bf7dbf76bf42bed58000,0xbea7bf51bf80bf4ebe9b3ea13f4f3f80,0x3f723f13bc49bf18bf74bf73bf168000
.octa 0x3f5d3e60bf11bf7dbf48bd973f2e3f80,0x3f013f7a3f533e16bf20bf7fbf3c8000,0x3f2a3f7c3ebebf18bf7fbee63f063f80,0xbf403e2f3f6e3f4ebdb0bf65bf5a8000,0xbf1b3f093f7a3e16bf60bf423eb23f80,0xbf4cbf583e543f7d3ef7bf27bf708000,0xbf66bf133f373f4ebeecbf733e233f80,0x3ee1bf51bf333f183f63bea1bf7d8000
.octa 0x3e82bf7abe3b3f7d3de2bf7fbd173f80,0x3f783e60bf7cbe163f7e3d97bf808000,0x3f80be2fbf6b3f183f25bf65be6d3f80,0xbd7b3f7cbecabf4e3f443ee6bf798000,0x3e0a3f58bf57be163f76bf27bed53f80,0xbf7e3f093f0cbf7d3e8f3f42bf698000,0xbf723f51bc49bf4e3f74bea1bf163f80,0xbea7bf133f80bf18be9b3f73bf4f8000
.octa 0xbf01be603f53bf7d3f203d97bf3c3f80,0x3f5dbf7a3f113e16bf483f7fbf2e8000,0x3f40bf7c3f6ebf183db03ee6bf5a3f80,0x3f2abe2fbebe3f4ebf7f3f65bf068000,0x3f4cbf093e543e16bef73f42bf703f80,0xbf1b3f58bf7a3f7dbf603f27beb28000,0xbee13f13bf333f4ebf633f73bf7d3f80,0xbf663f51bf373f18beec3ea1be238000
.octa 0x3f5a3f5f3f633f673f6b3f6f3f723f75,0xbf06befcbeecbedbbecabeb8bea7be95,0xbf70bf7ebf7ebf71bf57bf31bf01be95,0x3eb23dfbbde2beacbf0cbf39bf5dbf75,0x3f7d3f773f443edb3c49becfbf40bf75,0xbe233e893f253f673f803f6a3f2a3e95,0xbf80bf4abe8f3eac3f533f803f4c3e95,0xbd17bf1dbf76bf71bf113cc93f1b3f75
.octa 0x3f793efcbe9bbf67bf6ebeb83ee13f75,0x3e6d3f5f3f743edbbebebf6fbf66be95,0xbf69bdfb3f483f713e54bf39bf78be95,0xbed5bf7ebf203eac3f7a3f31be82bf75,0x3f4fbe89bf7fbedb3f333f6abd7bbf75,0x3f163f773db0bf67bf373ecf3f803e95,0xbf2e3f1d3f60beacbf7c3cc93f7e3e95,0xbf3cbf4a3ef73f71be3bbf80be0a3f75
.octa 0x3f06bf5fbeec3f673ecabf6fbea73f75,0x3f5a3efcbf63bedb3f6b3eb8bf72be95,0xbeb23f7ebde2bf713f0c3f31bf5dbe95,0xbf70bdfb3f7ebeacbf573f393f01bf75,0x3e23bf773f253edbbf803ecf3f2abf75,0x3f7dbe89bf443f673c49bf6a3f403e95,0x3d173f4abf763eac3f11bf803f1b3e95,0xbf803f1d3e8fbf713f53bcc9bf4c3f75
.octa 0xbe6dbefc3f74bf673ebe3eb8bf663f75,0x3f79bf5f3e9b3edbbf6e3f6fbee1be95,0x3ed53dfbbf203f71bf7a3f39be82be95,0xbf693f7ebf483eac3e54bf313f78bf75,0xbf163e893db0bedb3f37bf6a3f80bf75,0x3f4fbf773f7fbf673f33becf3d7b3e95,0x3f3cbf1d3ef7beac3e3bbcc9be0a3e95,0xbf2e3f4abf603f71bf7c3f80bf7e3f75
.octa 0x3f2a3f313f373f3e3f443f4a3f4f3f55,0xbf40bf39bf33bf2cbf25bf1dbf16bf0e,0x3f1b3ecf3e3bbd49be8fbefcbf2ebf55,0x3f4c3f6a3f7c3f803f763f5f3f3c3f0e,0xbf66bf80bf6bbf2cbe9b3dfb3f063f55,0x3ee13cc9becabf3ebf74bf7ebf5abf0e,0xbe823eb83f573f803f483e89beb2bf55,0xbf78bf6fbf0c3d493f203f773f703f0e
.octa 0x3f803f39bc49bf3ebf7fbf1d3e233f55,0xbd7b3f313f803f2cbdb0bf4abf7dbf0e,0xbe0abf6abf533d493f603f5f3d17bf55,0x3f7e3ecfbf11bf80bef73efc3f803f0e,0xbf72bcc93f6e3f2cbeecbf7ebe6d3f55,0xbea7bf80bebe3f3e3f63bdfbbf79bf0e,0x3f013f6fbe54bf80bde23f773ed5bf55,0xbf5d3eb83f7abd49bf7ebe893f693f0e
.octa 0x3f40bf31bf333f3e3f25bf4abf163f55,0x3f2a3f39bf37bf2c3f443f1dbf4fbf0e,0xbf4cbecf3f7cbd49bf763efc3f3cbf55,0x3f1bbf6abe3b3f80be8fbf5f3f2e3f0e,0xbee13f80becabf2c3f74bdfbbf5a3f55,0xbf66bcc93f6bbf3ebe9b3f7ebf06bf0e,0x3f78beb8bf0c3f80bf20be893f70bf55,0xbe823f6fbf573d493f48bf773eb23f0e
.octa 0x3d7bbf393f80bf3e3db03f1dbf7d3f55,0x3f80bf313c493f2cbf7f3f4abe23bf0e,0xbf7e3f6abf113d493ef7bf5f3f80bf55,0xbe0abecf3f53bf803f60befcbd173f0e,0x3ea73cc9bebe3f2cbf633f7ebf793f55,0xbf723f80bf6e3f3ebeec3dfb3e6dbf0e,0x3f5dbf6f3f7abf803f7ebf773f69bf55,0x3f01beb83e54bd49bde23e89bed53f0e
.octa 0x3ed53ee63ef73f043f0c3f133f1b3f22,0xbf69bf65bf60bf5cbf57bf51bf4cbf46,0x3f163f423f633f783f803f7a3f663f46,0xbf4fbf27beecbe79bc493e603ee13f22,0x3f3c3f733f7e3f5c3f113e2fbe82bf22,0xbf2ebea13de23f043f533f7c3f783f46,0x3f5a3f7f3f443e79bebebf58bf80bf46,0xbf063d973f253f783f6e3f09bd7bbf22
.octa 0x3f703f653e8fbf04bf7abf51be0a3f22,0xbeb23ee63f763f5c3e54bf13bf7ebf46,0x3f7d3f27be9bbf78bf373e603f723f46,0xbe233f423f743e79bf33bf7abea73f22,0x3f803ea1bf48bf5c3e3b3f7c3f01bf22,0x3d173f733f20bf04bf7cbe2f3f5d3f46,0x3f79bd97bf7fbe793f6b3f09bf40bf46,0x3e6d3f7f3db0bf78beca3f583f2abf22
.octa 0x3f69bee6bf603f043f57bf13bf4c3f22,0x3ed53f65bef7bf5c3f0c3f51bf1bbf46,0x3f4fbf42beec3f783c49bf7a3ee13f46,0x3f163f27bf63be793f80be60bf663f22,0x3f2ebf733de23f5cbf53be2f3f78bf22,0x3f3c3ea1bf7e3f043f11bf7c3e823f46,0x3f06bf7f3f253e79bf6e3f58bd7bbf46,0x3f5abd97bf443f78bebebf093f80bf22
.octa 0x3eb2bf653f76bf04be543f51bf7e3f22,0x3f70bee6be8f3f5cbf7a3f133e0abf46,0x3e23bf273f74bf783f33be60bea73f46,0x3f7dbf423e9b3e79bf373f7abf723f22,0xbd17bea13f20bf5c3f7cbf7c3f5dbf22,0x3f80bf733f48bf043e3b3e2fbf013f46,0xbe6d3d973db0be793ecabf093f2abf46,0x3f79bf7f3f7fbf783f6bbf583f40bf22
.octa 0x3e823e603e3b3e163de23d973d170000,0x3f783f7a3f7c3f7d3f7e3f7f3f803f80,0x3f803f7c3f6b3f4e3f253ee63e6d0000,0xbd7b3e2f3eca3f183f443f653f793f80,0x3e0a3f093f573f7d3f763f423ed50000,0xbf7ebf58bf0cbe163e8f3f273f693f80,0xbf72bf133c493f183f743f733f160000,0xbea7bf51bf80bf4ebe9b3ea13f4f3f80
.octa 0xbf01bf7abf53be163f203f7f3f3c0000,0x3f5d3e60bf11bf7dbf48bd973f2e3f80,0x3f40be2fbf6ebf4e3db03f653f5a0000,0x3f2a3f7c3ebebf18bf7fbee63f063f80,0x3f4c3f58be54bf7dbef73f273f700000,0xbf1b3f093f7a3e16bf60bf423eb23f80,0xbee13f513f33bf18bf633ea13f7d0000,0xbf66bf133f373f4ebeecbf733e233f80
.octa 0xbf78be603f7c3e16bf7ebd973f800000,0x3e82bf7abe3b3f7d3de2bf7fbd173f80,0x3d7bbf7c3eca3f4ebf44bee63f790000,0x3f80be2fbf6b3f183f25bf65be6d3f80,0x3f7ebf09bf0c3f7dbe8fbf423f690000,0x3e0a3f58bf57be163f76bf27bed53f80,0x3ea73f13bf803f183e9bbf733f4f0000,0xbf723f51bc49bf4e3f74bea1bf163f80
.octa 0xbf5d3f7abf11be163f48bf7f3f2e0000,0xbf01be603f53bf7d3f203d97bf3c3f80,0xbf2a3e2f3ebebf4e3f7fbf653f060000,0x3f40bf7c3f6ebf183db03ee6bf5a3f80,0x3f1bbf583f7abf7d3f60bf273eb20000,0x3f4cbf093e543e16bef73f42bf703f80,0x3f66bf513f37bf183eecbea13e230000,0xbee13f13bf333f4ebf633f73bf7d3f80
.octa 0x3f063efc3eec3edb3eca3eb83ea73e95,0x3f5a3f5f3f633f673f6b3f6f3f723f75,0xbeb2bdfb3de23eac3f0c3f393f5d3f75,0xbf70bf7ebf7ebf71bf57bf31bf01be95,0x3e23be89bf25bf67bf80bf6abf2abe95,0x3f7d3f773f443edb3c49becfbf40bf75,0x3d173f1d3f763f713f11bcc9bf1bbf75,0xbf80bf4abe8f3eac3f533f803f4c3e95
.octa 0xbe6dbf5fbf74bedb3ebe3f6f3f663e95,0x3f793efcbe9bbf67bf6ebeb83ee13f75,0x3ed53f7e3f20beacbf7abf313e823f75,0xbf69bdfb3f483f713e54bf39bf78be95,0xbf16bf77bdb03f673f37becfbf80be95,0x3f4fbe89bf7fbedb3f333f6abd7bbf75,0x3f3c3f4abef7bf713e3b3f803e0abf75,0xbf2e3f1d3f60beacbf7c3cc93f7e3e95
.octa 0xbf5abefc3f633edbbf6bbeb83f723e95,0x3f06bf5fbeec3f673ecabf6fbea73f75,0x3f703dfbbf7e3eac3f57bf39bf013f75,0xbeb23f7ebde2bf713f0c3f31bf5dbe95,0xbf7d3e893f44bf67bc493f6abf40be95,0x3e23bf773f253edbbf803ecf3f2abf75,0x3f80bf1dbe8f3f71bf533cc93f4cbf75,0x3d173f4abf763eac3f11bf803f1b3e95
.octa 0xbf793f5fbe9bbedb3f6ebf6f3ee13e95,0xbe6dbefc3f74bf673ebe3eb8bf663f75,0x3f69bf7e3f48beacbe543f31bf783f75,0x3ed53dfbbf203f71bf7a3f39be82be95,0xbf4f3f77bf7f3f67bf333ecfbd7bbe95,0xbf163e893db0bedb3f37bf6a3f80bf75,0x3f2ebf4a3f60bf713f7cbf803f7ebf75,0x3f3cbf1d3ef7beac3e3bbcc9be0a3e95
.octa 0x3f403f393f333f2c3f253f1d3f163f0e,0x3f2a3f313f373f3e3f443f4a3f4f3f55,0xbf4cbf6abf7cbf80bf76bf5fbf3cbf0e,0x3f1b3ecf3e3bbd49be8fbefcbf2ebf55,0xbee1bcc93eca3f3e3f743f7e3f5a3f0e,0xbf66bf80bf6bbf2cbe9b3dfb3f063f55,0x3f783f6f3f0cbd49bf20bf77bf70bf0e,0xbe823eb83f573f803f483e89beb2bf55
.octa 0x3d7bbf31bf80bf2c3db03f4a3f7d3f0e,0x3f803f39bc49bf3ebf7fbf1d3e233f55,0xbf7ebecf3f113f803ef7befcbf80bf0e,0xbe0abf6abf533d493f603f5f3d17bf55,0x3ea73f803ebebf3ebf633dfb3f793f0e,0xbf72bcc93f6e3f2cbeecbf7ebe6d3f55,0x3f5dbeb8bf7a3d493f7e3e89bf69bf0e,0x3f013f6fbe54bf80bde23f773ed5bf55
.octa 0xbf2abf393f373f2cbf44bf1d3f4f3f0e,0x3f40bf31bf333f3e3f25bf4abf163f55,0xbf1b3f6a3e3bbf803e8f3f5fbf2ebf0e,0xbf4cbecf3f7cbd49bf763efc3f3cbf55,0x3f663cc9bf6b3f3e3e9bbf7e3f063f0e,0xbee13f80becabf2c3f74bdfbbf5a3f55,0x3e82bf6f3f57bd49bf483f77beb2bf0e,0x3f78beb8bf0c3f80bf20be893f70bf55
.octa 0xbf803f31bc49bf2c3f7fbf4a3e233f0e,0x3d7bbf393f80bf3e3db03f1dbf7d3f55,0x3e0a3ecfbf533f80bf603efc3d17bf0e,0xbf7e3f6abf113d493ef7bf5f3f80bf55,0x3f72bf803f6ebf3e3eecbdfbbe6d3f0e,0x3ea73cc9bebe3f2cbf633f7ebf793f55,0xbf013eb8be543d493de2be893ed5bf0e,0x3f5dbf6f3f7abf803f7ebf773f69bf55
.octa 0x3f693f653f603f5c3f573f513f4c3f46,0x3ed53ee63ef73f043f0c3f133f1b3f22,0x3f4f3f273eec3e793c49be60bee1bf22,0x3f163f423f633f783f803f7a3f663f46,0x3f2e3ea1bde2bf04bf53bf7cbf78bf46,0x3f3c3f733f7e3f5c3f113e2fbe82bf22,0x3f06bd97bf25bf78bf6ebf093d7b3f22,0x3f5a3f7f3f443e79bebebf58bf80bf46
.octa 0x3eb2bee6bf76bf5cbe543f133f7e3f46,0x3f703f653e8fbf04bf7abf51be0a3f22,0x3e23bf42bf74be793f333f7a3ea7bf22,0x3f7d3f27be9bbf78bf373e603f723f46,0xbd17bf73bf203f043f7c3e2fbf5dbf46,0x3f803ea1bf48bf5c3e3b3f7c3f01bf22,0xbe6dbf7fbdb03f783ecabf58bf2a3f22,0x3f79bd97bf7fbe793f6b3f09bf40bf46
.octa 0xbed5bf653ef73f5cbf0cbf513f1b3f46,0x3f69bee6bf603f043f57bf13bf4c3f22,0xbf16bf273f633e79bf803e603f66bf22,0x3f4fbf42beec3f783c49bf7a3ee13f46,0xbf3cbea13f7ebf04bf113f7cbe82bf46,0x3f2ebf733de23f5cbf53be2f3f78bf22,0xbf5a3d973f44bf783ebe3f09bf803f22,0x3f06bf7f3f253e79bf6e3f58bd7bbf46
.octa 0xbf703ee63e8fbf5c3f7abf13be0a3f46,0x3eb2bf653f76bf04be543f51bf7e3f22,0xbf7d3f42be9bbe793f37bf7a3f72bf22,0x3e23bf273f74bf783f33be60bea73f46,0xbf803f73bf483f04be3bbe2f3f01bf46,0xbd17bea13f20bf5c3f7cbf7c3f5dbf22,0xbf793f7fbf7f3f78bf6b3f58bf403f22,0xbe6d3d973db0be793ecabf093f2abf46
.octa 0xbf783f7abf7c3f7dbf7e3f7fbf803f80,0x3e82be603e3bbe163de2bd973d178000,0x3d7b3e2fbeca3f18bf443f65bf793f80,0x3f80bf7c3f6bbf4e3f25bee63e6d8000,0x3f7ebf583f0cbe16be8f3f27bf693f80,0x3e0abf093f57bf7d3f76bf423ed58000,0x3ea7bf513f80bf4e3e9b3ea1bf4f3f80,0xbf723f133c49bf183f74bf733f168000
.octa 0xbf5d3e603f11bf7d3f48bd97bf2e3f80,0xbf013f7abf533e163f20bf7f3f3c8000,0xbf2a3f7cbebebf183f7fbee6bf063f80,0x3f403e2fbf6e3f4e3db0bf653f5a8000,0x3f1b3f09bf7a3e163f60bf42beb23f80,0x3f4cbf58be543f7dbef7bf273f708000,0x3f66bf13bf373f4e3eecbf73be233f80,0xbee1bf513f333f18bf63bea13f7d8000
.octa 0xbe82bf7a3e3b3f7dbde2bf7f3d173f80,0xbf783e603f7cbe16bf7e3d973f808000,0xbf80be2f3f6b3f18bf25bf653e6d3f80,0x3d7b3f7c3ecabf4ebf443ee63f798000,0xbe0a3f583f57be16bf76bf273ed53f80,0x3f7e3f09bf0cbf7dbe8f3f423f698000,0x3f723f513c49bf4ebf74bea13f163f80,0x3ea7bf13bf80bf183e9b3f733f4f8000
.octa 0x3f01be60bf53bf7dbf203d973f3c3f80,0xbf5dbf7abf113e163f483f7f3f2e8000,0xbf40bf7cbf6ebf18bdb03ee63f5a3f80,0xbf2abe2f3ebe3f4e3f7f3f653f068000,0xbf4cbf09be543e163ef73f423f703f80,0x3f1b3f583f7a3f7d3f603f273eb28000,0x3ee13f133f333f4e3f633f733f7d3f80,0x3f663f513f373f183eec3ea13e238000
.octa 0xbf5a3f5fbf633f67bf6b3f6fbf723f75,0x3f06befc3eecbedb3ecabeb83ea7be95,0x3f70bf7e3f7ebf713f57bf313f01be95,0xbeb23dfb3de2beac3f0cbf393f5dbf75,0xbf7d3f77bf443edbbc49becf3f40bf75,0x3e233e89bf253f67bf803f6abf2a3e95,0x3f80bf4a3e8f3eacbf533f80bf4c3e95,0x3d17bf1d3f76bf713f113cc9bf1b3f75
.octa 0xbf793efc3e9bbf673f6ebeb8bee13f75,0xbe6d3f5fbf743edb3ebebf6f3f66be95,0x3f69bdfbbf483f71be54bf393f78be95,0x3ed5bf7e3f203eacbf7a3f313e82bf75,0xbf4fbe893f7fbedbbf333f6a3d7bbf75,0xbf163f77bdb0bf673f373ecfbf803e95,0x3f2e3f1dbf60beac3f7c3cc9bf7e3e95,0x3f3cbf4abef73f713e3bbf803e0a3f75
.octa 0xbf06bf5f3eec3f67becabf6f3ea73f75,0xbf5a3efc3f63bedbbf6b3eb83f72be95,0x3eb23f7e3de2bf71bf0c3f313f5dbe95,0x3f70bdfbbf7ebeac3f573f39bf01bf75,0xbe23bf77bf253edb3f803ecfbf2abf75,0xbf7dbe893f443f67bc49bf6abf403e95,0xbd173f4a3f763eacbf11bf80bf1b3e95,0x3f803f1dbe8fbf71bf53bcc93f4c3f75
.octa 0x3e6dbefcbf74bf67bebe3eb83f663f75,0xbf79bf5fbe9b3edb3f6e3f6f3ee1be95,0xbed53dfb3f203f713f7a3f393e82be95,0x3f693f7e3f483eacbe54bf31bf78bf75,0x3f163e89bdb0bedbbf37bf6abf80bf75,0xbf4fbf77bf7fbf67bf33becfbd7b3e95,0xbf3cbf1dbef7beacbe3bbcc93e0a3e95,0x3f2e3f4a3f603f713f7c3f803f7e3f75
.octa 0xbf2a3f31bf373f3ebf443f4abf4f3f55,0x3f40bf393f33bf2c3f25bf1d3f16bf0e,0xbf1b3ecfbe3bbd493e8fbefc3f2ebf55,0xbf4c3f6abf7c3f80bf763f5fbf3c3f0e,0x3f66bf803f6bbf2c3e9b3dfbbf063f55,0xbee13cc93ecabf3e3f74bf7e3f5abf0e,0x3e823eb8bf573f80bf483e893eb2bf55,0x3f78bf6f3f0c3d49bf203f77bf703f0e
.octa 0xbf803f393c49bf3e3f7fbf1dbe233f55,0x3d7b3f31bf803f2c3db0bf4a3f7dbf0e,0x3e0abf6a3f533d49bf603f5fbd17bf55,0xbf7e3ecf3f11bf803ef73efcbf803f0e,0x3f72bcc9bf6e3f2c3eecbf7e3e6d3f55,0x3ea7bf803ebe3f3ebf63bdfb3f79bf0e,0xbf013f6f3e54bf803de23f77bed5bf55,0x3f5d3eb8bf7abd493f7ebe89bf693f0e
.octa 0xbf40bf313f333f3ebf25bf4a3f163f55,0xbf2a3f393f37bf2cbf443f1d3f4fbf0e,0x3f4cbecfbf7cbd493f763efcbf3cbf55,0xbf1bbf6a3e3b3f803e8fbf5fbf2e3f0e,0x3ee13f803ecabf2cbf74bdfb3f5a3f55,0x3f66bcc9bf6bbf3e3e9b3f7e3f06bf0e,0xbf78beb83f0c3f803f20be89bf70bf55,0x3e823f6f3f573d49bf48bf77beb23f0e
.octa 0xbd7bbf39bf80bf3ebdb03f1d3f7d3f55,0xbf80bf31bc493f2c3f7f3f4a3e23bf0e,0x3f7e3f6a3f113d49bef7bf5fbf80bf55,0x3e0abecfbf53bf80bf60befc3d173f0e,0xbea73cc93ebe3f2c3f633f7e3f793f55,0x3f723f803f6e3f3e3eec3dfbbe6dbf0e,0xbf5dbf6fbf7abf80bf7ebf77bf69bf55,0xbf01beb8be54bd493de23e893ed53f0e
.octa 0xbed53ee6bef73f04bf0c3f13bf1b3f22,0x3f69bf653f60bf5c3f57bf513f4cbf46,0xbf163f42bf633f78bf803f7abf663f46,0x3f4fbf273eecbe793c493e60bee13f22,0xbf3c3f73bf7e3f5cbf113e2f3e82bf22,0x3f2ebea1bde23f04bf533f7cbf783f46,0xbf5a3f7fbf443e793ebebf583f80bf46,0x3f063d97bf253f78bf6e3f093d7bbf22
.octa 0xbf703f65be8fbf043f7abf513e0a3f22,0x3eb23ee6bf763f5cbe54bf133f7ebf46,0xbf7d3f273e9bbf783f373e60bf723f46,0x3e233f42bf743e793f33bf7a3ea73f22,0xbf803ea13f48bf5cbe3b3f7cbf01bf22,0xbd173f73bf20bf043f7cbe2fbf5d3f46,0xbf79bd973f7fbe79bf6b3f093f40bf46,0xbe6d3f7fbdb0bf783eca3f58bf2abf22
.octa 0xbf69bee63f603f04bf57bf133f4c3f22,0xbed53f653ef7bf5cbf0c3f513f1bbf46,0xbf4fbf423eec3f78bc49bf7abee13f46,0xbf163f273f63be79bf80be603f663f22,0xbf2ebf73bde23f5c3f53be2fbf78bf22,0xbf3c3ea13f7e3f04bf11bf7cbe823f46,0xbf06bf7fbf253e793f6e3f583d7bbf46,0xbf5abd973f443f783ebebf09bf80bf22
.octa 0xbeb2bf65bf76bf043e543f513f7e3f22,0xbf70bee63e8f3f5c3f7a3f13be0abf46,0xbe23bf27bf74bf78bf33be603ea73f46,0xbf7dbf42be9b3e793f373f7a3f723f22,0x3d17bea1bf20bf5cbf7cbf7cbf5dbf22,0xbf80bf73bf48bf04be3b3e2f3f013f46,0x3e6d3d97bdb0be79becabf09bf2abf46,0xbf79bf7fbf7fbf78bf6bbf58bf40bf22
.octa 0xbe823e60be3b3e16bde23d97bd170000,0xbf783f7abf7c3f7dbf7e3f7fbf803f80,0xbf803f7cbf6b3f4ebf253ee6be6d0000,0x3d7b3e2fbeca3f18bf443f65bf793f80,0xbe0a3f09bf573f7dbf763f42bed50000,0x3f7ebf583f0cbe16be8f3f27bf693f80,0x3f72bf13bc493f18bf743f73bf160000,0x3ea7bf513f80bf4e3e9b3ea1bf4f3f80
.octa 0x3f01bf7a3f53be16bf203f7fbf3c0000,0xbf5d3e603f11bf7d3f48bd97bf2e3f80,0xbf40be2f3f6ebf4ebdb03f65bf5a0000,0xbf2a3f7cbebebf183f7fbee6bf063f80,0xbf4c3f583e54bf7d3ef73f27bf700000,0x3f1b3f09bf7a3e163f60bf42beb23f80,0x3ee13f51bf33bf183f633ea1bf7d0000,0x3f66bf13bf373f4e3eecbf73be233f80
.octa 0x3f78be60bf7c3e163f7ebd97bf800000,0xbe82bf7a3e3b3f7dbde2bf7f3d173f80,0xbd7bbf7cbeca3f4e3f44bee6bf790000,0xbf80be2f3f6b3f18bf25bf653e6d3f80,0xbf7ebf093f0c3f7d3e8fbf42bf690000,0xbe0a3f583f57be16bf76bf273ed53f80,0xbea73f133f803f18be9bbf73bf4f0000,0x3f723f513c49bf4ebf74bea13f163f80
.octa 0x3f5d3f7a3f11be16bf48bf7fbf2e0000,0x3f01be60bf53bf7dbf203d973f3c3f80,0x3f2a3e2fbebebf4ebf7fbf65bf060000,0xbf40bf7cbf6ebf18bdb03ee63f5a3f80,0xbf1bbf58bf7abf7dbf60bf27beb20000,0xbf4cbf09be543e163ef73f423f703f80,0xbf66bf51bf37bf18beecbea1be230000,0x3ee13f133f333f4e3f633f733f7d3f80
.octa 0xbf063efcbeec3edbbeca3eb8bea73e95,0xbf5a3f5fbf633f67bf6b3f6fbf723f75,0x3eb2bdfbbde23eacbf0c3f39bf5d3f75,0x3f70bf7e3f7ebf713f57bf313f01be95,0xbe23be893f25bf673f80bf6a3f2abe95,0xbf7d3f77bf443edbbc49becf3f40bf75,0xbd173f1dbf763f71bf11bcc93f1bbf75,0x3f80bf4a3e8f3eacbf533f80bf4c3e95
.octa 0x3e6dbf5f3f74bedbbebe3f6fbf663e95,0xbf793efc3e9bbf673f6ebeb8bee13f75,0xbed53f7ebf20beac3f7abf31be823f75,0x3f69bdfbbf483f71be54bf393f78be95,0x3f16bf773db03f67bf37becf3f80be95,0xbf4fbe893f7fbedbbf333f6a3d7bbf75,0xbf3c3f4a3ef7bf71be3b3f80be0abf75,0x3f2e3f1dbf60beac3f7c3cc9bf7e3e95
.octa 0x3f5abefcbf633edb3f6bbeb8bf723e95,0xbf06bf5f3eec3f67becabf6f3ea73f75,0xbf703dfb3f7e3eacbf57bf393f013f75,0x3eb23f7e3de2bf71bf0c3f313f5dbe95,0x3f7d3e89bf44bf673c493f6a3f40be95,0xbe23bf77bf253edb3f803ecfbf2abf75,0xbf80bf1d3e8f3f713f533cc9bf4cbf75,0xbd173f4a3f763eacbf11bf80bf1b3e95
.octa 0x3f793f5f3e9bbedbbf6ebf6fbee13e95,0x3e6dbefcbf74bf67bebe3eb83f663f75,0xbf69bf7ebf48beac3e543f313f783f75,0xbed53dfb3f203f713f7a3f393e82be95,0x3f4f3f773f7f3f673f333ecf3d7bbe95,0x3f163e89bdb0bedbbf37bf6abf80bf75,0xbf2ebf4abf60bf71bf7cbf80bf7ebf75,0xbf3cbf1dbef7beacbe3bbcc93e0a3e95
.octa 0xbf403f39bf333f2cbf253f1dbf163f0e,0xbf2a3f31bf373f3ebf443f4abf4f3f55,0x3f4cbf6a3f7cbf803f76bf5f3f3cbf0e,0xbf1b3ecfbe3bbd493e8fbefc3f2ebf55,0x3ee1bcc9beca3f3ebf743f7ebf5a3f0e,0x3f66bf803f6bbf2c3e9b3dfbbf063f55,0xbf783f6fbf0cbd493f20bf773f70bf0e,0x3e823eb8bf573f80bf483e893eb2bf55
.octa 0xbd7bbf313f80bf2cbdb03f4abf7d3f0e,0xbf803f393c49bf3e3f7fbf1dbe233f55,0x3f7ebecfbf113f80bef7befc3f80bf0e,0x3e0abf6a3f533d49bf603f5fbd17bf55,0xbea73f80bebebf3e3f633dfbbf793f0e,0x3f72bcc9bf6e3f2c3eecbf7e3e6d3f55,0xbf5dbeb83f7a3d49bf7e3e893f69bf0e,0xbf013f6f3e54bf803de23f77bed5bf55
.octa 0x3f2abf39bf373f2c3f44bf1dbf4f3f0e,0xbf40bf313f333f3ebf25bf4a3f163f55,0x3f1b3f6abe3bbf80be8f3f5f3f2ebf0e,0x3f4cbecfbf7cbd493f763efcbf3cbf55,0xbf663cc93f6b3f3ebe9bbf7ebf063f0e,0x3ee13f803ecabf2cbf74bdfb3f5a3f55,0xbe82bf6fbf57bd493f483f773eb2bf0e,0xbf78beb83f0c3f803f20be89bf70bf55
.octa 0x3f803f313c49bf2cbf7fbf4abe233f0e,0xbd7bbf39bf80bf3ebdb03f1d3f7d3f55,0xbe0a3ecf3f533f803f603efcbd17bf0e,0x3f7e3f6a3f113d49bef7bf5fbf80bf55,0xbf72bf80bf6ebf3ebeecbdfb3e6d3f0e,0xbea73cc93ebe3f2c3f633f7e3f793f55,0x3f013eb83e543d49bde2be89bed5bf0e,0xbf5dbf6fbf7abf80bf7ebf77bf69bf55
.octa 0xbf693f65bf603f5cbf573f51bf4c3f46,0xbed53ee6bef73f04bf0c3f13bf1b3f22,0xbf4f3f27beec3e79bc49be603ee1bf22,0xbf163f42bf633f78bf803f7abf663f46,0xbf2e3ea13de2bf043f53bf7c3f78bf46,0xbf3c3f73bf7e3f5cbf113e2f3e82bf22,0xbf06bd973f25bf783f6ebf09bd7b3f22,0xbf5a3f7fbf443e793ebebf583f80bf46
.octa 0xbeb2bee63f76bf5c3e543f13bf7e3f46,0xbf703f65be8fbf043f7abf513e0a3f22,0xbe23bf423f74be79bf333f7abea7bf22,0xbf7d3f273e9bbf783f373e60bf723f46,0x3d17bf733f203f04bf7c3e2f3f5dbf46,0xbf803ea13f48bf5cbe3b3f7cbf01bf22,0x3e6dbf7f3db03f78becabf583f2a3f22,0xbf79bd973f7fbe79bf6b3f093f40bf46
.octa 0x3ed5bf65bef73f5c3f0cbf51bf1b3f46,0xbf69bee63f603f04bf57bf133f4c3f22,0x3f16bf27bf633e793f803e60bf66bf22,0xbf4fbf423eec3f78bc49bf7abee13f46,0x3f3cbea1bf7ebf043f113f7c3e82bf46,0xbf2ebf73bde23f5c3f53be2fbf78bf22,0x3f5a3d97bf44bf78bebe3f093f803f22,0xbf06bf7fbf253e793f6e3f583d7bbf46
.octa 0x3f703ee6be8fbf5cbf7abf133e0a3f46,0xbeb2bf65bf76bf043e543f513f7e3f22,0x3f7d3f423e9bbe79bf37bf7abf72bf22,0xbe23bf27bf74bf78bf33be603ea73f46,0x3f803f733f483f043e3bbe2fbf01bf46,0x3d17bea1bf20bf5cbf7cbf7cbf5dbf22,0x3f793f7f3f7f3f783f6b3f583f403f22,0x3e6d3d97bdb0be79becabf09bf2abf46
.octa 0x3f763f793f7b3f7d3f7e3f7f3f803f80,0xbe8dbe73be4bbe23bdf4bda3bd238000,0xbda93e1c3ec23f163f423f643f793f80,0xbf7fbf7dbf6dbf4fbf27bee9be708000,0xbf7ebf5bbf0fbe233e8a3f263f683f80,0xbde8bf05bf54bf7dbf77bf43bed78000,0xbe9cbf4fbf80bf4fbe9f3e9e3f4f3f80,0x3f743f173b49bf16bf73bf74bf178000
.octa 0x3f603e73bf0ebf7dbf49bda33f2e3f80,0x3ef83f793f553e23bf1ebf7fbf3c8000,0x3f253f7d3ec5bf16bf7fbee93f063f80,0xbf433e1c3f6c3f4fbd9dbf64bf5a8000,0xbf1f3f053f7b3e23bf5fbf433eb13f80,0xbf48bf5b3e453f7d3efbbf26bf708000,0xbf64bf173f343f4fbee8bf743e203f80,0x3eeabf4fbf363f163f64be9ebf7d8000
.octa 0x3e8dbf79be4b3f7d3df4bf7fbd233f80,0x3f763e73bf7bbe233f7e3da3bf808000,0x3f7fbe1cbf6d3f163f27bf64be703f80,0xbda93f7dbec2bf4f3f423ee9bf798000,0x3de83f5bbf54be233f77bf26bed73f80,0xbf7e3f053f0fbf7d3e8a3f43bf688000,0xbf743f4f3b49bf4f3f73be9ebf173f80,0xbe9cbf173f80bf16be9f3f74bf4f8000
.octa 0xbef8be733f55bf7d3f1e3da3bf3c3f80,0x3f60bf793f0e3e23bf493f7fbf2e8000,0x3f43bf7d3f6cbf163d9d3ee9bf5a3f80,0x3f25be1cbec53f4fbf7f3f64bf068000,0x3f48bf053e453e23befb3f43bf703f80,0xbf1f3f5bbf7b3f7dbf5f3f26beb18000,0xbeea3f17bf363f4fbf643f74bf7d3f80,0xbf643f4fbf343f16bee83e9ebe208000
.octa 0x3f543f593f5e3f633f683f6c3f703f73,0xbf10bf08befebeecbed9bec7beb4bea1,0xbf6cbf7cbf7fbf74bf5bbf36bf07bea1,0x3ec83e29bd90be9bbf04bf34bf5abf73,0x3f7b3f793f4a3eec3d3cbec1bf3bbf73,0xbe513e663f1d3f633f803f6d3f2f3ea1,0xbf80bf50bea23e9b3f4e3f803f503ea1,0x3c17bf15bf73bf74bf18bbc93f153f73
.octa 0x3f7c3f08be87bf63bf71bec73ed43f73,0x3e3f3f593f773eecbeaebf6cbf69bea1,0xbf6dbe293f413f743e76bf34bf79bea1,0xbec0bf7cbf283e9b3f793f36be6abf73,0x3f56be66bf7ebeec3f2d3f6dbd0abf73,0x3f0c3f793e00bf63bf3d3ec13f803ea1,0xbf373f153f65be9bbf7dbbc93f7d3ea1,0xbf33bf503ee53f74be19bf80be263f73
.octa 0x3f10bf59befe3f633ed9bf6cbeb43f73,0x3f543f08bf5ebeec3f683ec7bf70bea1,0xbec83f7cbd90bf743f043f36bf5abea1,0xbf6cbe293f7fbe9bbf5b3f343f07bf73,0x3e51bf793f1d3eecbf803ec13f2fbf73,0x3f7bbe66bf4a3f633d3cbf6d3f3b3ea1,0xbc173f50bf733e9b3f18bf803f153ea1,0xbf803f153ea2bf743f4e3bc9bf503f73
.octa 0xbe3fbf083f77bf633eae3ec7bf693f73,0x3f7cbf593e873eecbf713f6cbed4bea1,0x3ec03e29bf283f74bf793f34be6abea1,0xbf6d3f7cbf413e9b3e76bf363f79bf73,0xbf0c3e663e00beec3f3dbf6d3f80bf73,0x3f56bf793f7ebf633f2dbec13d0a3ea1,0x3f33bf153ee5be9b3e193bc9be263ea1,0xbf373f50bf653f74bf7d3f80bf7d3f73
.octa 0x3f1c3f243f2b3f333f3a3f413f473f4e,0xbf4bbf45bf3ebf37bf30bf28bf21bf18,0x3f293eef3e7c3c49be63bee3bf24bf4e,0x3f403f633f783f803f7a3f653f443f18,0xbf5ebf7fbf71bf37beb73d8a3ef63f4e,0x3f003dbcbeabbf33bf6fbf7fbf61bf18,0xbea53e983f4d3f803f513ea4be99bf4e,0xbf72bf75bf19bc493f143f733f743f18
.octa 0x3f7e3f453d56bf33bf80bf283ddb3f4e,0xbe073f243f803f37bce2bf41bf7fbf18,0xbd84bf63bf5cbc493f593f653db6bf4e,0x3f7f3eefbf03bf80bf083ee33f7f3f18,0xbf77bdbc3f673f37bed1bf7fbe903f4e,0xbe84bf7fbedc3f333f6abd8abf76bf18,0x3ee23f75be13bf80be2c3f733eedbf4e,0xbf663e983f7d3c49bf7cbea43f633f18
.octa 0x3f4bbf24bf3e3f333f30bf41bf213f4e,0x3f1c3f45bf2bbf373f3a3f28bf47bf18,0xbf40beef3f783c49bf7a3ee33f44bf4e,0x3f29bf63be7c3f80be63bf653f243f18,0xbf003f7fbeabbf373f6fbd8abf613f4e,0xbf5ebdbc3f71bf33beb73f7fbef6bf18,0x3f72be98bf193f80bf14bea43f74bf4e,0xbea53f75bf4dbc493f51bf733e993f18
.octa 0x3e07bf453f80bf333ce23f28bf7f3f4e,0x3f7ebf24bd563f37bf803f41bddbbf18,0xbf7f3f63bf03bc493f08bf653f7fbf4e,0xbd84beef3f5cbf803f59bee3bdb63f18,0x3e843dbcbedc3f37bf6a3f7fbf763f4e,0xbf773f7fbf673f33bed13d8a3e90bf18,0x3f66bf753f7dbf803f7cbf733f63bf4e,0x3ee2be983e133c49be2c3ea4beed3f18
.octa 0x3ea83ebb3ece3ee13ef33f023f0b3f13,0xbf72bf6ebf6abf66bf61bf5cbf57bf51,0x3f023f323f583f723f7f3f7d3f6e3f51,0xbf5dbf38bf0abea7bdc23e103ebd3f13,0x3f2a3f6b3f803f663f223e7fbe38bf13,0xbf3fbecd3cb03ee13f463f783f7c3f51,0x3f4c3f803f523ea7be96bf4dbf80bf51,0xbf1abc973f133f723f753f1a3c7bbf13
.octa 0x3f663f6e3ebabee1bf75bf5cbe573f13,0xbedf3ebb3f6f3f663e93bf02bf7abf51,0x3f783f38be5dbf72bf453e103f6b3f51,0xbe813f323f7a3ea7bf23bf7dbecb3f13,0x3f803ecdbf39bf663dcf3f783f11bf13,0xbd6f3f6b3f31bee1bf7fbe7f3f533f51,0x3f7e3c97bf7cbea73f623f1abf32bf51,0x3e0d3f803e32bf72bef03f4d3f38bf13
.octa 0x3f72bebbbf6a3ee13f61bf02bf573f13,0x3ea83f6ebecebf663ef33f5cbf0bbf51,0x3f5dbf32bf0a3f723dc2bf7d3ebd3f51,0x3f023f38bf58bea73f7fbe10bf6e3f13,0x3f3fbf6b3cb03f66bf46be7f3f7cbf13,0x3f2a3ecdbf803ee13f22bf783e383f51,0x3f1abf803f133ea7bf753f4d3c7bbf51,0x3f4c3c97bf523f72be96bf1a3f80bf13
.octa 0x3edfbf6e3f6fbee1be933f5cbf7a3f13,0x3f66bebbbeba3f66bf753f023e57bf51,0x3e81bf383f7abf723f23be10becb3f51,0x3f78bf323e5d3ea7bf453f7dbf6b3f13,0x3d6fbecd3f31bf663f7fbf783f53bf13,0x3f80bf6b3f39bee13dcf3e7fbf113f51,0xbe0dbc973e32bea73ef0bf1a3f38bf51,0x3f7ebf803f7cbf723f62bf4d3f32bf13
.octa 0x3e8d3e733e4b3e233df43da33d230000,0x3f763f793f7b3f7d3f7e3f7f3f803f80,0x3f7f3f7d3f6d3f4f3f273ee93e700000,0xbda93e1c3ec23f163f423f643f793f80,0x3de83f053f543f7d3f773f433ed70000,0xbf7ebf5bbf0fbe233e8a3f263f683f80,0xbf74bf17bb493f163f733f743f170000,0xbe9cbf4fbf80bf4fbe9f3e9e3f4f3f80
.octa 0xbef8bf79bf55be233f1e3f7f3f3c0000,0x3f603e73bf0ebf7dbf49bda33f2e3f80,0x3f43be1cbf6cbf4f3d9d3f643f5a0000,0x3f253f7d3ec5bf16bf7fbee93f063f80,0x3f483f5bbe45bf7dbefb3f263f700000,0xbf1f3f053f7b3e23bf5fbf433eb13f80,0xbeea3f4f3f36bf16bf643e9e3f7d0000,0xbf64bf173f343f4fbee8bf743e203f80
.octa 0xbf76be733f7b3e23bf7ebda33f800000,0x3e8dbf79be4b3f7d3df4bf7fbd233f80,0x3da9bf7d3ec23f4fbf42bee93f790000,0x3f7fbe1cbf6d3f163f27bf64be703f80,0x3f7ebf05bf0f3f7dbe8abf433f680000,0x3de83f5bbf54be233f77bf26bed73f80,0x3e9c3f17bf803f163e9fbf743f4f0000,0xbf743f4f3b49bf4f3f73be9ebf173f80
.octa 0xbf603f79bf0ebe233f49bf7f3f2e0000,0xbef8be733f55bf7d3f1e3da3bf3c3f80,0xbf253e1c3ec5bf4f3f7fbf643f060000,0x3f43bf7d3f6cbf163d9d3ee9bf5a3f80,0x3f1fbf5b3f7bbf7d3f5fbf263eb10000,0x3f48bf053e453e23befb3f43bf703f80,0x3f64bf4f3f34bf163ee8be9e3e200000,0xbeea3f17bf363f4fbf643f74bf7d3f80
.octa 0x3f103f083efe3eec3ed93ec73eb43ea1,0x3f543f593f5e3f633f683f6c3f703f73,0xbec8be293d903e9b3f043f343f5a3f73,0xbf6cbf7cbf7fbf74bf5bbf36bf07bea1,0x3e51be66bf1dbf63bf80bf6dbf2fbea1,0x3f7b3f793f4a3eec3d3cbec1bf3bbf73,0xbc173f153f733f743f183bc9bf15bf73,0xbf80bf50bea23e9b3f4e3f803f503ea1
.octa 0xbe3fbf59bf77beec3eae3f6c3f693ea1,0x3f7c3f08be87bf63bf71bec73ed43f73,0x3ec03f7c3f28be9bbf79bf363e6a3f73,0xbf6dbe293f413f743e76bf34bf79bea1,0xbf0cbf79be003f633f3dbec1bf80bea1,0x3f56be66bf7ebeec3f2d3f6dbd0abf73,0x3f333f50bee5bf743e193f803e26bf73,0xbf373f153f65be9bbf7dbbc93f7d3ea1
.octa 0xbf54bf083f5e3eecbf68bec73f703ea1,0x3f10bf59befe3f633ed9bf6cbeb43f73,0x3f6c3e29bf7f3e9b3f5bbf34bf073f73,0xbec83f7cbd90bf743f043f36bf5abea1,0xbf7b3e663f4abf63bd3c3f6dbf3bbea1,0x3e51bf793f1d3eecbf803ec13f2fbf73,0x3f80bf15bea23f74bf4ebbc93f50bf73,0xbc173f50bf733e9b3f18bf803f153ea1
.octa 0xbf7c3f59be87beec3f71bf6c3ed43ea1,0xbe3fbf083f77bf633eae3ec7bf693f73,0x3f6dbf7c3f41be9bbe763f36bf793f73,0x3ec03e29bf283f74bf793f34be6abea1,0xbf563f79bf7e3f63bf2d3ec1bd0abea1,0xbf0c3e663e00beec3f3dbf6d3f80bf73,0x3f37bf503f65bf743f7dbf803f7dbf73,0x3f33bf153ee5be9b3e193bc9be263ea1
.octa 0x3f4b3f453f3e3f373f303f283f213f18,0x3f1c3f243f2b3f333f3a3f413f473f4e,0xbf40bf63bf78bf80bf7abf65bf44bf18,0x3f293eef3e7c3c49be63bee3bf24bf4e,0xbf00bdbc3eab3f333f6f3f7f3f613f18,0xbf5ebf7fbf71bf37beb73d8a3ef63f4e,0x3f723f753f193c49bf14bf73bf74bf18,0xbea53e983f4d3f803f513ea4be99bf4e
.octa 0x3e07bf24bf80bf373ce23f413f7f3f18,0x3f7e3f453d56bf33bf80bf283ddb3f4e,0xbf7fbeef3f033f803f08bee3bf7fbf18,0xbd84bf63bf5cbc493f593f653db6bf4e,0x3e843f7f3edcbf33bf6a3d8a3f763f18,0xbf77bdbc3f673f37bed1bf7fbe903f4e,0x3f66be98bf7dbc493f7c3ea4bf63bf18,0x3ee23f75be13bf80be2c3f733eedbf4e
.octa 0xbf1cbf453f2b3f37bf3abf283f473f18,0x3f4bbf24bf3e3f333f30bf41bf213f4e,0xbf293f633e7cbf803e633f65bf24bf18,0xbf40beef3f783c49bf7a3ee33f44bf4e,0x3f5e3dbcbf713f333eb7bf7f3ef63f18,0xbf003f7fbeabbf373f6fbd8abf613f4e,0x3ea5bf753f4d3c49bf513f73be99bf18,0x3f72be98bf193f80bf14bea43f74bf4e
.octa 0xbf7e3f243d56bf373f80bf413ddb3f18,0x3e07bf453f80bf333ce23f28bf7f3f4e,0x3d843eefbf5c3f80bf593ee33db6bf18,0xbf7f3f63bf03bc493f08bf653f7fbf4e,0x3f77bf7f3f67bf333ed1bd8abe903f18,0x3e843dbcbedc3f37bf6a3f7fbf763f4e,0xbee23e98be13bc493e2cbea43eedbf18,0x3f66bf753f7dbf803f7cbf733f63bf4e
.octa 0x3f723f6e3f6a3f663f613f5c3f573f51,0x3ea83ebb3ece3ee13ef33f023f0b3f13,0x3f5d3f383f0a3ea73dc2be10bebdbf13,0x3f023f323f583f723f7f3f7d3f6e3f51,0x3f3f3ecdbcb0bee1bf46bf78bf7cbf51,0x3f2a3f6b3f803f663f223e7fbe38bf13,0x3f1a3c97bf13bf72bf75bf1abc7b3f13,0x3f4c3f803f523ea7be96bf4dbf80bf51
.octa 0x3edfbebbbf6fbf66be933f023f7a3f51,0x3f663f6e3ebabee1bf75bf5cbe573f13,0x3e81bf32bf7abea73f233f7d3ecbbf13,0x3f783f38be5dbf72bf453e103f6b3f51,0x3d6fbf6bbf313ee13f7f3e7fbf53bf51,0x3f803ecdbf39bf663dcf3f783f11bf13,0xbe0dbf80be323f723ef0bf4dbf383f13,0x3f7e3c97bf7cbea73f623f1abf32bf51
.octa 0xbea8bf6e3ece3f66bef3bf5c3f0b3f51,0x3f72bebbbf6a3ee13f61bf02bf573f13,0xbf02bf383f583ea7bf7f3e103f6ebf13,0x3f5dbf32bf0a3f723dc2bf7d3ebd3f51,0xbf2abecd3f80bee1bf223f78be38bf51,0x3f3fbf6b3cb03f66bf46be7f3f7cbf13,0xbf4cbc973f52bf723e963f1abf803f13,0x3f1abf803f133ea7bf753f4d3c7bbf51
.octa 0xbf663ebb3ebabf663f75bf02be573f51,0x3edfbf6e3f6fbee1be933f5cbf7a3f13,0xbf783f32be5dbea73f45bf7d3f6bbf13,0x3e81bf383f7abf723f23be10becb3f51,0xbf803f6bbf393ee1bdcfbe7f3f11bf51,0x3d6fbecd3f31bf663f7fbf783f53bf13,0xbf7e3f80bf7c3f72bf623f4dbf323f13,0xbe0dbc973e32bea73ef0bf1a3f38bf51
.octa 0xbf763f79bf7b3f7dbf7e3f7fbf803f80,0x3e8dbe733e4bbe233df4bda33d238000,0x3da93e1cbec23f16bf423f64bf793f80,0x3f7fbf7d3f6dbf4f3f27bee93e708000,0x3f7ebf5b3f0fbe23be8a3f26bf683f80,0x3de8bf053f54bf7d3f77bf433ed78000,0x3e9cbf4f3f80bf4f3e9f3e9ebf4f3f80,0xbf743f17bb49bf163f73bf743f178000
.octa 0xbf603e733f0ebf7d3f49bda3bf2e3f80,0xbef83f79bf553e233f1ebf7f3f3c8000,0xbf253f7dbec5bf163f7fbee9bf063f80,0x3f433e1cbf6c3f4f3d9dbf643f5a8000,0x3f1f3f05bf7b3e233f5fbf43beb13f80,0x3f48bf5bbe453f7dbefbbf263f708000,0x3f64bf17bf343f4f3ee8bf74be203f80,0xbeeabf4f3f363f16bf64be9e3f7d8000
.octa 0xbe8dbf793e4b3f7dbdf4bf7f3d233f80,0xbf763e733f7bbe23bf7e3da33f808000,0xbf7fbe1c3f6d3f16bf27bf643e703f80,0x3da93f7d3ec2bf4fbf423ee93f798000,0xbde83f5b3f54be23bf77bf263ed73f80,0x3f7e3f05bf0fbf7dbe8a3f433f688000,0x3f743f4fbb49bf4fbf73be9e3f173f80,0x3e9cbf17bf80bf163e9f3f743f4f8000
.octa 0x3ef8be73bf55bf7dbf1e3da33f3c3f80,0xbf60bf79bf0e3e233f493f7f3f2e8000,0xbf43bf7dbf6cbf16bd9d3ee93f5a3f80,0xbf25be1c3ec53f4f3f7f3f643f068000,0xbf48bf05be453e233efb3f433f703f80,0x3f1f3f5b3f7b3f7d3f5f3f263eb18000,0x3eea3f173f363f4f3f643f743f7d3f80,0x3f643f4f3f343f163ee83e9e3e208000
.octa 0xbf543f59bf5e3f63bf683f6cbf703f73,0x3f10bf083efebeec3ed9bec73eb4bea1,0x3f6cbf7c3f7fbf743f5bbf363f07bea1,0xbec83e293d90be9b3f04bf343f5abf73,0xbf7b3f79bf4a3eecbd3cbec13f3bbf73,0x3e513e66bf1d3f63bf803f6dbf2f3ea1,0x3f80bf503ea23e9bbf4e3f80bf503ea1,0xbc17bf153f73bf743f18bbc9bf153f73
.octa 0xbf7c3f083e87bf633f71bec7bed43f73,0xbe3f3f59bf773eec3eaebf6c3f69bea1,0x3f6dbe29bf413f74be76bf343f79bea1,0x3ec0bf7c3f283e9bbf793f363e6abf73,0xbf56be663f7ebeecbf2d3f6d3d0abf73,0xbf0c3f79be00bf633f3d3ec1bf803ea1,0x3f373f15bf65be9b3f7dbbc9bf7d3ea1,0x3f33bf50bee53f743e19bf803e263f73
.octa 0xbf10bf593efe3f63bed9bf6c3eb43f73,0xbf543f083f5ebeecbf683ec73f70bea1,0x3ec83f7c3d90bf74bf043f363f5abea1,0x3f6cbe29bf7fbe9b3f5b3f34bf07bf73,0xbe51bf79bf1d3eec3f803ec1bf2fbf73,0xbf7bbe663f4a3f63bd3cbf6dbf3b3ea1,0x3c173f503f733e9bbf18bf80bf153ea1,0x3f803f15bea2bf74bf4e3bc93f503f73
.octa 0x3e3fbf08bf77bf63beae3ec73f693f73,0xbf7cbf59be873eec3f713f6c3ed4bea1,0xbec03e293f283f743f793f343e6abea1,0x3f6d3f7c3f413e9bbe76bf36bf79bf73,0x3f0c3e66be00beecbf3dbf6dbf80bf73,0xbf56bf79bf7ebf63bf2dbec1bd0a3ea1,0xbf33bf15bee5be9bbe193bc93e263ea1,0x3f373f503f653f743f7d3f803f7d3f73
.octa 0xbf1c3f24bf2b3f33bf3a3f41bf473f4e,0x3f4bbf453f3ebf373f30bf283f21bf18,0xbf293eefbe7c3c493e63bee33f24bf4e,0xbf403f63bf783f80bf7a3f65bf443f18,0x3f5ebf7f3f71bf373eb73d8abef63f4e,0xbf003dbc3eabbf333f6fbf7f3f61bf18,0x3ea53e98bf4d3f80bf513ea43e99bf4e,0x3f72bf753f19bc49bf143f73bf743f18
.octa 0xbf7e3f45bd56bf333f80bf28bddb3f4e,0x3e073f24bf803f373ce2bf413f7fbf18,0x3d84bf633f5cbc49bf593f65bdb6bf4e,0xbf7f3eef3f03bf803f083ee3bf7f3f18,0x3f77bdbcbf673f373ed1bf7f3e903f4e,0x3e84bf7f3edc3f33bf6abd8a3f76bf18,0xbee23f753e13bf803e2c3f73beedbf4e,0x3f663e98bf7d3c493f7cbea4bf633f18
.octa 0xbf4bbf243f3e3f33bf30bf413f213f4e,0xbf1c3f453f2bbf37bf3a3f283f47bf18,0x3f40beefbf783c493f7a3ee3bf44bf4e,0xbf29bf633e7c3f803e63bf65bf243f18,0x3f003f7f3eabbf37bf6fbd8a3f613f4e,0x3f5ebdbcbf71bf333eb73f7f3ef6bf18,0xbf72be983f193f803f14bea4bf74bf4e,0x3ea53f753f4dbc49bf51bf73be993f18
.octa 0xbe07bf45bf80bf33bce23f283f7f3f4e,0xbf7ebf243d563f373f803f413ddbbf18,0x3f7f3f633f03bc49bf08bf65bf7fbf4e,0x3d84beefbf5cbf80bf59bee33db63f18,0xbe843dbc3edc3f373f6a3f7f3f763f4e,0x3f773f7f3f673f333ed13d8abe90bf18,0xbf66bf75bf7dbf80bf7cbf73bf63bf4e,0xbee2be98be133c493e2c3ea43eed3f18
.octa 0xbea83ebbbece3ee1bef33f02bf0b3f13,0x3f72bf6e3f6abf663f61bf5c3f57bf51,0xbf023f32bf583f72bf7f3f7dbf6e3f51,0x3f5dbf383f0abea73dc23e10bebd3f13,0xbf2a3f6bbf803f66bf223e7f3e38bf13,0x3f3fbecdbcb03ee1bf463f78bf7c3f51,0xbf4c3f80bf523ea73e96bf4d3f80bf51,0x3f1abc97bf133f72bf753f1abc7bbf13
.octa 0xbf663f6ebebabee13f75bf5c3e573f13,0x3edf3ebbbf6f3f66be93bf023f7abf51,0xbf783f383e5dbf723f453e10bf6b3f51,0x3e813f32bf7a3ea73f23bf7d3ecb3f13,0xbf803ecd3f39bf66bdcf3f78bf11bf13,0x3d6f3f6bbf31bee13f7fbe7fbf533f51,0xbf7e3c973f7cbea7bf623f1a3f32bf51,0xbe0d3f80be32bf723ef03f4dbf38bf13
.octa 0xbf72bebb3f6a3ee1bf61bf023f573f13,0xbea83f6e3ecebf66bef33f5c3f0bbf51,0xbf5dbf323f0a3f72bdc2bf7dbebd3f51,0xbf023f383f58bea7bf7fbe103f6e3f13,0xbf3fbf6bbcb03f663f46be7fbf7cbf13,0xbf2a3ecd3f803ee1bf22bf78be383f51,0xbf1abf80bf133ea73f753f4dbc7bbf51,0xbf4c3c973f523f723e96bf1abf80bf13
.octa 0xbedfbf6ebf6fbee13e933f5c3f7a3f13,0xbf66bebb3eba3f663f753f02be57bf51,0xbe81bf38bf7abf72bf23be103ecb3f51,0xbf78bf32be5d3ea73f453f7d3f6b3f13,0xbd6fbecdbf31bf66bf7fbf78bf53bf13,0xbf80bf6bbf39bee1bdcf3e7f3f113f51,0x3e0dbc97be32bea7bef0bf1abf38bf51,0xbf7ebf80bf7cbf72bf62bf4dbf32bf13
.octa 0xbe8d3e73be4b3e23bdf43da3bd230000,0xbf763f79bf7b3f7dbf7e3f7fbf803f80,0xbf7f3f7dbf6d3f4fbf273ee9be700000,0x3da93e1cbec23f16bf423f64bf793f80,0xbde83f05bf543f7dbf773f43bed70000,0x3f7ebf5b3f0fbe23be8a3f26bf683f80,0x3f74bf173b493f16bf733f74bf170000,0x3e9cbf4f3f80bf4f3e9f3e9ebf4f3f80
.octa 0x3ef8bf793f55be23bf1e3f7fbf3c0000,0xbf603e733f0ebf7d3f49bda3bf2e3f80,0xbf43be1c3f6cbf4fbd9d3f64bf5a0000,0xbf253f7dbec5bf163f7fbee9bf063f80,0xbf483f5b3e45bf7d3efb3f26bf700000,0x3f1f3f05bf7b3e233f5fbf43beb13f80,0x3eea3f4fbf36bf163f643e9ebf7d0000,0x3f64bf17bf343f4f3ee8bf74be203f80
.octa 0x3f76be73bf7b3e233f7ebda3bf800000,0xbe8dbf793e4b3f7dbdf4bf7f3d233f80,0xbda9bf7dbec23f4f3f42bee9bf790000,0xbf7fbe1c3f6d3f16bf27bf643e703f80,0xbf7ebf053f0f3f7d3e8abf43bf680000,0xbde83f5b3f54be23bf77bf263ed73f80,0xbe9c3f173f803f16be9fbf74bf4f0000,0x3f743f4fbb49bf4fbf73be9e3f173f80
.octa 0x3f603f793f0ebe23bf49bf7fbf2e0000,0x3ef8be73bf55bf7dbf1e3da33f3c3f80,0x3f253e1cbec5bf4fbf7fbf64bf060000,0xbf43bf7dbf6cbf16bd9d3ee93f5a3f80,0xbf1fbf5bbf7bbf7dbf5fbf26beb10000,0xbf48bf05be453e233efb3f433f703f80,0xbf64bf4fbf34bf16bee8be9ebe200000,0x3eea3f173f363f4f3f643f743f7d3f80
.octa 0xbf103f08befe3eecbed93ec7beb43ea1,0xbf543f59bf5e3f63bf683f6cbf703f73,0x3ec8be29bd903e9bbf043f34bf5a3f73,0x3f6cbf7c3f7fbf743f5bbf363f07bea1,0xbe51be663f1dbf633f80bf6d3f2fbea1,0xbf7b3f79bf4a3eecbd3cbec13f3bbf73,0x3c173f15bf733f74bf183bc93f15bf73,0x3f80bf503ea23e9bbf4e3f80bf503ea1
.octa 0x3e3fbf593f77beecbeae3f6cbf693ea1,0xbf7c3f083e87bf633f71bec7bed43f73,0xbec03f7cbf28be9b3f79bf36be6a3f73,0x3f6dbe29bf413f74be76bf343f79bea1,0x3f0cbf793e003f63bf3dbec13f80bea1,0xbf56be663f7ebeecbf2d3f6d3d0abf73,0xbf333f503ee5bf74be193f80be26bf73,0x3f373f15bf65be9b3f7dbbc9bf7d3ea1
.octa 0x3f54bf08bf5e3eec3f68bec7bf703ea1,0xbf10bf593efe3f63bed9bf6c3eb43f73,0xbf6c3e293f7f3e9bbf5bbf343f073f73,0x3ec83f7c3d90bf74bf043f363f5abea1,0x3f7b3e66bf4abf633d3c3f6d3f3bbea1,0xbe51bf79bf1d3eec3f803ec1bf2fbf73,0xbf80bf153ea23f743f4ebbc9bf50bf73,0x3c173f503f733e9bbf18bf80bf153ea1
.octa 0x3f7c3f593e87beecbf71bf6cbed43ea1,0x3e3fbf08bf77bf63beae3ec73f693f73,0xbf6dbf7cbf41be9b3e763f363f793f73,0xbec03e293f283f743f793f343e6abea1,0x3f563f793f7e3f633f2d3ec13d0abea1,0x3f0c3e66be00beecbf3dbf6dbf80bf73,0xbf37bf50bf65bf74bf7dbf80bf7dbf73,0xbf33bf15bee5be9bbe193bc93e263ea1
.octa 0xbf4b3f45bf3e3f37bf303f28bf213f18,0xbf1c3f24bf2b3f33bf3a3f41bf473f4e,0x3f40bf633f78bf803f7abf653f44bf18,0xbf293eefbe7c3c493e63bee33f24bf4e,0x3f00bdbcbeab3f33bf6f3f7fbf613f18,0x3f5ebf7f3f71bf373eb73d8abef63f4e,0xbf723f75bf193c493f14bf733f74bf18,0x3ea53e98bf4d3f80bf513ea43e99bf4e
.octa 0xbe07bf243f80bf37bce23f41bf7f3f18,0xbf7e3f45bd56bf333f80bf28bddb3f4e,0x3f7fbeefbf033f80bf08bee33f7fbf18,0x3d84bf633f5cbc49bf593f65bdb6bf4e,0xbe843f7fbedcbf333f6a3d8abf763f18,0x3f77bdbcbf673f373ed1bf7f3e903f4e,0xbf66be983f7dbc49bf7c3ea43f63bf18,0xbee23f753e13bf803e2c3f73beedbf4e
.octa 0x3f1cbf45bf2b3f373f3abf28bf473f18,0xbf4bbf243f3e3f33bf30bf413f213f4e,0x3f293f63be7cbf80be633f653f24bf18,0x3f40beefbf783c493f7a3ee3bf44bf4e,0xbf5e3dbc3f713f33beb7bf7fbef63f18,0x3f003f7f3eabbf37bf6fbd8a3f613f4e,0xbea5bf75bf4d3c493f513f733e99bf18,0xbf72be983f193f803f14bea4bf74bf4e
.octa 0x3f7e3f24bd56bf37bf80bf41bddb3f18,0xbe07bf45bf80bf33bce23f283f7f3f4e,0xbd843eef3f5c3f803f593ee3bdb6bf18,0x3f7f3f633f03bc49bf08bf65bf7fbf4e,0xbf77bf7fbf67bf33bed1bd8a3e903f18,0xbe843dbc3edc3f373f6a3f7f3f763f4e,0x3ee23e983e13bc49be2cbea4beedbf18,0xbf66bf75bf7dbf80bf7cbf73bf63bf4e
.octa 0xbf723f6ebf6a3f66bf613f5cbf573f51,0xbea83ebbbece3ee1bef33f02bf0b3f13,0xbf5d3f38bf0a3ea7bdc2be103ebdbf13,0xbf023f32bf583f72bf7f3f7dbf6e3f51,0xbf3f3ecd3cb0bee13f46bf783f7cbf51,0xbf2a3f6bbf803f66bf223e7f3e38bf13,0xbf1a3c973f13bf723f75bf1a3c7b3f13,0xbf4c3f80bf523ea73e96bf4d3f80bf51
.octa 0xbedfbebb3f6fbf663e933f02bf7a3f51,0xbf663f6ebebabee13f75bf5c3e573f13,0xbe81bf323f7abea7bf233f7dbecbbf13,0xbf783f383e5dbf723f453e10bf6b3f51,0xbd6fbf6b3f313ee1bf7f3e7f3f53bf51,0xbf803ecd3f39bf66bdcf3f78bf11bf13,0x3e0dbf803e323f72bef0bf4d3f383f13,0xbf7e3c973f7cbea7bf623f1a3f32bf51
.octa 0x3ea8bf6ebece3f663ef3bf5cbf0b3f51,0xbf72bebb3f6a3ee1bf61bf023f573f13,0x3f02bf38bf583ea73f7f3e10bf6ebf13,0xbf5dbf323f0a3f72bdc2bf7dbebd3f51,0x3f2abecdbf80bee13f223f783e38bf51,0xbf3fbf6bbcb03f663f46be7fbf7cbf13,0x3f4cbc97bf52bf72be963f1a3f803f13,0xbf1abf80bf133ea73f753f4dbc7bbf51
.octa 0x3f663ebbbebabf66bf75bf023e573f51,0xbedfbf6ebf6fbee13e933f5c3f7a3f13,0x3f783f323e5dbea7bf45bf7dbf6bbf13,0xbe81bf38bf7abf72bf23be103ecb3f51,0x3f803f6b3f393ee13dcfbe7fbf11bf51,0xbd6fbecdbf31bf66bf7fbf78bf53bf13,0x3f7e3f803f7c3f723f623f4d3f323f13,0x3e0dbc97be32bea7bef0bf1abf38bf51
.octa 0x3f753f783f7a3f7c3f7e3f7f3f803f80,0xbe98be82be5abe2fbe04bdb0bd308000,0xbdd53e0a3ebb3f133f413f633f793f80,0xbf7fbf7ebf6ebf51bf28beecbe738000,0xbf7fbf5dbf12be2f3e863f253f683f80,0xbdbcbf01bf52bf7cbf77bf44bed88000,0xbe92bf4cbf80bf51bea43e9b3f4f3f80,0x3f753f1b3c97bf13bf73bf74bf178000
.octa 0x3f633e82bf0abf7cbf4bbdb03f2d3f80,0x3eef3f783f573e2fbf1cbf7fbf3d8000,0x3f213f7e3ecdbf13bf7fbeec3f053f80,0xbf473e0a3f6b3f51bd8abf63bf5b8000,0xbf243f013f7c3e2fbf5ebf443eaf3f80,0xbf45bf5d3e353f7c3effbf25bf718000,0xbf61bf1b3f323f51bee3bf743e1c3f80,0x3ef4bf4cbf383f133f65be9bbf7d8000
.octa 0x3e98bf78be5a3f7c3e04bf7fbd303f80,0x3f753e82bf7abe2f3f7e3db0bf808000,0x3f7fbe0abf6e3f133f28bf63be733f80,0xbdd53f7ebebbbf513f413eecbf798000,0x3dbc3f5dbf52be2f3f77bf25bed83f80,0xbf7f3f013f12bf7c3e863f44bf688000,0xbf753f4c3c97bf513f73be9bbf173f80,0xbe92bf1b3f80bf13bea43f74bf4f8000
.octa 0xbeefbe823f57bf7c3f1c3db0bf3d3f80,0x3f63bf783f0a3e2fbf4b3f7fbf2d8000,0x3f47bf7e3f6bbf133d8a3eecbf5b3f80,0x3f21be0abecd3f51bf7f3f63bf058000,0x3f45bf013e353e2fbeff3f44bf713f80,0xbf243f5dbf7c3f7cbf5e3f25beaf8000,0xbef43f1bbf383f51bf653f74bf7d3f80,0xbf613f4cbf323f13bee33e9bbe1c8000
.octa 0x3f4d3f533f593f5f3f643f693f6d3f71,0xbf1abf11bf08befcbee9bed5bec1beac,0xbf67bf7abf80bf77bf60bf3cbf0dbeac,0x3ede3e54bcfbbe89befabf2ebf56bf71,0x3f783f7c3f503efc3da3beb2bf36bf71,0xbe7f3e3b3f153f5f3f7f3f703f343eac,0xbf80bf57beb53e893f493f803f543eac,0x3d62bf0cbf6fbf77bf1fbd173f103f71
.octa 0x3f7d3f11be66bf5fbf74bed53ec73f71,0x3e103f533f793efcbe9ebf69bf6cbeac,0xbf72be543f3a3f773e8cbf2ebf7bbeac,0xbeaabf7abf2f3e893f763f3cbe4ebf71,0x3f5cbe3bbf7cbefc3f263f70bbc9bf71,0x3f023f7c3e29bf5fbf433eb23f803eac,0xbf3f3f0c3f69be89bf7ebd173f7b3eac,0xbf2bbf573ed23f77bdeebf80be423f71
.octa 0x3f1abf53bf083f5f3ee9bf69bec13f71,0x3f4d3f11bf59befc3f643ed5bf6dbeac,0xbede3f7abcfbbf773efa3f3cbf56beac,0xbf67be543f80be89bf603f2e3f0dbf71,0x3e7fbf7c3f153efcbf7f3eb23f34bf71,0x3f78be3bbf503f5f3da3bf703f363eac,0xbd623f57bf6f3e893f1fbf803f103eac,0xbf803f0c3eb5bf773f493d17bf543f71
.octa 0xbe10bf113f79bf5f3e9e3ed5bf6c3f71,0x3f7dbf533e663efcbf743f69bec7beac,0x3eaa3e54bf2f3f77bf763f2ebe4ebeac,0xbf723f7abf3a3e893e8cbf3c3f7bbf71,0xbf023e3b3e29befc3f43bf703f80bf71,0x3f5cbf7c3f7cbf5f3f26beb23bc93eac,0x3f2bbf0c3ed2be893dee3d17be423eac,0xbf3f3f57bf693f77bf7e3f80bf7b3f71
.octa 0x3f0d3f163f1f3f273f2f3f373f3f3f46,0xbf56bf4fbf49bf42bf3abf33bf2bbf22,0x3f363f063e9e3d97be29becabf1abf46,0x3f343f5a3f743f7f3f7c3f6b3f4d3f22,0xbf54bf7dbf76bf42bed23c493ede3f46,0x3f103e23be8cbf27bf69bf80bf67bf22,0xbec73e6d3f433f7f3f593ebebe7fbf46,0xbf6cbf79bf26bd973f083f6e3f783f22
.octa 0x3f7b3f4f3deebf27bf80bf333d623f46,0xbe4e3f163f7e3f423cfbbf37bf80bf22,0x3bc9bf5abf64bd973f503f6b3e10bf46,0x3f803f06bee9bf7fbf153eca3f7d3f22,0xbf7bbe233f603f42beb5bf80beaa3f46,0xbe42bf7dbefa3f273f6fbc49bf72bf22,0x3ec13f79bda3bf7fbe663f6e3f02bf46,0xbf6d3e6d3f7f3d97bf79bebe3f5c3f22
.octa 0x3f56bf16bf493f273f3abf37bf2b3f46,0x3f0d3f4fbf1fbf423f2f3f33bf3fbf22,0xbf34bf063f743d97bf7c3eca3f4dbf46,0x3f36bf5abe9e3f7fbe29bf6b3f1a3f22,0xbf103f7dbe8cbf423f69bc49bf673f46,0xbf54be233f76bf27bed23f80bedebf22,0x3f6cbe6dbf263f7fbf08bebe3f78bf46,0xbec73f79bf43bd973f59bf6e3e7f3f22
.octa 0x3e4ebf4f3f7ebf27bcfb3f33bf803f46,0x3f7bbf16bdee3f42bf803f37bd62bf22,0xbf803f5abee9bd973f15bf6b3f7dbf46,0x3bc9bf063f64bf7f3f50becabe103f22,0x3e423e23befa3f42bf6f3f80bf723f46,0xbf7b3f7dbf603f27beb53c493eaabf22,0x3f6dbf793f7fbf7f3f79bf6e3f5cbf46,0x3ec1be6d3da33d97be663ebebf023f22
.octa 0x3e733e8f3ea43eb83ecd3ee13ef43f04,0xbf79bf76bf73bf6fbf6bbf66bf61bf5c,0x3ed83f203f4b3f6a3f7c3f803f753f5c,0xbf68bf48bf1cbecfbe353d7b3e983f04,0x3f173f603f7f3f6f3f323ea7bdd5bf04,0xbf4fbef7bd8a3eb83f383f723f7f3f5c,0x3f3d3f7e3f5e3ecfbe5abf40bf7fbf5c,0xbf2dbde23eff3f6a3f7a3f2a3dbcbf04
.octa 0x3f5b3f763ee3beb8bf6ebf66be923f04,0xbf053e8f3f653f6f3ebbbee1bf75bf5c,0x3f713f48be04bf6abf523d7b3f633f5c,0xbeaf3f203f7e3ecfbf12bf80beef3f04,0x3f7d3ef7bf28bf6f3c973f723f21bf04,0xbe1c3f603f41beb8bf80bea73f473f5c,0x3f803de2bf77becf3f573f2abf24bf5c,0x3d303f7e3e86bf6abf0a3f403f45bf04
.octa 0x3f79be8fbf733eb83f6bbee1bf613f04,0x3e733f76bea4bf6f3ecd3f66bef4bf5c,0x3f68bf20bf1c3f6a3e35bf803e983f5c,0x3ed83f48bf4bbecf3f7cbd7bbf753f04,0x3f4fbf60bd8a3f6fbf38bea73f7fbf04,0x3f173ef7bf7f3eb83f32bf723dd53f5c,0x3f2dbf7e3eff3ecfbf7a3f403dbcbf5c,0x3f3d3de2bf5e3f6abe5abf2a3f7fbf04
.octa 0x3f05bf763f65beb8bebb3f66bf753f04,0x3f5bbe8fbee33f6fbf6e3ee13e92bf5c,0x3eafbf483f7ebf6a3f12bd7bbeef3f5c,0x3f71bf203e043ecfbf523f80bf633f04,0x3e1cbef73f41bf6f3f80bf723f47bf04,0x3f7dbf603f28beb83c973ea7bf213f5c,0xbd30bde23e86becf3f0abf2a3f45bf5c,0x3f80bf7e3f77bf6a3f57bf403f24bf04
.octa 0x3e983e823e5a3e2f3e043db03d300000,0x3f753f783f7a3f7c3f7e3f7f3f803f80,0x3f7f3f7e3f6e3f513f283eec3e730000,0xbdd53e0a3ebb3f133f413f633f793f80,0x3dbc3f013f523f7c3f773f443ed80000,0xbf7fbf5dbf12be2f3e863f253f683f80,0xbf75bf1bbc973f133f733f743f170000,0xbe92bf4cbf80bf51bea43e9b3f4f3f80
.octa 0xbeefbf78bf57be2f3f1c3f7f3f3d0000,0x3f633e82bf0abf7cbf4bbdb03f2d3f80,0x3f47be0abf6bbf513d8a3f633f5b0000,0x3f213f7e3ecdbf13bf7fbeec3f053f80,0x3f453f5dbe35bf7cbeff3f253f710000,0xbf243f013f7c3e2fbf5ebf443eaf3f80,0xbef43f4c3f38bf13bf653e9b3f7d0000,0xbf61bf1b3f323f51bee3bf743e1c3f80
.octa 0xbf75be823f7a3e2fbf7ebdb03f800000,0x3e98bf78be5a3f7c3e04bf7fbd303f80,0x3dd5bf7e3ebb3f51bf41beec3f790000,0x3f7fbe0abf6e3f133f28bf63be733f80,0x3f7fbf01bf123f7cbe86bf443f680000,0x3dbc3f5dbf52be2f3f77bf25bed83f80,0x3e923f1bbf803f133ea4bf743f4f0000,0xbf753f4c3c97bf513f73be9bbf173f80
.octa 0xbf633f78bf0abe2f3f4bbf7f3f2d0000,0xbeefbe823f57bf7c3f1c3db0bf3d3f80,0xbf213e0a3ecdbf513f7fbf633f050000,0x3f47bf7e3f6bbf133d8a3eecbf5b3f80,0x3f24bf5d3f7cbf7c3f5ebf253eaf0000,0x3f45bf013e353e2fbeff3f44bf713f80,0x3f61bf4c3f32bf133ee3be9b3e1c0000,0xbef43f1bbf383f51bf653f74bf7d3f80
.octa 0x3f1a3f113f083efc3ee93ed53ec13eac,0x3f4d3f533f593f5f3f643f693f6d3f71,0xbedebe543cfb3e893efa3f2e3f563f71,0xbf67bf7abf80bf77bf60bf3cbf0dbeac,0x3e7fbe3bbf15bf5fbf7fbf70bf34beac,0x3f783f7c3f503efc3da3beb2bf36bf71,0xbd623f0c3f6f3f773f1f3d17bf10bf71,0xbf80bf57beb53e893f493f803f543eac
.octa 0xbe10bf53bf79befc3e9e3f693f6c3eac,0x3f7d3f11be66bf5fbf74bed53ec73f71,0x3eaa3f7a3f2fbe89bf76bf3c3e4e3f71,0xbf72be543f3a3f773e8cbf2ebf7bbeac,0xbf02bf7cbe293f5f3f43beb2bf80beac,0x3f5cbe3bbf7cbefc3f263f70bbc9bf71,0x3f2b3f57bed2bf773dee3f803e42bf71,0xbf3f3f0c3f69be89bf7ebd173f7b3eac
.octa 0xbf4dbf113f593efcbf64bed53f6d3eac,0x3f1abf53bf083f5f3ee9bf69bec13f71,0x3f673e54bf803e893f60bf2ebf0d3f71,0xbede3f7abcfbbf773efa3f3cbf56beac,0xbf783e3b3f50bf5fbda33f70bf36beac,0x3e7fbf7c3f153efcbf7f3eb23f34bf71,0x3f80bf0cbeb53f77bf49bd173f54bf71,0xbd623f57bf6f3e893f1fbf803f103eac
.octa 0xbf7d3f53be66befc3f74bf693ec73eac,0xbe10bf113f79bf5f3e9e3ed5bf6c3f71,0x3f72bf7a3f3abe89be8c3f3cbf7b3f71,0x3eaa3e54bf2f3f77bf763f2ebe4ebeac,0xbf5c3f7cbf7c3f5fbf263eb2bbc9beac,0xbf023e3b3e29befc3f43bf703f80bf71,0x3f3fbf573f69bf773f7ebf803f7bbf71,0x3f2bbf0c3ed2be893dee3d17be423eac
.octa 0x3f563f4f3f493f423f3a3f333f2b3f22,0x3f0d3f163f1f3f273f2f3f373f3f3f46,0xbf34bf5abf74bf7fbf7cbf6bbf4dbf22,0x3f363f063e9e3d97be29becabf1abf46,0xbf10be233e8c3f273f693f803f673f22,0xbf54bf7dbf76bf42bed23c493ede3f46,0x3f6c3f793f263d97bf08bf6ebf78bf22,0xbec73e6d3f433f7f3f593ebebe7fbf46
.octa 0x3e4ebf16bf7ebf42bcfb3f373f803f22,0x3f7b3f4f3deebf27bf80bf333d623f46,0xbf80bf063ee93f7f3f15becabf7dbf22,0x3bc9bf5abf64bd973f503f6b3e10bf46,0x3e423f7d3efabf27bf6f3c493f723f22,0xbf7bbe233f603f42beb5bf80beaa3f46,0x3f6dbe6dbf7fbd973f793ebebf5cbf22,0x3ec13f79bda3bf7fbe663f6e3f02bf46
.octa 0xbf0dbf4f3f1f3f42bf2fbf333f3f3f22,0x3f56bf16bf493f273f3abf37bf2b3f46,0xbf363f5a3e9ebf7f3e293f6bbf1abf22,0xbf34bf063f743d97bf7c3eca3f4dbf46,0x3f543e23bf763f273ed2bf803ede3f22,0xbf103f7dbe8cbf423f69bc49bf673f46,0x3ec7bf793f433d97bf593f6ebe7fbf22,0x3f6cbe6dbf263f7fbf08bebe3f78bf46
.octa 0xbf7b3f163deebf423f80bf373d623f22,0x3e4ebf4f3f7ebf27bcfb3f33bf803f46,0xbbc93f06bf643f7fbf503eca3e10bf22,0xbf803f5abee9bd973f15bf6b3f7dbf46,0x3f7bbf7d3f60bf273eb5bc49beaa3f22,0x3e423e23befa3f42bf6f3f80bf723f46,0xbec13e6dbda3bd973e66bebe3f02bf22,0x3f6dbf793f7fbf7f3f79bf6e3f5cbf46
.octa 0x3f793f763f733f6f3f6b3f663f613f5c,0x3e733e8f3ea43eb83ecd3ee13ef43f04,0x3f683f483f1c3ecf3e35bd7bbe98bf04,0x3ed83f203f4b3f6a3f7c3f803f753f5c,0x3f4f3ef73d8abeb8bf38bf72bf7fbf5c,0x3f173f603f7f3f6f3f323ea7bdd5bf04,0x3f2d3de2beffbf6abf7abf2abdbc3f04,0x3f3d3f7e3f5e3ecfbe5abf40bf7fbf5c
.octa 0x3f05be8fbf65bf6fbebb3ee13f753f5c,0x3f5b3f763ee3beb8bf6ebf66be923f04,0x3eafbf20bf7ebecf3f123f803eefbf04,0x3f713f48be04bf6abf523d7b3f633f5c,0x3e1cbf60bf413eb83f803ea7bf47bf5c,0x3f7d3ef7bf28bf6f3c973f723f21bf04,0xbd30bf7ebe863f6a3f0abf40bf453f04,0x3f803de2bf77becf3f573f2abf24bf5c
.octa 0xbe73bf763ea43f6fbecdbf663ef43f5c,0x3f79be8fbf733eb83f6bbee1bf613f04,0xbed8bf483f4b3ecfbf7c3d7b3f75bf04,0x3f68bf20bf1c3f6a3e35bf803e983f5c,0xbf17bef73f7fbeb8bf323f72bdd5bf5c,0x3f4fbf60bd8a3f6fbf38bea73f7fbf04,0xbf3dbde23f5ebf6a3e5a3f2abf7f3f04,0x3f2dbf7e3eff3ecfbf7a3f403dbcbf5c
.octa 0xbf5b3e8f3ee3bf6f3f6ebee1be923f5c,0x3f05bf763f65beb8bebb3f66bf753f04,0xbf713f20be04becf3f52bf803f63bf04,0x3eafbf483f7ebf6a3f12bd7bbeef3f5c,0xbf7d3f60bf283eb8bc97bea73f21bf5c,0x3e1cbef73f41bf6f3f80bf723f47bf04,0xbf803f7ebf773f6abf573f40bf243f04,0xbd30bde23e86becf3f0abf2a3f45bf5c
.octa 0xbf753f78bf7a3f7cbf7e3f7fbf803f80,0x3e98be823e5abe2f3e04bdb03d308000,0x3dd53e0abebb3f13bf413f63bf793f80,0x3f7fbf7e3f6ebf513f28beec3e738000,0x3f7fbf5d3f12be2fbe863f25bf683f80,0x3dbcbf013f52bf7c3f77bf443ed88000,0x3e92bf4c3f80bf513ea43e9bbf4f3f80,0xbf753f1bbc97bf133f73bf743f178000
.octa 0xbf633e823f0abf7c3f4bbdb0bf2d3f80,0xbeef3f78bf573e2f3f1cbf7f3f3d8000,0xbf213f7ebecdbf133f7fbeecbf053f80,0x3f473e0abf6b3f513d8abf633f5b8000,0x3f243f01bf7c3e2f3f5ebf44beaf3f80,0x3f45bf5dbe353f7cbeffbf253f718000,0x3f61bf1bbf323f513ee3bf74be1c3f80,0xbef4bf4c3f383f13bf65be9b3f7d8000
.octa 0xbe98bf783e5a3f7cbe04bf7f3d303f80,0xbf753e823f7abe2fbf7e3db03f808000,0xbf7fbe0a3f6e3f13bf28bf633e733f80,0x3dd53f7e3ebbbf51bf413eec3f798000,0xbdbc3f5d3f52be2fbf77bf253ed83f80,0x3f7f3f01bf12bf7cbe863f443f688000,0x3f753f4cbc97bf51bf73be9b3f173f80,0x3e92bf1bbf80bf133ea43f743f4f8000
.octa 0x3eefbe82bf57bf7cbf1c3db03f3d3f80,0xbf63bf78bf0a3e2f3f4b3f7f3f2d8000,0xbf47bf7ebf6bbf13bd8a3eec3f5b3f80,0xbf21be0a3ecd3f513f7f3f633f058000,0xbf45bf01be353e2f3eff3f443f713f80,0x3f243f5d3f7c3f7c3f5e3f253eaf8000,0x3ef43f1b3f383f513f653f743f7d3f80,0x3f613f4c3f323f133ee33e9b3e1c8000
.octa 0xbf4d3f53bf593f5fbf643f69bf6d3f71,0x3f1abf113f08befc3ee9bed53ec1beac,0x3f67bf7a3f80bf773f60bf3c3f0dbeac,0xbede3e543cfbbe893efabf2e3f56bf71,0xbf783f7cbf503efcbda3beb23f36bf71,0x3e7f3e3bbf153f5fbf7f3f70bf343eac,0x3f80bf573eb53e89bf493f80bf543eac,0xbd62bf0c3f6fbf773f1fbd17bf103f71
.octa 0xbf7d3f113e66bf5f3f74bed5bec73f71,0xbe103f53bf793efc3e9ebf693f6cbeac,0x3f72be54bf3a3f77be8cbf2e3f7bbeac,0x3eaabf7a3f2f3e89bf763f3c3e4ebf71,0xbf5cbe3b3f7cbefcbf263f703bc9bf71,0xbf023f7cbe29bf5f3f433eb2bf803eac,0x3f3f3f0cbf69be893f7ebd17bf7b3eac,0x3f2bbf57bed23f773deebf803e423f71
.octa 0xbf1abf533f083f5fbee9bf693ec13f71,0xbf4d3f113f59befcbf643ed53f6dbeac,0x3ede3f7a3cfbbf77befa3f3c3f56beac,0x3f67be54bf80be893f603f2ebf0dbf71,0xbe7fbf7cbf153efc3f7f3eb2bf34bf71,0xbf78be3b3f503f5fbda3bf70bf363eac,0x3d623f573f6f3e89bf1fbf80bf103eac,0x3f803f0cbeb5bf77bf493d173f543f71
.octa 0x3e10bf11bf79bf5fbe9e3ed53f6c3f71,0xbf7dbf53be663efc3f743f693ec7beac,0xbeaa3e543f2f3f773f763f2e3e4ebeac,0x3f723f7a3f3a3e89be8cbf3cbf7bbf71,0x3f023e3bbe29befcbf43bf70bf80bf71,0xbf5cbf7cbf7cbf5fbf26beb2bbc93eac,0xbf2bbf0cbed2be89bdee3d173e423eac,0x3f3f3f573f693f773f7e3f803f7b3f71
.octa 0xbf0d3f16bf1f3f27bf2f3f37bf3f3f46,0x3f56bf4f3f49bf423f3abf333f2bbf22,0xbf363f06be9e3d973e29beca3f1abf46,0xbf343f5abf743f7fbf7c3f6bbf4d3f22,0x3f54bf7d3f76bf423ed23c49bede3f46,0xbf103e233e8cbf273f69bf803f67bf22,0x3ec73e6dbf433f7fbf593ebe3e7fbf46,0x3f6cbf793f26bd97bf083f6ebf783f22
.octa 0xbf7b3f4fbdeebf273f80bf33bd623f46,0x3e4e3f16bf7e3f42bcfbbf373f80bf22,0xbbc9bf5a3f64bd97bf503f6bbe10bf46,0xbf803f063ee9bf7f3f153ecabf7d3f22,0x3f7bbe23bf603f423eb5bf803eaa3f46,0x3e42bf7d3efa3f27bf6fbc493f72bf22,0xbec13f793da3bf7f3e663f6ebf02bf46,0x3f6d3e6dbf7f3d973f79bebebf5c3f22
.octa 0xbf56bf163f493f27bf3abf373f2b3f46,0xbf0d3f4f3f1fbf42bf2f3f333f3fbf22,0x3f34bf06bf743d973f7c3ecabf4dbf46,0xbf36bf5a3e9e3f7f3e29bf6bbf1a3f22,0x3f103f7d3e8cbf42bf69bc493f673f46,0x3f54be23bf76bf273ed23f803edebf22,0xbf6cbe6d3f263f7f3f08bebebf78bf46,0x3ec73f793f43bd97bf59bf6ebe7f3f22
.octa 0xbe4ebf4fbf7ebf273cfb3f333f803f46,0xbf7bbf163dee3f423f803f373d62bf22,0x3f803f5a3ee9bd97bf15bf6bbf7dbf46,0xbbc9bf06bf64bf7fbf50beca3e103f22,0xbe423e233efa3f423f6f3f803f723f46,0x3f7b3f7d3f603f273eb53c49beaabf22,0xbf6dbf79bf7fbf7fbf79bf6ebf5cbf46,0xbec1be6dbda33d973e663ebe3f023f22
.octa 0xbe733e8fbea43eb8becd3ee1bef43f04,0x3f79bf763f73bf6f3f6bbf663f61bf5c,0xbed83f20bf4b3f6abf7c3f80bf753f5c,0x3f68bf483f1cbecf3e353d7bbe983f04,0xbf173f60bf7f3f6fbf323ea73dd5bf04,0x3f4fbef73d8a3eb8bf383f72bf7f3f5c,0xbf3d3f7ebf5e3ecf3e5abf403f7fbf5c,0x3f2dbde2beff3f6abf7a3f2abdbcbf04
.octa 0xbf5b3f76bee3beb83f6ebf663e923f04,0x3f053e8fbf653f6fbebbbee13f75bf5c,0xbf713f483e04bf6a3f523d7bbf633f5c,0x3eaf3f20bf7e3ecf3f12bf803eef3f04,0xbf7d3ef73f28bf6fbc973f72bf21bf04,0x3e1c3f60bf41beb83f80bea7bf473f5c,0xbf803de23f77becfbf573f2a3f24bf5c,0xbd303f7ebe86bf6a3f0a3f40bf45bf04
.octa 0xbf79be8f3f733eb8bf6bbee13f613f04,0xbe733f763ea4bf6fbecd3f663ef4bf5c,0xbf68bf203f1c3f6abe35bf80be983f5c,0xbed83f483f4bbecfbf7cbd7b3f753f04,0xbf4fbf603d8a3f6f3f38bea7bf7fbf04,0xbf173ef73f7f3eb8bf32bf72bdd53f5c,0xbf2dbf7ebeff3ecf3f7a3f40bdbcbf5c,0xbf3d3de23f5e3f6a3e5abf2abf7fbf04
.octa 0xbf05bf76bf65beb83ebb3f663f753f04,0xbf5bbe8f3ee33f6f3f6e3ee1be92bf5c,0xbeafbf48bf7ebf6abf12bd7b3eef3f5c,0xbf71bf20be043ecf3f523f803f633f04,0xbe1cbef7bf41bf6fbf80bf72bf47bf04,0xbf7dbf60bf28beb8bc973ea73f213f5c,0x3d30bde2be86becfbf0abf2abf45bf5c,0xbf80bf7ebf77bf6abf57bf40bf24bf04
.octa 0xbe983e82be5a3e2fbe043db0bd300000,0xbf753f78bf7a3f7cbf7e3f7fbf803f80,0xbf7f3f7ebf6e3f51bf283eecbe730000,0x3dd53e0abebb3f13bf413f63bf793f80,0xbdbc3f01bf523f7cbf773f44bed80000,0x3f7fbf5d3f12be2fbe863f25bf683f80,0x3f75bf1b3c973f13bf733f74bf170000,0x3e92bf4c3f80bf513ea43e9bbf4f3f80
.octa 0x3eefbf783f57be2fbf1c3f7fbf3d0000,0xbf633e823f0abf7c3f4bbdb0bf2d3f80,0xbf47be0a3f6bbf51bd8a3f63bf5b0000,0xbf213f7ebecdbf133f7fbeecbf053f80,0xbf453f5d3e35bf7c3eff3f25bf710000,0x3f243f01bf7c3e2f3f5ebf44beaf3f80,0x3ef43f4cbf38bf133f653e9bbf7d0000,0x3f61bf1bbf323f513ee3bf74be1c3f80
.octa 0x3f75be82bf7a3e2f3f7ebdb0bf800000,0xbe98bf783e5a3f7cbe04bf7f3d303f80,0xbdd5bf7ebebb3f513f41beecbf790000,0xbf7fbe0a3f6e3f13bf28bf633e733f80,0xbf7fbf013f123f7c3e86bf44bf680000,0xbdbc3f5d3f52be2fbf77bf253ed83f80,0xbe923f1b3f803f13bea4bf74bf4f0000,0x3f753f4cbc97bf51bf73be9b3f173f80
.octa 0x3f633f783f0abe2fbf4bbf7fbf2d0000,0x3eefbe82bf57bf7cbf1c3db03f3d3f80,0x3f213e0abecdbf51bf7fbf63bf050000,0xbf47bf7ebf6bbf13bd8a3eec3f5b3f80,0xbf24bf5dbf7cbf7cbf5ebf25beaf0000,0xbf45bf01be353e2f3eff3f443f713f80,0xbf61bf4cbf32bf13bee3be9bbe1c0000,0x3ef43f1b3f383f513f653f743f7d3f80
.octa 0xbf1a3f11bf083efcbee93ed5bec13eac,0xbf4d3f53bf593f5fbf643f69bf6d3f71,0x3edebe54bcfb3e89befa3f2ebf563f71,0x3f67bf7a3f80bf773f60bf3c3f0dbeac,0xbe7fbe3b3f15bf5f3f7fbf703f34beac,0xbf783f7cbf503efcbda3beb23f36bf71,0x3d623f0cbf6f3f77bf1f3d173f10bf71,0x3f80bf573eb53e89bf493f80bf543eac
.octa 0x3e10bf533f79befcbe9e3f69bf6c3eac,0xbf7d3f113e66bf5f3f74bed5bec73f71,0xbeaa3f7abf2fbe893f76bf3cbe4e3f71,0x3f72be54bf3a3f77be8cbf2e3f7bbeac,0x3f02bf7c3e293f5fbf43beb23f80beac,0xbf5cbe3b3f7cbefcbf263f703bc9bf71,0xbf2b3f573ed2bf77bdee3f80be42bf71,0x3f3f3f0cbf69be893f7ebd17bf7b3eac
.octa 0x3f4dbf11bf593efc3f64bed5bf6d3eac,0xbf1abf533f083f5fbee9bf693ec13f71,0xbf673e543f803e89bf60bf2e3f0d3f71,0x3ede3f7a3cfbbf77befa3f3c3f56beac,0x3f783e3bbf50bf5f3da33f703f36beac,0xbe7fbf7cbf153efc3f7f3eb2bf34bf71,0xbf80bf0c3eb53f773f49bd17bf54bf71,0x3d623f573f6f3e89bf1fbf80bf103eac
.octa 0x3f7d3f533e66befcbf74bf69bec73eac,0x3e10bf11bf79bf5fbe9e3ed53f6c3f71,0xbf72bf7abf3abe893e8c3f3c3f7b3f71,0xbeaa3e543f2f3f773f763f2e3e4ebeac,0x3f5c3f7c3f7c3f5f3f263eb23bc9beac,0x3f023e3bbe29befcbf43bf70bf80bf71,0xbf3fbf57bf69bf77bf7ebf80bf7bbf71,0xbf2bbf0cbed2be89bdee3d173e423eac
.octa 0xbf563f4fbf493f42bf3a3f33bf2b3f22,0xbf0d3f16bf1f3f27bf2f3f37bf3f3f46,0x3f34bf5a3f74bf7f3f7cbf6b3f4dbf22,0xbf363f06be9e3d973e29beca3f1abf46,0x3f10be23be8c3f27bf693f80bf673f22,0x3f54bf7d3f76bf423ed23c49bede3f46,0xbf6c3f79bf263d973f08bf6e3f78bf22,0x3ec73e6dbf433f7fbf593ebe3e7fbf46
.octa 0xbe4ebf163f7ebf423cfb3f37bf803f22,0xbf7b3f4fbdeebf273f80bf33bd623f46,0x3f80bf06bee93f7fbf15beca3f7dbf22,0xbbc9bf5a3f64bd97bf503f6bbe10bf46,0xbe423f7dbefabf273f6f3c49bf723f22,0x3f7bbe23bf603f423eb5bf803eaa3f46,0xbf6dbe6d3f7fbd97bf793ebe3f5cbf22,0xbec13f793da3bf7f3e663f6ebf02bf46
.octa 0x3f0dbf4fbf1f3f423f2fbf33bf3f3f22,0xbf56bf163f493f27bf3abf373f2b3f46,0x3f363f5abe9ebf7fbe293f6b3f1abf22,0x3f34bf06bf743d973f7c3ecabf4dbf46,0xbf543e233f763f27bed2bf80bede3f22,0x3f103f7d3e8cbf42bf69bc493f673f46,0xbec7bf79bf433d973f593f6e3e7fbf22,0xbf6cbe6d3f263f7f3f08bebebf78bf46
.octa 0x3f7b3f16bdeebf42bf80bf37bd623f22,0xbe4ebf4fbf7ebf273cfb3f333f803f46,0x3bc93f063f643f7f3f503ecabe10bf22,0x3f803f5a3ee9bd97bf15bf6bbf7dbf46,0xbf7bbf7dbf60bf27beb5bc493eaa3f22,0xbe423e233efa3f423f6f3f803f723f46,0x3ec13e6d3da3bd97be66bebebf02bf22,0xbf6dbf79bf7fbf7fbf79bf6ebf5cbf46
.octa 0xbf793f76bf733f6fbf6b3f66bf613f5c,0xbe733e8fbea43eb8becd3ee1bef43f04,0xbf683f48bf1c3ecfbe35bd7b3e98bf04,0xbed83f20bf4b3f6abf7c3f80bf753f5c,0xbf4f3ef7bd8abeb83f38bf723f7fbf5c,0xbf173f60bf7f3f6fbf323ea73dd5bf04,0xbf2d3de23effbf6a3f7abf2a3dbc3f04,0xbf3d3f7ebf5e3ecf3e5abf403f7fbf5c
.octa 0xbf05be8f3f65bf6f3ebb3ee1bf753f5c,0xbf5b3f76bee3beb83f6ebf663e923f04,0xbeafbf203f7ebecfbf123f80beefbf04,0xbf713f483e04bf6a3f523d7bbf633f5c,0xbe1cbf603f413eb8bf803ea73f47bf5c,0xbf7d3ef73f28bf6fbc973f72bf21bf04,0x3d30bf7e3e863f6abf0abf403f453f04,0xbf803de23f77becfbf573f2a3f24bf5c
.octa 0x3e73bf76bea43f6f3ecdbf66bef43f5c,0xbf79be8f3f733eb8bf6bbee13f613f04,0x3ed8bf48bf4b3ecf3f7c3d7bbf75bf04,0xbf68bf203f1c3f6abe35bf80be983f5c,0x3f17bef7bf7fbeb83f323f723dd5bf5c,0xbf4fbf603d8a3f6f3f38bea7bf7fbf04,0x3f3dbde2bf5ebf6abe5a3f2a3f7f3f04,0xbf2dbf7ebeff3ecf3f7a3f40bdbcbf5c
.octa 0x3f5b3e8fbee3bf6fbf6ebee13e923f5c,0xbf05bf76bf65beb83ebb3f663f753f04,0x3f713f203e04becfbf52bf80bf63bf04,0xbeafbf48bf7ebf6abf12bd7b3eef3f5c,0x3f7d3f603f283eb83c97bea7bf21bf5c,0xbe1cbef7bf41bf6fbf80bf72bf47bf04,0x3f803f7e3f773f6a3f573f403f243f04,0x3d30bde2be86becfbf0abf2abf45bf5c
.octa 0x3f733f763f793f7c3f7e3f7f3f803f80,0xbea2be8cbe6abe3bbe0dbdbcbd3c8000,0xbe003dee3eb43f113f3f3f633f793f80,0xbf7ebf7ebf70bf53bf2abeefbe768000,0xbf7fbf60bf15be3b3e813f243f683f80,0xbd90befabf50bf7cbf78bf45bed98000,0xbe87bf49bf80bf53bea83e983f4e3f80,0x3f773f1f3d0abf11bf72bf75bf188000
.octa 0x3f653e8cbf07bf7cbf4cbdbc3f2d3f80,0x3ee53f763f5a3e3bbf1abf7fbf3d8000,0x3f1d3f7e3ed4bf11bf80beef3f043f80,0xbf4a3dee3f693f53bd6fbf63bf5b8000,0xbf283efa3f7d3e3bbf5dbf453eae3f80,0xbf41bf603e263f7c3f02bf24bf718000,0xbf5ebf1f3f2f3f53bedfbf753e193f80,0x3efebf49bf3b3f113f66be98bf7d8000
.octa 0x3ea2bf76be6a3f7c3e0dbf7fbd3c3f80,0x3f733e8cbf79be3b3f7e3dbcbf808000,0x3f7ebdeebf703f113f2abf63be763f80,0xbe003f7ebeb4bf533f3f3eefbf798000,0x3d903f60bf50be3b3f78bf24bed93f80,0xbf7f3efa3f15bf7c3e813f45bf688000,0xbf773f493d0abf533f72be98bf183f80,0xbe87bf1f3f80bf11bea83f75bf4e8000
.octa 0xbee5be8c3f5abf7c3f1a3dbcbf3d3f80,0x3f65bf763f073e3bbf4c3f7fbf2d8000,0x3f4abf7e3f69bf113d6f3eefbf5b3f80,0x3f1dbdeebed43f53bf803f63bf048000,0x3f41befa3e263e3bbf023f45bf713f80,0xbf283f60bf7d3f7cbf5d3f24beae8000,0xbefe3f1fbf3b3f53bf663f75bf7d3f80,0xbf5e3f49bf2f3f11bedf3e98be198000
.octa 0x3f453f4d3f543f5a3f603f653f6a3f6f,0xbf23bf1abf10bf06bef8bee3becebeb8,0xbf61bf78bf80bf79bf64bf41bf13beb8,0x3ef33e7f3c17be6dbeeabf28bf52bf6f,0x3f753f7d3f563f063de8bea4bf31bf6f,0xbe963e103f0c3f5a3f7e3f733f393eb8,0xbf7fbf5cbec83e6d3f433f7f3f583eb8,0x3dcfbf02bf6cbf79bf25bd8a3f0a3f6f
.octa 0x3f7f3f1abe3fbf5abf76bee33eba3f6f,0x3dc23f4d3f7c3f06be8dbf65bf6fbeb8,0xbf75be7f3f333f793e9cbf28bf7cbeb8,0xbe93bf78bf373e6d3f743f41be32bf6f,0x3f62be10bf7bbf063f1f3f733cb0bf6f,0x3ef03f7d3e51bf5abf483ea43f803eb8,0xbf463f023f6dbe6dbf7fbd8a3f7a3eb8,0xbf22bf5c3ec03f79bda9bf7fbe5d3f6f
.octa 0x3f23bf4dbf103f5a3ef8bf65bece3f6f,0x3f453f1abf54bf063f603ee3bf6abeb8,0xbef33f783c17bf793eea3f41bf52beb8,0xbf61be7f3f80be6dbf643f283f13bf6f,0x3e96bf7d3f0c3f06bf7e3ea43f39bf6f,0x3f75be10bf563f5a3de8bf733f313eb8,0xbdcf3f5cbf6c3e6d3f25bf7f3f0a3eb8,0xbf7f3f023ec8bf793f433d8abf583f6f
.octa 0xbdc2bf1a3f7cbf5a3e8d3ee3bf6f3f6f,0x3f7fbf4d3e3f3f06bf763f65bebabeb8,0x3e933e7fbf373f79bf743f28be32beb8,0xbf753f78bf333e6d3e9cbf413f7cbf6f,0xbef03e103e51bf063f48bf733f80bf6f,0x3f62bf7d3f7bbf5a3f1fbea4bcb03eb8,0x3f22bf023ec0be6d3da93d8abe5d3eb8,0xbf463f5cbf6d3f79bf7f3f7fbf7a3f6f
.octa 0x3efb3f083f113f1b3f243f2d3f363f3e,0xbf5fbf59bf53bf4cbf44bf3dbf34bf2c,0x3f423f153ebd3e0abddbbeafbf0fbf3e,0x3f273f503f6e3f7e3f7f3f713f543f2c,0xbf49bf79bf7abf4cbeedbd303ec53f3e,0x3f1e3e66be57bf1bbf63bf80bf6cbf2c,0xbee83e293f383f7e3f613ed8be4bbf3e,0xbf64bf7cbf32be0a3ef63f683f7b3f2c
.octa 0x3f773f593e38bf1bbf7fbf3d3b493f3e,0xbe8a3f083f7c3f4c3db6bf2dbf80bf2c,0x3d9dbf50bf6bbe0a3f473f713e45bf3e,0x3f7f3f15becbbf7ebf213eaf3f7b3f2c,0xbf7ebe663f573f4cbe99bf80bec23f3e,0xbdf4bf79bf0b3f1b3f743d30bf6dbf2c,0x3e9f3f7cbc7bbf7ebe903f683f0ebf3e,0xbf733e293f803e0abf76bed83f553f2c
.octa 0x3f5fbf08bf533f1b3f44bf2dbf343f3e,0x3efb3f59bf11bf4c3f243f3dbf36bf2c,0xbf27bf153f6e3e0abf7f3eaf3f54bf3e,0x3f42bf50bebd3f7ebddbbf713f0f3f2c,0xbf1e3f79be57bf4c3f633d30bf6c3f3e,0xbf49be663f7abf1bbeed3f80bec5bf2c,0x3f64be29bf323f7ebef6bed83f7bbf3e,0xbee83f7cbf38be0a3f61bf683e4b3f2c
.octa 0x3e8abf593f7cbf1bbdb63f3dbf803f3e,0x3f77bf08be383f4cbf7f3f2dbb49bf2c,0xbf7f3f50becbbe0a3f21bf713f7bbf3e,0x3d9dbf153f6bbf7e3f47beafbe453f2c,0x3df43e66bf0b3f4cbf743f80bf6d3f3e,0xbf7e3f79bf573f1bbe99bd303ec2bf2c,0x3f73bf7c3f80bf7e3f76bf683f55bf3e,0x3e9fbe293c7b3e0abe903ed8bf0e3f2c
.octa 0x3e133e423e703e8f3ea53ebb3ed13ee6,0xbf7dbf7bbf79bf76bf72bf6ebf6abf65,0x3eab3f0d3f3c3f603f773f803f7a3f65,0xbf71bf56bf2ebef7be84bc973e633ee6,0x3f033f543f7d3f763f403ecdbce2bee6,0xbf5cbf10be203e8f3f293f6b3f803f65,0x3f2b3f7b3f683ef7be07bf32bf7cbf65,0xbf3ebe4e3ed73f603f7e3f383e2cbee6
.octa 0x3f4d3f7b3f06be8fbf66bf6ebeb73ee6,0xbf193e423f5a3f763ee2bebbbf6fbf65,0x3f673f56bd23bf60bf5ebc973f593f65,0xbedc3f0d3f803ef7bf00bf80bf083ee6,0x3f783f10bf17bf76bd843f6b3f30bee6,0xbe7c3f543f4fbe8fbf7fbecd3f3a3f65,0x3f803e4ebf70bef73f4b3f38bf14bf65,0xbd563f7b3eb1bf60bf1c3f323f51bee6
.octa 0x3f7dbe42bf793e8f3f72bebbbf6a3ee6,0x3e133f7bbe70bf763ea53f6ebed1bf65,0x3f71bf0dbf2e3f603e84bf803e633f65,0x3eab3f56bf3cbef73f773c97bf7a3ee6,0x3f5cbf54be203f76bf29becd3f80bee6,0x3f033f10bf7d3e8f3f40bf6b3ce23f65,0x3f3ebf7b3ed73ef7bf7e3f323e2cbf65,0x3f2b3e4ebf683f60be07bf383f7cbee6
.octa 0x3f19bf7b3f5abe8fbee23f6ebf6f3ee6,0x3f4dbe42bf063f76bf663ebb3eb7bf65,0x3edcbf563f80bf603f003c97bf083f65,0x3f67bf0d3d233ef7bf5e3f80bf593ee6,0x3e7cbf103f4fbf763f7fbf6b3f3abee6,0x3f78bf543f17be8fbd843ecdbf303f65,0x3d56be4e3eb1bef73f1cbf383f51bf65,0x3f80bf7b3f70bf603f4bbf323f14bee6
.octa 0x3ea23e8c3e6a3e3b3e0d3dbc3d3c0000,0x3f733f763f793f7c3f7e3f7f3f803f80,0x3f7e3f7e3f703f533f2a3eef3e760000,0xbe003dee3eb43f113f3f3f633f793f80,0x3d903efa3f503f7c3f783f453ed90000,0xbf7fbf60bf15be3b3e813f243f683f80,0xbf77bf1fbd0a3f113f723f753f180000,0xbe87bf49bf80bf53bea83e983f4e3f80
.octa 0xbee5bf76bf5abe3b3f1a3f7f3f3d0000,0x3f653e8cbf07bf7cbf4cbdbc3f2d3f80,0x3f4abdeebf69bf533d6f3f633f5b0000,0x3f1d3f7e3ed4bf11bf80beef3f043f80,0x3f413f60be26bf7cbf023f243f710000,0xbf283efa3f7d3e3bbf5dbf453eae3f80,0xbefe3f493f3bbf11bf663e983f7d0000,0xbf5ebf1f3f2f3f53bedfbf753e193f80
.octa 0xbf73be8c3f793e3bbf7ebdbc3f800000,0x3ea2bf76be6a3f7c3e0dbf7fbd3c3f80,0x3e00bf7e3eb43f53bf3fbeef3f790000,0x3f7ebdeebf703f113f2abf63be763f80,0x3f7fbefabf153f7cbe81bf453f680000,0x3d903f60bf50be3b3f78bf24bed93f80,0x3e873f1fbf803f113ea8bf753f4e0000,0xbf773f493d0abf533f72be98bf183f80
.octa 0xbf653f76bf07be3b3f4cbf7f3f2d0000,0xbee5be8c3f5abf7c3f1a3dbcbf3d3f80,0xbf1d3dee3ed4bf533f80bf633f040000,0x3f4abf7e3f69bf113d6f3eefbf5b3f80,0x3f28bf603f7dbf7c3f5dbf243eae0000,0x3f41befa3e263e3bbf023f45bf713f80,0x3f5ebf493f2fbf113edfbe983e190000,0xbefe3f1fbf3b3f53bf663f75bf7d3f80
.octa 0x3f233f1a3f103f063ef83ee33ece3eb8,0x3f453f4d3f543f5a3f603f653f6a3f6f,0xbef3be7fbc173e6d3eea3f283f523f6f,0xbf61bf78bf80bf79bf64bf41bf13beb8,0x3e96be10bf0cbf5abf7ebf73bf39beb8,0x3f753f7d3f563f063de8bea4bf31bf6f,0xbdcf3f023f6c3f793f253d8abf0abf6f,0xbf7fbf5cbec83e6d3f433f7f3f583eb8
.octa 0xbdc2bf4dbf7cbf063e8d3f653f6f3eb8,0x3f7f3f1abe3fbf5abf76bee33eba3f6f,0x3e933f783f37be6dbf74bf413e323f6f,0xbf75be7f3f333f793e9cbf28bf7cbeb8,0xbef0bf7dbe513f5a3f48bea4bf80beb8,0x3f62be10bf7bbf063f1f3f733cb0bf6f,0x3f223f5cbec0bf793da93f7f3e5dbf6f,0xbf463f023f6dbe6dbf7fbd8a3f7a3eb8
.octa 0xbf45bf1a3f543f06bf60bee33f6a3eb8,0x3f23bf4dbf103f5a3ef8bf65bece3f6f,0x3f613e7fbf803e6d3f64bf28bf133f6f,0xbef33f783c17bf793eea3f41bf52beb8,0xbf753e103f56bf5abde83f73bf31beb8,0x3e96bf7d3f0c3f06bf7e3ea43f39bf6f,0x3f7fbf02bec83f79bf43bd8a3f58bf6f,0xbdcf3f5cbf6c3e6d3f25bf7f3f0a3eb8
.octa 0xbf7f3f4dbe3fbf063f76bf653eba3eb8,0xbdc2bf1a3f7cbf5a3e8d3ee3bf6f3f6f,0x3f75bf783f33be6dbe9c3f41bf7c3f6f,0x3e933e7fbf373f79bf743f28be32beb8,0xbf623f7dbf7b3f5abf1f3ea43cb0beb8,0xbef03e103e51bf063f48bf733f80bf6f,0x3f46bf5c3f6dbf793f7fbf7f3f7abf6f,0x3f22bf023ec0be6d3da93d8abe5d3eb8
.octa 0x3f5f3f593f533f4c3f443f3d3f343f2c,0x3efb3f083f113f1b3f243f2d3f363f3e,0xbf27bf50bf6ebf7ebf7fbf71bf54bf2c,0x3f423f153ebd3e0abddbbeafbf0fbf3e,0xbf1ebe663e573f1b3f633f803f6c3f2c,0xbf49bf79bf7abf4cbeedbd303ec53f3e,0x3f643f7c3f323e0abef6bf68bf7bbf2c,0xbee83e293f383f7e3f613ed8be4bbf3e
.octa 0x3e8abf08bf7cbf4cbdb63f2d3f803f2c,0x3f773f593e38bf1bbf7fbf3d3b493f3e,0xbf7fbf153ecb3f7e3f21beafbf7bbf2c,0x3d9dbf50bf6bbe0a3f473f713e45bf3e,0x3df43f793f0bbf1bbf74bd303f6d3f2c,0xbf7ebe663f573f4cbe99bf80bec23f3e,0x3f73be29bf80be0a3f763ed8bf55bf2c,0x3e9f3f7cbc7bbf7ebe903f683f0ebf3e
.octa 0xbefbbf593f113f4cbf24bf3d3f363f2c,0x3f5fbf08bf533f1b3f44bf2dbf343f3e,0xbf423f503ebdbf7e3ddb3f71bf0fbf2c,0xbf27bf153f6e3e0abf7f3eaf3f54bf3e,0x3f493e66bf7a3f1b3eedbf803ec53f2c,0xbf1e3f79be57bf4c3f633d30bf6c3f3e,0x3ee8bf7c3f383e0abf613f68be4bbf2c,0x3f64be29bf323f7ebef6bed83f7bbf3e
.octa 0xbf773f083e38bf4c3f7fbf2d3b493f2c,0x3e8abf593f7cbf1bbdb63f3dbf803f3e,0xbd9d3f15bf6b3f7ebf473eaf3e45bf2c,0xbf7f3f50becbbe0a3f21bf713f7bbf3e,0x3f7ebf793f57bf1b3e993d30bec23f2c,0x3df43e66bf0b3f4cbf743f80bf6d3f3e,0xbe9f3e29bc7bbe0a3e90bed83f0ebf2c,0x3f73bf7c3f80bf7e3f76bf683f55bf3e
.octa 0x3f7d3f7b3f793f763f723f6e3f6a3f65,0x3e133e423e703e8f3ea53ebb3ed13ee6,0x3f713f563f2e3ef73e843c97be63bee6,0x3eab3f0d3f3c3f603f773f803f7a3f65,0x3f5c3f103e20be8fbf29bf6bbf80bf65,0x3f033f543f7d3f763f403ecdbce2bee6,0x3f3e3e4ebed7bf60bf7ebf38be2c3ee6,0x3f2b3f7b3f683ef7be07bf32bf7cbf65
.octa 0x3f19be42bf5abf76bee23ebb3f6f3f65,0x3f4d3f7b3f06be8fbf66bf6ebeb73ee6,0x3edcbf0dbf80bef73f003f803f08bee6,0x3f673f56bd23bf60bf5ebc973f593f65,0x3e7cbf54bf4f3e8f3f7f3ecdbf3abf65,0x3f783f10bf17bf76bd843f6b3f30bee6,0x3d56bf7bbeb13f603f1cbf32bf513ee6,0x3f803e4ebf70bef73f4b3f38bf14bf65
.octa 0xbe13bf7b3e703f76bea5bf6e3ed13f65,0x3f7dbe42bf793e8f3f72bebbbf6a3ee6,0xbeabbf563f3c3ef7bf77bc973f7abee6,0x3f71bf0dbf2e3f603e84bf803e633f65,0xbf03bf103f7dbe8fbf403f6bbce2bf65,0x3f5cbf54be203f76bf29becd3f80bee6,0xbf2bbe4e3f68bf603e073f38bf7c3ee6,0x3f3ebf7b3ed73ef7bf7e3f323e2cbf65
.octa 0xbf4d3e423f06bf763f66bebbbeb73f65,0x3f19bf7b3f5abe8fbee23f6ebf6f3ee6,0xbf673f0dbd23bef73f5ebf803f59bee6,0x3edcbf563f80bf603f003c97bf083f65,0xbf783f54bf173e8f3d84becd3f30bf65,0x3e7cbf103f4fbf763f7fbf6b3f3abee6,0xbf803f7bbf703f60bf4b3f32bf143ee6,0x3d56be4e3eb1bef73f1cbf383f51bf65
.octa 0xbf733f76bf793f7cbf7e3f7fbf803f80,0x3ea2be8c3e6abe3b3e0dbdbc3d3c8000,0x3e003deebeb43f11bf3f3f63bf793f80,0x3f7ebf7e3f70bf533f2abeef3e768000,0x3f7fbf603f15be3bbe813f24bf683f80,0x3d90befa3f50bf7c3f78bf453ed98000,0x3e87bf493f80bf533ea83e98bf4e3f80,0xbf773f1fbd0abf113f72bf753f188000
.octa 0xbf653e8c3f07bf7c3f4cbdbcbf2d3f80,0xbee53f76bf5a3e3b3f1abf7f3f3d8000,0xbf1d3f7ebed4bf113f80beefbf043f80,0x3f4a3deebf693f533d6fbf633f5b8000,0x3f283efabf7d3e3b3f5dbf45beae3f80,0x3f41bf60be263f7cbf02bf243f718000,0x3f5ebf1fbf2f3f533edfbf75be193f80,0xbefebf493f3b3f11bf66be983f7d8000
.octa 0xbea2bf763e6a3f7cbe0dbf7f3d3c3f80,0xbf733e8c3f79be3bbf7e3dbc3f808000,0xbf7ebdee3f703f11bf2abf633e763f80,0x3e003f7e3eb4bf53bf3f3eef3f798000,0xbd903f603f50be3bbf78bf243ed93f80,0x3f7f3efabf15bf7cbe813f453f688000,0x3f773f49bd0abf53bf72be983f183f80,0x3e87bf1fbf80bf113ea83f753f4e8000
.octa 0x3ee5be8cbf5abf7cbf1a3dbc3f3d3f80,0xbf65bf76bf073e3b3f4c3f7f3f2d8000,0xbf4abf7ebf69bf11bd6f3eef3f5b3f80,0xbf1dbdee3ed43f533f803f633f048000,0xbf41befabe263e3b3f023f453f713f80,0x3f283f603f7d3f7c3f5d3f243eae8000,0x3efe3f1f3f3b3f533f663f753f7d3f80,0x3f5e3f493f2f3f113edf3e983e198000
.octa 0xbf453f4dbf543f5abf603f65bf6a3f6f,0x3f23bf1a3f10bf063ef8bee33ecebeb8,0x3f61bf783f80bf793f64bf413f13beb8,0xbef33e7fbc17be6d3eeabf283f52bf6f,0xbf753f7dbf563f06bde8bea43f31bf6f,0x3e963e10bf0c3f5abf7e3f73bf393eb8,0x3f7fbf5c3ec83e6dbf433f7fbf583eb8,0xbdcfbf023f6cbf793f25bd8abf0a3f6f
.octa 0xbf7f3f1a3e3fbf5a3f76bee3beba3f6f,0xbdc23f4dbf7c3f063e8dbf653f6fbeb8,0x3f75be7fbf333f79be9cbf283f7cbeb8,0x3e93bf783f373e6dbf743f413e32bf6f,0xbf62be103f7bbf06bf1f3f73bcb0bf6f,0xbef03f7dbe51bf5a3f483ea4bf803eb8,0x3f463f02bf6dbe6d3f7fbd8abf7a3eb8,0x3f22bf5cbec03f793da9bf7f3e5d3f6f
.octa 0xbf23bf4d3f103f5abef8bf653ece3f6f,0xbf453f1a3f54bf06bf603ee33f6abeb8,0x3ef33f78bc17bf79beea3f413f52beb8,0x3f61be7fbf80be6d3f643f28bf13bf6f,0xbe96bf7dbf0c3f063f7e3ea4bf39bf6f,0xbf75be103f563f5abde8bf73bf313eb8,0x3dcf3f5c3f6c3e6dbf25bf7fbf0a3eb8,0x3f7f3f02bec8bf79bf433d8a3f583f6f
.octa 0x3dc2bf1abf7cbf5abe8d3ee33f6f3f6f,0xbf7fbf4dbe3f3f063f763f653ebabeb8,0xbe933e7f3f373f793f743f283e32beb8,0x3f753f783f333e6dbe9cbf41bf7cbf6f,0x3ef03e10be51bf06bf48bf73bf80bf6f,0xbf62bf7dbf7bbf5abf1fbea43cb03eb8,0xbf22bf02bec0be6dbda93d8a3e5d3eb8,0x3f463f5c3f6d3f793f7f3f7f3f7a3f6f
.octa 0xbefb3f08bf113f1bbf243f2dbf363f3e,0x3f5fbf593f53bf4c3f44bf3d3f34bf2c,0xbf423f15bebd3e0a3ddbbeaf3f0fbf3e,0xbf273f50bf6e3f7ebf7f3f71bf543f2c,0x3f49bf793f7abf4c3eedbd30bec53f3e,0xbf1e3e663e57bf1b3f63bf803f6cbf2c,0x3ee83e29bf383f7ebf613ed83e4bbf3e,0x3f64bf7c3f32be0abef63f68bf7b3f2c
.octa 0xbf773f59be38bf1b3f7fbf3dbb493f3e,0x3e8a3f08bf7c3f4cbdb6bf2d3f80bf2c,0xbd9dbf503f6bbe0abf473f71be45bf3e,0xbf7f3f153ecbbf7e3f213eafbf7b3f2c,0x3f7ebe66bf573f4c3e99bf803ec23f3e,0x3df4bf793f0b3f1bbf743d303f6dbf2c,0xbe9f3f7c3c7bbf7e3e903f68bf0ebf3e,0x3f733e29bf803e0a3f76bed8bf553f2c
.octa 0xbf5fbf083f533f1bbf44bf2d3f343f3e,0xbefb3f593f11bf4cbf243f3d3f36bf2c,0x3f27bf15bf6e3e0a3f7f3eafbf54bf3e,0xbf42bf503ebd3f7e3ddbbf71bf0f3f2c,0x3f1e3f793e57bf4cbf633d303f6c3f3e,0x3f49be66bf7abf1b3eed3f803ec5bf2c,0xbf64be293f323f7e3ef6bed8bf7bbf3e,0x3ee83f7c3f38be0abf61bf68be4b3f2c
.octa 0xbe8abf59bf7cbf1b3db63f3d3f803f3e,0xbf77bf083e383f4c3f7f3f2d3b49bf2c,0x3f7f3f503ecbbe0abf21bf71bf7bbf3e,0xbd9dbf15bf6bbf7ebf47beaf3e453f2c,0xbdf43e663f0b3f4c3f743f803f6d3f3e,0x3f7e3f793f573f1b3e99bd30bec2bf2c,0xbf73bf7cbf80bf7ebf76bf68bf55bf3e,0xbe9fbe29bc7b3e0a3e903ed83f0e3f2c
.octa 0xbe133e42be703e8fbea53ebbbed13ee6,0x3f7dbf7b3f79bf763f72bf6e3f6abf65,0xbeab3f0dbf3c3f60bf773f80bf7a3f65,0x3f71bf563f2ebef73e84bc97be633ee6,0xbf033f54bf7d3f76bf403ecd3ce2bee6,0x3f5cbf103e203e8fbf293f6bbf803f65,0xbf2b3f7bbf683ef73e07bf323f7cbf65,0x3f3ebe4ebed73f60bf7e3f38be2cbee6
.octa 0xbf4d3f7bbf06be8f3f66bf6e3eb73ee6,0x3f193e42bf5a3f76bee2bebb3f6fbf65,0xbf673f563d23bf603f5ebc97bf593f65,0x3edc3f0dbf803ef73f00bf803f083ee6,0xbf783f103f17bf763d843f6bbf30bee6,0x3e7c3f54bf4fbe8f3f7fbecdbf3a3f65,0xbf803e4e3f70bef7bf4b3f383f14bf65,0x3d563f7bbeb1bf603f1c3f32bf51bee6
.octa 0xbf7dbe423f793e8fbf72bebb3f6a3ee6,0xbe133f7b3e70bf76bea53f6e3ed1bf65,0xbf71bf0d3f2e3f60be84bf80be633f65,0xbeab3f563f3cbef7bf773c973f7a3ee6,0xbf5cbf543e203f763f29becdbf80bee6,0xbf033f103f7d3e8fbf40bf6bbce23f65,0xbf3ebf7bbed73ef73f7e3f32be2cbf65,0xbf2b3e4e3f683f603e07bf38bf7cbee6
.octa 0xbf19bf7bbf5abe8f3ee23f6e3f6f3ee6,0xbf4dbe423f063f763f663ebbbeb7bf65,0xbedcbf56bf80bf60bf003c973f083f65,0xbf67bf0dbd233ef73f5e3f803f593ee6,0xbe7cbf10bf4fbf76bf7fbf6bbf3abee6,0xbf78bf54bf17be8f3d843ecd3f303f65,0xbd56be4ebeb1bef7bf1cbf38bf51bf65,0xbf80bf7bbf70bf60bf4bbf32bf14bee6
.octa 0xbea23e8cbe6a3e3bbe0d3dbcbd3c0000,0xbf733f76bf793f7cbf7e3f7fbf803f80,0xbf7e3f7ebf703f53bf2a3eefbe760000,0x3e003deebeb43f11bf3f3f63bf793f80,0xbd903efabf503f7cbf783f45bed90000,0x3f7fbf603f15be3bbe813f24bf683f80,0x3f77bf1f3d0a3f11bf723f75bf180000,0x3e87bf493f80bf533ea83e98bf4e3f80
.octa 0x3ee5bf763f5abe3bbf1a3f7fbf3d0000,0xbf653e8c3f07bf7c3f4cbdbcbf2d3f80,0xbf4abdee3f69bf53bd6f3f63bf5b0000,0xbf1d3f7ebed4bf113f80beefbf043f80,0xbf413f603e26bf7c3f023f24bf710000,0x3f283efabf7d3e3b3f5dbf45beae3f80,0x3efe3f49bf3bbf113f663e98bf7d0000,0x3f5ebf1fbf2f3f533edfbf75be193f80
.octa 0x3f73be8cbf793e3b3f7ebdbcbf800000,0xbea2bf763e6a3f7cbe0dbf7f3d3c3f80,0xbe00bf7ebeb43f533f3fbeefbf790000,0xbf7ebdee3f703f11bf2abf633e763f80,0xbf7fbefa3f153f7c3e81bf45bf680000,0xbd903f603f50be3bbf78bf243ed93f80,0xbe873f1f3f803f11bea8bf75bf4e0000,0x3f773f49bd0abf53bf72be983f183f80
.octa 0x3f653f763f07be3bbf4cbf7fbf2d0000,0x3ee5be8cbf5abf7cbf1a3dbc3f3d3f80,0x3f1d3deebed4bf53bf80bf63bf040000,0xbf4abf7ebf69bf11bd6f3eef3f5b3f80,0xbf28bf60bf7dbf7cbf5dbf24beae0000,0xbf41befabe263e3b3f023f453f713f80,0xbf5ebf49bf2fbf11bedfbe98be190000,0x3efe3f1f3f3b3f533f663f753f7d3f80
.octa 0xbf233f1abf103f06bef83ee3bece3eb8,0xbf453f4dbf543f5abf603f65bf6a3f6f,0x3ef3be7f3c173e6dbeea3f28bf523f6f,0x3f61bf783f80bf793f64bf413f13beb8,0xbe96be103f0cbf5a3f7ebf733f39beb8,0xbf753f7dbf563f06bde8bea43f31bf6f,0x3dcf3f02bf6c3f79bf253d8a3f0abf6f,0x3f7fbf5c3ec83e6dbf433f7fbf583eb8
.octa 0x3dc2bf4d3f7cbf06be8d3f65bf6f3eb8,0xbf7f3f1a3e3fbf5a3f76bee3beba3f6f,0xbe933f78bf37be6d3f74bf41be323f6f,0x3f75be7fbf333f79be9cbf283f7cbeb8,0x3ef0bf7d3e513f5abf48bea43f80beb8,0xbf62be103f7bbf06bf1f3f73bcb0bf6f,0xbf223f5c3ec0bf79bda93f7fbe5dbf6f,0x3f463f02bf6dbe6d3f7fbd8abf7a3eb8
.octa 0x3f45bf1abf543f063f60bee3bf6a3eb8,0xbf23bf4d3f103f5abef8bf653ece3f6f,0xbf613e7f3f803e6dbf64bf283f133f6f,0x3ef33f78bc17bf79beea3f413f52beb8,0x3f753e10bf56bf5a3de83f733f31beb8,0xbe96bf7dbf0c3f063f7e3ea4bf39bf6f,0xbf7fbf023ec83f793f43bd8abf58bf6f,0x3dcf3f5c3f6c3e6dbf25bf7fbf0a3eb8
.octa 0x3f7f3f4d3e3fbf06bf76bf65beba3eb8,0x3dc2bf1abf7cbf5abe8d3ee33f6f3f6f,0xbf75bf78bf33be6d3e9c3f413f7c3f6f,0xbe933e7f3f373f793f743f283e32beb8,0x3f623f7d3f7b3f5a3f1f3ea4bcb0beb8,0x3ef03e10be51bf06bf48bf73bf80bf6f,0xbf46bf5cbf6dbf79bf7fbf7fbf7abf6f,0xbf22bf02bec0be6dbda93d8a3e5d3eb8
.octa 0xbf5f3f59bf533f4cbf443f3dbf343f2c,0xbefb3f08bf113f1bbf243f2dbf363f3e,0x3f27bf503f6ebf7e3f7fbf713f54bf2c,0xbf423f15bebd3e0a3ddbbeaf3f0fbf3e,0x3f1ebe66be573f1bbf633f80bf6c3f2c,0x3f49bf793f7abf4c3eedbd30bec53f3e,0xbf643f7cbf323e0a3ef6bf683f7bbf2c,0x3ee83e29bf383f7ebf613ed83e4bbf3e
.octa 0xbe8abf083f7cbf4c3db63f2dbf803f2c,0xbf773f59be38bf1b3f7fbf3dbb493f3e,0x3f7fbf15becb3f7ebf21beaf3f7bbf2c,0xbd9dbf503f6bbe0abf473f71be45bf3e,0xbdf43f79bf0bbf1b3f74bd30bf6d3f2c,0x3f7ebe66bf573f4c3e99bf803ec23f3e,0xbf73be293f80be0abf763ed83f55bf2c,0xbe9f3f7c3c7bbf7e3e903f68bf0ebf3e
.octa 0x3efbbf59bf113f4c3f24bf3dbf363f2c,0xbf5fbf083f533f1bbf44bf2d3f343f3e,0x3f423f50bebdbf7ebddb3f713f0fbf2c,0x3f27bf15bf6e3e0a3f7f3eafbf54bf3e,0xbf493e663f7a3f1bbeedbf80bec53f2c,0x3f1e3f793e57bf4cbf633d303f6c3f3e,0xbee8bf7cbf383e0a3f613f683e4bbf2c,0xbf64be293f323f7e3ef6bed8bf7bbf3e
.octa 0x3f773f08be38bf4cbf7fbf2dbb493f2c,0xbe8abf59bf7cbf1b3db63f3d3f803f3e,0x3d9d3f153f6b3f7e3f473eafbe45bf2c,0x3f7f3f503ecbbe0abf21bf71bf7bbf3e,0xbf7ebf79bf57bf1bbe993d303ec23f2c,0xbdf43e663f0b3f4c3f743f803f6d3f3e,0x3e9f3e293c7bbe0abe90bed8bf0ebf2c,0xbf73bf7cbf80bf7ebf76bf68bf55bf3e
.octa 0xbf7d3f7bbf793f76bf723f6ebf6a3f65,0xbe133e42be703e8fbea53ebbbed13ee6,0xbf713f56bf2e3ef7be843c973e63bee6,0xbeab3f0dbf3c3f60bf773f80bf7a3f65,0xbf5c3f10be20be8f3f29bf6b3f80bf65,0xbf033f54bf7d3f76bf403ecd3ce2bee6,0xbf3e3e4e3ed7bf603f7ebf383e2c3ee6,0xbf2b3f7bbf683ef73e07bf323f7cbf65
.octa 0xbf19be423f5abf763ee23ebbbf6f3f65,0xbf4d3f7bbf06be8f3f66bf6e3eb73ee6,0xbedcbf0d3f80bef7bf003f80bf08bee6,0xbf673f563d23bf603f5ebc97bf593f65,0xbe7cbf543f4f3e8fbf7f3ecd3f3abf65,0xbf783f103f17bf763d843f6bbf30bee6,0xbd56bf7b3eb13f60bf1cbf323f513ee6,0xbf803e4e3f70bef7bf4b3f383f14bf65
.octa 0x3e13bf7bbe703f763ea5bf6ebed13f65,0xbf7dbe423f793e8fbf72bebb3f6a3ee6,0x3eabbf56bf3c3ef73f77bc97bf7abee6,0xbf71bf0d3f2e3f60be84bf80be633f65,0x3f03bf10bf7dbe8f3f403f6b3ce2bf65,0xbf5cbf543e203f763f29becdbf80bee6,0x3f2bbe4ebf68bf60be073f383f7c3ee6,0xbf3ebf7bbed73ef73f7e3f32be2cbf65
.octa 0x3f4d3e42bf06bf76bf66bebb3eb73f65,0xbf19bf7bbf5abe8f3ee23f6e3f6f3ee6,0x3f673f0d3d23bef7bf5ebf80bf59bee6,0xbedcbf56bf80bf60bf003c973f083f65,0x3f783f543f173e8fbd84becdbf30bf65,0xbe7cbf10bf4fbf76bf7fbf6bbf3abee6,0x3f803f7b3f703f603f4b3f323f143ee6,0xbd56be4ebeb1bef7bf1cbf38bf51bf65
.octa 0x3f713f753f783f7b3f7d3f7f3f803f80,0xbeacbe95be79be48be16bdc9bd498000,0xbe163dc93eac3f0e3f3e3f623f783f80,0xbf7dbf7fbf71bf55bf2cbef1be798000,0xbf80bf62bf18be483e793f223f673f80,0xbd49bef1bf4ebf7bbf78bf46bedb8000,0xbe79bf46bf80bf55beac3e953f4e3f80,0x3f783f223d49bf0ebf71bf75bf188000
.octa 0x3f673e95bf04bf7bbf4ebdc93f2c3f80,0x3edb3f753f5c3e48bf18bf7fbf3e8000,0x3f183f7f3edbbf0ebf80bef13f043f80,0xbf4e3dc93f673f55bd49bf62bf5c8000,0xbf2c3ef13f7d3e48bf5cbf463eac3f80,0xbf3ebf623e163f7b3f04bf22bf718000,0xbf5cbf223f2c3f55bedbbf753e163f80,0x3f04bf46bf3e3f0e3f67be95bf7d8000
.octa 0x3eacbf75be793f7b3e16bf7fbd493f80,0x3f713e95bf78be483f7d3dc9bf808000,0x3f7dbdc9bf713f0e3f2cbf62be793f80,0xbe163f7fbeacbf553f3e3ef1bf788000,0x3d493f62bf4ebe483f78bf22bedb3f80,0xbf803ef13f18bf7b3e793f46bf678000,0xbf783f463d49bf553f71be95bf183f80,0xbe79bf223f80bf0ebeac3f75bf4e8000
.octa 0xbedbbe953f5cbf7b3f183dc9bf3e3f80,0x3f67bf753f043e48bf4e3f7fbf2c8000,0x3f4ebf7f3f67bf0e3d493ef1bf5c3f80,0x3f18bdc9bedb3f55bf803f62bf048000,0x3f3ebef13e163e48bf043f46bf713f80,0xbf2c3f62bf7d3f7bbf5c3f22beac8000,0xbf043f22bf3e3f55bf673f75bf7d3f80,0xbf5c3f46bf2c3f0ebedb3e95be168000
.octa 0x3f3e3f463f4e3f553f5c3f623f673f6d,0xbf2cbf22bf18bf0ebf04bef1bedbbec4,0xbf5cbf75bf80bf7bbf67bf46bf18bec4,0x3f043e953d49be48bedbbf22bf4ebf6d,0x3f713f7f3f5c3f0e3e16be95bf2cbf6d,0xbeac3dc93f043f553f7d3f753f3e3ec4,0xbf7dbf62bedb3e483f3e3f7f3f5c3ec4,0x3e16bef1bf67bf7bbf2cbdc93f043f6d
.octa 0x3f803f22be16bf55bf78bef13eac3f6d,0x3d493f463f7d3f0ebe79bf62bf71bec4,0xbf78be953f2c3f7b3eacbf22bf7dbec4,0xbe79bf75bf3e3e483f713f46be16bf6d,0x3f67bdc9bf78bf0e3f183f753d49bf6d,0x3edb3f7f3e79bf55bf4e3e953f803ec4,0xbf4e3ef13f71be48bf80bdc93f783ec4,0xbf18bf623eac3f7bbd49bf7fbe793f6d
.octa 0x3f2cbf46bf183f553f04bf62bedb3f6d,0x3f3e3f22bf4ebf0e3f5c3ef1bf67bec4,0xbf043f753d49bf7b3edb3f46bf4ebec4,0xbf5cbe953f80be48bf673f223f18bf6d,0x3eacbf7f3f043f0ebf7d3e953f3ebf6d,0x3f71bdc9bf5c3f553e16bf753f2c3ec4,0xbe163f62bf673e483f2cbf7f3f043ec4,0xbf7d3ef13edbbf7b3f3e3dc9bf5c3f6d
.octa 0xbd49bf223f7dbf553e793ef1bf713f6d,0x3f80bf463e163f0ebf783f62beacbec4,0x3e793e95bf3e3f7bbf713f22be16bec4,0xbf783f75bf2c3e483eacbf463f7dbf6d,0xbedb3dc93e79bf0e3f4ebf753f80bf6d,0x3f67bf7f3f78bf553f18be95bd493ec4,0x3f18bef13eacbe483d493dc9be793ec4,0xbf4e3f62bf713f7bbf803f7fbf783f6d
.octa 0x3edb3ef13f043f0e3f183f223f2c3f35,0xbf67bf62bf5cbf55bf4ebf46bf3ebf35,0x3f4e3f223edb3e48bd49be95bf04bf35,0x3f183f463f673f7b3f803f753f5c3f35,0xbf3ebf75bf7dbf55bf04bdc93eac3f35,0x3f2c3e95be16bf0ebf5cbf7fbf71bf35,0xbf043dc93f2c3f7b3f673ef1be16bf35,0xbf5cbf7fbf3ebe483edb3f623f7d3f35
.octa 0x3f713f623e79bf0ebf7dbf46bd493f35,0xbeac3ef13f783f553e16bf22bf80bf35,0x3e16bf46bf71be483f3e3f753e79bf35,0x3f7d3f22beacbf7bbf2c3e953f783f35,0xbf80be953f4e3f55be79bf7fbedb3f35,0xbd49bf75bf183f0e3f783dc9bf67bf35,0x3e793f7f3d49bf7bbeac3f623f18bf35,0xbf783dc93f803e48bf71bef13f4e3f35
.octa 0x3f67bef1bf5c3f0e3f4ebf22bf3e3f35,0x3edb3f62bf04bf553f183f46bf2cbf35,0xbf18bf223f673e48bf803e953f5cbf35,0x3f4ebf46bedb3f7bbd49bf753f043f35,0xbf2c3f75be16bf553f5c3dc9bf713f35,0xbf3ebe953f7dbf0ebf043f7fbeacbf35,0x3f5cbdc9bf3e3f7bbedbbef13f7dbf35,0xbf043f7fbf2cbe483f67bf623e163f35
.octa 0x3eacbf623f78bf0ebe163f46bf803f35,0x3f71bef1be793f55bf7d3f223d49bf35,0xbf7d3f46beacbe483f2cbf753f78bf35,0x3e16bf223f71bf7b3f3ebe95be793f35,0x3d493e95bf183f55bf783f7fbf673f35,0xbf803f75bf4e3f0ebe79bdc93edbbf35,0x3f78bf7f3f80bf7b3f71bf623f4ebf35,0x3e79bdc9bd493e48beac3ef1bf183f35
.octa 0x3d493dc93e163e483e793e953eac3ec4,0xbf80bf7fbf7dbf7bbf78bf75bf71bf6d,0x3e793ef13f2c3f553f713f7f3f7d3f6d,0xbf78bf62bf3ebf0ebeacbdc93e163ec4,0x3edb3f463f783f7b3f4e3ef13d49bec4,0xbf67bf22be793e483f183f623f803f6d,0x3f183f753f713f0ebd49bf22bf78bf6d,0xbf4ebe953eac3f553f803f463e79bec4
.octa 0x3f3e3f7f3f18be48bf5cbf75bedb3ec4,0xbf2c3dc93f4e3f7b3f04be95bf67bf6d,0x3f5c3f623d49bf55bf67bdc93f4e3f6d,0xbf043ef13f803f0ebedbbf7fbf183ec4,0x3f713f22bf04bf7bbe163f623f3ebec4,0xbeac3f463f5cbe48bf7dbef13f2c3f6d,0x3f7d3e95bf67bf0e3f3e3f46bf04bf6d,0xbe163f753edbbf55bf2c3f223f5cbec4
.octa 0x3f80bdc9bf7d3e483f78be95bf713ec4,0x3d493f7fbe16bf7b3e793f75beacbf6d,0x3f78bef1bf3e3f553eacbf7f3e163f6d,0x3e793f62bf2cbf0e3f713dc9bf7d3ec4,0x3f67bf46be793f7bbf18bef13f80bec4,0x3edb3f22bf783e483f4ebf62bd493f6d,0x3f4ebf753eac3f0ebf803f223e79bf6d,0x3f183e95bf713f55bd49bf463f78bec4
.octa 0x3f2cbf7f3f4ebe48bf043f75bf673ec4,0x3f3ebdc9bf183f7bbf5c3e953edbbf6d,0x3f04bf623f80bf553edb3dc9bf183f6d,0x3f5cbef1bd493f0ebf673f7fbf4e3ec4,0x3eacbf223f5cbf7b3f7dbf623f2cbec4,0x3f71bf463f04be48be163ef1bf3e3f6d,0x3e16be953edbbf0e3f2cbf463f5cbf6d,0x3f7dbf753f67bf553f3ebf223f04bec4
.octa 0x3eac3e953e793e483e163dc93d490000,0x3f713f753f783f7b3f7d3f7f3f803f80,0x3f7d3f7f3f713f553f2c3ef13e790000,0xbe163dc93eac3f0e3f3e3f623f783f80,0x3d493ef13f4e3f7b3f783f463edb0000,0xbf80bf62bf18be483e793f223f673f80,0xbf78bf22bd493f0e3f713f753f180000,0xbe79bf46bf80bf55beac3e953f4e3f80
.octa 0xbedbbf75bf5cbe483f183f7f3f3e0000,0x3f673e95bf04bf7bbf4ebdc93f2c3f80,0x3f4ebdc9bf67bf553d493f623f5c0000,0x3f183f7f3edbbf0ebf80bef13f043f80,0x3f3e3f62be16bf7bbf043f223f710000,0xbf2c3ef13f7d3e48bf5cbf463eac3f80,0xbf043f463f3ebf0ebf673e953f7d0000,0xbf5cbf223f2c3f55bedbbf753e163f80
.octa 0xbf71be953f783e48bf7dbdc93f800000,0x3eacbf75be793f7b3e16bf7fbd493f80,0x3e16bf7f3eac3f55bf3ebef13f780000,0x3f7dbdc9bf713f0e3f2cbf62be793f80,0x3f80bef1bf183f7bbe79bf463f670000,0x3d493f62bf4ebe483f78bf22bedb3f80,0x3e793f22bf803f0e3eacbf753f4e0000,0xbf783f463d49bf553f71be95bf183f80
.octa 0xbf673f75bf04be483f4ebf7f3f2c0000,0xbedbbe953f5cbf7b3f183dc9bf3e3f80,0xbf183dc93edbbf553f80bf623f040000,0x3f4ebf7f3f67bf0e3d493ef1bf5c3f80,0x3f2cbf623f7dbf7b3f5cbf223eac0000,0x3f3ebef13e163e48bf043f46bf713f80,0x3f5cbf463f2cbf0e3edbbe953e160000,0xbf043f22bf3e3f55bf673f75bf7d3f80
.octa 0x3f2c3f223f183f0e3f043ef13edb3ec4,0x3f3e3f463f4e3f553f5c3f623f673f6d,0xbf04be95bd493e483edb3f223f4e3f6d,0xbf5cbf75bf80bf7bbf67bf46bf18bec4,0x3eacbdc9bf04bf55bf7dbf75bf3ebec4,0x3f713f7f3f5c3f0e3e16be95bf2cbf6d,0xbe163ef13f673f7b3f2c3dc9bf04bf6d,0xbf7dbf62bedb3e483f3e3f7f3f5c3ec4
.octa 0xbd49bf46bf7dbf0e3e793f623f713ec4,0x3f803f22be16bf55bf78bef13eac3f6d,0x3e793f753f3ebe48bf71bf463e163f6d,0xbf78be953f2c3f7b3eacbf22bf7dbec4,0xbedbbf7fbe793f553f4ebe95bf80bec4,0x3f67bdc9bf78bf0e3f183f753d49bf6d,0x3f183f62beacbf7b3d493f7f3e79bf6d,0xbf4e3ef13f71be48bf80bdc93f783ec4
.octa 0xbf3ebf223f4e3f0ebf5cbef13f673ec4,0x3f2cbf46bf183f553f04bf62bedb3f6d,0x3f5c3e95bf803e483f67bf22bf183f6d,0xbf043f753d49bf7b3edb3f46bf4ebec4,0xbf713dc93f5cbf55be163f75bf2cbec4,0x3eacbf7f3f043f0ebf7d3e953f3ebf6d,0x3f7dbef1bedb3f7bbf3ebdc93f5cbf6d,0xbe163f62bf673e483f2cbf7f3f043ec4
.octa 0xbf803f46be16bf0e3f78bf623eac3ec4,0xbd49bf223f7dbf553e793ef1bf713f6d,0x3f78bf753f2cbe48beac3f46bf7d3f6d,0x3e793e95bf3e3f7bbf713f22be16bec4,0xbf673f7fbf783f55bf183e953d49bec4,0xbedb3dc93e79bf0e3f4ebf753f80bf6d,0x3f4ebf623f71bf7b3f80bf7f3f78bf6d,0x3f18bef13eacbe483d493dc9be793ec4
.octa 0x3f673f623f5c3f553f4e3f463f3e3f35,0x3edb3ef13f043f0e3f183f223f2c3f35,0xbf18bf46bf67bf7bbf80bf75bf5cbf35,0x3f4e3f223edb3e48bd49be95bf04bf35,0xbf2cbe953e163f0e3f5c3f7f3f713f35,0xbf3ebf75bf7dbf55bf04bdc93eac3f35,0x3f5c3f7f3f3e3e48bedbbf62bf7dbf35,0xbf043dc93f2c3f7b3f673ef1be16bf35
.octa 0x3eacbef1bf78bf55be163f223f803f35,0x3f713f623e79bf0ebf7dbf46bd493f35,0xbf7dbf223eac3f7b3f2cbe95bf78bf35,0x3e16bf46bf71be483f3e3f753e79bf35,0x3d493f753f18bf0ebf78bdc93f673f35,0xbf80be953f4e3f55be79bf7fbedb3f35,0x3f78bdc9bf80be483f713ef1bf4ebf35,0x3e793f7f3d49bf7bbeac3f623f18bf35
.octa 0xbedbbf623f043f55bf18bf463f2c3f35,0x3f67bef1bf5c3f0e3f4ebf22bf3e3f35,0xbf4e3f463edbbf7b3d493f75bf04bf35,0xbf18bf223f673e48bf803e953f5cbf35,0x3f3e3e95bf7d3f0e3f04bf7f3eac3f35,0xbf2c3f75be16bf553f5c3dc9bf713f35,0x3f04bf7f3f2c3e48bf673f62be16bf35,0x3f5cbdc9bf3e3f7bbedbbef13f7dbf35
.octa 0xbf713ef13e79bf553f7dbf22bd493f35,0x3eacbf623f78bf0ebe163f46bf803f35,0xbe163f22bf713f7bbf3e3e953e79bf35,0xbf7d3f46beacbe483f2cbf753f78bf35,0x3f80bf753f4ebf0e3e793dc9bedb3f35,0x3d493e95bf183f55bf783f7fbf673f35,0xbe793dc93d49be483eacbef13f18bf35,0x3f78bf7f3f80bf7b3f71bf623f4ebf35
.octa 0x3f803f7f3f7d3f7b3f783f753f713f6d,0x3d493dc93e163e483e793e953eac3ec4,0x3f783f623f3e3f0e3eac3dc9be16bec4,0x3e793ef13f2c3f553f713f7f3f7d3f6d,0x3f673f223e79be48bf18bf62bf80bf6d,0x3edb3f463f783f7b3f4e3ef13d49bec4,0x3f4e3e95beacbf55bf80bf46be793ec4,0x3f183f753f713f0ebd49bf22bf78bf6d
.octa 0x3f2cbdc9bf4ebf7bbf043e953f673f6d,0x3f3e3f7f3f18be48bf5cbf75bedb3ec4,0x3f04bef1bf80bf0e3edb3f7f3f18bec4,0x3f5c3f623d49bf55bf67bdc93f4e3f6d,0x3eacbf46bf5c3e483f7d3ef1bf2cbf6d,0x3f713f22bf04bf7bbe163f623f3ebec4,0x3e16bf75bedb3f553f2cbf22bf5c3ec4,0x3f7d3e95bf67bf0e3f3e3f46bf04bf6d
.octa 0xbd49bf7f3e163f7bbe79bf753eac3f6d,0x3f80bdc9bf7d3e483f78be95bf713ec4,0xbe79bf623f2c3f0ebf71bdc93f7dbec4,0x3f78bef1bf3e3f553eacbf7f3e163f6d,0xbedbbf223f78be48bf4e3f623d49bf6d,0x3f67bf46be793f7bbf18bef13f80bec4,0xbf18be953f71bf553d493f46bf783ec4,0x3f4ebf753eac3f0ebf803f223e79bf6d
.octa 0xbf3e3dc93f18bf7b3f5cbe95bedb3f6d,0x3f2cbf7f3f4ebe48bf043f75bf673ec4,0xbf5c3ef13d49bf0e3f67bf7f3f4ebec4,0x3f04bf623f80bf553edb3dc9bf183f6d,0xbf713f46bf043e483e16bef13f3ebf6d,0x3eacbf223f5cbf7b3f7dbf623f2cbec4,0xbf7d3f75bf673f55bf3e3f22bf043ec4,0x3e16be953edbbf0e3f2cbf463f5cbf6d
.octa 0xbf713f75bf783f7bbf7d3f7fbf803f80,0x3eacbe953e79be483e16bdc93d498000,0x3e163dc9beac3f0ebf3e3f62bf783f80,0x3f7dbf7f3f71bf553f2cbef13e798000,0x3f80bf623f18be48be793f22bf673f80,0x3d49bef13f4ebf7b3f78bf463edb8000,0x3e79bf463f80bf553eac3e95bf4e3f80,0xbf783f22bd49bf0e3f71bf753f188000
.octa 0xbf673e953f04bf7b3f4ebdc9bf2c3f80,0xbedb3f75bf5c3e483f18bf7f3f3e8000,0xbf183f7fbedbbf0e3f80bef1bf043f80,0x3f4e3dc9bf673f553d49bf623f5c8000,0x3f2c3ef1bf7d3e483f5cbf46beac3f80,0x3f3ebf62be163f7bbf04bf223f718000,0x3f5cbf22bf2c3f553edbbf75be163f80,0xbf04bf463f3e3f0ebf67be953f7d8000
.octa 0xbeacbf753e793f7bbe16bf7f3d493f80,0xbf713e953f78be48bf7d3dc93f808000,0xbf7dbdc93f713f0ebf2cbf623e793f80,0x3e163f7f3eacbf55bf3e3ef13f788000,0xbd493f623f4ebe48bf78bf223edb3f80,0x3f803ef1bf18bf7bbe793f463f678000,0x3f783f46bd49bf55bf71be953f183f80,0x3e79bf22bf80bf0e3eac3f753f4e8000
.octa 0x3edbbe95bf5cbf7bbf183dc93f3e3f80,0xbf67bf75bf043e483f4e3f7f3f2c8000,0xbf4ebf7fbf67bf0ebd493ef13f5c3f80,0xbf18bdc93edb3f553f803f623f048000,0xbf3ebef1be163e483f043f463f713f80,0x3f2c3f623f7d3f7b3f5c3f223eac8000,0x3f043f223f3e3f553f673f753f7d3f80,0x3f5c3f463f2c3f0e3edb3e953e168000
.octa 0xbf3e3f46bf4e3f55bf5c3f62bf673f6d,0x3f2cbf223f18bf0e3f04bef13edbbec4,0x3f5cbf753f80bf7b3f67bf463f18bec4,0xbf043e95bd49be483edbbf223f4ebf6d,0xbf713f7fbf5c3f0ebe16be953f2cbf6d,0x3eac3dc9bf043f55bf7d3f75bf3e3ec4,0x3f7dbf623edb3e48bf3e3f7fbf5c3ec4,0xbe16bef13f67bf7b3f2cbdc9bf043f6d
.octa 0xbf803f223e16bf553f78bef1beac3f6d,0xbd493f46bf7d3f0e3e79bf623f71bec4,0x3f78be95bf2c3f7bbeacbf223f7dbec4,0x3e79bf753f3e3e48bf713f463e16bf6d,0xbf67bdc93f78bf0ebf183f75bd49bf6d,0xbedb3f7fbe79bf553f4e3e95bf803ec4,0x3f4e3ef1bf71be483f80bdc9bf783ec4,0x3f18bf62beac3f7b3d49bf7f3e793f6d
.octa 0xbf2cbf463f183f55bf04bf623edb3f6d,0xbf3e3f223f4ebf0ebf5c3ef13f67bec4,0x3f043f75bd49bf7bbedb3f463f4ebec4,0x3f5cbe95bf80be483f673f22bf18bf6d,0xbeacbf7fbf043f0e3f7d3e95bf3ebf6d,0xbf71bdc93f5c3f55be16bf75bf2c3ec4,0x3e163f623f673e48bf2cbf7fbf043ec4,0x3f7d3ef1bedbbf7bbf3e3dc93f5c3f6d
.octa 0x3d49bf22bf7dbf55be793ef13f713f6d,0xbf80bf46be163f0e3f783f623eacbec4,0xbe793e953f3e3f7b3f713f223e16bec4,0x3f783f753f2c3e48beacbf46bf7dbf6d,0x3edb3dc9be79bf0ebf4ebf75bf80bf6d,0xbf67bf7fbf78bf55bf18be953d493ec4,0xbf18bef1beacbe48bd493dc93e793ec4,0x3f4e3f623f713f7b3f803f7f3f783f6d
.octa 0xbedb3ef1bf043f0ebf183f22bf2c3f35,0x3f67bf623f5cbf553f4ebf463f3ebf35,0xbf4e3f22bedb3e483d49be953f04bf35,0xbf183f46bf673f7bbf803f75bf5c3f35,0x3f3ebf753f7dbf553f04bdc9beac3f35,0xbf2c3e953e16bf0e3f5cbf7f3f71bf35,0x3f043dc9bf2c3f7bbf673ef13e16bf35,0x3f5cbf7f3f3ebe48bedb3f62bf7d3f35
.octa 0xbf713f62be79bf0e3f7dbf463d493f35,0x3eac3ef1bf783f55be16bf223f80bf35,0xbe16bf463f71be48bf3e3f75be79bf35,0xbf7d3f223eacbf7b3f2c3e95bf783f35,0x3f80be95bf4e3f553e79bf7f3edb3f35,0x3d49bf753f183f0ebf783dc93f67bf35,0xbe793f7fbd49bf7b3eac3f62bf18bf35,0x3f783dc9bf803e483f71bef1bf4e3f35
.octa 0xbf67bef13f5c3f0ebf4ebf223f3e3f35,0xbedb3f623f04bf55bf183f463f2cbf35,0x3f18bf22bf673e483f803e95bf5cbf35,0xbf4ebf463edb3f7b3d49bf75bf043f35,0x3f2c3f753e16bf55bf5c3dc93f713f35,0x3f3ebe95bf7dbf0e3f043f7f3eacbf35,0xbf5cbdc93f3e3f7b3edbbef1bf7dbf35,0x3f043f7f3f2cbe48bf67bf62be163f35
.octa 0xbeacbf62bf78bf0e3e163f463f803f35,0xbf71bef13e793f553f7d3f22bd49bf35,0x3f7d3f463eacbe48bf2cbf75bf78bf35,0xbe16bf22bf71bf7bbf3ebe953e793f35,0xbd493e953f183f553f783f7f3f673f35,0x3f803f753f4e3f0e3e79bdc9bedbbf35,0xbf78bf7fbf80bf7bbf71bf62bf4ebf35,0xbe79bdc93d493e483eac3ef13f183f35
.octa 0xbd493dc9be163e48be793e95beac3ec4,0x3f80bf7f3f7dbf7b3f78bf753f71bf6d,0xbe793ef1bf2c3f55bf713f7fbf7d3f6d,0x3f78bf623f3ebf0e3eacbdc9be163ec4,0xbedb3f46bf783f7bbf4e3ef1bd49bec4,0x3f67bf223e793e48bf183f62bf803f6d,0xbf183f75bf713f0e3d49bf223f78bf6d,0x3f4ebe95beac3f55bf803f46be79bec4
.octa 0xbf3e3f7fbf18be483f5cbf753edb3ec4,0x3f2c3dc9bf4e3f7bbf04be953f67bf6d,0xbf5c3f62bd49bf553f67bdc9bf4e3f6d,0x3f043ef1bf803f0e3edbbf7f3f183ec4,0xbf713f223f04bf7b3e163f62bf3ebec4,0x3eac3f46bf5cbe483f7dbef1bf2c3f6d,0xbf7d3e953f67bf0ebf3e3f463f04bf6d,0x3e163f75bedbbf553f2c3f22bf5cbec4
.octa 0xbf80bdc93f7d3e48bf78be953f713ec4,0xbd493f7f3e16bf7bbe793f753eacbf6d,0xbf78bef13f3e3f55beacbf7fbe163f6d,0xbe793f623f2cbf0ebf713dc93f7d3ec4,0xbf67bf463e793f7b3f18bef1bf80bec4,0xbedb3f223f783e48bf4ebf623d493f6d,0xbf4ebf75beac3f0e3f803f22be79bf6d,0xbf183e953f713f553d49bf46bf78bec4
.octa 0xbf2cbf7fbf4ebe483f043f753f673ec4,0xbf3ebdc93f183f7b3f5c3e95bedbbf6d,0xbf04bf62bf80bf55bedb3dc93f183f6d,0xbf5cbef13d493f0e3f673f7f3f4e3ec4,0xbeacbf22bf5cbf7bbf7dbf62bf2cbec4,0xbf71bf46bf04be483e163ef13f3e3f6d,0xbe16be95bedbbf0ebf2cbf46bf5cbf6d,0xbf7dbf75bf67bf55bf3ebf22bf04bec4
.octa 0xbeac3e95be793e48be163dc9bd490000,0xbf713f75bf783f7bbf7d3f7fbf803f80,0xbf7d3f7fbf713f55bf2c3ef1be790000,0x3e163dc9beac3f0ebf3e3f62bf783f80,0xbd493ef1bf4e3f7bbf783f46bedb0000,0x3f80bf623f18be48be793f22bf673f80,0x3f78bf223d493f0ebf713f75bf180000,0x3e79bf463f80bf553eac3e95bf4e3f80
.octa 0x3edbbf753f5cbe48bf183f7fbf3e0000,0xbf673e953f04bf7b3f4ebdc9bf2c3f80,0xbf4ebdc93f67bf55bd493f62bf5c0000,0xbf183f7fbedbbf0e3f80bef1bf043f80,0xbf3e3f623e16bf7b3f043f22bf710000,0x3f2c3ef1bf7d3e483f5cbf46beac3f80,0x3f043f46bf3ebf0e3f673e95bf7d0000,0x3f5cbf22bf2c3f553edbbf75be163f80
.octa 0x3f71be95bf783e483f7dbdc9bf800000,0xbeacbf753e793f7bbe16bf7f3d493f80,0xbe16bf7fbeac3f553f3ebef1bf780000,0xbf7dbdc93f713f0ebf2cbf623e793f80,0xbf80bef13f183f7b3e79bf46bf670000,0xbd493f623f4ebe48bf78bf223edb3f80,0xbe793f223f803f0ebeacbf75bf4e0000,0x3f783f46bd49bf55bf71be953f183f80
.octa 0x3f673f753f04be48bf4ebf7fbf2c0000,0x3edbbe95bf5cbf7bbf183dc93f3e3f80,0x3f183dc9bedbbf55bf80bf62bf040000,0xbf4ebf7fbf67bf0ebd493ef13f5c3f80,0xbf2cbf62bf7dbf7bbf5cbf22beac0000,0xbf3ebef1be163e483f043f463f713f80,0xbf5cbf46bf2cbf0ebedbbe95be160000,0x3f043f223f3e3f553f673f753f7d3f80
.octa 0xbf2c3f22bf183f0ebf043ef1bedb3ec4,0xbf3e3f46bf4e3f55bf5c3f62bf673f6d,0x3f04be953d493e48bedb3f22bf4e3f6d,0x3f5cbf753f80bf7b3f67bf463f18bec4,0xbeacbdc93f04bf553f7dbf753f3ebec4,0xbf713f7fbf5c3f0ebe16be953f2cbf6d,0x3e163ef1bf673f7bbf2c3dc93f04bf6d,0x3f7dbf623edb3e48bf3e3f7fbf5c3ec4
.octa 0x3d49bf463f7dbf0ebe793f62bf713ec4,0xbf803f223e16bf553f78bef1beac3f6d,0xbe793f75bf3ebe483f71bf46be163f6d,0x3f78be95bf2c3f7bbeacbf223f7dbec4,0x3edbbf7f3e793f55bf4ebe953f80bec4,0xbf67bdc93f78bf0ebf183f75bd49bf6d,0xbf183f623eacbf7bbd493f7fbe79bf6d,0x3f4e3ef1bf71be483f80bdc9bf783ec4
.octa 0x3f3ebf22bf4e3f0e3f5cbef1bf673ec4,0xbf2cbf463f183f55bf04bf623edb3f6d,0xbf5c3e953f803e48bf67bf223f183f6d,0x3f043f75bd49bf7bbedb3f463f4ebec4,0x3f713dc9bf5cbf553e163f753f2cbec4,0xbeacbf7fbf043f0e3f7d3e95bf3ebf6d,0xbf7dbef13edb3f7b3f3ebdc9bf5cbf6d,0x3e163f623f673e48bf2cbf7fbf043ec4
.octa 0x3f803f463e16bf0ebf78bf62beac3ec4,0x3d49bf22bf7dbf55be793ef13f713f6d,0xbf78bf75bf2cbe483eac3f463f7d3f6d,0xbe793e953f3e3f7b3f713f223e16bec4,0x3f673f7f3f783f553f183e95bd49bec4,0x3edb3dc9be79bf0ebf4ebf75bf80bf6d,0xbf4ebf62bf71bf7bbf80bf7fbf78bf6d,0xbf18bef1beacbe48bd493dc93e793ec4
.octa 0xbf673f62bf5c3f55bf4e3f46bf3e3f35,0xbedb3ef1bf043f0ebf183f22bf2c3f35,0x3f18bf463f67bf7b3f80bf753f5cbf35,0xbf4e3f22bedb3e483d49be953f04bf35,0x3f2cbe95be163f0ebf5c3f7fbf713f35,0x3f3ebf753f7dbf553f04bdc9beac3f35,0xbf5c3f7fbf3e3e483edbbf623f7dbf35,0x3f043dc9bf2c3f7bbf673ef13e16bf35
.octa 0xbeacbef13f78bf553e163f22bf803f35,0xbf713f62be79bf0e3f7dbf463d493f35,0x3f7dbf22beac3f7bbf2cbe953f78bf35,0xbe16bf463f71be48bf3e3f75be79bf35,0xbd493f75bf18bf0e3f78bdc9bf673f35,0x3f80be95bf4e3f553e79bf7f3edb3f35,0xbf78bdc93f80be48bf713ef13f4ebf35,0xbe793f7fbd49bf7b3eac3f62bf18bf35
.octa 0x3edbbf62bf043f553f18bf46bf2c3f35,0xbf67bef13f5c3f0ebf4ebf223f3e3f35,0x3f4e3f46bedbbf7bbd493f753f04bf35,0x3f18bf22bf673e483f803e95bf5cbf35,0xbf3e3e953f7d3f0ebf04bf7fbeac3f35,0x3f2c3f753e16bf55bf5c3dc93f713f35,0xbf04bf7fbf2c3e483f673f623e16bf35,0xbf5cbdc93f3e3f7b3edbbef1bf7dbf35
.octa 0x3f713ef1be79bf55bf7dbf223d493f35,0xbeacbf62bf78bf0e3e163f463f803f35,0x3e163f223f713f7b3f3e3e95be79bf35,0x3f7d3f463eacbe48bf2cbf75bf78bf35,0xbf80bf75bf4ebf0ebe793dc93edb3f35,0xbd493e953f183f553f783f7f3f673f35,0x3e793dc9bd49be48beacbef1bf18bf35,0xbf78bf7fbf80bf7bbf71bf62bf4ebf35
.octa 0xbf803f7fbf7d3f7bbf783f75bf713f6d,0xbd493dc9be163e48be793e95beac3ec4,0xbf783f62bf3e3f0ebeac3dc93e16bec4,0xbe793ef1bf2c3f55bf713f7fbf7d3f6d,0xbf673f22be79be483f18bf623f80bf6d,0xbedb3f46bf783f7bbf4e3ef1bd49bec4,0xbf4e3e953eacbf553f80bf463e793ec4,0xbf183f75bf713f0e3d49bf223f78bf6d
.octa 0xbf2cbdc93f4ebf7b3f043e95bf673f6d,0xbf3e3f7fbf18be483f5cbf753edb3ec4,0xbf04bef13f80bf0ebedb3f7fbf18bec4,0xbf5c3f62bd49bf553f67bdc9bf4e3f6d,0xbeacbf463f5c3e48bf7d3ef13f2cbf6d,0xbf713f223f04bf7b3e163f62bf3ebec4,0xbe16bf753edb3f55bf2cbf223f5c3ec4,0xbf7d3e953f67bf0ebf3e3f463f04bf6d
.octa 0x3d49bf7fbe163f7b3e79bf75beac3f6d,0xbf80bdc93f7d3e48bf78be953f713ec4,0x3e79bf62bf2c3f0e3f71bdc9bf7dbec4,0xbf78bef13f3e3f55beacbf7fbe163f6d,0x3edbbf22bf78be483f4e3f62bd49bf6d,0xbf67bf463e793f7b3f18bef1bf80bec4,0x3f18be95bf71bf55bd493f463f783ec4,0xbf4ebf75beac3f0e3f803f22be79bf6d
.octa 0x3f3e3dc9bf18bf7bbf5cbe953edb3f6d,0xbf2cbf7fbf4ebe483f043f753f673ec4,0x3f5c3ef1bd49bf0ebf67bf7fbf4ebec4,0xbf04bf62bf80bf55bedb3dc93f183f6d,0x3f713f463f043e48be16bef1bf3ebf6d,0xbeacbf22bf5cbf7bbf7dbf62bf2cbec4,0x3f7d3f753f673f553f3e3f223f043ec4,0xbe16be95bedbbf0ebf2cbf46bf5cbf6d
.octa 0x3f6f3f743f773f7a3f7d3f7f3f803f80,0xbeb7be9ebe84be54be20bdd5bd568000,0xbe2c3da33ea53f0c3f3c3f613f783f80,0xbf7cbf7fbf72bf57bf2ebef4be7c8000,0xbf80bf64bf1cbe543e703f213f673f80,0xbce2bee9bf4bbf7abf79bf47bedc8000,0xbe63bf43bf7fbf57beb13e923f4d3f80,0x3f7a3f263d84bf0cbf70bf75bf198000
.octa 0x3f6a3e9ebf00bf7abf4fbdd53f2b3f80,0x3ed13f743f5e3e54bf17bf7fbf3e8000,0x3f143f7f3ee2bf0cbf80bef43f033f80,0xbf513da33f663f57bd23bf61bf5c8000,0xbf303ee93f7e3e54bf5abf473eab3f80,0xbf3abf643e073f7a3f06bf21bf718000,0xbf59bf263f293f57bed7bf753e133f80,0x3f08bf43bf403f0c3f68be92bf7d8000
.octa 0x3eb7bf74be843f7a3e20bf7fbd563f80,0x3f6f3e9ebf77be543f7d3dd5bf808000,0x3f7cbda3bf723f0c3f2ebf61be7c3f80,0xbe2c3f7fbea5bf573f3c3ef4bf788000,0x3ce23f64bf4bbe543f79bf21bedc3f80,0xbf803ee93f1cbf7a3e703f47bf678000,0xbf7a3f433d84bf573f70be92bf193f80,0xbe63bf263f7fbf0cbeb13f75bf4d8000
.octa 0xbed1be9e3f5ebf7a3f173dd5bf3e3f80,0x3f6abf743f003e54bf4f3f7fbf2b8000,0x3f51bf7f3f66bf0c3d233ef4bf5c3f80,0x3f14bda3bee23f57bf803f61bf038000,0x3f3abee93e073e54bf063f47bf713f80,0xbf303f64bf7e3f7abf5a3f21beab8000,0xbf083f26bf403f57bf683f75bf7d3f80,0xbf593f43bf293f0cbed73e92be138000
.octa 0x3f363f3f3f473f4f3f573f5e3f643f6a,0xbf34bf2bbf21bf16bf0bbeffbee8becf,0xbf55bf72bf7fbf7dbf6bbf4bbf1ebecf,0x3f0e3eaa3db6be23becbbf1cbf49bf6a,0x3f6d3f803f613f163e38be86bf27bf6a,0xbec23d623ef63f4f3f7c3f773f423ecf,0xbf7bbf67beed3e233f383f7e3f5f3ecf,0x3e45bedebf63bf7dbf32be043efb3f6a
.octa 0x3f803f2bbddbbf4fbf7abeff3e9f3f6a,0x3b493f3f3f7f3f16be57bf5ebf73becf,0xbf7bbeaa3f243f7d3ebdbf1cbf7ebecf,0xbe4bbf72bf443e233f6e3f4bbdf4bf6a,0x3f6cbd62bf76bf163f113f773d9dbf6a,0x3ec53f803e90bf4fbf533e863f7f3ecf,0xbf543ede3f74be23bf80be043f773ecf,0xbf0fbf673e993f7dbc7bbf7ebe8a3f6a
.octa 0x3f34bf3fbf213f4f3f0bbf5ebee83f6a,0x3f363f2bbf47bf163f573effbf64becf,0xbf0e3f723db6bf7d3ecb3f4bbf49becf,0xbf55beaa3f7fbe23bf6b3f1c3f1ebf6a,0x3ec2bf803ef63f16bf7c3e863f42bf6a,0x3f6dbd62bf613f4f3e38bf773f273ecf,0xbe453f67bf633e233f32bf7e3efb3ecf,0xbf7b3ede3eedbf7d3f383e04bf5f3f6a
.octa 0xbb49bf2b3f7fbf4f3e573effbf733f6a,0x3f80bf3f3ddb3f16bf7a3f5ebe9fbecf,0x3e4b3eaabf443f7dbf6e3f1cbdf4becf,0xbf7b3f72bf243e233ebdbf4b3f7ebf6a,0xbec53d623e90bf163f53bf773f7fbf6a,0x3f6cbf803f76bf4f3f11be86bd9d3ecf,0x3f0fbede3e99be233c7b3e04be8a3ecf,0xbf543f67bf743f7dbf803f7ebf773f6a
.octa 0x3eba3ed23eea3f013f0c3f173f223f2c,0xbf6fbf69bf64bf5dbf56bf4fbf46bf3e,0x3f583f2f3ef83e823c17be73bef0bf2c,0x3f0a3f3a3f603f783f803f793f623f3e,0xbf31bf6fbf7fbf5dbf10be1c3e933f2c,0x3f393eb5bda9bf01bf54bf7dbf75bf3e,0xbf133cfb3f1f3f783f6d3f05bdc2bf2c,0xbf52bf80bf48be823ec03f5b3f7f3f3e
.octa 0x3f6a3f693e9cbf01bf7bbf4fbdcf3f2c,0xbece3ed23f743f5d3e51bf17bf7fbf3e,0x3e5dbf3abf76be823f333f793e96bf2c,0x3f7a3f2fbe8dbf78bf373e733f753f3e,0xbf80beb53f433f5dbe3fbf7dbef33f2c,0x3cb0bf6fbf253f013f7c3e1cbf61bf3e,0x3e323f803de8bf78bec83f5b3f23bf2c,0xbf7c3cfb3f7e3e82bf6cbf053f453f3e
.octa 0x3f6fbed2bf643f013f56bf17bf463f2c,0x3eba3f69beeabf5d3f0c3f4fbf22bf3e,0xbf0abf2f3f603e82bf803e733f62bf2c,0x3f58bf3abef83f783c17bf793ef03f3e,0xbf393f6fbda9bf5d3f543e1cbf753f2c,0xbf31beb53f7fbf01bf103f7dbe93bf3e,0x3f52bcfbbf483f78bec0bf053f7fbf2c,0xbf133f80bf1fbe823f6dbf5b3dc23f3e
.octa 0x3ecebf693f74bf01be513f4fbf7f3f2c,0x3f6abed2be9c3f5dbf7b3f173dcfbf3e,0xbf7a3f3abe8dbe823f37bf793f75bf2c,0x3e5dbf2f3f76bf783f33be73be963f3e,0xbcb03eb5bf253f5dbf7c3f7dbf613f2c,0xbf803f6fbf433f01be3fbe1c3ef3bf3e,0x3f7cbf803f7ebf783f6cbf5b3f45bf2c,0x3e32bcfbbde83e82bec83f05bf233f3e
.octa 0xbd3c3bc93d6f3de23e263e5a3e873ea1,0xbf80bf80bf80bf7ebf7dbf7abf77bf73,0x3e193ec73f1a3f483f693f7c3f7f3f73,0xbf7dbf6cbf4cbf20bed4be353d903ea1,0x3eae3f363f723f7e3f5a3f0a3e00bea1,0xbf71bf34bea83de23f073f573f7e3f73,0x3f043f6d3f783f203d0abf12bf73bf73,0xbf5bbec13e813f483f803f523ea2bea1
.octa 0x3f2d3f803f2abde2bf50bf7abefe3ea1,0xbf3d3bc93f3f3f7e3f15be5abf5ebf73,0x3f4e3f6c3e0dbf48bf70be353f413f73,0xbf183ec73f7e3f20beb4bf7cbf283ea1,0x3f683f34bedfbf7ebe6a3f573f4abea1,0xbed93f363f66bde2bf79bf0a3f1d3f73,0x3f793ec1bf5dbf203f2f3f52bee5bf73,0xbe763f6d3f02bf48bf3b3f123f65bea1
.octa 0x3f80bbc9bf803de23f7dbe5abf773ea1,0xbd3c3f80bd6fbf7e3e263f7abe87bf73,0x3f7dbec7bf4c3f483ed4bf7c3d903f73,0x3e193f6cbf1abf203f693e35bf7f3ea1,0x3f71bf36bea83f7ebf07bf0a3f7ebea1,0x3eae3f34bf723de23f5abf57be003f73,0x3f5bbf6d3e813f20bf803f123ea2bf73,0x3f043ec1bf783f483d0abf523f73bea1
.octa 0x3f3dbf803f3fbde2bf153f7abf5e3ea1,0x3f2dbbc9bf2a3f7ebf503e5a3efebf73,0x3f18bf6c3f7ebf483eb43e35bf283f73,0x3f4ebec7be0d3f20bf703f7cbf413ea1,0x3ed9bf343f66bf7e3f79bf573f1dbea1,0x3f68bf363edfbde2be6a3f0abf4a3f73,0x3e76bec13f02bf203f3bbf523f65bf73,0x3f79bf6d3f5dbf483f2fbf123ee5bea1
.octa 0x3eb73e9e3e843e543e203dd53d560000,0x3f6f3f743f773f7a3f7d3f7f3f803f80,0x3f7c3f7f3f723f573f2e3ef43e7c0000,0xbe2c3da33ea53f0c3f3c3f613f783f80,0x3ce23ee93f4b3f7a3f793f473edc0000,0xbf80bf64bf1cbe543e703f213f673f80,0xbf7abf26bd843f0c3f703f753f190000,0xbe63bf43bf7fbf57beb13e923f4d3f80
.octa 0xbed1bf74bf5ebe543f173f7f3f3e0000,0x3f6a3e9ebf00bf7abf4fbdd53f2b3f80,0x3f51bda3bf66bf573d233f613f5c0000,0x3f143f7f3ee2bf0cbf80bef43f033f80,0x3f3a3f64be07bf7abf063f213f710000,0xbf303ee93f7e3e54bf5abf473eab3f80,0xbf083f433f40bf0cbf683e923f7d0000,0xbf59bf263f293f57bed7bf753e133f80
.octa 0xbf6fbe9e3f773e54bf7dbdd53f800000,0x3eb7bf74be843f7a3e20bf7fbd563f80,0x3e2cbf7f3ea53f57bf3cbef43f780000,0x3f7cbda3bf723f0c3f2ebf61be7c3f80,0x3f80bee9bf1c3f7abe70bf473f670000,0x3ce23f64bf4bbe543f79bf21bedc3f80,0x3e633f26bf7f3f0c3eb1bf753f4d0000,0xbf7a3f433d84bf573f70be92bf193f80
.octa 0xbf6a3f74bf00be543f4fbf7f3f2b0000,0xbed1be9e3f5ebf7a3f173dd5bf3e3f80,0xbf143da33ee2bf573f80bf613f030000,0x3f51bf7f3f66bf0c3d233ef4bf5c3f80,0x3f30bf643f7ebf7a3f5abf213eab0000,0x3f3abee93e073e54bf063f47bf713f80,0x3f59bf433f29bf0c3ed7be923e130000,0xbf083f26bf403f57bf683f75bf7d3f80
.octa 0x3f343f2b3f213f163f0b3eff3ee83ecf,0x3f363f3f3f473f4f3f573f5e3f643f6a,0xbf0ebeaabdb63e233ecb3f1c3f493f6a,0xbf55bf72bf7fbf7dbf6bbf4bbf1ebecf,0x3ec2bd62bef6bf4fbf7cbf77bf42becf,0x3f6d3f803f613f163e38be86bf27bf6a,0xbe453ede3f633f7d3f323e04befbbf6a,0xbf7bbf67beed3e233f383f7e3f5f3ecf
.octa 0xbb49bf3fbf7fbf163e573f5e3f733ecf,0x3f803f2bbddbbf4fbf7abeff3e9f3f6a,0x3e4b3f723f44be23bf6ebf4b3df43f6a,0xbf7bbeaa3f243f7d3ebdbf1cbf7ebecf,0xbec5bf80be903f4f3f53be86bf7fbecf,0x3f6cbd62bf76bf163f113f773d9dbf6a,0x3f0f3f67be99bf7d3c7b3f7e3e8abf6a,0xbf543ede3f74be23bf80be043f773ecf
.octa 0xbf36bf2b3f473f16bf57beff3f643ecf,0x3f34bf3fbf213f4f3f0bbf5ebee83f6a,0x3f553eaabf7f3e233f6bbf1cbf1e3f6a,0xbf0e3f723db6bf7d3ecb3f4bbf49becf,0xbf6d3d623f61bf4fbe383f77bf27becf,0x3ec2bf803ef63f16bf7c3e863f42bf6a,0x3f7bbedebeed3f7dbf38be043f5fbf6a,0xbe453f67bf633e233f32bf7e3efb3ecf
.octa 0xbf803f3fbddbbf163f7abf5e3e9f3ecf,0xbb49bf2b3f7fbf4f3e573effbf733f6a,0x3f7bbf723f24be23bebd3f4bbf7e3f6a,0x3e4b3eaabf443f7dbf6e3f1cbdf4becf,0xbf6c3f80bf763f4fbf113e863d9dbecf,0xbec53d623e90bf163f53bf773f7fbf6a,0x3f54bf673f74bf7d3f80bf7e3f77bf6a,0x3f0fbede3e99be233c7b3e04be8a3ecf
.octa 0x3f6f3f693f643f5d3f563f4f3f463f3e,0x3eba3ed23eea3f013f0c3f173f223f2c,0xbf0abf3abf60bf78bf80bf79bf62bf3e,0x3f583f2f3ef83e823c17be73bef0bf2c,0xbf39beb53da93f013f543f7d3f753f3e,0xbf31bf6fbf7fbf5dbf10be1c3e933f2c,0x3f523f803f483e82bec0bf5bbf7fbf3e,0xbf133cfb3f1f3f783f6d3f05bdc2bf2c
.octa 0x3ecebed2bf74bf5dbe513f173f7f3f3e,0x3f6a3f693e9cbf01bf7bbf4fbdcf3f2c,0xbf7abf2f3e8d3f783f37be73bf75bf3e,0x3e5dbf3abf76be823f333f793e96bf2c,0xbcb03f6f3f25bf01bf7cbe1c3f613f3e,0xbf80beb53f433f5dbe3fbf7dbef33f2c,0x3f7cbcfbbf7ebe823f6c3f05bf45bf3e,0x3e323f803de8bf78bec83f5b3f23bf2c
.octa 0xbebabf693eea3f5dbf0cbf4f3f223f3e,0x3f6fbed2bf643f013f56bf17bf463f2c,0xbf583f3a3ef8bf78bc173f79bef0bf3e,0xbf0abf2f3f603e82bf803e733f62bf2c,0x3f313eb5bf7f3f013f10bf7d3e933f3e,0xbf393f6fbda9bf5d3f543e1cbf753f2c,0x3f13bf803f1f3e82bf6d3f5bbdc2bf3e,0x3f52bcfbbf483f78bec0bf053f7fbf2c
.octa 0xbf6a3ed23e9cbf5d3f7bbf17bdcf3f3e,0x3ecebf693f74bf01be513f4fbf7f3f2c,0xbe5d3f2fbf763f78bf333e733e96bf3e,0xbf7a3f3abe8dbe823f37bf793f75bf2c,0x3f80bf6f3f43bf013e3f3e1cbef33f3e,0xbcb03eb5bf253f5dbf7c3f7dbf613f2c,0xbe323cfb3de8be823ec8bf053f23bf3e,0x3f7cbf803f7ebf783f6cbf5b3f45bf2c
.octa 0x3f803f803f803f7e3f7d3f7a3f773f73,0xbd3c3bc93d6f3de23e263e5a3e873ea1,0x3f7d3f6c3f4c3f203ed43e35bd90bea1,0x3e193ec73f1a3f483f693f7c3f7f3f73,0x3f713f343ea8bde2bf07bf57bf7ebf73,0x3eae3f363f723f7e3f5a3f0a3e00bea1,0x3f5b3ec1be81bf48bf80bf52bea23ea1,0x3f043f6d3f783f203d0abf12bf73bf73
.octa 0x3f3dbbc9bf3fbf7ebf153e5a3f5e3f73,0x3f2d3f803f2abde2bf50bf7abefe3ea1,0x3f18bec7bf7ebf203eb43f7c3f28bea1,0x3f4e3f6c3e0dbf48bf70be353f413f73,0x3ed9bf36bf663de23f793f0abf1dbf73,0x3f683f34bedfbf7ebe6a3f573f4abea1,0x3e76bf6dbf023f483f3bbf12bf653ea1,0x3f793ec1bf5dbf203f2f3f52bee5bf73
.octa 0x3d3cbf803d6f3f7ebe26bf7a3e873f73,0x3f80bbc9bf803de23f7dbe5abf773ea1,0xbe19bf6c3f1a3f20bf69be353f7fbea1,0x3f7dbec7bf4c3f483ed4bf7c3d903f73,0xbeaebf343f72bde2bf5a3f573e00bf73,0x3f71bf36bea83f7ebf07bf0a3f7ebea1,0xbf04bec13f78bf48bd0a3f52bf733ea1,0x3f5bbf6d3e813f20bf803f123ea2bf73
.octa 0xbf2d3bc93f2abf7e3f50be5abefe3f73,0x3f3dbf803f3fbde2bf153f7abf5e3ea1,0xbf4e3ec73e0dbf203f70bf7c3f41bea1,0x3f18bf6c3f7ebf483eb43e35bf283f73,0xbf683f36bedf3de23e6abf0a3f4abf73,0x3ed9bf343f66bf7e3f79bf573f1dbea1,0xbf793f6dbf5d3f48bf2f3f12bee53ea1,0x3e76bec13f02bf203f3bbf523f65bf73
.octa 0xbf6f3f74bf773f7abf7d3f7fbf803f80,0x3eb7be9e3e84be543e20bdd53d568000,0x3e2c3da3bea53f0cbf3c3f61bf783f80,0x3f7cbf7f3f72bf573f2ebef43e7c8000,0x3f80bf643f1cbe54be703f21bf673f80,0x3ce2bee93f4bbf7a3f79bf473edc8000,0x3e63bf433f7fbf573eb13e92bf4d3f80,0xbf7a3f26bd84bf0c3f70bf753f198000
.octa 0xbf6a3e9e3f00bf7a3f4fbdd5bf2b3f80,0xbed13f74bf5e3e543f17bf7f3f3e8000,0xbf143f7fbee2bf0c3f80bef4bf033f80,0x3f513da3bf663f573d23bf613f5c8000,0x3f303ee9bf7e3e543f5abf47beab3f80,0x3f3abf64be073f7abf06bf213f718000,0x3f59bf26bf293f573ed7bf75be133f80,0xbf08bf433f403f0cbf68be923f7d8000
.octa 0xbeb7bf743e843f7abe20bf7f3d563f80,0xbf6f3e9e3f77be54bf7d3dd53f808000,0xbf7cbda33f723f0cbf2ebf613e7c3f80,0x3e2c3f7f3ea5bf57bf3c3ef43f788000,0xbce23f643f4bbe54bf79bf213edc3f80,0x3f803ee9bf1cbf7abe703f473f678000,0x3f7a3f43bd84bf57bf70be923f193f80,0x3e63bf26bf7fbf0c3eb13f753f4d8000
.octa 0x3ed1be9ebf5ebf7abf173dd53f3e3f80,0xbf6abf74bf003e543f4f3f7f3f2b8000,0xbf51bf7fbf66bf0cbd233ef43f5c3f80,0xbf14bda33ee23f573f803f613f038000,0xbf3abee9be073e543f063f473f713f80,0x3f303f643f7e3f7a3f5a3f213eab8000,0x3f083f263f403f573f683f753f7d3f80,0x3f593f433f293f0c3ed73e923e138000
.octa 0xbf363f3fbf473f4fbf573f5ebf643f6a,0x3f34bf2b3f21bf163f0bbeff3ee8becf,0x3f55bf723f7fbf7d3f6bbf4b3f1ebecf,0xbf0e3eaabdb6be233ecbbf1c3f49bf6a,0xbf6d3f80bf613f16be38be863f27bf6a,0x3ec23d62bef63f4fbf7c3f77bf423ecf,0x3f7bbf673eed3e23bf383f7ebf5f3ecf,0xbe45bede3f63bf7d3f32be04befb3f6a
.octa 0xbf803f2b3ddbbf4f3f7abeffbe9f3f6a,0xbb493f3fbf7f3f163e57bf5e3f73becf,0x3f7bbeaabf243f7dbebdbf1c3f7ebecf,0x3e4bbf723f443e23bf6e3f4b3df4bf6a,0xbf6cbd623f76bf16bf113f77bd9dbf6a,0xbec53f80be90bf4f3f533e86bf7f3ecf,0x3f543edebf74be233f80be04bf773ecf,0x3f0fbf67be993f7d3c7bbf7e3e8a3f6a
.octa 0xbf34bf3f3f213f4fbf0bbf5e3ee83f6a,0xbf363f2b3f47bf16bf573eff3f64becf,0x3f0e3f72bdb6bf7dbecb3f4b3f49becf,0x3f55beaabf7fbe233f6b3f1cbf1ebf6a,0xbec2bf80bef63f163f7c3e86bf42bf6a,0xbf6dbd623f613f4fbe38bf77bf273ecf,0x3e453f673f633e23bf32bf7ebefb3ecf,0x3f7b3edebeedbf7dbf383e043f5f3f6a
.octa 0x3b49bf2bbf7fbf4fbe573eff3f733f6a,0xbf80bf3fbddb3f163f7a3f5e3e9fbecf,0xbe4b3eaa3f443f7d3f6e3f1c3df4becf,0x3f7b3f723f243e23bebdbf4bbf7ebf6a,0x3ec53d62be90bf16bf53bf77bf7fbf6a,0xbf6cbf80bf76bf4fbf11be863d9d3ecf,0xbf0fbedebe99be23bc7b3e043e8a3ecf,0x3f543f673f743f7d3f803f7e3f773f6a
.octa 0xbeba3ed2beea3f01bf0c3f17bf223f2c,0x3f6fbf693f64bf5d3f56bf4f3f46bf3e,0xbf583f2fbef83e82bc17be733ef0bf2c,0xbf0a3f3abf603f78bf803f79bf623f3e,0x3f31bf6f3f7fbf5d3f10be1cbe933f2c,0xbf393eb53da9bf013f54bf7d3f75bf3e,0x3f133cfbbf1f3f78bf6d3f053dc2bf2c,0x3f52bf803f48be82bec03f5bbf7f3f3e
.octa 0xbf6a3f69be9cbf013f7bbf4f3dcf3f2c,0x3ece3ed2bf743f5dbe51bf173f7fbf3e,0xbe5dbf3a3f76be82bf333f79be96bf2c,0xbf7a3f2f3e8dbf783f373e73bf753f3e,0x3f80beb5bf433f5d3e3fbf7d3ef33f2c,0xbcb0bf6f3f253f01bf7c3e1c3f61bf3e,0xbe323f80bde8bf783ec83f5bbf23bf2c,0x3f7c3cfbbf7e3e823f6cbf05bf453f3e
.octa 0xbf6fbed23f643f01bf56bf173f463f2c,0xbeba3f693eeabf5dbf0c3f4f3f22bf3e,0x3f0abf2fbf603e823f803e73bf62bf2c,0xbf58bf3a3ef83f78bc17bf79bef03f3e,0x3f393f6f3da9bf5dbf543e1c3f753f2c,0x3f31beb5bf7fbf013f103f7d3e93bf3e,0xbf52bcfb3f483f783ec0bf05bf7fbf2c,0x3f133f803f1fbe82bf6dbf5bbdc23f3e
.octa 0xbecebf69bf74bf013e513f4f3f7f3f2c,0xbf6abed23e9c3f5d3f7b3f17bdcfbf3e,0x3f7a3f3a3e8dbe82bf37bf79bf75bf2c,0xbe5dbf2fbf76bf78bf33be733e963f3e,0x3cb03eb53f253f5d3f7c3f7d3f613f2c,0x3f803f6f3f433f013e3fbe1cbef3bf3e,0xbf7cbf80bf7ebf78bf6cbf5bbf45bf2c,0xbe32bcfb3de83e823ec83f053f233f3e
.octa 0x3d3c3bc9bd6f3de2be263e5abe873ea1,0x3f80bf803f80bf7e3f7dbf7a3f77bf73,0xbe193ec7bf1a3f48bf693f7cbf7f3f73,0x3f7dbf6c3f4cbf203ed4be35bd903ea1,0xbeae3f36bf723f7ebf5a3f0abe00bea1,0x3f71bf343ea83de2bf073f57bf7e3f73,0xbf043f6dbf783f20bd0abf123f73bf73,0x3f5bbec1be813f48bf803f52bea2bea1
.octa 0xbf2d3f80bf2abde23f50bf7a3efe3ea1,0x3f3d3bc9bf3f3f7ebf15be5a3f5ebf73,0xbf4e3f6cbe0dbf483f70be35bf413f73,0x3f183ec7bf7e3f203eb4bf7c3f283ea1,0xbf683f343edfbf7e3e6a3f57bf4abea1,0x3ed93f36bf66bde23f79bf0abf1d3f73,0xbf793ec13f5dbf20bf2f3f523ee5bf73,0x3e763f6dbf02bf483f3b3f12bf65bea1
.octa 0xbf80bbc93f803de2bf7dbe5a3f773ea1,0x3d3c3f803d6fbf7ebe263f7a3e87bf73,0xbf7dbec73f4c3f48bed4bf7cbd903f73,0xbe193f6c3f1abf20bf693e353f7f3ea1,0xbf71bf363ea83f7e3f07bf0abf7ebea1,0xbeae3f343f723de2bf5abf573e003f73,0xbf5bbf6dbe813f203f803f12bea2bf73,0xbf043ec13f783f48bd0abf52bf73bea1
.octa 0xbf3dbf80bf3fbde23f153f7a3f5e3ea1,0xbf2dbbc93f2a3f7e3f503e5abefebf73,0xbf18bf6cbf7ebf48beb43e353f283f73,0xbf4ebec73e0d3f203f703f7c3f413ea1,0xbed9bf34bf66bf7ebf79bf57bf1dbea1,0xbf68bf36bedfbde23e6a3f0a3f4a3f73,0xbe76bec1bf02bf20bf3bbf52bf65bf73,0xbf79bf6dbf5dbf48bf2fbf12bee5bea1
.octa 0xbeb73e9ebe843e54be203dd5bd560000,0xbf6f3f74bf773f7abf7d3f7fbf803f80,0xbf7c3f7fbf723f57bf2e3ef4be7c0000,0x3e2c3da3bea53f0cbf3c3f61bf783f80,0xbce23ee9bf4b3f7abf793f47bedc0000,0x3f80bf643f1cbe54be703f21bf673f80,0x3f7abf263d843f0cbf703f75bf190000,0x3e63bf433f7fbf573eb13e92bf4d3f80
.octa 0x3ed1bf743f5ebe54bf173f7fbf3e0000,0xbf6a3e9e3f00bf7a3f4fbdd5bf2b3f80,0xbf51bda33f66bf57bd233f61bf5c0000,0xbf143f7fbee2bf0c3f80bef4bf033f80,0xbf3a3f643e07bf7a3f063f21bf710000,0x3f303ee9bf7e3e543f5abf47beab3f80,0x3f083f43bf40bf0c3f683e92bf7d0000,0x3f59bf26bf293f573ed7bf75be133f80
.octa 0x3f6fbe9ebf773e543f7dbdd5bf800000,0xbeb7bf743e843f7abe20bf7f3d563f80,0xbe2cbf7fbea53f573f3cbef4bf780000,0xbf7cbda33f723f0cbf2ebf613e7c3f80,0xbf80bee93f1c3f7a3e70bf47bf670000,0xbce23f643f4bbe54bf79bf213edc3f80,0xbe633f263f7f3f0cbeb1bf75bf4d0000,0x3f7a3f43bd84bf57bf70be923f193f80
.octa 0x3f6a3f743f00be54bf4fbf7fbf2b0000,0x3ed1be9ebf5ebf7abf173dd53f3e3f80,0x3f143da3bee2bf57bf80bf61bf030000,0xbf51bf7fbf66bf0cbd233ef43f5c3f80,0xbf30bf64bf7ebf7abf5abf21beab0000,0xbf3abee9be073e543f063f473f713f80,0xbf59bf43bf29bf0cbed7be92be130000,0x3f083f263f403f573f683f753f7d3f80
.octa 0xbf343f2bbf213f16bf0b3effbee83ecf,0xbf363f3fbf473f4fbf573f5ebf643f6a,0x3f0ebeaa3db63e23becb3f1cbf493f6a,0x3f55bf723f7fbf7d3f6bbf4b3f1ebecf,0xbec2bd623ef6bf4f3f7cbf773f42becf,0xbf6d3f80bf613f16be38be863f27bf6a,0x3e453edebf633f7dbf323e043efbbf6a,0x3f7bbf673eed3e23bf383f7ebf5f3ecf
.octa 0x3b49bf3f3f7fbf16be573f5ebf733ecf,0xbf803f2b3ddbbf4f3f7abeffbe9f3f6a,0xbe4b3f72bf44be233f6ebf4bbdf43f6a,0x3f7bbeaabf243f7dbebdbf1c3f7ebecf,0x3ec5bf803e903f4fbf53be863f7fbecf,0xbf6cbd623f76bf16bf113f77bd9dbf6a,0xbf0f3f673e99bf7dbc7b3f7ebe8abf6a,0x3f543edebf74be233f80be04bf773ecf
.octa 0x3f36bf2bbf473f163f57beffbf643ecf,0xbf34bf3f3f213f4fbf0bbf5e3ee83f6a,0xbf553eaa3f7f3e23bf6bbf1c3f1e3f6a,0x3f0e3f72bdb6bf7dbecb3f4b3f49becf,0x3f6d3d62bf61bf4f3e383f773f27becf,0xbec2bf80bef63f163f7c3e86bf42bf6a,0xbf7bbede3eed3f7d3f38be04bf5fbf6a,0x3e453f673f633e23bf32bf7ebefb3ecf
.octa 0x3f803f3f3ddbbf16bf7abf5ebe9f3ecf,0x3b49bf2bbf7fbf4fbe573eff3f733f6a,0xbf7bbf72bf24be233ebd3f4b3f7e3f6a,0xbe4b3eaa3f443f7d3f6e3f1c3df4becf,0x3f6c3f803f763f4f3f113e86bd9dbecf,0x3ec53d62be90bf16bf53bf77bf7fbf6a,0xbf54bf67bf74bf7dbf80bf7ebf77bf6a,0xbf0fbedebe99be23bc7b3e043e8a3ecf
.octa 0xbf6f3f69bf643f5dbf563f4fbf463f3e,0xbeba3ed2beea3f01bf0c3f17bf223f2c,0x3f0abf3a3f60bf783f80bf793f62bf3e,0xbf583f2fbef83e82bc17be733ef0bf2c,0x3f39beb5bda93f01bf543f7dbf753f3e,0x3f31bf6f3f7fbf5d3f10be1cbe933f2c,0xbf523f80bf483e823ec0bf5b3f7fbf3e,0x3f133cfbbf1f3f78bf6d3f053dc2bf2c
.octa 0xbecebed23f74bf5d3e513f17bf7f3f3e,0xbf6a3f69be9cbf013f7bbf4f3dcf3f2c,0x3f7abf2fbe8d3f78bf37be733f75bf3e,0xbe5dbf3a3f76be82bf333f79be96bf2c,0x3cb03f6fbf25bf013f7cbe1cbf613f3e,0x3f80beb5bf433f5d3e3fbf7d3ef33f2c,0xbf7cbcfb3f7ebe82bf6c3f053f45bf3e,0xbe323f80bde8bf783ec83f5bbf23bf2c
.octa 0x3ebabf69beea3f5d3f0cbf4fbf223f3e,0xbf6fbed23f643f01bf56bf173f463f2c,0x3f583f3abef8bf783c173f793ef0bf3e,0x3f0abf2fbf603e823f803e73bf62bf2c,0xbf313eb53f7f3f01bf10bf7dbe933f3e,0x3f393f6f3da9bf5dbf543e1c3f753f2c,0xbf13bf80bf1f3e823f6d3f5b3dc2bf3e,0xbf52bcfb3f483f783ec0bf05bf7fbf2c
.octa 0x3f6a3ed2be9cbf5dbf7bbf173dcf3f3e,0xbecebf69bf74bf013e513f4f3f7f3f2c,0x3e5d3f2f3f763f783f333e73be96bf3e,0x3f7a3f3a3e8dbe82bf37bf79bf75bf2c,0xbf80bf6fbf43bf01be3f3e1c3ef33f3e,0x3cb03eb53f253f5d3f7c3f7d3f613f2c,0x3e323cfbbde8be82bec8bf05bf23bf3e,0xbf7cbf80bf7ebf78bf6cbf5bbf45bf2c
.octa 0xbf803f80bf803f7ebf7d3f7abf773f73,0x3d3c3bc9bd6f3de2be263e5abe873ea1,0xbf7d3f6cbf4c3f20bed43e353d90bea1,0xbe193ec7bf1a3f48bf693f7cbf7f3f73,0xbf713f34bea8bde23f07bf573f7ebf73,0xbeae3f36bf723f7ebf5a3f0abe00bea1,0xbf5b3ec13e81bf483f80bf523ea23ea1,0xbf043f6dbf783f20bd0abf123f73bf73
.octa 0xbf3dbbc93f3fbf7e3f153e5abf5e3f73,0xbf2d3f80bf2abde23f50bf7a3efe3ea1,0xbf18bec73f7ebf20beb43f7cbf28bea1,0xbf4e3f6cbe0dbf483f70be35bf413f73,0xbed9bf363f663de2bf793f0a3f1dbf73,0xbf683f343edfbf7e3e6a3f57bf4abea1,0xbe76bf6d3f023f48bf3bbf123f653ea1,0xbf793ec13f5dbf20bf2f3f523ee5bf73
.octa 0xbd3cbf80bd6f3f7e3e26bf7abe873f73,0xbf80bbc93f803de2bf7dbe5a3f773ea1,0x3e19bf6cbf1a3f203f69be35bf7fbea1,0xbf7dbec73f4c3f48bed4bf7cbd903f73,0x3eaebf34bf72bde23f5a3f57be00bf73,0xbf71bf363ea83f7e3f07bf0abf7ebea1,0x3f04bec1bf78bf483d0a3f523f733ea1,0xbf5bbf6dbe813f203f803f12bea2bf73
.octa 0x3f2d3bc9bf2abf7ebf50be5a3efe3f73,0xbf3dbf80bf3fbde23f153f7a3f5e3ea1,0x3f4e3ec7be0dbf20bf70bf7cbf41bea1,0xbf18bf6cbf7ebf48beb43e353f283f73,0x3f683f363edf3de2be6abf0abf4abf73,0xbed9bf34bf66bf7ebf79bf57bf1dbea1,0x3f793f6d3f5d3f483f2f3f123ee53ea1,0xbe76bec1bf02bf20bf3bbf52bf65bf73
.octa 0x3f6d3f723f763f7a3f7c3f7e3f803f80,0xbec1bea7be8cbe60be29bde2bd628000,0xbe423d7b3e9e3f093f3a3f603f783f80,0xbf7bbf80bf74bf58bf2fbef7be7f8000,0xbf80bf66bf1fbe603e663f203f673f80,0xbbc9bee1bf49bf7abf79bf48bede8000,0xbe4ebf40bf7fbf58beb53e8f3f4d3f80,0x3f7b3f2a3da3bf09bf6fbf76bf1a8000
.octa 0x3f6c3ea7befabf7abf50bde23f2b3f80,0x3ec73f723f603e60bf15bf7ebf3f8000,0x3f103f803ee9bf09bf80bef73f023f80,0xbf543d7b3f643f58bcfbbf60bf5c8000,0xbf343ee13f7e3e60bf59bf483eaa3f80,0xbf36bf663dee3f7a3f08bf20bf728000,0xbf56bf2a3f263f58bed2bf763e103f80,0x3f0dbf40bf433f093f69be8fbf7d8000
.octa 0x3ec1bf72be8c3f7a3e29bf7ebd623f80,0x3f6d3ea7bf76be603f7c3de2bf808000,0x3f7bbd7bbf743f093f2fbf60be7f3f80,0xbe423f80be9ebf583f3a3ef7bf788000,0x3bc93f66bf49be603f79bf20bede3f80,0xbf803ee13f1fbf7a3e663f48bf678000,0xbf7b3f403da3bf583f6fbe8fbf1a3f80,0xbe4ebf2a3f7fbf09beb53f76bf4d8000
.octa 0xbec7bea73f60bf7a3f153de2bf3f3f80,0x3f6cbf723efa3e60bf503f7ebf2b8000,0x3f54bf803f64bf093cfb3ef7bf5c3f80,0x3f10bd7bbee93f58bf803f60bf028000,0x3f36bee13dee3e60bf083f48bf723f80,0xbf343f66bf7e3f7abf593f20beaa8000,0xbf0d3f2abf433f58bf693f76bf7d3f80,0xbf563f40bf263f09bed23e8fbe108000
.octa 0x3f2d3f373f413f4a3f523f5a3f613f67,0xbf3dbf33bf28bf1dbf12bf06bef4bedb,0xbf4fbf6ebf7ebf7ebf6ebf4fbf24bedb,0x3f173ebe3e04bdfbbebbbf16bf45bf67,0x3f683f803f653f1d3e5abe6dbf21bf67,0xbed83c493ee33f4a3f7a3f793f473edb,0xbf79bf6bbeff3dfb3f323f7d3f633edb,0x3e73becabf5ebf7ebf38be233eef3f67
.octa 0x3f803f33bd8abf4abf7cbf063e923f67,0xbd303f373f7f3f1dbe35bf5abf75bedb,0xbf7dbebe3f1c3f7e3ecdbf16bf7fbedb,0xbe1cbf6ebf4b3dfb3f6b3f4fbdbcbf67,0x3f71bc49bf73bf1d3f0a3f793dd5bf67,0x3eaf3f803ea4bf4abf573e6d3f7f3edb,0xbf5b3eca3f77bdfbbf80be233f753edb,0xbf05bf6b3e863f7e3c97bf7dbe983f67
.octa 0x3f3dbf37bf283f4a3f12bf5abef43f67,0x3f2d3f33bf41bf1d3f523f06bf61bedb,0xbf173f6e3e04bf7e3ebb3f4fbf45bedb,0xbf4fbebe3f7ebdfbbf6e3f163f24bf67,0x3ed8bf803ee33f1dbf7a3e6d3f47bf67,0x3f68bc49bf653f4a3e5abf793f213edb,0xbe733f6bbf5e3dfb3f38bf7d3eef3edb,0xbf793eca3effbf7e3f323e23bf633f67
.octa 0x3d30bf333f7fbf4a3e353f06bf753f67,0x3f80bf373d8a3f1dbf7c3f5abe92bedb,0x3e1c3ebebf4b3f7ebf6b3f16bdbcbedb,0xbf7d3f6ebf1c3dfb3ecdbf4f3f7fbf67,0xbeaf3c493ea4bf1d3f57bf793f7fbf67,0x3f71bf803f73bf4a3f0abe6dbdd53edb,0x3f05beca3e86bdfbbc973e23be983edb,0xbf5b3f6bbf773f7ebf803f7dbf753f67
.octa 0x3e983eb23ecd3ee63eff3f0c3f173f22,0xbf75bf70bf6bbf65bf5ebf57bf4fbf46,0x3f613f3c3f0a3ea13d8abe3bbed8bf22,0x3ef43f2e3f573f733f7f3f7c3f683f46,0xbf24bf69bf80bf65bf1cbe543e733f22,0x3f453ed5bc97bee6bf4bbf7abf79bf46,0xbf21bd173f123f733f733f11bd30bf22,0xbf47bf80bf52bea13ea43f533f803f46
.octa 0x3f633f703ebbbee6bf77bf57be1c3f22,0xbeef3eb23f6e3f653e86bf0cbf7dbf46,0x3e92bf2ebf7abea13f283f7c3eafbf22,0x3f753f3cbe5abf73bf413e3b3f713f46,0xbf7fbed53f383f65be04bf7abf053f22,0x3dbcbf69bf323ee63f7e3e54bf5bbf46,0x3dd53f803e35bf73bee33f533f2dbf22,0xbf7fbd173f7c3ea1bf65bf113f3d3f46
.octa 0x3f75beb2bf6b3ee63f5ebf0cbf4f3f22,0x3e983f70becdbf653eff3f57bf17bf46,0xbef4bf3c3f573ea1bf7f3e3b3f68bf22,0x3f61bf2ebf0a3f733d8abf7c3ed83f46,0xbf453f69bc97bf653f4b3e54bf793f22,0xbf24bed53f80bee6bf1c3f7abe73bf46,0x3f473d17bf523f73bea4bf113f80bf22,0xbf213f80bf12bea13f73bf533d303f46
.octa 0x3eefbf703f6ebee6be863f57bf7d3f22,0x3f63beb2bebb3f65bf773f0c3e1cbf46,0xbf753f2ebe5abea13f41bf7c3f71bf22,0x3e92bf3c3f7abf733f28be3bbeaf3f46,0xbdbc3ed5bf323f65bf7e3f7abf5b3f22,0xbf7f3f69bf383ee6be04be543f05bf46,0x3f7fbf803f7cbf733f65bf533f3dbf22,0x3dd53d17be353ea1bee33f11bf2d3f46
.octa 0xbe10bdb0bcfb3cc93da33e0a3e423e79,0xbf7dbf7fbf80bf80bf7fbf7ebf7bbf78,0x3d623e9b3f083f393f603f783f803f78,0xbf80bf74bf59bf31befabe82bbc93e79,0x3e7f3f253f693f803f643f1b3e4ebe79,0xbf78bf44bed23cc93ee93f4c3f7b3f78,0x3ede3f633f7c3f313deebf01bf6cbf78,0xbf67beec3e293f393f7e3f5d3ec7be79
.octa 0x3f1a3f7f3f3abcc9bf43bf7ebf103e79,0xbf4dbdb03f2f3f803f26be0abf54bf78,0x3f3f3f743e66bf39bf76be823f343f78,0xbf2b3e9b3f793f31be8cbf78bf363e79,0x3f5c3f44beb5bf80be9e3f4c3f56be79,0xbf023f253f6fbcc9bf74bf1b3f0d3f78,0x3f723eecbf50bf313f1f3f5dbec1bf78,0xbeaa3f633f15bf39bf493f013f6dbe79
.octa 0x3f7d3db0bf803cc93f7fbe0abf7b3e79,0xbe103f7f3cfbbf803da33f7ebe42bf78,0x3f80be9bbf593f393efabf78bbc93f78,0x3d623f74bf08bf313f603e82bf803e79,0x3f78bf25bed23f80bee9bf1b3f7bbe79,0x3e7f3f44bf693cc93f64bf4cbe4e3f78,0x3f67bf633e293f31bf7e3f013ec7bf78,0x3ede3eecbf7c3f393deebf5d3f6cbe79
.octa 0x3f4dbf7f3f2fbcc9bf263f7ebf543e79,0x3f1a3db0bf3a3f80bf433e0a3f10bf78,0x3f2bbf743f79bf393e8c3e82bf363f78,0x3f3fbe9bbe663f31bf763f78bf343e79,0x3f02bf443f6fbf803f74bf4c3f0dbe79,0x3f5cbf253eb5bcc9be9e3f1bbf563f78,0x3eaabeec3f15bf313f49bf5d3f6dbf78,0x3f72bf633f50bf393f1fbf013ec1be79
.octa 0x3ec13ea73e8c3e603e293de23d620000,0x3f6d3f723f763f7a3f7c3f7e3f803f80,0x3f7b3f803f743f583f2f3ef73e7f0000,0xbe423d7b3e9e3f093f3a3f603f783f80,0x3bc93ee13f493f7a3f793f483ede0000,0xbf80bf66bf1fbe603e663f203f673f80,0xbf7bbf2abda33f093f6f3f763f1a0000,0xbe4ebf40bf7fbf58beb53e8f3f4d3f80
.octa 0xbec7bf72bf60be603f153f7e3f3f0000,0x3f6c3ea7befabf7abf50bde23f2b3f80,0x3f54bd7bbf64bf583cfb3f603f5c0000,0x3f103f803ee9bf09bf80bef73f023f80,0x3f363f66bdeebf7abf083f203f720000,0xbf343ee13f7e3e60bf59bf483eaa3f80,0xbf0d3f403f43bf09bf693e8f3f7d0000,0xbf56bf2a3f263f58bed2bf763e103f80
.octa 0xbf6dbea73f763e60bf7cbde23f800000,0x3ec1bf72be8c3f7a3e29bf7ebd623f80,0x3e42bf803e9e3f58bf3abef73f780000,0x3f7bbd7bbf743f093f2fbf60be7f3f80,0x3f80bee1bf1f3f7abe66bf483f670000,0x3bc93f66bf49be603f79bf20bede3f80,0x3e4e3f2abf7f3f093eb5bf763f4d0000,0xbf7b3f403da3bf583f6fbe8fbf1a3f80
.octa 0xbf6c3f72befabe603f50bf7e3f2b0000,0xbec7bea73f60bf7a3f153de2bf3f3f80,0xbf103d7b3ee9bf583f80bf603f020000,0x3f54bf803f64bf093cfb3ef7bf5c3f80,0x3f34bf663f7ebf7a3f59bf203eaa0000,0x3f36bee13dee3e60bf083f48bf723f80,0x3f56bf403f26bf093ed2be8f3e100000,0xbf0d3f2abf433f58bf693f76bf7d3f80
.octa 0x3f3d3f333f283f1d3f123f063ef43edb,0x3f2d3f373f413f4a3f523f5a3f613f67,0xbf17bebebe043dfb3ebb3f163f453f67,0xbf4fbf6ebf7ebf7ebf6ebf4fbf24bedb,0x3ed8bc49bee3bf4abf7abf79bf47bedb,0x3f683f803f653f1d3e5abe6dbf21bf67,0xbe733eca3f5e3f7e3f383e23beefbf67,0xbf79bf6bbeff3dfb3f323f7d3f633edb
.octa 0x3d30bf37bf7fbf1d3e353f5a3f753edb,0x3f803f33bd8abf4abf7cbf063e923f67,0x3e1c3f6e3f4bbdfbbf6bbf4f3dbc3f67,0xbf7dbebe3f1c3f7e3ecdbf16bf7fbedb,0xbeafbf80bea43f4a3f57be6dbf7fbedb,0x3f71bc49bf73bf1d3f0a3f793dd5bf67,0x3f053f6bbe86bf7ebc973f7d3e98bf67,0xbf5b3eca3f77bdfbbf80be233f753edb
.octa 0xbf2dbf333f413f1dbf52bf063f613edb,0x3f3dbf37bf283f4a3f12bf5abef43f67,0x3f4f3ebebf7e3dfb3f6ebf16bf243f67,0xbf173f6e3e04bf7e3ebb3f4fbf45bedb,0xbf683c493f65bf4abe5a3f79bf21bedb,0x3ed8bf803ee33f1dbf7a3e6d3f47bf67,0x3f79becabeff3f7ebf32be233f63bf67,0xbe733f6bbf5e3dfb3f38bf7d3eef3edb
.octa 0xbf803f37bd8abf1d3f7cbf5a3e923edb,0x3d30bf333f7fbf4a3e353f06bf753f67,0x3f7dbf6e3f1cbdfbbecd3f4fbf7f3f67,0x3e1c3ebebf4b3f7ebf6b3f16bdbcbedb,0xbf713f80bf733f4abf0a3e6d3dd5bedb,0xbeaf3c493ea4bf1d3f57bf793f7fbf67,0x3f5bbf6b3f77bf7e3f80bf7d3f75bf67,0x3f05beca3e86bdfbbc973e23be983edb
.octa 0x3f753f703f6b3f653f5e3f573f4f3f46,0x3e983eb23ecd3ee63eff3f0c3f173f22,0xbef4bf2ebf57bf73bf7fbf7cbf68bf46,0x3f613f3c3f0a3ea13d8abe3bbed8bf22,0xbf45bed53c973ee63f4b3f7a3f793f46,0xbf24bf69bf80bf65bf1cbe543e733f22,0x3f473f803f523ea1bea4bf53bf80bf46,0xbf21bd173f123f733f733f11bd30bf22
.octa 0x3eefbeb2bf6ebf65be863f0c3f7d3f46,0x3f633f703ebbbee6bf77bf57be1c3f22,0xbf75bf3c3e5a3f733f41be3bbf71bf46,0x3e92bf2ebf7abea13f283f7c3eafbf22,0xbdbc3f693f32bee6bf7ebe543f5b3f46,0xbf7fbed53f383f65be04bf7abf053f22,0x3f7f3d17bf7cbea13f653f11bf3dbf46,0x3dd53f803e35bf73bee33f533f2dbf22
.octa 0xbe98bf703ecd3f65beffbf573f173f46,0x3f75beb2bf6b3ee63f5ebf0cbf4f3f22,0xbf613f2e3f0abf73bd8a3f7cbed8bf46,0xbef4bf3c3f573ea1bf7f3e3b3f68bf22,0x3f243ed5bf803ee63f1cbf7a3e733f46,0xbf453f69bc97bf653f4b3e54bf793f22,0x3f21bf803f123ea1bf733f53bd30bf46,0x3f473d17bf523f73bea4bf113f80bf22
.octa 0xbf633eb23ebbbf653f77bf0cbe1c3f46,0x3eefbf703f6ebee6be863f57bf7d3f22,0xbe923f3cbf7a3f73bf283e3b3eafbf46,0xbf753f2ebe5abea13f41bf7c3f71bf22,0x3f7fbf693f38bee63e043e54bf053f46,0xbdbc3ed5bf323f65bf7e3f7abf5b3f22,0xbdd5bd173e35bea13ee3bf113f2dbf46,0x3f7fbf803f7cbf733f65bf533f3dbf22
.octa 0x3f7d3f7f3f803f803f7f3f7e3f7b3f78,0xbe10bdb0bcfb3cc93da33e0a3e423e79,0x3f803f743f593f313efa3e823bc9be79,0x3d623e9b3f083f393f603f783f803f78,0x3f783f443ed2bcc9bee9bf4cbf7bbf78,0x3e7f3f253f693f803f643f1b3e4ebe79,0x3f673eecbe29bf39bf7ebf5dbec73e79,0x3ede3f633f7c3f313deebf01bf6cbf78
.octa 0x3f4d3db0bf2fbf80bf263e0a3f543f78,0x3f1a3f7f3f3abcc9bf43bf7ebf103e79,0x3f2bbe9bbf79bf313e8c3f783f36be79,0x3f3f3f743e66bf39bf76be823f343f78,0x3f02bf25bf6f3cc93f743f1bbf0dbf78,0x3f5c3f44beb5bf80be9e3f4c3f56be79,0x3eaabf63bf153f393f49bf01bf6d3e79,0x3f723eecbf50bf313f1f3f5dbec1bf78
.octa 0x3e10bf7fbcfb3f80bda3bf7e3e423f78,0x3f7d3db0bf803cc93f7fbe0abf7b3e79,0xbd62bf743f083f31bf60be823f80be79,0x3f80be9bbf593f393efabf78bbc93f78,0xbe7fbf443f69bcc9bf643f4c3e4ebf78,0x3f78bf25bed23f80bee9bf1b3f7bbe79,0xbedebeec3f7cbf39bdee3f5dbf6c3e79,0x3f67bf633e293f31bf7e3f013ec7bf78
.octa 0xbf1abdb03f3abf803f43be0abf103f78,0x3f4dbf7f3f2fbcc9bf263f7ebf543e79,0xbf3f3e9b3e66bf313f76bf783f34be79,0x3f2bbf743f79bf393e8c3e82bf363f78,0xbf5c3f25beb53cc93e9ebf1b3f56bf78,0x3f02bf443f6fbf803f74bf4c3f0dbe79,0xbf723f63bf503f39bf1f3f01bec13e79,0x3eaabeec3f15bf313f49bf5d3f6dbf78
.octa 0xbf6d3f72bf763f7abf7c3f7ebf803f80,0x3ec1bea73e8cbe603e29bde23d628000,0x3e423d7bbe9e3f09bf3a3f60bf783f80,0x3f7bbf803f74bf583f2fbef73e7f8000,0x3f80bf663f1fbe60be663f20bf673f80,0x3bc9bee13f49bf7a3f79bf483ede8000,0x3e4ebf403f7fbf583eb53e8fbf4d3f80,0xbf7b3f2abda3bf093f6fbf763f1a8000
.octa 0xbf6c3ea73efabf7a3f50bde2bf2b3f80,0xbec73f72bf603e603f15bf7e3f3f8000,0xbf103f80bee9bf093f80bef7bf023f80,0x3f543d7bbf643f583cfbbf603f5c8000,0x3f343ee1bf7e3e603f59bf48beaa3f80,0x3f36bf66bdee3f7abf08bf203f728000,0x3f56bf2abf263f583ed2bf76be103f80,0xbf0dbf403f433f09bf69be8f3f7d8000
.octa 0xbec1bf723e8c3f7abe29bf7e3d623f80,0xbf6d3ea73f76be60bf7c3de23f808000,0xbf7bbd7b3f743f09bf2fbf603e7f3f80,0x3e423f803e9ebf58bf3a3ef73f788000,0xbbc93f663f49be60bf79bf203ede3f80,0x3f803ee1bf1fbf7abe663f483f678000,0x3f7b3f40bda3bf58bf6fbe8f3f1a3f80,0x3e4ebf2abf7fbf093eb53f763f4d8000
.octa 0x3ec7bea7bf60bf7abf153de23f3f3f80,0xbf6cbf72befa3e603f503f7e3f2b8000,0xbf54bf80bf64bf09bcfb3ef73f5c3f80,0xbf10bd7b3ee93f583f803f603f028000,0xbf36bee1bdee3e603f083f483f723f80,0x3f343f663f7e3f7a3f593f203eaa8000,0x3f0d3f2a3f433f583f693f763f7d3f80,0x3f563f403f263f093ed23e8f3e108000
.octa 0xbf2d3f37bf413f4abf523f5abf613f67,0x3f3dbf333f28bf1d3f12bf063ef4bedb,0x3f4fbf6e3f7ebf7e3f6ebf4f3f24bedb,0xbf173ebebe04bdfb3ebbbf163f45bf67,0xbf683f80bf653f1dbe5abe6d3f21bf67,0x3ed83c49bee33f4abf7a3f79bf473edb,0x3f79bf6b3eff3dfbbf323f7dbf633edb,0xbe73beca3f5ebf7e3f38be23beef3f67
.octa 0xbf803f333d8abf4a3f7cbf06be923f67,0x3d303f37bf7f3f1d3e35bf5a3f75bedb,0x3f7dbebebf1c3f7ebecdbf163f7fbedb,0x3e1cbf6e3f4b3dfbbf6b3f4f3dbcbf67,0xbf71bc493f73bf1dbf0a3f79bdd5bf67,0xbeaf3f80bea4bf4a3f573e6dbf7f3edb,0x3f5b3ecabf77bdfb3f80be23bf753edb,0x3f05bf6bbe863f7ebc97bf7d3e983f67
.octa 0xbf3dbf373f283f4abf12bf5a3ef43f67,0xbf2d3f333f41bf1dbf523f063f61bedb,0x3f173f6ebe04bf7ebebb3f4f3f45bedb,0x3f4fbebebf7ebdfb3f6e3f16bf24bf67,0xbed8bf80bee33f1d3f7a3e6dbf47bf67,0xbf68bc493f653f4abe5abf79bf213edb,0x3e733f6b3f5e3dfbbf38bf7dbeef3edb,0x3f793ecabeffbf7ebf323e233f633f67
.octa 0xbd30bf33bf7fbf4abe353f063f753f67,0xbf80bf37bd8a3f1d3f7c3f5a3e92bedb,0xbe1c3ebe3f4b3f7e3f6b3f163dbcbedb,0x3f7d3f6e3f1c3dfbbecdbf4fbf7fbf67,0x3eaf3c49bea4bf1dbf57bf79bf7fbf67,0xbf71bf80bf73bf4abf0abe6d3dd53edb,0xbf05becabe86bdfb3c973e233e983edb,0x3f5b3f6b3f773f7e3f803f7d3f753f67
.octa 0xbe983eb2becd3ee6beff3f0cbf173f22,0x3f75bf703f6bbf653f5ebf573f4fbf46,0xbf613f3cbf0a3ea1bd8abe3b3ed8bf22,0xbef43f2ebf573f73bf7f3f7cbf683f46,0x3f24bf693f80bf653f1cbe54be733f22,0xbf453ed53c97bee63f4bbf7a3f79bf46,0x3f21bd17bf123f73bf733f113d30bf22,0x3f47bf803f52bea1bea43f53bf803f46
.octa 0xbf633f70bebbbee63f77bf573e1c3f22,0x3eef3eb2bf6e3f65be86bf0c3f7dbf46,0xbe92bf2e3f7abea1bf283f7cbeafbf22,0xbf753f3c3e5abf733f413e3bbf713f46,0x3f7fbed5bf383f653e04bf7a3f053f22,0xbdbcbf693f323ee6bf7e3e543f5bbf46,0xbdd53f80be35bf733ee33f53bf2dbf22,0x3f7fbd17bf7c3ea13f65bf11bf3d3f46
.octa 0xbf75beb23f6b3ee6bf5ebf0c3f4f3f22,0xbe983f703ecdbf65beff3f573f17bf46,0x3ef4bf3cbf573ea13f7f3e3bbf68bf22,0xbf61bf2e3f0a3f73bd8abf7cbed83f46,0x3f453f693c97bf65bf4b3e543f793f22,0x3f24bed5bf80bee63f1c3f7a3e73bf46,0xbf473d173f523f733ea4bf11bf80bf22,0x3f213f803f12bea1bf73bf53bd303f46
.octa 0xbeefbf70bf6ebee63e863f573f7d3f22,0xbf63beb23ebb3f653f773f0cbe1cbf46,0x3f753f2e3e5abea1bf41bf7cbf71bf22,0xbe92bf3cbf7abf73bf28be3b3eaf3f46,0x3dbc3ed53f323f653f7e3f7a3f5b3f22,0x3f7f3f693f383ee63e04be54bf05bf46,0xbf7fbf80bf7cbf73bf65bf53bf3dbf22,0xbdd53d173e353ea13ee33f113f2d3f46
.octa 0x3e10bdb03cfb3cc9bda33e0abe423e79,0x3f7dbf7f3f80bf803f7fbf7e3f7bbf78,0xbd623e9bbf083f39bf603f78bf803f78,0x3f80bf743f59bf313efabe823bc93e79,0xbe7f3f25bf693f80bf643f1bbe4ebe79,0x3f78bf443ed23cc9bee93f4cbf7b3f78,0xbede3f63bf7c3f31bdeebf013f6cbf78,0x3f67beecbe293f39bf7e3f5dbec7be79
.octa 0xbf1a3f7fbf3abcc93f43bf7e3f103e79,0x3f4dbdb0bf2f3f80bf26be0a3f54bf78,0xbf3f3f74be66bf393f76be82bf343f78,0x3f2b3e9bbf793f313e8cbf783f363e79,0xbf5c3f443eb5bf803e9e3f4cbf56be79,0x3f023f25bf6fbcc93f74bf1bbf0d3f78,0xbf723eec3f50bf31bf1f3f5d3ec1bf78,0x3eaa3f63bf15bf393f493f01bf6dbe79
.octa 0xbf7d3db03f803cc9bf7fbe0a3f7b3e79,0x3e103f7fbcfbbf80bda33f7e3e42bf78,0xbf80be9b3f593f39befabf783bc93f78,0xbd623f743f08bf31bf603e823f803e79,0xbf78bf253ed23f803ee9bf1bbf7bbe79,0xbe7f3f443f693cc9bf64bf4c3e4e3f78,0xbf67bf63be293f313f7e3f01bec7bf78,0xbede3eec3f7c3f39bdeebf5dbf6cbe79
.octa 0xbf4dbf7fbf2fbcc93f263f7e3f543e79,0xbf1a3db03f3a3f803f433e0abf10bf78,0xbf2bbf74bf79bf39be8c3e823f363f78,0xbf3fbe9b3e663f313f763f783f343e79,0xbf02bf44bf6fbf80bf74bf4cbf0dbe79,0xbf5cbf25beb5bcc93e9e3f1b3f563f78,0xbeaabeecbf15bf31bf49bf5dbf6dbf78,0xbf72bf63bf50bf39bf1fbf01bec1be79
.octa 0xbec13ea7be8c3e60be293de2bd620000,0xbf6d3f72bf763f7abf7c3f7ebf803f80,0xbf7b3f80bf743f58bf2f3ef7be7f0000,0x3e423d7bbe9e3f09bf3a3f60bf783f80,0xbbc93ee1bf493f7abf793f48bede0000,0x3f80bf663f1fbe60be663f20bf673f80,0x3f7bbf2a3da33f09bf6f3f76bf1a0000,0x3e4ebf403f7fbf583eb53e8fbf4d3f80
.octa 0x3ec7bf723f60be60bf153f7ebf3f0000,0xbf6c3ea73efabf7a3f50bde2bf2b3f80,0xbf54bd7b3f64bf58bcfb3f60bf5c0000,0xbf103f80bee9bf093f80bef7bf023f80,0xbf363f663deebf7a3f083f20bf720000,0x3f343ee1bf7e3e603f59bf48beaa3f80,0x3f0d3f40bf43bf093f693e8fbf7d0000,0x3f56bf2abf263f583ed2bf76be103f80
.octa 0x3f6dbea7bf763e603f7cbde2bf800000,0xbec1bf723e8c3f7abe29bf7e3d623f80,0xbe42bf80be9e3f583f3abef7bf780000,0xbf7bbd7b3f743f09bf2fbf603e7f3f80,0xbf80bee13f1f3f7a3e66bf48bf670000,0xbbc93f663f49be60bf79bf203ede3f80,0xbe4e3f2a3f7f3f09beb5bf76bf4d0000,0x3f7b3f40bda3bf58bf6fbe8f3f1a3f80
.octa 0x3f6c3f723efabe60bf50bf7ebf2b0000,0x3ec7bea7bf60bf7abf153de23f3f3f80,0x3f103d7bbee9bf58bf80bf60bf020000,0xbf54bf80bf64bf09bcfb3ef73f5c3f80,0xbf34bf66bf7ebf7abf59bf20beaa0000,0xbf36bee1bdee3e603f083f483f723f80,0xbf56bf40bf26bf09bed2be8fbe100000,0x3f0d3f2a3f433f583f693f763f7d3f80
.octa 0xbf3d3f33bf283f1dbf123f06bef43edb,0xbf2d3f37bf413f4abf523f5abf613f67,0x3f17bebe3e043dfbbebb3f16bf453f67,0x3f4fbf6e3f7ebf7e3f6ebf4f3f24bedb,0xbed8bc493ee3bf4a3f7abf793f47bedb,0xbf683f80bf653f1dbe5abe6d3f21bf67,0x3e733ecabf5e3f7ebf383e233eefbf67,0x3f79bf6b3eff3dfbbf323f7dbf633edb
.octa 0xbd30bf373f7fbf1dbe353f5abf753edb,0xbf803f333d8abf4a3f7cbf06be923f67,0xbe1c3f6ebf4bbdfb3f6bbf4fbdbc3f67,0x3f7dbebebf1c3f7ebecdbf163f7fbedb,0x3eafbf803ea43f4abf57be6d3f7fbedb,0xbf71bc493f73bf1dbf0a3f79bdd5bf67,0xbf053f6b3e86bf7e3c973f7dbe98bf67,0x3f5b3ecabf77bdfb3f80be23bf753edb
.octa 0x3f2dbf33bf413f1d3f52bf06bf613edb,0xbf3dbf373f283f4abf12bf5a3ef43f67,0xbf4f3ebe3f7e3dfbbf6ebf163f243f67,0x3f173f6ebe04bf7ebebb3f4f3f45bedb,0x3f683c49bf65bf4a3e5a3f793f21bedb,0xbed8bf80bee33f1d3f7a3e6dbf47bf67,0xbf79beca3eff3f7e3f32be23bf63bf67,0x3e733f6b3f5e3dfbbf38bf7dbeef3edb
.octa 0x3f803f373d8abf1dbf7cbf5abe923edb,0xbd30bf33bf7fbf4abe353f063f753f67,0xbf7dbf6ebf1cbdfb3ecd3f4f3f7f3f67,0xbe1c3ebe3f4b3f7e3f6b3f163dbcbedb,0x3f713f803f733f4a3f0a3e6dbdd5bedb,0x3eaf3c49bea4bf1dbf57bf79bf7fbf67,0xbf5bbf6bbf77bf7ebf80bf7dbf75bf67,0xbf05becabe86bdfb3c973e233e983edb
.octa 0xbf753f70bf6b3f65bf5e3f57bf4f3f46,0xbe983eb2becd3ee6beff3f0cbf173f22,0x3ef4bf2e3f57bf733f7fbf7c3f68bf46,0xbf613f3cbf0a3ea1bd8abe3b3ed8bf22,0x3f45bed5bc973ee6bf4b3f7abf793f46,0x3f24bf693f80bf653f1cbe54be733f22,0xbf473f80bf523ea13ea4bf533f80bf46,0x3f21bd17bf123f73bf733f113d30bf22
.octa 0xbeefbeb23f6ebf653e863f0cbf7d3f46,0xbf633f70bebbbee63f77bf573e1c3f22,0x3f75bf3cbe5a3f73bf41be3b3f71bf46,0xbe92bf2e3f7abea1bf283f7cbeafbf22,0x3dbc3f69bf32bee63f7ebe54bf5b3f46,0x3f7fbed5bf383f653e04bf7a3f053f22,0xbf7f3d173f7cbea1bf653f113f3dbf46,0xbdd53f80be35bf733ee33f53bf2dbf22
.octa 0x3e98bf70becd3f653effbf57bf173f46,0xbf75beb23f6b3ee6bf5ebf0c3f4f3f22,0x3f613f2ebf0abf733d8a3f7c3ed8bf46,0x3ef4bf3cbf573ea13f7f3e3bbf68bf22,0xbf243ed53f803ee6bf1cbf7abe733f46,0x3f453f693c97bf65bf4b3e543f793f22,0xbf21bf80bf123ea13f733f533d30bf46,0xbf473d173f523f733ea4bf11bf80bf22
.octa 0x3f633eb2bebbbf65bf77bf0c3e1c3f46,0xbeefbf70bf6ebee63e863f573f7d3f22,0x3e923f3c3f7a3f733f283e3bbeafbf46,0x3f753f2e3e5abea1bf41bf7cbf71bf22,0xbf7fbf69bf38bee6be043e543f053f46,0x3dbc3ed53f323f653f7e3f7a3f5b3f22,0x3dd5bd17be35bea1bee3bf11bf2dbf46,0xbf7fbf80bf7cbf73bf65bf53bf3dbf22
.octa 0xbf7d3f7fbf803f80bf7f3f7ebf7b3f78,0x3e10bdb03cfb3cc9bda33e0abe423e79,0xbf803f74bf593f31befa3e82bbc9be79,0xbd623e9bbf083f39bf603f78bf803f78,0xbf783f44bed2bcc93ee9bf4c3f7bbf78,0xbe7f3f25bf693f80bf643f1bbe4ebe79,0xbf673eec3e29bf393f7ebf5d3ec73e79,0xbede3f63bf7c3f31bdeebf013f6cbf78
.octa 0xbf4d3db03f2fbf803f263e0abf543f78,0xbf1a3f7fbf3abcc93f43bf7e3f103e79,0xbf2bbe9b3f79bf31be8c3f78bf36be79,0xbf3f3f74be66bf393f76be82bf343f78,0xbf02bf253f6f3cc9bf743f1b3f0dbf78,0xbf5c3f443eb5bf803e9e3f4cbf56be79,0xbeaabf633f153f39bf49bf013f6d3e79,0xbf723eec3f50bf31bf1f3f5d3ec1bf78
.octa 0xbe10bf7f3cfb3f803da3bf7ebe423f78,0xbf7d3db03f803cc9bf7fbe0a3f7b3e79,0x3d62bf74bf083f313f60be82bf80be79,0xbf80be9b3f593f39befabf783bc93f78,0x3e7fbf44bf69bcc93f643f4cbe4ebf78,0xbf78bf253ed23f803ee9bf1bbf7bbe79,0x3edebeecbf7cbf393dee3f5d3f6c3e79,0xbf67bf63be293f313f7e3f01bec7bf78
.octa 0x3f1abdb0bf3abf80bf43be0a3f103f78,0xbf4dbf7fbf2fbcc93f263f7e3f543e79,0x3f3f3e9bbe66bf31bf76bf78bf34be79,0xbf2bbf74bf79bf39be8c3e823f363f78,0x3f5c3f253eb53cc9be9ebf1bbf56bf78,0xbf02bf44bf6fbf80bf74bf4cbf0dbe79,0x3f723f633f503f393f1f3f013ec13e79,0xbeaabeecbf15bf31bf49bf5dbf6dbf78
.octa 0x3f6b3f713f753f793f7c3f7e3f803f80,0xbecbbeafbe93be6dbe32bdeebd6f8000,0xbe573d303e963f063f393f603f783f80,0xbf7abf80bf75bf5abf31befabe818000,0xbf80bf68bf22be6d3e5d3f1f3f663f80,0x3c7bbed8bf46bf79bf7abf49bedf8000,0xbe38bf3dbf7fbf5abeba3e8c3f4c3f80,0x3f7c3f2d3dc2bf06bf6fbf76bf1a8000
.octa 0x3f6e3eafbef3bf79bf52bdee3f2a3f80,0x3ebd3f713f613e6dbf13bf7ebf3f8000,0x3f0b3f803ef0bf06bf80befa3f023f80,0xbf573d303f623f5abcb0bf60bf5d8000,0xbf383ed83f7f3e6dbf58bf493ea83f80,0xbf32bf683dcf3f793f0abf1fbf728000,0xbf53bf2d3f233f5abecebf763e0d3f80,0x3f11bf3dbf453f063f6abe8cbf7e8000
.octa 0x3ecbbf71be933f793e32bf7ebd6f3f80,0x3f6b3eafbf75be6d3f7c3deebf808000,0x3f7abd30bf753f063f31bf60be813f80,0xbe573f80be96bf5a3f393efabf788000,0xbc7b3f68bf46be6d3f7abf1fbedf3f80,0xbf803ed83f22bf793e5d3f49bf668000,0xbf7c3f3d3dc2bf5a3f6fbe8cbf1a3f80,0xbe38bf2d3f7fbf06beba3f76bf4c8000
.octa 0xbebdbeaf3f61bf793f133deebf3f3f80,0x3f6ebf713ef33e6dbf523f7ebf2a8000,0x3f57bf803f62bf063cb03efabf5d3f80,0x3f0bbd30bef03f5abf803f60bf028000,0x3f32bed83dcf3e6dbf0a3f49bf723f80,0xbf383f68bf7f3f79bf583f1fbea88000,0xbf113f2dbf453f5abf6a3f76bf7e3f80,0xbf533f3dbf233f06bece3e8cbe0d8000
.octa 0x3f243f2f3f3a3f443f4d3f563f5e3f65,0xbf44bf3abf30bf25bf19bf0dbf00bee6,0xbf47bf69bf7cbf7fbf71bf54bf29bee6,0x3f213ed23e2cbdb0beabbf10bf40bf65,0x3f633f803f6a3f253e7cbe4ebf1cbf65,0xbeedbcfb3ed13f443f783f7b3f4b3ee6,0xbf76bf6fbf083db03f2b3f7b3f663ee6,0x3e90beb5bf59bf7fbf3ebe423ee23f65
.octa 0x3f7f3f3abce2bf44bf7dbf0d3e843f65,0xbdb63f2f3f803f25be13bf56bf77bee6,0xbf7fbed23f143f7f3edcbf10bf7fbee6,0xbddbbf69bf513db03f673f54bd84bf65,0x3f743cfbbf6fbf253f033f7b3e07bf65,0x3e993f803eb7bf44bf5c3e4e3f7e3ee6,0xbf613eb53f7abdb0bf80be423f723ee6,0xbef6bf6f3e633f7f3d56bf7bbea53f65
.octa 0x3f44bf2fbf303f443f19bf56bf003f65,0x3f243f3abf3abf253f4d3f0dbf5ebee6,0xbf213f693e2cbf7f3eab3f54bf40bee6,0xbf47bed23f7cbdb0bf713f103f29bf65,0x3eedbf803ed13f25bf783e4e3f4bbf65,0x3f633cfbbf6a3f443e7cbf7b3f1c3ee6,0xbe903f6fbf593db03f3ebf7b3ee23ee6,0xbf763eb53f08bf7f3f2b3e42bf663f65
.octa 0x3db6bf3a3f80bf443e133f0dbf773f65,0x3f7fbf2f3ce23f25bf7d3f56be84bee6,0x3ddb3ed2bf513f7fbf673f10bd84bee6,0xbf7f3f69bf143db03edcbf543f7fbf65,0xbe99bcfb3eb7bf253f5cbf7b3f7ebf65,0x3f74bf803f6fbf443f03be4ebe073ee6,0x3ef6beb53e63bdb0bd563e42bea53ee6,0xbf613f6fbf7a3f7fbf803f7bbf723f65
.octa 0x3e6a3e923eae3eca3ee53eff3f0c3f18,0xbf79bf75bf71bf6bbf65bf5ebf56bf4e,0x3f693f473f183ebe3e00be04bec0bf18,0x3ed43f213f4e3f6e3f7e3f7e3f6d3f4e,0xbf15bf61bf80bf6bbf28be863e3f3f18,0x3f503ef43d3cbecabf41bf77bf7cbf4e,0xbf2fbdd53f043f6e3f773f1c3c17bf18,0xbf3bbf7fbf5bbebe3e873f4b3f803f4e
.octa 0x3f5a3f753ed9becabf73bf5ebe513f18,0xbf073e923f683f6b3ea2beffbf7bbf4e,0x3eb4bf21bf7dbebe3f1d3f7e3ec8bf18,0x3f703f47be19bf6ebf4a3e043f6c3f4e,0xbf7dbef43f2d3f6bbd90bf77bf103f18,0x3e26bf61bf3d3eca3f7f3e86bf54bf4e,0x3d0a3f7f3e76bf6ebefe3f4b3f37bf18,0xbf80bdd53f793ebebf5ebf1c3f333f4e
.octa 0x3f79be92bf713eca3f65beffbf563f18,0x3e6a3f75beaebf6b3ee53f5ebf0cbf4e,0xbed4bf473f4e3ebebf7e3e043f6dbf18,0x3f69bf21bf183f6e3e00bf7e3ec03f4e,0xbf503f613d3cbf6b3f413e86bf7c3f18,0xbf15bef43f80becabf283f77be3fbf4e,0x3f3b3dd5bf5b3f6ebe87bf1c3f80bf18,0xbf2f3f7fbf04bebe3f77bf4bbc173f4e
.octa 0x3f07bf753f68becabea23f5ebf7b3f18,0x3f5abe92bed93f6bbf733eff3e51bf4e,0xbf703f21be19bebe3f4abf7e3f6cbf18,0x3eb4bf473f7dbf6e3f1dbe04bec83f4e,0xbe263ef4bf3d3f6bbf7f3f77bf543f18,0xbf7d3f61bf2d3ecabd90be863f10bf4e,0x3f80bf7f3f79bf6e3f5ebf4b3f33bf18,0x3d0a3dd5be763ebebefe3f1cbf373f4e
.octa 0xbe70be35bdf4bd7bbb493d623de83e2f,0xbf79bf7cbf7ebf80bf80bf80bf7ebf7c,0xbd233e5a3ee83f2a3f543f723f7f3f7c,0xbf80bf7abf64bf40bf0fbeaabda93e2f,0x3e203f123f5f3f803f6d3f2b3e8dbe2f,0xbf7dbf52befbbd7b3ec23f3f3f763f7c,0x3eb13f573f7f3f403e4bbedebf64bf7c,0xbf70bf0a3d9d3f2a3f7b3f673eeabe2f
.octa 0x3f063f7c3f493d7bbf34bf80bf1f3e2f,0xbf5abe353f1e3f803f36bd62bf48bf7c,0x3f2e3f7a3e9fbf2abf7bbeaa3f253f7c,0xbf3c3e5a3f733f40be45bf72bf433e2f,0x3f4f3f52be8abf80bec53f3f3f60be2f,0xbf173f123f773d7bbf6cbf2b3ef83f7c,0x3f683f0abf42bf403f0e3f67be9cbf7c,0xbed73f573f27bf2abf553ede3f74be2f
.octa 0x3f793e35bf7ebd7b3f80bd62bf7e3e2f,0xbe703f7c3df4bf80bb493f80bde8bf7c,0x3f80be5abf643f2a3f0fbf72bda93f7c,0xbd233f7abee8bf403f543eaabf7f3e2f,0x3f7dbf12befb3f80bec2bf2b3f76be2f,0x3e203f52bf5fbd7b3f6dbf3fbe8d3f7c,0x3f70bf573d9d3f40bf7b3ede3eeabf7c,0x3eb13f0abf7f3f2a3e4bbf673f64be2f
.octa 0x3f5abf7c3f1e3d7bbf363f80bf483e2f,0x3f063e35bf493f80bf343d623f1fbf7c,0x3f3cbf7a3f73bf2a3e453eaabf433f7c,0x3f2ebe5abe9f3f40bf7b3f72bf253e2f,0x3f17bf523f77bf803f6cbf3f3ef8be2f,0x3f4fbf123e8a3d7bbec53f2bbf603f7c,0x3ed7bf0a3f27bf403f55bf673f74bf7c,0x3f68bf573f42bf2a3f0ebede3e9cbe2f
.octa 0x3ecb3eaf3e933e6d3e323dee3d6f0000,0x3f6b3f713f753f793f7c3f7e3f803f80,0x3f7a3f803f753f5a3f313efa3e810000,0xbe573d303e963f063f393f603f783f80,0xbc7b3ed83f463f793f7a3f493edf0000,0xbf80bf68bf22be6d3e5d3f1f3f663f80,0xbf7cbf2dbdc23f063f6f3f763f1a0000,0xbe38bf3dbf7fbf5abeba3e8c3f4c3f80
.octa 0xbebdbf71bf61be6d3f133f7e3f3f0000,0x3f6e3eafbef3bf79bf52bdee3f2a3f80,0x3f57bd30bf62bf5a3cb03f603f5d0000,0x3f0b3f803ef0bf06bf80befa3f023f80,0x3f323f68bdcfbf79bf0a3f1f3f720000,0xbf383ed83f7f3e6dbf58bf493ea83f80,0xbf113f3d3f45bf06bf6a3e8c3f7e0000,0xbf53bf2d3f233f5abecebf763e0d3f80
.octa 0xbf6bbeaf3f753e6dbf7cbdee3f800000,0x3ecbbf71be933f793e32bf7ebd6f3f80,0x3e57bf803e963f5abf39befa3f780000,0x3f7abd30bf753f063f31bf60be813f80,0x3f80bed8bf223f79be5dbf493f660000,0xbc7b3f68bf46be6d3f7abf1fbedf3f80,0x3e383f2dbf7f3f063ebabf763f4c0000,0xbf7c3f3d3dc2bf5a3f6fbe8cbf1a3f80
.octa 0xbf6e3f71bef3be6d3f52bf7e3f2a0000,0xbebdbeaf3f61bf793f133deebf3f3f80,0xbf0b3d303ef0bf5a3f80bf603f020000,0x3f57bf803f62bf063cb03efabf5d3f80,0x3f38bf683f7fbf793f58bf1f3ea80000,0x3f32bed83dcf3e6dbf0a3f49bf723f80,0x3f53bf3d3f23bf063ecebe8c3e0d0000,0xbf113f2dbf453f5abf6a3f76bf7e3f80
.octa 0x3f443f3a3f303f253f193f0d3f003ee6,0x3f243f2f3f3a3f443f4d3f563f5e3f65,0xbf21bed2be2c3db03eab3f103f403f65,0xbf47bf69bf7cbf7fbf71bf54bf29bee6,0x3eed3cfbbed1bf44bf78bf7bbf4bbee6,0x3f633f803f6a3f253e7cbe4ebf1cbf65,0xbe903eb53f593f7f3f3e3e42bee2bf65,0xbf76bf6fbf083db03f2b3f7b3f663ee6
.octa 0x3db6bf2fbf80bf253e133f563f773ee6,0x3f7f3f3abce2bf44bf7dbf0d3e843f65,0x3ddb3f693f51bdb0bf67bf543d843f65,0xbf7fbed23f143f7f3edcbf10bf7fbee6,0xbe99bf80beb73f443f5cbe4ebf7ebee6,0x3f743cfbbf6fbf253f033f7b3e07bf65,0x3ef63f6fbe63bf7fbd563f7b3ea5bf65,0xbf613eb53f7abdb0bf80be423f723ee6
.octa 0xbf24bf3a3f3a3f25bf4dbf0d3f5e3ee6,0x3f44bf2fbf303f443f19bf56bf003f65,0x3f473ed2bf7c3db03f71bf10bf293f65,0xbf213f693e2cbf7f3eab3f54bf40bee6,0xbf63bcfb3f6abf44be7c3f7bbf1cbee6,0x3eedbf803ed13f25bf783e4e3f4bbf65,0x3f76beb5bf083f7fbf2bbe423f66bf65,0xbe903f6fbf593db03f3ebf7b3ee23ee6
.octa 0xbf7f3f2fbce2bf253f7dbf563e843ee6,0x3db6bf3a3f80bf443e133f0dbf773f65,0x3f7fbf693f14bdb0bedc3f54bf7f3f65,0x3ddb3ed2bf513f7fbf673f10bd84bee6,0xbf743f80bf6f3f44bf033e4e3e07bee6,0xbe99bcfb3eb7bf253f5cbf7b3f7ebf65,0x3f61bf6f3f7abf7f3f80bf7b3f72bf65,0x3ef6beb53e63bdb0bd563e42bea53ee6
.octa 0x3f793f753f713f6b3f653f5e3f563f4e,0x3e6a3e923eae3eca3ee53eff3f0c3f18,0xbed4bf21bf4ebf6ebf7ebf7ebf6dbf4e,0x3f693f473f183ebe3e00be04bec0bf18,0xbf50bef4bd3c3eca3f413f773f7c3f4e,0xbf15bf61bf80bf6bbf28be863e3f3f18,0x3f3b3f7f3f5b3ebebe87bf4bbf80bf4e,0xbf2fbdd53f043f6e3f773f1c3c17bf18
.octa 0x3f07be92bf68bf6bbea23eff3f7b3f4e,0x3f5a3f753ed9becabf73bf5ebe513f18,0xbf70bf473e193f6e3f4abe04bf6cbf4e,0x3eb4bf21bf7dbebe3f1d3f7e3ec8bf18,0xbe263f613f3dbecabf7fbe863f543f4e,0xbf7dbef43f2d3f6bbd90bf77bf103f18,0x3f803dd5bf79bebe3f5e3f1cbf33bf4e,0x3d0a3f7f3e76bf6ebefe3f4b3f37bf18
.octa 0xbe6abf753eae3f6bbee5bf5e3f0c3f4e,0x3f79be92bf713eca3f65beffbf563f18,0xbf693f213f18bf6ebe003f7ebec0bf4e,0xbed4bf473f4e3ebebf7e3e043f6dbf18,0x3f153ef4bf803eca3f28bf773e3f3f4e,0xbf503f613d3cbf6b3f413e86bf7c3f18,0x3f2fbf7f3f043ebebf773f4b3c17bf4e,0x3f3b3dd5bf5b3f6ebe87bf1c3f80bf18
.octa 0xbf5a3e923ed9bf6b3f73beffbe513f4e,0x3f07bf753f68becabea23f5ebf7b3f18,0xbeb43f47bf7d3f6ebf1d3e043ec8bf4e,0xbf703f21be19bebe3f4abf7e3f6cbf18,0x3f7dbf613f2dbeca3d903e86bf103f4e,0xbe263ef4bf3d3f6bbf7f3f77bf543f18,0xbd0abdd53e76bebe3efebf1c3f37bf4e,0x3f80bf7f3f79bf6e3f5ebf4b3f33bf18
.octa 0x3f793f7c3f7e3f803f803f803f7e3f7c,0xbe70be35bdf4bd7bbb493d623de83e2f,0x3f803f7a3f643f403f0f3eaa3da9be2f,0xbd233e5a3ee83f2a3f543f723f7f3f7c,0x3f7d3f523efb3d7bbec2bf3fbf76bf7c,0x3e203f123f5f3f803f6d3f2b3e8dbe2f,0x3f703f0abd9dbf2abf7bbf67beea3e2f,0x3eb13f573f7f3f403e4bbedebf64bf7c
.octa 0x3f5a3e35bf1ebf80bf363d623f483f7c,0x3f063f7c3f493d7bbf34bf80bf1f3e2f,0x3f3cbe5abf73bf403e453f723f43be2f,0x3f2e3f7a3e9fbf2abf7bbeaa3f253f7c,0x3f17bf12bf77bd7b3f6c3f2bbef8bf7c,0x3f4f3f52be8abf80bec53f3f3f60be2f,0x3ed7bf57bf273f2a3f55bedebf743e2f,0x3f683f0abf42bf403f0e3f67be9cbf7c
.octa 0x3e70bf7cbdf43f803b49bf803de83f7c,0x3f793e35bf7ebd7b3f80bd62bf7e3e2f,0x3d23bf7a3ee83f40bf54beaa3f7fbe2f,0x3f80be5abf643f2a3f0fbf72bda93f7c,0xbe20bf523f5f3d7bbf6d3f3f3e8dbf7c,0x3f7dbf12befb3f80bec2bf2b3f76be2f,0xbeb1bf0a3f7fbf2abe4b3f67bf643e2f,0x3f70bf573d9d3f40bf7b3ede3eeabf7c
.octa 0xbf06be353f49bf803f34bd62bf1f3f7c,0x3f5abf7c3f1e3d7bbf363f80bf483e2f,0xbf2e3e5a3e9fbf403f7bbf723f25be2f,0x3f3cbf7a3f73bf2a3e453eaabf433f7c,0xbf4f3f12be8abd7b3ec5bf2b3f60bf7c,0x3f17bf523f77bf803f6cbf3f3ef8be2f,0xbf683f57bf423f2abf0e3edebe9c3e2f,0x3ed7bf0a3f27bf403f55bf673f74bf7c
.octa 0xbf6b3f71bf753f79bf7c3f7ebf803f80,0x3ecbbeaf3e93be6d3e32bdee3d6f8000,0x3e573d30be963f06bf393f60bf783f80,0x3f7abf803f75bf5a3f31befa3e818000,0x3f80bf683f22be6dbe5d3f1fbf663f80,0xbc7bbed83f46bf793f7abf493edf8000,0x3e38bf3d3f7fbf5a3eba3e8cbf4c3f80,0xbf7c3f2dbdc2bf063f6fbf763f1a8000
.octa 0xbf6e3eaf3ef3bf793f52bdeebf2a3f80,0xbebd3f71bf613e6d3f13bf7e3f3f8000,0xbf0b3f80bef0bf063f80befabf023f80,0x3f573d30bf623f5a3cb0bf603f5d8000,0x3f383ed8bf7f3e6d3f58bf49bea83f80,0x3f32bf68bdcf3f79bf0abf1f3f728000,0x3f53bf2dbf233f5a3ecebf76be0d3f80,0xbf11bf3d3f453f06bf6abe8c3f7e8000
.octa 0xbecbbf713e933f79be32bf7e3d6f3f80,0xbf6b3eaf3f75be6dbf7c3dee3f808000,0xbf7abd303f753f06bf31bf603e813f80,0x3e573f803e96bf5abf393efa3f788000,0x3c7b3f683f46be6dbf7abf1f3edf3f80,0x3f803ed8bf22bf79be5d3f493f668000,0x3f7c3f3dbdc2bf5abf6fbe8c3f1a3f80,0x3e38bf2dbf7fbf063eba3f763f4c8000
.octa 0x3ebdbeafbf61bf79bf133dee3f3f3f80,0xbf6ebf71bef33e6d3f523f7e3f2a8000,0xbf57bf80bf62bf06bcb03efa3f5d3f80,0xbf0bbd303ef03f5a3f803f603f028000,0xbf32bed8bdcf3e6d3f0a3f493f723f80,0x3f383f683f7f3f793f583f1f3ea88000,0x3f113f2d3f453f5a3f6a3f763f7e3f80,0x3f533f3d3f233f063ece3e8c3e0d8000
.octa 0xbf243f2fbf3a3f44bf4d3f56bf5e3f65,0x3f44bf3a3f30bf253f19bf0d3f00bee6,0x3f47bf693f7cbf7f3f71bf543f29bee6,0xbf213ed2be2cbdb03eabbf103f40bf65,0xbf633f80bf6a3f25be7cbe4e3f1cbf65,0x3eedbcfbbed13f44bf783f7bbf4b3ee6,0x3f76bf6f3f083db0bf2b3f7bbf663ee6,0xbe90beb53f59bf7f3f3ebe42bee23f65
.octa 0xbf7f3f3a3ce2bf443f7dbf0dbe843f65,0x3db63f2fbf803f253e13bf563f77bee6,0x3f7fbed2bf143f7fbedcbf103f7fbee6,0x3ddbbf693f513db0bf673f543d84bf65,0xbf743cfb3f6fbf25bf033f7bbe07bf65,0xbe993f80beb7bf443f5c3e4ebf7e3ee6,0x3f613eb5bf7abdb03f80be42bf723ee6,0x3ef6bf6fbe633f7fbd56bf7b3ea53f65
.octa 0xbf44bf2f3f303f44bf19bf563f003f65,0xbf243f3a3f3abf25bf4d3f0d3f5ebee6,0x3f213f69be2cbf7fbeab3f543f40bee6,0x3f47bed2bf7cbdb03f713f10bf29bf65,0xbeedbf80bed13f253f783e4ebf4bbf65,0xbf633cfb3f6a3f44be7cbf7bbf1c3ee6,0x3e903f6f3f593db0bf3ebf7bbee23ee6,0x3f763eb5bf08bf7fbf2b3e423f663f65
.octa 0xbdb6bf3abf80bf44be133f0d3f773f65,0xbf7fbf2fbce23f253f7d3f563e84bee6,0xbddb3ed23f513f7f3f673f103d84bee6,0x3f7f3f693f143db0bedcbf54bf7fbf65,0x3e99bcfbbeb7bf25bf5cbf7bbf7ebf65,0xbf74bf80bf6fbf44bf03be4e3e073ee6,0xbef6beb5be63bdb03d563e423ea53ee6,0x3f613f6f3f7a3f7f3f803f7b3f723f65
.octa 0xbe6a3e92beae3ecabee53effbf0c3f18,0x3f79bf753f71bf6b3f65bf5e3f56bf4e,0xbf693f47bf183ebebe00be043ec0bf18,0xbed43f21bf4e3f6ebf7e3f7ebf6d3f4e,0x3f15bf613f80bf6b3f28be86be3f3f18,0xbf503ef4bd3cbeca3f41bf773f7cbf4e,0x3f2fbdd5bf043f6ebf773f1cbc17bf18,0x3f3bbf7f3f5bbebebe873f4bbf803f4e
.octa 0xbf5a3f75bed9beca3f73bf5e3e513f18,0x3f073e92bf683f6bbea2beff3f7bbf4e,0xbeb4bf213f7dbebebf1d3f7ebec8bf18,0xbf703f473e19bf6e3f4a3e04bf6c3f4e,0x3f7dbef4bf2d3f6b3d90bf773f103f18,0xbe26bf613f3d3ecabf7f3e863f54bf4e,0xbd0a3f7fbe76bf6e3efe3f4bbf37bf18,0x3f80bdd5bf793ebe3f5ebf1cbf333f4e
.octa 0xbf79be923f713ecabf65beff3f563f18,0xbe6a3f753eaebf6bbee53f5e3f0cbf4e,0x3ed4bf47bf4e3ebe3f7e3e04bf6dbf18,0xbf69bf213f183f6ebe00bf7ebec03f4e,0x3f503f61bd3cbf6bbf413e863f7c3f18,0x3f15bef4bf80beca3f283f773e3fbf4e,0xbf3b3dd53f5b3f6e3e87bf1cbf80bf18,0x3f2f3f7f3f04bebebf77bf4b3c173f4e
.octa 0xbf07bf75bf68beca3ea23f5e3f7b3f18,0xbf5abe923ed93f6b3f733effbe51bf4e,0x3f703f213e19bebebf4abf7ebf6cbf18,0xbeb4bf47bf7dbf6ebf1dbe043ec83f4e,0x3e263ef43f3d3f6b3f7f3f773f543f18,0x3f7d3f613f2d3eca3d90be86bf10bf4e,0xbf80bf7fbf79bf6ebf5ebf4bbf33bf18,0xbd0a3dd53e763ebe3efe3f1c3f373f4e
.octa 0x3e70be353df4bd7b3b493d62bde83e2f,0x3f79bf7c3f7ebf803f80bf803f7ebf7c,0x3d233e5abee83f2abf543f72bf7f3f7c,0x3f80bf7a3f64bf403f0fbeaa3da93e2f,0xbe203f12bf5f3f80bf6d3f2bbe8dbe2f,0x3f7dbf523efbbd7bbec23f3fbf763f7c,0xbeb13f57bf7f3f40be4bbede3f64bf7c,0x3f70bf0abd9d3f2abf7b3f67beeabe2f
.octa 0xbf063f7cbf493d7b3f34bf803f1f3e2f,0x3f5abe35bf1e3f80bf36bd623f48bf7c,0xbf2e3f7abe9fbf2a3f7bbeaabf253f7c,0x3f3c3e5abf733f403e45bf723f433e2f,0xbf4f3f523e8abf803ec53f3fbf60be2f,0x3f173f12bf773d7b3f6cbf2bbef83f7c,0xbf683f0a3f42bf40bf0e3f673e9cbf7c,0x3ed73f57bf27bf2a3f553edebf74be2f
.octa 0xbf793e353f7ebd7bbf80bd623f7e3e2f,0x3e703f7cbdf4bf803b493f803de8bf7c,0xbf80be5a3f643f2abf0fbf723da93f7c,0x3d233f7a3ee8bf40bf543eaa3f7f3e2f,0xbf7dbf123efb3f803ec2bf2bbf76be2f,0xbe203f523f5fbd7bbf6dbf3f3e8d3f7c,0xbf70bf57bd9d3f403f7b3edebeeabf7c,0xbeb13f0a3f7f3f2abe4bbf67bf64be2f
.octa 0xbf5abf7cbf1e3d7b3f363f803f483e2f,0xbf063e353f493f803f343d62bf1fbf7c,0xbf3cbf7abf73bf2abe453eaa3f433f7c,0xbf2ebe5a3e9f3f403f7b3f723f253e2f,0xbf17bf52bf77bf80bf6cbf3fbef8be2f,0xbf4fbf12be8a3d7b3ec53f2b3f603f7c,0xbed7bf0abf27bf40bf55bf67bf74bf7c,0xbf68bf57bf42bf2abf0ebedebe9cbe2f
.octa 0xbecb3eafbe933e6dbe323deebd6f0000,0xbf6b3f71bf753f79bf7c3f7ebf803f80,0xbf7a3f80bf753f5abf313efabe810000,0x3e573d30be963f06bf393f60bf783f80,0x3c7b3ed8bf463f79bf7a3f49bedf0000,0x3f80bf683f22be6dbe5d3f1fbf663f80,0x3f7cbf2d3dc23f06bf6f3f76bf1a0000,0x3e38bf3d3f7fbf5a3eba3e8cbf4c3f80
.octa 0x3ebdbf713f61be6dbf133f7ebf3f0000,0xbf6e3eaf3ef3bf793f52bdeebf2a3f80,0xbf57bd303f62bf5abcb03f60bf5d0000,0xbf0b3f80bef0bf063f80befabf023f80,0xbf323f683dcfbf793f0a3f1fbf720000,0x3f383ed8bf7f3e6d3f58bf49bea83f80,0x3f113f3dbf45bf063f6a3e8cbf7e0000,0x3f53bf2dbf233f5a3ecebf76be0d3f80
.octa 0x3f6bbeafbf753e6d3f7cbdeebf800000,0xbecbbf713e933f79be32bf7e3d6f3f80,0xbe57bf80be963f5a3f39befabf780000,0xbf7abd303f753f06bf31bf603e813f80,0xbf80bed83f223f793e5dbf49bf660000,0x3c7b3f683f46be6dbf7abf1f3edf3f80,0xbe383f2d3f7f3f06bebabf76bf4c0000,0x3f7c3f3dbdc2bf5abf6fbe8c3f1a3f80
.octa 0x3f6e3f713ef3be6dbf52bf7ebf2a0000,0x3ebdbeafbf61bf79bf133dee3f3f3f80,0x3f0b3d30bef0bf5abf80bf60bf020000,0xbf57bf80bf62bf06bcb03efa3f5d3f80,0xbf38bf68bf7fbf79bf58bf1fbea80000,0xbf32bed8bdcf3e6d3f0a3f493f723f80,0xbf53bf3dbf23bf06becebe8cbe0d0000,0x3f113f2d3f453f5a3f6a3f763f7e3f80
.octa 0xbf443f3abf303f25bf193f0dbf003ee6,0xbf243f2fbf3a3f44bf4d3f56bf5e3f65,0x3f21bed23e2c3db0beab3f10bf403f65,0x3f47bf693f7cbf7f3f71bf543f29bee6,0xbeed3cfb3ed1bf443f78bf7b3f4bbee6,0xbf633f80bf6a3f25be7cbe4e3f1cbf65,0x3e903eb5bf593f7fbf3e3e423ee2bf65,0x3f76bf6f3f083db0bf2b3f7bbf663ee6
.octa 0xbdb6bf2f3f80bf25be133f56bf773ee6,0xbf7f3f3a3ce2bf443f7dbf0dbe843f65,0xbddb3f69bf51bdb03f67bf54bd843f65,0x3f7fbed2bf143f7fbedcbf103f7fbee6,0x3e99bf803eb73f44bf5cbe4e3f7ebee6,0xbf743cfb3f6fbf25bf033f7bbe07bf65,0xbef63f6f3e63bf7f3d563f7bbea5bf65,0x3f613eb5bf7abdb03f80be42bf723ee6
.octa 0x3f24bf3abf3a3f253f4dbf0dbf5e3ee6,0xbf44bf2f3f303f44bf19bf563f003f65,0xbf473ed23f7c3db0bf71bf103f293f65,0x3f213f69be2cbf7fbeab3f543f40bee6,0x3f63bcfbbf6abf443e7c3f7b3f1cbee6,0xbeedbf80bed13f253f783e4ebf4bbf65,0xbf76beb53f083f7f3f2bbe42bf66bf65,0x3e903f6f3f593db0bf3ebf7bbee23ee6
.octa 0x3f7f3f2f3ce2bf25bf7dbf56be843ee6,0xbdb6bf3abf80bf44be133f0d3f773f65,0xbf7fbf69bf14bdb03edc3f543f7f3f65,0xbddb3ed23f513f7f3f673f103d84bee6,0x3f743f803f6f3f443f033e4ebe07bee6,0x3e99bcfbbeb7bf25bf5cbf7bbf7ebf65,0xbf61bf6fbf7abf7fbf80bf7bbf72bf65,0xbef6beb5be63bdb03d563e423ea53ee6
.octa 0xbf793f75bf713f6bbf653f5ebf563f4e,0xbe6a3e92beae3ecabee53effbf0c3f18,0x3ed4bf213f4ebf6e3f7ebf7e3f6dbf4e,0xbf693f47bf183ebebe00be043ec0bf18,0x3f50bef43d3c3ecabf413f77bf7c3f4e,0x3f15bf613f80bf6b3f28be86be3f3f18,0xbf3b3f7fbf5b3ebe3e87bf4b3f80bf4e,0x3f2fbdd5bf043f6ebf773f1cbc17bf18
.octa 0xbf07be923f68bf6b3ea23effbf7b3f4e,0xbf5a3f75bed9beca3f73bf5e3e513f18,0x3f70bf47be193f6ebf4abe043f6cbf4e,0xbeb4bf213f7dbebebf1d3f7ebec8bf18,0x3e263f61bf3dbeca3f7fbe86bf543f4e,0x3f7dbef4bf2d3f6b3d90bf773f103f18,0xbf803dd53f79bebebf5e3f1c3f33bf4e,0xbd0a3f7fbe76bf6e3efe3f4bbf37bf18
.octa 0x3e6abf75beae3f6b3ee5bf5ebf0c3f4e,0xbf79be923f713ecabf65beff3f563f18,0x3f693f21bf18bf6e3e003f7e3ec0bf4e,0x3ed4bf47bf4e3ebe3f7e3e04bf6dbf18,0xbf153ef43f803ecabf28bf77be3f3f4e,0x3f503f61bd3cbf6bbf413e863f7c3f18,0xbf2fbf7fbf043ebe3f773f4bbc17bf4e,0xbf3b3dd53f5b3f6e3e87bf1cbf80bf18
.octa 0x3f5a3e92bed9bf6bbf73beff3e513f4e,0xbf07bf75bf68beca3ea23f5e3f7b3f18,0x3eb43f473f7d3f6e3f1d3e04bec8bf4e,0x3f703f213e19bebebf4abf7ebf6cbf18,0xbf7dbf61bf2dbecabd903e863f103f4e,0x3e263ef43f3d3f6b3f7f3f773f543f18,0x3d0abdd5be76bebebefebf1cbf37bf4e,0xbf80bf7fbf79bf6ebf5ebf4bbf33bf18
.octa 0xbf793f7cbf7e3f80bf803f80bf7e3f7c,0x3e70be353df4bd7b3b493d62bde83e2f,0xbf803f7abf643f40bf0f3eaabda9be2f,0x3d233e5abee83f2abf543f72bf7f3f7c,0xbf7d3f52befb3d7b3ec2bf3f3f76bf7c,0xbe203f12bf5f3f80bf6d3f2bbe8dbe2f,0xbf703f0a3d9dbf2a3f7bbf673eea3e2f,0xbeb13f57bf7f3f40be4bbede3f64bf7c
.octa 0xbf5a3e353f1ebf803f363d62bf483f7c,0xbf063f7cbf493d7b3f34bf803f1f3e2f,0xbf3cbe5a3f73bf40be453f72bf43be2f,0xbf2e3f7abe9fbf2a3f7bbeaabf253f7c,0xbf17bf123f77bd7bbf6c3f2b3ef8bf7c,0xbf4f3f523e8abf803ec53f3fbf60be2f,0xbed7bf573f273f2abf55bede3f743e2f,0xbf683f0a3f42bf40bf0e3f673e9cbf7c
.octa 0xbe70bf7c3df43f80bb49bf80bde83f7c,0xbf793e353f7ebd7bbf80bd623f7e3e2f,0xbd23bf7abee83f403f54beaabf7fbe2f,0xbf80be5a3f643f2abf0fbf723da93f7c,0x3e20bf52bf5f3d7b3f6d3f3fbe8dbf7c,0xbf7dbf123efb3f803ec2bf2bbf76be2f,0x3eb1bf0abf7fbf2a3e4b3f673f643e2f,0xbf70bf57bd9d3f403f7b3edebeeabf7c
.octa 0x3f06be35bf49bf80bf34bd623f1f3f7c,0xbf5abf7cbf1e3d7b3f363f803f483e2f,0x3f2e3e5abe9fbf40bf7bbf72bf25be2f,0xbf3cbf7abf73bf2abe453eaa3f433f7c,0x3f4f3f123e8abd7bbec5bf2bbf60bf7c,0xbf17bf52bf77bf80bf6cbf3fbef8be2f,0x3f683f573f423f2a3f0e3ede3e9c3e2f,0xbed7bf0abf27bf40bf55bf67bf74bf7c
.octa 0x3f693f6f3f743f783f7c3f7e3f803f80,0xbed5beb8be9bbe79be3bbdfbbd7b8000,0xbe6d3cc93e8f3f043f373f5f3f783f80,0xbf79bf80bf76bf5cbf33befcbe828000,0xbf80bf6abf25be793e543f1d3f663f80,0x3d17becfbf44bf78bf7abf4abee18000,0xbe23bf39bf7ebf5cbebe3e893f4c3f80,0x3f7d3f313de2bf04bf6ebf77bf1b8000
.octa 0x3f703eb8beecbf78bf53bdfb3f2a3f80,0x3eb23f6f3f633e79bf11bf7ebf408000,0x3f063f803ef7bf04bf80befc3f013f80,0xbf5a3cc93f603f5cbc49bf5fbf5d8000,0xbf3c3ecf3f7f3e79bf57bf4a3ea73f80,0xbf2ebf6a3db03f783f0cbf1dbf728000,0xbf4fbf313f203f5cbecabf773e0a3f80,0x3f16bf39bf483f043f6bbe89bf7e8000
.octa 0x3ed5bf6fbe9b3f783e3bbf7ebd7b3f80,0x3f693eb8bf74be793f7c3dfbbf808000,0x3f79bcc9bf763f043f33bf5fbe823f80,0xbe6d3f80be8fbf5c3f373efcbf788000,0xbd173f6abf44be793f7abf1dbee13f80,0xbf803ecf3f25bf783e543f4abf668000,0xbf7d3f393de2bf5c3f6ebe89bf1b3f80,0xbe23bf313f7ebf04bebe3f77bf4c8000
.octa 0xbeb2beb83f63bf783f113dfbbf403f80,0x3f70bf6f3eec3e79bf533f7ebf2a8000,0x3f5abf803f60bf043c493efcbf5d3f80,0x3f06bcc9bef73f5cbf803f5fbf018000,0x3f2ebecf3db03e79bf0c3f4abf723f80,0xbf3c3f6abf7f3f78bf573f1dbea78000,0xbf163f31bf483f5cbf6b3f77bf7e3f80,0xbf4f3f39bf203f04beca3e89be0a8000
.octa 0x3f1b3f273f333f3e3f483f513f5a3f62,0xbf4cbf42bf37bf2cbf20bf13bf06bef1,0xbf40bf65bf7abf80bf74bf58bf2ebef1,0x3f2a3ee63e54bd49be9bbf09bf3cbf62,0x3f5d3f7f3f6e3f2c3e8fbe2fbf16bf62,0xbf01bd973ebe3f3e3f763f7c3f4f3ef1,0xbf72bf73bf113d493f253f7a3f693ef1,0x3ea7bea1bf53bf80bf44be603ed53f62
.octa 0x3f7e3f423c49bf3ebf7ebf133e6d3f62,0xbe0a3f273f803f2cbde2bf51bf79bef1,0xbf80bee63f0c3f803eecbf09bf80bef1,0xbd7bbf65bf573d493f633f58bd17bf62,0x3f783d97bf6bbf2c3ef73f7c3e23bf62,0x3e823f7f3ecabf3ebf603e2f3f7d3ef1,0xbf663ea13f7cbd49bf7fbe603f703ef1,0xbee1bf733e3b3f803db0bf7abeb23f62
.octa 0x3f4cbf27bf373f3e3f20bf51bf063f62,0x3f1b3f42bf33bf2c3f483f13bf5abef1,0xbf2a3f653e54bf803e9b3f58bf3cbef1,0xbf40bee63f7abd49bf743f093f2ebf62,0x3f01bf7f3ebe3f2cbf763e2f3f4fbf62,0x3f5d3d97bf6e3f3e3e8fbf7c3f163ef1,0xbea73f73bf533d493f44bf7a3ed53ef1,0xbf723ea13f11bf803f253e60bf693f62
.octa 0x3e0abf423f80bf3e3de23f13bf793f62,0x3f7ebf27bc493f2cbf7e3f51be6dbef1,0x3d7b3ee6bf573f80bf633f09bd17bef1,0xbf803f65bf0c3d493eecbf583f80bf62,0xbe82bd973ecabf2c3f60bf7c3f7dbf62,0x3f78bf7f3f6bbf3e3ef7be2fbe233ef1,0x3ee1bea13e3bbd49bdb03e60beb23ef1,0xbf663f73bf7c3f80bf7f3f7abf703f62
.octa 0x3e233e603e8f3eac3eca3ee63f013f0e,0xbf7dbf7abf76bf71bf6bbf65bf5dbf55,0x3f703f513f253edb3e3bbd97bea7bf0e,0x3eb23f133f443f673f7c3f7f3f723f55,0xbf06bf58bf7ebf71bf33bea13e0a3f0e,0x3f5a3f093de2beacbf37bf73bf7ebf55,0xbf3cbe2f3eec3f673f7a3f273d7bbf0e,0xbf2ebf7cbf63bedb3e543f423f803f55
.octa 0x3f4f3f7a3ef7beacbf6ebf65be823f0e,0xbf163e603f603f713ebebee6bf78bf55,0x3ed5bf13bf7fbedb3f113f7f3ee1bf0e,0x3f693f51bdb0bf67bf533d973f663f55,0xbf79bf093f203f71bc49bf73bf1b3f0e,0x3e6dbf58bf483eac3f803ea1bf4cbf55,0xbd173f7c3e9bbf67bf0c3f423f40bf0e,0xbf80be2f3f743edbbf57bf273f2a3f55
.octa 0x3f7dbe60bf763eac3f6bbee6bf5d3f0e,0x3e233f7abe8fbf713eca3f65bf01bf55,0xbeb2bf513f443edbbf7c3d973f72bf0e,0x3f70bf13bf253f673e3bbf7f3ea73f55,0xbf5a3f583de2bf713f373ea1bf7e3f0e,0xbf06bf093f7ebeacbf333f73be0abf55,0x3f2e3e2fbf633f67be54bf273f80bf0e,0xbf3c3f7cbeecbedb3f7abf42bd7b3f55
.octa 0x3f16bf7a3f60beacbebe3f65bf783f0e,0x3f4fbe60bef73f71bf6e3ee63e82bf55,0xbf693f13bdb0bedb3f53bf7f3f66bf0e,0x3ed5bf513f7fbf673f11bd97bee13f55,0xbe6d3f09bf483f71bf803f73bf4c3f0e,0xbf793f58bf203eacbc49bea13f1bbf55,0x3f80bf7c3f74bf673f57bf423f2abf0e,0xbd173e2fbe9b3edbbf0c3f27bf403f55
.octa 0xbea7be89be54be16bdb0bcc93d173dc9,0xbf72bf77bf7abf7dbf7fbf80bf80bf7f,0xbe0a3dfb3ebe3f183f483f6a3f7d3f7f,0xbf7ebf7ebf6ebf4ebf20becfbe233dc9,0x3d7b3efc3f533f7d3f743f393eb2bdc9,0xbf80bf5fbf11be163e9b3f313f703f7f,0x3e823f4a3f803f4e3e8fbeb8bf5abf7f,0xbf78bf1dbc493f183f763f6f3f06bdc9
.octa 0x3ee13f773f573e16bf25bf80bf2e3dc9,0xbf66be893f0c3f7d3f443cc9bf3cbf7f,0x3f1b3f7e3ecabf18bf7ebecf3f163f7f,0xbf4c3dfb3f6b3f4ebde2bf6abf4f3dc9,0x3f403f5fbe3bbf7dbeec3f313f69bdc9,0xbf2a3efc3f7c3e16bf63bf393ed53f7f,0x3f5d3f1dbf33bf4e3ef73f6fbe6dbf7f,0xbf013f4a3f37bf18bf603eb83f79bdc9
.octa 0x3f723e89bf7abe163f7f3cc9bf803dc9,0xbea73f773e54bf7dbdb03f80bd17bf7f,0x3f7ebdfbbf6e3f183f20bf6abe233f7f,0xbe0a3f7ebebebf4e3f483ecfbf7d3dc9,0x3f80befcbf113f7dbe9bbf393f70bdc9,0x3d7b3f5fbf53be163f74bf31beb23f7f,0x3f78bf4abc493f4ebf763eb83f06bf7f,0x3e823f1dbf803f183e8fbf6f3f5abdc9
.octa 0x3f66bf773f0c3e16bf443f80bf3c3dc9,0x3ee13e89bf573f7dbf25bcc93f2ebf7f,0x3f4cbf7e3f6bbf183de23ecfbf4f3f7f,0x3f1bbdfbbeca3f4ebf7e3f6abf163dc9,0x3f2abf5f3f7cbf7d3f63bf313ed5bdc9,0x3f40befc3e3b3e16beec3f39bf693f7f,0x3f01bf1d3f37bf4e3f60bf6f3f79bf7f,0x3f5dbf4a3f33bf183ef7beb83e6dbdc9
.octa 0x3ed53eb83e9b3e793e3b3dfb3d7b0000,0x3f693f6f3f743f783f7c3f7e3f803f80,0x3f793f803f763f5c3f333efc3e820000,0xbe6d3cc93e8f3f043f373f5f3f783f80,0xbd173ecf3f443f783f7a3f4a3ee10000,0xbf80bf6abf25be793e543f1d3f663f80,0xbf7dbf31bde23f043f6e3f773f1b0000,0xbe23bf39bf7ebf5cbebe3e893f4c3f80
.octa 0xbeb2bf6fbf63be793f113f7e3f400000,0x3f703eb8beecbf78bf53bdfb3f2a3f80,0x3f5abcc9bf60bf5c3c493f5f3f5d0000,0x3f063f803ef7bf04bf80befc3f013f80,0x3f2e3f6abdb0bf78bf0c3f1d3f720000,0xbf3c3ecf3f7f3e79bf57bf4a3ea73f80,0xbf163f393f48bf04bf6b3e893f7e0000,0xbf4fbf313f203f5cbecabf773e0a3f80
.octa 0xbf69beb83f743e79bf7cbdfb3f800000,0x3ed5bf6fbe9b3f783e3bbf7ebd7b3f80,0x3e6dbf803e8f3f5cbf37befc3f780000,0x3f79bcc9bf763f043f33bf5fbe823f80,0x3f80becfbf253f78be54bf4a3f660000,0xbd173f6abf44be793f7abf1dbee13f80,0x3e233f31bf7e3f043ebebf773f4c0000,0xbf7d3f393de2bf5c3f6ebe89bf1b3f80
.octa 0xbf703f6fbeecbe793f53bf7e3f2a0000,0xbeb2beb83f63bf783f113dfbbf403f80,0xbf063cc93ef7bf5c3f80bf5f3f010000,0x3f5abf803f60bf043c493efcbf5d3f80,0x3f3cbf6a3f7fbf783f57bf1d3ea70000,0x3f2ebecf3db03e79bf0c3f4abf723f80,0x3f4fbf393f20bf043ecabe893e0a0000,0xbf163f31bf483f5cbf6b3f77bf7e3f80
.octa 0x3f4c3f423f373f2c3f203f133f063ef1,0x3f1b3f273f333f3e3f483f513f5a3f62,0xbf2abee6be543d493e9b3f093f3c3f62,0xbf40bf65bf7abf80bf74bf58bf2ebef1,0x3f013d97bebebf3ebf76bf7cbf4fbef1,0x3f5d3f7f3f6e3f2c3e8fbe2fbf16bf62,0xbea73ea13f533f803f443e60bed5bf62,0xbf72bf73bf113d493f253f7a3f693ef1
.octa 0x3e0abf27bf80bf2c3de23f513f793ef1,0x3f7e3f423c49bf3ebf7ebf133e6d3f62,0x3d7b3f653f57bd49bf63bf583d173f62,0xbf80bee63f0c3f803eecbf09bf80bef1,0xbe82bf7fbeca3f3e3f60be2fbf7dbef1,0x3f783d97bf6bbf2c3ef73f7c3e23bf62,0x3ee13f73be3bbf80bdb03f7a3eb2bf62,0xbf663ea13f7cbd49bf7fbe603f703ef1
.octa 0xbf1bbf423f333f2cbf48bf133f5a3ef1,0x3f4cbf27bf373f3e3f20bf51bf063f62,0x3f403ee6bf7a3d493f74bf09bf2e3f62,0xbf2a3f653e54bf803e9b3f58bf3cbef1,0xbf5dbd973f6ebf3ebe8f3f7cbf16bef1,0x3f01bf7f3ebe3f2cbf763e2f3f4fbf62,0x3f72bea1bf113f80bf25be603f69bf62,0xbea73f73bf533d493f44bf7a3ed53ef1
.octa 0xbf7e3f273c49bf2c3f7ebf513e6d3ef1,0x3e0abf423f80bf3e3de23f13bf793f62,0x3f80bf653f0cbd49beec3f58bf803f62,0x3d7b3ee6bf573f80bf633f09bd17bef1,0xbf783f7fbf6b3f3ebef73e2f3e23bef1,0xbe82bd973ecabf2c3f60bf7c3f7dbf62,0x3f66bf733f7cbf803f7fbf7a3f70bf62,0x3ee1bea13e3bbd49bdb03e60beb23ef1
.octa 0x3f7d3f7a3f763f713f6b3f653f5d3f55,0x3e233e603e8f3eac3eca3ee63f013f0e,0xbeb2bf13bf44bf67bf7cbf7fbf72bf55,0x3f703f513f253edb3e3bbd97bea7bf0e,0xbf5abf09bde23eac3f373f733f7e3f55,0xbf06bf58bf7ebf71bf33bea13e0a3f0e,0x3f2e3f7c3f633edbbe54bf42bf80bf55,0xbf3cbe2f3eec3f673f7a3f273d7bbf0e
.octa 0x3f16be60bf60bf71bebe3ee63f783f55,0x3f4f3f7a3ef7beacbf6ebf65be823f0e,0xbf69bf513db03f673f53bd97bf66bf55,0x3ed5bf13bf7fbedb3f113f7f3ee1bf0e,0xbe6d3f583f48beacbf80bea13f4c3f55,0xbf79bf093f203f71bc49bf73bf1b3f0e,0x3f803e2fbf74bedb3f573f27bf2abf55,0xbd173f7c3e9bbf67bf0c3f423f40bf0e
.octa 0xbe23bf7a3e8f3f71becabf653f013f55,0x3f7dbe60bf763eac3f6bbee6bf5d3f0e,0xbf703f133f25bf67be3b3f7fbea7bf55,0xbeb2bf513f443edbbf7c3d973f72bf0e,0x3f063f09bf7e3eac3f33bf733e0a3f55,0xbf5a3f583de2bf713f373ea1bf7e3f0e,0x3f3cbf7c3eec3edbbf7a3f423d7bbf55,0x3f2e3e2fbf633f67be54bf273f80bf0e
.octa 0xbf4f3e603ef7bf713f6ebee6be823f55,0x3f16bf7a3f60beacbebe3f65bf783f0e,0xbed53f51bf7f3f67bf113d973ee1bf55,0xbf693f13bdb0bedb3f53bf7f3f66bf0e,0x3f79bf583f20beac3c493ea1bf1b3f55,0xbe6d3f09bf483f71bf803f73bf4c3f0e,0x3d17be2f3e9bbedb3f0cbf273f40bf55,0x3f80bf7c3f74bf673f57bf423f2abf0e
.octa 0x3f723f773f7a3f7d3f7f3f803f803f7f,0xbea7be89be54be16bdb0bcc93d173dc9,0x3f7e3f7e3f6e3f4e3f203ecf3e23bdc9,0xbe0a3dfb3ebe3f183f483f6a3f7d3f7f,0x3f803f5f3f113e16be9bbf31bf70bf7f,0x3d7b3efc3f533f7d3f743f393eb2bdc9,0x3f783f1d3c49bf18bf76bf6fbf063dc9,0x3e823f4a3f803f4e3e8fbeb8bf5abf7f
.octa 0x3f663e89bf0cbf7dbf44bcc93f3c3f7f,0x3ee13f773f573e16bf25bf80bf2e3dc9,0x3f4cbdfbbf6bbf4e3de23f6a3f4fbdc9,0x3f1b3f7e3ecabf18bf7ebecf3f163f7f,0x3f2abefcbf7cbe163f633f39bed5bf7f,0x3f403f5fbe3bbf7dbeec3f313f69bdc9,0x3f01bf4abf373f183f60beb8bf793dc9,0x3f5d3f1dbf33bf4e3ef73f6fbe6dbf7f
.octa 0x3ea7bf77be543f7d3db0bf803d173f7f,0x3f723e89bf7abe163f7f3cc9bf803dc9,0x3e0abf7e3ebe3f4ebf48becf3f7dbdc9,0x3f7ebdfbbf6e3f183f20bf6abe233f7f,0xbd7bbf5f3f533e16bf743f313eb2bf7f,0x3f80befcbf113f7dbe9bbf393f70bdc9,0xbe82bf1d3f80bf18be8f3f6fbf5a3dc9,0x3f78bf4abc493f4ebf763eb83f06bf7f
.octa 0xbee1be893f57bf7d3f253cc9bf2e3f7f,0x3f66bf773f0c3e16bf443f80bf3c3dc9,0xbf1b3dfb3ecabf4e3f7ebf6a3f16bdc9,0x3f4cbf7e3f6bbf183de23ecfbf4f3f7f,0xbf403efcbe3bbe163eecbf393f69bf7f,0x3f2abf5f3f7cbf7d3f63bf313ed5bdc9,0xbf5d3f4abf333f18bef73eb8be6d3dc9,0x3f01bf1d3f37bf4e3f60bf6f3f79bf7f
.octa 0xbf693f6fbf743f78bf7c3f7ebf803f80,0x3ed5beb83e9bbe793e3bbdfb3d7b8000,0x3e6d3cc9be8f3f04bf373f5fbf783f80,0x3f79bf803f76bf5c3f33befc3e828000,0x3f80bf6a3f25be79be543f1dbf663f80,0xbd17becf3f44bf783f7abf4a3ee18000,0x3e23bf393f7ebf5c3ebe3e89bf4c3f80,0xbf7d3f31bde2bf043f6ebf773f1b8000
.octa 0xbf703eb83eecbf783f53bdfbbf2a3f80,0xbeb23f6fbf633e793f11bf7e3f408000,0xbf063f80bef7bf043f80befcbf013f80,0x3f5a3cc9bf603f5c3c49bf5f3f5d8000,0x3f3c3ecfbf7f3e793f57bf4abea73f80,0x3f2ebf6abdb03f78bf0cbf1d3f728000,0x3f4fbf31bf203f5c3ecabf77be0a3f80,0xbf16bf393f483f04bf6bbe893f7e8000
.octa 0xbed5bf6f3e9b3f78be3bbf7e3d7b3f80,0xbf693eb83f74be79bf7c3dfb3f808000,0xbf79bcc93f763f04bf33bf5f3e823f80,0x3e6d3f803e8fbf5cbf373efc3f788000,0x3d173f6a3f44be79bf7abf1d3ee13f80,0x3f803ecfbf25bf78be543f4a3f668000,0x3f7d3f39bde2bf5cbf6ebe893f1b3f80,0x3e23bf31bf7ebf043ebe3f773f4c8000
.octa 0x3eb2beb8bf63bf78bf113dfb3f403f80,0xbf70bf6fbeec3e793f533f7e3f2a8000,0xbf5abf80bf60bf04bc493efc3f5d3f80,0xbf06bcc93ef73f5c3f803f5f3f018000,0xbf2ebecfbdb03e793f0c3f4a3f723f80,0x3f3c3f6a3f7f3f783f573f1d3ea78000,0x3f163f313f483f5c3f6b3f773f7e3f80,0x3f4f3f393f203f043eca3e893e0a8000
.octa 0xbf1b3f27bf333f3ebf483f51bf5a3f62,0x3f4cbf423f37bf2c3f20bf133f06bef1,0x3f40bf653f7abf803f74bf583f2ebef1,0xbf2a3ee6be54bd493e9bbf093f3cbf62,0xbf5d3f7fbf6e3f2cbe8fbe2f3f16bf62,0x3f01bd97bebe3f3ebf763f7cbf4f3ef1,0x3f72bf733f113d49bf253f7abf693ef1,0xbea7bea13f53bf803f44be60bed53f62
.octa 0xbf7e3f42bc49bf3e3f7ebf13be6d3f62,0x3e0a3f27bf803f2c3de2bf513f79bef1,0x3f80bee6bf0c3f80beecbf093f80bef1,0x3d7bbf653f573d49bf633f583d17bf62,0xbf783d973f6bbf2cbef73f7cbe23bf62,0xbe823f7fbecabf3e3f603e2fbf7d3ef1,0x3f663ea1bf7cbd493f7fbe60bf703ef1,0x3ee1bf73be3b3f80bdb0bf7a3eb23f62
.octa 0xbf4cbf273f373f3ebf20bf513f063f62,0xbf1b3f423f33bf2cbf483f133f5abef1,0x3f2a3f65be54bf80be9b3f583f3cbef1,0x3f40bee6bf7abd493f743f09bf2ebf62,0xbf01bf7fbebe3f2c3f763e2fbf4fbf62,0xbf5d3d973f6e3f3ebe8fbf7cbf163ef1,0x3ea73f733f533d49bf44bf7abed53ef1,0x3f723ea1bf11bf80bf253e603f693f62
.octa 0xbe0abf42bf80bf3ebde23f133f793f62,0xbf7ebf273c493f2c3f7e3f513e6dbef1,0xbd7b3ee63f573f803f633f093d17bef1,0x3f803f653f0c3d49beecbf58bf80bf62,0x3e82bd97becabf2cbf60bf7cbf7dbf62,0xbf78bf7fbf6bbf3ebef7be2f3e233ef1,0xbee1bea1be3bbd493db03e603eb23ef1,0x3f663f733f7c3f803f7f3f7a3f703f62
.octa 0xbe233e60be8f3eacbeca3ee6bf013f0e,0x3f7dbf7a3f76bf713f6bbf653f5dbf55,0xbf703f51bf253edbbe3bbd973ea7bf0e,0xbeb23f13bf443f67bf7c3f7fbf723f55,0x3f06bf583f7ebf713f33bea1be0a3f0e,0xbf5a3f09bde2beac3f37bf733f7ebf55,0x3f3cbe2fbeec3f67bf7a3f27bd7bbf0e,0x3f2ebf7c3f63bedbbe543f42bf803f55
.octa 0xbf4f3f7abef7beac3f6ebf653e823f0e,0x3f163e60bf603f71bebebee63f78bf55,0xbed5bf133f7fbedbbf113f7fbee1bf0e,0xbf693f513db0bf673f533d97bf663f55,0x3f79bf09bf203f713c49bf733f1b3f0e,0xbe6dbf583f483eacbf803ea13f4cbf55,0x3d173f7cbe9bbf673f0c3f42bf40bf0e,0x3f80be2fbf743edb3f57bf27bf2a3f55
.octa 0xbf7dbe603f763eacbf6bbee63f5d3f0e,0xbe233f7a3e8fbf71beca3f653f01bf55,0x3eb2bf51bf443edb3f7c3d97bf72bf0e,0xbf70bf133f253f67be3bbf7fbea73f55,0x3f5a3f58bde2bf71bf373ea13f7e3f0e,0x3f06bf09bf7ebeac3f333f733e0abf55,0xbf2e3e2f3f633f673e54bf27bf80bf0e,0x3f3c3f7c3eecbedbbf7abf423d7b3f55
.octa 0xbf16bf7abf60beac3ebe3f653f783f0e,0xbf4fbe603ef73f713f6e3ee6be82bf55,0x3f693f133db0bedbbf53bf7fbf66bf0e,0xbed5bf51bf7fbf67bf11bd973ee13f55,0x3e6d3f093f483f713f803f733f4c3f0e,0x3f793f583f203eac3c49bea1bf1bbf55,0xbf80bf7cbf74bf67bf57bf42bf2abf0e,0x3d173e2f3e9b3edb3f0c3f273f403f55
.octa 0x3ea7be893e54be163db0bcc9bd173dc9,0x3f72bf773f7abf7d3f7fbf803f80bf7f,0x3e0a3dfbbebe3f18bf483f6abf7d3f7f,0x3f7ebf7e3f6ebf4e3f20becf3e233dc9,0xbd7b3efcbf533f7dbf743f39beb2bdc9,0x3f80bf5f3f11be16be9b3f31bf703f7f,0xbe823f4abf803f4ebe8fbeb83f5abf7f,0x3f78bf1d3c493f18bf763f6fbf06bdc9
.octa 0xbee13f77bf573e163f25bf803f2e3dc9,0x3f66be89bf0c3f7dbf443cc93f3cbf7f,0xbf1b3f7ebecabf183f7ebecfbf163f7f,0x3f4c3dfbbf6b3f4e3de2bf6a3f4f3dc9,0xbf403f5f3e3bbf7d3eec3f31bf69bdc9,0x3f2a3efcbf7c3e163f63bf39bed53f7f,0xbf5d3f1d3f33bf4ebef73f6f3e6dbf7f,0x3f013f4abf37bf183f603eb8bf79bdc9
.octa 0xbf723e893f7abe16bf7f3cc93f803dc9,0x3ea73f77be54bf7d3db03f803d17bf7f,0xbf7ebdfb3f6e3f18bf20bf6a3e233f7f,0x3e0a3f7e3ebebf4ebf483ecf3f7d3dc9,0xbf80befc3f113f7d3e9bbf39bf70bdc9,0xbd7b3f5f3f53be16bf74bf313eb23f7f,0xbf78bf4a3c493f4e3f763eb8bf06bf7f,0xbe823f1d3f803f18be8fbf6fbf5abdc9
.octa 0xbf66bf77bf0c3e163f443f803f3c3dc9,0xbee13e893f573f7d3f25bcc9bf2ebf7f,0xbf4cbf7ebf6bbf18bde23ecf3f4f3f7f,0xbf1bbdfb3eca3f4e3f7e3f6a3f163dc9,0xbf2abf5fbf7cbf7dbf63bf31bed5bdc9,0xbf40befcbe3b3e163eec3f393f693f7f,0xbf01bf1dbf37bf4ebf60bf6fbf79bf7f,0xbf5dbf4abf33bf18bef7beb8be6dbdc9
.octa 0xbed53eb8be9b3e79be3b3dfbbd7b0000,0xbf693f6fbf743f78bf7c3f7ebf803f80,0xbf793f80bf763f5cbf333efcbe820000,0x3e6d3cc9be8f3f04bf373f5fbf783f80,0x3d173ecfbf443f78bf7a3f4abee10000,0x3f80bf6a3f25be79be543f1dbf663f80,0x3f7dbf313de23f04bf6e3f77bf1b0000,0x3e23bf393f7ebf5c3ebe3e89bf4c3f80
.octa 0x3eb2bf6f3f63be79bf113f7ebf400000,0xbf703eb83eecbf783f53bdfbbf2a3f80,0xbf5abcc93f60bf5cbc493f5fbf5d0000,0xbf063f80bef7bf043f80befcbf013f80,0xbf2e3f6a3db0bf783f0c3f1dbf720000,0x3f3c3ecfbf7f3e793f57bf4abea73f80,0x3f163f39bf48bf043f6b3e89bf7e0000,0x3f4fbf31bf203f5c3ecabf77be0a3f80
.octa 0x3f69beb8bf743e793f7cbdfbbf800000,0xbed5bf6f3e9b3f78be3bbf7e3d7b3f80,0xbe6dbf80be8f3f5c3f37befcbf780000,0xbf79bcc93f763f04bf33bf5f3e823f80,0xbf80becf3f253f783e54bf4abf660000,0x3d173f6a3f44be79bf7abf1d3ee13f80,0xbe233f313f7e3f04bebebf77bf4c0000,0x3f7d3f39bde2bf5cbf6ebe893f1b3f80
.octa 0x3f703f6f3eecbe79bf53bf7ebf2a0000,0x3eb2beb8bf63bf78bf113dfb3f403f80,0x3f063cc9bef7bf5cbf80bf5fbf010000,0xbf5abf80bf60bf04bc493efc3f5d3f80,0xbf3cbf6abf7fbf78bf57bf1dbea70000,0xbf2ebecfbdb03e793f0c3f4a3f723f80,0xbf4fbf39bf20bf04becabe89be0a0000,0x3f163f313f483f5c3f6b3f773f7e3f80
.octa 0xbf4c3f42bf373f2cbf203f13bf063ef1,0xbf1b3f27bf333f3ebf483f51bf5a3f62,0x3f2abee63e543d49be9b3f09bf3c3f62,0x3f40bf653f7abf803f74bf583f2ebef1,0xbf013d973ebebf3e3f76bf7c3f4fbef1,0xbf5d3f7fbf6e3f2cbe8fbe2f3f16bf62,0x3ea73ea1bf533f80bf443e603ed5bf62,0x3f72bf733f113d49bf253f7abf693ef1
.octa 0xbe0abf273f80bf2cbde23f51bf793ef1,0xbf7e3f42bc49bf3e3f7ebf13be6d3f62,0xbd7b3f65bf57bd493f63bf58bd173f62,0x3f80bee6bf0c3f80beecbf093f80bef1,0x3e82bf7f3eca3f3ebf60be2f3f7dbef1,0xbf783d973f6bbf2cbef73f7cbe23bf62,0xbee13f733e3bbf803db03f7abeb2bf62,0x3f663ea1bf7cbd493f7fbe60bf703ef1
.octa 0x3f1bbf42bf333f2c3f48bf13bf5a3ef1,0xbf4cbf273f373f3ebf20bf513f063f62,0xbf403ee63f7a3d49bf74bf093f2e3f62,0x3f2a3f65be54bf80be9b3f583f3cbef1,0x3f5dbd97bf6ebf3e3e8f3f7c3f16bef1,0xbf01bf7fbebe3f2c3f763e2fbf4fbf62,0xbf72bea13f113f803f25be60bf69bf62,0x3ea73f733f533d49bf44bf7abed53ef1
.octa 0x3f7e3f27bc49bf2cbf7ebf51be6d3ef1,0xbe0abf42bf80bf3ebde23f133f793f62,0xbf80bf65bf0cbd493eec3f583f803f62,0xbd7b3ee63f573f803f633f093d17bef1,0x3f783f7f3f6b3f3e3ef73e2fbe23bef1,0x3e82bd97becabf2cbf60bf7cbf7dbf62,0xbf66bf73bf7cbf80bf7fbf7abf70bf62,0xbee1bea1be3bbd493db03e603eb23ef1
.octa 0xbf7d3f7abf763f71bf6b3f65bf5d3f55,0xbe233e60be8f3eacbeca3ee6bf013f0e,0x3eb2bf133f44bf673f7cbf7f3f72bf55,0xbf703f51bf253edbbe3bbd973ea7bf0e,0x3f5abf093de23eacbf373f73bf7e3f55,0x3f06bf583f7ebf713f33bea1be0a3f0e,0xbf2e3f7cbf633edb3e54bf423f80bf55,0x3f3cbe2fbeec3f67bf7a3f27bd7bbf0e
.octa 0xbf16be603f60bf713ebe3ee6bf783f55,0xbf4f3f7abef7beac3f6ebf653e823f0e,0x3f69bf51bdb03f67bf53bd973f66bf55,0xbed5bf133f7fbedbbf113f7fbee1bf0e,0x3e6d3f58bf48beac3f80bea1bf4c3f55,0x3f79bf09bf203f713c49bf733f1b3f0e,0xbf803e2f3f74bedbbf573f273f2abf55,0x3d173f7cbe9bbf673f0c3f42bf40bf0e
.octa 0x3e23bf7abe8f3f713ecabf65bf013f55,0xbf7dbe603f763eacbf6bbee63f5d3f0e,0x3f703f13bf25bf673e3b3f7f3ea7bf55,0x3eb2bf51bf443edb3f7c3d97bf72bf0e,0xbf063f093f7e3eacbf33bf73be0a3f55,0x3f5a3f58bde2bf71bf373ea13f7e3f0e,0xbf3cbf7cbeec3edb3f7a3f42bd7bbf55,0xbf2e3e2f3f633f673e54bf27bf80bf0e
.octa 0x3f4f3e60bef7bf71bf6ebee63e823f55,0xbf16bf7abf60beac3ebe3f653f783f0e,0x3ed53f513f7f3f673f113d97bee1bf55,0x3f693f133db0bedbbf53bf7fbf66bf0e,0xbf79bf58bf20beacbc493ea13f1b3f55,0x3e6d3f093f483f713f803f733f4c3f0e,0xbd17be2fbe9bbedbbf0cbf27bf40bf55,0xbf80bf7cbf74bf67bf57bf42bf2abf0e
.octa 0xbf723f77bf7a3f7dbf7f3f80bf803f7f,0x3ea7be893e54be163db0bcc9bd173dc9,0xbf7e3f7ebf6e3f4ebf203ecfbe23bdc9,0x3e0a3dfbbebe3f18bf483f6abf7d3f7f,0xbf803f5fbf113e163e9bbf313f70bf7f,0xbd7b3efcbf533f7dbf743f39beb2bdc9,0xbf783f1dbc49bf183f76bf6f3f063dc9,0xbe823f4abf803f4ebe8fbeb83f5abf7f
.octa 0xbf663e893f0cbf7d3f44bcc9bf3c3f7f,0xbee13f77bf573e163f25bf803f2e3dc9,0xbf4cbdfb3f6bbf4ebde23f6abf4fbdc9,0xbf1b3f7ebecabf183f7ebecfbf163f7f,0xbf2abefc3f7cbe16bf633f393ed5bf7f,0xbf403f5f3e3bbf7d3eec3f31bf69bdc9,0xbf01bf4a3f373f18bf60beb83f793dc9,0xbf5d3f1d3f33bf4ebef73f6f3e6dbf7f
.octa 0xbea7bf773e543f7dbdb0bf80bd173f7f,0xbf723e893f7abe16bf7f3cc93f803dc9,0xbe0abf7ebebe3f4e3f48becfbf7dbdc9,0xbf7ebdfb3f6e3f18bf20bf6a3e233f7f,0x3d7bbf5fbf533e163f743f31beb2bf7f,0xbf80befc3f113f7d3e9bbf39bf70bdc9,0x3e82bf1dbf80bf183e8f3f6f3f5a3dc9,0xbf78bf4a3c493f4e3f763eb8bf06bf7f
.octa 0x3ee1be89bf57bf7dbf253cc93f2e3f7f,0xbf66bf77bf0c3e163f443f803f3c3dc9,0x3f1b3dfbbecabf4ebf7ebf6abf16bdc9,0xbf4cbf7ebf6bbf18bde23ecf3f4f3f7f,0x3f403efc3e3bbe16beecbf39bf69bf7f,0xbf2abf5fbf7cbf7dbf63bf31bed5bdc9,0x3f5d3f4a3f333f183ef73eb83e6d3dc9,0xbf01bf1dbf37bf4ebf60bf6fbf79bf7f
.octa 0x3f663f6d3f733f783f7b3f7e3f7f3f80,0xbedfbec1bea2be82be45be04bd848000,0xbe813bc93e873f013f363f5e3f773f80,0xbf78bf80bf77bf5dbf34beffbe848000,0xbf80bf6cbf28be823e4b3f1c3f663f80,0x3d6fbec7bf41bf78bf7bbf4bbee28000,0xbe0dbf36bf7ebf5dbec23e863f4b3f80,0x3f7e3f343e00bf01bf6dbf77bf1c8000
.octa 0x3f723ec1bee5bf78bf54be043f293f80,0x3ea83f6d3f653e82bf0fbf7ebf408000,0x3f023f803efebf01bf80beff3f003f80,0xbf5d3bc93f5e3f5dbb49bf5ebf5e8000,0xbf3f3ec73f7f3e82bf55bf4b3ea53f80,0xbf2abf6c3d903f783f0ebf1cbf728000,0xbf4cbf343f1d3f5dbec5bf773e073f80,0x3f1abf36bf4a3f013f6cbe86bf7e8000
.octa 0x3edfbf6dbea23f783e45bf7ebd843f80,0x3f663ec1bf73be823f7b3e04bf7f8000,0x3f78bbc9bf773f013f34bf5ebe843f80,0xbe813f80be87bf5d3f363effbf778000,0xbd6f3f6cbf41be823f7bbf1cbee23f80,0xbf803ec73f28bf783e4b3f4bbf668000,0xbf7e3f363e00bf5d3f6dbe86bf1c3f80,0xbe0dbf343f7ebf01bec23f77bf4b8000
.octa 0xbea8bec13f65bf783f0f3e04bf403f80,0x3f72bf6d3ee53e82bf543f7ebf298000,0x3f5dbf803f5ebf013b493effbf5e3f80,0x3f02bbc9befe3f5dbf803f5ebf008000,0x3f2abec73d903e82bf0e3f4bbf723f80,0xbf3f3f6cbf7f3f78bf553f1cbea58000,0xbf1a3f34bf4a3f5dbf6c3f77bf7e3f80,0xbf4c3f36bf1d3f01bec53e86be078000
.octa 0x3f113f1f3f2b3f373f423f4d3f563f5f,0xbf53bf49bf3ebf33bf27bf1abf0cbefc,0xbf38bf60bf78bf80bf77bf5cbf33befc,0x3f323efa3e7cbc49be8abf02bf37bf5f,0x3f573f7e3f713f333e9fbe10bf10bf5f,0xbf0bbdee3eab3f373f733f7d3f543efc,0xbf6ebf76bf193c493f1e3f783f6c3efc,0x3ebdbe8cbf4dbf80bf49be7f3ec83f5f
.octa 0x3f7c3f493d56bf37bf7fbf1a3e513f5f,0xbe383f1f3f803f33bd9dbf4dbf7bbefc,0xbf80befa3f033f803efbbf02bf80befc,0xbc7bbf60bf5c3c493f5f3f5cbc17bf5f,0x3f7a3deebf67bf333ee83f7d3e3fbf5f,0x3e573f7e3edcbf37bf643e103f7c3efc,0xbf6b3e8c3f7dbc49bf7ebe7f3f6d3efc,0xbecbbf763e133f803df4bf78bec03f5f
.octa 0x3f53bf1fbf3e3f373f27bf4dbf0c3f5f,0x3f113f49bf2bbf333f423f1abf56befc,0xbf323f603e7cbf803e8a3f5cbf37befc,0xbf38befa3f78bc49bf773f023f33bf5f,0x3f0bbf7e3eab3f33bf733e103f54bf5f,0x3f573deebf713f373e9fbf7d3f103efc,0xbebd3f76bf4d3c493f49bf783ec83efc,0xbf6e3e8c3f19bf803f1e3e7fbf6c3f5f
.octa 0x3e38bf493f80bf373d9d3f1abf7b3f5f,0x3f7cbf1fbd563f33bf7f3f4dbe51befc,0x3c7b3efabf5c3f80bf5f3f02bc17befc,0xbf803f60bf033c493efbbf5c3f80bf5f,0xbe57bdee3edcbf333f64bf7d3f7cbf5f,0x3f7abf7e3f67bf373ee8be10be3f3efc,0x3ecbbe8c3e13bc49bdf43e7fbec03efc,0xbf6b3f76bf7d3f80bf7e3f78bf6d3f5f
.octa 0x3db63e1c3e5d3e8f3eae3ecd3eea3f04,0xbf7fbf7dbf7abf76bf71bf6bbf64bf5c,0x3f763f5b3f313ef73e76bc97be8dbf04,0x3e903f053f393f603f793f803f763f5c,0xbeedbf4fbf7cbf76bf3dbebb3da93f04,0x3f633f173e32be8fbf2dbf6ebf7fbf5c,0xbf47be733ece3f603f7d3f323de8bf04,0xbf21bf79bf6abef73e193f383f7e3f5c
.octa 0x3f443f7d3f0abe8fbf68bf6bbe9c3f04,0xbf243e1c3f583f763ed9becdbf74bf5c,0x3ef6bf05bf80bef73f043f803ef8bf04,0x3f613f5bbcb0bf60bf5b3c973f603f5c,0xbf74bf173f133f763d3cbf6ebf253f04,0x3e99bf4fbf523e8f3f803ebbbf43bf5c,0xbddb3f793ebabf60bf183f383f48bf04,0xbf7fbe733f6f3ef7bf4ebf323f1f3f5c
.octa 0x3f7fbe1cbf7a3e8f3f71becdbf643f04,0x3db63f7dbe5dbf763eae3f6bbeeabf5c,0xbe90bf5b3f393ef7bf793c973f76bf04,0x3f76bf05bf313f603e76bf803e8d3f5c,0xbf633f4f3e32bf763f2d3ebbbf7f3f04,0xbeedbf173f7cbe8fbf3d3f6ebda9bf5c,0x3f213e73bf6a3f60be19bf323f7ebf04,0xbf473f79becebef73f7dbf38bde83f5c
.octa 0x3f24bf7d3f58be8fbed93f6bbf743f04,0x3f44be1cbf0a3f76bf683ecd3e9cbf5c,0xbf613f05bcb0bef73f5bbf803f60bf04,0x3ef6bf5b3f80bf603f04bc97bef83f5c,0xbe993f17bf523f76bf803f6ebf433f04,0xbf743f4fbf133e8f3d3cbebb3f25bf5c,0x3f7fbf793f6fbf603f4ebf383f1fbf04,0xbddb3e73beba3ef7bf183f32bf483f5c
.octa 0xbed4beb5be96be6dbe2cbdd5bd233cc9,0xbf69bf6fbf75bf79bf7cbf7fbf80bf80,0xbe6a3cfb3e933f063f3a3f613f793f80,0xbf79bf80bf75bf5abf30bef4be703cc9,0xbd0a3ed23f453f793f7a3f473ed7bcc9,0xbf80bf69bf23be6d3e633f213f683f80,0x3e263f3a3f7f3f5a3eb7be92bf4fbf80,0xbf7dbf2fbdcf3f063f6f3f753f17bcc9
.octa 0x3eb43f6f3f623e6dbf14bf7fbf3c3cc9,0xbf70beb53ef03f793f513dd5bf2ebf80,0x3f073f803ef3bf06bf80bef43f063f80,0xbf5a3cfb3f613f5abce2bf61bf5a3cc9,0x3f2f3f69bdc2bf79bf083f213f70bcc9,0xbf3b3ed23f7f3e6dbf59bf473eb13f80,0x3f503f2fbf22bf5a3ed13f75be20bf80,0xbf153f3a3f46bf06bf6a3e923f7dbcc9
.octa 0x3f693eb5bf75be6d3f7c3dd5bf803cc9,0xbed43f6f3e96bf79be2c3f7f3d23bf80,0x3f79bcfbbf753f063f30bf61be703f80,0xbe6a3f80be93bf5a3f3a3ef4bf793cc9,0x3f80bed2bf233f79be63bf473f68bcc9,0xbd0a3f69bf45be6d3f7abf21bed73f80,0x3f7dbf3abdcf3f5abf6f3e923f17bf80,0x3e263f2fbf7f3f063eb7bf753f4fbcc9
.octa 0x3f70bf6f3ef03e6dbf513f7fbf2e3cc9,0x3eb43eb5bf623f79bf14bdd53f3cbf80,0x3f5abf803f61bf063ce23ef4bf5a3f80,0x3f07bcfbbef33f5abf803f61bf063cc9,0x3f3bbf693f7fbf793f59bf213eb1bcc9,0x3f2fbed23dc23e6dbf083f47bf703f80,0x3f15bf2f3f46bf5a3f6abf753f7dbf80,0x3f50bf3a3f22bf063ed1be923e20bcc9
.octa 0x3edf3ec13ea23e823e453e043d840000,0x3f663f6d3f733f783f7b3f7e3f7f3f80,0x3f783f803f773f5d3f343eff3e840000,0xbe813bc93e873f013f363f5e3f773f80,0xbd6f3ec73f413f783f7b3f4b3ee20000,0xbf80bf6cbf28be823e4b3f1c3f663f80,0xbf7ebf34be003f013f6d3f773f1c0000,0xbe0dbf36bf7ebf5dbec23e863f4b3f80
.octa 0xbea8bf6dbf65be823f0f3f7e3f400000,0x3f723ec1bee5bf78bf54be043f293f80,0x3f5dbbc9bf5ebf5d3b493f5e3f5e0000,0x3f023f803efebf01bf80beff3f003f80,0x3f2a3f6cbd90bf78bf0e3f1c3f720000,0xbf3f3ec73f7f3e82bf55bf4b3ea53f80,0xbf1a3f363f4abf01bf6c3e863f7e0000,0xbf4cbf343f1d3f5dbec5bf773e073f80
.octa 0xbf66bec13f733e82bf7bbe043f7f0000,0x3edfbf6dbea23f783e45bf7ebd843f80,0x3e81bf803e873f5dbf36beff3f770000,0x3f78bbc9bf773f013f34bf5ebe843f80,0x3f80bec7bf283f78be4bbf4b3f660000,0xbd6f3f6cbf41be823f7bbf1cbee23f80,0x3e0d3f34bf7e3f013ec2bf773f4b0000,0xbf7e3f363e00bf5d3f6dbe86bf1c3f80
.octa 0xbf723f6dbee5be823f54bf7e3f290000,0xbea8bec13f65bf783f0f3e04bf403f80,0xbf023bc93efebf5d3f80bf5e3f000000,0x3f5dbf803f5ebf013b493effbf5e3f80,0x3f3fbf6c3f7fbf783f55bf1c3ea50000,0x3f2abec73d903e82bf0e3f4bbf723f80,0x3f4cbf363f1dbf013ec5be863e070000,0xbf1a3f34bf4a3f5dbf6c3f77bf7e3f80
.octa 0x3f533f493f3e3f333f273f1a3f0c3efc,0x3f113f1f3f2b3f373f423f4d3f563f5f,0xbf32befabe7c3c493e8a3f023f373f5f,0xbf38bf60bf78bf80bf77bf5cbf33befc,0x3f0b3deebeabbf37bf73bf7dbf54befc,0x3f573f7e3f713f333e9fbe10bf10bf5f,0xbebd3e8c3f4d3f803f493e7fbec8bf5f,0xbf6ebf76bf193c493f1e3f783f6c3efc
.octa 0x3e38bf1fbf80bf333d9d3f4d3f7b3efc,0x3f7c3f493d56bf37bf7fbf1a3e513f5f,0x3c7b3f603f5cbc49bf5fbf5c3c173f5f,0xbf80befa3f033f803efbbf02bf80befc,0xbe57bf7ebedc3f373f64be10bf7cbefc,0x3f7a3deebf67bf333ee83f7d3e3fbf5f,0x3ecb3f76be13bf80bdf43f783ec0bf5f,0xbf6b3e8c3f7dbc49bf7ebe7f3f6d3efc
.octa 0xbf11bf493f2b3f33bf42bf1a3f563efc,0x3f53bf1fbf3e3f373f27bf4dbf0c3f5f,0x3f383efabf783c493f77bf02bf333f5f,0xbf323f603e7cbf803e8a3f5cbf37befc,0xbf57bdee3f71bf37be9f3f7dbf10befc,0x3f0bbf7e3eab3f33bf733e103f54bf5f,0x3f6ebe8cbf193f80bf1ebe7f3f6cbf5f,0xbebd3f76bf4d3c493f49bf783ec83efc
.octa 0xbf7c3f1f3d56bf333f7fbf4d3e513efc,0x3e38bf493f80bf373d9d3f1abf7b3f5f,0x3f80bf603f03bc49befb3f5cbf803f5f,0x3c7b3efabf5c3f80bf5f3f02bc17befc,0xbf7a3f7ebf673f37bee83e103e3fbefc,0xbe57bdee3edcbf333f64bf7d3f7cbf5f,0x3f6bbf763f7dbf803f7ebf783f6dbf5f,0x3ecbbe8c3e13bc49bdf43e7fbec03efc
.octa 0x3f7f3f7d3f7a3f763f713f6b3f643f5c,0x3db63e1c3e5d3e8f3eae3ecd3eea3f04,0xbe90bf05bf39bf60bf79bf80bf76bf5c,0x3f763f5b3f313ef73e76bc97be8dbf04,0xbf63bf17be323e8f3f2d3f6e3f7f3f5c,0xbeedbf4fbf7cbf76bf3dbebb3da93f04,0x3f213f793f6a3ef7be19bf38bf7ebf5c,0xbf47be733ece3f603f7d3f323de8bf04
.octa 0x3f24be1cbf58bf76bed93ecd3f743f5c,0x3f443f7d3f0abe8fbf68bf6bbe9c3f04,0xbf61bf5b3cb03f603f5bbc97bf60bf5c,0x3ef6bf05bf80bef73f043f803ef8bf04,0xbe993f4f3f52be8fbf80bebb3f433f5c,0xbf74bf173f133f763d3cbf6ebf253f04,0x3f7f3e73bf6fbef73f4e3f32bf1fbf5c,0xbddb3f793ebabf60bf183f383f48bf04
.octa 0xbdb6bf7d3e5d3f76beaebf6b3eea3f5c,0x3f7fbe1cbf7a3e8f3f71becdbf643f04,0xbf763f053f31bf60be763f80be8dbf5c,0xbe90bf5b3f393ef7bf793c973f76bf04,0x3eed3f17bf7c3e8f3f3dbf6e3da93f5c,0xbf633f4f3e32bf763f2d3ebbbf7f3f04,0x3f47bf793ece3ef7bf7d3f383de8bf5c,0x3f213e73bf6a3f60be19bf323f7ebf04
.octa 0xbf443e1c3f0abf763f68becdbe9c3f5c,0x3f24bf7d3f58be8fbed93f6bbf743f04,0xbef63f5bbf803f60bf043c973ef8bf5c,0xbf613f05bcb0bef73f5bbf803f60bf04,0x3f74bf4f3f13be8fbd3c3ebbbf253f5c,0xbe993f17bf523f76bf803f6ebf433f04,0x3ddbbe733ebabef73f18bf323f48bf5c,0x3f7fbf793f6fbf603f4ebf383f1fbf04
.octa 0x3f693f6f3f753f793f7c3f7f3f803f80,0xbed4beb5be96be6dbe2cbdd5bd233cc9,0x3f793f803f753f5a3f303ef43e70bcc9,0xbe6a3cfb3e933f063f3a3f613f793f80,0x3f803f693f233e6dbe63bf21bf68bf80,0xbd0a3ed23f453f793f7a3f473ed7bcc9,0x3f7d3f2f3dcfbf06bf6fbf75bf173cc9,0x3e263f3a3f7f3f5a3eb7be92bf4fbf80
.octa 0x3f703eb5bef0bf79bf51bdd53f2e3f80,0x3eb43f6f3f623e6dbf14bf7fbf3c3cc9,0x3f5abcfbbf61bf5a3ce23f613f5abcc9,0x3f073f803ef3bf06bf80bef43f063f80,0x3f3bbed2bf7fbe6d3f593f47beb1bf80,0x3f2f3f69bdc2bf79bf083f213f70bcc9,0x3f15bf3abf463f063f6abe92bf7d3cc9,0x3f503f2fbf22bf5a3ed13f75be20bf80
.octa 0x3ed4bf6fbe963f793e2cbf7fbd233f80,0x3f693eb5bf75be6d3f7c3dd5bf803cc9,0x3e6abf803e933f5abf3abef43f79bcc9,0x3f79bcfbbf753f063f30bf61be703f80,0x3d0abf693f453e6dbf7a3f213ed7bf80,0x3f80bed2bf233f79be63bf473f68bcc9,0xbe26bf2f3f7fbf06beb73f75bf4f3cc9,0x3f7dbf3abdcf3f5abf6f3e923f17bf80
.octa 0xbeb4beb53f62bf793f143dd5bf3c3f80,0x3f70bf6f3ef03e6dbf513f7fbf2e3cc9,0xbf073cfb3ef3bf5a3f80bf613f06bcc9,0x3f5abf803f61bf063ce23ef4bf5a3f80,0xbf2f3ed2bdc2be6d3f08bf473f70bf80,0x3f3bbf693f7fbf793f59bf213eb1bcc9,0xbf503f3abf223f06bed13e92be203cc9,0x3f15bf2f3f46bf5a3f6abf753f7dbf80
.octa 0xbf663f6dbf733f78bf7b3f7ebf7f3f80,0x3edfbec13ea2be823e45be043d848000,0x3e813bc9be873f01bf363f5ebf773f80,0x3f78bf803f77bf5d3f34beff3e848000,0x3f80bf6c3f28be82be4b3f1cbf663f80,0xbd6fbec73f41bf783f7bbf4b3ee28000,0x3e0dbf363f7ebf5d3ec23e86bf4b3f80,0xbf7e3f34be00bf013f6dbf773f1c8000
.octa 0xbf723ec13ee5bf783f54be04bf293f80,0xbea83f6dbf653e823f0fbf7e3f408000,0xbf023f80befebf013f80beffbf003f80,0x3f5d3bc9bf5e3f5d3b49bf5e3f5e8000,0x3f3f3ec7bf7f3e823f55bf4bbea53f80,0x3f2abf6cbd903f78bf0ebf1c3f728000,0x3f4cbf34bf1d3f5d3ec5bf77be073f80,0xbf1abf363f4a3f01bf6cbe863f7e8000
.octa 0xbedfbf6d3ea23f78be45bf7e3d843f80,0xbf663ec13f73be82bf7b3e043f7f8000,0xbf78bbc93f773f01bf34bf5e3e843f80,0x3e813f803e87bf5dbf363eff3f778000,0x3d6f3f6c3f41be82bf7bbf1c3ee23f80,0x3f803ec7bf28bf78be4b3f4b3f668000,0x3f7e3f36be00bf5dbf6dbe863f1c3f80,0x3e0dbf34bf7ebf013ec23f773f4b8000
.octa 0x3ea8bec1bf65bf78bf0f3e043f403f80,0xbf72bf6dbee53e823f543f7e3f298000,0xbf5dbf80bf5ebf01bb493eff3f5e3f80,0xbf02bbc93efe3f5d3f803f5e3f008000,0xbf2abec7bd903e823f0e3f4b3f723f80,0x3f3f3f6c3f7f3f783f553f1c3ea58000,0x3f1a3f343f4a3f5d3f6c3f773f7e3f80,0x3f4c3f363f1d3f013ec53e863e078000
.octa 0xbf113f1fbf2b3f37bf423f4dbf563f5f,0x3f53bf493f3ebf333f27bf1a3f0cbefc,0x3f38bf603f78bf803f77bf5c3f33befc,0xbf323efabe7cbc493e8abf023f37bf5f,0xbf573f7ebf713f33be9fbe103f10bf5f,0x3f0bbdeebeab3f37bf733f7dbf543efc,0x3f6ebf763f193c49bf1e3f78bf6c3efc,0xbebdbe8c3f4dbf803f49be7fbec83f5f
.octa 0xbf7c3f49bd56bf373f7fbf1abe513f5f,0x3e383f1fbf803f333d9dbf4d3f7bbefc,0x3f80befabf033f80befbbf023f80befc,0x3c7bbf603f5c3c49bf5f3f5c3c17bf5f,0xbf7a3dee3f67bf33bee83f7dbe3fbf5f,0xbe573f7ebedcbf373f643e10bf7c3efc,0x3f6b3e8cbf7dbc493f7ebe7fbf6d3efc,0x3ecbbf76be133f80bdf4bf783ec03f5f
.octa 0xbf53bf1f3f3e3f37bf27bf4d3f0c3f5f,0xbf113f493f2bbf33bf423f1a3f56befc,0x3f323f60be7cbf80be8a3f5c3f37befc,0x3f38befabf78bc493f773f02bf33bf5f,0xbf0bbf7ebeab3f333f733e10bf54bf5f,0xbf573dee3f713f37be9fbf7dbf103efc,0x3ebd3f763f4d3c49bf49bf78bec83efc,0x3f6e3e8cbf19bf80bf1e3e7f3f6c3f5f
.octa 0xbe38bf49bf80bf37bd9d3f1a3f7b3f5f,0xbf7cbf1f3d563f333f7f3f4d3e51befc,0xbc7b3efa3f5c3f803f5f3f023c17befc,0x3f803f603f033c49befbbf5cbf80bf5f,0x3e57bdeebedcbf33bf64bf7dbf7cbf5f,0xbf7abf7ebf67bf37bee8be103e3f3efc,0xbecbbe8cbe13bc493df43e7f3ec03efc,0x3f6b3f763f7d3f803f7e3f783f6d3f5f
.octa 0xbdb63e1cbe5d3e8fbeae3ecdbeea3f04,0x3f7fbf7d3f7abf763f71bf6b3f64bf5c,0xbf763f5bbf313ef7be76bc973e8dbf04,0xbe903f05bf393f60bf793f80bf763f5c,0x3eedbf4f3f7cbf763f3dbebbbda93f04,0xbf633f17be32be8f3f2dbf6e3f7fbf5c,0x3f47be73bece3f60bf7d3f32bde8bf04,0x3f21bf793f6abef7be193f38bf7e3f5c
.octa 0xbf443f7dbf0abe8f3f68bf6b3e9c3f04,0x3f243e1cbf583f76bed9becd3f74bf5c,0xbef6bf053f80bef7bf043f80bef8bf04,0xbf613f5b3cb0bf603f5b3c97bf603f5c,0x3f74bf17bf133f76bd3cbf6e3f253f04,0xbe99bf4f3f523e8fbf803ebb3f43bf5c,0x3ddb3f79bebabf603f183f38bf48bf04,0x3f7fbe73bf6f3ef73f4ebf32bf1f3f5c
.octa 0xbf7fbe1c3f7a3e8fbf71becd3f643f04,0xbdb63f7d3e5dbf76beae3f6b3eeabf5c,0x3e90bf5bbf393ef73f793c97bf76bf04,0xbf76bf053f313f60be76bf80be8d3f5c,0x3f633f4fbe32bf76bf2d3ebb3f7f3f04,0x3eedbf17bf7cbe8f3f3d3f6e3da9bf5c,0xbf213e733f6a3f603e19bf32bf7ebf04,0x3f473f793ecebef7bf7dbf383de83f5c
.octa 0xbf24bf7dbf58be8f3ed93f6b3f743f04,0xbf44be1c3f0a3f763f683ecdbe9cbf5c,0x3f613f053cb0bef7bf5bbf80bf60bf04,0xbef6bf5bbf80bf60bf04bc973ef83f5c,0x3e993f173f523f763f803f6e3f433f04,0x3f743f4f3f133e8fbd3cbebbbf25bf5c,0xbf7fbf79bf6fbf60bf4ebf38bf1fbf04,0x3ddb3e733eba3ef73f183f323f483f5c
.octa 0x3ed4beb53e96be6d3e2cbdd53d233cc9,0x3f69bf6f3f75bf793f7cbf7f3f80bf80,0x3e6a3cfbbe933f06bf3a3f61bf793f80,0x3f79bf803f75bf5a3f30bef43e703cc9,0x3d0a3ed2bf453f79bf7a3f47bed7bcc9,0x3f80bf693f23be6dbe633f21bf683f80,0xbe263f3abf7f3f5abeb7be923f4fbf80,0x3f7dbf2f3dcf3f06bf6f3f75bf17bcc9
.octa 0xbeb43f6fbf623e6d3f14bf7f3f3c3cc9,0x3f70beb5bef03f79bf513dd53f2ebf80,0xbf073f80bef3bf063f80bef4bf063f80,0x3f5a3cfbbf613f5a3ce2bf613f5a3cc9,0xbf2f3f693dc2bf793f083f21bf70bcc9,0x3f3b3ed2bf7f3e6d3f59bf47beb13f80,0xbf503f2f3f22bf5abed13f753e20bf80,0x3f153f3abf46bf063f6a3e92bf7dbcc9
.octa 0xbf693eb53f75be6dbf7c3dd53f803cc9,0x3ed43f6fbe96bf793e2c3f7fbd23bf80,0xbf79bcfb3f753f06bf30bf613e703f80,0x3e6a3f803e93bf5abf3a3ef43f793cc9,0xbf80bed23f233f793e63bf47bf68bcc9,0x3d0a3f693f45be6dbf7abf213ed73f80,0xbf7dbf3a3dcf3f5a3f6f3e92bf17bf80,0xbe263f2f3f7f3f06beb7bf75bf4fbcc9
.octa 0xbf70bf6fbef03e6d3f513f7f3f2e3cc9,0xbeb43eb53f623f793f14bdd5bf3cbf80,0xbf5abf80bf61bf06bce23ef43f5a3f80,0xbf07bcfb3ef33f5a3f803f613f063cc9,0xbf3bbf69bf7fbf79bf59bf21beb1bcc9,0xbf2fbed2bdc23e6d3f083f473f703f80,0xbf15bf2fbf46bf5abf6abf75bf7dbf80,0xbf50bf3abf22bf06bed1be92be20bcc9
.octa 0xbedf3ec1bea23e82be453e04bd840000,0xbf663f6dbf733f78bf7b3f7ebf7f3f80,0xbf783f80bf773f5dbf343effbe840000,0x3e813bc9be873f01bf363f5ebf773f80,0x3d6f3ec7bf413f78bf7b3f4bbee20000,0x3f80bf6c3f28be82be4b3f1cbf663f80,0x3f7ebf343e003f01bf6d3f77bf1c0000,0x3e0dbf363f7ebf5d3ec23e86bf4b3f80
.octa 0x3ea8bf6d3f65be82bf0f3f7ebf400000,0xbf723ec13ee5bf783f54be04bf293f80,0xbf5dbbc93f5ebf5dbb493f5ebf5e0000,0xbf023f80befebf013f80beffbf003f80,0xbf2a3f6c3d90bf783f0e3f1cbf720000,0x3f3f3ec7bf7f3e823f55bf4bbea53f80,0x3f1a3f36bf4abf013f6c3e86bf7e0000,0x3f4cbf34bf1d3f5d3ec5bf77be073f80
.octa 0x3f66bec1bf733e823f7bbe04bf7f0000,0xbedfbf6d3ea23f78be45bf7e3d843f80,0xbe81bf80be873f5d3f36beffbf770000,0xbf78bbc93f773f01bf34bf5e3e843f80,0xbf80bec73f283f783e4bbf4bbf660000,0x3d6f3f6c3f41be82bf7bbf1c3ee23f80,0xbe0d3f343f7e3f01bec2bf77bf4b0000,0x3f7e3f36be00bf5dbf6dbe863f1c3f80
.octa 0x3f723f6d3ee5be82bf54bf7ebf290000,0x3ea8bec1bf65bf78bf0f3e043f403f80,0x3f023bc9befebf5dbf80bf5ebf000000,0xbf5dbf80bf5ebf01bb493eff3f5e3f80,0xbf3fbf6cbf7fbf78bf55bf1cbea50000,0xbf2abec7bd903e823f0e3f4b3f723f80,0xbf4cbf36bf1dbf01bec5be86be070000,0x3f1a3f343f4a3f5d3f6c3f773f7e3f80
.octa 0xbf533f49bf3e3f33bf273f1abf0c3efc,0xbf113f1fbf2b3f37bf423f4dbf563f5f,0x3f32befa3e7c3c49be8a3f02bf373f5f,0x3f38bf603f78bf803f77bf5c3f33befc,0xbf0b3dee3eabbf373f73bf7d3f54befc,0xbf573f7ebf713f33be9fbe103f10bf5f,0x3ebd3e8cbf4d3f80bf493e7f3ec8bf5f,0x3f6ebf763f193c49bf1e3f78bf6c3efc
.octa 0xbe38bf1f3f80bf33bd9d3f4dbf7b3efc,0xbf7c3f49bd56bf373f7fbf1abe513f5f,0xbc7b3f60bf5cbc493f5fbf5cbc173f5f,0x3f80befabf033f80befbbf023f80befc,0x3e57bf7e3edc3f37bf64be103f7cbefc,0xbf7a3dee3f67bf33bee83f7dbe3fbf5f,0xbecb3f763e13bf803df43f78bec0bf5f,0x3f6b3e8cbf7dbc493f7ebe7fbf6d3efc
.octa 0x3f11bf49bf2b3f333f42bf1abf563efc,0xbf53bf1f3f3e3f37bf27bf4d3f0c3f5f,0xbf383efa3f783c49bf77bf023f333f5f,0x3f323f60be7cbf80be8a3f5c3f37befc,0x3f57bdeebf71bf373e9f3f7d3f10befc,0xbf0bbf7ebeab3f333f733e10bf54bf5f,0xbf6ebe8c3f193f803f1ebe7fbf6cbf5f,0x3ebd3f763f4d3c49bf49bf78bec83efc
.octa 0x3f7c3f1fbd56bf33bf7fbf4dbe513efc,0xbe38bf49bf80bf37bd9d3f1a3f7b3f5f,0xbf80bf60bf03bc493efb3f5c3f803f5f,0xbc7b3efa3f5c3f803f5f3f023c17befc,0x3f7a3f7e3f673f373ee83e10be3fbefc,0x3e57bdeebedcbf33bf64bf7dbf7cbf5f,0xbf6bbf76bf7dbf80bf7ebf78bf6dbf5f,0xbecbbe8cbe13bc493df43e7f3ec03efc
.octa 0xbf7f3f7dbf7a3f76bf713f6bbf643f5c,0xbdb63e1cbe5d3e8fbeae3ecdbeea3f04,0x3e90bf053f39bf603f79bf803f76bf5c,0xbf763f5bbf313ef7be76bc973e8dbf04,0x3f63bf173e323e8fbf2d3f6ebf7f3f5c,0x3eedbf4f3f7cbf763f3dbebbbda93f04,0xbf213f79bf6a3ef73e19bf383f7ebf5c,0x3f47be73bece3f60bf7d3f32bde8bf04
.octa 0xbf24be1c3f58bf763ed93ecdbf743f5c,0xbf443f7dbf0abe8f3f68bf6b3e9c3f04,0x3f61bf5bbcb03f60bf5bbc973f60bf5c,0xbef6bf053f80bef7bf043f80bef8bf04,0x3e993f4fbf52be8f3f80bebbbf433f5c,0x3f74bf17bf133f76bd3cbf6e3f253f04,0xbf7f3e733f6fbef7bf4e3f323f1fbf5c,0x3ddb3f79bebabf603f183f38bf48bf04
.octa 0x3db6bf7dbe5d3f763eaebf6bbeea3f5c,0xbf7fbe1c3f7a3e8fbf71becd3f643f04,0x3f763f05bf31bf603e763f803e8dbf5c,0x3e90bf5bbf393ef73f793c97bf76bf04,0xbeed3f173f7c3e8fbf3dbf6ebda93f5c,0x3f633f4fbe32bf76bf2d3ebb3f7f3f04,0xbf47bf79bece3ef73f7d3f38bde8bf5c,0xbf213e733f6a3f603e19bf32bf7ebf04
.octa 0x3f443e1cbf0abf76bf68becd3e9c3f5c,0xbf24bf7dbf58be8f3ed93f6b3f743f04,0x3ef63f5b3f803f603f043c97bef8bf5c,0x3f613f053cb0bef7bf5bbf80bf60bf04,0xbf74bf4fbf13be8f3d3c3ebb3f253f5c,0x3e993f173f523f763f803f6e3f433f04,0xbddbbe73bebabef7bf18bf32bf48bf5c,0xbf7fbf79bf6fbf60bf4ebf38bf1fbf04
.octa 0xbf693f6fbf753f79bf7c3f7fbf803f80,0x3ed4beb53e96be6d3e2cbdd53d233cc9,0xbf793f80bf753f5abf303ef4be70bcc9,0x3e6a3cfbbe933f06bf3a3f61bf793f80,0xbf803f69bf233e6d3e63bf213f68bf80,0x3d0a3ed2bf453f79bf7a3f47bed7bcc9,0xbf7d3f2fbdcfbf063f6fbf753f173cc9,0xbe263f3abf7f3f5abeb7be923f4fbf80
.octa 0xbf703eb53ef0bf793f51bdd5bf2e3f80,0xbeb43f6fbf623e6d3f14bf7f3f3c3cc9,0xbf5abcfb3f61bf5abce23f61bf5abcc9,0xbf073f80bef3bf063f80bef4bf063f80,0xbf3bbed23f7fbe6dbf593f473eb1bf80,0xbf2f3f693dc2bf793f083f21bf70bcc9,0xbf15bf3a3f463f06bf6abe923f7d3cc9,0xbf503f2f3f22bf5abed13f753e20bf80
.octa 0xbed4bf6f3e963f79be2cbf7f3d233f80,0xbf693eb53f75be6dbf7c3dd53f803cc9,0xbe6abf80be933f5a3f3abef4bf79bcc9,0xbf79bcfb3f753f06bf30bf613e703f80,0xbd0abf69bf453e6d3f7a3f21bed7bf80,0xbf80bed23f233f793e63bf47bf68bcc9,0x3e26bf2fbf7fbf063eb73f753f4f3cc9,0xbf7dbf3a3dcf3f5a3f6f3e92bf17bf80
.octa 0x3eb4beb5bf62bf79bf143dd53f3c3f80,0xbf70bf6fbef03e6d3f513f7f3f2e3cc9,0x3f073cfbbef3bf5abf80bf61bf06bcc9,0xbf5abf80bf61bf06bce23ef43f5a3f80,0x3f2f3ed23dc2be6dbf08bf47bf70bf80,0xbf3bbf69bf7fbf79bf59bf21beb1bcc9,0x3f503f3a3f223f063ed13e923e203cc9,0xbf15bf2fbf46bf5abf6abf75bf7dbf80
.octa 0x3f643f6b3f723f773f7b3f7e3f7f3f80,0xbee9becabeaabe89be4ebe0abd8a8000,0xbe8cbc493e7f3efc3f343f5d3f773f80,0xbf76bf80bf78bf5fbf36bf01be868000,0xbf7fbf6ebf2bbe893e423f1b3f653f80,0x3da3bebebf3fbf77bf7bbf4cbee38000,0xbdeebf33bf7dbf5fbec73e823f4b3f80,0x3f7e3f373e10befcbf6cbf78bf1c8000
.octa 0x3f743ecabedebf77bf56be0a3f283f80,0x3e9e3f6b3f673e89bf0dbf7ebf418000,0x3efa3f803f02befcbf80bf013eff3f80,0xbf60bc493f5c3f5f3bc9bf5dbf5e8000,0xbf433ebe3f803e89bf54bf4c3ea43f80,0xbf26bf6e3d623f773f10bf1bbf738000,0xbf49bf373f1a3f5fbec1bf783e043f80,0x3f1fbf33bf4d3efc3f6dbe82bf7e8000
.octa 0x3ee9bf6bbeaa3f773e4ebf7ebd8a3f80,0x3f643ecabf72be893f7b3e0abf7f8000,0x3f763c49bf783efc3f36bf5dbe863f80,0xbe8c3f80be7fbf5f3f343f01bf778000,0xbda33f6ebf3fbe893f7bbf1bbee33f80,0xbf7f3ebe3f2bbf773e423f4cbf658000,0xbf7e3f333e10bf5f3f6cbe82bf1c3f80,0xbdeebf373f7dbefcbec73f78bf4b8000
.octa 0xbe9ebeca3f67bf773f0d3e0abf413f80,0x3f74bf6b3ede3e89bf563f7ebf288000,0x3f60bf803f5cbefcbbc93f01bf5e3f80,0x3efa3c49bf023f5fbf803f5dbeff8000,0x3f26bebe3d623e89bf103f4cbf733f80,0xbf433f6ebf803f77bf543f1bbea48000,0xbf1f3f37bf4d3f5fbf6d3f78bf7e3f80,0xbf493f33bf1a3efcbec13e82be048000
.octa 0x3f083f163f243f313f3d3f483f523f5c,0xbf59bf4fbf45bf39bf2dbf20bf12bf04,0xbf2fbf5abf75bf80bf79bf60bf38bf04,0x3f3a3f063e923cc9be73bef7bf32bf5c,0x3f503f7d3f753f393eafbde2bf0abf5c,0xbf15be233e983f313f713f7e3f573f04,0xbf69bf79bf21bcc93f173f763f6e3f04,0x3ed2be6dbf47bf80bf4fbe8f3ebb3f5c
.octa 0x3f793f4f3dbcbf31bf80bf203e353f5c,0xbe663f163f7f3f39bd30bf48bf7cbf04,0xbf80bf063ef43f803f05bef7bf80bf04,0x3cfbbf5abf61bcc93f5b3f603c97bf5c,0x3f7c3e23bf63bf393ed83f7e3e5abf5c,0x3e293f7d3eefbf31bf683de23f7a3f04,0xbf6f3e6d3f7f3cc9bf7dbe8f3f6b3f04,0xbeb5bf793dd53f803e1cbf76becd3f5c
.octa 0x3f59bf16bf453f313f2dbf48bf123f5c,0x3f083f4fbf24bf393f3d3f20bf52bf04,0xbf3a3f5a3e92bf803e733f60bf32bf04,0xbf2fbf063f753cc9bf793ef73f38bf5c,0x3f15bf7d3e983f39bf713de23f57bf5c,0x3f503e23bf753f313eafbf7e3f0a3f04,0xbed23f79bf47bcc93f4fbf763ebb3f04,0xbf693e6d3f21bf803f173e8fbf6e3f5c
.octa 0x3e66bf4f3f7fbf313d303f20bf7c3f5c,0x3f79bf16bdbc3f39bf803f48be35bf04,0xbcfb3f06bf613f80bf5b3ef73c97bf04,0xbf803f5abef4bcc93f05bf603f80bf5c,0xbe29be233eefbf393f68bf7e3f7abf5c,0x3f7cbf7d3f63bf313ed8bde2be5a3f04,0x3eb5be6d3dd53cc9be1c3e8fbecd3f04,0xbf6f3f79bf7f3f80bf7d3f76bf6b3f5c
.octa 0x3c973db03e1c3e603e923eb23ed23ef1,0xbf80bf7fbf7dbf7abf75bf70bf69bf62,0x3f7a3f633f3d3f093e983d17be66bef1,0x3e5a3eec3f2d3f583f753f803f793f62,0xbecdbf44bf79bf7abf47bed53cfb3ef1,0x3f6b3f253e73be60bf21bf69bf80bf62,0xbf52be9b3eaf3f583f7f3f3c3e29bef1,0xbf12bf74bf71bf093dbc3f2e3f7c3f62
.octa 0x3f383f7f3f17be60bf61bf70beb53ef1,0xbf323db03f4f3f7a3ef4beb2bf6fbf62,0x3f0abeecbf80bf093eef3f803f08bef1,0x3f573f633d30bf58bf63bd173f593f62,0xbf6ebf253f053f7a3dd5bf69bf2f3ef1,0x3ebbbf44bf5b3e603f7f3ed5bf3abf62,0xbe353f743ed8bf58bf243f2e3f50bef1,0xbf7cbe9b3f683f09bf45bf3c3f153f62
.octa 0x3f80bdb0bf7d3e603f75beb2bf693ef1,0x3c973f7fbe1cbf7a3e923f70bed2bf62,0xbe5abf633f2d3f09bf75bd173f79bef1,0x3f7abeecbf3d3f583e98bf803e663f62,0xbf6b3f443e73bf7a3f213ed5bf803ef1,0xbecdbf253f79be60bf473f69bcfbbf62,0x3f123e9bbf713f58bdbcbf3c3f7cbef1,0xbf523f74beafbf093f7fbf2ebe293f62
.octa 0x3f32bf7f3f4fbe60bef43f70bf6f3ef1,0x3f38bdb0bf173f7abf613eb23eb5bf62,0xbf573eec3d30bf093f63bf803f59bef1,0x3f0abf633f80bf583eef3d17bf083f62,0xbebb3f25bf5b3f7abf7f3f69bf3a3ef1,0xbf6e3f44bf053e603dd5bed53f2fbf62,0x3f7cbf743f68bf583f45bf2e3f15bef1,0xbe353e9bbed83f09bf243f3cbf503f62
.octa 0xbeffbee1bec1bea1be7fbe3bbdeebd49,0xbf5ebf66bf6dbf73bf78bf7cbf7ebf80,0xbea4bd7b3e4e3ee63f2b3f573f743f80,0xbf73bf80bf7bbf65bf3fbf0cbe9ebd49,0xbe043ea73f363f733f7d3f533efa3d49,0xbf7ebf72bf34bea13e103f113f603f80,0x3d8a3f2a3f7b3f653edebe54bf43bf80,0xbf7fbf40be423ee63f673f7a3f263d49
.octa 0x3e863f663f6c3ea1bf02bf7cbf49bd49,0xbf77bee13ec73f733f5c3e3bbf1fbf80,0x3ee33f803f0dbee6bf80bf0c3ee93f80,0xbf65bd7b3f563f653d62bf57bf64bd49,0x3f1c3f72bbc9bf73bf1a3f113f763d49,0xbf4b3ea73f803ea1bf4dbf533e8c3f80,0x3f413f40bf10bf653eaa3f7abda3bf80,0xbf283f2a3f54bee6bf723e543f7f3d49
.octa 0x3f5e3ee1bf6dbea13f783e3bbf7ebd49,0xbeff3f663ec1bf73be7f3f7c3deebf80,0x3f733d7bbf7b3ee63f3fbf57be9e3f80,0xbea43f80be4ebf653f2b3f0cbf74bd49,0x3f7ebea7bf343f73be10bf533f603d49,0xbe043f72bf36bea13f7dbf11befa3f80,0x3f7fbf2abe423f65bf673e543f26bf80,0x3d8a3f40bf7b3ee63edebf7a3f433d49
.octa 0x3f77bf663ec73ea1bf5c3f7cbf1fbd49,0x3e863ee1bf6c3f73bf02be3b3f49bf80,0x3f65bf803f56bee6bd623f0cbf643f80,0x3ee33d7bbf0d3f65bf803f57bee9bd49,0x3f4bbf723f80bf733f4dbf113e8c3d49,0x3f1cbea73bc93ea1bf1a3f53bf763f80,0x3f28bf403f54bf653f72bf7a3f7fbf80,0x3f41bf2a3f10bee63eaabe543da33d49
.octa 0x3ee93eca3eaa3e893e4e3e0a3d8a0000,0x3f643f6b3f723f773f7b3f7e3f7f3f80,0x3f763f803f783f5f3f363f013e860000,0xbe8cbc493e7f3efc3f343f5d3f773f80,0xbda33ebe3f3f3f773f7b3f4c3ee30000,0xbf7fbf6ebf2bbe893e423f1b3f653f80,0xbf7ebf37be103efc3f6c3f783f1c0000,0xbdeebf33bf7dbf5fbec73e823f4b3f80
.octa 0xbe9ebf6bbf67be893f0d3f7e3f410000,0x3f743ecabedebf77bf56be0a3f283f80,0x3f603c49bf5cbf5fbbc93f5d3f5e0000,0x3efa3f803f02befcbf80bf013eff3f80,0x3f263f6ebd62bf77bf103f1b3f730000,0xbf433ebe3f803e89bf54bf4c3ea43f80,0xbf1f3f333f4dbefcbf6d3e823f7e0000,0xbf49bf373f1a3f5fbec1bf783e043f80
.octa 0xbf64beca3f723e89bf7bbe0a3f7f0000,0x3ee9bf6bbeaa3f773e4ebf7ebd8a3f80,0x3e8cbf803e7f3f5fbf34bf013f770000,0x3f763c49bf783efc3f36bf5dbe863f80,0x3f7fbebebf2b3f77be42bf4c3f650000,0xbda33f6ebf3fbe893f7bbf1bbee33f80,0x3dee3f37bf7d3efc3ec7bf783f4b0000,0xbf7e3f333e10bf5f3f6cbe82bf1c3f80
.octa 0xbf743f6bbedebe893f56bf7e3f280000,0xbe9ebeca3f67bf773f0d3e0abf413f80,0xbefabc493f02bf5f3f80bf5d3eff0000,0x3f60bf803f5cbefcbbc93f01bf5e3f80,0x3f43bf6e3f80bf773f54bf1b3ea40000,0x3f26bebe3d623e89bf103f4cbf733f80,0x3f49bf333f1abefc3ec1be823e040000,0xbf1f3f37bf4d3f5fbf6d3f78bf7e3f80
.octa 0x3f593f4f3f453f393f2d3f203f123f04,0x3f083f163f243f313f3d3f483f523f5c,0xbf3abf06be92bcc93e733ef73f323f5c,0xbf2fbf5abf75bf80bf79bf60bf38bf04,0x3f153e23be98bf31bf71bf7ebf57bf04,0x3f503f7d3f753f393eafbde2bf0abf5c,0xbed23e6d3f473f803f4f3e8fbebbbf5c,0xbf69bf79bf21bcc93f173f763f6e3f04
.octa 0x3e66bf16bf7fbf393d303f483f7c3f04,0x3f793f4f3dbcbf31bf80bf203e353f5c,0xbcfb3f5a3f613cc9bf5bbf60bc973f5c,0xbf80bf063ef43f803f05bef7bf80bf04,0xbe29bf7dbeef3f313f68bde2bf7abf04,0x3f7c3e23bf63bf393ed83f7e3e5abf5c,0x3eb53f79bdd5bf80be1c3f763ecdbf5c,0xbf6f3e6d3f7f3cc9bf7dbe8f3f6b3f04
.octa 0xbf08bf4f3f243f39bf3dbf203f523f04,0x3f59bf16bf453f313f2dbf48bf123f5c,0x3f2f3f06bf75bcc93f79bef7bf383f5c,0xbf3a3f5a3e92bf803e733f60bf32bf04,0xbf50be233f75bf31beaf3f7ebf0abf04,0x3f15bf7d3e983f39bf713de23f57bf5c,0x3f69be6dbf213f80bf17be8f3f6ebf5c,0xbed23f79bf47bcc93f4fbf763ebb3f04
.octa 0xbf793f163dbcbf393f80bf483e353f04,0x3e66bf4f3f7fbf313d303f20bf7c3f5c,0x3f80bf5a3ef43cc9bf053f60bf803f5c,0xbcfb3f06bf613f80bf5b3ef73c97bf04,0xbf7c3f7dbf633f31bed83de23e5abf04,0xbe29be233eefbf393f68bf7e3f7abf5c,0x3f6fbf793f7fbf803f7dbf763f6bbf5c,0x3eb5be6d3dd53cc9be1c3e8fbecd3f04
.octa 0x3f803f7f3f7d3f7a3f753f703f693f62,0x3c973db03e1c3e603e923eb23ed23ef1,0xbe5abeecbf2dbf58bf75bf80bf79bf62,0x3f7a3f633f3d3f093e983d17be66bef1,0xbf6bbf25be733e603f213f693f803f62,0xbecdbf44bf79bf7abf47bed53cfb3ef1,0x3f123f743f713f09bdbcbf2ebf7cbf62,0xbf52be9b3eaf3f583f7f3f3c3e29bef1
.octa 0x3f32bdb0bf4fbf7abef43eb23f6f3f62,0x3f383f7f3f17be60bf61bf70beb53ef1,0xbf57bf63bd303f583f633d17bf59bf62,0x3f0abeecbf80bf093eef3f803f08bef1,0xbebb3f443f5bbe60bf7fbed53f3a3f62,0xbf6ebf253f053f7a3dd5bf69bf2f3ef1,0x3f7c3e9bbf68bf093f453f3cbf15bf62,0xbe353f743ed8bf58bf243f2e3f50bef1
.octa 0xbc97bf7f3e1c3f7abe92bf703ed23f62,0x3f80bdb0bf7d3e603f75beb2bf693ef1,0xbf7a3eec3f3dbf58be983f80be66bf62,0xbe5abf633f2d3f09bf75bd173f79bef1,0x3ecd3f25bf793e603f47bf693cfb3f62,0xbf6b3f443e73bf7a3f213ed5bf803ef1,0x3f52bf743eaf3f09bf7f3f2e3e29bf62,0x3f123e9bbf713f58bdbcbf3c3f7cbef1
.octa 0xbf383db03f17bf7a3f61beb2beb53f62,0x3f32bf7f3f4fbe60bef43f70bf6f3ef1,0xbf0a3f63bf803f58beefbd173f08bf62,0xbf573eec3d30bf093f63bf803f59bef1,0x3f6ebf443f05be60bdd53ed5bf2f3f62,0xbebb3f25bf5b3f7abf7f3f69bf3a3ef1,0x3e35be9b3ed8bf093f24bf3c3f50bf62,0x3f7cbf743f68bf583f45bf2e3f15bef1
.octa 0x3f5e3f663f6d3f733f783f7c3f7e3f80,0xbeffbee1bec1bea1be7fbe3bbdeebd49,0x3f733f803f7b3f653f3f3f0c3e9e3d49,0xbea4bd7b3e4e3ee63f2b3f573f743f80,0x3f7e3f723f343ea1be10bf11bf60bf80,0xbe043ea73f363f733f7d3f533efa3d49,0x3f7f3f403e42bee6bf67bf7abf26bd49,0x3d8a3f2a3f7b3f653edebe54bf43bf80
.octa 0x3f773ee1bec7bf73bf5cbe3b3f1f3f80,0x3e863f663f6c3ea1bf02bf7cbf49bd49,0x3f653d7bbf56bf65bd623f573f643d49,0x3ee33f803f0dbee6bf80bf0c3ee93f80,0x3f4bbea7bf80bea13f4d3f53be8cbf80,0x3f1c3f72bbc9bf73bf1a3f113f763d49,0x3f28bf2abf543ee63f72be54bf7fbd49,0x3f413f40bf10bf653eaa3f7abda3bf80
.octa 0x3effbf66bec13f733e7fbf7cbdee3f80,0x3f5e3ee1bf6dbea13f783e3bbf7ebd49,0x3ea4bf803e4e3f65bf2bbf0c3f743d49,0x3f733d7bbf7b3ee63f3fbf57be9e3f80,0x3e04bf723f363ea1bf7d3f113efabf80,0x3f7ebea7bf343f73be10bf533f603d49,0xbd8abf403f7bbee6bede3f7abf43bd49,0x3f7fbf2abe423f65bf673e543f26bf80
.octa 0xbe86bee13f6cbf733f023e3bbf493f80,0x3f77bf663ec73ea1bf5c3f7cbf1fbd49,0xbee3bd7b3f0dbf653f80bf573ee93d49,0x3f65bf803f56bee6bd623f0cbf643f80,0xbf1c3ea7bbc9bea13f1abf533f76bf80,0x3f4bbf723f80bf733f4dbf113e8c3d49,0xbf413f2abf103ee6beaa3e54bda3bd49,0x3f28bf403f54bf653f72bf7a3f7fbf80
.octa 0xbf643f6bbf723f77bf7b3f7ebf7f3f80,0x3ee9beca3eaabe893e4ebe0a3d8a8000,0x3e8cbc49be7f3efcbf343f5dbf773f80,0x3f76bf803f78bf5f3f36bf013e868000,0x3f7fbf6e3f2bbe89be423f1bbf653f80,0xbda3bebe3f3fbf773f7bbf4c3ee38000,0x3deebf333f7dbf5f3ec73e82bf4b3f80,0xbf7e3f37be10befc3f6cbf783f1c8000
.octa 0xbf743eca3edebf773f56be0abf283f80,0xbe9e3f6bbf673e893f0dbf7e3f418000,0xbefa3f80bf02befc3f80bf01beff3f80,0x3f60bc49bf5c3f5fbbc9bf5d3f5e8000,0x3f433ebebf803e893f54bf4cbea43f80,0x3f26bf6ebd623f77bf10bf1b3f738000,0x3f49bf37bf1a3f5f3ec1bf78be043f80,0xbf1fbf333f4d3efcbf6dbe823f7e8000
.octa 0xbee9bf6b3eaa3f77be4ebf7e3d8a3f80,0xbf643eca3f72be89bf7b3e0a3f7f8000,0xbf763c493f783efcbf36bf5d3e863f80,0x3e8c3f803e7fbf5fbf343f013f778000,0x3da33f6e3f3fbe89bf7bbf1b3ee33f80,0x3f7f3ebebf2bbf77be423f4c3f658000,0x3f7e3f33be10bf5fbf6cbe823f1c3f80,0x3deebf37bf7dbefc3ec73f783f4b8000
.octa 0x3e9ebecabf67bf77bf0d3e0a3f413f80,0xbf74bf6bbede3e893f563f7e3f288000,0xbf60bf80bf5cbefc3bc93f013f5e3f80,0xbefa3c493f023f5f3f803f5d3eff8000,0xbf26bebebd623e893f103f4c3f733f80,0x3f433f6e3f803f773f543f1b3ea48000,0x3f1f3f373f4d3f5f3f6d3f783f7e3f80,0x3f493f333f1a3efc3ec13e823e048000
.octa 0xbf083f16bf243f31bf3d3f48bf523f5c,0x3f59bf4f3f45bf393f2dbf203f12bf04,0x3f2fbf5a3f75bf803f79bf603f38bf04,0xbf3a3f06be923cc93e73bef73f32bf5c,0xbf503f7dbf753f39beafbde23f0abf5c,0x3f15be23be983f31bf713f7ebf573f04,0x3f69bf793f21bcc9bf173f76bf6e3f04,0xbed2be6d3f47bf803f4fbe8fbebb3f5c
.octa 0xbf793f4fbdbcbf313f80bf20be353f5c,0x3e663f16bf7f3f393d30bf483f7cbf04,0x3f80bf06bef43f80bf05bef73f80bf04,0xbcfbbf5a3f61bcc9bf5b3f60bc97bf5c,0xbf7c3e233f63bf39bed83f7ebe5abf5c,0xbe293f7dbeefbf313f683de2bf7a3f04,0x3f6f3e6dbf7f3cc93f7dbe8fbf6b3f04,0x3eb5bf79bdd53f80be1cbf763ecd3f5c
.octa 0xbf59bf163f453f31bf2dbf483f123f5c,0xbf083f4f3f24bf39bf3d3f203f52bf04,0x3f3a3f5abe92bf80be733f603f32bf04,0x3f2fbf06bf753cc93f793ef7bf38bf5c,0xbf15bf7dbe983f393f713de2bf57bf5c,0xbf503e233f753f31beafbf7ebf0a3f04,0x3ed23f793f47bcc9bf4fbf76bebb3f04,0x3f693e6dbf21bf80bf173e8f3f6e3f5c
.octa 0xbe66bf4fbf7fbf31bd303f203f7c3f5c,0xbf79bf163dbc3f393f803f483e35bf04,0x3cfb3f063f613f803f5b3ef7bc97bf04,0x3f803f5a3ef4bcc9bf05bf60bf80bf5c,0x3e29be23beefbf39bf68bf7ebf7abf5c,0xbf7cbf7dbf63bf31bed8bde23e5a3f04,0xbeb5be6dbdd53cc93e1c3e8f3ecd3f04,0x3f6f3f793f7f3f803f7d3f763f6b3f5c
.octa 0xbc973db0be1c3e60be923eb2bed23ef1,0x3f80bf7f3f7dbf7a3f75bf703f69bf62,0xbf7a3f63bf3d3f09be983d173e66bef1,0xbe5a3eecbf2d3f58bf753f80bf793f62,0x3ecdbf443f79bf7a3f47bed5bcfb3ef1,0xbf6b3f25be73be603f21bf693f80bf62,0x3f52be9bbeaf3f58bf7f3f3cbe29bef1,0x3f12bf743f71bf09bdbc3f2ebf7c3f62
.octa 0xbf383f7fbf17be603f61bf703eb53ef1,0x3f323db0bf4f3f7abef4beb23f6fbf62,0xbf0abeec3f80bf09beef3f80bf08bef1,0xbf573f63bd30bf583f63bd17bf593f62,0x3f6ebf25bf053f7abdd5bf693f2f3ef1,0xbebbbf443f5b3e60bf7f3ed53f3abf62,0x3e353f74bed8bf583f243f2ebf50bef1,0x3f7cbe9bbf683f093f45bf3cbf153f62
.octa 0xbf80bdb03f7d3e60bf75beb23f693ef1,0xbc973f7f3e1cbf7abe923f703ed2bf62,0x3e5abf63bf2d3f093f75bd17bf79bef1,0xbf7abeec3f3d3f58be98bf80be663f62,0x3f6b3f44be73bf7abf213ed53f803ef1,0x3ecdbf25bf79be603f473f693cfbbf62,0xbf123e9b3f713f583dbcbf3cbf7cbef1,0x3f523f743eafbf09bf7fbf2e3e293f62
.octa 0xbf32bf7fbf4fbe603ef43f703f6f3ef1,0xbf38bdb03f173f7a3f613eb2beb5bf62,0x3f573eecbd30bf09bf63bf80bf59bef1,0xbf0abf63bf80bf58beef3d173f083f62,0x3ebb3f253f5b3f7a3f7f3f693f3a3ef1,0x3f6e3f443f053e60bdd5bed5bf2fbf62,0xbf7cbf74bf68bf58bf45bf2ebf15bef1,0x3e353e9b3ed83f093f243f3c3f503f62
.octa 0x3effbee13ec1bea13e7fbe3b3deebd49,0x3f5ebf663f6dbf733f78bf7c3f7ebf80,0x3ea4bd7bbe4e3ee6bf2b3f57bf743f80,0x3f73bf803f7bbf653f3fbf0c3e9ebd49,0x3e043ea7bf363f73bf7d3f53befa3d49,0x3f7ebf723f34bea1be103f11bf603f80,0xbd8a3f2abf7b3f65bedebe543f43bf80,0x3f7fbf403e423ee6bf673f7abf263d49
.octa 0xbe863f66bf6c3ea13f02bf7c3f49bd49,0x3f77bee1bec73f73bf5c3e3b3f1fbf80,0xbee33f80bf0dbee63f80bf0cbee93f80,0x3f65bd7bbf563f65bd62bf573f64bd49,0xbf1c3f723bc9bf733f1a3f11bf763d49,0x3f4b3ea7bf803ea13f4dbf53be8c3f80,0xbf413f403f10bf65beaa3f7a3da3bf80,0x3f283f2abf54bee63f723e54bf7f3d49
.octa 0xbf5e3ee13f6dbea1bf783e3b3f7ebd49,0x3eff3f66bec1bf733e7f3f7cbdeebf80,0xbf733d7b3f7b3ee6bf3fbf573e9e3f80,0x3ea43f803e4ebf65bf2b3f0c3f74bd49,0xbf7ebea73f343f733e10bf53bf603d49,0x3e043f723f36bea1bf7dbf113efa3f80,0xbf7fbf2a3e423f653f673e54bf26bf80,0xbd8a3f403f7b3ee6bedebf7abf433d49
.octa 0xbf77bf66bec73ea13f5c3f7c3f1fbd49,0xbe863ee13f6c3f733f02be3bbf49bf80,0xbf65bf80bf56bee63d623f0c3f643f80,0xbee33d7b3f0d3f653f803f573ee9bd49,0xbf4bbf72bf80bf73bf4dbf11be8c3d49,0xbf1cbea7bbc93ea13f1a3f533f763f80,0xbf28bf40bf54bf65bf72bf7abf7fbf80,0xbf41bf2abf10bee6beaabe54bda33d49
.octa 0xbee93ecabeaa3e89be4e3e0abd8a0000,0xbf643f6bbf723f77bf7b3f7ebf7f3f80,0xbf763f80bf783f5fbf363f01be860000,0x3e8cbc49be7f3efcbf343f5dbf773f80,0x3da33ebebf3f3f77bf7b3f4cbee30000,0x3f7fbf6e3f2bbe89be423f1bbf653f80,0x3f7ebf373e103efcbf6c3f78bf1c0000,0x3deebf333f7dbf5f3ec73e82bf4b3f80
.octa 0x3e9ebf6b3f67be89bf0d3f7ebf410000,0xbf743eca3edebf773f56be0abf283f80,0xbf603c493f5cbf5f3bc93f5dbf5e0000,0xbefa3f80bf02befc3f80bf01beff3f80,0xbf263f6e3d62bf773f103f1bbf730000,0x3f433ebebf803e893f54bf4cbea43f80,0x3f1f3f33bf4dbefc3f6d3e82bf7e0000,0x3f49bf37bf1a3f5f3ec1bf78be043f80
.octa 0x3f64becabf723e893f7bbe0abf7f0000,0xbee9bf6b3eaa3f77be4ebf7e3d8a3f80,0xbe8cbf80be7f3f5f3f34bf01bf770000,0xbf763c493f783efcbf36bf5d3e863f80,0xbf7fbebe3f2b3f773e42bf4cbf650000,0x3da33f6e3f3fbe89bf7bbf1b3ee33f80,0xbdee3f373f7d3efcbec7bf78bf4b0000,0x3f7e3f33be10bf5fbf6cbe823f1c3f80
.octa 0x3f743f6b3edebe89bf56bf7ebf280000,0x3e9ebecabf67bf77bf0d3e0a3f413f80,0x3efabc49bf02bf5fbf80bf5dbeff0000,0xbf60bf80bf5cbefc3bc93f013f5e3f80,0xbf43bf6ebf80bf77bf54bf1bbea40000,0xbf26bebebd623e893f103f4c3f733f80,0xbf49bf33bf1abefcbec1be82be040000,0x3f1f3f373f4d3f5f3f6d3f783f7e3f80
.octa 0xbf593f4fbf453f39bf2d3f20bf123f04,0xbf083f16bf243f31bf3d3f48bf523f5c,0x3f3abf063e92bcc9be733ef7bf323f5c,0x3f2fbf5a3f75bf803f79bf603f38bf04,0xbf153e233e98bf313f71bf7e3f57bf04,0xbf503f7dbf753f39beafbde23f0abf5c,0x3ed23e6dbf473f80bf4f3e8f3ebbbf5c,0x3f69bf793f21bcc9bf173f76bf6e3f04
.octa 0xbe66bf163f7fbf39bd303f48bf7c3f04,0xbf793f4fbdbcbf313f80bf20be353f5c,0x3cfb3f5abf613cc93f5bbf603c973f5c,0x3f80bf06bef43f80bf05bef73f80bf04,0x3e29bf7d3eef3f31bf68bde23f7abf04,0xbf7c3e233f63bf39bed83f7ebe5abf5c,0xbeb53f793dd5bf803e1c3f76becdbf5c,0x3f6f3e6dbf7f3cc93f7dbe8fbf6b3f04
.octa 0x3f08bf4fbf243f393f3dbf20bf523f04,0xbf59bf163f453f31bf2dbf483f123f5c,0xbf2f3f063f75bcc9bf79bef73f383f5c,0x3f3a3f5abe92bf80be733f603f32bf04,0x3f50be23bf75bf313eaf3f7e3f0abf04,0xbf15bf7dbe983f393f713de2bf57bf5c,0xbf69be6d3f213f803f17be8fbf6ebf5c,0x3ed23f793f47bcc9bf4fbf76bebb3f04
.octa 0x3f793f16bdbcbf39bf80bf48be353f04,0xbe66bf4fbf7fbf31bd303f203f7c3f5c,0xbf80bf5abef43cc93f053f603f803f5c,0x3cfb3f063f613f803f5b3ef7bc97bf04,0x3f7c3f7d3f633f313ed83de2be5abf04,0x3e29be23beefbf39bf68bf7ebf7abf5c,0xbf6fbf79bf7fbf80bf7dbf76bf6bbf5c,0xbeb5be6dbdd53cc93e1c3e8f3ecd3f04
.octa 0xbf803f7fbf7d3f7abf753f70bf693f62,0xbc973db0be1c3e60be923eb2bed23ef1,0x3e5abeec3f2dbf583f75bf803f79bf62,0xbf7a3f63bf3d3f09be983d173e66bef1,0x3f6bbf253e733e60bf213f69bf803f62,0x3ecdbf443f79bf7a3f47bed5bcfb3ef1,0xbf123f74bf713f093dbcbf2e3f7cbf62,0x3f52be9bbeaf3f58bf7f3f3cbe29bef1
.octa 0xbf32bdb03f4fbf7a3ef43eb2bf6f3f62,0xbf383f7fbf17be603f61bf703eb53ef1,0x3f57bf633d303f58bf633d173f59bf62,0xbf0abeec3f80bf09beef3f80bf08bef1,0x3ebb3f44bf5bbe603f7fbed5bf3a3f62,0x3f6ebf25bf053f7abdd5bf693f2f3ef1,0xbf7c3e9b3f68bf09bf453f3c3f15bf62,0x3e353f74bed8bf583f243f2ebf50bef1
.octa 0x3c97bf7fbe1c3f7a3e92bf70bed23f62,0xbf80bdb03f7d3e60bf75beb23f693ef1,0x3f7a3eecbf3dbf583e983f803e66bf62,0x3e5abf63bf2d3f093f75bd17bf79bef1,0xbecd3f253f793e60bf47bf69bcfb3f62,0x3f6b3f44be73bf7abf213ed53f803ef1,0xbf52bf74beaf3f093f7f3f2ebe29bf62,0xbf123e9b3f713f583dbcbf3cbf7cbef1
.octa 0x3f383db0bf17bf7abf61beb23eb53f62,0xbf32bf7fbf4fbe603ef43f703f6f3ef1,0x3f0a3f633f803f583eefbd17bf08bf62,0x3f573eecbd30bf09bf63bf80bf59bef1,0xbf6ebf44bf05be603dd53ed53f2f3f62,0x3ebb3f253f5b3f7a3f7f3f693f3a3ef1,0xbe35be9bbed8bf09bf24bf3cbf50bf62,0xbf7cbf74bf68bf58bf45bf2ebf15bef1
.octa 0xbf5e3f66bf6d3f73bf783f7cbf7e3f80,0x3effbee13ec1bea13e7fbe3b3deebd49,0xbf733f80bf7b3f65bf3f3f0cbe9e3d49,0x3ea4bd7bbe4e3ee6bf2b3f57bf743f80,0xbf7e3f72bf343ea13e10bf113f60bf80,0x3e043ea7bf363f73bf7d3f53befa3d49,0xbf7f3f40be42bee63f67bf7a3f26bd49,0xbd8a3f2abf7b3f65bedebe543f43bf80
.octa 0xbf773ee13ec7bf733f5cbe3bbf1f3f80,0xbe863f66bf6c3ea13f02bf7c3f49bd49,0xbf653d7b3f56bf653d623f57bf643d49,0xbee33f80bf0dbee63f80bf0cbee93f80,0xbf4bbea73f80bea1bf4d3f533e8cbf80,0xbf1c3f723bc9bf733f1a3f11bf763d49,0xbf28bf2a3f543ee6bf72be543f7fbd49,0xbf413f403f10bf65beaa3f7a3da3bf80
.octa 0xbeffbf663ec13f73be7fbf7c3dee3f80,0xbf5e3ee13f6dbea1bf783e3b3f7ebd49,0xbea4bf80be4e3f653f2bbf0cbf743d49,0xbf733d7b3f7b3ee6bf3fbf573e9e3f80,0xbe04bf72bf363ea13f7d3f11befabf80,0xbf7ebea73f343f733e10bf53bf603d49,0x3d8abf40bf7bbee63ede3f7a3f43bd49,0xbf7fbf2a3e423f653f673e54bf26bf80
.octa 0x3e86bee1bf6cbf73bf023e3b3f493f80,0xbf77bf66bec73ea13f5c3f7c3f1fbd49,0x3ee3bd7bbf0dbf65bf80bf57bee93d49,0xbf65bf80bf56bee63d623f0c3f643f80,0x3f1c3ea73bc9bea1bf1abf53bf76bf80,0xbf4bbf72bf80bf73bf4dbf11be8c3d49,0x3f413f2a3f103ee63eaa3e543da3bd49,0xbf28bf40bf54bf65bf72bf7abf7fbf80
.octa 0x3f613f693f703f763f7a3f7d3f7f3f80,0xbef3bed2beb1be8fbe57be10bd908000,0xbe96bcfb3e703ef73f323f5c3f773f80,0xbf75bf80bf79bf60bf38bf02be878000,0xbf7fbf6fbf2ebe8f3e383f1a3f653f80,0x3dcfbeb5bf3cbf76bf7cbf4dbee58000,0xbdc2bf2fbf7dbf60becb3e7f3f4a3f80,0x3f7f3f3a3e20bef7bf6bbf78bf1d8000
.octa 0x3f753ed2bed7bf76bf57be103f283f80,0x3e933f693f683e8fbf0bbf7dbf418000,0x3ef03f803f06bef7bf80bf023efe3f80,0xbf62bcfb3f5a3f603c7bbf5cbf5e8000,0xbf463eb53f803e8fbf53bf4d3ea23f80,0xbf22bf6f3d233f763f11bf1abf738000,0xbf45bf3a3f173f60bebdbf783e003f80,0x3f23bf2fbf4f3ef73f6ebe7fbf7e8000
.octa 0x3ef3bf69beb13f763e57bf7dbd903f80,0x3f613ed2bf70be8f3f7a3e10bf7f8000,0x3f753cfbbf793ef73f38bf5cbe873f80,0xbe963f80be70bf603f323f02bf778000,0xbdcf3f6fbf3cbe8f3f7cbf1abee53f80,0xbf7f3eb53f2ebf763e383f4dbf658000,0xbf7f3f2f3e20bf603f6bbe7fbf1d3f80,0xbdc2bf3a3f7dbef7becb3f78bf4a8000
.octa 0xbe93bed23f68bf763f0b3e10bf413f80,0x3f75bf693ed73e8fbf573f7dbf288000,0x3f62bf803f5abef7bc7b3f02bf5e3f80,0x3ef03cfbbf063f60bf803f5cbefe8000,0x3f22beb53d233e8fbf113f4dbf733f80,0xbf463f6fbf803f76bf533f1abea28000,0xbf233f3abf4f3f60bf6e3f78bf7e3f80,0xbf453f2fbf173ef7bebd3e7fbe008000
.octa 0x3efb3f0d3f1c3f2a3f373f433f4e3f58,0xbf5fbf56bf4bbf40bf33bf26bf18bf09,0xbf27bf54bf72bf80bf7bbf64bf3dbf09,0x3f423f103ea53d7bbe51bee9bf2dbf58,0x3f493f7b3f773f403ec0bda3bf04bf58,0xbf1ebe4e3e843f2a3f6d3f7f3f5b3f09,0xbf64bf7bbf29bd7b3f103f743f713f09,0x3ee8be42bf40bf80bf54be9e3eae3f58
.octa 0x3f773f563e07bf2abf80bf263e193f58,0xbe8a3f0d3f7e3f40bc17bf43bf7dbf09,0xbf7fbf103ee23f803f0cbee9bf80bf09,0x3d9dbf54bf66bd7b3f563f643d3cbf58,0x3f7e3e4ebf5ebf403ec83f7f3e76bf58,0x3df43f7b3f00bf2abf6c3da33f793f09,0xbf733e423f7f3d7bbf7cbe9e3f683f09,0xbe9fbf7b3d843f803e3fbf74bed93f58
.octa 0x3f5fbf0dbf4b3f2a3f33bf43bf183f58,0x3efb3f56bf1cbf403f373f26bf4ebf09,0xbf423f543ea5bf803e513f64bf2dbf09,0xbf27bf103f723d7bbf7b3ee93f3dbf58,0x3f1ebf7b3e843f40bf6d3da33f5bbf58,0x3f493e4ebf773f2a3ec0bf7f3f043f09,0xbee83f7bbf40bd7b3f54bf743eae3f09,0xbf643e423f29bf803f103e9ebf713f58
.octa 0x3e8abf563f7ebf2a3c173f26bf7d3f58,0x3f77bf0dbe073f40bf803f43be19bf09,0xbd9d3f10bf663f80bf563ee93d3cbf09,0xbf7f3f54bee2bd7b3f0cbf643f80bf58,0xbdf4be4e3f00bf403f6cbf7f3f79bf58,0x3f7ebf7b3f5ebf2a3ec8bda3be763f09,0x3e9fbe423d843d7bbe3f3e9ebed93f09,0xbf733f7bbf7f3f80bf7c3f74bf683f58
.octa 0xbd563c973db63e233e6a3e983eba3edb,0xbf80bf80bf7fbf7dbf79bf75bf6fbf67,0x3f7d3f6b3f473f163eb43dbcbe32bedb,0x3e133ecd3f213f4f3f703f7f3f7c3f67,0xbeabbf38bf74bf7dbf50beefbcb03edb,0x3f713f323e99be23bf15bf63bf80bf67,0xbf5cbebb3e903f4f3f803f453e5dbedb,0xbf03bf6ebf76bf163d0a3f243f7a3f67
.octa 0x3f2b3f803f24be23bf5abf75bece3edb,0xbf3e3c973f443f7d3f07be98bf6abf67,0x3f19becdbf7fbf163ed43f7f3f13bedb,0x3f4d3f6b3ddbbf4fbf69bdbc3f523f67,0xbf67bf323eed3f7d3e26bf63bf393edb,0x3edcbf38bf633e233f7d3eefbf31bf67,0xbe7c3f6e3ef6bf4fbf2f3f243f58bedb,0xbf78bebb3f613f16bf3bbf453f0a3f67
.octa 0x3f80bc97bf7f3e233f79be98bf6f3edb,0xbd563f80bdb6bf7d3e6a3f75bebabf67,0xbe13bf6b3f213f16bf70bdbc3f7cbedb,0x3f7dbecdbf473f4f3eb4bf7f3e323f67,0xbf713f383e99bf7d3f153eefbf803edb,0xbeabbf323f74be23bf503f633cb0bf67,0x3f033ebbbf763f4fbd0abf453f7abedb,0xbf5c3f6ebe90bf163f80bf24be5d3f67
.octa 0x3f3ebf803f44be23bf073f75bf6a3edb,0x3f2bbc97bf243f7dbf5a3e983ecebf67,0xbf4d3ecd3ddbbf163f69bf7f3f52bedb,0x3f19bf6b3f7fbf4f3ed43dbcbf133f67,0xbedc3f32bf633f7dbf7d3f63bf313edb,0xbf673f38beed3e233e26beef3f39bf67,0x3f78bf6e3f61bf4f3f3bbf243f0abedb,0xbe7c3ebbbef63f16bf2f3f45bf583f67
.octa 0xbf14bf05beeabecabea8be86be45bdfb,0xbf51bf5bbf64bf6bbf72bf77bf7bbf7e,0xbed1be1c3de83ebe3f1a3f4b3f6d3f7e,0xbf6abf7dbf7ebf6ebf4cbf1cbec2bdfb,0xbe633e733f253f6b3f803f5e3f0e3dfb,0xbf7abf79bf43beca3d6f3eff3f553f7e,0xbce23f173f763f6e3f02be04bf36bf7e,0xbf80bf4fbe8d3ebe3f5d3f7e3f343dfb
.octa 0x3e2c3f5b3f743ecabedfbf77bf54bdfb,0xbf7cbf053e9c3f6b3f663e86bf0fbf7e,0x3eb73f7d3f1fbebebf7ebf1c3ec53f7e,0xbf6fbe1c3f483f6e3e0dbf4bbf6cbdfb,0x3f083f793da9bf6bbf2a3eff3f7b3dfb,0xbf593e733f7f3ecabf3fbf5e3e4b3f7e,0x3f303f4fbef8bf6e3e813f7ebb49bf7e,0xbf3a3f173f60bebebf783e043f803dfb
.octa 0x3f513f05bf64beca3f723e86bf7bbdfb,0xbf143f5b3eeabf6bbea83f773e45bf7e,0x3f6a3e1cbf7e3ebe3f4cbf4bbec23f7e,0xbed13f7dbde8bf6e3f1a3f1cbf6dbdfb,0x3f7abe73bf433f6bbd6fbf5e3f553dfb,0xbe633f79bf25beca3f80beffbf0e3f7e,0x3f80bf17be8d3f6ebf5d3e043f34bf7e,0xbce23f4fbf763ebe3f02bf7e3f363dfb
.octa 0x3f7cbf5b3e9c3ecabf663f77bf0fbdfb,0x3e2c3f05bf743f6bbedfbe863f54bf7e,0x3f6fbf7d3f48bebebe0d3f1cbf6c3f7e,0x3eb73e1cbf1f3f6ebf7e3f4bbec5bdfb,0x3f59bf793f7fbf6b3f3fbeff3e4b3dfb,0x3f08be73bda93ecabf2a3f5ebf7b3f7e,0x3f3abf4f3f60bf6e3f78bf7e3f80bf7e,0x3f30bf173ef8bebe3e81be043b493dfb
.octa 0x3ef33ed23eb13e8f3e573e103d900000,0x3f613f693f703f763f7a3f7d3f7f3f80,0x3f753f803f793f603f383f023e870000,0xbe96bcfb3e703ef73f323f5c3f773f80,0xbdcf3eb53f3c3f763f7c3f4d3ee50000,0xbf7fbf6fbf2ebe8f3e383f1a3f653f80,0xbf7fbf3abe203ef73f6b3f783f1d0000,0xbdc2bf2fbf7dbf60becb3e7f3f4a3f80
.octa 0xbe93bf69bf68be8f3f0b3f7d3f410000,0x3f753ed2bed7bf76bf57be103f283f80,0x3f623cfbbf5abf60bc7b3f5c3f5e0000,0x3ef03f803f06bef7bf80bf023efe3f80,0x3f223f6fbd23bf76bf113f1a3f730000,0xbf463eb53f803e8fbf53bf4d3ea23f80,0xbf233f2f3f4fbef7bf6e3e7f3f7e0000,0xbf45bf3a3f173f60bebdbf783e003f80
.octa 0xbf61bed23f703e8fbf7abe103f7f0000,0x3ef3bf69beb13f763e57bf7dbd903f80,0x3e96bf803e703f60bf32bf023f770000,0x3f753cfbbf793ef73f38bf5cbe873f80,0x3f7fbeb5bf2e3f76be38bf4d3f650000,0xbdcf3f6fbf3cbe8f3f7cbf1abee53f80,0x3dc23f3abf7d3ef73ecbbf783f4a0000,0xbf7f3f2f3e20bf603f6bbe7fbf1d3f80
.octa 0xbf753f69bed7be8f3f57bf7d3f280000,0xbe93bed23f68bf763f0b3e10bf413f80,0xbef0bcfb3f06bf603f80bf5c3efe0000,0x3f62bf803f5abef7bc7b3f02bf5e3f80,0x3f46bf6f3f80bf763f53bf1a3ea20000,0x3f22beb53d233e8fbf113f4dbf733f80,0x3f45bf2f3f17bef73ebdbe7f3e000000,0xbf233f3abf4f3f60bf6e3f78bf7e3f80
.octa 0x3f5f3f563f4b3f403f333f263f183f09,0x3efb3f0d3f1c3f2a3f373f433f4e3f58,0xbf42bf10bea5bd7b3e513ee93f2d3f58,0xbf27bf54bf72bf80bf7bbf64bf3dbf09,0x3f1e3e4ebe84bf2abf6dbf7fbf5bbf09,0x3f493f7b3f773f403ec0bda3bf04bf58,0xbee83e423f403f803f543e9ebeaebf58,0xbf64bf7bbf29bd7b3f103f743f713f09
.octa 0x3e8abf0dbf7ebf403c173f433f7d3f09,0x3f773f563e07bf2abf80bf263e193f58,0xbd9d3f543f663d7bbf56bf64bd3c3f58,0xbf7fbf103ee23f803f0cbee9bf80bf09,0xbdf4bf7bbf003f2a3f6cbda3bf79bf09,0x3f7e3e4ebf5ebf403ec83f7f3e76bf58,0x3e9f3f7bbd84bf80be3f3f743ed9bf58,0xbf733e423f7f3d7bbf7cbe9e3f683f09
.octa 0xbefbbf563f1c3f40bf37bf263f4e3f09,0x3f5fbf0dbf4b3f2a3f33bf43bf183f58,0x3f273f10bf72bd7b3f7bbee9bf3d3f58,0xbf423f543ea5bf803e513f64bf2dbf09,0xbf49be4e3f77bf2abec03f7fbf04bf09,0x3f1ebf7b3e843f40bf6d3da33f5bbf58,0x3f64be42bf293f80bf10be9e3f71bf58,0xbee83f7bbf40bd7b3f54bf743eae3f09
.octa 0xbf773f0d3e07bf403f80bf433e193f09,0x3e8abf563f7ebf2a3c173f26bf7d3f58,0x3f7fbf543ee23d7bbf0c3f64bf803f58,0xbd9d3f10bf663f80bf563ee93d3cbf09,0xbf7e3f7bbf5e3f2abec83da33e76bf09,0xbdf4be4e3f00bf403f6cbf7f3f79bf58,0x3f73bf7b3f7fbf803f7cbf743f68bf58,0x3e9fbe423d843d7bbe3f3e9ebed93f09
.octa 0x3f803f803f7f3f7d3f793f753f6f3f67,0xbd563c973db63e233e6a3e983eba3edb,0xbe13becdbf21bf4fbf70bf7fbf7cbf67,0x3f7d3f6b3f473f163eb43dbcbe32bedb,0xbf71bf32be993e233f153f633f803f67,0xbeabbf38bf74bf7dbf50beefbcb03edb,0x3f033f6e3f763f16bd0abf24bf7abf67,0xbf5cbebb3e903f4f3f803f453e5dbedb
.octa 0x3f3ebc97bf44bf7dbf073e983f6a3f67,0x3f2b3f803f24be23bf5abf75bece3edb,0xbf4dbf6bbddb3f4f3f693dbcbf52bf67,0x3f19becdbf7fbf163ed43f7f3f13bedb,0xbedc3f383f63be23bf7dbeef3f313f67,0xbf67bf323eed3f7d3e26bf63bf393edb,0x3f783ebbbf61bf163f3b3f45bf0abf67,0xbe7c3f6e3ef6bf4fbf2f3f243f58bedb
.octa 0x3d56bf803db63f7dbe6abf753eba3f67,0x3f80bc97bf7f3e233f79be98bf6f3edb,0xbf7d3ecd3f47bf4fbeb43f7fbe32bf67,0xbe13bf6b3f213f16bf70bdbc3f7cbedb,0x3eab3f32bf743e233f50bf63bcb03f67,0xbf713f383e99bf7d3f153eefbf803edb,0x3f5cbf6e3e903f16bf803f243e5dbf67,0x3f033ebbbf763f4fbd0abf453f7abedb
.octa 0xbf2b3c973f24bf7d3f5abe98bece3f67,0x3f3ebf803f44be23bf073f75bf6a3edb,0xbf193f6bbf7f3f4fbed4bdbc3f13bf67,0xbf4d3ecd3ddbbf163f69bf7f3f52bedb,0x3f67bf383eedbe23be263eefbf393f67,0xbedc3f32bf633f7dbf7d3f63bf313edb,0x3e7cbebb3ef6bf163f2fbf453f58bf67,0x3f78bf6e3f61bf4f3f3bbf243f0abedb
.octa 0x3f513f5b3f643f6b3f723f773f7b3f7e,0xbf14bf05beeabecabea8be86be45bdfb,0x3f6a3f7d3f7e3f6e3f4c3f1c3ec23dfb,0xbed1be1c3de83ebe3f1a3f4b3f6d3f7e,0x3f7a3f793f433ecabd6fbeffbf55bf7e,0xbe633e733f253f6b3f803f5e3f0e3dfb,0x3f803f4f3e8dbebebf5dbf7ebf34bdfb,0xbce23f173f763f6e3f02be04bf36bf7e
.octa 0x3f7c3f05be9cbf6bbf66be863f0f3f7e,0x3e2c3f5b3f743ecabedfbf77bf54bdfb,0x3f6f3e1cbf48bf6ebe0d3f4b3f6c3dfb,0x3eb73f7d3f1fbebebf7ebf1c3ec53f7e,0x3f59be73bf7fbeca3f3f3f5ebe4bbf7e,0x3f083f793da9bf6bbf2a3eff3f7b3dfb,0x3f3abf17bf603ebe3f78be04bf80bdfb,0x3f303f4fbef8bf6e3e813f7ebb49bf7e
.octa 0x3f14bf5bbeea3f6b3ea8bf77be453f7e,0x3f513f05bf64beca3f723e86bf7bbdfb,0x3ed1bf7d3de83f6ebf1abf1c3f6d3dfb,0x3f6a3e1cbf7e3ebe3f4cbf4bbec23f7e,0x3e63bf793f253ecabf803eff3f0ebf7e,0x3f7abe73bf433f6bbd6fbf5e3f553dfb,0x3ce2bf4f3f76bebebf023f7ebf36bdfb,0x3f80bf17be8d3f6ebf5d3e043f34bf7e
.octa 0xbe2cbf053f74bf6b3edf3e86bf543f7e,0x3f7cbf5b3e9c3ecabf663f77bf0fbdfb,0xbeb7be1c3f1fbf6e3f7ebf4b3ec53dfb,0x3f6fbf7d3f48bebebe0d3f1cbf6c3f7e,0xbf083e733da9beca3f2abf5e3f7bbf7e,0x3f59bf793f7fbf6b3f3fbeff3e4b3dfb,0xbf303f17bef83ebebe813e04bb49bdfb,0x3f3abf4f3f60bf6e3f78bf7e3f80bf7e
.octa 0xbf613f69bf703f76bf7a3f7dbf7f3f80,0x3ef3bed23eb1be8f3e57be103d908000,0x3e96bcfbbe703ef7bf323f5cbf773f80,0x3f75bf803f79bf603f38bf023e878000,0x3f7fbf6f3f2ebe8fbe383f1abf653f80,0xbdcfbeb53f3cbf763f7cbf4d3ee58000,0x3dc2bf2f3f7dbf603ecb3e7fbf4a3f80,0xbf7f3f3abe20bef73f6bbf783f1d8000
.octa 0xbf753ed23ed7bf763f57be10bf283f80,0xbe933f69bf683e8f3f0bbf7d3f418000,0xbef03f80bf06bef73f80bf02befe3f80,0x3f62bcfbbf5a3f60bc7bbf5c3f5e8000,0x3f463eb5bf803e8f3f53bf4dbea23f80,0x3f22bf6fbd233f76bf11bf1a3f738000,0x3f45bf3abf173f603ebdbf78be003f80,0xbf23bf2f3f4f3ef7bf6ebe7f3f7e8000
.octa 0xbef3bf693eb13f76be57bf7d3d903f80,0xbf613ed23f70be8fbf7a3e103f7f8000,0xbf753cfb3f793ef7bf38bf5c3e873f80,0x3e963f803e70bf60bf323f023f778000,0x3dcf3f6f3f3cbe8fbf7cbf1a3ee53f80,0x3f7f3eb5bf2ebf76be383f4d3f658000,0x3f7f3f2fbe20bf60bf6bbe7f3f1d3f80,0x3dc2bf3abf7dbef73ecb3f783f4a8000
.octa 0x3e93bed2bf68bf76bf0b3e103f413f80,0xbf75bf69bed73e8f3f573f7d3f288000,0xbf62bf80bf5abef73c7b3f023f5e3f80,0xbef03cfb3f063f603f803f5c3efe8000,0xbf22beb5bd233e8f3f113f4d3f733f80,0x3f463f6f3f803f763f533f1a3ea28000,0x3f233f3a3f4f3f603f6e3f783f7e3f80,0x3f453f2f3f173ef73ebd3e7f3e008000
.octa 0xbefb3f0dbf1c3f2abf373f43bf4e3f58,0x3f5fbf563f4bbf403f33bf263f18bf09,0x3f27bf543f72bf803f7bbf643f3dbf09,0xbf423f10bea53d7b3e51bee93f2dbf58,0xbf493f7bbf773f40bec0bda33f04bf58,0x3f1ebe4ebe843f2abf6d3f7fbf5b3f09,0x3f64bf7b3f29bd7bbf103f74bf713f09,0xbee8be423f40bf803f54be9ebeae3f58
.octa 0xbf773f56be07bf2a3f80bf26be193f58,0x3e8a3f0dbf7e3f403c17bf433f7dbf09,0x3f7fbf10bee23f80bf0cbee93f80bf09,0xbd9dbf543f66bd7bbf563f64bd3cbf58,0xbf7e3e4e3f5ebf40bec83f7fbe76bf58,0xbdf43f7bbf00bf2a3f6c3da3bf793f09,0x3f733e42bf7f3d7b3f7cbe9ebf683f09,0x3e9fbf7bbd843f80be3fbf743ed93f58
.octa 0xbf5fbf0d3f4b3f2abf33bf433f183f58,0xbefb3f563f1cbf40bf373f263f4ebf09,0x3f423f54bea5bf80be513f643f2dbf09,0x3f27bf10bf723d7b3f7b3ee9bf3dbf58,0xbf1ebf7bbe843f403f6d3da3bf5bbf58,0xbf493e4e3f773f2abec0bf7fbf043f09,0x3ee83f7b3f40bd7bbf54bf74beae3f09,0x3f643e42bf29bf80bf103e9e3f713f58
.octa 0xbe8abf56bf7ebf2abc173f263f7d3f58,0xbf77bf0d3e073f403f803f433e19bf09,0x3d9d3f103f663f803f563ee9bd3cbf09,0x3f7f3f543ee2bd7bbf0cbf64bf80bf58,0x3df4be4ebf00bf40bf6cbf7fbf79bf58,0xbf7ebf7bbf5ebf2abec8bda33e763f09,0xbe9fbe42bd843d7b3e3f3e9e3ed93f09,0x3f733f7b3f7f3f803f7c3f743f683f58
.octa 0x3d563c97bdb63e23be6a3e98beba3edb,0x3f80bf803f7fbf7d3f79bf753f6fbf67,0xbf7d3f6bbf473f16beb43dbc3e32bedb,0xbe133ecdbf213f4fbf703f7fbf7c3f67,0x3eabbf383f74bf7d3f50beef3cb03edb,0xbf713f32be99be233f15bf633f80bf67,0x3f5cbebbbe903f4fbf803f45be5dbedb,0x3f03bf6e3f76bf16bd0a3f24bf7a3f67
.octa 0xbf2b3f80bf24be233f5abf753ece3edb,0x3f3e3c97bf443f7dbf07be983f6abf67,0xbf19becd3f7fbf16bed43f7fbf13bedb,0xbf4d3f6bbddbbf4f3f69bdbcbf523f67,0x3f67bf32beed3f7dbe26bf633f393edb,0xbedcbf383f633e23bf7d3eef3f31bf67,0x3e7c3f6ebef6bf4f3f2f3f24bf58bedb,0x3f78bebbbf613f163f3bbf45bf0a3f67
.octa 0xbf80bc973f7f3e23bf79be983f6f3edb,0x3d563f803db6bf7dbe6a3f753ebabf67,0x3e13bf6bbf213f163f70bdbcbf7cbedb,0xbf7dbecd3f473f4fbeb4bf7fbe323f67,0x3f713f38be99bf7dbf153eef3f803edb,0x3eabbf32bf74be233f503f63bcb0bf67,0xbf033ebb3f763f4f3d0abf45bf7abedb,0x3f5c3f6e3e90bf16bf80bf243e5d3f67
.octa 0xbf3ebf80bf44be233f073f753f6a3edb,0xbf2bbc973f243f7d3f5a3e98becebf67,0x3f4d3ecdbddbbf16bf69bf7fbf52bedb,0xbf19bf6bbf7fbf4fbed43dbc3f133f67,0x3edc3f323f633f7d3f7d3f633f313edb,0x3f673f383eed3e23be26beefbf39bf67,0xbf78bf6ebf61bf4fbf3bbf24bf0abedb,0x3e7c3ebb3ef63f163f2f3f453f583f67
.octa 0x3f14bf053eeabeca3ea8be863e45bdfb,0x3f51bf5b3f64bf6b3f72bf773f7bbf7e,0x3ed1be1cbde83ebebf1a3f4bbf6d3f7e,0x3f6abf7d3f7ebf6e3f4cbf1c3ec2bdfb,0x3e633e73bf253f6bbf803f5ebf0e3dfb,0x3f7abf793f43becabd6f3effbf553f7e,0x3ce23f17bf763f6ebf02be043f36bf7e,0x3f80bf4f3e8d3ebebf5d3f7ebf343dfb
.octa 0xbe2c3f5bbf743eca3edfbf773f54bdfb,0x3f7cbf05be9c3f6bbf663e863f0fbf7e,0xbeb73f7dbf1fbebe3f7ebf1cbec53f7e,0x3f6fbe1cbf483f6ebe0dbf4b3f6cbdfb,0xbf083f79bda9bf6b3f2a3effbf7b3dfb,0x3f593e73bf7f3eca3f3fbf5ebe4b3f7e,0xbf303f4f3ef8bf6ebe813f7e3b49bf7e,0x3f3a3f17bf60bebe3f783e04bf803dfb
.octa 0xbf513f053f64becabf723e863f7bbdfb,0x3f143f5bbeeabf6b3ea83f77be45bf7e,0xbf6a3e1c3f7e3ebebf4cbf4b3ec23f7e,0x3ed13f7d3de8bf6ebf1a3f1c3f6dbdfb,0xbf7abe733f433f6b3d6fbf5ebf553dfb,0x3e633f793f25becabf80beff3f0e3f7e,0xbf80bf173e8d3f6e3f5d3e04bf34bf7e,0x3ce23f4f3f763ebebf02bf7ebf363dfb
.octa 0xbf7cbf5bbe9c3eca3f663f773f0fbdfb,0xbe2c3f053f743f6b3edfbe86bf54bf7e,0xbf6fbf7dbf48bebe3e0d3f1c3f6c3f7e,0xbeb73e1c3f1f3f6e3f7e3f4b3ec5bdfb,0xbf59bf79bf7fbf6bbf3fbeffbe4b3dfb,0xbf08be733da93eca3f2a3f5e3f7b3f7e,0xbf3abf4fbf60bf6ebf78bf7ebf80bf7e,0xbf30bf17bef8bebebe81be04bb493dfb
.octa 0xbef33ed2beb13e8fbe573e10bd900000,0xbf613f69bf703f76bf7a3f7dbf7f3f80,0xbf753f80bf793f60bf383f02be870000,0x3e96bcfbbe703ef7bf323f5cbf773f80,0x3dcf3eb5bf3c3f76bf7c3f4dbee50000,0x3f7fbf6f3f2ebe8fbe383f1abf653f80,0x3f7fbf3a3e203ef7bf6b3f78bf1d0000,0x3dc2bf2f3f7dbf603ecb3e7fbf4a3f80
.octa 0x3e93bf693f68be8fbf0b3f7dbf410000,0xbf753ed23ed7bf763f57be10bf283f80,0xbf623cfb3f5abf603c7b3f5cbf5e0000,0xbef03f80bf06bef73f80bf02befe3f80,0xbf223f6f3d23bf763f113f1abf730000,0x3f463eb5bf803e8f3f53bf4dbea23f80,0x3f233f2fbf4fbef73f6e3e7fbf7e0000,0x3f45bf3abf173f603ebdbf78be003f80
.octa 0x3f61bed2bf703e8f3f7abe10bf7f0000,0xbef3bf693eb13f76be57bf7d3d903f80,0xbe96bf80be703f603f32bf02bf770000,0xbf753cfb3f793ef7bf38bf5c3e873f80,0xbf7fbeb53f2e3f763e38bf4dbf650000,0x3dcf3f6f3f3cbe8fbf7cbf1a3ee53f80,0xbdc23f3a3f7d3ef7becbbf78bf4a0000,0x3f7f3f2fbe20bf60bf6bbe7f3f1d3f80
.octa 0x3f753f693ed7be8fbf57bf7dbf280000,0x3e93bed2bf68bf76bf0b3e103f413f80,0x3ef0bcfbbf06bf60bf80bf5cbefe0000,0xbf62bf80bf5abef73c7b3f023f5e3f80,0xbf46bf6fbf80bf76bf53bf1abea20000,0xbf22beb5bd233e8f3f113f4d3f733f80,0xbf45bf2fbf17bef7bebdbe7fbe000000,0x3f233f3a3f4f3f603f6e3f783f7e3f80
.octa 0xbf5f3f56bf4b3f40bf333f26bf183f09,0xbefb3f0dbf1c3f2abf373f43bf4e3f58,0x3f42bf103ea5bd7bbe513ee9bf2d3f58,0x3f27bf543f72bf803f7bbf643f3dbf09,0xbf1e3e4e3e84bf2a3f6dbf7f3f5bbf09,0xbf493f7bbf773f40bec0bda33f04bf58,0x3ee83e42bf403f80bf543e9e3eaebf58,0x3f64bf7b3f29bd7bbf103f74bf713f09
.octa 0xbe8abf0d3f7ebf40bc173f43bf7d3f09,0xbf773f56be07bf2a3f80bf26be193f58,0x3d9d3f54bf663d7b3f56bf643d3c3f58,0x3f7fbf10bee23f80bf0cbee93f80bf09,0x3df4bf7b3f003f2abf6cbda33f79bf09,0xbf7e3e4e3f5ebf40bec83f7fbe76bf58,0xbe9f3f7b3d84bf803e3f3f74bed9bf58,0x3f733e42bf7f3d7b3f7cbe9ebf683f09
.octa 0x3efbbf56bf1c3f403f37bf26bf4e3f09,0xbf5fbf0d3f4b3f2abf33bf433f183f58,0xbf273f103f72bd7bbf7bbee93f3d3f58,0x3f423f54bea5bf80be513f643f2dbf09,0x3f49be4ebf77bf2a3ec03f7f3f04bf09,0xbf1ebf7bbe843f403f6d3da3bf5bbf58,0xbf64be423f293f803f10be9ebf71bf58,0x3ee83f7b3f40bd7bbf54bf74beae3f09
.octa 0x3f773f0dbe07bf40bf80bf43be193f09,0xbe8abf56bf7ebf2abc173f263f7d3f58,0xbf7fbf54bee23d7b3f0c3f643f803f58,0x3d9d3f103f663f803f563ee9bd3cbf09,0x3f7e3f7b3f5e3f2a3ec83da3be76bf09,0x3df4be4ebf00bf40bf6cbf7fbf79bf58,0xbf73bf7bbf7fbf80bf7cbf74bf68bf58,0xbe9fbe42bd843d7b3e3f3e9e3ed93f09
.octa 0xbf803f80bf7f3f7dbf793f75bf6f3f67,0x3d563c97bdb63e23be6a3e98beba3edb,0x3e13becd3f21bf4f3f70bf7f3f7cbf67,0xbf7d3f6bbf473f16beb43dbc3e32bedb,0x3f71bf323e993e23bf153f63bf803f67,0x3eabbf383f74bf7d3f50beef3cb03edb,0xbf033f6ebf763f163d0abf243f7abf67,0x3f5cbebbbe903f4fbf803f45be5dbedb
.octa 0xbf3ebc973f44bf7d3f073e98bf6a3f67,0xbf2b3f80bf24be233f5abf753ece3edb,0x3f4dbf6b3ddb3f4fbf693dbc3f52bf67,0xbf19becd3f7fbf16bed43f7fbf13bedb,0x3edc3f38bf63be233f7dbeefbf313f67,0x3f67bf32beed3f7dbe26bf633f393edb,0xbf783ebb3f61bf16bf3b3f453f0abf67,0x3e7c3f6ebef6bf4f3f2f3f24bf58bedb
.octa 0xbd56bf80bdb63f7d3e6abf75beba3f67,0xbf80bc973f7f3e23bf79be983f6f3edb,0x3f7d3ecdbf47bf4f3eb43f7f3e32bf67,0x3e13bf6bbf213f163f70bdbcbf7cbedb,0xbeab3f323f743e23bf50bf633cb03f67,0x3f713f38be99bf7dbf153eef3f803edb,0xbf5cbf6ebe903f163f803f24be5dbf67,0xbf033ebb3f763f4f3d0abf45bf7abedb
.octa 0x3f2b3c97bf24bf7dbf5abe983ece3f67,0xbf3ebf80bf44be233f073f753f6a3edb,0x3f193f6b3f7f3f4f3ed4bdbcbf13bf67,0x3f4d3ecdbddbbf16bf69bf7fbf52bedb,0xbf67bf38beedbe233e263eef3f393f67,0x3edc3f323f633f7d3f7d3f633f313edb,0xbe7cbebbbef6bf16bf2fbf45bf58bf67,0xbf78bf6ebf61bf4fbf3bbf24bf0abedb
.octa 0xbf513f5bbf643f6bbf723f77bf7b3f7e,0x3f14bf053eeabeca3ea8be863e45bdfb,0xbf6a3f7dbf7e3f6ebf4c3f1cbec23dfb,0x3ed1be1cbde83ebebf1a3f4bbf6d3f7e,0xbf7a3f79bf433eca3d6fbeff3f55bf7e,0x3e633e73bf253f6bbf803f5ebf0e3dfb,0xbf803f4fbe8dbebe3f5dbf7e3f34bdfb,0x3ce23f17bf763f6ebf02be043f36bf7e
.octa 0xbf7c3f053e9cbf6b3f66be86bf0f3f7e,0xbe2c3f5bbf743eca3edfbf773f54bdfb,0xbf6f3e1c3f48bf6e3e0d3f4bbf6c3dfb,0xbeb73f7dbf1fbebe3f7ebf1cbec53f7e,0xbf59be733f7fbecabf3f3f5e3e4bbf7e,0xbf083f79bda9bf6b3f2a3effbf7b3dfb,0xbf3abf173f603ebebf78be043f80bdfb,0xbf303f4f3ef8bf6ebe813f7e3b49bf7e
.octa 0xbf14bf5b3eea3f6bbea8bf773e453f7e,0xbf513f053f64becabf723e863f7bbdfb,0xbed1bf7dbde83f6e3f1abf1cbf6d3dfb,0xbf6a3e1c3f7e3ebebf4cbf4b3ec23f7e,0xbe63bf79bf253eca3f803effbf0ebf7e,0xbf7abe733f433f6b3d6fbf5ebf553dfb,0xbce2bf4fbf76bebe3f023f7e3f36bdfb,0xbf80bf173e8d3f6e3f5d3e04bf34bf7e
.octa 0x3e2cbf05bf74bf6bbedf3e863f543f7e,0xbf7cbf5bbe9c3eca3f663f773f0fbdfb,0x3eb7be1cbf1fbf6ebf7ebf4bbec53dfb,0xbf6fbf7dbf48bebe3e0d3f1c3f6c3f7e,0x3f083e73bda9becabf2abf5ebf7bbf7e,0xbf59bf79bf7fbf6bbf3fbeffbe4b3dfb,0x3f303f173ef83ebe3e813e043b49bdfb,0xbf3abf4fbf60bf6ebf78bf7ebf80bf7e
.octa 0x3f5f3f673f6f3f753f7a3f7d3f7f3f80,0xbefcbedbbeb8be95be60be16bd978000,0xbea1bd493e603ef13f313f5c3f773f80,0xbf73bf80bf7abf62bf39bf04be898000,0xbf7ebf71bf31be953e2f3f183f653f80,0x3dfbbeacbf39bf75bf7cbf4ebee68000,0xbd97bf2cbf7cbf62becf3e793f4a3f80,0x3f7f3f3e3e2fbef1bf6abf78bf1d8000
.octa 0x3f773edbbecfbf75bf58be163f273f80,0x3e893f673f6a3e95bf09bf7dbf428000,0x3ee63f803f09bef1bf80bf043efc3f80,0xbf65bd493f583f623cc9bf5cbf5f8000,0xbf4a3eac3f803e95bf51bf4e3ea13f80,0xbf1dbf713cc93f753f13bf18bf738000,0xbf42bf3e3f133f62beb8bf783dfb3f80,0x3f27bf2cbf513ef13f6fbe79bf7e8000
.octa 0x3efcbf67beb83f753e60bf7dbd973f80,0x3f5f3edbbf6fbe953f7a3e16bf7f8000,0x3f733d49bf7a3ef13f39bf5cbe893f80,0xbea13f80be60bf623f313f04bf778000,0xbdfb3f71bf39be953f7cbf18bee63f80,0xbf7e3eac3f31bf753e2f3f4ebf658000,0xbf7f3f2c3e2fbf623f6abe79bf1d3f80,0xbd97bf3e3f7cbef1becf3f78bf4a8000
.octa 0xbe89bedb3f6abf753f093e16bf423f80,0x3f77bf673ecf3e95bf583f7dbf278000,0x3f65bf803f58bef1bcc93f04bf5f3f80,0x3ee63d49bf093f62bf803f5cbefc8000,0x3f1dbeac3cc93e95bf133f4ebf733f80,0xbf4a3f71bf803f75bf513f18bea18000,0xbf273f3ebf513f62bf6f3f78bf7e3f80,0xbf423f2cbf133ef1beb83e79bdfb8000
.octa 0x3ee63f043f133f223f313f3e3f4a3f55,0xbf65bf5cbf51bf46bf39bf2cbf1dbf0e,0xbf1dbf4ebf6fbf7fbf7cbf67bf42bf0e,0x3f4a3f183eb83dc9be2fbedbbf27bf55,0x3f423f783f7a3f463ecfbd49befcbf55,0xbf27be793e603f223f6a3f803f5f3f0e,0xbf5fbf7dbf31bdc93f093f713f733f0e,0x3efcbe16bf39bf7fbf58beac3ea13f55
.octa 0x3f733f5c3e2fbf22bf80bf2c3dfb3f55,0xbea13f043f7c3f463cc9bf3ebf7ebf0e,0xbf7ebf183ecf3f7f3f13bedbbf7fbf0e,0x3dfbbf4ebf6abdc93f513f673d97bf55,0x3f7f3e79bf58bf463eb83f803e89bf55,0x3d973f783f09bf22bf6f3d493f773f0e,0xbf773e163f803dc9bf7abeac3f653f0e,0xbe89bf7d3cc93f7f3e60bf71bee63f55
.octa 0x3f65bf04bf513f223f39bf3ebf1d3f55,0x3ee63f5cbf13bf463f313f2cbf4abf0e,0xbf4a3f4e3eb8bf7f3e2f3f67bf27bf0e,0xbf1dbf183f6f3dc9bf7c3edb3f42bf55,0x3f27bf783e603f46bf6a3d493f5fbf55,0x3f423e79bf7a3f223ecfbf803efc3f0e,0xbefc3f7dbf39bdc93f58bf713ea13f0e,0xbf5f3e163f31bf7f3f093eacbf733f55
.octa 0x3ea1bf5c3f7cbf22bcc93f2cbf7e3f55,0x3f73bf04be2f3f46bf803f3ebdfbbf0e,0xbdfb3f18bf6a3f7fbf513edb3d97bf0e,0xbf7e3f4ebecfbdc93f13bf673f7fbf55,0xbd97be793f09bf463f6fbf803f77bf55,0x3f7fbf783f58bf223eb8bd49be893f0e,0x3e89be163cc93dc9be603eacbee63f0e,0xbf773f7dbf803f7fbf7a3f71bf653f55
.octa 0xbdfbbd493cc93dc93e2f3e793ea13ec4,0xbf7ebf80bf80bf7fbf7cbf78bf73bf6d,0x3f7f3f713f513f223ecf3e16bdfbbec4,0x3d973eac3f133f463f6a3f7d3f7e3f6d,0xbe89bf2cbf6fbf7fbf58bf04bd973ec4,0x3f773f3e3eb8bdc9bf09bf5cbf7fbf6d,0xbf65bedb3e603f463f803f4e3e89bec4,0xbee6bf67bf7abf22bcc93f183f773f6d
.octa 0x3f1d3f803f31bdc9bf51bf78bee63ec4,0xbf4abd493f393f7f3f13be79bf65bf6d,0x3f27beacbf7cbf223eb83f7d3f1dbec4,0x3f423f713e2fbf46bf6fbe163f4a3f6d,0xbf5fbf3e3ecf3f7f3e60bf5cbf423ec4,0x3efcbf2cbf6a3dc93f7a3f04bf27bf6d,0xbea13f673f09bf46bf393f183f5fbec4,0xbf73bedb3f583f22bf31bf4e3efc3f6d
.octa 0x3f7e3d49bf803dc93f7cbe79bf733ec4,0xbdfb3f80bcc9bf7f3e2f3f78bea1bf6d,0xbd97bf713f133f22bf6abe163f7ebec4,0x3f7fbeacbf513f463ecfbf7d3dfb3f6d,0xbf773f2c3eb8bf7f3f093f04bf7f3ec4,0xbe89bf3e3f6fbdc9bf583f5c3d97bf6d,0x3ee63edbbf7a3f463cc9bf4e3f77bec4,0xbf653f67be60bf223f80bf18be893f6d
.octa 0x3f4abf803f39bdc9bf133f78bf653ec4,0x3f1d3d49bf313f7fbf513e793ee6bf6d,0xbf423eac3e2fbf223f6fbf7d3f4abec4,0x3f27bf713f7cbf463eb83e16bf1d3f6d,0xbefc3f3ebf6a3f7fbf7a3f5cbf273ec4,0xbf5f3f2cbecf3dc93e60bf043f42bf6d,0x3f73bf673f58bf463f31bf183efcbec4,0xbea13edbbf093f22bf393f4ebf5f3f6d
.octa 0xbf27bf18bf09bef1becfbeacbe89be48,0xbf42bf4ebf58bf62bf6abf71bf77bf7b,0xbefcbe793cc93e953f093f3e3f653f7b,0xbf5fbf78bf80bf75bf58bf2cbee6be48,0xbea13e163f133f623f803f673f1d3e48,0xbf73bf7dbf51bef1bcc93edb3f4a3f7b,0xbdfb3f043f6f3f753f13bd49bf27bf7b,0xbf7ebf5cbeb83e953f513f803f423e48
.octa 0x3d973f4e3f7a3ef1beb8bf71bf5fbe48,0xbf7fbf183e603f623f6f3eacbefcbf7b,0x3e893f783f31be95bf7abf2c3ea13f7b,0xbf77be793f393f753e60bf3ebf73be48,0x3ee63f7d3e2fbf62bf393edb3f7e3e48,0xbf653e163f7c3ef1bf31bf673dfb3f7b,0x3f1d3f5cbecfbf753e2f3f803d97bf7b,0xbf4a3f043f6abe95bf7c3d493f7f3e48
.octa 0x3f423f18bf58bef13f6a3eacbf77be48,0xbf273f4e3f09bf62becf3f713e89bf7b,0x3f5f3e79bf803e953f58bf3ebee63f7b,0xbefc3f78bcc9bf753f093f2cbf65be48,0x3f73be16bf513f623cc9bf673f4a3e48,0xbea13f7dbf13bef13f80bedbbf1d3f7b,0x3f7ebf04beb83f75bf513d493f42bf7b,0xbdfb3f5cbf6f3e953f13bf803f273e48
.octa 0x3f7fbf4e3e603ef1bf6f3f71befcbe48,0x3d973f18bf7a3f62beb8beac3f5fbf7b,0x3f77bf783f39be95be603f2cbf733f7b,0x3e893e79bf313f75bf7a3f3ebea1be48,0x3f65bf7d3f7cbf623f31bedb3dfb3e48,0x3ee6be16be2f3ef1bf393f67bf7e3f7b,0x3f4abf5c3f6abf753f7cbf803f7fbf7b,0x3f1dbf043ecfbe953e2fbd49bd973e48
.octa 0x3efc3edb3eb83e953e603e163d970000,0x3f5f3f673f6f3f753f7a3f7d3f7f3f80,0x3f733f803f7a3f623f393f043e890000,0xbea1bd493e603ef13f313f5c3f773f80,0xbdfb3eac3f393f753f7c3f4e3ee60000,0xbf7ebf71bf31be953e2f3f183f653f80,0xbf7fbf3ebe2f3ef13f6a3f783f1d0000,0xbd97bf2cbf7cbf62becf3e793f4a3f80
.octa 0xbe89bf67bf6abe953f093f7d3f420000,0x3f773edbbecfbf75bf58be163f273f80,0x3f653d49bf58bf62bcc93f5c3f5f0000,0x3ee63f803f09bef1bf80bf043efc3f80,0x3f1d3f71bcc9bf75bf133f183f730000,0xbf4a3eac3f803e95bf51bf4e3ea13f80,0xbf273f2c3f51bef1bf6f3e793f7e0000,0xbf42bf3e3f133f62beb8bf783dfb3f80
.octa 0xbf5fbedb3f6f3e95bf7abe163f7f0000,0x3efcbf67beb83f753e60bf7dbd973f80,0x3ea1bf803e603f62bf31bf043f770000,0x3f733d49bf7a3ef13f39bf5cbe893f80,0x3f7ebeacbf313f75be2fbf4e3f650000,0xbdfb3f71bf39be953f7cbf18bee63f80,0x3d973f3ebf7c3ef13ecfbf783f4a0000,0xbf7f3f2c3e2fbf623f6abe79bf1d3f80
.octa 0xbf773f67becfbe953f58bf7d3f270000,0xbe89bedb3f6abf753f093e16bf423f80,0xbee6bd493f09bf623f80bf5c3efc0000,0x3f65bf803f58bef1bcc93f04bf5f3f80,0x3f4abf713f80bf753f51bf183ea10000,0x3f1dbeac3cc93e95bf133f4ebf733f80,0x3f42bf2c3f13bef13eb8be793dfb0000,0xbf273f3ebf513f62bf6f3f78bf7e3f80
.octa 0x3f653f5c3f513f463f393f2c3f1d3f0e,0x3ee63f043f133f223f313f3e3f4a3f55,0xbf4abf18beb8bdc93e2f3edb3f273f55,0xbf1dbf4ebf6fbf7fbf7cbf67bf42bf0e,0x3f273e79be60bf22bf6abf80bf5fbf0e,0x3f423f783f7a3f463ecfbd49befcbf55,0xbefc3e163f393f7f3f583eacbea1bf55,0xbf5fbf7dbf31bdc93f093f713f733f0e
.octa 0x3ea1bf04bf7cbf46bcc93f3e3f7e3f0e,0x3f733f5c3e2fbf22bf80bf2c3dfb3f55,0xbdfb3f4e3f6a3dc9bf51bf67bd973f55,0xbf7ebf183ecf3f7f3f13bedbbf7fbf0e,0xbd97bf78bf093f223f6fbd49bf77bf0e,0x3f7f3e79bf58bf463eb83f803e89bf55,0x3e893f7dbcc9bf7fbe603f713ee6bf55,0xbf773e163f803dc9bf7abeac3f653f0e
.octa 0xbee6bf5c3f133f46bf31bf2c3f4a3f0e,0x3f65bf04bf513f223f39bf3ebf1d3f55,0x3f1d3f18bf6fbdc93f7cbedbbf423f55,0xbf4a3f4e3eb8bf7f3e2f3f67bf27bf0e,0xbf42be793f7abf22becf3f80befcbf0e,0x3f27bf783e603f46bf6a3d493f5fbf55,0x3f5fbe16bf313f7fbf09beac3f73bf55,0xbefc3f7dbf39bdc93f58bf713ea13f0e
.octa 0xbf733f043e2fbf463f80bf3e3dfb3f0e,0x3ea1bf5c3f7cbf22bcc93f2cbf7e3f55,0x3f7ebf4e3ecf3dc9bf133f67bf7f3f55,0xbdfb3f18bf6a3f7fbf513edb3d97bf0e,0xbf7f3f78bf583f22beb83d493e89bf0e,0xbd97be793f09bf463f6fbf803f77bf55,0x3f77bf7d3f80bf7f3f7abf713f65bf55,0x3e89be163cc93dc9be603eacbee63f0e
.octa 0x3f7e3f803f803f7f3f7c3f783f733f6d,0xbdfbbd493cc93dc93e2f3e793ea13ec4,0xbd97beacbf13bf46bf6abf7dbf7ebf6d,0x3f7f3f713f513f223ecf3e16bdfbbec4,0xbf77bf3ebeb83dc93f093f5c3f7f3f6d,0xbe89bf2cbf6fbf7fbf58bf04bd973ec4,0x3ee63f673f7a3f223cc9bf18bf77bf6d,0xbf65bedb3e603f463f803f4e3e89bec4
.octa 0x3f4a3d49bf39bf7fbf133e793f653f6d,0x3f1d3f803f31bdc9bf51bf78bee63ec4,0xbf42bf71be2f3f463f6f3e16bf4abf6d,0x3f27beacbf7cbf223eb83f7d3f1dbec4,0xbefc3f2c3f6abdc9bf7abf043f273f6d,0xbf5fbf3e3ecf3f7f3e60bf5cbf423ec4,0x3f733edbbf58bf223f313f4ebefcbf6d,0xbea13f673f09bf46bf393f183f5fbec4
.octa 0x3dfbbf803cc93f7fbe2fbf783ea13f6d,0x3f7e3d49bf803dc93f7cbe79bf733ec4,0xbf7f3eac3f51bf46becf3f7dbdfbbf6d,0xbd97bf713f133f22bf6abe163f7ebec4,0x3e893f3ebf6f3dc93f58bf5cbd973f6d,0xbf773f2c3eb8bf7f3f093f04bf7f3ec4,0x3f65bf673e603f22bf803f183e89bf6d,0x3ee63edbbf7a3f463cc9bf4e3f77bec4
.octa 0xbf1dbd493f31bf7f3f51be79bee63f6d,0x3f4abf803f39bdc9bf133f78bf653ec4,0xbf273f71bf7c3f46beb8be163f1dbf6d,0xbf423eac3e2fbf223f6fbf7d3f4abec4,0x3f5fbf2c3ecfbdc9be603f04bf423f6d,0xbefc3f3ebf6a3f7fbf7a3f5cbf273ec4,0x3ea1bedb3f09bf223f39bf4e3f5fbf6d,0x3f73bf673f58bf463f31bf183efcbec4
.octa 0x3f423f4e3f583f623f6a3f713f773f7b,0xbf27bf18bf09bef1becfbeacbe89be48,0x3f5f3f783f803f753f583f2c3ee63e48,0xbefcbe793cc93e953f093f3e3f653f7b,0x3f733f7d3f513ef13cc9bedbbf4abf7b,0xbea13e163f133f623f803f673f1d3e48,0x3f7e3f5c3eb8be95bf51bf80bf42be48,0xbdfb3f043f6f3f753f13bd49bf27bf7b
.octa 0x3f7f3f18be60bf62bf6fbeac3efc3f7b,0x3d973f4e3f7a3ef1beb8bf71bf5fbe48,0x3f773e79bf39bf75be603f3e3f733e48,0x3e893f783f31be95bf7abf2c3ea13f7b,0x3f65be16bf7cbef13f313f67bdfbbf7b,0x3ee63f7d3e2fbf62bf393edb3f7e3e48,0x3f4abf04bf6a3e953f7cbd49bf7fbe48,0x3f1d3f5cbecfbf753e2f3f803d97bf7b
.octa 0x3f27bf4ebf093f623ecfbf71be893f7b,0x3f423f18bf58bef13f6a3eacbf77be48,0x3efcbf783cc93f75bf09bf2c3f653e48,0x3f5f3e79bf803e953f58bf3ebee63f7b,0x3ea1bf7d3f133ef1bf803edb3f1dbf7b,0x3f73be16bf513f623cc9bf673f4a3e48,0x3dfbbf5c3f6fbe95bf133f80bf27be48,0x3f7ebf04beb83f75bf513d493f42bf7b
.octa 0xbd97bf183f7abf623eb83eacbf5f3f7b,0x3f7fbf4e3e603ef1bf6f3f71befcbe48,0xbe89be793f31bf753f7abf3e3ea13e48,0x3f77bf783f39be95be603f2cbf733f7b,0xbee63e163e2fbef13f39bf673f7ebf7b,0x3f65bf7d3f7cbf623f31bedb3dfb3e48,0xbf1d3f04becf3e95be2f3d493d97be48,0x3f4abf5c3f6abf753f7cbf803f7fbf7b
.octa 0xbf5f3f67bf6f3f75bf7a3f7dbf7f3f80,0x3efcbedb3eb8be953e60be163d978000,0x3ea1bd49be603ef1bf313f5cbf773f80,0x3f73bf803f7abf623f39bf043e898000,0x3f7ebf713f31be95be2f3f18bf653f80,0xbdfbbeac3f39bf753f7cbf4e3ee68000,0x3d97bf2c3f7cbf623ecf3e79bf4a3f80,0xbf7f3f3ebe2fbef13f6abf783f1d8000
.octa 0xbf773edb3ecfbf753f58be16bf273f80,0xbe893f67bf6a3e953f09bf7d3f428000,0xbee63f80bf09bef13f80bf04befc3f80,0x3f65bd49bf583f62bcc9bf5c3f5f8000,0x3f4a3eacbf803e953f51bf4ebea13f80,0x3f1dbf71bcc93f75bf13bf183f738000,0x3f42bf3ebf133f623eb8bf78bdfb3f80,0xbf27bf2c3f513ef1bf6fbe793f7e8000
.octa 0xbefcbf673eb83f75be60bf7d3d973f80,0xbf5f3edb3f6fbe95bf7a3e163f7f8000,0xbf733d493f7a3ef1bf39bf5c3e893f80,0x3ea13f803e60bf62bf313f043f778000,0x3dfb3f713f39be95bf7cbf183ee63f80,0x3f7e3eacbf31bf75be2f3f4e3f658000,0x3f7f3f2cbe2fbf62bf6abe793f1d3f80,0x3d97bf3ebf7cbef13ecf3f783f4a8000
.octa 0x3e89bedbbf6abf75bf093e163f423f80,0xbf77bf67becf3e953f583f7d3f278000,0xbf65bf80bf58bef13cc93f043f5f3f80,0xbee63d493f093f623f803f5c3efc8000,0xbf1dbeacbcc93e953f133f4e3f733f80,0x3f4a3f713f803f753f513f183ea18000,0x3f273f3e3f513f623f6f3f783f7e3f80,0x3f423f2c3f133ef13eb83e793dfb8000
.octa 0xbee63f04bf133f22bf313f3ebf4a3f55,0x3f65bf5c3f51bf463f39bf2c3f1dbf0e,0x3f1dbf4e3f6fbf7f3f7cbf673f42bf0e,0xbf4a3f18beb83dc93e2fbedb3f27bf55,0xbf423f78bf7a3f46becfbd493efcbf55,0x3f27be79be603f22bf6a3f80bf5f3f0e,0x3f5fbf7d3f31bdc9bf093f71bf733f0e,0xbefcbe163f39bf7f3f58beacbea13f55
.octa 0xbf733f5cbe2fbf223f80bf2cbdfb3f55,0x3ea13f04bf7c3f46bcc9bf3e3f7ebf0e,0x3f7ebf18becf3f7fbf13bedb3f7fbf0e,0xbdfbbf4e3f6abdc9bf513f67bd97bf55,0xbf7f3e793f58bf46beb83f80be89bf55,0xbd973f78bf09bf223f6f3d49bf773f0e,0x3f773e16bf803dc93f7abeacbf653f0e,0x3e89bf7dbcc93f7fbe60bf713ee63f55
.octa 0xbf65bf043f513f22bf39bf3e3f1d3f55,0xbee63f5c3f13bf46bf313f2c3f4abf0e,0x3f4a3f4ebeb8bf7fbe2f3f673f27bf0e,0x3f1dbf18bf6f3dc93f7c3edbbf42bf55,0xbf27bf78be603f463f6a3d49bf5fbf55,0xbf423e793f7a3f22becfbf80befc3f0e,0x3efc3f7d3f39bdc9bf58bf71bea13f0e,0x3f5f3e16bf31bf7fbf093eac3f733f55
.octa 0xbea1bf5cbf7cbf223cc93f2c3f7e3f55,0xbf73bf043e2f3f463f803f3e3dfbbf0e,0x3dfb3f183f6a3f7f3f513edbbd97bf0e,0x3f7e3f4e3ecfbdc9bf13bf67bf7fbf55,0x3d97be79bf09bf46bf6fbf80bf77bf55,0xbf7fbf78bf58bf22beb8bd493e893f0e,0xbe89be16bcc93dc93e603eac3ee63f0e,0x3f773f7d3f803f7f3f7a3f713f653f55
.octa 0x3dfbbd49bcc93dc9be2f3e79bea13ec4,0x3f7ebf803f80bf7f3f7cbf783f73bf6d,0xbf7f3f71bf513f22becf3e163dfbbec4,0xbd973eacbf133f46bf6a3f7dbf7e3f6d,0x3e89bf2c3f6fbf7f3f58bf043d973ec4,0xbf773f3ebeb8bdc93f09bf5c3f7fbf6d,0x3f65bedbbe603f46bf803f4ebe89bec4,0x3ee6bf673f7abf223cc93f18bf773f6d
.octa 0xbf1d3f80bf31bdc93f51bf783ee63ec4,0x3f4abd49bf393f7fbf13be793f65bf6d,0xbf27beac3f7cbf22beb83f7dbf1dbec4,0xbf423f71be2fbf463f6fbe16bf4a3f6d,0x3f5fbf3ebecf3f7fbe60bf5c3f423ec4,0xbefcbf2c3f6a3dc9bf7a3f043f27bf6d,0x3ea13f67bf09bf463f393f18bf5fbec4,0x3f73bedbbf583f223f31bf4ebefc3f6d
.octa 0xbf7e3d493f803dc9bf7cbe793f733ec4,0x3dfb3f803cc9bf7fbe2f3f783ea1bf6d,0x3d97bf71bf133f223f6abe16bf7ebec4,0xbf7fbeac3f513f46becfbf7dbdfb3f6d,0x3f773f2cbeb8bf7fbf093f043f7f3ec4,0x3e89bf3ebf6fbdc93f583f5cbd97bf6d,0xbee63edb3f7a3f46bcc9bf4ebf77bec4,0x3f653f673e60bf22bf80bf183e893f6d
.octa 0xbf4abf80bf39bdc93f133f783f653ec4,0xbf1d3d493f313f7f3f513e79bee6bf6d,0x3f423eacbe2fbf22bf6fbf7dbf4abec4,0xbf27bf71bf7cbf46beb83e163f1d3f6d,0x3efc3f3e3f6a3f7f3f7a3f5c3f273ec4,0x3f5f3f2c3ecf3dc9be60bf04bf42bf6d,0xbf73bf67bf58bf46bf31bf18befcbec4,0x3ea13edb3f093f223f393f4e3f5f3f6d
.octa 0x3f27bf183f09bef13ecfbeac3e89be48,0x3f42bf4e3f58bf623f6abf713f77bf7b,0x3efcbe79bcc93e95bf093f3ebf653f7b,0x3f5fbf783f80bf753f58bf2c3ee6be48,0x3ea13e16bf133f62bf803f67bf1d3e48,0x3f73bf7d3f51bef13cc93edbbf4a3f7b,0x3dfb3f04bf6f3f75bf13bd493f27bf7b,0x3f7ebf5c3eb83e95bf513f80bf423e48
.octa 0xbd973f4ebf7a3ef13eb8bf713f5fbe48,0x3f7fbf18be603f62bf6f3eac3efcbf7b,0xbe893f78bf31be953f7abf2cbea13f7b,0x3f77be79bf393f75be60bf3e3f73be48,0xbee63f7dbe2fbf623f393edbbf7e3e48,0x3f653e16bf7c3ef13f31bf67bdfb3f7b,0xbf1d3f5c3ecfbf75be2f3f80bd97bf7b,0x3f4a3f04bf6abe953f7c3d49bf7f3e48
.octa 0xbf423f183f58bef1bf6a3eac3f77be48,0x3f273f4ebf09bf623ecf3f71be89bf7b,0xbf5f3e793f803e95bf58bf3e3ee63f7b,0x3efc3f783cc9bf75bf093f2c3f65be48,0xbf73be163f513f62bcc9bf67bf4a3e48,0x3ea13f7d3f13bef1bf80bedb3f1d3f7b,0xbf7ebf043eb83f753f513d49bf42bf7b,0x3dfb3f5c3f6f3e95bf13bf80bf273e48
.octa 0xbf7fbf4ebe603ef13f6f3f713efcbe48,0xbd973f183f7a3f623eb8beacbf5fbf7b,0xbf77bf78bf39be953e603f2c3f733f7b,0xbe893e793f313f753f7a3f3e3ea1be48,0xbf65bf7dbf7cbf62bf31bedbbdfb3e48,0xbee6be163e2f3ef13f393f673f7e3f7b,0xbf4abf5cbf6abf75bf7cbf80bf7fbf7b,0xbf1dbf04becfbe95be2fbd493d973e48
.octa 0xbefc3edbbeb83e95be603e16bd970000,0xbf5f3f67bf6f3f75bf7a3f7dbf7f3f80,0xbf733f80bf7a3f62bf393f04be890000,0x3ea1bd49be603ef1bf313f5cbf773f80,0x3dfb3eacbf393f75bf7c3f4ebee60000,0x3f7ebf713f31be95be2f3f18bf653f80,0x3f7fbf3e3e2f3ef1bf6a3f78bf1d0000,0x3d97bf2c3f7cbf623ecf3e79bf4a3f80
.octa 0x3e89bf673f6abe95bf093f7dbf420000,0xbf773edb3ecfbf753f58be16bf273f80,0xbf653d493f58bf623cc93f5cbf5f0000,0xbee63f80bf09bef13f80bf04befc3f80,0xbf1d3f713cc9bf753f133f18bf730000,0x3f4a3eacbf803e953f51bf4ebea13f80,0x3f273f2cbf51bef13f6f3e79bf7e0000,0x3f42bf3ebf133f623eb8bf78bdfb3f80
.octa 0x3f5fbedbbf6f3e953f7abe16bf7f0000,0xbefcbf673eb83f75be60bf7d3d973f80,0xbea1bf80be603f623f31bf04bf770000,0xbf733d493f7a3ef1bf39bf5c3e893f80,0xbf7ebeac3f313f753e2fbf4ebf650000,0x3dfb3f713f39be95bf7cbf183ee63f80,0xbd973f3e3f7c3ef1becfbf78bf4a0000,0x3f7f3f2cbe2fbf62bf6abe793f1d3f80
.octa 0x3f773f673ecfbe95bf58bf7dbf270000,0x3e89bedbbf6abf75bf093e163f423f80,0x3ee6bd49bf09bf62bf80bf5cbefc0000,0xbf65bf80bf58bef13cc93f043f5f3f80,0xbf4abf71bf80bf75bf51bf18bea10000,0xbf1dbeacbcc93e953f133f4e3f733f80,0xbf42bf2cbf13bef1beb8be79bdfb0000,0x3f273f3e3f513f623f6f3f783f7e3f80
.octa 0xbf653f5cbf513f46bf393f2cbf1d3f0e,0xbee63f04bf133f22bf313f3ebf4a3f55,0x3f4abf183eb8bdc9be2f3edbbf273f55,0x3f1dbf4e3f6fbf7f3f7cbf673f42bf0e,0xbf273e793e60bf223f6abf803f5fbf0e,0xbf423f78bf7a3f46becfbd493efcbf55,0x3efc3e16bf393f7fbf583eac3ea1bf55,0x3f5fbf7d3f31bdc9bf093f71bf733f0e
.octa 0xbea1bf043f7cbf463cc93f3ebf7e3f0e,0xbf733f5cbe2fbf223f80bf2cbdfb3f55,0x3dfb3f4ebf6a3dc93f51bf673d973f55,0x3f7ebf18becf3f7fbf13bedb3f7fbf0e,0x3d97bf783f093f22bf6fbd493f77bf0e,0xbf7f3e793f58bf46beb83f80be89bf55,0xbe893f7d3cc9bf7f3e603f71bee6bf55,0x3f773e16bf803dc93f7abeacbf653f0e
.octa 0x3ee6bf5cbf133f463f31bf2cbf4a3f0e,0xbf65bf043f513f22bf39bf3e3f1d3f55,0xbf1d3f183f6fbdc9bf7cbedb3f423f55,0x3f4a3f4ebeb8bf7fbe2f3f673f27bf0e,0x3f42be79bf7abf223ecf3f803efcbf0e,0xbf27bf78be603f463f6a3d49bf5fbf55,0xbf5fbe163f313f7f3f09beacbf73bf55,0x3efc3f7d3f39bdc9bf58bf71bea13f0e
.octa 0x3f733f04be2fbf46bf80bf3ebdfb3f0e,0xbea1bf5cbf7cbf223cc93f2c3f7e3f55,0xbf7ebf4ebecf3dc93f133f673f7f3f55,0x3dfb3f183f6a3f7f3f513edbbd97bf0e,0x3f7f3f783f583f223eb83d49be89bf0e,0x3d97be79bf09bf46bf6fbf80bf77bf55,0xbf77bf7dbf80bf7fbf7abf71bf65bf55,0xbe89be16bcc93dc93e603eac3ee63f0e
.octa 0xbf7e3f80bf803f7fbf7c3f78bf733f6d,0x3dfbbd49bcc93dc9be2f3e79bea13ec4,0x3d97beac3f13bf463f6abf7d3f7ebf6d,0xbf7f3f71bf513f22becf3e163dfbbec4,0x3f77bf3e3eb83dc9bf093f5cbf7f3f6d,0x3e89bf2c3f6fbf7f3f58bf043d973ec4,0xbee63f67bf7a3f22bcc9bf183f77bf6d,0x3f65bedbbe603f46bf803f4ebe89bec4
.octa 0xbf4a3d493f39bf7f3f133e79bf653f6d,0xbf1d3f80bf31bdc93f51bf783ee63ec4,0x3f42bf713e2f3f46bf6f3e163f4abf6d,0xbf27beac3f7cbf22beb83f7dbf1dbec4,0x3efc3f2cbf6abdc93f7abf04bf273f6d,0x3f5fbf3ebecf3f7fbe60bf5c3f423ec4,0xbf733edb3f58bf22bf313f4e3efcbf6d,0x3ea13f67bf09bf463f393f18bf5fbec4
.octa 0xbdfbbf80bcc93f7f3e2fbf78bea13f6d,0xbf7e3d493f803dc9bf7cbe793f733ec4,0x3f7f3eacbf51bf463ecf3f7d3dfbbf6d,0x3d97bf71bf133f223f6abe16bf7ebec4,0xbe893f3e3f6f3dc9bf58bf5c3d973f6d,0x3f773f2cbeb8bf7fbf093f043f7f3ec4,0xbf65bf67be603f223f803f18be89bf6d,0xbee63edb3f7a3f46bcc9bf4ebf77bec4
.octa 0x3f1dbd49bf31bf7fbf51be793ee63f6d,0xbf4abf80bf39bdc93f133f783f653ec4,0x3f273f713f7c3f463eb8be16bf1dbf6d,0x3f423eacbe2fbf22bf6fbf7dbf4abec4,0xbf5fbf2cbecfbdc93e603f043f423f6d,0x3efc3f3e3f6a3f7f3f7a3f5c3f273ec4,0xbea1bedbbf09bf22bf39bf4ebf5fbf6d,0xbf73bf67bf58bf46bf31bf18befcbec4
.octa 0xbf423f4ebf583f62bf6a3f71bf773f7b,0x3f27bf183f09bef13ecfbeac3e89be48,0xbf5f3f78bf803f75bf583f2cbee63e48,0x3efcbe79bcc93e95bf093f3ebf653f7b,0xbf733f7dbf513ef1bcc9bedb3f4abf7b,0x3ea13e16bf133f62bf803f67bf1d3e48,0xbf7e3f5cbeb8be953f51bf803f42be48,0x3dfb3f04bf6f3f75bf13bd493f27bf7b
.octa 0xbf7f3f183e60bf623f6fbeacbefc3f7b,0xbd973f4ebf7a3ef13eb8bf713f5fbe48,0xbf773e793f39bf753e603f3ebf733e48,0xbe893f78bf31be953f7abf2cbea13f7b,0xbf65be163f7cbef1bf313f673dfbbf7b,0xbee63f7dbe2fbf623f393edbbf7e3e48,0xbf4abf043f6a3e95bf7cbd493f7fbe48,0xbf1d3f5c3ecfbf75be2f3f80bd97bf7b
.octa 0xbf27bf4e3f093f62becfbf713e893f7b,0xbf423f183f58bef1bf6a3eac3f77be48,0xbefcbf78bcc93f753f09bf2cbf653e48,0xbf5f3e793f803e95bf58bf3e3ee63f7b,0xbea1bf7dbf133ef13f803edbbf1dbf7b,0xbf73be163f513f62bcc9bf67bf4a3e48,0xbdfbbf5cbf6fbe953f133f803f27be48,0xbf7ebf043eb83f753f513d49bf42bf7b
.octa 0x3d97bf18bf7abf62beb83eac3f5f3f7b,0xbf7fbf4ebe603ef13f6f3f713efcbe48,0x3e89be79bf31bf75bf7abf3ebea13e48,0xbf77bf78bf39be953e603f2c3f733f7b,0x3ee63e16be2fbef1bf39bf67bf7ebf7b,0xbf65bf7dbf7cbf62bf31bedbbdfb3e48,0x3f1d3f043ecf3e953e2f3d49bd97be48,0xbf4abf5cbf6abf75bf7cbf80bf7fbf7b
.octa 0x3f5c3f653f6d3f743f793f7d3f7f3f80,0xbf03bee3bec0be9bbe6abe1cbd9d8000,0xbeabbd8a3e513eec3f2f3f5b3f773f80,0xbf71bf7fbf7bbf63bf3bbf05be8a8000,0xbf7dbf73bf33be9b3e263f173f643f80,0x3e13bea4bf37bf74bf7dbf4fbee88000,0xbd56bf28bf7cbf63bed43e733f493f80,0x3f803f413e3fbeecbf69bf79bf1e8000
.octa 0x3f783ee3bec8bf74bf5abe1c3f273f80,0x3e7c3f653f6c3e9bbf07bf7dbf428000,0x3edc3f7f3f0cbeecbf80bf053efb3f80,0xbf67bd8a3f563f633d0abf5bbf5f8000,0xbf4d3ea43f803e9bbf50bf4f3e9f3f80,0xbf19bf733c173f743f15bf17bf738000,0xbf3ebf413f103f63beb4bf793df43f80,0x3f2bbf28bf543eec3f70be73bf7e8000
.octa 0x3f03bf65bec03f743e6abf7dbd9d3f80,0x3f5c3ee3bf6dbe9b3f793e1cbf7f8000,0x3f713d8abf7b3eec3f3bbf5bbe8a3f80,0xbeab3f7fbe51bf633f2f3f05bf778000,0xbe133f73bf37be9b3f7dbf17bee83f80,0xbf7d3ea43f33bf743e263f4fbf648000,0xbf803f283e3fbf633f69be73bf1e3f80,0xbd56bf413f7cbeecbed43f79bf498000
.octa 0xbe7cbee33f6cbf743f073e1cbf423f80,0x3f78bf653ec83e9bbf5a3f7dbf278000,0x3f67bf7f3f56beecbd0a3f05bf5f3f80,0x3edc3d8abf0c3f63bf803f5bbefb8000,0x3f19bea43c173e9bbf153f4fbf733f80,0xbf4d3f73bf803f74bf503f17be9f8000,0xbf2b3f41bf543f63bf703f79bf7e3f80,0xbf3e3f28bf103eecbeb43e73bdf48000
.octa 0x3ed13ef43f0b3f1b3f2a3f383f453f51,0xbf6abf61bf57bf4cbf3fbf32bf23bf13,0xbf14bf47bf6bbf7ebf7ebf6bbf46bf13,0x3f513f213ecb3e0abe0dbecdbf22bf51,0x3f3a3f753f7c3f4c3edfbc97bef0bf51,0xbf30be923e383f1b3f663f803f623f13,0xbf59bf7fbf38be0a3f023f6e3f753f13,0x3f08bdd5bf32bf7ebf5dbebb3e933f51
.octa 0x3f6f3f613e57bf1bbf80bf323dc23f51,0xbeb73ef43f7a3f4c3d6fbf38bf7fbf13,0xbf7cbf213ebd3f7e3f1abecdbf7fbf13,0x3e2cbf47bf6ebe0a3f4c3f6b3dcfbf51,0x3f803e92bf53bf4c3ea83f803e96bf51,0x3ce23f753f11bf1bbf723c973f753f13,0xbf7a3dd53f803e0abf78bebb3f613f13,0xbe63bf7fbc7b3f7e3e81bf6ebef33f51
.octa 0x3f6abef4bf573f1b3f3fbf38bf233f51,0x3ed13f61bf0bbf4c3f2a3f32bf45bf13,0xbf513f473ecbbf7e3e0d3f6bbf22bf13,0xbf14bf213f6b3e0abf7e3ecd3f46bf51,0x3f30bf753e383f4cbf663c973f62bf51,0x3f3a3e92bf7c3f1b3edfbf803ef03f13,0xbf083f7fbf32be0a3f5dbf6e3e933f13,0xbf593dd53f38bf7e3f023ebbbf753f51
.octa 0x3eb7bf613f7abf1bbd6f3f32bf7f3f51,0x3f6fbef4be573f4cbf803f38bdc2bf13,0xbe2c3f21bf6e3f7ebf4c3ecd3dcfbf13,0xbf7c3f47bebdbe0a3f1abf6b3f7fbf51,0xbce2be923f11bf4c3f72bf803f75bf51,0x3f80bf753f53bf1b3ea8bc97be963f13,0x3e63bdd5bc7b3e0abe813ebbbef33f13,0xbf7a3f7fbf803f7ebf783f6ebf613f51
.octa 0xbe45bdeebd233d173de83e423e873eac,0xbf7bbf7ebf80bf80bf7ebf7bbf77bf71,0x3f803f763f5a3f2e3eea3e4ebd90beac,0x3b493e8c3f063f3c3f643f7b3f7f3f71,0xbe4bbf1fbf68bf80bf60bf10be003eac,0x3f7b3f493ed7bd17bef8bf54bf7ebf71,0xbf6cbefa3e203f3c3f7f3f563ea2beac,0xbec5bf60bf7dbf2ebda93f0d3f733f71
.octa 0x3f0f3f7e3f3cbd17bf48bf7bbefe3eac,0xbf54bdee3f2e3f803f1fbe42bf5ebf71,0x3f34be8cbf79bf2e3e9c3f7b3f28beac,0x3f363f763e70bf3cbf74be4e3f413f71,0xbf55bf493eb13f803e8dbf54bf4a3eac,0x3f0ebf1fbf703d173f763f10bf1dbf71,0xbec23f603f17bf3cbf433f0d3f65beac,0xbf6dbefa3f4f3f2ebf25bf563ee53f71
.octa 0x3f7b3deebf803d173f7ebe42bf773eac,0xbe453f7e3d23bf803de83f7bbe87bf71,0xbb49bf763f063f2ebf64be4e3f7fbeac,0x3f80be8cbf5a3f3c3eeabf7b3d903f71,0xbf7b3f1f3ed7bf803ef83f10bf7e3eac,0xbe4bbf493f68bd17bf603f543e00bf71,0x3ec53efabf7d3f3c3da9bf563f73beac,0xbf6c3f60be20bf2e3f7fbf0dbea23f71
.octa 0x3f54bf7e3f2ebd17bf1f3f7bbf5e3eac,0x3f0f3deebf3c3f80bf483e423efebf71,0xbf363e8c3e70bf2e3f74bf7b3f41beac,0x3f34bf763f79bf3c3e9c3e4ebf283f71,0xbf0e3f49bf703f80bf763f54bf1d3eac,0xbf553f1fbeb13d173e8dbf103f4abf71,0x3f6dbf603f4fbf3c3f25bf0d3ee5beac,0xbec23efabf173f2ebf433f56bf653f71
.octa 0xbf39bf2bbf1cbf0cbef6bed2beaebe89,0xbf31bf3fbf4bbf57bf61bf69bf71bf77,0xbf13beaabd843e543eed3f2f3f5b3f77,0xbf52bf72bf7fbf7abf63bf3abf04be89,0xbece3d623f003f573f7f3f6f3f2d3e89,0xbf6abf80bf5ebf0cbddb3eb53f3d3f77,0xbe5d3ede3f663f7a3f243cfbbf18bf77,0xbf7abf67bee23e543f443f803f4e3e89
.octa 0xbcb03f3f3f7e3f0cbe90bf69bf68be89,0xbf80bf2b3e073f573f763ed2bed9bf77,0x3e323f723f40be54bf74bf3a3e763f77,0xbf7cbeaa3f293f7a3e99bf2fbf79be89,0x3eba3f803e84bf57bf473eb53f803e89,0xbf6f3d623f773f0cbf21bf6f3d3c3f77,0x3f0a3f67bea5bf7a3db63f803e19bf77,0xbf583ede3f72be54bf7fbcfb3f7d3e89
.octa 0x3f313f2bbf4bbf0c3f613ed2bf71be89,0xbf393f3f3f1cbf57bef63f693eaebf77,0x3f523eaabf7f3e543f63bf2fbf043f77,0xbf133f723d84bf7a3eed3f3abf5bbe89,0x3f6abd62bf5e3f573ddbbf6f3f3d3e89,0xbece3f80bf00bf0c3f7fbeb5bf2d3f77,0x3f7abedebee23f7abf44bcfb3f4ebf77,0xbe5d3f67bf663e543f24bf803f183e89
.octa 0x3f80bf3f3e073f0cbf763f69bed9be89,0xbcb03f2bbf7e3f57be90bed23f68bf77,0x3f7cbf723f29be54be993f3abf793f77,0x3e323eaabf403f7abf743f2fbe76be89,0x3f6fbf803f77bf573f21beb53d3c3e89,0x3ebabd62be843f0cbf473f6fbf803f77,0x3f58bf673f72bf7a3f7fbf803f7dbf77,0x3f0abede3ea5be543db63cfbbe193e89
.octa 0x3f033ee33ec03e9b3e6a3e1c3d9d0000,0x3f5c3f653f6d3f743f793f7d3f7f3f80,0x3f713f7f3f7b3f633f3b3f053e8a0000,0xbeabbd8a3e513eec3f2f3f5b3f773f80,0xbe133ea43f373f743f7d3f4f3ee80000,0xbf7dbf73bf33be9b3e263f173f643f80,0xbf80bf41be3f3eec3f693f793f1e0000,0xbd56bf28bf7cbf63bed43e733f493f80
.octa 0xbe7cbf65bf6cbe9b3f073f7d3f420000,0x3f783ee3bec8bf74bf5abe1c3f273f80,0x3f673d8abf56bf63bd0a3f5b3f5f0000,0x3edc3f7f3f0cbeecbf80bf053efb3f80,0x3f193f73bc17bf74bf153f173f730000,0xbf4d3ea43f803e9bbf50bf4f3e9f3f80,0xbf2b3f283f54beecbf703e733f7e0000,0xbf3ebf413f103f63beb4bf793df43f80
.octa 0xbf5cbee33f6d3e9bbf79be1c3f7f0000,0x3f03bf65bec03f743e6abf7dbd9d3f80,0x3eabbf7f3e513f63bf2fbf053f770000,0x3f713d8abf7b3eec3f3bbf5bbe8a3f80,0x3f7dbea4bf333f74be26bf4f3f640000,0xbe133f73bf37be9b3f7dbf17bee83f80,0x3d563f41bf7c3eec3ed4bf793f490000,0xbf803f283e3fbf633f69be73bf1e3f80
.octa 0xbf783f65bec8be9b3f5abf7d3f270000,0xbe7cbee33f6cbf743f073e1cbf423f80,0xbedcbd8a3f0cbf633f80bf5b3efb0000,0x3f67bf7f3f56beecbd0a3f05bf5f3f80,0x3f4dbf733f80bf743f50bf173e9f0000,0x3f19bea43c173e9bbf153f4fbf733f80,0x3f3ebf283f10beec3eb4be733df40000,0xbf2b3f41bf543f63bf703f79bf7e3f80
.octa 0x3f6a3f613f573f4c3f3f3f323f233f13,0x3ed13ef43f0b3f1b3f2a3f383f453f51,0xbf51bf21becbbe0a3e0d3ecd3f223f51,0xbf14bf47bf6bbf7ebf7ebf6bbf46bf13,0x3f303e92be38bf1bbf66bf80bf62bf13,0x3f3a3f753f7c3f4c3edfbc97bef0bf51,0xbf083dd53f323f7e3f5d3ebbbe93bf51,0xbf59bf7fbf38be0a3f023f6e3f753f13
.octa 0x3eb7bef4bf7abf4cbd6f3f383f7f3f13,0x3f6f3f613e57bf1bbf80bf323dc23f51,0xbe2c3f473f6e3e0abf4cbf6bbdcf3f51,0xbf7cbf213ebd3f7e3f1abecdbf7fbf13,0xbce2bf75bf113f1b3f72bc97bf75bf13,0x3f803e92bf53bf4c3ea83f803e96bf51,0x3e633f7f3c7bbf7ebe813f6e3ef3bf51,0xbf7a3dd53f803e0abf78bebb3f613f13
.octa 0xbed1bf613f0b3f4cbf2abf323f453f13,0x3f6abef4bf573f1b3f3fbf38bf233f51,0x3f143f21bf6bbe0a3f7ebecdbf463f51,0xbf513f473ecbbf7e3e0d3f6bbf22bf13,0xbf3abe923f7cbf1bbedf3f80bef0bf13,0x3f30bf753e383f4cbf663c973f62bf51,0x3f59bdd5bf383f7ebf02bebb3f75bf51,0xbf083f7fbf32be0a3f5dbf6e3e933f13
.octa 0xbf6f3ef43e57bf4c3f80bf383dc23f13,0x3eb7bf613f7abf1bbd6f3f32bf7f3f51,0x3f7cbf473ebd3e0abf1a3f6bbf7f3f51,0xbe2c3f21bf6e3f7ebf4c3ecd3dcfbf13,0xbf803f75bf533f1bbea83c973e96bf13,0xbce2be923f11bf4c3f72bf803f75bf51,0x3f7abf7f3f80bf7e3f78bf6e3f61bf51,0x3e63bdd5bc7b3e0abe813ebbbef33f13
.octa 0x3f7b3f7e3f803f803f7e3f7b3f773f71,0xbe45bdeebd233d173de83e423e873eac,0xbb49be8cbf06bf3cbf64bf7bbf7fbf71,0x3f803f763f5a3f2e3eea3e4ebd90beac,0xbf7bbf49bed73d173ef83f543f7e3f71,0xbe4bbf1fbf68bf80bf60bf10be003eac,0x3ec53f603f7d3f2e3da9bf0dbf73bf71,0xbf6cbefa3e203f3c3f7f3f563ea2beac
.octa 0x3f543deebf2ebf80bf1f3e423f5e3f71,0x3f0f3f7e3f3cbd17bf48bf7bbefe3eac,0xbf36bf76be703f3c3f743e4ebf41bf71,0x3f34be8cbf79bf2e3e9c3f7b3f28beac,0xbf0e3f1f3f70bd17bf76bf103f1d3f71,0xbf55bf493eb13f803e8dbf54bf4a3eac,0x3f6d3efabf4fbf2e3f253f56bee5bf71,0xbec23f603f17bf3cbf433f0d3f65beac
.octa 0x3e45bf7ebd233f80bde8bf7b3e873f71,0x3f7b3deebf803d173f7ebe42bf773eac,0xbf803e8c3f5abf3cbeea3f7bbd90bf71,0xbb49bf763f063f2ebf64be4e3f7fbeac,0x3e4b3f49bf683d173f60bf54be003f71,0xbf7b3f1f3ed7bf803ef83f10bf7e3eac,0x3f6cbf603e203f2ebf7f3f0d3ea2bf71,0x3ec53efabf7d3f3c3da9bf563f73beac
.octa 0xbf0fbdee3f3cbf803f48be42befe3f71,0x3f54bf7e3f2ebd17bf1f3f7bbf5e3eac,0xbf343f76bf793f3cbe9cbe4e3f28bf71,0xbf363e8c3e70bf2e3f74bf7b3f41beac,0x3f55bf1f3eb1bd17be8d3f10bf4a3f71,0xbf0e3f49bf703f80bf763f54bf1d3eac,0x3ec2befa3f17bf2e3f43bf563f65bf71,0x3f6dbf603f4fbf3c3f25bf0d3ee5beac
.octa 0x3f313f3f3f4b3f573f613f693f713f77,0xbf39bf2bbf1cbf0cbef6bed2beaebe89,0x3f523f723f7f3f7a3f633f3a3f043e89,0xbf13beaabd843e543eed3f2f3f5b3f77,0x3f6a3f803f5e3f0c3ddbbeb5bf3dbf77,0xbece3d623f003f573f7f3f6f3f2d3e89,0x3f7a3f673ee2be54bf44bf80bf4ebe89,0xbe5d3ede3f663f7a3f243cfbbf18bf77
.octa 0x3f803f2bbe07bf57bf76bed23ed93f77,0xbcb03f3f3f7e3f0cbe90bf69bf68be89,0x3f7c3eaabf29bf7abe993f2f3f793e89,0x3e323f723f40be54bf74bf3a3e763f77,0x3f6fbd62bf77bf0c3f213f6fbd3cbf77,0x3eba3f803e84bf57bf473eb53f803e89,0x3f58bedebf723e543f7f3cfbbf7dbe89,0x3f0a3f67bea5bf7a3db63f803e19bf77
.octa 0x3f39bf3fbf1c3f573ef6bf69beae3f77,0x3f313f2bbf4bbf0c3f613ed2bf71be89,0x3f13bf72bd843f7abeedbf3a3f5b3e89,0x3f523eaabf7f3e543f63bf2fbf043f77,0x3ecebf803f003f0cbf7f3eb53f2dbf77,0x3f6abd62bf5e3f573ddbbf6f3f3d3e89,0x3e5dbf673f66be54bf243f80bf18be89,0x3f7abedebee23f7abf44bcfb3f4ebf77
.octa 0x3cb0bf2b3f7ebf573e903ed2bf683f77,0x3f80bf3f3e073f0cbf763f69bed9be89,0xbe32beaa3f40bf7a3f74bf2f3e763e89,0x3f7cbf723f29be54be993f3abf793f77,0xbeba3d623e84bf0c3f47bf6f3f80bf77,0x3f6fbf803f77bf573f21beb53d3c3e89,0xbf0a3edebea53e54bdb6bcfb3e19be89,0x3f58bf673f72bf7a3f7fbf803f7dbf77
.octa 0xbf5c3f65bf6d3f74bf793f7dbf7f3f80,0x3f03bee33ec0be9b3e6abe1c3d9d8000,0x3eabbd8abe513eecbf2f3f5bbf773f80,0x3f71bf7f3f7bbf633f3bbf053e8a8000,0x3f7dbf733f33be9bbe263f17bf643f80,0xbe13bea43f37bf743f7dbf4f3ee88000,0x3d56bf283f7cbf633ed43e73bf493f80,0xbf803f41be3fbeec3f69bf793f1e8000
.octa 0xbf783ee33ec8bf743f5abe1cbf273f80,0xbe7c3f65bf6c3e9b3f07bf7d3f428000,0xbedc3f7fbf0cbeec3f80bf05befb3f80,0x3f67bd8abf563f63bd0abf5b3f5f8000,0x3f4d3ea4bf803e9b3f50bf4fbe9f3f80,0x3f19bf73bc173f74bf15bf173f738000,0x3f3ebf41bf103f633eb4bf79bdf43f80,0xbf2bbf283f543eecbf70be733f7e8000
.octa 0xbf03bf653ec03f74be6abf7d3d9d3f80,0xbf5c3ee33f6dbe9bbf793e1c3f7f8000,0xbf713d8a3f7b3eecbf3bbf5b3e8a3f80,0x3eab3f7f3e51bf63bf2f3f053f778000,0x3e133f733f37be9bbf7dbf173ee83f80,0x3f7d3ea4bf33bf74be263f4f3f648000,0x3f803f28be3fbf63bf69be733f1e3f80,0x3d56bf41bf7cbeec3ed43f793f498000
.octa 0x3e7cbee3bf6cbf74bf073e1c3f423f80,0xbf78bf65bec83e9b3f5a3f7d3f278000,0xbf67bf7fbf56beec3d0a3f053f5f3f80,0xbedc3d8a3f0c3f633f803f5b3efb8000,0xbf19bea4bc173e9b3f153f4f3f733f80,0x3f4d3f733f803f743f503f173e9f8000,0x3f2b3f413f543f633f703f793f7e3f80,0x3f3e3f283f103eec3eb43e733df48000
.octa 0xbed13ef4bf0b3f1bbf2a3f38bf453f51,0x3f6abf613f57bf4c3f3fbf323f23bf13,0x3f14bf473f6bbf7e3f7ebf6b3f46bf13,0xbf513f21becb3e0a3e0dbecd3f22bf51,0xbf3a3f75bf7c3f4cbedfbc973ef0bf51,0x3f30be92be383f1bbf663f80bf623f13,0x3f59bf7f3f38be0abf023f6ebf753f13,0xbf08bdd53f32bf7e3f5dbebbbe933f51
.octa 0xbf6f3f61be57bf1b3f80bf32bdc23f51,0x3eb73ef4bf7a3f4cbd6fbf383f7fbf13,0x3f7cbf21bebd3f7ebf1abecd3f7fbf13,0xbe2cbf473f6ebe0abf4c3f6bbdcfbf51,0xbf803e923f53bf4cbea83f80be96bf51,0xbce23f75bf11bf1b3f723c97bf753f13,0x3f7a3dd5bf803e0a3f78bebbbf613f13,0x3e63bf7f3c7b3f7ebe81bf6e3ef33f51
.octa 0xbf6abef43f573f1bbf3fbf383f233f51,0xbed13f613f0bbf4cbf2a3f323f45bf13,0x3f513f47becbbf7ebe0d3f6b3f22bf13,0x3f14bf21bf6b3e0a3f7e3ecdbf46bf51,0xbf30bf75be383f4c3f663c97bf62bf51,0xbf3a3e923f7c3f1bbedfbf80bef03f13,0x3f083f7f3f32be0abf5dbf6ebe933f13,0x3f593dd5bf38bf7ebf023ebb3f753f51
.octa 0xbeb7bf61bf7abf1b3d6f3f323f7f3f51,0xbf6fbef43e573f4c3f803f383dc2bf13,0x3e2c3f213f6e3f7e3f4c3ecdbdcfbf13,0x3f7c3f473ebdbe0abf1abf6bbf7fbf51,0x3ce2be92bf11bf4cbf72bf80bf75bf51,0xbf80bf75bf53bf1bbea8bc973e963f13,0xbe63bdd53c7b3e0a3e813ebb3ef33f13,0x3f7a3f7f3f803f7e3f783f6e3f613f51
.octa 0x3e45bdee3d233d17bde83e42be873eac,0x3f7bbf7e3f80bf803f7ebf7b3f77bf71,0xbf803f76bf5a3f2ebeea3e4e3d90beac,0xbb493e8cbf063f3cbf643f7bbf7f3f71,0x3e4bbf1f3f68bf803f60bf103e003eac,0xbf7b3f49bed7bd173ef8bf543f7ebf71,0x3f6cbefabe203f3cbf7f3f56bea2beac,0x3ec5bf603f7dbf2e3da93f0dbf733f71
.octa 0xbf0f3f7ebf3cbd173f48bf7b3efe3eac,0x3f54bdeebf2e3f80bf1fbe423f5ebf71,0xbf34be8c3f79bf2ebe9c3f7bbf28beac,0xbf363f76be70bf3c3f74be4ebf413f71,0x3f55bf49beb13f80be8dbf543f4a3eac,0xbf0ebf1f3f703d17bf763f103f1dbf71,0x3ec23f60bf17bf3c3f433f0dbf65beac,0x3f6dbefabf4f3f2e3f25bf56bee53f71
.octa 0xbf7b3dee3f803d17bf7ebe423f773eac,0x3e453f7ebd23bf80bde83f7b3e87bf71,0x3b49bf76bf063f2e3f64be4ebf7fbeac,0xbf80be8c3f5a3f3cbeeabf7bbd903f71,0x3f7b3f1fbed7bf80bef83f103f7e3eac,0x3e4bbf49bf68bd173f603f54be00bf71,0xbec53efa3f7d3f3cbda9bf56bf73beac,0x3f6c3f603e20bf2ebf7fbf0d3ea23f71
.octa 0xbf54bf7ebf2ebd173f1f3f7b3f5e3eac,0xbf0f3dee3f3c3f803f483e42befebf71,0x3f363e8cbe70bf2ebf74bf7bbf41beac,0xbf34bf76bf79bf3cbe9c3e4e3f283f71,0x3f0e3f493f703f803f763f543f1d3eac,0x3f553f1f3eb13d17be8dbf10bf4abf71,0xbf6dbf60bf4fbf3cbf25bf0dbee5beac,0x3ec23efa3f173f2e3f433f563f653f71
.octa 0x3f39bf2b3f1cbf0c3ef6bed23eaebe89,0x3f31bf3f3f4bbf573f61bf693f71bf77,0x3f13beaa3d843e54beed3f2fbf5b3f77,0x3f52bf723f7fbf7a3f63bf3a3f04be89,0x3ece3d62bf003f57bf7f3f6fbf2d3e89,0x3f6abf803f5ebf0c3ddb3eb5bf3d3f77,0x3e5d3edebf663f7abf243cfb3f18bf77,0x3f7abf673ee23e54bf443f80bf4e3e89
.octa 0x3cb03f3fbf7e3f0c3e90bf693f68be89,0x3f80bf2bbe073f57bf763ed23ed9bf77,0xbe323f72bf40be543f74bf3abe763f77,0x3f7cbeaabf293f7abe99bf2f3f79be89,0xbeba3f80be84bf573f473eb5bf803e89,0x3f6f3d62bf773f0c3f21bf6fbd3c3f77,0xbf0a3f673ea5bf7abdb63f80be19bf77,0x3f583edebf72be543f7fbcfbbf7d3e89
.octa 0xbf313f2b3f4bbf0cbf613ed23f71be89,0x3f393f3fbf1cbf573ef63f69beaebf77,0xbf523eaa3f7f3e54bf63bf2f3f043f77,0x3f133f72bd84bf7abeed3f3a3f5bbe89,0xbf6abd623f5e3f57bddbbf6fbf3d3e89,0x3ece3f803f00bf0cbf7fbeb53f2d3f77,0xbf7abede3ee23f7a3f44bcfbbf4ebf77,0x3e5d3f673f663e54bf24bf80bf183e89
.octa 0xbf80bf3fbe073f0c3f763f693ed9be89,0x3cb03f2b3f7e3f573e90bed2bf68bf77,0xbf7cbf72bf29be543e993f3a3f793f77,0xbe323eaa3f403f7a3f743f2f3e76be89,0xbf6fbf80bf77bf57bf21beb5bd3c3e89,0xbebabd623e843f0c3f473f6f3f803f77,0xbf58bf67bf72bf7abf7fbf80bf7dbf77,0xbf0abedebea5be54bdb63cfb3e193e89
.octa 0xbf033ee3bec03e9bbe6a3e1cbd9d0000,0xbf5c3f65bf6d3f74bf793f7dbf7f3f80,0xbf713f7fbf7b3f63bf3b3f05be8a0000,0x3eabbd8abe513eecbf2f3f5bbf773f80,0x3e133ea4bf373f74bf7d3f4fbee80000,0x3f7dbf733f33be9bbe263f17bf643f80,0x3f80bf413e3f3eecbf693f79bf1e0000,0x3d56bf283f7cbf633ed43e73bf493f80
.octa 0x3e7cbf653f6cbe9bbf073f7dbf420000,0xbf783ee33ec8bf743f5abe1cbf273f80,0xbf673d8a3f56bf633d0a3f5bbf5f0000,0xbedc3f7fbf0cbeec3f80bf05befb3f80,0xbf193f733c17bf743f153f17bf730000,0x3f4d3ea4bf803e9b3f50bf4fbe9f3f80,0x3f2b3f28bf54beec3f703e73bf7e0000,0x3f3ebf41bf103f633eb4bf79bdf43f80
.octa 0x3f5cbee3bf6d3e9b3f79be1cbf7f0000,0xbf03bf653ec03f74be6abf7d3d9d3f80,0xbeabbf7fbe513f633f2fbf05bf770000,0xbf713d8a3f7b3eecbf3bbf5b3e8a3f80,0xbf7dbea43f333f743e26bf4fbf640000,0x3e133f733f37be9bbf7dbf173ee83f80,0xbd563f413f7c3eecbed4bf79bf490000,0x3f803f28be3fbf63bf69be733f1e3f80
.octa 0x3f783f653ec8be9bbf5abf7dbf270000,0x3e7cbee3bf6cbf74bf073e1c3f423f80,0x3edcbd8abf0cbf63bf80bf5bbefb0000,0xbf67bf7fbf56beec3d0a3f053f5f3f80,0xbf4dbf73bf80bf74bf50bf17be9f0000,0xbf19bea4bc173e9b3f153f4f3f733f80,0xbf3ebf28bf10beecbeb4be73bdf40000,0x3f2b3f413f543f633f703f793f7e3f80
.octa 0xbf6a3f61bf573f4cbf3f3f32bf233f13,0xbed13ef4bf0b3f1bbf2a3f38bf453f51,0x3f51bf213ecbbe0abe0d3ecdbf223f51,0x3f14bf473f6bbf7e3f7ebf6b3f46bf13,0xbf303e923e38bf1b3f66bf803f62bf13,0xbf3a3f75bf7c3f4cbedfbc973ef0bf51,0x3f083dd5bf323f7ebf5d3ebb3e93bf51,0x3f59bf7f3f38be0abf023f6ebf753f13
.octa 0xbeb7bef43f7abf4c3d6f3f38bf7f3f13,0xbf6f3f61be57bf1b3f80bf32bdc23f51,0x3e2c3f47bf6e3e0a3f4cbf6b3dcf3f51,0x3f7cbf21bebd3f7ebf1abecd3f7fbf13,0x3ce2bf753f113f1bbf72bc973f75bf13,0xbf803e923f53bf4cbea83f80be96bf51,0xbe633f7fbc7bbf7e3e813f6ebef3bf51,0x3f7a3dd5bf803e0a3f78bebbbf613f13
.octa 0x3ed1bf61bf0b3f4c3f2abf32bf453f13,0xbf6abef43f573f1bbf3fbf383f233f51,0xbf143f213f6bbe0abf7ebecd3f463f51,0x3f513f47becbbf7ebe0d3f6b3f22bf13,0x3f3abe92bf7cbf1b3edf3f803ef0bf13,0xbf30bf75be383f4c3f663c97bf62bf51,0xbf59bdd53f383f7e3f02bebbbf75bf51,0x3f083f7f3f32be0abf5dbf6ebe933f13
.octa 0x3f6f3ef4be57bf4cbf80bf38bdc23f13,0xbeb7bf61bf7abf1b3d6f3f323f7f3f51,0xbf7cbf47bebd3e0a3f1a3f6b3f7f3f51,0x3e2c3f213f6e3f7e3f4c3ecdbdcfbf13,0x3f803f753f533f1b3ea83c97be96bf13,0x3ce2be92bf11bf4cbf72bf80bf75bf51,0xbf7abf7fbf80bf7ebf78bf6ebf61bf51,0xbe63bdd53c7b3e0a3e813ebb3ef33f13
.octa 0xbf7b3f7ebf803f80bf7e3f7bbf773f71,0x3e45bdee3d233d17bde83e42be873eac,0x3b49be8c3f06bf3c3f64bf7b3f7fbf71,0xbf803f76bf5a3f2ebeea3e4e3d90beac,0x3f7bbf493ed73d17bef83f54bf7e3f71,0x3e4bbf1f3f68bf803f60bf103e003eac,0xbec53f60bf7d3f2ebda9bf0d3f73bf71,0x3f6cbefabe203f3cbf7f3f56bea2beac
.octa 0xbf543dee3f2ebf803f1f3e42bf5e3f71,0xbf0f3f7ebf3cbd173f48bf7b3efe3eac,0x3f36bf763e703f3cbf743e4e3f41bf71,0xbf34be8c3f79bf2ebe9c3f7bbf28beac,0x3f0e3f1fbf70bd173f76bf10bf1d3f71,0x3f55bf49beb13f80be8dbf543f4a3eac,0xbf6d3efa3f4fbf2ebf253f563ee5bf71,0x3ec23f60bf17bf3c3f433f0dbf65beac
.octa 0xbe45bf7e3d233f803de8bf7bbe873f71,0xbf7b3dee3f803d17bf7ebe423f773eac,0x3f803e8cbf5abf3c3eea3f7b3d90bf71,0x3b49bf76bf063f2e3f64be4ebf7fbeac,0xbe4b3f493f683d17bf60bf543e003f71,0x3f7b3f1fbed7bf80bef83f103f7e3eac,0xbf6cbf60be203f2e3f7f3f0dbea2bf71,0xbec53efa3f7d3f3cbda9bf56bf73beac
.octa 0x3f0fbdeebf3cbf80bf48be423efe3f71,0xbf54bf7ebf2ebd173f1f3f7b3f5e3eac,0x3f343f763f793f3c3e9cbe4ebf28bf71,0x3f363e8cbe70bf2ebf74bf7bbf41beac,0xbf55bf1fbeb1bd173e8d3f103f4a3f71,0x3f0e3f493f703f803f763f543f1d3eac,0xbec2befabf17bf2ebf43bf56bf65bf71,0xbf6dbf60bf4fbf3cbf25bf0dbee5beac
.octa 0xbf313f3fbf4b3f57bf613f69bf713f77,0x3f39bf2b3f1cbf0c3ef6bed23eaebe89,0xbf523f72bf7f3f7abf633f3abf043e89,0x3f13beaa3d843e54beed3f2fbf5b3f77,0xbf6a3f80bf5e3f0cbddbbeb53f3dbf77,0x3ece3d62bf003f57bf7f3f6fbf2d3e89,0xbf7a3f67bee2be543f44bf803f4ebe89,0x3e5d3edebf663f7abf243cfb3f18bf77
.octa 0xbf803f2b3e07bf573f76bed2bed93f77,0x3cb03f3fbf7e3f0c3e90bf693f68be89,0xbf7c3eaa3f29bf7a3e993f2fbf793e89,0xbe323f72bf40be543f74bf3abe763f77,0xbf6fbd623f77bf0cbf213f6f3d3cbf77,0xbeba3f80be84bf573f473eb5bf803e89,0xbf58bede3f723e54bf7f3cfb3f7dbe89,0xbf0a3f673ea5bf7abdb63f80be19bf77
.octa 0xbf39bf3f3f1c3f57bef6bf693eae3f77,0xbf313f2b3f4bbf0cbf613ed23f71be89,0xbf13bf723d843f7a3eedbf3abf5b3e89,0xbf523eaa3f7f3e54bf63bf2f3f043f77,0xbecebf80bf003f0c3f7f3eb5bf2dbf77,0xbf6abd623f5e3f57bddbbf6fbf3d3e89,0xbe5dbf67bf66be543f243f803f18be89,0xbf7abede3ee23f7a3f44bcfbbf4ebf77
.octa 0xbcb0bf2bbf7ebf57be903ed23f683f77,0xbf80bf3fbe073f0c3f763f693ed9be89,0x3e32beaabf40bf7abf74bf2fbe763e89,0xbf7cbf72bf29be543e993f3a3f793f77,0x3eba3d62be84bf0cbf47bf6fbf80bf77,0xbf6fbf80bf77bf57bf21beb5bd3c3e89,0x3f0a3ede3ea53e543db6bcfbbe19be89,0xbf58bf67bf72bf7abf7fbf80bf7dbf77
.octa 0x3f593f633f6c3f733f793f7d3f7f3f80,0xbf08beecbec7bea1be73be23bda38000,0xbeb5bdb03e423ee63f2d3f5a3f763f80,0xbf6fbf7fbf7bbf65bf3dbf06be8c8000,0xbf7cbf74bf36bea13e1c3f163f643f80,0x3e29be9bbf34bf73bf7dbf4fbee98000,0xbcfbbf25bf7bbf65bed83e6d3f493f80,0x3f803f443e4ebee6bf68bf79bf1f8000
.octa 0x3f793eecbec1bf73bf5bbe233f263f80,0x3e663f633f6d3ea1bf05bf7dbf438000,0x3ed23f7f3f10bee6bf80bf063efa3f80,0xbf69bdb03f543f653d30bf5abf608000,0xbf503e9b3f803ea1bf4fbf4f3e9e3f80,0xbf15bf74bbc93f733f17bf16bf748000,0xbf3abf443f0d3f65beafbf793dee3f80,0x3f2fbf25bf563ee63f71be6dbf7e8000
.octa 0x3f08bf63bec73f733e73bf7dbda33f80,0x3f593eecbf6cbea13f793e23bf7f8000,0x3f6f3db0bf7b3ee63f3dbf5abe8c3f80,0xbeb53f7fbe42bf653f2d3f06bf768000,0xbe293f74bf34bea13f7dbf16bee93f80,0xbf7c3e9b3f36bf733e1c3f4fbf648000,0xbf803f253e4ebf653f68be6dbf1f3f80,0xbcfbbf443f7bbee6bed83f79bf498000
.octa 0xbe66beec3f6dbf733f053e23bf433f80,0x3f79bf633ec13ea1bf5b3f7dbf268000,0x3f69bf7f3f54bee6bd303f06bf603f80,0x3ed23db0bf103f65bf803f5abefa8000,0x3f15be9bbbc93ea1bf173f4fbf743f80,0xbf503f74bf803f73bf4f3f16be9e8000,0xbf2f3f44bf563f65bf713f79bf7e3f80,0xbf3a3f25bf0d3ee6beaf3e6dbdee8000
.octa 0x3ebb3ee13f023f133f243f333f413f4e,0xbf6ebf66bf5cbf51bf45bf37bf28bf18,0xbf0abf40bf67bf7cbf7fbf6ebf4bbf18,0x3f573f2a3ede3e2fbdd5bebebf1cbf4e,0x3f323f723f7d3f513eef3c49bee3bf4e,0xbf38bea73e103f133f633f803f653f18,0xbf52bf80bf3fbe2f3ef43f6b3f773f18,0x3f12bd7bbf2bbf7cbf61beca3e863f4e
.octa 0x3f6b3f663e7fbf13bf7fbf373d8a3f4e,0xbecd3ee13f783f513dbcbf33bf7fbf18,0xbf7abf2a3eaa3f7c3f21bebebf7ebf18,0x3e5abf40bf72be2f3f473f6e3e04bf4e,0x3f803ea7bf4dbf513e983f803ea4bf4e,0xbc973f723f1abf13bf75bc493f733f18,0xbf7c3d7b3f803e2fbf75beca3f5e3f18,0xbe35bf80bd623f7c3e92bf6bbeff3f4e
.octa 0x3f6ebee1bf5c3f133f45bf33bf283f4e,0x3ebb3f66bf02bf513f243f37bf41bf18,0xbf573f403edebf7c3dd53f6ebf1cbf18,0xbf0abf2a3f673e2fbf7f3ebe3f4bbf4e,0x3f38bf723e103f51bf63bc493f65bf4e,0x3f323ea7bf7d3f133eefbf803ee33f18,0xbf123f80bf2bbe2f3f61bf6b3e863f18,0xbf523d7b3f3fbf7c3ef43ecabf773f4e
.octa 0x3ecdbf663f78bf13bdbc3f37bf7f3f4e,0x3f6bbee1be7f3f51bf7f3f33bd8abf18,0xbe5a3f2abf723f7cbf473ebe3e04bf18,0xbf7a3f40beaabe2f3f21bf6e3f7ebf4e,0x3c97bea73f1abf513f75bf803f73bf4e,0x3f80bf723f4dbf133e983c49bea43f18,0x3e35bd7bbd623e2fbe923ecabeff3f18,0xbf7c3f80bf803f7cbf753f6bbf5e3f4e
.octa 0xbe86be3bbdd5bcc93d623e0a3e5a3e95,0xbf77bf7cbf7fbf80bf80bf7ebf7abf75,0x3f7f3f7a3f633f393f023e82bc97be95,0xbd8a3e543eef3f313f5c3f783f803f75,0xbe04bf11bf61bf80bf67bf1bbe353e95,0x3f7e3f533ef43cc9bedebf4cbf7cbf75,0xbf73bf0c3dbc3f313f7d3f5d3ebbbe95,0xbea4bf57bf7fbf39be103f013f6e3f75
.octa 0x3eff3f7c3f473cc9bf3fbf7ebf0a3e95,0xbf5ebe3b3f213f803f2bbe0abf57bf75,0x3f41be54bf75bf393e7f3f783f32be95,0x3f283f7a3e98bf31bf78be823f383f75,0xbf4bbf533e923f803eaabf4cbf523e95,0x3f1cbf11bf75bcc93f723f1bbf12bf75,0xbee33f573f24bf31bf4d3f013f6bbe95,0xbf65bf0c3f453f39bf1abf5d3ecd3f75
.octa 0x3f773e3bbf7fbcc93f80be0abf7a3e95,0xbe863f7c3dd5bf803d623f7ebe5abf75,0x3d8abf7a3eef3f39bf5cbe823f80be95,0x3f7fbe54bf633f313f02bf783c973f75,0xbf7e3f113ef4bf803ede3f1bbf7c3e95,0xbe04bf533f613cc9bf673f4c3e35bf75,0x3ea43f0cbf7f3f313e10bf5d3f6ebe95,0xbf733f57bdbcbf393f7dbf01bebb3f75
.octa 0x3f5ebf7c3f213cc9bf2b3f7ebf573e95,0x3eff3e3bbf473f80bf3f3e0a3f0abf75,0xbf283e543e98bf393f78bf783f38be95,0x3f41bf7a3f75bf313e7f3e82bf323f75,0xbf1c3f53bf753f80bf723f4cbf123e95,0xbf4b3f11be92bcc93eaabf1b3f52bf75,0x3f65bf573f45bf313f1abf013ecdbe95,0xbee33f0cbf243f39bf4d3f5dbf6b3f75
.octa 0xbf49bf3cbf2dbf1dbf0dbef7bed2beac,0xbf1fbf2ebf3dbf4abf56bf60bf69bf71,0xbf26bed5be1c3dfb3ec73f203f503f71,0xbf43bf69bf7dbf7ebf6cbf48bf15beac,0xbefabd173ed83f4a3f7b3f763f3a3eac,0xbf60bf80bf68bf1dbe423e8f3f2f3f71,0xbe9e3eb23f5b3f7e3f343de2bf08bf71,0xbf74bf70bf053dfb3f363f7e3f593eac
.octa 0xbdee3f2e3f803f1dbe4ebf60bf6fbeac,0xbf7ebf3c3d303f4a3f7b3ef7beb5bf71,0x3da33f693f4fbdfbbf6dbf483e293f71,0xbf7fbed53f173f7e3ec1bf20bf7cbeac,0x3e8c3f803eafbf4abf543e8f3f803eac,0xbf76bd173f713f1dbf10bf76bcfb3f71,0x3ee93f70be73bf7e3bc93f7e3e66bf71,0xbf643eb23f79bdfbbf80bde23f793eac
.octa 0x3f1f3f3cbf3dbf1d3f563ef7bf69beac,0xbf493f2e3f2dbf4abf0d3f603ed2bf71,0x3f433ed5bf7d3dfb3f6cbf20bf153f71,0xbf263f693e1cbf7e3ec73f48bf50beac,0x3f603d17bf683f4a3e42bf763f2f3eac,0xbefa3f80bed8bf1d3f7bbe8fbf3a3f71,0x3f74beb2bf053f7ebf36bde23f59bf71,0xbe9e3f70bf5b3dfb3f34bf7e3f083eac
.octa 0x3f7ebf2e3d303f1dbf7b3f60beb5beac,0xbdee3f3cbf803f4abe4ebef73f6fbf71,0x3f7fbf693f17bdfbbec13f48bf7c3f71,0x3da33ed5bf4f3f7ebf6d3f20be29beac,0x3f76bf803f71bf4a3f10be8fbcfb3eac,0x3e8c3d17beaf3f1dbf543f76bf803f71,0x3f64bf703f79bf7e3f80bf7e3f79bf71,0x3ee9beb23e73bdfb3bc93de2be663eac
.octa 0x3f083eec3ec73ea13e733e233da30000,0x3f593f633f6c3f733f793f7d3f7f3f80,0x3f6f3f7f3f7b3f653f3d3f063e8c0000,0xbeb5bdb03e423ee63f2d3f5a3f763f80,0xbe293e9b3f343f733f7d3f4f3ee90000,0xbf7cbf74bf36bea13e1c3f163f643f80,0xbf80bf44be4e3ee63f683f793f1f0000,0xbcfbbf25bf7bbf65bed83e6d3f493f80
.octa 0xbe66bf63bf6dbea13f053f7d3f430000,0x3f793eecbec1bf73bf5bbe233f263f80,0x3f693db0bf54bf65bd303f5a3f600000,0x3ed23f7f3f10bee6bf80bf063efa3f80,0x3f153f743bc9bf73bf173f163f740000,0xbf503e9b3f803ea1bf4fbf4f3e9e3f80,0xbf2f3f253f56bee6bf713e6d3f7e0000,0xbf3abf443f0d3f65beafbf793dee3f80
.octa 0xbf59beec3f6c3ea1bf79be233f7f0000,0x3f08bf63bec73f733e73bf7dbda33f80,0x3eb5bf7f3e423f65bf2dbf063f760000,0x3f6f3db0bf7b3ee63f3dbf5abe8c3f80,0x3f7cbe9bbf363f73be1cbf4f3f640000,0xbe293f74bf34bea13f7dbf16bee93f80,0x3cfb3f44bf7b3ee63ed8bf793f490000,0xbf803f253e4ebf653f68be6dbf1f3f80
.octa 0xbf793f63bec1bea13f5bbf7d3f260000,0xbe66beec3f6dbf733f053e23bf433f80,0xbed2bdb03f10bf653f80bf5a3efa0000,0x3f69bf7f3f54bee6bd303f06bf603f80,0x3f50bf743f80bf733f4fbf163e9e0000,0x3f15be9bbbc93ea1bf173f4fbf743f80,0x3f3abf253f0dbee63eafbe6d3dee0000,0xbf2f3f44bf563f65bf713f79bf7e3f80
.octa 0x3f6e3f663f5c3f513f453f373f283f18,0x3ebb3ee13f023f133f243f333f413f4e,0xbf57bf2abedebe2f3dd53ebe3f1c3f4e,0xbf0abf40bf67bf7cbf7fbf6ebf4bbf18,0x3f383ea7be10bf13bf63bf80bf65bf18,0x3f323f723f7d3f513eef3c49bee3bf4e,0xbf123d7b3f2b3f7c3f613ecabe86bf4e,0xbf52bf80bf3fbe2f3ef43f6b3f773f18
.octa 0x3ecdbee1bf78bf51bdbc3f333f7f3f18,0x3f6b3f663e7fbf13bf7fbf373d8a3f4e,0xbe5a3f403f723e2fbf47bf6ebe043f4e,0xbf7abf2a3eaa3f7c3f21bebebf7ebf18,0x3c97bf72bf1a3f133f753c49bf73bf18,0x3f803ea7bf4dbf513e983f803ea4bf4e,0x3e353f803d62bf7cbe923f6b3effbf4e,0xbf7c3d7b3f803e2fbf75beca3f5e3f18
.octa 0xbebbbf663f023f51bf24bf373f413f18,0x3f6ebee1bf5c3f133f45bf33bf283f4e,0x3f0a3f2abf67be2f3f7fbebebf4b3f4e,0xbf573f403edebf7c3dd53f6ebf1cbf18,0xbf32bea73f7dbf13beef3f80bee3bf18,0x3f38bf723e103f51bf63bc493f65bf4e,0x3f52bd7bbf3f3f7cbef4beca3f77bf4e,0xbf123f80bf2bbe2f3f61bf6b3e863f18
.octa 0xbf6b3ee13e7fbf513f7fbf333d8a3f18,0x3ecdbf663f78bf13bdbc3f37bf7f3f4e,0x3f7abf403eaa3e2fbf213f6ebf7e3f4e,0xbe5a3f2abf723f7cbf473ebe3e04bf18,0xbf803f72bf4d3f13be98bc493ea4bf18,0x3c97bea73f1abf513f75bf803f73bf4e,0x3f7cbf803f80bf7c3f75bf6b3f5ebf4e,0x3e35bd7bbd623e2fbe923ecabeff3f18
.octa 0x3f773f7c3f7f3f803f803f7e3f7a3f75,0xbe86be3bbdd5bcc93d623e0a3e5a3e95,0x3d8abe54beefbf31bf5cbf78bf80bf75,0x3f7f3f7a3f633f393f023e82bc97be95,0xbf7ebf53bef4bcc93ede3f4c3f7c3f75,0xbe04bf11bf61bf80bf67bf1bbe353e95,0x3ea43f573f7f3f393e10bf01bf6ebf75,0xbf73bf0c3dbc3f313f7d3f5d3ebbbe95
.octa 0x3f5e3e3bbf21bf80bf2b3e0a3f573f75,0x3eff3f7c3f473cc9bf3fbf7ebf0a3e95,0xbf28bf7abe983f313f783e82bf38bf75,0x3f41be54bf75bf393e7f3f783f32be95,0xbf1c3f113f753cc9bf72bf1b3f123f75,0xbf4bbf533e923f803eaabf4cbf523e95,0x3f653f0cbf45bf393f1a3f5dbecdbf75,0xbee33f573f24bf31bf4d3f013f6bbe95
.octa 0x3e86bf7cbdd53f80bd62bf7e3e5a3f75,0x3f773e3bbf7fbcc93f80be0abf7a3e95,0xbf7f3e543f63bf31bf023f78bc97bf75,0x3d8abf7a3eef3f39bf5cbe823f80be95,0x3e043f53bf61bcc93f67bf4cbe353f75,0xbf7e3f113ef4bf803ede3f1bbf7c3e95,0x3f73bf573dbc3f39bf7d3f013ebbbf75,0x3ea43f0cbf7f3f313e10bf5d3f6ebe95
.octa 0xbeffbe3b3f47bf803f3fbe0abf0a3f75,0x3f5ebf7c3f213cc9bf2b3f7ebf573e95,0xbf413f7abf753f31be7fbe823f32bf75,0xbf283e543e98bf393f78bf783f38be95,0x3f4bbf113e923cc9beaa3f1bbf523f75,0xbf1c3f53bf753f80bf723f4cbf123e95,0x3ee3bf0c3f24bf393f4dbf5d3f6bbf75,0x3f65bf573f45bf313f1abf013ecdbe95
.octa 0x3f1f3f2e3f3d3f4a3f563f603f693f71,0xbf49bf3cbf2dbf1dbf0dbef7bed2beac,0x3f433f693f7d3f7e3f6c3f483f153eac,0xbf26bed5be1c3dfb3ec73f203f503f71,0x3f603f803f683f1d3e42be8fbf2fbf71,0xbefabd173ed83f4a3f7b3f763f3a3eac,0x3f743f703f05bdfbbf36bf7ebf59beac,0xbe9e3eb23f5b3f7e3f343de2bf08bf71
.octa 0x3f7e3f3cbd30bf4abf7bbef73eb53f71,0xbdee3f2e3f803f1dbe4ebf60bf6fbeac,0x3f7f3ed5bf17bf7ebec13f203f7c3eac,0x3da33f693f4fbdfbbf6dbf483e293f71,0x3f763d17bf71bf1d3f103f763cfbbf71,0x3e8c3f803eafbf4abf543e8f3f803eac,0x3f64beb2bf793dfb3f803de2bf79beac,0x3ee93f70be73bf7e3bc93f7e3e66bf71
.octa 0x3f49bf2ebf2d3f4a3f0dbf60bed23f71,0x3f1f3f3cbf3dbf1d3f563ef7bf69beac,0x3f26bf69be1c3f7ebec7bf483f503eac,0x3f433ed5bf7d3dfb3f6cbf20bf153f71,0x3efabf803ed83f1dbf7b3e8f3f3abf71,0x3f603d17bf683f4a3e42bf763f2f3eac,0x3e9ebf703f5bbdfbbf343f7ebf08beac,0x3f74beb2bf053f7ebf36bde23f59bf71
.octa 0x3deebf3c3f80bf4a3e4e3ef7bf6f3f71,0x3f7ebf2e3d303f1dbf7b3f60beb5beac,0xbda3bed53f4fbf7e3f6dbf203e293eac,0x3f7fbf693f17bdfbbec13f48bf7c3f71,0xbe8cbd173eafbf1d3f54bf763f80bf71,0x3f76bf803f71bf4a3f10be8fbcfb3eac,0xbee93eb2be733dfbbbc9bde23e66beac,0x3f64bf703f79bf7e3f80bf7e3f79bf71
.octa 0xbf593f63bf6c3f73bf793f7dbf7f3f80,0x3f08beec3ec7bea13e73be233da38000,0x3eb5bdb0be423ee6bf2d3f5abf763f80,0x3f6fbf7f3f7bbf653f3dbf063e8c8000,0x3f7cbf743f36bea1be1c3f16bf643f80,0xbe29be9b3f34bf733f7dbf4f3ee98000,0x3cfbbf253f7bbf653ed83e6dbf493f80,0xbf803f44be4ebee63f68bf793f1f8000
.octa 0xbf793eec3ec1bf733f5bbe23bf263f80,0xbe663f63bf6d3ea13f05bf7d3f438000,0xbed23f7fbf10bee63f80bf06befa3f80,0x3f69bdb0bf543f65bd30bf5a3f608000,0x3f503e9bbf803ea13f4fbf4fbe9e3f80,0x3f15bf743bc93f73bf17bf163f748000,0x3f3abf44bf0d3f653eafbf79bdee3f80,0xbf2fbf253f563ee6bf71be6d3f7e8000
.octa 0xbf08bf633ec73f73be73bf7d3da33f80,0xbf593eec3f6cbea1bf793e233f7f8000,0xbf6f3db03f7b3ee6bf3dbf5a3e8c3f80,0x3eb53f7f3e42bf65bf2d3f063f768000,0x3e293f743f34bea1bf7dbf163ee93f80,0x3f7c3e9bbf36bf73be1c3f4f3f648000,0x3f803f25be4ebf65bf68be6d3f1f3f80,0x3cfbbf44bf7bbee63ed83f793f498000
.octa 0x3e66beecbf6dbf73bf053e233f433f80,0xbf79bf63bec13ea13f5b3f7d3f268000,0xbf69bf7fbf54bee63d303f063f603f80,0xbed23db03f103f653f803f5a3efa8000,0xbf15be9b3bc93ea13f173f4f3f743f80,0x3f503f743f803f733f4f3f163e9e8000,0x3f2f3f443f563f653f713f793f7e3f80,0x3f3a3f253f0d3ee63eaf3e6d3dee8000
.octa 0xbebb3ee1bf023f13bf243f33bf413f4e,0x3f6ebf663f5cbf513f45bf373f28bf18,0x3f0abf403f67bf7c3f7fbf6e3f4bbf18,0xbf573f2abede3e2f3dd5bebe3f1cbf4e,0xbf323f72bf7d3f51beef3c493ee3bf4e,0x3f38bea7be103f13bf633f80bf653f18,0x3f52bf803f3fbe2fbef43f6bbf773f18,0xbf12bd7b3f2bbf7c3f61becabe863f4e
.octa 0xbf6b3f66be7fbf133f7fbf37bd8a3f4e,0x3ecd3ee1bf783f51bdbcbf333f7fbf18,0x3f7abf2abeaa3f7cbf21bebe3f7ebf18,0xbe5abf403f72be2fbf473f6ebe04bf4e,0xbf803ea73f4dbf51be983f80bea4bf4e,0x3c973f72bf1abf133f75bc49bf733f18,0x3f7c3d7bbf803e2f3f75becabf5e3f18,0x3e35bf803d623f7cbe92bf6b3eff3f4e
.octa 0xbf6ebee13f5c3f13bf45bf333f283f4e,0xbebb3f663f02bf51bf243f373f41bf18,0x3f573f40bedebf7cbdd53f6e3f1cbf18,0x3f0abf2abf673e2f3f7f3ebebf4bbf4e,0xbf38bf72be103f513f63bc49bf65bf4e,0xbf323ea73f7d3f13beefbf80bee33f18,0x3f123f803f2bbe2fbf61bf6bbe863f18,0x3f523d7bbf3fbf7cbef43eca3f773f4e
.octa 0xbecdbf66bf78bf133dbc3f373f7f3f4e,0xbf6bbee13e7f3f513f7f3f333d8abf18,0x3e5a3f2a3f723f7c3f473ebebe04bf18,0x3f7a3f403eaabe2fbf21bf6ebf7ebf4e,0xbc97bea7bf1abf51bf75bf80bf73bf4e,0xbf80bf72bf4dbf13be983c493ea43f18,0xbe35bd7b3d623e2f3e923eca3eff3f18,0x3f7c3f803f803f7c3f753f6b3f5e3f4e
.octa 0x3e86be3b3dd5bcc9bd623e0abe5a3e95,0x3f77bf7c3f7fbf803f80bf7e3f7abf75,0xbf7f3f7abf633f39bf023e823c97be95,0x3d8a3e54beef3f31bf5c3f78bf803f75,0x3e04bf113f61bf803f67bf1b3e353e95,0xbf7e3f53bef43cc93edebf4c3f7cbf75,0x3f73bf0cbdbc3f31bf7d3f5dbebbbe95,0x3ea4bf573f7fbf393e103f01bf6e3f75
.octa 0xbeff3f7cbf473cc93f3fbf7e3f0a3e95,0x3f5ebe3bbf213f80bf2bbe0a3f57bf75,0xbf41be543f75bf39be7f3f78bf32be95,0xbf283f7abe98bf313f78be82bf383f75,0x3f4bbf53be923f80beaabf4c3f523e95,0xbf1cbf113f75bcc9bf723f1b3f12bf75,0x3ee33f57bf24bf313f4d3f01bf6bbe95,0x3f65bf0cbf453f393f1abf5dbecd3f75
.octa 0xbf773e3b3f7fbcc9bf80be0a3f7a3e95,0x3e863f7cbdd5bf80bd623f7e3e5abf75,0xbd8abf7abeef3f393f5cbe82bf80be95,0xbf7fbe543f633f31bf02bf78bc973f75,0x3f7e3f11bef4bf80bede3f1b3f7c3e95,0x3e04bf53bf613cc93f673f4cbe35bf75,0xbea43f0c3f7f3f31be10bf5dbf6ebe95,0x3f733f573dbcbf39bf7dbf013ebb3f75
.octa 0xbf5ebf7cbf213cc93f2b3f7e3f573e95,0xbeff3e3b3f473f803f3f3e0abf0abf75,0x3f283e54be98bf39bf78bf78bf38be95,0xbf41bf7abf75bf31be7f3e823f323f75,0x3f1c3f533f753f803f723f4c3f123e95,0x3f4b3f113e92bcc9beaabf1bbf52bf75,0xbf65bf57bf45bf31bf1abf01becdbe95,0x3ee33f0c3f243f393f4d3f5d3f6b3f75
.octa 0x3f49bf3c3f2dbf1d3f0dbef73ed2beac,0x3f1fbf2e3f3dbf4a3f56bf603f69bf71,0x3f26bed53e1c3dfbbec73f20bf503f71,0x3f43bf693f7dbf7e3f6cbf483f15beac,0x3efabd17bed83f4abf7b3f76bf3a3eac,0x3f60bf803f68bf1d3e423e8fbf2f3f71,0x3e9e3eb2bf5b3f7ebf343de23f08bf71,0x3f74bf703f053dfbbf363f7ebf593eac
.octa 0x3dee3f2ebf803f1d3e4ebf603f6fbeac,0x3f7ebf3cbd303f4abf7b3ef73eb5bf71,0xbda33f69bf4fbdfb3f6dbf48be293f71,0x3f7fbed5bf173f7ebec1bf203f7cbeac,0xbe8c3f80beafbf4a3f543e8fbf803eac,0x3f76bd17bf713f1d3f10bf763cfb3f71,0xbee93f703e73bf7ebbc93f7ebe66bf71,0x3f643eb2bf79bdfb3f80bde2bf793eac
.octa 0xbf1f3f3c3f3dbf1dbf563ef73f69beac,0x3f493f2ebf2dbf4a3f0d3f60bed2bf71,0xbf433ed53f7d3dfbbf6cbf203f153f71,0x3f263f69be1cbf7ebec73f483f50beac,0xbf603d173f683f4abe42bf76bf2f3eac,0x3efa3f803ed8bf1dbf7bbe8f3f3a3f71,0xbf74beb23f053f7e3f36bde2bf59bf71,0x3e9e3f703f5b3dfbbf34bf7ebf083eac
.octa 0xbf7ebf2ebd303f1d3f7b3f603eb5beac,0x3dee3f3c3f803f4a3e4ebef7bf6fbf71,0xbf7fbf69bf17bdfb3ec13f483f7c3f71,0xbda33ed53f4f3f7e3f6d3f203e29beac,0xbf76bf80bf71bf4abf10be8f3cfb3eac,0xbe8c3d173eaf3f1d3f543f763f803f71,0xbf64bf70bf79bf7ebf80bf7ebf79bf71,0xbee9beb2be73bdfbbbc93de23e663eac
.octa 0xbf083eecbec73ea1be733e23bda30000,0xbf593f63bf6c3f73bf793f7dbf7f3f80,0xbf6f3f7fbf7b3f65bf3d3f06be8c0000,0x3eb5bdb0be423ee6bf2d3f5abf763f80,0x3e293e9bbf343f73bf7d3f4fbee90000,0x3f7cbf743f36bea1be1c3f16bf643f80,0x3f80bf443e4e3ee6bf683f79bf1f0000,0x3cfbbf253f7bbf653ed83e6dbf493f80
.octa 0x3e66bf633f6dbea1bf053f7dbf430000,0xbf793eec3ec1bf733f5bbe23bf263f80,0xbf693db03f54bf653d303f5abf600000,0xbed23f7fbf10bee63f80bf06befa3f80,0xbf153f74bbc9bf733f173f16bf740000,0x3f503e9bbf803ea13f4fbf4fbe9e3f80,0x3f2f3f25bf56bee63f713e6dbf7e0000,0x3f3abf44bf0d3f653eafbf79bdee3f80
.octa 0x3f59beecbf6c3ea13f79be23bf7f0000,0xbf08bf633ec73f73be73bf7d3da33f80,0xbeb5bf7fbe423f653f2dbf06bf760000,0xbf6f3db03f7b3ee6bf3dbf5a3e8c3f80,0xbf7cbe9b3f363f733e1cbf4fbf640000,0x3e293f743f34bea1bf7dbf163ee93f80,0xbcfb3f443f7b3ee6bed8bf79bf490000,0x3f803f25be4ebf65bf68be6d3f1f3f80
.octa 0x3f793f633ec1bea1bf5bbf7dbf260000,0x3e66beecbf6dbf73bf053e233f433f80,0x3ed2bdb0bf10bf65bf80bf5abefa0000,0xbf69bf7fbf54bee63d303f063f603f80,0xbf50bf74bf80bf73bf4fbf16be9e0000,0xbf15be9b3bc93ea13f173f4f3f743f80,0xbf3abf25bf0dbee6beafbe6dbdee0000,0x3f2f3f443f563f653f713f793f7e3f80
.octa 0xbf6e3f66bf5c3f51bf453f37bf283f18,0xbebb3ee1bf023f13bf243f33bf413f4e,0x3f57bf2a3edebe2fbdd53ebebf1c3f4e,0x3f0abf403f67bf7c3f7fbf6e3f4bbf18,0xbf383ea73e10bf133f63bf803f65bf18,0xbf323f72bf7d3f51beef3c493ee3bf4e,0x3f123d7bbf2b3f7cbf613eca3e86bf4e,0x3f52bf803f3fbe2fbef43f6bbf773f18
.octa 0xbecdbee13f78bf513dbc3f33bf7f3f18,0xbf6b3f66be7fbf133f7fbf37bd8a3f4e,0x3e5a3f40bf723e2f3f47bf6e3e043f4e,0x3f7abf2abeaa3f7cbf21bebe3f7ebf18,0xbc97bf723f1a3f13bf753c493f73bf18,0xbf803ea73f4dbf51be983f80bea4bf4e,0xbe353f80bd62bf7c3e923f6bbeffbf4e,0x3f7c3d7bbf803e2f3f75becabf5e3f18
.octa 0x3ebbbf66bf023f513f24bf37bf413f18,0xbf6ebee13f5c3f13bf45bf333f283f4e,0xbf0a3f2a3f67be2fbf7fbebe3f4b3f4e,0x3f573f40bedebf7cbdd53f6e3f1cbf18,0x3f32bea7bf7dbf133eef3f803ee3bf18,0xbf38bf72be103f513f63bc49bf65bf4e,0xbf52bd7b3f3f3f7c3ef4becabf77bf4e,0x3f123f803f2bbe2fbf61bf6bbe863f18
.octa 0x3f6b3ee1be7fbf51bf7fbf33bd8a3f18,0xbecdbf66bf78bf133dbc3f373f7f3f4e,0xbf7abf40beaa3e2f3f213f6e3f7e3f4e,0x3e5a3f2a3f723f7c3f473ebebe04bf18,0x3f803f723f4d3f133e98bc49bea4bf18,0xbc97bea7bf1abf51bf75bf80bf73bf4e,0xbf7cbf80bf80bf7cbf75bf6bbf5ebf4e,0xbe35bd7b3d623e2f3e923eca3eff3f18
.octa 0xbf773f7cbf7f3f80bf803f7ebf7a3f75,0x3e86be3b3dd5bcc9bd623e0abe5a3e95,0xbd8abe543eefbf313f5cbf783f80bf75,0xbf7f3f7abf633f39bf023e823c97be95,0x3f7ebf533ef4bcc9bede3f4cbf7c3f75,0x3e04bf113f61bf803f67bf1b3e353e95,0xbea43f57bf7f3f39be10bf013f6ebf75,0x3f73bf0cbdbc3f31bf7d3f5dbebbbe95
.octa 0xbf5e3e3b3f21bf803f2b3e0abf573f75,0xbeff3f7cbf473cc93f3fbf7e3f0a3e95,0x3f28bf7a3e983f31bf783e823f38bf75,0xbf41be543f75bf39be7f3f78bf32be95,0x3f1c3f11bf753cc93f72bf1bbf123f75,0x3f4bbf53be923f80beaabf4c3f523e95,0xbf653f0c3f45bf39bf1a3f5d3ecdbf75,0x3ee33f57bf24bf313f4d3f01bf6bbe95
.octa 0xbe86bf7c3dd53f803d62bf7ebe5a3f75,0xbf773e3b3f7fbcc9bf80be0a3f7a3e95,0x3f7f3e54bf63bf313f023f783c97bf75,0xbd8abf7abeef3f393f5cbe82bf80be95,0xbe043f533f61bcc9bf67bf4c3e353f75,0x3f7e3f11bef4bf80bede3f1b3f7c3e95,0xbf73bf57bdbc3f393f7d3f01bebbbf75,0xbea43f0c3f7f3f31be10bf5dbf6ebe95
.octa 0x3effbe3bbf47bf80bf3fbe0a3f0a3f75,0xbf5ebf7cbf213cc93f2b3f7e3f573e95,0x3f413f7a3f753f313e7fbe82bf32bf75,0x3f283e54be98bf39bf78bf78bf38be95,0xbf4bbf11be923cc93eaa3f1b3f523f75,0x3f1c3f533f753f803f723f4c3f123e95,0xbee3bf0cbf24bf39bf4dbf5dbf6bbf75,0xbf65bf57bf45bf31bf1abf01becdbe95
.octa 0xbf1f3f2ebf3d3f4abf563f60bf693f71,0x3f49bf3c3f2dbf1d3f0dbef73ed2beac,0xbf433f69bf7d3f7ebf6c3f48bf153eac,0x3f26bed53e1c3dfbbec73f20bf503f71,0xbf603f80bf683f1dbe42be8f3f2fbf71,0x3efabd17bed83f4abf7b3f76bf3a3eac,0xbf743f70bf05bdfb3f36bf7e3f59beac,0x3e9e3eb2bf5b3f7ebf343de23f08bf71
.octa 0xbf7e3f3c3d30bf4a3f7bbef7beb53f71,0x3dee3f2ebf803f1d3e4ebf603f6fbeac,0xbf7f3ed53f17bf7e3ec13f20bf7c3eac,0xbda33f69bf4fbdfb3f6dbf48be293f71,0xbf763d173f71bf1dbf103f76bcfbbf71,0xbe8c3f80beafbf4a3f543e8fbf803eac,0xbf64beb23f793dfbbf803de23f79beac,0xbee93f703e73bf7ebbc93f7ebe66bf71
.octa 0xbf49bf2e3f2d3f4abf0dbf603ed23f71,0xbf1f3f3c3f3dbf1dbf563ef73f69beac,0xbf26bf693e1c3f7e3ec7bf48bf503eac,0xbf433ed53f7d3dfbbf6cbf203f153f71,0xbefabf80bed83f1d3f7b3e8fbf3abf71,0xbf603d173f683f4abe42bf76bf2f3eac,0xbe9ebf70bf5bbdfb3f343f7e3f08beac,0xbf74beb23f053f7e3f36bde2bf59bf71
.octa 0xbdeebf3cbf80bf4abe4e3ef73f6f3f71,0xbf7ebf2ebd303f1d3f7b3f603eb5beac,0x3da3bed5bf4fbf7ebf6dbf20be293eac,0xbf7fbf69bf17bdfb3ec13f483f7c3f71,0x3e8cbd17beafbf1dbf54bf76bf80bf71,0xbf76bf80bf71bf4abf10be8f3cfb3eac,0x3ee93eb23e733dfb3bc9bde2be66beac,0xbf64bf70bf79bf7ebf80bf7ebf79bf71
.octa 0x3f563f613f6a3f723f783f7c3f7f3f80,0xbf0cbef4becebea7be7cbe29bda98000,0xbec0bdd53e323ee13f2b3f593f763f80,0xbf6dbf7fbf7cbf66bf3ebf08be8d8000,0xbf7cbf75bf39bea73e133f153f643f80,0x3e3fbe92bf31bf72bf7dbf50beea8000,0xbc17bf21bf7abf66bedc3e663f483f80,0x3f803f473e5dbee1bf67bf79bf1f8000
.octa 0x3f7b3ef4bebabf72bf5cbe293f253f80,0x3e513f613f6f3ea7bf03bf7cbf438000,0x3ec83f7f3f13bee1bf80bf083ef83f80,0xbf6cbdd53f523f663d56bf59bf608000,0xbf543e923f803ea7bf4dbf503e9c3f80,0xbf10bf75bcb03f723f19bf15bf748000,0xbf37bf473f0a3f66beabbf793de83f80,0x3f33bf21bf583ee13f71be66bf7e8000
.octa 0x3f0cbf61bece3f723e7cbf7cbda93f80,0x3f563ef4bf6abea73f783e29bf7f8000,0x3f6d3dd5bf7c3ee13f3ebf59be8d3f80,0xbec03f7fbe32bf663f2b3f08bf768000,0xbe3f3f75bf31bea73f7dbf15beea3f80,0xbf7c3e923f39bf723e133f50bf648000,0xbf803f213e5dbf663f67be66bf1f3f80,0xbc17bf473f7abee1bedc3f79bf488000
.octa 0xbe51bef43f6fbf723f033e29bf433f80,0x3f7bbf613eba3ea7bf5c3f7cbf258000,0x3f6cbf7f3f52bee1bd563f08bf603f80,0x3ec83dd5bf133f66bf803f59bef88000,0x3f10be92bcb03ea7bf193f50bf743f80,0xbf543f75bf803f72bf4d3f15be9c8000,0xbf333f47bf583f66bf713f79bf7e3f80,0xbf373f21bf0a3ee1beab3e66bde88000
.octa 0x3ea53ecd3ef33f0c3f1d3f2d3f3c3f4a,0xbf72bf6bbf61bf57bf4abf3dbf2ebf1d,0xbf00bf38bf62bf7abf7fbf71bf4fbf1d,0x3f5e3f323ef03e54bd90beafbf17bf4a,0x3f293f6e3f7f3f573efe3d30bed7bf4a,0xbf40bebb3dcf3f0c3f5e3f803f683f1d,0xbf4bbf80bf45be543ee53f683f793f1d,0x3f1cbc97bf23bf7abf65bed83e703f4a
.octa 0x3f663f6b3e93bf0cbf7ebf3d3d233f4a,0xbee23ecd3f753f573e00bf2dbf80bf1d,0xbf77bf323e963f7a3f28beafbf7dbf1d,0x3e84bf38bf75be543f413f713e20bf4a,0x3f7f3ebbbf46bf573e873f803eb1bf4a,0xbd843f6e3f22bf0cbf77bd303f703f1d,0xbf7e3c973f7f3e54bf73bed83f5a3f1d,0xbe07bf80bdc23f7a3ea2bf68bf063f4a
.octa 0x3f72becdbf613f0c3f4abf2dbf2e3f4a,0x3ea53f6bbef3bf573f1d3f3dbf3cbf1d,0xbf5e3f383ef0bf7a3d903f71bf17bf1d,0xbf00bf323f623e54bf7f3eaf3f4fbf4a,0x3f40bf6e3dcf3f57bf5ebd303f68bf4a,0x3f293ebbbf7f3f0c3efebf803ed73f1d,0xbf1c3f80bf23be543f65bf683e703f1d,0xbf4b3c973f45bf7a3ee53ed8bf793f4a
.octa 0x3ee2bf6b3f75bf0cbe003f3dbf803f4a,0x3f66becdbe933f57bf7e3f2dbd23bf1d,0xbe843f32bf753f7abf413eaf3e20bf1d,0xbf773f38be96be543f28bf713f7dbf4a,0x3d84bebb3f22bf573f77bf803f70bf4a,0x3f7fbf6e3f46bf0c3e873d30beb13f1d,0x3e07bc97bdc23e54bea23ed8bf063f1d,0xbf7e3f80bf7f3f7abf733f68bf5a3f4a
.octa 0xbea8be7fbe2cbdb0bb493da33e263e79,0xbf72bf78bf7cbf7fbf80bf7fbf7dbf78,0x3f7e3f7d3f6a3f443f0f3e9e3d0abe79,0xbe0d3e103ed13f253f543f743f803f78,0xbd6fbf02bf59bf7fbf6dbf26be6a3e79,0x3f803f5c3f083db0bec2bf43bf79bf78,0xbf78bf1a3ce23f253f7b3f643ed4be79,0xbe81bf4dbf80bf44be4b3ee93f693f78
.octa 0x3edf3f783f513db0bf34bf7fbf153e79,0xbf66be7f3f143f7f3f36bda3bf50bf78,0x3f4cbe10bf6fbf443e453f743f3bbe79,0x3f1a3f7d3eb7bf25bf7bbe9e3f2f3f78,0xbf3fbf5c3e633f7f3ec5bf43bf5a3e79,0x3f2abf02bf7abdb03f6c3f26bf07bf78,0xbf023f4d3f30bf25bf553ee93f70be79,0xbf5dbf1a3f3a3f44bf0ebf643eb43f78
.octa 0x3f723e7fbf7cbdb03f80bda3bf7d3e79,0xbea83f783e2cbf7fbb493f7fbe26bf78,0x3e0dbf7d3ed13f44bf54be9e3f80be79,0x3f7ebe10bf6a3f253f0fbf74bd0a3f78,0xbf803f023f08bf7f3ec23f26bf793e79,0xbd6fbf5c3f593db0bf6d3f433e6abf78,0x3e813f1abf803f253e4bbf643f69be79,0xbf783f4dbce2bf443f7bbee9bed43f78
.octa 0x3f66bf783f143db0bf363f7fbf503e79,0x3edf3e7fbf513f7fbf343da33f15bf78,0xbf1a3e103eb7bf443f7bbf743f2fbe79,0x3f4cbf7d3f6fbf253e453e9ebf3b3f78,0xbf2a3f5cbf7a3f7fbf6c3f43bf073e79,0xbf3f3f02be63bdb03ec5bf263f5abf78,0x3f5dbf4d3f3abf253f0ebee93eb4be79,0xbf023f1abf303f44bf553f64bf703f78
.octa 0xbf57bf4bbf3dbf2ebf1ebf0dbef6becf,0xbf0bbf1cbf2dbf3cbf49bf56bf61bf6a,0xbf38beffbe763d173e9f3f103f443f6a,0xbf32bf5ebf79bf80bf73bf54bf24becf,0xbf11be043eae3f3c3f773f7b3f473ecf,0xbf53bf7ebf71bf2ebe8a3e4e3f213f6a,0xbecb3e863f4e3f803f423e42beedbf6a,0xbf6bbf77bf183d173f273f7b3f633ecf
.octa 0xbe573f1c3f803f2ebdf4bf56bf76becf,0xbf7abf4bbd3c3f3c3f7e3f0dbe90bf6a,0xbc7b3f5e3f5bbd17bf64bf543db63f6a,0xbf80beff3f043f803ee8bf10bf7fbecf,0x3e383f7e3ed9bf3cbf5f3e4e3f7f3ecf,0xbf7cbe043f683f2ebefbbf7bbddb3f6a,0x3ebd3f77be19bf80bd9d3f7b3e99bf6a,0xbf6e3e863f7dbd17bf7fbe423f743ecf
.octa 0x3f0b3f4bbf2dbf2e3f493f0dbf61becf,0xbf573f1c3f3dbf3cbf1e3f563ef6bf6a,0x3f323effbf793d173f73bf10bf243f6a,0xbf383f5e3e76bf803e9f3f54bf44becf,0x3f533e04bf713f3c3e8abf7b3f213ecf,0xbf113f7ebeaebf2e3f77be4ebf473f6a,0x3f6bbe86bf183f80bf27be423f63bf6a,0xbecb3f77bf4e3d173f42bf7b3eed3ecf
.octa 0x3f7abf1cbd3c3f2ebf7e3f56be90becf,0xbe573f4bbf803f3cbdf4bf0d3f76bf6a,0x3f80bf5e3f04bd17bee83f54bf7f3f6a,0xbc7b3effbf5b3f80bf643f10bdb6becf,0x3f7cbf7e3f68bf3c3efbbe4ebddb3ecf,0x3e383e04bed93f2ebf5f3f7bbf7f3f6a,0x3f6ebf773f7dbf803f7fbf7b3f74bf6a,0x3ebdbe863e19bd17bd9d3e42be993ecf
.octa 0x3f0c3ef43ece3ea73e7c3e293da90000,0x3f563f613f6a3f723f783f7c3f7f3f80,0x3f6d3f7f3f7c3f663f3e3f083e8d0000,0xbec0bdd53e323ee13f2b3f593f763f80,0xbe3f3e923f313f723f7d3f503eea0000,0xbf7cbf75bf39bea73e133f153f643f80,0xbf80bf47be5d3ee13f673f793f1f0000,0xbc17bf21bf7abf66bedc3e663f483f80
.octa 0xbe51bf61bf6fbea73f033f7c3f430000,0x3f7b3ef4bebabf72bf5cbe293f253f80,0x3f6c3dd5bf52bf66bd563f593f600000,0x3ec83f7f3f13bee1bf80bf083ef83f80,0x3f103f753cb0bf72bf193f153f740000,0xbf543e923f803ea7bf4dbf503e9c3f80,0xbf333f213f58bee1bf713e663f7e0000,0xbf37bf473f0a3f66beabbf793de83f80
.octa 0xbf56bef43f6a3ea7bf78be293f7f0000,0x3f0cbf61bece3f723e7cbf7cbda93f80,0x3ec0bf7f3e323f66bf2bbf083f760000,0x3f6d3dd5bf7c3ee13f3ebf59be8d3f80,0x3f7cbe92bf393f72be13bf503f640000,0xbe3f3f75bf31bea73f7dbf15beea3f80,0x3c173f47bf7a3ee13edcbf793f480000,0xbf803f213e5dbf663f67be66bf1f3f80
.octa 0xbf7b3f61bebabea73f5cbf7c3f250000,0xbe51bef43f6fbf723f033e29bf433f80,0xbec8bdd53f13bf663f80bf593ef80000,0x3f6cbf7f3f52bee1bd563f08bf603f80,0x3f54bf753f80bf723f4dbf153e9c0000,0x3f10be92bcb03ea7bf193f50bf743f80,0x3f37bf213f0abee13eabbe663de80000,0xbf333f47bf583f66bf713f79bf7e3f80
.octa 0x3f723f6b3f613f573f4a3f3d3f2e3f1d,0x3ea53ecd3ef33f0c3f1d3f2d3f3c3f4a,0xbf5ebf32bef0be543d903eaf3f173f4a,0xbf00bf38bf62bf7abf7fbf71bf4fbf1d,0x3f403ebbbdcfbf0cbf5ebf80bf68bf1d,0x3f293f6e3f7f3f573efe3d30bed7bf4a,0xbf1c3c973f233f7a3f653ed8be70bf4a,0xbf4bbf80bf45be543ee53f683f793f1d
.octa 0x3ee2becdbf75bf57be003f2d3f803f1d,0x3f663f6b3e93bf0cbf7ebf3d3d233f4a,0xbe843f383f753e54bf41bf71be203f4a,0xbf77bf323e963f7a3f28beafbf7dbf1d,0x3d84bf6ebf223f0c3f773d30bf70bf1d,0x3f7f3ebbbf46bf573e873f803eb1bf4a,0x3e073f803dc2bf7abea23f683f06bf4a,0xbf7e3c973f7f3e54bf73bed83f5a3f1d
.octa 0xbea5bf6b3ef33f57bf1dbf3d3f3c3f1d,0x3f72becdbf613f0c3f4abf2dbf2e3f4a,0x3f003f32bf62be543f7fbeafbf4f3f4a,0xbf5e3f383ef0bf7a3d903f71bf17bf1d,0xbf29bebb3f7fbf0cbefe3f80bed7bf1d,0x3f40bf6e3dcf3f57bf5ebd303f68bf4a,0x3f4bbc97bf453f7abee5bed83f79bf4a,0xbf1c3f80bf23be543f65bf683e703f1d
.octa 0xbf663ecd3e93bf573f7ebf2d3d233f1d,0x3ee2bf6b3f75bf0cbe003f3dbf803f4a,0x3f77bf383e963e54bf283f71bf7d3f4a,0xbe843f32bf753f7abf413eaf3e20bf1d,0xbf7f3f6ebf463f0cbe87bd303eb1bf1d,0x3d84bebb3f22bf573f77bf803f70bf4a,0x3f7ebf803f7fbf7a3f73bf683f5abf4a,0x3e07bc97bdc23e54bea23ed8bf063f1d
.octa 0x3f723f783f7c3f7f3f803f7f3f7d3f78,0xbea8be7fbe2cbdb0bb493da33e263e79,0x3e0dbe10bed1bf25bf54bf74bf80bf78,0x3f7e3f7d3f6a3f443f0f3e9e3d0abe79,0xbf80bf5cbf08bdb03ec23f433f793f78,0xbd6fbf02bf59bf7fbf6dbf26be6a3e79,0x3e813f4d3f803f443e4bbee9bf69bf78,0xbf78bf1a3ce23f253f7b3f643ed4be79
.octa 0x3f663e7fbf14bf7fbf363da33f503f78,0x3edf3f783f513db0bf34bf7fbf153e79,0xbf1abf7dbeb73f253f7b3e9ebf2fbf78,0x3f4cbe10bf6fbf443e453f743f3bbe79,0xbf2a3f023f7a3db0bf6cbf263f073f78,0xbf3fbf5c3e633f7f3ec5bf43bf5a3e79,0x3f5d3f1abf3abf443f0e3f64beb4bf78,0xbf023f4d3f30bf25bf553ee93f70be79
.octa 0x3ea8bf78be2c3f7f3b49bf7f3e263f78,0x3f723e7fbf7cbdb03f80bda3bf7d3e79,0xbf7e3e103f6abf25bf0f3f743d0abf78,0x3e0dbf7d3ed13f44bf54be9e3f80be79,0x3d6f3f5cbf59bdb03f6dbf43be6a3f78,0xbf803f023f08bf7f3ec23f26bf793e79,0x3f78bf4d3ce23f44bf7b3ee93ed4bf78,0x3e813f1abf803f253e4bbf643f69be79
.octa 0xbedfbe7f3f51bf7f3f34bda3bf153f78,0x3f66bf783f143db0bf363f7fbf503e79,0xbf4c3f7dbf6f3f25be45be9e3f3bbf78,0xbf1a3e103eb7bf443f7bbf743f2fbe79,0x3f3fbf023e633db0bec53f26bf5a3f78,0xbf2a3f5cbf7a3f7fbf6c3f43bf073e79,0x3f02bf1a3f30bf443f55bf643f70bf78,0x3f5dbf4d3f3abf253f0ebee93eb4be79
.octa 0x3f0b3f1c3f2d3f3c3f493f563f613f6a,0xbf57bf4bbf3dbf2ebf1ebf0dbef6becf,0x3f323f5e3f793f803f733f543f243ecf,0xbf38beffbe763d173e9f3f103f443f6a,0x3f533f7e3f713f2e3e8abe4ebf21bf6a,0xbf11be043eae3f3c3f773f7b3f473ecf,0x3f6b3f773f18bd17bf27bf7bbf63becf,0xbecb3e863f4e3f803f423e42beedbf6a
.octa 0x3f7a3f4b3d3cbf3cbf7ebf0d3e903f6a,0xbe573f1c3f803f2ebdf4bf56bf76becf,0x3f803effbf04bf80bee83f103f7f3ecf,0xbc7b3f5e3f5bbd17bf64bf543db63f6a,0x3f7c3e04bf68bf2e3efb3f7b3ddbbf6a,0x3e383f7e3ed9bf3cbf5f3e4e3f7f3ecf,0x3f6ebe86bf7d3d173f7f3e42bf74becf,0x3ebd3f77be19bf80bd9d3f7b3e99bf6a
.octa 0x3f57bf1cbf3d3f3c3f1ebf56bef63f6a,0x3f0b3f4bbf2dbf2e3f493f0dbf61becf,0x3f38bf5ebe763f80be9fbf543f443ecf,0x3f323effbf793d173f73bf10bf243f6a,0x3f11bf7e3eae3f2ebf773e4e3f47bf6a,0x3f533e04bf713f3c3e8abf7b3f213ecf,0x3ecbbf773f4ebd17bf423f7bbeedbecf,0x3f6bbe86bf183f80bf27be423f63bf6a
.octa 0x3e57bf4b3f80bf3c3df43f0dbf763f6a,0x3f7abf1cbd3c3f2ebf7e3f56be90becf,0x3c7bbeff3f5bbf803f64bf103db63ecf,0x3f80bf5e3f04bd17bee83f54bf7f3f6a,0xbe38be043ed9bf2e3f5fbf7b3f7fbf6a,0x3f7cbf7e3f68bf3c3efbbe4ebddb3ecf,0xbebd3e86be193d173d9dbe423e99becf,0x3f6ebf773f7dbf803f7fbf7b3f74bf6a
.octa 0xbf563f61bf6a3f72bf783f7cbf7f3f80,0x3f0cbef43ecebea73e7cbe293da98000,0x3ec0bdd5be323ee1bf2b3f59bf763f80,0x3f6dbf7f3f7cbf663f3ebf083e8d8000,0x3f7cbf753f39bea7be133f15bf643f80,0xbe3fbe923f31bf723f7dbf503eea8000,0x3c17bf213f7abf663edc3e66bf483f80,0xbf803f47be5dbee13f67bf793f1f8000
.octa 0xbf7b3ef43ebabf723f5cbe29bf253f80,0xbe513f61bf6f3ea73f03bf7c3f438000,0xbec83f7fbf13bee13f80bf08bef83f80,0x3f6cbdd5bf523f66bd56bf593f608000,0x3f543e92bf803ea73f4dbf50be9c3f80,0x3f10bf753cb03f72bf19bf153f748000,0x3f37bf47bf0a3f663eabbf79bde83f80,0xbf33bf213f583ee1bf71be663f7e8000
.octa 0xbf0cbf613ece3f72be7cbf7c3da93f80,0xbf563ef43f6abea7bf783e293f7f8000,0xbf6d3dd53f7c3ee1bf3ebf593e8d3f80,0x3ec03f7f3e32bf66bf2b3f083f768000,0x3e3f3f753f31bea7bf7dbf153eea3f80,0x3f7c3e92bf39bf72be133f503f648000,0x3f803f21be5dbf66bf67be663f1f3f80,0x3c17bf47bf7abee13edc3f793f488000
.octa 0x3e51bef4bf6fbf72bf033e293f433f80,0xbf7bbf61beba3ea73f5c3f7c3f258000,0xbf6cbf7fbf52bee13d563f083f603f80,0xbec83dd53f133f663f803f593ef88000,0xbf10be923cb03ea73f193f503f743f80,0x3f543f753f803f723f4d3f153e9c8000,0x3f333f473f583f663f713f793f7e3f80,0x3f373f213f0a3ee13eab3e663de88000
.octa 0xbea53ecdbef33f0cbf1d3f2dbf3c3f4a,0x3f72bf6b3f61bf573f4abf3d3f2ebf1d,0x3f00bf383f62bf7a3f7fbf713f4fbf1d,0xbf5e3f32bef03e543d90beaf3f17bf4a,0xbf293f6ebf7f3f57befe3d303ed7bf4a,0x3f40bebbbdcf3f0cbf5e3f80bf683f1d,0x3f4bbf803f45be54bee53f68bf793f1d,0xbf1cbc973f23bf7a3f65bed8be703f4a
.octa 0xbf663f6bbe93bf0c3f7ebf3dbd233f4a,0x3ee23ecdbf753f57be00bf2d3f80bf1d,0x3f77bf32be963f7abf28beaf3f7dbf1d,0xbe84bf383f75be54bf413f71be20bf4a,0xbf7f3ebb3f46bf57be873f80beb1bf4a,0x3d843f6ebf22bf0c3f77bd30bf703f1d,0x3f7e3c97bf7f3e543f73bed8bf5a3f1d,0x3e07bf803dc23f7abea2bf683f063f4a
.octa 0xbf72becd3f613f0cbf4abf2d3f2e3f4a,0xbea53f6b3ef3bf57bf1d3f3d3f3cbf1d,0x3f5e3f38bef0bf7abd903f713f17bf1d,0x3f00bf32bf623e543f7f3eafbf4fbf4a,0xbf40bf6ebdcf3f573f5ebd30bf68bf4a,0xbf293ebb3f7f3f0cbefebf80bed73f1d,0x3f1c3f803f23be54bf65bf68be703f1d,0x3f4b3c97bf45bf7abee53ed83f793f4a
.octa 0xbee2bf6bbf75bf0c3e003f3d3f803f4a,0xbf66becd3e933f573f7e3f2d3d23bf1d,0x3e843f323f753f7a3f413eafbe20bf1d,0x3f773f383e96be54bf28bf71bf7dbf4a,0xbd84bebbbf22bf57bf77bf80bf70bf4a,0xbf7fbf6ebf46bf0cbe873d303eb13f1d,0xbe07bc973dc23e543ea23ed83f063f1d,0x3f7e3f803f7f3f7a3f733f683f5a3f4a
.octa 0x3ea8be7f3e2cbdb03b493da3be263e79,0x3f72bf783f7cbf7f3f80bf7f3f7dbf78,0xbf7e3f7dbf6a3f44bf0f3e9ebd0abe79,0x3e0d3e10bed13f25bf543f74bf803f78,0x3d6fbf023f59bf7f3f6dbf263e6a3e79,0xbf803f5cbf083db03ec2bf433f79bf78,0x3f78bf1abce23f25bf7b3f64bed4be79,0x3e81bf4d3f80bf443e4b3ee9bf693f78
.octa 0xbedf3f78bf513db03f34bf7f3f153e79,0x3f66be7fbf143f7fbf36bda33f50bf78,0xbf4cbe103f6fbf44be453f74bf3bbe79,0xbf1a3f7dbeb7bf253f7bbe9ebf2f3f78,0x3f3fbf5cbe633f7fbec5bf433f5a3e79,0xbf2abf023f7abdb0bf6c3f263f07bf78,0x3f023f4dbf30bf253f553ee9bf70be79,0x3f5dbf1abf3a3f443f0ebf64beb43f78
.octa 0xbf723e7f3f7cbdb0bf80bda33f7d3e79,0x3ea83f78be2cbf7f3b493f7f3e26bf78,0xbe0dbf7dbed13f443f54be9ebf80be79,0xbf7ebe103f6a3f25bf0fbf743d0a3f78,0x3f803f02bf08bf7fbec23f263f793e79,0x3d6fbf5cbf593db03f6d3f43be6abf78,0xbe813f1a3f803f25be4bbf64bf69be79,0x3f783f4d3ce2bf44bf7bbee93ed43f78
.octa 0xbf66bf78bf143db03f363f7f3f503e79,0xbedf3e7f3f513f7f3f343da3bf15bf78,0x3f1a3e10beb7bf44bf7bbf74bf2fbe79,0xbf4cbf7dbf6fbf25be453e9e3f3b3f78,0x3f2a3f5c3f7a3f7f3f6c3f433f073e79,0x3f3f3f023e63bdb0bec5bf26bf5abf78,0xbf5dbf4dbf3abf25bf0ebee9beb4be79,0x3f023f1a3f303f443f553f643f703f78
.octa 0x3f57bf4b3f3dbf2e3f1ebf0d3ef6becf,0x3f0bbf1c3f2dbf3c3f49bf563f61bf6a,0x3f38beff3e763d17be9f3f10bf443f6a,0x3f32bf5e3f79bf803f73bf543f24becf,0x3f11be04beae3f3cbf773f7bbf473ecf,0x3f53bf7e3f71bf2e3e8a3e4ebf213f6a,0x3ecb3e86bf4e3f80bf423e423eedbf6a,0x3f6bbf773f183d17bf273f7bbf633ecf
.octa 0x3e573f1cbf803f2e3df4bf563f76becf,0x3f7abf4b3d3c3f3cbf7e3f0d3e90bf6a,0x3c7b3f5ebf5bbd173f64bf54bdb63f6a,0x3f80beffbf043f80bee8bf103f7fbecf,0xbe383f7ebed9bf3c3f5f3e4ebf7f3ecf,0x3f7cbe04bf683f2e3efbbf7b3ddb3f6a,0xbebd3f773e19bf803d9d3f7bbe99bf6a,0x3f6e3e86bf7dbd173f7fbe42bf743ecf
.octa 0xbf0b3f4b3f2dbf2ebf493f0d3f61becf,0x3f573f1cbf3dbf3c3f1e3f56bef6bf6a,0xbf323eff3f793d17bf73bf103f243f6a,0x3f383f5ebe76bf80be9f3f543f44becf,0xbf533e043f713f3cbe8abf7bbf213ecf,0x3f113f7e3eaebf2ebf77be4e3f473f6a,0xbf6bbe863f183f803f27be42bf63bf6a,0x3ecb3f773f4e3d17bf42bf7bbeed3ecf
.octa 0xbf7abf1c3d3c3f2e3f7e3f563e90becf,0x3e573f4b3f803f3c3df4bf0dbf76bf6a,0xbf80bf5ebf04bd173ee83f543f7f3f6a,0x3c7b3eff3f5b3f803f643f103db6becf,0xbf7cbf7ebf68bf3cbefbbe4e3ddb3ecf,0xbe383e043ed93f2e3f5f3f7b3f7f3f6a,0xbf6ebf77bf7dbf80bf7fbf7bbf74bf6a,0xbebdbe86be19bd173d9d3e423e993ecf
.octa 0xbf0c3ef4bece3ea7be7c3e29bda90000,0xbf563f61bf6a3f72bf783f7cbf7f3f80,0xbf6d3f7fbf7c3f66bf3e3f08be8d0000,0x3ec0bdd5be323ee1bf2b3f59bf763f80,0x3e3f3e92bf313f72bf7d3f50beea0000,0x3f7cbf753f39bea7be133f15bf643f80,0x3f80bf473e5d3ee1bf673f79bf1f0000,0x3c17bf213f7abf663edc3e66bf483f80
.octa 0x3e51bf613f6fbea7bf033f7cbf430000,0xbf7b3ef43ebabf723f5cbe29bf253f80,0xbf6c3dd53f52bf663d563f59bf600000,0xbec83f7fbf13bee13f80bf08bef83f80,0xbf103f75bcb0bf723f193f15bf740000,0x3f543e92bf803ea73f4dbf50be9c3f80,0x3f333f21bf58bee13f713e66bf7e0000,0x3f37bf47bf0a3f663eabbf79bde83f80
.octa 0x3f56bef4bf6a3ea73f78be29bf7f0000,0xbf0cbf613ece3f72be7cbf7c3da93f80,0xbec0bf7fbe323f663f2bbf08bf760000,0xbf6d3dd53f7c3ee1bf3ebf593e8d3f80,0xbf7cbe923f393f723e13bf50bf640000,0x3e3f3f753f31bea7bf7dbf153eea3f80,0xbc173f473f7a3ee1bedcbf79bf480000,0x3f803f21be5dbf66bf67be663f1f3f80
.octa 0x3f7b3f613ebabea7bf5cbf7cbf250000,0x3e51bef4bf6fbf72bf033e293f433f80,0x3ec8bdd5bf13bf66bf80bf59bef80000,0xbf6cbf7fbf52bee13d563f083f603f80,0xbf54bf75bf80bf72bf4dbf15be9c0000,0xbf10be923cb03ea73f193f503f743f80,0xbf37bf21bf0abee1beabbe66bde80000,0x3f333f473f583f663f713f793f7e3f80
.octa 0xbf723f6bbf613f57bf4a3f3dbf2e3f1d,0xbea53ecdbef33f0cbf1d3f2dbf3c3f4a,0x3f5ebf323ef0be54bd903eafbf173f4a,0x3f00bf383f62bf7a3f7fbf713f4fbf1d,0xbf403ebb3dcfbf0c3f5ebf803f68bf1d,0xbf293f6ebf7f3f57befe3d303ed7bf4a,0x3f1c3c97bf233f7abf653ed83e70bf4a,0x3f4bbf803f45be54bee53f68bf793f1d
.octa 0xbee2becd3f75bf573e003f2dbf803f1d,0xbf663f6bbe93bf0c3f7ebf3dbd233f4a,0x3e843f38bf753e543f41bf713e203f4a,0x3f77bf32be963f7abf28beaf3f7dbf1d,0xbd84bf6e3f223f0cbf773d303f70bf1d,0xbf7f3ebb3f46bf57be873f80beb1bf4a,0xbe073f80bdc2bf7a3ea23f68bf06bf4a,0x3f7e3c97bf7f3e543f73bed8bf5a3f1d
.octa 0x3ea5bf6bbef33f573f1dbf3dbf3c3f1d,0xbf72becd3f613f0cbf4abf2d3f2e3f4a,0xbf003f323f62be54bf7fbeaf3f4f3f4a,0x3f5e3f38bef0bf7abd903f713f17bf1d,0x3f29bebbbf7fbf0c3efe3f803ed7bf1d,0xbf40bf6ebdcf3f573f5ebd30bf68bf4a,0xbf4bbc973f453f7a3ee5bed8bf79bf4a,0x3f1c3f803f23be54bf65bf68be703f1d
.octa 0x3f663ecdbe93bf57bf7ebf2dbd233f1d,0xbee2bf6bbf75bf0c3e003f3d3f803f4a,0xbf77bf38be963e543f283f713f7d3f4a,0x3e843f323f753f7a3f413eafbe20bf1d,0x3f7f3f6e3f463f0c3e87bd30beb1bf1d,0xbd84bebbbf22bf57bf77bf80bf70bf4a,0xbf7ebf80bf7fbf7abf73bf68bf5abf4a,0xbe07bc973dc23e543ea23ed83f063f1d
.octa 0xbf723f78bf7c3f7fbf803f7fbf7d3f78,0x3ea8be7f3e2cbdb03b493da3be263e79,0xbe0dbe103ed1bf253f54bf743f80bf78,0xbf7e3f7dbf6a3f44bf0f3e9ebd0abe79,0x3f80bf5c3f08bdb0bec23f43bf793f78,0x3d6fbf023f59bf7f3f6dbf263e6a3e79,0xbe813f4dbf803f44be4bbee93f69bf78,0x3f78bf1abce23f25bf7b3f64bed4be79
.octa 0xbf663e7f3f14bf7f3f363da3bf503f78,0xbedf3f78bf513db03f34bf7f3f153e79,0x3f1abf7d3eb73f25bf7b3e9e3f2fbf78,0xbf4cbe103f6fbf44be453f74bf3bbe79,0x3f2a3f02bf7a3db03f6cbf26bf073f78,0x3f3fbf5cbe633f7fbec5bf433f5a3e79,0xbf5d3f1a3f3abf44bf0e3f643eb4bf78,0x3f023f4dbf30bf253f553ee9bf70be79
.octa 0xbea8bf783e2c3f7fbb49bf7fbe263f78,0xbf723e7f3f7cbdb0bf80bda33f7d3e79,0x3f7e3e10bf6abf253f0f3f74bd0abf78,0xbe0dbf7dbed13f443f54be9ebf80be79,0xbd6f3f5c3f59bdb0bf6dbf433e6a3f78,0x3f803f02bf08bf7fbec23f263f793e79,0xbf78bf4dbce23f443f7b3ee9bed4bf78,0xbe813f1a3f803f25be4bbf64bf69be79
.octa 0x3edfbe7fbf51bf7fbf34bda33f153f78,0xbf66bf78bf143db03f363f7f3f503e79,0x3f4c3f7d3f6f3f253e45be9ebf3bbf78,0x3f1a3e10beb7bf44bf7bbf74bf2fbe79,0xbf3fbf02be633db03ec53f263f5a3f78,0x3f2a3f5c3f7a3f7f3f6c3f433f073e79,0xbf02bf1abf30bf44bf55bf64bf70bf78,0xbf5dbf4dbf3abf25bf0ebee9beb4be79
.octa 0xbf0b3f1cbf2d3f3cbf493f56bf613f6a,0x3f57bf4b3f3dbf2e3f1ebf0d3ef6becf,0xbf323f5ebf793f80bf733f54bf243ecf,0x3f38beff3e763d17be9f3f10bf443f6a,0xbf533f7ebf713f2ebe8abe4e3f21bf6a,0x3f11be04beae3f3cbf773f7bbf473ecf,0xbf6b3f77bf18bd173f27bf7b3f63becf,0x3ecb3e86bf4e3f80bf423e423eedbf6a
.octa 0xbf7a3f4bbd3cbf3c3f7ebf0dbe903f6a,0x3e573f1cbf803f2e3df4bf563f76becf,0xbf803eff3f04bf803ee83f10bf7f3ecf,0x3c7b3f5ebf5bbd173f64bf54bdb63f6a,0xbf7c3e043f68bf2ebefb3f7bbddbbf6a,0xbe383f7ebed9bf3c3f5f3e4ebf7f3ecf,0xbf6ebe863f7d3d17bf7f3e423f74becf,0xbebd3f773e19bf803d9d3f7bbe99bf6a
.octa 0xbf57bf1c3f3d3f3cbf1ebf563ef63f6a,0xbf0b3f4b3f2dbf2ebf493f0d3f61becf,0xbf38bf5e3e763f803e9fbf54bf443ecf,0xbf323eff3f793d17bf73bf103f243f6a,0xbf11bf7ebeae3f2e3f773e4ebf47bf6a,0xbf533e043f713f3cbe8abf7bbf213ecf,0xbecbbf77bf4ebd173f423f7b3eedbecf,0xbf6bbe863f183f803f27be42bf63bf6a
.octa 0xbe57bf4bbf80bf3cbdf43f0d3f763f6a,0xbf7abf1c3d3c3f2e3f7e3f563e90becf,0xbc7bbeffbf5bbf80bf64bf10bdb63ecf,0xbf80bf5ebf04bd173ee83f543f7f3f6a,0x3e38be04bed9bf2ebf5fbf7bbf7fbf6a,0xbf7cbf7ebf68bf3cbefbbe4e3ddb3ecf,0x3ebd3e863e193d17bd9dbe42be99becf,0xbf6ebf77bf7dbf80bf7fbf7bbf74bf6a
.octa 0x3f533f5f3f693f713f783f7c3f7f3f80,0xbf11befcbed5beacbe82be2fbdb08000,0xbecabdfb3e233edb3f2a3f583f763f80,0xbf6bbf7ebf7dbf67bf40bf09be8f8000,0xbf7abf77bf3cbeac3e0a3f133f633f80,0x3e54be89bf2ebf71bf7ebf51beec8000,0x3c49bf1dbf79bf67bee13e603f483f80,0x3f803f4a3e6dbedbbf66bf7abf208000
.octa 0x3f7c3efcbeb2bf71bf5dbe2f3f253f80,0x3e3b3f5f3f703eacbf01bf7cbf448000,0x3ebe3f7e3f16bedbbf80bf093ef73f80,0xbf6ebdfb3f4f3f673d7bbf58bf608000,0xbf573e893f803eacbf4cbf513e9b3f80,0xbf0cbf77bd173f713f1bbf13bf748000,0xbf33bf4a3f063f67bea7bf7a3de23f80,0x3f37bf1dbf5a3edb3f72be60bf7e8000
.octa 0x3f11bf5fbed53f713e82bf7cbdb03f80,0x3f533efcbf69beac3f783e2fbf7f8000,0x3f6b3dfbbf7d3edb3f40bf58be8f3f80,0xbeca3f7ebe23bf673f2a3f09bf768000,0xbe543f77bf2ebeac3f7ebf13beec3f80,0xbf7a3e893f3cbf713e0a3f51bf638000,0xbf803f1d3e6dbf673f66be60bf203f80,0x3c49bf4a3f79bedbbee13f7abf488000
.octa 0xbe3bbefc3f70bf713f013e2fbf443f80,0x3f7cbf5f3eb23eacbf5d3f7cbf258000,0x3f6ebf7e3f4fbedbbd7b3f09bf603f80,0x3ebe3dfbbf163f67bf803f58bef78000,0x3f0cbe89bd173eacbf1b3f51bf743f80,0xbf573f77bf803f71bf4c3f13be9b8000,0xbf373f4abf5a3f67bf723f7abf7e3f80,0xbf333f1dbf063edbbea73e60bde28000
.octa 0x3e8f3eb83ee13f043f163f273f373f46,0xbf76bf6fbf66bf5cbf4fbf42bf33bf22,0xbeecbf31bf5dbf78bf80bf73bf53bf22,0x3f633f393f013e79bd17bea1bf11bf46,0x3f203f6a3f803f5c3f063d97becabf46,0xbf48becf3d7b3f043f5a3f7f3f6b3f22,0xbf44bf80bf4cbe793ed53f653f7a3f22,0x3f253cc9bf1bbf78bf69bee63e543f46
.octa 0x3f603f6f3ea7bf04bf7dbf423c493f46,0xbef73eb83f723f5c3e23bf27bf80bf22,0xbf74bf393e823f783f2ebea1bf7cbf22,0x3e9bbf31bf78be793f3c3f733e3bbf46,0x3f7e3ecfbf40bf5c3e6d3f7f3ebebf46,0xbde23f6a3f2abf04bf79bd973f6e3f22,0xbf7fbcc93f7e3e79bf70bee63f573f22,0xbdb0bf80be0a3f783eb2bf65bf0c3f46
.octa 0x3f76beb8bf663f043f4fbf27bf333f46,0x3e8f3f6fbee1bf5c3f163f42bf37bf22,0xbf633f313f01bf783d173f73bf11bf22,0xbeecbf393f5d3e79bf803ea13f53bf46,0x3f48bf6a3d7b3f5cbf5abd973f6bbf46,0x3f203ecfbf803f043f06bf7f3eca3f22,0xbf253f80bf1bbe793f69bf653e543f22,0xbf44bcc93f4cbf783ed53ee6bf7a3f46
.octa 0x3ef7bf6f3f72bf04be233f42bf803f46,0x3f60beb8bea73f5cbf7d3f27bc49bf22,0xbe9b3f39bf783f78bf3c3ea13e3bbf22,0xbf743f31be82be793f2ebf733f7cbf46,0x3de2becf3f2abf5c3f79bf7f3f6ebf46,0x3f7ebf6a3f40bf043e6d3d97bebe3f22,0x3db03cc9be0a3e79beb23ee6bf0c3f22,0xbf7f3f80bf7e3f78bf703f65bf573f46
.octa 0xbecabea1be6dbe16bd7b3cc93de23e48,0xbf6bbf73bf79bf7dbf80bf80bf7ebf7b,0x3f7a3f7f3f703f4e3f1b3eb83db0be48,0xbe543d973eb23f183f4c3f6f3f7f3f7b,0x3c49bee6bf4fbf7dbf72bf31be8f3e48,0x3f803f653f163e16bea7bf39bf76bf7b,0xbf7cbf27bd173f183f783f6a3eecbe48,0xbe3bbf42bf80bf4ebe823ecf3f633f7b
.octa 0x3ebe3f733f5a3e16bf2abf80bf203e48,0xbf6ebea13f063f7d3f40bcc9bf48bf7b,0x3f57bd97bf69bf4e3e0a3f6f3f44be48,0x3f0c3f7f3ed5bf18bf7ebeb83f253f7b,0xbf33bf653e233f7d3ee1bf39bf603e48,0x3f37bee6bf7dbe163f663f31bef7bf7b,0xbf113f423f3cbf18bf5d3ecf3f74be48,0xbf53bf273f2e3f4ebf01bf6a3e9b3f7b
.octa 0x3f6b3ea1bf79be163f80bcc9bf7e3e48,0xbeca3f733e6dbf7dbd7b3f80bde2bf7b,0x3e54bf7f3eb23f4ebf4cbeb83f7fbe48,0x3f7abd97bf703f183f1bbf6fbdb03f7b,0xbf803ee63f16bf7d3ea73f31bf763e48,0x3c49bf653f4f3e16bf723f393e8fbf7b,0x3e3b3f27bf803f183e82bf6a3f63be48,0xbf7c3f423d17bf4e3f78becfbeec3f7b
.octa 0x3f6ebf733f063e16bf403f80bf483e48,0x3ebe3ea1bf5a3f7dbf2a3cc93f20bf7b,0xbf0c3d973ed5bf4e3f7ebf6f3f25be48,0x3f57bf7f3f69bf183e0a3eb8bf443f7b,0xbf373f65bf7d3f7dbf663f39bef73e48,0xbf333ee6be23be163ee1bf313f60bf7b,0x3f53bf423f2ebf183f01becf3e9bbe48,0xbf113f27bf3c3f4ebf5d3f6abf743f7b
.octa 0xbf63bf58bf4cbf3ebf2ebf1dbf0cbef1,0xbeecbf09bf1bbf2cbf3cbf4abf57bf62,0xbf48bf13bea7bd493e6d3efc3f373f62,0xbf20bf51bf72bf80bf79bf5fbf33bef1,0xbf25be603e823f2c3f703f7e3f533ef1,0xbf44bf7abf78bf3ebeb23dfb3f113f62,0xbef73e2f3f403f803f4f3e89becabf62,0xbf60bf7cbf2abd493f163f773f6b3ef1
.octa 0xbe9b3f093f7e3f3ebd17bf4abf7abef1,0xbf74bf58be0a3f2c3f803f1dbe54bf62,0xbde23f513f663d49bf5abf5f3c493f62,0xbf7ebf133ee13f803f06befcbf80bef1,0x3db03f7a3f01bf2cbf693dfb3f7c3ef1,0xbf7fbe603f5d3f3ebed5bf7ebe3b3f62,0x3e8f3f7cbd7bbf80be233f773ebebf62,0xbf763e2f3f803d49bf7dbe893f6e3ef1
.octa 0x3eec3f58bf1bbf3e3f3c3f1dbf57bef1,0xbf633f093f4cbf2cbf2e3f4a3f0cbf62,0x3f203f13bf72bd493f79befcbf333f62,0xbf483f513ea7bf803e6d3f5fbf37bef1,0x3f443e60bf783f2c3eb2bf7e3f113ef1,0xbf253f7abe82bf3e3f70bdfbbf533f62,0x3f60be2fbf2a3f80bf16be893f6bbf62,0xbef73f7cbf40bd493f4fbf773eca3ef1
.octa 0x3f74bf09be0a3f3ebf803f4abe54bef1,0xbe9b3f58bf7e3f2cbd17bf1d3f7abf62,0x3f7ebf513ee13d49bf063f5fbf803f62,0xbde23f13bf663f80bf5a3efcbc49bef1,0x3f7fbf7a3f5dbf2c3ed5bdfbbe3b3ef1,0x3db03e60bf013f3ebf693f7ebf7c3f62,0x3f76bf7c3f80bf803f7dbf773f6ebf62,0x3e8fbe2f3d7b3d49be233e89bebe3ef1
.octa 0x3f113efc3ed53eac3e823e2f3db00000,0x3f533f5f3f693f713f783f7c3f7f3f80,0x3f6b3f7e3f7d3f673f403f093e8f0000,0xbecabdfb3e233edb3f2a3f583f763f80,0xbe543e893f2e3f713f7e3f513eec0000,0xbf7abf77bf3cbeac3e0a3f133f633f80,0xbf80bf4abe6d3edb3f663f7a3f200000,0x3c49bf1dbf79bf67bee13e603f483f80
.octa 0xbe3bbf5fbf70beac3f013f7c3f440000,0x3f7c3efcbeb2bf71bf5dbe2f3f253f80,0x3f6e3dfbbf4fbf67bd7b3f583f600000,0x3ebe3f7e3f16bedbbf80bf093ef73f80,0x3f0c3f773d17bf71bf1b3f133f740000,0xbf573e893f803eacbf4cbf513e9b3f80,0xbf373f1d3f5abedbbf723e603f7e0000,0xbf33bf4a3f063f67bea7bf7a3de23f80
.octa 0xbf53befc3f693eacbf78be2f3f7f0000,0x3f11bf5fbed53f713e82bf7cbdb03f80,0x3ecabf7e3e233f67bf2abf093f760000,0x3f6b3dfbbf7d3edb3f40bf58be8f3f80,0x3f7abe89bf3c3f71be0abf513f630000,0xbe543f77bf2ebeac3f7ebf13beec3f80,0xbc493f4abf793edb3ee1bf7a3f480000,0xbf803f1d3e6dbf673f66be60bf203f80
.octa 0xbf7c3f5fbeb2beac3f5dbf7c3f250000,0xbe3bbefc3f70bf713f013e2fbf443f80,0xbebebdfb3f16bf673f80bf583ef70000,0x3f6ebf7e3f4fbedbbd7b3f09bf603f80,0x3f57bf773f80bf713f4cbf133e9b0000,0x3f0cbe89bd173eacbf1b3f51bf743f80,0x3f33bf1d3f06bedb3ea7be603de20000,0xbf373f4abf5a3f67bf723f7abf7e3f80
.octa 0x3f763f6f3f663f5c3f4f3f423f333f22,0x3e8f3eb83ee13f043f163f273f373f46,0xbf63bf39bf01be793d173ea13f113f46,0xbeecbf31bf5dbf78bf80bf73bf53bf22,0x3f483ecfbd7bbf04bf5abf7fbf6bbf22,0x3f203f6a3f803f5c3f063d97becabf46,0xbf25bcc93f1b3f783f693ee6be54bf46,0xbf44bf80bf4cbe793ed53f653f7a3f22
.octa 0x3ef7beb8bf72bf5cbe233f273f803f22,0x3f603f6f3ea7bf04bf7dbf423c493f46,0xbe9b3f313f783e79bf3cbf73be3b3f46,0xbf74bf393e823f783f2ebea1bf7cbf22,0x3de2bf6abf2a3f043f793d97bf6ebf22,0x3f7e3ecfbf40bf5c3e6d3f7f3ebebf46,0x3db03f803e0abf78beb23f653f0cbf46,0xbf7fbcc93f7e3e79bf70bee63f573f22
.octa 0xbe8fbf6f3ee13f5cbf16bf423f373f22,0x3f76beb8bf663f043f4fbf27bf333f46,0x3eec3f39bf5dbe793f80bea1bf533f46,0xbf633f313f01bf783d173f73bf11bf22,0xbf20becf3f80bf04bf063f7fbecabf22,0x3f48bf6a3d7b3f5cbf5abd973f6bbf46,0x3f443cc9bf4c3f78bed5bee63f7abf46,0xbf253f80bf1bbe793f69bf653e543f22
.octa 0xbf603eb83ea7bf5c3f7dbf273c493f22,0x3ef7bf6f3f72bf04be233f42bf803f46,0x3f74bf313e823e79bf2e3f73bf7c3f46,0xbe9b3f39bf783f78bf3c3ea13e3bbf22,0xbf7e3f6abf403f04be6dbd973ebebf22,0x3de2becf3f2abf5c3f79bf7f3f6ebf46,0x3f7fbf803f7ebf783f70bf653f57bf46,0x3db03cc9be0a3e79beb23ee6bf0c3f22
.octa 0x3f6b3f733f793f7d3f803f803f7e3f7b,0xbecabea1be6dbe16bd7b3cc93de23e48,0x3e54bd97beb2bf18bf4cbf6fbf7fbf7b,0x3f7a3f7f3f703f4e3f1b3eb83db0be48,0xbf80bf65bf16be163ea73f393f763f7b,0x3c49bee6bf4fbf7dbf72bf31be8f3e48,0x3e3b3f423f803f4e3e82becfbf63bf7b,0xbf7cbf27bd173f183f783f6a3eecbe48
.octa 0x3f6e3ea1bf06bf7dbf403cc93f483f7b,0x3ebe3f733f5a3e16bf2abf80bf203e48,0xbf0cbf7fbed53f183f7e3eb8bf25bf7b,0x3f57bd97bf69bf4e3e0a3f6f3f44be48,0xbf373ee63f7d3e16bf66bf313ef73f7b,0xbf33bf653e233f7d3ee1bf39bf603e48,0x3f533f27bf2ebf4e3f013f6abe9bbf7b,0xbf113f423f3cbf18bf5d3ecf3f74be48
.octa 0x3ecabf73be6d3f7d3d7bbf803de23f7b,0x3f6b3ea1bf79be163f80bcc9bf7e3e48,0xbf7a3d973f70bf18bf1b3f6f3db0bf7b,0x3e54bf7f3eb23f4ebf4cbeb83f7fbe48,0xbc493f65bf4fbe163f72bf39be8f3f7b,0xbf803ee63f16bf7d3ea73f31bf763e48,0x3f7cbf42bd173f4ebf783ecf3eecbf7b,0x3e3b3f27bf803f183e82bf6a3f63be48
.octa 0xbebebea13f5abf7d3f2abcc9bf203f7b,0x3f6ebf733f063e16bf403f80bf483e48,0xbf573f7fbf693f18be0abeb83f44bf7b,0xbf0c3d973ed5bf4e3f7ebf6f3f25be48,0x3f33bee63e233e16bee13f31bf603f7b,0xbf373f65bf7d3f7dbf663f39bef73e48,0x3f11bf273f3cbf4e3f5dbf6a3f74bf7b,0x3f53bf423f2ebf183f01becf3e9bbe48
.octa 0x3eec3f093f1b3f2c3f3c3f4a3f573f62,0xbf63bf58bf4cbf3ebf2ebf1dbf0cbef1,0x3f203f513f723f803f793f5f3f333ef1,0xbf48bf13bea7bd493e6d3efc3f373f62,0x3f443f7a3f783f3e3eb2bdfbbf11bf62,0xbf25be603e823f2c3f703f7e3f533ef1,0x3f603f7c3f2a3d49bf16bf77bf6bbef1,0xbef73e2f3f403f803f4f3e89becabf62
.octa 0x3f743f583e0abf2cbf80bf1d3e543f62,0xbe9b3f093f7e3f3ebd17bf4abf7abef1,0x3f7e3f13bee1bf80bf063efc3f803ef1,0xbde23f513f663d49bf5abf5f3c493f62,0x3f7f3e60bf5dbf3e3ed53f7e3e3bbf62,0x3db03f7a3f01bf2cbf693dfb3f7c3ef1,0x3f76be2fbf80bd493f7d3e89bf6ebef1,0x3e8f3f7cbd7bbf80be233f773ebebf62
.octa 0x3f63bf09bf4c3f2c3f2ebf4abf0c3f62,0x3eec3f58bf1bbf3e3f3c3f1dbf57bef1,0x3f48bf51bea73f80be6dbf5f3f373ef1,0x3f203f13bf72bd493f79befcbf333f62,0x3f25bf7a3e823f3ebf703dfb3f53bf62,0x3f443e60bf783f2c3eb2bf7e3f113ef1,0x3ef7bf7c3f403d49bf4f3f77becabef1,0x3f60be2fbf2a3f80bf16be893f6bbf62
.octa 0x3e9bbf583f7ebf2c3d173f1dbf7a3f62,0x3f74bf09be0a3f3ebf803f4abe54bef1,0x3de2bf133f66bf803f5abefc3c493ef1,0x3f7ebf513ee13d49bf063f5fbf803f62,0xbdb0be603f01bf3e3f69bf7e3f7cbf62,0x3f7fbf7a3f5dbf2c3ed5bdfbbe3b3ef1,0xbe8f3e2fbd7bbd493e23be893ebebef1,0x3f76bf7c3f80bf803f7dbf773f6ebf62
.octa 0xbf533f5fbf693f71bf783f7cbf7f3f80,0x3f11befc3ed5beac3e82be2f3db08000,0x3ecabdfbbe233edbbf2a3f58bf763f80,0x3f6bbf7e3f7dbf673f40bf093e8f8000,0x3f7abf773f3cbeacbe0a3f13bf633f80,0xbe54be893f2ebf713f7ebf513eec8000,0xbc49bf1d3f79bf673ee13e60bf483f80,0xbf803f4abe6dbedb3f66bf7a3f208000
.octa 0xbf7c3efc3eb2bf713f5dbe2fbf253f80,0xbe3b3f5fbf703eac3f01bf7c3f448000,0xbebe3f7ebf16bedb3f80bf09bef73f80,0x3f6ebdfbbf4f3f67bd7bbf583f608000,0x3f573e89bf803eac3f4cbf51be9b3f80,0x3f0cbf773d173f71bf1bbf133f748000,0x3f33bf4abf063f673ea7bf7abde23f80,0xbf37bf1d3f5a3edbbf72be603f7e8000
.octa 0xbf11bf5f3ed53f71be82bf7c3db03f80,0xbf533efc3f69beacbf783e2f3f7f8000,0xbf6b3dfb3f7d3edbbf40bf583e8f3f80,0x3eca3f7e3e23bf67bf2a3f093f768000,0x3e543f773f2ebeacbf7ebf133eec3f80,0x3f7a3e89bf3cbf71be0a3f513f638000,0x3f803f1dbe6dbf67bf66be603f203f80,0xbc49bf4abf79bedb3ee13f7a3f488000
.octa 0x3e3bbefcbf70bf71bf013e2f3f443f80,0xbf7cbf5fbeb23eac3f5d3f7c3f258000,0xbf6ebf7ebf4fbedb3d7b3f093f603f80,0xbebe3dfb3f163f673f803f583ef78000,0xbf0cbe893d173eac3f1b3f513f743f80,0x3f573f773f803f713f4c3f133e9b8000,0x3f373f4a3f5a3f673f723f7a3f7e3f80,0x3f333f1d3f063edb3ea73e603de28000
.octa 0xbe8f3eb8bee13f04bf163f27bf373f46,0x3f76bf6f3f66bf5c3f4fbf423f33bf22,0x3eecbf313f5dbf783f80bf733f53bf22,0xbf633f39bf013e793d17bea13f11bf46,0xbf203f6abf803f5cbf063d973ecabf46,0x3f48becfbd7b3f04bf5a3f7fbf6b3f22,0x3f44bf803f4cbe79bed53f65bf7a3f22,0xbf253cc93f1bbf783f69bee6be543f46
.octa 0xbf603f6fbea7bf043f7dbf42bc493f46,0x3ef73eb8bf723f5cbe23bf273f80bf22,0x3f74bf39be823f78bf2ebea13f7cbf22,0xbe9bbf313f78be79bf3c3f73be3bbf46,0xbf7e3ecf3f40bf5cbe6d3f7fbebebf46,0x3de23f6abf2abf043f79bd97bf6e3f22,0x3f7fbcc9bf7e3e793f70bee6bf573f22,0x3db0bf803e0a3f78beb2bf653f0c3f46
.octa 0xbf76beb83f663f04bf4fbf273f333f46,0xbe8f3f6f3ee1bf5cbf163f423f37bf22,0x3f633f31bf01bf78bd173f733f11bf22,0x3eecbf39bf5d3e793f803ea1bf53bf46,0xbf48bf6abd7b3f5c3f5abd97bf6bbf46,0xbf203ecf3f803f04bf06bf7fbeca3f22,0x3f253f803f1bbe79bf69bf65be543f22,0x3f44bcc9bf4cbf78bed53ee63f7a3f46
.octa 0xbef7bf6fbf72bf043e233f423f803f46,0xbf60beb83ea73f5c3f7d3f273c49bf22,0x3e9b3f393f783f783f3c3ea1be3bbf22,0x3f743f313e82be79bf2ebf73bf7cbf46,0xbde2becfbf2abf5cbf79bf7fbf6ebf46,0xbf7ebf6abf40bf04be6d3d973ebe3f22,0xbdb03cc93e0a3e793eb23ee63f0c3f22,0x3f7f3f803f7e3f783f703f653f573f46
.octa 0x3ecabea13e6dbe163d7b3cc9bde23e48,0x3f6bbf733f79bf7d3f80bf803f7ebf7b,0xbf7a3f7fbf703f4ebf1b3eb8bdb0be48,0x3e543d97beb23f18bf4c3f6fbf7f3f7b,0xbc49bee63f4fbf7d3f72bf313e8f3e48,0xbf803f65bf163e163ea7bf393f76bf7b,0x3f7cbf273d173f18bf783f6abeecbe48,0x3e3bbf423f80bf4e3e823ecfbf633f7b
.octa 0xbebe3f73bf5a3e163f2abf803f203e48,0x3f6ebea1bf063f7dbf40bcc93f48bf7b,0xbf57bd973f69bf4ebe0a3f6fbf44be48,0xbf0c3f7fbed5bf183f7ebeb8bf253f7b,0x3f33bf65be233f7dbee1bf393f603e48,0xbf37bee63f7dbe16bf663f313ef7bf7b,0x3f113f42bf3cbf183f5d3ecfbf74be48,0x3f53bf27bf2e3f4e3f01bf6abe9b3f7b
.octa 0xbf6b3ea13f79be16bf80bcc93f7e3e48,0x3eca3f73be6dbf7d3d7b3f803de2bf7b,0xbe54bf7fbeb23f4e3f4cbeb8bf7fbe48,0xbf7abd973f703f18bf1bbf6f3db03f7b,0x3f803ee6bf16bf7dbea73f313f763e48,0xbc49bf65bf4f3e163f723f39be8fbf7b,0xbe3b3f273f803f18be82bf6abf63be48,0x3f7c3f42bd17bf4ebf78becf3eec3f7b
.octa 0xbf6ebf73bf063e163f403f803f483e48,0xbebe3ea13f5a3f7d3f2a3cc9bf20bf7b,0x3f0c3d97bed5bf4ebf7ebf6fbf25be48,0xbf57bf7fbf69bf18be0a3eb83f443f7b,0x3f373f653f7d3f7d3f663f393ef73e48,0x3f333ee63e23be16bee1bf31bf60bf7b,0xbf53bf42bf2ebf18bf01becfbe9bbe48,0x3f113f273f3c3f4e3f5d3f6a3f743f7b
.octa 0x3f63bf583f4cbf3e3f2ebf1d3f0cbef1,0x3eecbf093f1bbf2c3f3cbf4a3f57bf62,0x3f48bf133ea7bd49be6d3efcbf373f62,0x3f20bf513f72bf803f79bf5f3f33bef1,0x3f25be60be823f2cbf703f7ebf533ef1,0x3f44bf7a3f78bf3e3eb23dfbbf113f62,0x3ef73e2fbf403f80bf4f3e893ecabf62,0x3f60bf7c3f2abd49bf163f77bf6b3ef1
.octa 0x3e9b3f09bf7e3f3e3d17bf4a3f7abef1,0x3f74bf583e0a3f2cbf803f1d3e54bf62,0x3de23f51bf663d493f5abf5fbc493f62,0x3f7ebf13bee13f80bf06befc3f80bef1,0xbdb03f7abf01bf2c3f693dfbbf7c3ef1,0x3f7fbe60bf5d3f3e3ed5bf7e3e3b3f62,0xbe8f3f7c3d7bbf803e233f77bebebf62,0x3f763e2fbf803d493f7dbe89bf6e3ef1
.octa 0xbeec3f583f1bbf3ebf3c3f1d3f57bef1,0x3f633f09bf4cbf2c3f2e3f4abf0cbf62,0xbf203f133f72bd49bf79befc3f333f62,0x3f483f51bea7bf80be6d3f5f3f37bef1,0xbf443e603f783f2cbeb2bf7ebf113ef1,0x3f253f7a3e82bf3ebf70bdfb3f533f62,0xbf60be2f3f2a3f803f16be89bf6bbf62,0x3ef73f7c3f40bd49bf4fbf77beca3ef1
.octa 0xbf74bf093e0a3f3e3f803f4a3e54bef1,0x3e9b3f583f7e3f2c3d17bf1dbf7abf62,0xbf7ebf51bee13d493f063f5f3f803f62,0x3de23f133f663f803f5a3efc3c49bef1,0xbf7fbf7abf5dbf2cbed5bdfb3e3b3ef1,0xbdb03e603f013f3e3f693f7e3f7c3f62,0xbf76bf7cbf80bf80bf7dbf77bf6ebf62,0xbe8fbe2fbd7b3d493e233e893ebe3ef1
.octa 0xbf113efcbed53eacbe823e2fbdb00000,0xbf533f5fbf693f71bf783f7cbf7f3f80,0xbf6b3f7ebf7d3f67bf403f09be8f0000,0x3ecabdfbbe233edbbf2a3f58bf763f80,0x3e543e89bf2e3f71bf7e3f51beec0000,0x3f7abf773f3cbeacbe0a3f13bf633f80,0x3f80bf4a3e6d3edbbf663f7abf200000,0xbc49bf1d3f79bf673ee13e60bf483f80
.octa 0x3e3bbf5f3f70beacbf013f7cbf440000,0xbf7c3efc3eb2bf713f5dbe2fbf253f80,0xbf6e3dfb3f4fbf673d7b3f58bf600000,0xbebe3f7ebf16bedb3f80bf09bef73f80,0xbf0c3f77bd17bf713f1b3f13bf740000,0x3f573e89bf803eac3f4cbf51be9b3f80,0x3f373f1dbf5abedb3f723e60bf7e0000,0x3f33bf4abf063f673ea7bf7abde23f80
.octa 0x3f53befcbf693eac3f78be2fbf7f0000,0xbf11bf5f3ed53f71be82bf7c3db03f80,0xbecabf7ebe233f673f2abf09bf760000,0xbf6b3dfb3f7d3edbbf40bf583e8f3f80,0xbf7abe893f3c3f713e0abf51bf630000,0x3e543f773f2ebeacbf7ebf133eec3f80,0x3c493f4a3f793edbbee1bf7abf480000,0x3f803f1dbe6dbf67bf66be603f203f80
.octa 0x3f7c3f5f3eb2beacbf5dbf7cbf250000,0x3e3bbefcbf70bf71bf013e2f3f443f80,0x3ebebdfbbf16bf67bf80bf58bef70000,0xbf6ebf7ebf4fbedb3d7b3f093f603f80,0xbf57bf77bf80bf71bf4cbf13be9b0000,0xbf0cbe893d173eac3f1b3f513f743f80,0xbf33bf1dbf06bedbbea7be60bde20000,0x3f373f4a3f5a3f673f723f7a3f7e3f80
.octa 0xbf763f6fbf663f5cbf4f3f42bf333f22,0xbe8f3eb8bee13f04bf163f27bf373f46,0x3f63bf393f01be79bd173ea1bf113f46,0x3eecbf313f5dbf783f80bf733f53bf22,0xbf483ecf3d7bbf043f5abf7f3f6bbf22,0xbf203f6abf803f5cbf063d973ecabf46,0x3f25bcc9bf1b3f78bf693ee63e54bf46,0x3f44bf803f4cbe79bed53f65bf7a3f22
.octa 0xbef7beb83f72bf5c3e233f27bf803f22,0xbf603f6fbea7bf043f7dbf42bc493f46,0x3e9b3f31bf783e793f3cbf733e3b3f46,0x3f74bf39be823f78bf2ebea13f7cbf22,0xbde2bf6a3f2a3f04bf793d973f6ebf22,0xbf7e3ecf3f40bf5cbe6d3f7fbebebf46,0xbdb03f80be0abf783eb23f65bf0cbf46,0x3f7fbcc9bf7e3e793f70bee6bf573f22
.octa 0x3e8fbf6fbee13f5c3f16bf42bf373f22,0xbf76beb83f663f04bf4fbf273f333f46,0xbeec3f393f5dbe79bf80bea13f533f46,0x3f633f31bf01bf78bd173f733f11bf22,0x3f20becfbf80bf043f063f7f3ecabf22,0xbf48bf6abd7b3f5c3f5abd97bf6bbf46,0xbf443cc93f4c3f783ed5bee6bf7abf46,0x3f253f803f1bbe79bf69bf65be543f22
.octa 0x3f603eb8bea7bf5cbf7dbf27bc493f22,0xbef7bf6fbf72bf043e233f423f803f46,0xbf74bf31be823e793f2e3f733f7c3f46,0x3e9b3f393f783f783f3c3ea1be3bbf22,0x3f7e3f6a3f403f043e6dbd97bebebf22,0xbde2becfbf2abf5cbf79bf7fbf6ebf46,0xbf7fbf80bf7ebf78bf70bf65bf57bf46,0xbdb03cc93e0a3e793eb23ee63f0c3f22
.octa 0xbf6b3f73bf793f7dbf803f80bf7e3f7b,0x3ecabea13e6dbe163d7b3cc9bde23e48,0xbe54bd973eb2bf183f4cbf6f3f7fbf7b,0xbf7a3f7fbf703f4ebf1b3eb8bdb0be48,0x3f80bf653f16be16bea73f39bf763f7b,0xbc49bee63f4fbf7d3f72bf313e8f3e48,0xbe3b3f42bf803f4ebe82becf3f63bf7b,0x3f7cbf273d173f18bf783f6abeecbe48
.octa 0xbf6e3ea13f06bf7d3f403cc9bf483f7b,0xbebe3f73bf5a3e163f2abf803f203e48,0x3f0cbf7f3ed53f18bf7e3eb83f25bf7b,0xbf57bd973f69bf4ebe0a3f6fbf44be48,0x3f373ee6bf7d3e163f66bf31bef73f7b,0x3f33bf65be233f7dbee1bf393f603e48,0xbf533f273f2ebf4ebf013f6a3e9bbf7b,0x3f113f42bf3cbf183f5d3ecfbf74be48
.octa 0xbecabf733e6d3f7dbd7bbf80bde23f7b,0xbf6b3ea13f79be16bf80bcc93f7e3e48,0x3f7a3d97bf70bf183f1b3f6fbdb0bf7b,0xbe54bf7fbeb23f4e3f4cbeb8bf7fbe48,0x3c493f653f4fbe16bf72bf393e8f3f7b,0x3f803ee6bf16bf7dbea73f313f763e48,0xbf7cbf423d173f4e3f783ecfbeecbf7b,0xbe3b3f273f803f18be82bf6abf63be48
.octa 0x3ebebea1bf5abf7dbf2abcc93f203f7b,0xbf6ebf73bf063e163f403f803f483e48,0x3f573f7f3f693f183e0abeb8bf44bf7b,0x3f0c3d97bed5bf4ebf7ebf6fbf25be48,0xbf33bee6be233e163ee13f313f603f7b,0x3f373f653f7d3f7d3f663f393ef73e48,0xbf11bf27bf3cbf4ebf5dbf6abf74bf7b,0xbf53bf42bf2ebf18bf01becfbe9bbe48
.octa 0xbeec3f09bf1b3f2cbf3c3f4abf573f62,0x3f63bf583f4cbf3e3f2ebf1d3f0cbef1,0xbf203f51bf723f80bf793f5fbf333ef1,0x3f48bf133ea7bd49be6d3efcbf373f62,0xbf443f7abf783f3ebeb2bdfb3f11bf62,0x3f25be60be823f2cbf703f7ebf533ef1,0xbf603f7cbf2a3d493f16bf773f6bbef1,0x3ef73e2fbf403f80bf4f3e893ecabf62
.octa 0xbf743f58be0abf2c3f80bf1dbe543f62,0x3e9b3f09bf7e3f3e3d17bf4a3f7abef1,0xbf7e3f133ee1bf803f063efcbf803ef1,0x3de23f51bf663d493f5abf5fbc493f62,0xbf7f3e603f5dbf3ebed53f7ebe3bbf62,0xbdb03f7abf01bf2c3f693dfbbf7c3ef1,0xbf76be2f3f80bd49bf7d3e893f6ebef1,0xbe8f3f7c3d7bbf803e233f77bebebf62
.octa 0xbf63bf093f4c3f2cbf2ebf4a3f0c3f62,0xbeec3f583f1bbf3ebf3c3f1d3f57bef1,0xbf48bf513ea73f803e6dbf5fbf373ef1,0xbf203f133f72bd49bf79befc3f333f62,0xbf25bf7abe823f3e3f703dfbbf53bf62,0xbf443e603f783f2cbeb2bf7ebf113ef1,0xbef7bf7cbf403d493f4f3f773ecabef1,0xbf60be2f3f2a3f803f16be89bf6bbf62
.octa 0xbe9bbf58bf7ebf2cbd173f1d3f7a3f62,0xbf74bf093e0a3f3e3f803f4a3e54bef1,0xbde2bf13bf66bf80bf5abefcbc493ef1,0xbf7ebf51bee13d493f063f5f3f803f62,0x3db0be60bf01bf3ebf69bf7ebf7cbf62,0xbf7fbf7abf5dbf2cbed5bdfb3e3b3ef1,0x3e8f3e2f3d7bbd49be23be89bebebef1,0xbf76bf7cbf80bf80bf7dbf77bf6ebf62
.octa 0x3f503f5c3f673f703f773f7c3f7f3f80,0xbf15bf02bedcbeb2be87be35bdb68000,0xbed4be103e133ed53f283f573f763f80,0xbf69bf7dbf7dbf69bf41bf0abe908000,0xbf79bf78bf3ebeb23e003f123f633f80,0x3e6abe7fbf2bbf70bf7ebf52beed8000,0x3d0abf1abf78bf69bee53e5a3f473f80,0x3f803f4d3e7cbed5bf65bf7abf218000
.octa 0x3f7d3f02beabbf70bf5ebe353f243f80,0x3e263f5c3f713eb2befebf7cbf448000,0x3eb43f7d3f19bed5bf7fbf0a3ef63f80,0xbf70be103f4d3f693d90bf57bf618000,0xbf5a3e7f3f803eb2bf4abf523e993f80,0xbf07bf78bd563f703f1dbf12bf748000,0xbf2fbf4d3f033f69bea2bf7a3ddb3f80,0x3f3bbf1abf5c3ed53f73be5abf7f8000
.octa 0x3f15bf5cbedc3f703e87bf7cbdb63f80,0x3f503f02bf67beb23f773e35bf7f8000,0x3f693e10bf7d3ed53f41bf57be903f80,0xbed43f7dbe13bf693f283f0abf768000,0xbe6a3f78bf2bbeb23f7ebf12beed3f80,0xbf793e7f3f3ebf703e003f52bf638000,0xbf803f1a3e7cbf693f65be5abf213f80,0x3d0abf4d3f78bed5bee53f7abf478000
.octa 0xbe26bf023f71bf703efe3e35bf443f80,0x3f7dbf5c3eab3eb2bf5e3f7cbf248000,0x3f70bf7d3f4dbed5bd903f0abf613f80,0x3eb43e10bf193f69bf7f3f57bef68000,0x3f07be7fbd563eb2bf1d3f52bf743f80,0xbf5a3f78bf803f70bf4a3f12be998000,0xbf3b3f4dbf5c3f69bf733f7abf7f3f80,0xbf2f3f1abf033ed5bea23e5abddb8000
.octa 0x3e703ea43ece3ef73f0f3f213f323f42,0xbf79bf73bf6abf60bf54bf47bf38bf27,0xbed7bf28bf58bf76bf80bf75bf57bf27,0x3f683f413f0a3e8fbb49be92bf0bbf42,0x3f173f653f803f603f0e3dd5bebdbf42,0xbf4fbee33cb03ef73f553f7f3f6e3f27,0xbf3cbf7fbf52be8f3ec53f613f7c3f27,0x3f2e3d8abf13bf76bf6cbef43e383f42
.octa 0x3f5a3f733ebabef7bf7bbf47bc7b3f42,0xbf063ea43f6f3f603e45bf21bf80bf27,0xbf70bf413e5d3f763f34be92bf7abf27,0x3eb1bf28bf7abe8f3f363f753e57bf42,0x3f7d3ee3bf39bf603e4b3f7f3ecbbf42,0xbe203f653f31bef7bf7bbdd53f6b3f27,0xbf80bd8a3f7c3e8fbf6dbef43f533f27,0xbd23bf7fbe323f763ec2bf61bf113f42
.octa 0x3f79bea4bf6a3ef73f54bf21bf383f42,0x3e703f73becebf603f0f3f47bf32bf27,0xbf683f283f0abf763b493f75bf0bbf27,0xbed7bf413f583e8fbf803e923f57bf42,0x3f4fbf653cb03f60bf55bdd53f6ebf42,0x3f173ee3bf803ef73f0ebf7f3ebd3f27,0xbf2e3f7fbf13be8f3f6cbf613e383f27,0xbf3cbd8a3f52bf763ec53ef4bf7c3f42
.octa 0x3f06bf733f6fbef7be453f47bf803f42,0x3f5abea4beba3f60bf7b3f213c7bbf27,0xbeb13f41bf7a3f76bf363e923e57bf27,0xbf703f28be5dbe8f3f34bf753f7abf42,0x3e20bee33f31bf603f7bbf7f3f6bbf42,0x3f7dbf653f39bef73e4b3dd5becb3f27,0x3d233d8abe323e8fbec23ef4bf113f27,0xbf803f7fbf7c3f76bf6d3f61bf533f42
.octa 0xbeeabec1be96be54bdf4bcfb3d6f3e16,0xbf64bf6dbf75bf7abf7ebf80bf80bf7d,0x3f763f803f753f573f273ed23e0dbe16,0xbe8d3bc93e933f0c3f423f693f7e3f7d,0x3da9bec7bf45bf7abf77bf3abea83e16,0x3f7f3f6c3f233e54be8abf2fbf72bf7d,0xbf7ebf34bdcf3f0c3f733f6f3f02be16,0xbde8bf36bf7fbf57be9f3eb53f5d3f7d
.octa 0x3e9c3f6d3f623e54bf1ebf80bf2a3e16,0xbf74bec13ef03f7a3f493cfbbf3fbf7d,0x3f60bbc9bf61bf573d9d3f693f4cbe16,0x3ef83f803ef3bf0cbf7fbed23f1a3f7d,0xbf25bf6c3dc23f7a3efbbf2fbf663e16,0x3f43bec7bf7fbe543f5f3f3abedfbf7d,0xbf1f3f363f46bf0cbf643eb53f78be16,0xbf48bf343f223f57bee8bf6f3e813f7d
.octa 0x3f643ec1bf75be543f7e3cfbbf803e16,0xbeea3f6d3e96bf7abdf43f80bd6fbf7d,0x3e8dbf803e933f57bf42bed23f7ebe16,0x3f76bbc9bf753f0c3f27bf69be0d3f7d,0xbf7f3ec73f23bf7a3e8a3f3abf723e16,0x3da9bf6c3f453e54bf773f2f3ea8bf7d,0x3de83f34bf7f3f0c3e9fbf6f3f5dbe16,0xbf7e3f363dcfbf573f73beb5bf023f7d
.octa 0x3f74bf6d3ef03e54bf493f80bf3f3e16,0x3e9c3ec1bf623f7abf1ebcfb3f2abf7d,0xbef83bc93ef3bf573f7fbf693f1abe16,0x3f60bf803f61bf0c3d9d3ed2bf4c3f7d,0xbf433f6cbf7f3f7abf5f3f2fbedf3e16,0xbf253ec7bdc2be543efbbf3a3f66bf7d,0x3f48bf363f22bf0c3ee8beb53e81be16,0xbf1f3f34bf463f57bf643f6fbf783f7d
.octa 0xbf6dbf64bf59bf4cbf3dbf2dbf1cbf09,0xbec0bee9bf08bf1bbf2dbf3dbf4bbf58,0xbf56bf26bed1be0a3e193ed83f293f58,0xbf0cbf43bf6abf7ebf7dbf68bf40bf09,0xbf37be9e3e2c3f1b3f683f803f5e3f09,0xbf33bf74bf7cbf4cbed93d303f003f58,0xbf103da33f303f7e3f5b3eafbea5bf58,0xbf54bf7fbf3abe0a3f043f713f723f09
.octa 0xbec83ee93f7a3f4c3d3cbf3dbf7ebf09,0xbf6cbf64be633f1b3f803f2dbe07bf58,0xbe513f433f6f3e0abf4ebf68bd843f58,0xbf7bbf263eb73f7e3f18bed8bf7fbf09,0xbc173f743f14bf1bbf713d303f773f09,0xbf80be9e3f513f4cbeaebf80be843f58,0x3e3f3f7f3ce2bf7ebe763f713ee2bf58,0xbf7c3da33f803e0abf79beaf3f663f09
.octa 0x3ec03f64bf08bf4c3f2d3f2dbf4bbf09,0xbf6d3ee93f59bf1bbf3d3f3d3f1cbf58,0x3f0c3f26bf6abe0a3f7dbed8bf403f58,0xbf563f433ed1bf7e3e193f68bf29bf09,0x3f333e9ebf7c3f1b3ed9bf803f003f09,0xbf373f74be2cbf4c3f68bd30bf5e3f58,0x3f54bda3bf3a3f7ebf04beaf3f72bf58,0xbf103f7fbf30be0a3f5bbf713ea53f09
.octa 0x3f6cbee9be633f4cbf803f3dbe07bf09,0xbec83f64bf7a3f1b3d3cbf2d3f7ebf58,0x3f7bbf433eb73e0abf183f68bf7f3f58,0xbe513f26bf6f3f7ebf4e3ed83d84bf09,0x3f80bf743f51bf1b3eaebd30be843f09,0xbc173e9ebf143f4cbf713f80bf773f58,0x3f7cbf7f3f80bf7e3f79bf713f66bf58,0x3e3fbda3bce23e0abe763eafbee23f09
.octa 0x3f153f023edc3eb23e873e353db60000,0x3f503f5c3f673f703f773f7c3f7f3f80,0x3f693f7d3f7d3f693f413f0a3e900000,0xbed4be103e133ed53f283f573f763f80,0xbe6a3e7f3f2b3f703f7e3f523eed0000,0xbf79bf78bf3ebeb23e003f123f633f80,0xbf80bf4dbe7c3ed53f653f7a3f210000,0x3d0abf1abf78bf69bee53e5a3f473f80
.octa 0xbe26bf5cbf71beb23efe3f7c3f440000,0x3f7d3f02beabbf70bf5ebe353f243f80,0x3f703e10bf4dbf69bd903f573f610000,0x3eb43f7d3f19bed5bf7fbf0a3ef63f80,0x3f073f783d56bf70bf1d3f123f740000,0xbf5a3e7f3f803eb2bf4abf523e993f80,0xbf3b3f1a3f5cbed5bf733e5a3f7f0000,0xbf2fbf4d3f033f69bea2bf7a3ddb3f80
.octa 0xbf50bf023f673eb2bf77be353f7f0000,0x3f15bf5cbedc3f703e87bf7cbdb63f80,0x3ed4bf7d3e133f69bf28bf0a3f760000,0x3f693e10bf7d3ed53f41bf57be903f80,0x3f79be7fbf3e3f70be00bf523f630000,0xbe6a3f78bf2bbeb23f7ebf12beed3f80,0xbd0a3f4dbf783ed53ee5bf7a3f470000,0xbf803f1a3e7cbf693f65be5abf213f80
.octa 0xbf7d3f5cbeabbeb23f5ebf7c3f240000,0xbe26bf023f71bf703efe3e35bf443f80,0xbeb4be103f19bf693f7fbf573ef60000,0x3f70bf7d3f4dbed5bd903f0abf613f80,0x3f5abf783f80bf703f4abf123e990000,0x3f07be7fbd563eb2bf1d3f52bf743f80,0x3f2fbf1a3f03bed53ea2be5a3ddb0000,0xbf3b3f4dbf5c3f69bf733f7abf7f3f80
.octa 0x3f793f733f6a3f603f543f473f383f27,0x3e703ea43ece3ef73f0f3f213f323f42,0xbf68bf41bf0abe8f3b493e923f0b3f42,0xbed7bf28bf58bf76bf80bf75bf57bf27,0x3f4f3ee3bcb0bef7bf55bf7fbf6ebf27,0x3f173f653f803f603f0e3dd5bebdbf42,0xbf2ebd8a3f133f763f6c3ef4be38bf42,0xbf3cbf7fbf52be8f3ec53f613f7c3f27
.octa 0x3f06bea4bf6fbf60be453f213f803f27,0x3f5a3f733ebabef7bf7bbf47bc7b3f42,0xbeb13f283f7a3e8fbf36bf75be573f42,0xbf70bf413e5d3f763f34be92bf7abf27,0x3e20bf65bf313ef73f7b3dd5bf6bbf27,0x3f7d3ee3bf39bf603e4b3f7f3ecbbf42,0x3d233f7f3e32bf76bec23f613f11bf42,0xbf80bd8a3f7c3e8fbf6dbef43f533f27
.octa 0xbe70bf733ece3f60bf0fbf473f323f27,0x3f79bea4bf6a3ef73f54bf21bf383f42,0x3ed73f41bf58be8f3f80be92bf573f42,0xbf683f283f0abf763b493f75bf0bbf27,0xbf17bee33f80bef7bf0e3f7fbebdbf27,0x3f4fbf653cb03f60bf55bdd53f6ebf42,0x3f3c3d8abf523f76bec5bef43f7cbf42,0xbf2e3f7fbf13be8f3f6cbf613e383f27
.octa 0xbf5a3ea43ebabf603f7bbf21bc7b3f27,0x3f06bf733f6fbef7be453f47bf803f42,0x3f70bf283e5d3e8fbf343f75bf7a3f42,0xbeb13f41bf7a3f76bf363e923e57bf27,0xbf7d3f65bf393ef7be4bbdd53ecbbf27,0x3e20bee33f31bf603f7bbf7f3f6bbf42,0x3f80bf7f3f7cbf763f6dbf613f53bf42,0x3d233d8abe323e8fbec23ef4bf113f27
.octa 0x3f643f6d3f753f7a3f7e3f803f803f7d,0xbeeabec1be96be54bdf4bcfb3d6f3e16,0x3e8dbbc9be93bf0cbf42bf69bf7ebf7d,0x3f763f803f753f573f273ed23e0dbe16,0xbf7fbf6cbf23be543e8a3f2f3f723f7d,0x3da9bec7bf45bf7abf77bf3abea83e16,0x3de83f363f7f3f573e9fbeb5bf5dbf7d,0xbf7ebf34bdcf3f0c3f733f6f3f02be16
.octa 0x3f743ec1bef0bf7abf49bcfb3f3f3f7d,0x3e9c3f6d3f623e54bf1ebf80bf2a3e16,0xbef8bf80bef33f0c3f7f3ed2bf1abf7d,0x3f60bbc9bf61bf573d9d3f693f4cbe16,0xbf433ec73f7f3e54bf5fbf3a3edf3f7d,0xbf25bf6c3dc23f7a3efbbf2fbf663e16,0x3f483f34bf22bf573ee83f6fbe81bf7d,0xbf1f3f363f46bf0cbf643eb53f78be16
.octa 0x3eeabf6dbe963f7a3df4bf803d6f3f7d,0x3f643ec1bf75be543f7e3cfbbf803e16,0xbf763bc93f75bf0cbf273f693e0dbf7d,0x3e8dbf803e933f57bf42bed23f7ebe16,0xbda93f6cbf45be543f77bf2fbea83f7d,0xbf7f3ec73f23bf7a3e8a3f3abf723e16,0x3f7ebf36bdcf3f57bf733eb53f02bf7d,0x3de83f34bf7f3f0c3e9fbf6f3f5dbe16
.octa 0xbe9cbec13f62bf7a3f1e3cfbbf2a3f7d,0x3f74bf6d3ef03e54bf493f80bf3f3e16,0xbf603f80bf613f0cbd9dbed23f4cbf7d,0xbef83bc93ef3bf573f7fbf693f1abe16,0x3f25bec73dc23e54befb3f3abf663f7d,0xbf433f6cbf7f3f7abf5f3f2fbedf3e16,0x3f1fbf343f46bf573f64bf6f3f78bf7d,0x3f48bf363f22bf0c3ee8beb53e81be16
.octa 0x3ec03ee93f083f1b3f2d3f3d3f4b3f58,0xbf6dbf64bf59bf4cbf3dbf2dbf1cbf09,0x3f0c3f433f6a3f7e3f7d3f683f403f09,0xbf56bf26bed1be0a3e193ed83f293f58,0x3f333f743f7c3f4c3ed9bd30bf00bf58,0xbf37be9e3e2c3f1b3f683f803f5e3f09,0x3f543f7f3f3a3e0abf04bf71bf72bf09,0xbf103da33f303f7e3f5b3eafbea5bf58
.octa 0x3f6c3f643e63bf1bbf80bf2d3e073f58,0xbec83ee93f7a3f4c3d3cbf3dbf7ebf09,0x3f7b3f26beb7bf7ebf183ed83f7f3f09,0xbe513f433f6f3e0abf4ebf68bd843f58,0x3f803e9ebf51bf4c3eae3f803e84bf58,0xbc173f743f14bf1bbf713d303f773f09,0x3f7cbda3bf80be0a3f793eafbf66bf09,0x3e3f3f7f3ce2bf7ebe763f713ee2bf58
.octa 0x3f6dbee9bf593f1b3f3dbf3dbf1c3f58,0x3ec03f64bf08bf4c3f2d3f2dbf4bbf09,0x3f56bf43bed13f7ebe19bf683f293f09,0x3f0c3f26bf6abe0a3f7dbed8bf403f58,0x3f37bf743e2c3f4cbf683d303f5ebf58,0x3f333e9ebf7c3f1b3ed9bf803f003f09,0x3f10bf7f3f303e0abf5b3f71bea5bf09,0x3f54bda3bf3a3f7ebf04beaf3f72bf58
.octa 0x3ec8bf643f7abf1bbd3c3f2dbf7e3f58,0x3f6cbee9be633f4cbf803f3dbe07bf09,0x3e51bf263f6fbf7e3f4ebed8bd843f09,0x3f7bbf433eb73e0abf183f68bf7f3f58,0x3c17be9e3f14bf4c3f71bf803f77bf58,0x3f80bf743f51bf1b3eaebd30be843f09,0xbe3f3da33ce2be0a3e76beaf3ee2bf09,0x3f7cbf7f3f80bf7e3f79bf713f66bf58
.octa 0xbf503f5cbf673f70bf773f7cbf7f3f80,0x3f15bf023edcbeb23e87be353db68000,0x3ed4be10be133ed5bf283f57bf763f80,0x3f69bf7d3f7dbf693f41bf0a3e908000,0x3f79bf783f3ebeb2be003f12bf633f80,0xbe6abe7f3f2bbf703f7ebf523eed8000,0xbd0abf1a3f78bf693ee53e5abf473f80,0xbf803f4dbe7cbed53f65bf7a3f218000
.octa 0xbf7d3f023eabbf703f5ebe35bf243f80,0xbe263f5cbf713eb23efebf7c3f448000,0xbeb43f7dbf19bed53f7fbf0abef63f80,0x3f70be10bf4d3f69bd90bf573f618000,0x3f5a3e7fbf803eb23f4abf52be993f80,0x3f07bf783d563f70bf1dbf123f748000,0x3f2fbf4dbf033f693ea2bf7abddb3f80,0xbf3bbf1a3f5c3ed5bf73be5a3f7f8000
.octa 0xbf15bf5c3edc3f70be87bf7c3db63f80,0xbf503f023f67beb2bf773e353f7f8000,0xbf693e103f7d3ed5bf41bf573e903f80,0x3ed43f7d3e13bf69bf283f0a3f768000,0x3e6a3f783f2bbeb2bf7ebf123eed3f80,0x3f793e7fbf3ebf70be003f523f638000,0x3f803f1abe7cbf69bf65be5a3f213f80,0xbd0abf4dbf78bed53ee53f7a3f478000
.octa 0x3e26bf02bf71bf70befe3e353f443f80,0xbf7dbf5cbeab3eb23f5e3f7c3f248000,0xbf70bf7dbf4dbed53d903f0a3f613f80,0xbeb43e103f193f693f7f3f573ef68000,0xbf07be7f3d563eb23f1d3f523f743f80,0x3f5a3f783f803f703f4a3f123e998000,0x3f3b3f4d3f5c3f693f733f7a3f7f3f80,0x3f2f3f1a3f033ed53ea23e5a3ddb8000
.octa 0xbe703ea4bece3ef7bf0f3f21bf323f42,0x3f79bf733f6abf603f54bf473f38bf27,0x3ed7bf283f58bf763f80bf753f57bf27,0xbf683f41bf0a3e8f3b49be923f0bbf42,0xbf173f65bf803f60bf0e3dd53ebdbf42,0x3f4fbee3bcb03ef7bf553f7fbf6e3f27,0x3f3cbf7f3f52be8fbec53f61bf7c3f27,0xbf2e3d8a3f13bf763f6cbef4be383f42
.octa 0xbf5a3f73bebabef73f7bbf473c7b3f42,0x3f063ea4bf6f3f60be45bf213f80bf27,0x3f70bf41be5d3f76bf34be923f7abf27,0xbeb1bf283f7abe8fbf363f75be57bf42,0xbf7d3ee33f39bf60be4b3f7fbecbbf42,0x3e203f65bf31bef73f7bbdd5bf6b3f27,0x3f80bd8abf7c3e8f3f6dbef4bf533f27,0x3d23bf7f3e323f76bec2bf613f113f42
.octa 0xbf79bea43f6a3ef7bf54bf213f383f42,0xbe703f733ecebf60bf0f3f473f32bf27,0x3f683f28bf0abf76bb493f753f0bbf27,0x3ed7bf41bf583e8f3f803e92bf57bf42,0xbf4fbf65bcb03f603f55bdd5bf6ebf42,0xbf173ee33f803ef7bf0ebf7fbebd3f27,0x3f2e3f7f3f13be8fbf6cbf61be383f27,0x3f3cbd8abf52bf76bec53ef43f7c3f42
.octa 0xbf06bf73bf6fbef73e453f473f803f42,0xbf5abea43eba3f603f7b3f21bc7bbf27,0x3eb13f413f7a3f763f363e92be57bf27,0x3f703f283e5dbe8fbf34bf75bf7abf42,0xbe20bee3bf31bf60bf7bbf7fbf6bbf42,0xbf7dbf65bf39bef7be4b3dd53ecb3f27,0xbd233d8a3e323e8f3ec23ef43f113f27,0x3f803f7f3f7c3f763f6d3f613f533f42
.octa 0x3eeabec13e96be543df4bcfbbd6f3e16,0x3f64bf6d3f75bf7a3f7ebf803f80bf7d,0xbf763f80bf753f57bf273ed2be0dbe16,0x3e8d3bc9be933f0cbf423f69bf7e3f7d,0xbda9bec73f45bf7a3f77bf3a3ea83e16,0xbf7f3f6cbf233e543e8abf2f3f72bf7d,0x3f7ebf343dcf3f0cbf733f6fbf02be16,0x3de8bf363f7fbf573e9f3eb5bf5d3f7d
.octa 0xbe9c3f6dbf623e543f1ebf803f2a3e16,0x3f74bec1bef03f7abf493cfb3f3fbf7d,0xbf60bbc93f61bf57bd9d3f69bf4cbe16,0xbef83f80bef3bf0c3f7fbed2bf1a3f7d,0x3f25bf6cbdc23f7abefbbf2f3f663e16,0xbf43bec73f7fbe54bf5f3f3a3edfbf7d,0x3f1f3f36bf46bf0c3f643eb5bf78be16,0x3f48bf34bf223f573ee8bf6fbe813f7d
.octa 0xbf643ec13f75be54bf7e3cfb3f803e16,0x3eea3f6dbe96bf7a3df43f803d6fbf7d,0xbe8dbf80be933f573f42bed2bf7ebe16,0xbf76bbc93f753f0cbf27bf693e0d3f7d,0x3f7f3ec7bf23bf7abe8a3f3a3f723e16,0xbda9bf6cbf453e543f773f2fbea8bf7d,0xbde83f343f7f3f0cbe9fbf6fbf5dbe16,0x3f7e3f36bdcfbf57bf73beb53f023f7d
.octa 0xbf74bf6dbef03e543f493f803f3f3e16,0xbe9c3ec13f623f7a3f1ebcfbbf2abf7d,0x3ef83bc9bef3bf57bf7fbf69bf1abe16,0xbf60bf80bf61bf0cbd9d3ed23f4c3f7d,0x3f433f6c3f7f3f7a3f5f3f2f3edf3e16,0x3f253ec73dc2be54befbbf3abf66bf7d,0xbf48bf36bf22bf0cbee8beb5be81be16,0x3f1f3f343f463f573f643f6f3f783f7d
.octa 0x3f6dbf643f59bf4c3f3dbf2d3f1cbf09,0x3ec0bee93f08bf1b3f2dbf3d3f4bbf58,0x3f56bf263ed1be0abe193ed8bf293f58,0x3f0cbf433f6abf7e3f7dbf683f40bf09,0x3f37be9ebe2c3f1bbf683f80bf5e3f09,0x3f33bf743f7cbf4c3ed93d30bf003f58,0x3f103da3bf303f7ebf5b3eaf3ea5bf58,0x3f54bf7f3f3abe0abf043f71bf723f09
.octa 0x3ec83ee9bf7a3f4cbd3cbf3d3f7ebf09,0x3f6cbf643e633f1bbf803f2d3e07bf58,0x3e513f43bf6f3e0a3f4ebf683d843f58,0x3f7bbf26beb73f7ebf18bed83f7fbf09,0x3c173f74bf14bf1b3f713d30bf773f09,0x3f80be9ebf513f4c3eaebf803e843f58,0xbe3f3f7fbce2bf7e3e763f71bee2bf58,0x3f7c3da3bf803e0a3f79beafbf663f09
.octa 0xbec03f643f08bf4cbf2d3f2d3f4bbf09,0x3f6d3ee9bf59bf1b3f3d3f3dbf1cbf58,0xbf0c3f263f6abe0abf7dbed83f403f58,0x3f563f43bed1bf7ebe193f683f29bf09,0xbf333e9e3f7c3f1bbed9bf80bf003f09,0x3f373f743e2cbf4cbf68bd303f5e3f58,0xbf54bda33f3a3f7e3f04beafbf72bf58,0x3f103f7f3f30be0abf5bbf71bea53f09
.octa 0xbf6cbee93e633f4c3f803f3d3e07bf09,0x3ec83f643f7a3f1bbd3cbf2dbf7ebf58,0xbf7bbf43beb73e0a3f183f683f7f3f58,0x3e513f263f6f3f7e3f4e3ed8bd84bf09,0xbf80bf74bf51bf1bbeaebd303e843f09,0x3c173e9e3f143f4c3f713f803f773f58,0xbf7cbf7fbf80bf7ebf79bf71bf66bf58,0xbe3fbda33ce23e0a3e763eaf3ee23f09
.octa 0xbf153f02bedc3eb2be873e35bdb60000,0xbf503f5cbf673f70bf773f7cbf7f3f80,0xbf693f7dbf7d3f69bf413f0abe900000,0x3ed4be10be133ed5bf283f57bf763f80,0x3e6a3e7fbf2b3f70bf7e3f52beed0000,0x3f79bf783f3ebeb2be003f12bf633f80,0x3f80bf4d3e7c3ed5bf653f7abf210000,0xbd0abf1a3f78bf693ee53e5abf473f80
.octa 0x3e26bf5c3f71beb2befe3f7cbf440000,0xbf7d3f023eabbf703f5ebe35bf243f80,0xbf703e103f4dbf693d903f57bf610000,0xbeb43f7dbf19bed53f7fbf0abef63f80,0xbf073f78bd56bf703f1d3f12bf740000,0x3f5a3e7fbf803eb23f4abf52be993f80,0x3f3b3f1abf5cbed53f733e5abf7f0000,0x3f2fbf4dbf033f693ea2bf7abddb3f80
.octa 0x3f50bf02bf673eb23f77be35bf7f0000,0xbf15bf5c3edc3f70be87bf7c3db63f80,0xbed4bf7dbe133f693f28bf0abf760000,0xbf693e103f7d3ed5bf41bf573e903f80,0xbf79be7f3f3e3f703e00bf52bf630000,0x3e6a3f783f2bbeb2bf7ebf123eed3f80,0x3d0a3f4d3f783ed5bee5bf7abf470000,0x3f803f1abe7cbf69bf65be5a3f213f80
.octa 0x3f7d3f5c3eabbeb2bf5ebf7cbf240000,0x3e26bf02bf71bf70befe3e353f443f80,0x3eb4be10bf19bf69bf7fbf57bef60000,0xbf70bf7dbf4dbed53d903f0a3f613f80,0xbf5abf78bf80bf70bf4abf12be990000,0xbf07be7f3d563eb23f1d3f523f743f80,0xbf2fbf1abf03bed5bea2be5abddb0000,0x3f3b3f4d3f5c3f693f733f7a3f7f3f80
.octa 0xbf793f73bf6a3f60bf543f47bf383f27,0xbe703ea4bece3ef7bf0f3f21bf323f42,0x3f68bf413f0abe8fbb493e92bf0b3f42,0x3ed7bf283f58bf763f80bf753f57bf27,0xbf4f3ee33cb0bef73f55bf7f3f6ebf27,0xbf173f65bf803f60bf0e3dd53ebdbf42,0x3f2ebd8abf133f76bf6c3ef43e38bf42,0x3f3cbf7f3f52be8fbec53f61bf7c3f27
.octa 0xbf06bea43f6fbf603e453f21bf803f27,0xbf5a3f73bebabef73f7bbf473c7b3f42,0x3eb13f28bf7a3e8f3f36bf753e573f42,0x3f70bf41be5d3f76bf34be923f7abf27,0xbe20bf653f313ef7bf7b3dd53f6bbf27,0xbf7d3ee33f39bf60be4b3f7fbecbbf42,0xbd233f7fbe32bf763ec23f61bf11bf42,0x3f80bd8abf7c3e8f3f6dbef4bf533f27
.octa 0x3e70bf73bece3f603f0fbf47bf323f27,0xbf79bea43f6a3ef7bf54bf213f383f42,0xbed73f413f58be8fbf80be923f573f42,0x3f683f28bf0abf76bb493f753f0bbf27,0x3f17bee3bf80bef73f0e3f7f3ebdbf27,0xbf4fbf65bcb03f603f55bdd5bf6ebf42,0xbf3c3d8a3f523f763ec5bef4bf7cbf42,0x3f2e3f7f3f13be8fbf6cbf61be383f27
.octa 0x3f5a3ea4bebabf60bf7bbf213c7b3f27,0xbf06bf73bf6fbef73e453f473f803f42,0xbf70bf28be5d3e8f3f343f753f7a3f42,0x3eb13f413f7a3f763f363e92be57bf27,0x3f7d3f653f393ef73e4bbdd5becbbf27,0xbe20bee3bf31bf60bf7bbf7fbf6bbf42,0xbf80bf7fbf7cbf76bf6dbf61bf53bf42,0xbd233d8a3e323e8f3ec23ef43f113f27
.octa 0xbf643f6dbf753f7abf7e3f80bf803f7d,0x3eeabec13e96be543df4bcfbbd6f3e16,0xbe8dbbc93e93bf0c3f42bf693f7ebf7d,0xbf763f80bf753f57bf273ed2be0dbe16,0x3f7fbf6c3f23be54be8a3f2fbf723f7d,0xbda9bec73f45bf7a3f77bf3a3ea83e16,0xbde83f36bf7f3f57be9fbeb53f5dbf7d,0x3f7ebf343dcf3f0cbf733f6fbf02be16
.octa 0xbf743ec13ef0bf7a3f49bcfbbf3f3f7d,0xbe9c3f6dbf623e543f1ebf803f2a3e16,0x3ef8bf803ef33f0cbf7f3ed23f1abf7d,0xbf60bbc93f61bf57bd9d3f69bf4cbe16,0x3f433ec7bf7f3e543f5fbf3abedf3f7d,0x3f25bf6cbdc23f7abefbbf2f3f663e16,0xbf483f343f22bf57bee83f6f3e81bf7d,0x3f1f3f36bf46bf0c3f643eb5bf78be16
.octa 0xbeeabf6d3e963f7abdf4bf80bd6f3f7d,0xbf643ec13f75be54bf7e3cfb3f803e16,0x3f763bc9bf75bf0c3f273f69be0dbf7d,0xbe8dbf80be933f573f42bed2bf7ebe16,0x3da93f6c3f45be54bf77bf2f3ea83f7d,0x3f7f3ec7bf23bf7abe8a3f3a3f723e16,0xbf7ebf363dcf3f573f733eb5bf02bf7d,0xbde83f343f7f3f0cbe9fbf6fbf5dbe16
.octa 0x3e9cbec1bf62bf7abf1e3cfb3f2a3f7d,0xbf74bf6dbef03e543f493f803f3f3e16,0x3f603f803f613f0c3d9dbed2bf4cbf7d,0x3ef83bc9bef3bf57bf7fbf69bf1abe16,0xbf25bec7bdc23e543efb3f3a3f663f7d,0x3f433f6c3f7f3f7a3f5f3f2f3edf3e16,0xbf1fbf34bf46bf57bf64bf6fbf78bf7d,0xbf48bf36bf22bf0cbee8beb5be81be16
.octa 0xbec03ee9bf083f1bbf2d3f3dbf4b3f58,0x3f6dbf643f59bf4c3f3dbf2d3f1cbf09,0xbf0c3f43bf6a3f7ebf7d3f68bf403f09,0x3f56bf263ed1be0abe193ed8bf293f58,0xbf333f74bf7c3f4cbed9bd303f00bf58,0x3f37be9ebe2c3f1bbf683f80bf5e3f09,0xbf543f7fbf3a3e0a3f04bf713f72bf09,0x3f103da3bf303f7ebf5b3eaf3ea5bf58
.octa 0xbf6c3f64be63bf1b3f80bf2dbe073f58,0x3ec83ee9bf7a3f4cbd3cbf3d3f7ebf09,0xbf7b3f263eb7bf7e3f183ed8bf7f3f09,0x3e513f43bf6f3e0a3f4ebf683d843f58,0xbf803e9e3f51bf4cbeae3f80be84bf58,0x3c173f74bf14bf1b3f713d30bf773f09,0xbf7cbda33f80be0abf793eaf3f66bf09,0xbe3f3f7fbce2bf7e3e763f71bee2bf58
.octa 0xbf6dbee93f593f1bbf3dbf3d3f1c3f58,0xbec03f643f08bf4cbf2d3f2d3f4bbf09,0xbf56bf433ed13f7e3e19bf68bf293f09,0xbf0c3f263f6abe0abf7dbed83f403f58,0xbf37bf74be2c3f4c3f683d30bf5ebf58,0xbf333e9e3f7c3f1bbed9bf80bf003f09,0xbf10bf7fbf303e0a3f5b3f713ea5bf09,0xbf54bda33f3a3f7e3f04beafbf72bf58
.octa 0xbec8bf64bf7abf1b3d3c3f2d3f7e3f58,0xbf6cbee93e633f4c3f803f3d3e07bf09,0xbe51bf26bf6fbf7ebf4ebed83d843f09,0xbf7bbf43beb73e0a3f183f683f7f3f58,0xbc17be9ebf14bf4cbf71bf80bf77bf58,0xbf80bf74bf51bf1bbeaebd303e843f09,0x3e3f3da3bce2be0abe76beafbee2bf09,0xbf7cbf7fbf80bf7ebf79bf71bf66bf58
.octa 0x3f4d3f5a3f653f6f3f763f7c3f7f3f80,0xbf1abf06bee3beb8be8cbe3bbdbc8000,0xbedebe233e043ecf3f263f573f753f80,0xbf67bf7dbf7ebf6abf43bf0cbe928000,0xbf78bf79bf41beb83dee3f113f633f80,0x3e7fbe6dbf28bf6fbf7ebf53beef8000,0x3d62bf16bf77bf6abee93e543f473f80,0x3f803f4f3e86becfbf64bf7abf218000
.octa 0x3f7d3f06bea4bf6fbf60be3b3f243f80,0x3e103f5a3f733eb8befabf7cbf458000,0x3eaa3f7d3f1cbecfbf7fbf0c3ef43f80,0xbf72be233f4b3f6a3da3bf57bf618000,0xbf5c3e6d3f7f3eb8bf49bf533e983f80,0xbf02bf79bd8a3f6f3f1fbf11bf758000,0xbf2bbf4f3eff3f6abe9ebf7a3dd53f80,0x3f3fbf16bf5e3ecf3f74be54bf7f8000
.octa 0x3f1abf5abee33f6f3e8cbf7cbdbc3f80,0x3f4d3f06bf65beb83f763e3bbf7f8000,0x3f673e23bf7e3ecf3f43bf57be923f80,0xbede3f7dbe04bf6a3f263f0cbf758000,0xbe7f3f79bf28beb83f7ebf11beef3f80,0xbf783e6d3f41bf6f3dee3f53bf638000,0xbf803f163e86bf6a3f64be54bf213f80,0x3d62bf4f3f77becfbee93f7abf478000
.octa 0xbe10bf063f73bf6f3efa3e3bbf453f80,0x3f7dbf5a3ea43eb8bf603f7cbf248000,0x3f72bf7d3f4bbecfbda33f0cbf613f80,0x3eaa3e23bf1c3f6abf7f3f57bef48000,0x3f02be6dbd8a3eb8bf1f3f53bf753f80,0xbf5c3f79bf7f3f6fbf493f11be988000,0xbf3f3f4fbf5e3f6abf743f7abf7f3f80,0xbf2b3f16beff3ecfbe9e3e54bdd58000
.octa 0x3e423e8f3ebb3ee63f083f1b3f2d3f3e,0xbf7bbf76bf6ebf65bf59bf4cbf3dbf2c,0xbec1bf20bf52bf73bf80bf78bf5bbf2c,0x3f6d3f483f123ea13cfbbe82bf05bf3e,0x3f0d3f603f803f653f153e0abeafbf3e,0xbf56bef7bc973ee63f503f7e3f713f2c,0xbf34bf7ebf57bea13eb53f5d3f7d3f2c,0x3f363de2bf0abf73bf6fbf013e1c3f3e
.octa 0x3f543f763ecdbee6bf79bf4cbd303f3e,0xbf103e8f3f6b3f653e66bf1bbf80bf2c,0xbf6cbf483e353f733f3abe82bf79bf2c,0x3ec7bf20bf7cbea13f2f3f783e73bf3e,0x3f7b3ef7bf32bf653e293f7e3ed8bf3e,0xbe4e3f603f38bee6bf7cbe0a3f683f2c,0xbf80bde23f7a3ea1bf69bf013f4f3f2c,0x3bc9bf7ebe5a3f733ed2bf5dbf173f3e
.octa 0x3f7bbe8fbf6e3ee63f59bf1bbf3d3f3e,0x3e423f76bebbbf653f083f4cbf2dbf2c,0xbf6d3f203f12bf73bcfb3f78bf05bf2c,0xbec1bf483f523ea1bf803e823f5bbf3e,0x3f56bf60bc973f65bf50be0a3f71bf3e,0x3f0d3ef7bf803ee63f15bf7e3eaf3f2c,0xbf363f7ebf0abea13f6fbf5d3e1c3f2c,0xbf34bde23f57bf733eb53f01bf7d3f3e
.octa 0x3f10bf763f6bbee6be663f4cbf803f3e,0x3f54be8fbecd3f65bf793f1b3d30bf2c,0xbec73f48bf7c3f73bf2f3e823e73bf2c,0xbf6c3f20be35bea13f3abf783f79bf3e,0x3e4ebef73f38bf653f7cbf7e3f68bf3e,0x3f7bbf603f32bee63e293e0abed83f2c,0xbbc93de2be5a3ea1bed23f01bf173f2c,0xbf803f7ebf7a3f73bf693f5dbf4f3f3e
.octa 0xbf05bee1beb5be89be35bdb03bc93dc9,0xbf5bbf66bf6fbf77bf7cbf7fbf80bf7f,0x3f713f803f793f5f3f323eec3e42bdc9,0xbeafbd7b3e663efc3f383f633f7b3f7f,0x3e1cbea7bf3abf77bf7abf44bec13dc9,0x3f7d3f723f2f3e89be5abf25bf6dbf7f,0xbf80bf40be293efc3f6e3f743f0dbdc9,0xbd30bf2abf7cbf5fbebb3e9b3f563f7f
.octa 0x3e733f663f693e89bf12bf7fbf343dc9,0xbf79bee13ed23f773f523db0bf36bf7f,0x3f683d7bbf59bf5f3c973f633f54bdc9,0x3ed83f803f08befcbf80beec3f103f7f,0xbf17bf723cfb3f773f0abf25bf6c3dc9,0x3f4fbea7bf80be893f573f44bec7bf7f,0xbf2d3f2a3f50befcbf6b3e9b3f7bbdc9,0xbf3dbf403f153f5fbecdbf743e4e3f7f
.octa 0x3f5b3ee1bf6fbe893f7c3db0bf803dc9,0xbf053f663eb5bf77be353f7fbbc9bf7f,0x3eafbf803e663f5fbf38beec3f7bbdc9,0x3f713d7bbf793efc3f32bf63be423f7f,0xbf7d3ea73f2fbf773e5a3f44bf6d3dc9,0x3e1cbf723f3a3e89bf7a3f253ec1bf7f,0x3d303f40bf7c3efc3ebbbf743f56bdc9,0xbf803f2a3e29bf5f3f6ebe9bbf0d3f7f
.octa 0x3f79bf663ed23e89bf523f7fbf363dc9,0x3e733ee1bf693f77bf12bdb03f34bf7f,0xbed8bd7b3f08bf5f3f80bf633f10bdc9,0x3f68bf803f59befc3c973eecbf543f7f,0xbf4f3f72bf803f77bf573f25bec73dc9,0xbf173ea7bcfbbe893f0abf443f6cbf7f,0x3f3dbf2a3f15befc3ecdbe9b3e4ebdc9,0xbf2d3f40bf503f5fbf6b3f74bf7b3f7f
.octa 0xbf75bf6ebf64bf58bf4bbf3cbf2bbf18,0xbe92bebebee9bf09bf1cbf2ebf3fbf4e,0xbf63bf37befabe603d8a3eb23f1a3f4e,0xbeefbf33bf60bf7abf7fbf70bf4dbf18,0xbf47beca3da33f093f5e3f803f673f18,0xbf21bf6bbf7fbf58beffbd173ede3f4e,0xbf24bc493f1f3f7a3f653ed5be7fbf4e,0xbf45bf80bf49be603ee33f693f783f18
.octa 0xbef43ebe3f743f583e04bf2ebf80bf18,0xbf61bf6ebe9e3f093f7e3f3cbd62bf4e,0xbe983f333f763e60bf41bf70be103f4e,0xbf75bf373e8c3f7a3f28beb2bf7dbf18,0xbdd53f6b3f26bf09bf77bd173f723f18,0xbf7fbeca3f433f58be86bf80beaa3f4e,0x3dbc3f803deebf7abea43f693f02bf4e,0xbf7fbc493f7e3e60bf73bed53f5c3f18
.octa 0x3e923f6ebee9bf583f1c3f3cbf3fbf18,0xbf753ebe3f64bf09bf4b3f2e3f2bbf4e,0x3eef3f37bf60be603f7fbeb2bf4d3f4e,0xbf633f333efabf7a3d8a3f70bf1abf18,0x3f213ecabf7f3f093effbf803ede3f18,0xbf473f6bbda3bf583f5e3d17bf673f4e,0x3f453c49bf493f7abee3bed53f78bf4e,0xbf243f80bf1fbe603f65bf693e7f3f18
.octa 0x3f61bebebe9e3f58bf7e3f2ebd62bf18,0xbef43f6ebf743f093e04bf3c3f80bf4e,0x3f75bf333e8c3e60bf283f70bf7d3f4e,0xbe983f37bf763f7abf413eb23e10bf18,0x3f7fbf6b3f43bf093e863d17beaa3f18,0xbdd53ecabf263f58bf773f80bf723f4e,0x3f7fbf803f7ebf7a3f73bf693f5cbf4e,0x3dbc3c49bdee3e60bea43ed5bf023f18
.octa 0x3f1a3f063ee33eb83e8c3e3b3dbc0000,0x3f4d3f5a3f653f6f3f763f7c3f7f3f80,0x3f673f7d3f7e3f6a3f433f0c3e920000,0xbedebe233e043ecf3f263f573f753f80,0xbe7f3e6d3f283f6f3f7e3f533eef0000,0xbf78bf79bf41beb83dee3f113f633f80,0xbf80bf4fbe863ecf3f643f7a3f210000,0x3d62bf16bf77bf6abee93e543f473f80
.octa 0xbe10bf5abf73beb83efa3f7c3f450000,0x3f7d3f06bea4bf6fbf60be3b3f243f80,0x3f723e23bf4bbf6abda33f573f610000,0x3eaa3f7d3f1cbecfbf7fbf0c3ef43f80,0x3f023f793d8abf6fbf1f3f113f750000,0xbf5c3e6d3f7f3eb8bf49bf533e983f80,0xbf3f3f163f5ebecfbf743e543f7f0000,0xbf2bbf4f3eff3f6abe9ebf7a3dd53f80
.octa 0xbf4dbf063f653eb8bf76be3b3f7f0000,0x3f1abf5abee33f6f3e8cbf7cbdbc3f80,0x3edebf7d3e043f6abf26bf0c3f750000,0x3f673e23bf7e3ecf3f43bf57be923f80,0x3f78be6dbf413f6fbdeebf533f630000,0xbe7f3f79bf28beb83f7ebf11beef3f80,0xbd623f4fbf773ecf3ee9bf7a3f470000,0xbf803f163e86bf6a3f64be54bf213f80
.octa 0xbf7d3f5abea4beb83f60bf7c3f240000,0xbe10bf063f73bf6f3efa3e3bbf453f80,0xbeaabe233f1cbf6a3f7fbf573ef40000,0x3f72bf7d3f4bbecfbda33f0cbf613f80,0x3f5cbf793f7fbf6f3f49bf113e980000,0x3f02be6dbd8a3eb8bf1f3f53bf753f80,0x3f2bbf163effbecf3e9ebe543dd50000,0xbf3f3f4fbf5e3f6abf743f7abf7f3f80
.octa 0x3f7b3f763f6e3f653f593f4c3f3d3f2c,0x3e423e8f3ebb3ee63f083f1b3f2d3f3e,0xbf6dbf48bf12bea1bcfb3e823f053f3e,0xbec1bf20bf52bf73bf80bf78bf5bbf2c,0x3f563ef73c97bee6bf50bf7ebf71bf2c,0x3f0d3f603f803f653f153e0abeafbf3e,0xbf36bde23f0a3f733f6f3f01be1cbf3e,0xbf34bf7ebf57bea13eb53f5d3f7d3f2c
.octa 0x3f10be8fbf6bbf65be663f1b3f803f2c,0x3f543f763ecdbee6bf79bf4cbd303f3e,0xbec73f203f7c3ea1bf2fbf78be733f3e,0xbf6cbf483e353f733f3abe82bf79bf2c,0x3e4ebf60bf383ee63f7c3e0abf68bf2c,0x3f7b3ef7bf32bf653e293f7e3ed8bf3e,0xbbc93f7e3e5abf73bed23f5d3f17bf3e,0xbf80bde23f7a3ea1bf69bf013f4f3f2c
.octa 0xbe42bf763ebb3f65bf08bf4c3f2d3f2c,0x3f7bbe8fbf6e3ee63f59bf1bbf3d3f3e,0x3ec13f48bf52bea13f80be82bf5b3f3e,0xbf6d3f203f12bf73bcfb3f78bf05bf2c,0xbf0dbef73f80bee6bf153f7ebeafbf2c,0x3f56bf60bc973f65bf50be0a3f71bf3e,0x3f343de2bf573f73beb5bf013f7dbf3e,0xbf363f7ebf0abea13f6fbf5d3e1c3f2c
.octa 0xbf543e8f3ecdbf653f79bf1bbd303f2c,0x3f10bf763f6bbee6be663f4cbf803f3e,0x3f6cbf203e353ea1bf3a3f78bf793f3e,0xbec73f48bf7c3f73bf2f3e823e73bf2c,0xbf7b3f60bf323ee6be29be0a3ed8bf2c,0x3e4ebef73f38bf653f7cbf7e3f68bf3e,0x3f80bf7e3f7abf733f69bf5d3f4fbf3e,0xbbc93de2be5a3ea1bed23f01bf173f2c
.octa 0x3f5b3f663f6f3f773f7c3f7f3f803f7f,0xbf05bee1beb5be89be35bdb03bc93dc9,0x3eaf3d7bbe66befcbf38bf63bf7bbf7f,0x3f713f803f793f5f3f323eec3e42bdc9,0xbf7dbf72bf2fbe893e5a3f253f6d3f7f,0x3e1cbea7bf3abf77bf7abf44bec13dc9,0x3d303f2a3f7c3f5f3ebbbe9bbf56bf7f,0xbf80bf40be293efc3f6e3f743f0dbdc9
.octa 0x3f793ee1bed2bf77bf52bdb03f363f7f,0x3e733f663f693e89bf12bf7fbf343dc9,0xbed8bf80bf083efc3f803eecbf10bf7f,0x3f683d7bbf59bf5f3c973f633f54bdc9,0xbf4f3ea73f803e89bf57bf443ec73f7f,0xbf17bf723cfb3f773f0abf25bf6c3dc9,0x3f3d3f40bf15bf5f3ecd3f74be4ebf7f,0xbf2d3f2a3f50befcbf6b3e9b3f7bbdc9
.octa 0x3f05bf66beb53f773e35bf7f3bc93f7f,0x3f5b3ee1bf6fbe893f7c3db0bf803dc9,0xbf71bd7b3f79befcbf323f633e42bf7f,0x3eafbf803e663f5fbf38beec3f7bbdc9,0xbe1c3f72bf3abe893f7abf25bec13f7f,0xbf7d3ea73f2fbf773e5a3f44bf6d3dc9,0x3f80bf2abe293f5fbf6e3e9b3f0dbf7f,0x3d303f40bf7c3efc3ebbbf743f56bdc9
.octa 0xbe73bee13f69bf773f123db0bf343f7f,0x3f79bf663ed23e89bf523f7fbf363dc9,0xbf683f80bf593efcbc97beec3f54bf7f,0xbed8bd7b3f08bf5f3f80bf633f10bdc9,0x3f17bea73cfb3e89bf0a3f44bf6c3f7f,0xbf4f3f72bf803f77bf573f25bec73dc9,0x3f2dbf403f50bf5f3f6bbf743f7bbf7f,0x3f3dbf2a3f15befc3ecdbe9b3e4ebdc9
.octa 0x3e923ebe3ee93f093f1c3f2e3f3f3f4e,0xbf75bf6ebf64bf58bf4bbf3cbf2bbf18,0x3eef3f333f603f7a3f7f3f703f4d3f18,0xbf63bf37befabe603d8a3eb23f1a3f4e,0x3f213f6b3f7f3f583eff3d17bedebf4e,0xbf47beca3da33f093f5e3f803f673f18,0x3f453f803f493e60bee3bf69bf78bf18,0xbf24bc493f1f3f7a3f653ed5be7fbf4e
.octa 0x3f613f6e3e9ebf09bf7ebf3c3d623f4e,0xbef43ebe3f743f583e04bf2ebf80bf18,0x3f753f37be8cbf7abf283eb23f7d3f18,0xbe983f333f763e60bf41bf70be103f4e,0x3f7f3ecabf43bf583e863f803eaabf4e,0xbdd53f6b3f26bf09bf77bd173f723f18,0x3f7f3c49bf7ebe603f733ed5bf5cbf18,0x3dbc3f803deebf7abea43f693f02bf4e
.octa 0x3f75bebebf643f093f4bbf2ebf2b3f4e,0x3e923f6ebee9bf583f1c3f3cbf3fbf18,0x3f63bf33befa3f7abd8abf703f1a3f18,0x3eef3f37bf60be603f7fbeb2bf4d3f4e,0x3f47bf6b3da33f58bf5ebd173f67bf4e,0x3f213ecabf7f3f093effbf803ede3f18,0x3f24bf803f1f3e60bf653f69be7fbf18,0x3f453c49bf493f7abee3bed53f78bf4e
.octa 0x3ef4bf6e3f74bf09be043f3cbf803f4e,0x3f61bebebe9e3f58bf7e3f2ebd62bf18,0x3e98bf373f76bf7a3f41beb2be103f18,0x3f75bf333e8c3e60bf283f70bf7d3f4e,0x3dd5beca3f26bf583f77bf803f72bf4e,0x3f7fbf6b3f43bf093e863d17beaa3f18,0xbdbcbc493deebe603ea4bed53f02bf18,0x3f7fbf803f7ebf7a3f73bf693f5cbf4e
.octa 0xbf4d3f5abf653f6fbf763f7cbf7f3f80,0x3f1abf063ee3beb83e8cbe3b3dbc8000,0x3edebe23be043ecfbf263f57bf753f80,0x3f67bf7d3f7ebf6a3f43bf0c3e928000,0x3f78bf793f41beb8bdee3f11bf633f80,0xbe7fbe6d3f28bf6f3f7ebf533eef8000,0xbd62bf163f77bf6a3ee93e54bf473f80,0xbf803f4fbe86becf3f64bf7a3f218000
.octa 0xbf7d3f063ea4bf6f3f60be3bbf243f80,0xbe103f5abf733eb83efabf7c3f458000,0xbeaa3f7dbf1cbecf3f7fbf0cbef43f80,0x3f72be23bf4b3f6abda3bf573f618000,0x3f5c3e6dbf7f3eb83f49bf53be983f80,0x3f02bf793d8a3f6fbf1fbf113f758000,0x3f2bbf4fbeff3f6a3e9ebf7abdd53f80,0xbf3fbf163f5e3ecfbf74be543f7f8000
.octa 0xbf1abf5a3ee33f6fbe8cbf7c3dbc3f80,0xbf4d3f063f65beb8bf763e3b3f7f8000,0xbf673e233f7e3ecfbf43bf573e923f80,0x3ede3f7d3e04bf6abf263f0c3f758000,0x3e7f3f793f28beb8bf7ebf113eef3f80,0x3f783e6dbf41bf6fbdee3f533f638000,0x3f803f16be86bf6abf64be543f213f80,0xbd62bf4fbf77becf3ee93f7a3f478000
.octa 0x3e10bf06bf73bf6fbefa3e3b3f453f80,0xbf7dbf5abea43eb83f603f7c3f248000,0xbf72bf7dbf4bbecf3da33f0c3f613f80,0xbeaa3e233f1c3f6a3f7f3f573ef48000,0xbf02be6d3d8a3eb83f1f3f533f753f80,0x3f5c3f793f7f3f6f3f493f113e988000,0x3f3f3f4f3f5e3f6a3f743f7a3f7f3f80,0x3f2b3f163eff3ecf3e9e3e543dd58000
.octa 0xbe423e8fbebb3ee6bf083f1bbf2d3f3e,0x3f7bbf763f6ebf653f59bf4c3f3dbf2c,0x3ec1bf203f52bf733f80bf783f5bbf2c,0xbf6d3f48bf123ea1bcfbbe823f05bf3e,0xbf0d3f60bf803f65bf153e0a3eafbf3e,0x3f56bef73c973ee6bf503f7ebf713f2c,0x3f34bf7e3f57bea1beb53f5dbf7d3f2c,0xbf363de23f0abf733f6fbf01be1c3f3e
.octa 0xbf543f76becdbee63f79bf4c3d303f3e,0x3f103e8fbf6b3f65be66bf1b3f80bf2c,0x3f6cbf48be353f73bf3abe823f79bf2c,0xbec7bf203f7cbea1bf2f3f78be73bf3e,0xbf7b3ef73f32bf65be293f7ebed8bf3e,0x3e4e3f60bf38bee63f7cbe0abf683f2c,0x3f80bde2bf7a3ea13f69bf01bf4f3f2c,0xbbc9bf7e3e5a3f73bed2bf5d3f173f3e
.octa 0xbf7bbe8f3f6e3ee6bf59bf1b3f3d3f3e,0xbe423f763ebbbf65bf083f4c3f2dbf2c,0x3f6d3f20bf12bf733cfb3f783f05bf2c,0x3ec1bf48bf523ea13f803e82bf5bbf3e,0xbf56bf603c973f653f50be0abf71bf3e,0xbf0d3ef73f803ee6bf15bf7ebeaf3f2c,0x3f363f7e3f0abea1bf6fbf5dbe1c3f2c,0x3f34bde2bf57bf73beb53f013f7d3f3e
.octa 0xbf10bf76bf6bbee63e663f4c3f803f3e,0xbf54be8f3ecd3f653f793f1bbd30bf2c,0x3ec73f483f7c3f733f2f3e82be73bf2c,0x3f6c3f203e35bea1bf3abf78bf79bf3e,0xbe4ebef7bf38bf65bf7cbf7ebf68bf3e,0xbf7bbf60bf32bee6be293e0a3ed83f2c,0x3bc93de23e5a3ea13ed23f013f173f2c,0x3f803f7e3f7a3f733f693f5d3f4f3f3e
.octa 0x3f05bee13eb5be893e35bdb0bbc93dc9,0x3f5bbf663f6fbf773f7cbf7f3f80bf7f,0xbf713f80bf793f5fbf323eecbe42bdc9,0x3eafbd7bbe663efcbf383f63bf7b3f7f,0xbe1cbea73f3abf773f7abf443ec13dc9,0xbf7d3f72bf2f3e893e5abf253f6dbf7f,0x3f80bf403e293efcbf6e3f74bf0dbdc9,0x3d30bf2a3f7cbf5f3ebb3e9bbf563f7f
.octa 0xbe733f66bf693e893f12bf7f3f343dc9,0x3f79bee1bed23f77bf523db03f36bf7f,0xbf683d7b3f59bf5fbc973f63bf54bdc9,0xbed83f80bf08befc3f80beecbf103f7f,0x3f17bf72bcfb3f77bf0abf253f6c3dc9,0xbf4fbea73f80be89bf573f443ec7bf7f,0x3f2d3f2abf50befc3f6b3e9bbf7bbdc9,0x3f3dbf40bf153f5f3ecdbf74be4e3f7f
.octa 0xbf5b3ee13f6fbe89bf7c3db03f803dc9,0x3f053f66beb5bf773e353f7f3bc9bf7f,0xbeafbf80be663f5f3f38beecbf7bbdc9,0xbf713d7b3f793efcbf32bf633e423f7f,0x3f7d3ea7bf2fbf77be5a3f443f6d3dc9,0xbe1cbf72bf3a3e893f7a3f25bec1bf7f,0xbd303f403f7c3efcbebbbf74bf56bdc9,0x3f803f2abe29bf5fbf6ebe9b3f0d3f7f
.octa 0xbf79bf66bed23e893f523f7f3f363dc9,0xbe733ee13f693f773f12bdb0bf34bf7f,0x3ed8bd7bbf08bf5fbf80bf63bf10bdc9,0xbf68bf80bf59befcbc973eec3f543f7f,0x3f4f3f723f803f773f573f253ec73dc9,0x3f173ea73cfbbe89bf0abf44bf6cbf7f,0xbf3dbf2abf15befcbecdbe9bbe4ebdc9,0x3f2d3f403f503f5f3f6b3f743f7b3f7f
.octa 0x3f75bf6e3f64bf583f4bbf3c3f2bbf18,0x3e92bebe3ee9bf093f1cbf2e3f3fbf4e,0x3f63bf373efabe60bd8a3eb2bf1a3f4e,0x3eefbf333f60bf7a3f7fbf703f4dbf18,0x3f47becabda33f09bf5e3f80bf673f18,0x3f21bf6b3f7fbf583effbd17bede3f4e,0x3f24bc49bf1f3f7abf653ed53e7fbf4e,0x3f45bf803f49be60bee33f69bf783f18
.octa 0x3ef43ebebf743f58be04bf2e3f80bf18,0x3f61bf6e3e9e3f09bf7e3f3c3d62bf4e,0x3e983f33bf763e603f41bf703e103f4e,0x3f75bf37be8c3f7abf28beb23f7dbf18,0x3dd53f6bbf26bf093f77bd17bf723f18,0x3f7fbecabf433f583e86bf803eaa3f4e,0xbdbc3f80bdeebf7a3ea43f69bf02bf4e,0x3f7fbc49bf7e3e603f73bed5bf5c3f18
.octa 0xbe923f6e3ee9bf58bf1c3f3c3f3fbf18,0x3f753ebebf64bf093f4b3f2ebf2bbf4e,0xbeef3f373f60be60bf7fbeb23f4d3f4e,0x3f633f33befabf7abd8a3f703f1abf18,0xbf213eca3f7f3f09beffbf80bede3f18,0x3f473f6b3da3bf58bf5e3d173f673f4e,0xbf453c493f493f7a3ee3bed5bf78bf4e,0x3f243f803f1fbe60bf65bf69be7f3f18
.octa 0xbf61bebe3e9e3f583f7e3f2e3d62bf18,0x3ef43f6e3f743f09be04bf3cbf80bf4e,0xbf75bf33be8c3e603f283f703f7d3f4e,0x3e983f373f763f7a3f413eb2be10bf18,0xbf7fbf6bbf43bf09be863d173eaa3f18,0x3dd53eca3f263f583f773f803f723f4e,0xbf7fbf80bf7ebf7abf73bf69bf5cbf4e,0xbdbc3c493dee3e603ea43ed53f023f18
.octa 0xbf1a3f06bee33eb8be8c3e3bbdbc0000,0xbf4d3f5abf653f6fbf763f7cbf7f3f80,0xbf673f7dbf7e3f6abf433f0cbe920000,0x3edebe23be043ecfbf263f57bf753f80,0x3e7f3e6dbf283f6fbf7e3f53beef0000,0x3f78bf793f41beb8bdee3f11bf633f80,0x3f80bf4f3e863ecfbf643f7abf210000,0xbd62bf163f77bf6a3ee93e54bf473f80
.octa 0x3e10bf5a3f73beb8befa3f7cbf450000,0xbf7d3f063ea4bf6f3f60be3bbf243f80,0xbf723e233f4bbf6a3da33f57bf610000,0xbeaa3f7dbf1cbecf3f7fbf0cbef43f80,0xbf023f79bd8abf6f3f1f3f11bf750000,0x3f5c3e6dbf7f3eb83f49bf53be983f80,0x3f3f3f16bf5ebecf3f743e54bf7f0000,0x3f2bbf4fbeff3f6a3e9ebf7abdd53f80
.octa 0x3f4dbf06bf653eb83f76be3bbf7f0000,0xbf1abf5a3ee33f6fbe8cbf7c3dbc3f80,0xbedebf7dbe043f6a3f26bf0cbf750000,0xbf673e233f7e3ecfbf43bf573e923f80,0xbf78be6d3f413f6f3deebf53bf630000,0x3e7f3f793f28beb8bf7ebf113eef3f80,0x3d623f4f3f773ecfbee9bf7abf470000,0x3f803f16be86bf6abf64be543f213f80
.octa 0x3f7d3f5a3ea4beb8bf60bf7cbf240000,0x3e10bf06bf73bf6fbefa3e3b3f453f80,0x3eaabe23bf1cbf6abf7fbf57bef40000,0xbf72bf7dbf4bbecf3da33f0c3f613f80,0xbf5cbf79bf7fbf6fbf49bf11be980000,0xbf02be6d3d8a3eb83f1f3f533f753f80,0xbf2bbf16beffbecfbe9ebe54bdd50000,0x3f3f3f4f3f5e3f6a3f743f7a3f7f3f80
.octa 0xbf7b3f76bf6e3f65bf593f4cbf3d3f2c,0xbe423e8fbebb3ee6bf083f1bbf2d3f3e,0x3f6dbf483f12bea13cfb3e82bf053f3e,0x3ec1bf203f52bf733f80bf783f5bbf2c,0xbf563ef7bc97bee63f50bf7e3f71bf2c,0xbf0d3f60bf803f65bf153e0a3eafbf3e,0x3f36bde2bf0a3f73bf6f3f013e1cbf3e,0x3f34bf7e3f57bea1beb53f5dbf7d3f2c
.octa 0xbf10be8f3f6bbf653e663f1bbf803f2c,0xbf543f76becdbee63f79bf4c3d303f3e,0x3ec73f20bf7c3ea13f2fbf783e733f3e,0x3f6cbf48be353f73bf3abe823f79bf2c,0xbe4ebf603f383ee6bf7c3e0a3f68bf2c,0xbf7b3ef73f32bf65be293f7ebed8bf3e,0x3bc93f7ebe5abf733ed23f5dbf17bf3e,0x3f80bde2bf7a3ea13f69bf01bf4f3f2c
.octa 0x3e42bf76bebb3f653f08bf4cbf2d3f2c,0xbf7bbe8f3f6e3ee6bf59bf1b3f3d3f3e,0xbec13f483f52bea1bf80be823f5b3f3e,0x3f6d3f20bf12bf733cfb3f783f05bf2c,0x3f0dbef7bf80bee63f153f7e3eafbf2c,0xbf56bf603c973f653f50be0abf71bf3e,0xbf343de23f573f733eb5bf01bf7dbf3e,0x3f363f7e3f0abea1bf6fbf5dbe1c3f2c
.octa 0x3f543e8fbecdbf65bf79bf1b3d303f2c,0xbf10bf76bf6bbee63e663f4c3f803f3e,0xbf6cbf20be353ea13f3a3f783f793f3e,0x3ec73f483f7c3f733f2f3e82be73bf2c,0x3f7b3f603f323ee63e29be0abed8bf2c,0xbe4ebef7bf38bf65bf7cbf7ebf68bf3e,0xbf80bf7ebf7abf73bf69bf5dbf4fbf3e,0x3bc93de23e5a3ea13ed23f013f173f2c
.octa 0xbf5b3f66bf6f3f77bf7c3f7fbf803f7f,0x3f05bee13eb5be893e35bdb0bbc93dc9,0xbeaf3d7b3e66befc3f38bf633f7bbf7f,0xbf713f80bf793f5fbf323eecbe42bdc9,0x3f7dbf723f2fbe89be5a3f25bf6d3f7f,0xbe1cbea73f3abf773f7abf443ec13dc9,0xbd303f2abf7c3f5fbebbbe9b3f56bf7f,0x3f80bf403e293efcbf6e3f74bf0dbdc9
.octa 0xbf793ee13ed2bf773f52bdb0bf363f7f,0xbe733f66bf693e893f12bf7f3f343dc9,0x3ed8bf803f083efcbf803eec3f10bf7f,0xbf683d7b3f59bf5fbc973f63bf54bdc9,0x3f4f3ea7bf803e893f57bf44bec73f7f,0x3f17bf72bcfb3f77bf0abf253f6c3dc9,0xbf3d3f403f15bf5fbecd3f743e4ebf7f,0x3f2d3f2abf50befc3f6b3e9bbf7bbdc9
.octa 0xbf05bf663eb53f77be35bf7fbbc93f7f,0xbf5b3ee13f6fbe89bf7c3db03f803dc9,0x3f71bd7bbf79befc3f323f63be42bf7f,0xbeafbf80be663f5f3f38beecbf7bbdc9,0x3e1c3f723f3abe89bf7abf253ec13f7f,0x3f7d3ea7bf2fbf77be5a3f443f6d3dc9,0xbf80bf2a3e293f5f3f6e3e9bbf0dbf7f,0xbd303f403f7c3efcbebbbf74bf56bdc9
.octa 0x3e73bee1bf69bf77bf123db03f343f7f,0xbf79bf66bed23e893f523f7f3f363dc9,0x3f683f803f593efc3c97beecbf54bf7f,0x3ed8bd7bbf08bf5fbf80bf63bf10bdc9,0xbf17bea7bcfb3e893f0a3f443f6c3f7f,0x3f4f3f723f803f773f573f253ec73dc9,0xbf2dbf40bf50bf5fbf6bbf74bf7bbf7f,0xbf3dbf2abf15befcbecdbe9bbe4ebdc9
.octa 0xbe923ebebee93f09bf1c3f2ebf3f3f4e,0x3f75bf6e3f64bf583f4bbf3c3f2bbf18,0xbeef3f33bf603f7abf7f3f70bf4d3f18,0x3f63bf373efabe60bd8a3eb2bf1a3f4e,0xbf213f6bbf7f3f58beff3d173edebf4e,0x3f47becabda33f09bf5e3f80bf673f18,0xbf453f80bf493e603ee3bf693f78bf18,0x3f24bc49bf1f3f7abf653ed53e7fbf4e
.octa 0xbf613f6ebe9ebf093f7ebf3cbd623f4e,0x3ef43ebebf743f58be04bf2e3f80bf18,0xbf753f373e8cbf7a3f283eb2bf7d3f18,0x3e983f33bf763e603f41bf703e103f4e,0xbf7f3eca3f43bf58be863f80beaabf4e,0x3dd53f6bbf26bf093f77bd17bf723f18,0xbf7f3c493f7ebe60bf733ed53f5cbf18,0xbdbc3f80bdeebf7a3ea43f69bf02bf4e
.octa 0xbf75bebe3f643f09bf4bbf2e3f2b3f4e,0xbe923f6e3ee9bf58bf1c3f3c3f3fbf18,0xbf63bf333efa3f7a3d8abf70bf1a3f18,0xbeef3f373f60be60bf7fbeb23f4d3f4e,0xbf47bf6bbda33f583f5ebd17bf67bf4e,0xbf213eca3f7f3f09beffbf80bede3f18,0xbf24bf80bf1f3e603f653f693e7fbf18,0xbf453c493f493f7a3ee3bed5bf78bf4e
.octa 0xbef4bf6ebf74bf093e043f3c3f803f4e,0xbf61bebe3e9e3f583f7e3f2e3d62bf18,0xbe98bf37bf76bf7abf41beb23e103f18,0xbf75bf33be8c3e603f283f703f7d3f4e,0xbdd5becabf26bf58bf77bf80bf72bf4e,0xbf7fbf6bbf43bf09be863d173eaa3f18,0x3dbcbc49bdeebe60bea4bed5bf02bf18,0xbf7fbf80bf7ebf7abf73bf69bf5cbf4e
.octa 0x3f493f573f643f6e3f763f7b3f7f3f80,0xbf1ebf0abeeabebebe90be42bdc28000,0xbee8be353de83eca3f243f563f753f80,0xbf64bf7cbf7ebf6bbf44bf0dbe938000,0xbf77bf7abf43bebe3ddb3f103f623f80,0x3e8abe5abf25bf6ebf7fbf54bef08000,0x3d9dbf12bf76bf6bbeed3e4e3f463f80,0x3f7f3f523e8dbecabf63bf7bbf228000
.octa 0x3f7e3f0abe9cbf6ebf61be423f233f80,0x3df43f573f743ebebef6bf7bbf458000,0x3e9f3f7c3f1fbecabf7fbf0d3ef33f80,0xbf73be353f483f6b3db6bf56bf618000,0xbf5f3e5a3f7f3ebebf47bf543e963f80,0xbefbbf7abda93f6e3f21bf10bf758000,0xbf27bf523ef83f6bbe99bf7b3dcf3f80,0x3f42bf12bf603eca3f74be4ebf7f8000
.octa 0x3f1ebf57beea3f6e3e90bf7bbdc23f80,0x3f493f0abf64bebe3f763e42bf7f8000,0x3f643e35bf7e3eca3f44bf56be933f80,0xbee83f7cbde8bf6b3f243f0dbf758000,0xbe8a3f7abf25bebe3f7fbf10bef03f80,0xbf773e5a3f43bf6e3ddb3f54bf628000,0xbf7f3f123e8dbf6b3f63be4ebf223f80,0x3d9dbf523f76becabeed3f7bbf468000
.octa 0xbdf4bf0a3f74bf6e3ef63e42bf453f80,0x3f7ebf573e9c3ebebf613f7bbf238000,0x3f73bf7c3f48becabdb63f0dbf613f80,0x3e9f3e35bf1f3f6bbf7f3f56bef38000,0x3efbbe5abda93ebebf213f54bf753f80,0xbf5f3f7abf7f3f6ebf473f10be968000,0xbf423f52bf603f6bbf743f7bbf7f3f80,0xbf273f12bef83ecabe993e4ebdcf8000
.octa 0x3e133e733ea83ed53f003f153f283f39,0xbf7dbf79bf72bf69bf5ebf50bf41bf31,0xbeabbf17bf4cbf70bf7fbf79bf5ebf31,0x3f713f4f3f1a3eb23d84be66befebf39,0x3f033f5b3f803f693f1c3e29bea2bf39,0xbf5cbf05bd6f3ed53f4b3f7c3f733f31,0xbf2bbf7dbf5dbeb23ea53f593f7e3f31,0x3f3e3e1cbf02bf70bf72bf083e003f39
.octa 0x3f4d3f793edfbed5bf77bf50bd903f39,0xbf193e733f663f693e84bf15bf7fbf31,0xbf67bf4f3e0d3f703f40be66bf77bf31,0x3edcbf17bf7ebeb23f293f793e87bf39,0x3f783f05bf2abf693e073f7c3ee5bf39,0xbe7c3f5b3f3fbed5bf7ebe293f653f31,0xbf80be1c3f783eb2bf66bf083f4a3f31,0x3d56bf7dbe813f703ee2bf59bf1d3f39
.octa 0x3f7dbe73bf723ed53f5ebf15bf413f39,0x3e133f79bea8bf693f003f50bf28bf31,0xbf713f173f1abf70bd843f79befebf31,0xbeabbf4f3f4c3eb2bf7f3e663f5ebf39,0x3f5cbf5bbd6f3f69bf4bbe293f73bf39,0x3f033f05bf803ed53f1cbf7c3ea23f31,0xbf3e3f7dbf02beb23f72bf593e003f31,0xbf2bbe1c3f5dbf703ea53f08bf7e3f39
.octa 0x3f19bf793f66bed5be843f50bf7f3f39,0x3f4dbe73bedf3f69bf773f153d90bf31,0xbedc3f4fbf7e3f70bf293e663e87bf31,0xbf673f17be0dbeb23f40bf793f77bf39,0x3e7cbf053f3fbf693f7ebf7c3f65bf39,0x3f78bf5b3f2abed53e073e29bee53f31,0xbd563e1cbe813eb2bee23f08bf1d3f31,0xbf803f7dbf783f70bf663f59bf4a3f39
.octa 0xbf14beffbed4bea7be70be10bd3c3d49,0xbf51bf5ebf69bf72bf79bf7dbf80bf80,0x3f6a3f7e3f7d3f663f3c3f023e76bd49,0xbed1be043e263ee13f2e3f5c3f793f80,0x3e63be86bf2fbf72bf7dbf4dbed93d49,0x3f7a3f773f3b3ea7be20bf1abf68bf80,0xbf80bf4bbe6a3ee13f683f783f18bd49,0x3ce2bf1cbf79bf66bed73e7f3f4e3f80
.octa 0x3e2c3f5e3f703ea7bf06bf7dbf3d3d49,0xbf7cbeff3eb43f723f5a3e10bf2dbf80,0x3f6f3e04bf50bf66bd233f5c3f5bbd49,0x3eb73f7e3f15bee1bf80bf023f043f80,0xbf08bf77bd0a3f723f17bf1abf713d49,0x3f59be86bf80bea73f4f3f4dbeaebf80,0xbf3a3f1c3f5abee1bf703e7f3f7dbd49,0xbf30bf4b3f073f66beb1bf783e193f80
.octa 0x3f513effbf69bea73f793e10bf803d49,0xbf143f5e3ed4bf72be703f7d3d3cbf80,0x3ed1bf7e3e263f66bf2ebf023f79bd49,0x3f6a3e04bf7d3ee13f3cbf5cbe763f80,0xbf7a3e863f3bbf723e203f4dbf683d49,0x3e63bf773f2f3ea7bf7d3f1a3ed9bf80,0xbce23f4bbf793ee13ed7bf783f4ebd49,0xbf803f1c3e6abf663f68be7fbf183f80
.octa 0x3f7cbf5e3eb43ea7bf5a3f7dbf2d3d49,0x3e2c3effbf703f72bf06be103f3dbf80,0xbeb7be043f15bf663f80bf5c3f04bd49,0x3f6fbf7e3f50bee1bd233f02bf5b3f80,0xbf593f77bf803f72bf4f3f1abeae3d49,0xbf083e863d0abea73f17bf4d3f71bf80,0x3f30bf1c3f07bee13eb1be7f3e19bd49,0xbf3a3f4bbf5a3f66bf703f78bf7d3f80
.octa 0xbf7bbf75bf6dbf63bf57bf49bf39bf27,0xbe45be92bec0beecbf0bbf1fbf31bf42,0xbf6dbf47bf10be9bbc7b3e8c3f0a3f42,0xbec2bf21bf54bf74bf80bf76bf58bf27,0xbf55bef4bc173eec3f533f7e3f6f3f27,0xbf0ebf61bf80bf63bf11bdee3eba3f42,0xbf36bdd53f0c3f743f6e3efabe32bf42,0xbf34bf7fbf56be9b3ebd3f603f7c3f27
.octa 0xbf0f3e923f6c3f633e57bf1fbf80bf27,0xbf54bf75bec83eec3f7a3f493cb0bf42,0xbec53f213f7c3e9bbf32bf76be5d3f42,0xbf6cbf473e3f3f743f38be8cbf7abf27,0xbe4b3f613f37beecbf7cbdee3f6a3f27,0xbf7bbef43f333f63be38bf7ebece3f42,0xbb493f7f3e51bf74becb3f603f13bf42,0xbf80bdd53f7b3e9bbf6bbefa3f523f27
.octa 0x3e453f75bec0bf633f0b3f49bf31bf27,0xbf7b3e923f6dbeecbf573f1f3f39bf42,0x3ec23f47bf54be9b3f80be8cbf583f42,0xbf6d3f213f10bf74bc7b3f76bf0abf27,0x3f0e3ef4bf803eec3f11bf7e3eba3f27,0xbf553f613c17bf633f533deebf6f3f42,0x3f343dd5bf563f74bebdbefa3f7cbf42,0xbf363f7fbf0cbe9b3f6ebf603e323f27
.octa 0x3f54be92bec83f63bf7a3f1f3cb0bf27,0xbf0f3f75bf6c3eec3e57bf493f80bf42,0x3f6cbf213e3f3e9bbf383f76bf7a3f42,0xbec53f47bf7c3f74bf323e8c3e5dbf27,0x3f7bbf613f33beec3e383deebece3f27,0xbe4b3ef4bf373f63bf7c3f7ebf6a3f42,0x3f80bf7f3f7bbf743f6bbf603f52bf42,0xbb493dd5be513e9bbecb3efabf133f27
.octa 0x3f1e3f0a3eea3ebe3e903e423dc20000,0x3f493f573f643f6e3f763f7b3f7f3f80,0x3f643f7c3f7e3f6b3f443f0d3e930000,0xbee8be353de83eca3f243f563f753f80,0xbe8a3e5a3f253f6e3f7f3f543ef00000,0xbf77bf7abf43bebe3ddb3f103f623f80,0xbf7fbf52be8d3eca3f633f7b3f220000,0x3d9dbf12bf76bf6bbeed3e4e3f463f80
.octa 0xbdf4bf57bf74bebe3ef63f7b3f450000,0x3f7e3f0abe9cbf6ebf61be423f233f80,0x3f733e35bf48bf6bbdb63f563f610000,0x3e9f3f7c3f1fbecabf7fbf0d3ef33f80,0x3efb3f7a3da9bf6ebf213f103f750000,0xbf5f3e5a3f7f3ebebf47bf543e963f80,0xbf423f123f60becabf743e4e3f7f0000,0xbf27bf523ef83f6bbe99bf7b3dcf3f80
.octa 0xbf49bf0a3f643ebebf76be423f7f0000,0x3f1ebf57beea3f6e3e90bf7bbdc23f80,0x3ee8bf7c3de83f6bbf24bf0d3f750000,0x3f643e35bf7e3eca3f44bf56be933f80,0x3f77be5abf433f6ebddbbf543f620000,0xbe8a3f7abf25bebe3f7fbf10bef03f80,0xbd9d3f52bf763eca3eedbf7b3f460000,0xbf7f3f123e8dbf6b3f63be4ebf223f80
.octa 0xbf7e3f57be9cbebe3f61bf7b3f230000,0xbdf4bf0a3f74bf6e3ef63e42bf453f80,0xbe9fbe353f1fbf6b3f7fbf563ef30000,0x3f73bf7c3f48becabdb63f0dbf613f80,0x3f5fbf7a3f7fbf6e3f47bf103e960000,0x3efbbe5abda93ebebf213f54bf753f80,0x3f27bf123ef8beca3e99be4e3dcf0000,0xbf423f52bf603f6bbf743f7bbf7f3f80
.octa 0x3f7d3f793f723f693f5e3f503f413f31,0x3e133e733ea83ed53f003f153f283f39,0xbf71bf4fbf1abeb2bd843e663efe3f39,0xbeabbf17bf4cbf70bf7fbf79bf5ebf31,0x3f5c3f053d6fbed5bf4bbf7cbf73bf31,0x3f033f5b3f803f693f1c3e29bea2bf39,0xbf3ebe1c3f023f703f723f08be00bf39,0xbf2bbf7dbf5dbeb23ea53f593f7e3f31
.octa 0x3f19be73bf66bf69be843f153f7f3f31,0x3f4d3f793edfbed5bf77bf50bd903f39,0xbedc3f173f7e3eb2bf29bf79be873f39,0xbf67bf4f3e0d3f703f40be66bf77bf31,0x3e7cbf5bbf3f3ed53f7e3e29bf65bf31,0x3f783f05bf2abf693e073f7c3ee5bf39,0xbd563f7d3e81bf70bee23f593f1dbf39,0xbf80be1c3f783eb2bf66bf083f4a3f31
.octa 0xbe13bf793ea83f69bf00bf503f283f31,0x3f7dbe73bf723ed53f5ebf15bf413f39,0x3eab3f4fbf4cbeb23f7fbe66bf5e3f39,0xbf713f173f1abf70bd843f79befebf31,0xbf03bf053f80bed5bf1c3f7cbea2bf31,0x3f5cbf5bbd6f3f69bf4bbe293f73bf39,0x3f2b3e1cbf5d3f70bea5bf083f7ebf39,0xbf3e3f7dbf02beb23f72bf593e003f31
.octa 0xbf4d3e733edfbf693f77bf15bd903f31,0x3f19bf793f66bed5be843f50bf7f3f39,0x3f67bf173e0d3eb2bf403f79bf773f39,0xbedc3f4fbf7e3f70bf293e663e87bf31,0xbf783f5bbf2a3ed5be07be293ee5bf31,0x3e7cbf053f3fbf693f7ebf7c3f65bf39,0x3f80bf7d3f78bf703f66bf593f4abf39,0xbd563e1cbe813eb2bee23f08bf1d3f31
.octa 0x3f513f5e3f693f723f793f7d3f803f80,0xbf14beffbed4bea7be70be10bd3c3d49,0x3ed13e04be26bee1bf2ebf5cbf79bf80,0x3f6a3f7e3f7d3f663f3c3f023e76bd49,0xbf7abf77bf3bbea73e203f1a3f683f80,0x3e63be86bf2fbf72bf7dbf4dbed93d49,0xbce23f1c3f793f663ed7be7fbf4ebf80,0xbf80bf4bbe6a3ee13f683f783f18bd49
.octa 0x3f7c3effbeb4bf72bf5abe103f2d3f80,0x3e2c3f5e3f703ea7bf06bf7dbf3d3d49,0xbeb7bf7ebf153ee13f803f02bf04bf80,0x3f6f3e04bf50bf66bd233f5c3f5bbd49,0xbf593e863f803ea7bf4fbf4d3eae3f80,0xbf08bf77bd0a3f723f17bf1abf713d49,0x3f303f4bbf07bf663eb13f78be19bf80,0xbf3a3f1c3f5abee1bf703e7f3f7dbd49
.octa 0x3f14bf5ebed43f723e70bf7dbd3c3f80,0x3f513effbf69bea73f793e10bf803d49,0xbf6abe043f7dbee1bf3c3f5c3e76bf80,0x3ed1bf7e3e263f66bf2ebf023f79bd49,0xbe633f77bf2fbea73f7dbf1abed93f80,0xbf7a3e863f3bbf723e203f4dbf683d49,0x3f80bf1cbe6a3f66bf683e7f3f18bf80,0xbce23f4bbf793ee13ed7bf783f4ebd49
.octa 0xbe2cbeff3f70bf723f063e10bf3d3f80,0x3f7cbf5e3eb43ea7bf5a3f7dbf2d3d49,0xbf6f3f7ebf503ee13d23bf023f5bbf80,0xbeb7be043f15bf663f80bf5c3f04bd49,0x3f08be86bd0a3ea7bf173f4dbf713f80,0xbf593f77bf803f72bf4f3f1abeae3d49,0x3f3abf4b3f5abf663f70bf783f7dbf80,0x3f30bf1c3f07bee13eb1be7f3e19bd49
.octa 0x3e453e923ec03eec3f0b3f1f3f313f42,0xbf7bbf75bf6dbf63bf57bf49bf39bf27,0x3ec23f213f543f743f803f763f583f27,0xbf6dbf47bf10be9bbc7b3e8c3f0a3f42,0x3f0e3f613f803f633f113deebebabf42,0xbf55bef4bc173eec3f533f7e3f6f3f27,0x3f343f7f3f563e9bbebdbf60bf7cbf27,0xbf36bdd53f0c3f743f6e3efabe32bf42
.octa 0x3f543f753ec8beecbf7abf49bcb03f42,0xbf0f3e923f6c3f633e57bf1fbf80bf27,0x3f6c3f47be3fbf74bf383e8c3f7a3f27,0xbec53f213f7c3e9bbf32bf76be5d3f42,0x3f7b3ef4bf33bf633e383f7e3ecebf42,0xbe4b3f613f37beecbf7cbdee3f6a3f27,0x3f803dd5bf7bbe9b3f6b3efabf52bf27,0xbb493f7f3e51bf74becb3f603f13bf42
.octa 0x3f7bbe92bf6d3eec3f57bf1fbf393f42,0x3e453f75bec0bf633f0b3f49bf31bf27,0x3f6dbf21bf103f743c7bbf763f0a3f27,0x3ec23f47bf54be9b3f80be8cbf583f42,0x3f55bf61bc173f63bf53bdee3f6fbf42,0x3f0e3ef4bf803eec3f11bf7e3eba3f27,0x3f36bf7f3f0c3e9bbf6e3f60be32bf27,0x3f343dd5bf563f74bebdbefa3f7cbf42
.octa 0x3f0fbf753f6cbeecbe573f49bf803f42,0x3f54be92bec83f63bf7a3f1f3cb0bf27,0x3ec5bf473f7cbf743f32be8cbe5d3f27,0x3f6cbf213e3f3e9bbf383f76bf7a3f42,0x3e4bbef43f37bf633f7cbf7e3f6abf42,0x3f7bbf613f33beec3e383deebece3f27,0x3b49bdd53e51be9b3ecbbefa3f13bf27,0x3f80bf7f3f7bbf743f6bbf603f52bf42
.octa 0xbf493f57bf643f6ebf763f7bbf7f3f80,0x3f1ebf0a3eeabebe3e90be423dc28000,0x3ee8be35bde83ecabf243f56bf753f80,0x3f64bf7c3f7ebf6b3f44bf0d3e938000,0x3f77bf7a3f43bebebddb3f10bf623f80,0xbe8abe5a3f25bf6e3f7fbf543ef08000,0xbd9dbf123f76bf6b3eed3e4ebf463f80,0xbf7f3f52be8dbeca3f63bf7b3f228000
.octa 0xbf7e3f0a3e9cbf6e3f61be42bf233f80,0xbdf43f57bf743ebe3ef6bf7b3f458000,0xbe9f3f7cbf1fbeca3f7fbf0dbef33f80,0x3f73be35bf483f6bbdb6bf563f618000,0x3f5f3e5abf7f3ebe3f47bf54be963f80,0x3efbbf7a3da93f6ebf21bf103f758000,0x3f27bf52bef83f6b3e99bf7bbdcf3f80,0xbf42bf123f603ecabf74be4e3f7f8000
.octa 0xbf1ebf573eea3f6ebe90bf7b3dc23f80,0xbf493f0a3f64bebebf763e423f7f8000,0xbf643e353f7e3ecabf44bf563e933f80,0x3ee83f7c3de8bf6bbf243f0d3f758000,0x3e8a3f7a3f25bebebf7fbf103ef03f80,0x3f773e5abf43bf6ebddb3f543f628000,0x3f7f3f12be8dbf6bbf63be4e3f223f80,0xbd9dbf52bf76beca3eed3f7b3f468000
.octa 0x3df4bf0abf74bf6ebef63e423f453f80,0xbf7ebf57be9c3ebe3f613f7b3f238000,0xbf73bf7cbf48beca3db63f0d3f613f80,0xbe9f3e353f1f3f6b3f7f3f563ef38000,0xbefbbe5a3da93ebe3f213f543f753f80,0x3f5f3f7a3f7f3f6e3f473f103e968000,0x3f423f523f603f6b3f743f7b3f7f3f80,0x3f273f123ef83eca3e993e4e3dcf8000
.octa 0xbe133e73bea83ed5bf003f15bf283f39,0x3f7dbf793f72bf693f5ebf503f41bf31,0x3eabbf173f4cbf703f7fbf793f5ebf31,0xbf713f4fbf1a3eb2bd84be663efebf39,0xbf033f5bbf803f69bf1c3e293ea2bf39,0x3f5cbf053d6f3ed5bf4b3f7cbf733f31,0x3f2bbf7d3f5dbeb2bea53f59bf7e3f31,0xbf3e3e1c3f02bf703f72bf08be003f39
.octa 0xbf4d3f79bedfbed53f77bf503d903f39,0x3f193e73bf663f69be84bf153f7fbf31,0x3f67bf4fbe0d3f70bf40be663f77bf31,0xbedcbf173f7ebeb2bf293f79be87bf39,0xbf783f053f2abf69be073f7cbee5bf39,0x3e7c3f5bbf3fbed53f7ebe29bf653f31,0x3f80be1cbf783eb23f66bf08bf4a3f31,0xbd56bf7d3e813f70bee2bf593f1d3f39
.octa 0xbf7dbe733f723ed5bf5ebf153f413f39,0xbe133f793ea8bf69bf003f503f28bf31,0x3f713f17bf1abf703d843f793efebf31,0x3eabbf4fbf4c3eb23f7f3e66bf5ebf39,0xbf5cbf5b3d6f3f693f4bbe29bf73bf39,0xbf033f053f803ed5bf1cbf7cbea23f31,0x3f3e3f7d3f02beb2bf72bf59be003f31,0x3f2bbe1cbf5dbf70bea53f083f7e3f39
.octa 0xbf19bf79bf66bed53e843f503f7f3f39,0xbf4dbe733edf3f693f773f15bd90bf31,0x3edc3f4f3f7e3f703f293e66be87bf31,0x3f673f173e0dbeb2bf40bf79bf77bf39,0xbe7cbf05bf3fbf69bf7ebf7cbf65bf39,0xbf78bf5bbf2abed5be073e293ee53f31,0x3d563e1c3e813eb23ee23f083f1d3f31,0x3f803f7d3f783f703f663f593f4a3f39
.octa 0x3f14beff3ed4bea73e70be103d3c3d49,0x3f51bf5e3f69bf723f79bf7d3f80bf80,0xbf6a3f7ebf7d3f66bf3c3f02be76bd49,0x3ed1be04be263ee1bf2e3f5cbf793f80,0xbe63be863f2fbf723f7dbf4d3ed93d49,0xbf7a3f77bf3b3ea73e20bf1a3f68bf80,0x3f80bf4b3e6a3ee1bf683f78bf18bd49,0xbce2bf1c3f79bf663ed73e7fbf4e3f80
.octa 0xbe2c3f5ebf703ea73f06bf7d3f3d3d49,0x3f7cbeffbeb43f72bf5a3e103f2dbf80,0xbf6f3e043f50bf663d233f5cbf5bbd49,0xbeb73f7ebf15bee13f80bf02bf043f80,0x3f08bf773d0a3f72bf17bf1a3f713d49,0xbf59be863f80bea7bf4f3f4d3eaebf80,0x3f3a3f1cbf5abee13f703e7fbf7dbd49,0x3f30bf4bbf073f663eb1bf78be193f80
.octa 0xbf513eff3f69bea7bf793e103f803d49,0x3f143f5ebed4bf723e703f7dbd3cbf80,0xbed1bf7ebe263f663f2ebf02bf79bd49,0xbf6a3e043f7d3ee1bf3cbf5c3e763f80,0x3f7a3e86bf3bbf72be203f4d3f683d49,0xbe63bf77bf2f3ea73f7d3f1abed9bf80,0x3ce23f4b3f793ee1bed7bf78bf4ebd49,0x3f803f1cbe6abf66bf68be7f3f183f80
.octa 0xbf7cbf5ebeb43ea73f5a3f7d3f2d3d49,0xbe2c3eff3f703f723f06be10bf3dbf80,0x3eb7be04bf15bf66bf80bf5cbf04bd49,0xbf6fbf7ebf50bee13d233f023f5b3f80,0x3f593f773f803f723f4f3f1a3eae3d49,0x3f083e86bd0abea7bf17bf4dbf71bf80,0xbf30bf1cbf07bee1beb1be7fbe19bd49,0x3f3a3f4b3f5a3f663f703f783f7d3f80
.octa 0x3f7bbf753f6dbf633f57bf493f39bf27,0x3e45be923ec0beec3f0bbf1f3f31bf42,0x3f6dbf473f10be9b3c7b3e8cbf0a3f42,0x3ec2bf213f54bf743f80bf763f58bf27,0x3f55bef43c173eecbf533f7ebf6f3f27,0x3f0ebf613f80bf633f11bdeebeba3f42,0x3f36bdd5bf0c3f74bf6e3efa3e32bf42,0x3f34bf7f3f56be9bbebd3f60bf7c3f27
.octa 0x3f0f3e92bf6c3f63be57bf1f3f80bf27,0x3f54bf753ec83eecbf7a3f49bcb0bf42,0x3ec53f21bf7c3e9b3f32bf763e5d3f42,0x3f6cbf47be3f3f74bf38be8c3f7abf27,0x3e4b3f61bf37beec3f7cbdeebf6a3f27,0x3f7bbef4bf333f633e38bf7e3ece3f42,0x3b493f7fbe51bf743ecb3f60bf13bf42,0x3f80bdd5bf7b3e9b3f6bbefabf523f27
.octa 0xbe453f753ec0bf63bf0b3f493f31bf27,0x3f7b3e92bf6dbeec3f573f1fbf39bf42,0xbec23f473f54be9bbf80be8c3f583f42,0x3f6d3f21bf10bf743c7b3f763f0abf27,0xbf0e3ef43f803eecbf11bf7ebeba3f27,0x3f553f61bc17bf63bf533dee3f6f3f42,0xbf343dd53f563f743ebdbefabf7cbf42,0x3f363f7f3f0cbe9bbf6ebf60be323f27
.octa 0xbf54be923ec83f633f7a3f1fbcb0bf27,0x3f0f3f753f6c3eecbe57bf49bf80bf42,0xbf6cbf21be3f3e9b3f383f763f7a3f42,0x3ec53f473f7c3f743f323e8cbe5dbf27,0xbf7bbf61bf33beecbe383dee3ece3f27,0x3e4b3ef43f373f633f7c3f7e3f6a3f42,0xbf80bf7fbf7bbf74bf6bbf60bf52bf42,0x3b493dd53e513e9b3ecb3efa3f133f27
.octa 0xbf1e3f0abeea3ebebe903e42bdc20000,0xbf493f57bf643f6ebf763f7bbf7f3f80,0xbf643f7cbf7e3f6bbf443f0dbe930000,0x3ee8be35bde83ecabf243f56bf753f80,0x3e8a3e5abf253f6ebf7f3f54bef00000,0x3f77bf7a3f43bebebddb3f10bf623f80,0x3f7fbf523e8d3ecabf633f7bbf220000,0xbd9dbf123f76bf6b3eed3e4ebf463f80
.octa 0x3df4bf573f74bebebef63f7bbf450000,0xbf7e3f0a3e9cbf6e3f61be42bf233f80,0xbf733e353f48bf6b3db63f56bf610000,0xbe9f3f7cbf1fbeca3f7fbf0dbef33f80,0xbefb3f7abda9bf6e3f213f10bf750000,0x3f5f3e5abf7f3ebe3f47bf54be963f80,0x3f423f12bf60beca3f743e4ebf7f0000,0x3f27bf52bef83f6b3e99bf7bbdcf3f80
.octa 0x3f49bf0abf643ebe3f76be42bf7f0000,0xbf1ebf573eea3f6ebe90bf7b3dc23f80,0xbee8bf7cbde83f6b3f24bf0dbf750000,0xbf643e353f7e3ecabf44bf563e933f80,0xbf77be5a3f433f6e3ddbbf54bf620000,0x3e8a3f7a3f25bebebf7fbf103ef03f80,0x3d9d3f523f763ecabeedbf7bbf460000,0x3f7f3f12be8dbf6bbf63be4e3f223f80
.octa 0x3f7e3f573e9cbebebf61bf7bbf230000,0x3df4bf0abf74bf6ebef63e423f453f80,0x3e9fbe35bf1fbf6bbf7fbf56bef30000,0xbf73bf7cbf48beca3db63f0d3f613f80,0xbf5fbf7abf7fbf6ebf47bf10be960000,0xbefbbe5a3da93ebe3f213f543f753f80,0xbf27bf12bef8becabe99be4ebdcf0000,0x3f423f523f603f6b3f743f7b3f7f3f80
.octa 0xbf7d3f79bf723f69bf5e3f50bf413f31,0xbe133e73bea83ed5bf003f15bf283f39,0x3f71bf4f3f1abeb23d843e66befe3f39,0x3eabbf173f4cbf703f7fbf793f5ebf31,0xbf5c3f05bd6fbed53f4bbf7c3f73bf31,0xbf033f5bbf803f69bf1c3e293ea2bf39,0x3f3ebe1cbf023f70bf723f083e00bf39,0x3f2bbf7d3f5dbeb2bea53f59bf7e3f31
.octa 0xbf19be733f66bf693e843f15bf7f3f31,0xbf4d3f79bedfbed53f77bf503d903f39,0x3edc3f17bf7e3eb23f29bf793e873f39,0x3f67bf4fbe0d3f70bf40be663f77bf31,0xbe7cbf5b3f3f3ed5bf7e3e293f65bf31,0xbf783f053f2abf69be073f7cbee5bf39,0x3d563f7dbe81bf703ee23f59bf1dbf39,0x3f80be1cbf783eb23f66bf08bf4a3f31
.octa 0x3e13bf79bea83f693f00bf50bf283f31,0xbf7dbe733f723ed5bf5ebf153f413f39,0xbeab3f4f3f4cbeb2bf7fbe663f5e3f39,0x3f713f17bf1abf703d843f793efebf31,0x3f03bf05bf80bed53f1c3f7c3ea2bf31,0xbf5cbf5b3d6f3f693f4bbe29bf73bf39,0xbf2b3e1c3f5d3f703ea5bf08bf7ebf39,0x3f3e3f7d3f02beb2bf72bf59be003f31
.octa 0x3f4d3e73bedfbf69bf77bf153d903f31,0xbf19bf79bf66bed53e843f503f7f3f39,0xbf67bf17be0d3eb23f403f793f773f39,0x3edc3f4f3f7e3f703f293e66be87bf31,0x3f783f5b3f2a3ed53e07be29bee5bf31,0xbe7cbf05bf3fbf69bf7ebf7cbf65bf39,0xbf80bf7dbf78bf70bf66bf59bf4abf39,0x3d563e1c3e813eb23ee23f083f1d3f31
.octa 0xbf513f5ebf693f72bf793f7dbf803f80,0x3f14beff3ed4bea73e70be103d3c3d49,0xbed13e043e26bee13f2ebf5c3f79bf80,0xbf6a3f7ebf7d3f66bf3c3f02be76bd49,0x3f7abf773f3bbea7be203f1abf683f80,0xbe63be863f2fbf723f7dbf4d3ed93d49,0x3ce23f1cbf793f66bed7be7f3f4ebf80,0x3f80bf4b3e6a3ee1bf683f78bf18bd49
.octa 0xbf7c3eff3eb4bf723f5abe10bf2d3f80,0xbe2c3f5ebf703ea73f06bf7d3f3d3d49,0x3eb7bf7e3f153ee1bf803f023f04bf80,0xbf6f3e043f50bf663d233f5cbf5bbd49,0x3f593e86bf803ea73f4fbf4dbeae3f80,0x3f08bf773d0a3f72bf17bf1a3f713d49,0xbf303f4b3f07bf66beb13f783e19bf80,0x3f3a3f1cbf5abee13f703e7fbf7dbd49
.octa 0xbf14bf5e3ed43f72be70bf7d3d3c3f80,0xbf513eff3f69bea7bf793e103f803d49,0x3f6abe04bf7dbee13f3c3f5cbe76bf80,0xbed1bf7ebe263f663f2ebf02bf79bd49,0x3e633f773f2fbea7bf7dbf1a3ed93f80,0x3f7a3e86bf3bbf72be203f4d3f683d49,0xbf80bf1c3e6a3f663f683e7fbf18bf80,0x3ce23f4b3f793ee1bed7bf78bf4ebd49
.octa 0x3e2cbeffbf70bf72bf063e103f3d3f80,0xbf7cbf5ebeb43ea73f5a3f7d3f2d3d49,0x3f6f3f7e3f503ee1bd23bf02bf5bbf80,0x3eb7be04bf15bf66bf80bf5cbf04bd49,0xbf08be863d0a3ea73f173f4d3f713f80,0x3f593f773f803f723f4f3f1a3eae3d49,0xbf3abf4bbf5abf66bf70bf78bf7dbf80,0xbf30bf1cbf07bee1beb1be7fbe19bd49
.octa 0xbe453e92bec03eecbf0b3f1fbf313f42,0x3f7bbf753f6dbf633f57bf493f39bf27,0xbec23f21bf543f74bf803f76bf583f27,0x3f6dbf473f10be9b3c7b3e8cbf0a3f42,0xbf0e3f61bf803f63bf113dee3ebabf42,0x3f55bef43c173eecbf533f7ebf6f3f27,0xbf343f7fbf563e9b3ebdbf603f7cbf27,0x3f36bdd5bf0c3f74bf6e3efa3e32bf42
.octa 0xbf543f75bec8beec3f7abf493cb03f42,0x3f0f3e92bf6c3f63be57bf1f3f80bf27,0xbf6c3f473e3fbf743f383e8cbf7a3f27,0x3ec53f21bf7c3e9b3f32bf763e5d3f42,0xbf7b3ef43f33bf63be383f7ebecebf42,0x3e4b3f61bf37beec3f7cbdeebf6a3f27,0xbf803dd53f7bbe9bbf6b3efa3f52bf27,0x3b493f7fbe51bf743ecb3f60bf13bf42
.octa 0xbf7bbe923f6d3eecbf57bf1f3f393f42,0xbe453f753ec0bf63bf0b3f493f31bf27,0xbf6dbf213f103f74bc7bbf76bf0a3f27,0xbec23f473f54be9bbf80be8c3f583f42,0xbf55bf613c173f633f53bdeebf6fbf42,0xbf0e3ef43f803eecbf11bf7ebeba3f27,0xbf36bf7fbf0c3e9b3f6e3f603e32bf27,0xbf343dd53f563f743ebdbefabf7cbf42
.octa 0xbf0fbf75bf6cbeec3e573f493f803f42,0xbf54be923ec83f633f7a3f1fbcb0bf27,0xbec5bf47bf7cbf74bf32be8c3e5d3f27,0xbf6cbf21be3f3e9b3f383f763f7a3f42,0xbe4bbef4bf37bf63bf7cbf7ebf6abf42,0xbf7bbf61bf33beecbe383dee3ece3f27,0xbb49bdd5be51be9bbecbbefabf13bf27,0xbf80bf7fbf7bbf74bf6bbf60bf52bf42
```
